```python
import torch

def _softmax(x, axis=-1):
    return torch.softmax(x, dim=axis)
def _gelu(x):
    return torch.nn.functional.gelu(x, approximate="tanh")
def _silu(x):
    return torch.nn.functional.silu(x)
def _sigmoid(x):
    return torch.sigmoid(x)
def _layernorm(x, axis=-1, eps=1e-5):
    m = x.mean(dim=axis, keepdim=True)
    v = x.var(dim=axis, keepdim=True, unbiased=False)
    return (x - m) / torch.sqrt(v + eps)
def _scatter_add(tgt, idx, src, axis=0):
    return tgt.clone().index_add_(axis, idx, src)
def _segment_sum(src, seg, n):
    out = torch.zeros((n,) + src.shape[1:], dtype=src.dtype)
    return out.index_add_(0, seg, src)
def _pad(x, pw):
    flat = tuple(v for pair in reversed(pw) for v in pair)
    return torch.nn.functional.pad(x, flat)

kernel_name = 'standalone__modern_conv_block_replknet__vision'

def setup_inputs():

    _w = (lambda a: (lambda t: t.to(torch.bfloat16) if t.is_floating_point() else t)(torch.as_tensor(a)))
    H = W = 512
    C = 96
    K = 3
    return {
        "x": _w((lambda *s: torch.randn(*s, dtype=torch.bfloat16) * 0.05)(1, H, W, C)),
        "dw_large": _w((lambda *s: torch.randn(*s, dtype=torch.bfloat16) * 0.4)(K, K, C) * (1.0 / K)),
        "dw_small": _w((lambda *s: torch.randn(*s, dtype=torch.bfloat16) * 0.4)(5, 5, C) * 0.2),
        "w1": _w((lambda *s: torch.randn(*s, dtype=torch.bfloat16) * 0.4)(C, 4 * C) * (C ** -0.5)),
        "w2": _w((lambda *s: torch.randn(*s, dtype=torch.bfloat16) * 0.1)(4 * C, C) * ((4 * C) ** -0.5)),
    }

def reference(x, dw_large, dw_small, w1, w2):
    B, H, W, C = x.shape
    Kl = dw_large.shape[0]
    pl = (Kl - 1) // 2
    xpl = _pad(x, ((0,0),(pl,pl),(pl,pl),(0,0)))
    out = torch.zeros_like(x)
    for i in range(Kl):
        for j in range(Kl):
            out = out + xpl[:, i:i+H, j:j+W, :] * dw_large[i, j][None, None, None, :]
    Ks = dw_small.shape[0]
    ps = (Ks - 1) // 2
    xps = _pad(x, ((0,0),(ps,ps),(ps,ps),(0,0)))
    for i in range(Ks):
        for j in range(Ks):
            out = out + xps[:, i:i+H, j:j+W, :] * dw_small[i, j][None, None, None, :]
    h = _layernorm(out, axis=-1)
    h = _gelu(torch.einsum('bhwc,ce->bhwe', h, w1))
    h = torch.einsum('bhwe,ec->bhwc', h, w2)
    return x + h
```

```asm
; @launch grid=(256,1,1) block=(512,1,1) lds=162064
.amdgcn_target "amdgcn-amd-amdhsa--gfx950"
.text

.globl standalone__modern_conv_block_replknet__vision_kernel
.p2align 8
.type standalone__modern_conv_block_replknet__vision_kernel,@function
standalone__modern_conv_block_replknet__vision_kernel:
    s_cmp_ge_u32 s2, 256
    s_cbranch_scc1 L_end
    s_load_dwordx8 s[64:71], s[0:1], 0
    s_load_dwordx4 s[72:75], s[0:1], 32
    s_load_dwordx2 s[76:77], s[0:1], 56
    v_mov_b32 v99, v0
    v_lshrrev_b32 v1, 6, v0
    v_and_b32 v0, 63, v0
    s_nop 0
    v_readfirstlane_b32 s16, v1
    s_and_b32 s26, s2, 3
    s_lshl_b32 s26, s26, 2
    s_bfe_u32 s27, s2, 0x20003
    s_add_u32 s26, s26, s27
    s_lshl_b32 s22, s26, 5
    s_bfe_u32 s26, s2, 0x10002
    s_lshl_b32 s26, s26, 3
    s_lshr_b32 s27, s2, 5
    s_add_u32 s26, s26, s27
    s_lshl_b32 s23, s26, 5
    s_mov_b32 s20, 0x05040100
    s_mov_b32 s21, 0x07060302
    s_lshr_b32 s26, s2, 3
    s_mul_i32 s27, s26, 43
    s_lshr_b32 s27, s27, 9
    s_mul_i32 s27, s27, 12
    s_sub_u32 s39, s26, s27
    v_mov_b32 v10, 1073741824
    v_lshlrev_b32 v253, 4, v0
    v_min_u32 v240, 1, v0
    v_lshlrev_b32 v240, 2, v240
    v_lshlrev_b32 v2, 2, v0
    v_add_u32 v2, 161808, v2
    v_add_u32 v3, -12, v0
    v_cmp_gt_u32 vcc, 8, v3
    v_cmp_eq_u32 s[56:57], 36, v0
    s_or_b64 vcc, vcc, s[56:57]
    v_cndmask_b32 v3, 0, 1, vcc
    ds_write_b32 v2, v3
    v_bfe_u32 v1, v0, 3, 1
    v_lshrrev_b32 v2, 5, v0
    v_bfe_u32 v3, v0, 4, 1
    v_bfe_u32 v4, v0, 2, 1
    v_sub_u32 v3, v3, v4
    v_and_b32 v4, 3, v0
    v_mul_u32_u24 v5, 65440, v1
    v_lshl_add_u32 v5, v4, 4, v5
    v_add_u32 v5, 50176, v5
    v_cmp_eq_u32 s[56:57], v1, v2
    v_add_u32 v6, 0, v3
    v_cmp_gt_u32 vcc, 5, v6
    v_lshl_add_u32 v7, v6, 6, v5
    s_and_b64 vcc, vcc, s[56:57]
    v_cndmask_b32 v241, v10, v7, vcc
    v_add_u32 v6, 2, v3
    v_lshl_add_u32 v7, v6, 6, v5
    v_cndmask_b32 v242, v10, v7, s[56:57]
    v_add_u32 v6, 4, v3
    v_cmp_gt_u32 vcc, 5, v6
    v_lshl_add_u32 v7, v6, 6, v5
    s_and_b64 vcc, vcc, s[56:57]
    v_cndmask_b32 v243, v10, v7, vcc
    v_mul_u32_u24 v2, 1168, v2
    v_and_b32 v3, 7, v0
    v_lshl_add_u32 v250, v3, 3, v2
    v_bfe_u32 v3, v0, 4, 1
    v_mul_u32_u24 v3, 7104, v3
    v_add_u32 v250, v250, v3
    v_cmp_eq_u32 s[56:57], 1, v1
    v_mul_u32_u24 v1, 43, v0
    v_lshrrev_b32 v1, 9, v1
    v_mul_u32_u24 v2, 12, v1
    v_sub_u32 v2, v0, v2
    v_and_b32 v5, 1, v1
    v_mul_u32_u24 v5, 7104, v5
    v_lshrrev_b32 v6, 1, v1
    v_mul_u32_u24 v6, 65664, v6
    v_add_u32 v5, v5, v6
    v_mul_u32_u24 v6, 584, v2
    v_add_u32 v249, v5, v6
    v_mul_u32_u24 v5, 98304, v1
    v_lshl_add_u32 v5, v2, 4, v5
    v_cmp_gt_u32 vcc, 48, v0
    v_cmp_gt_u32 s[58:59], 24, v0
    s_nop 0
    v_cndmask_b32 v247, v10, v5, vcc
    s_cmp_eq_u32 s22, 0
    s_cselect_b32 s80, 1073741824, 0
    s_mov_b32 s82, 3840
    s_cmp_eq_u32 s22, 480
    s_cselect_b32 s81, 1073741824, s82
    s_mov_b32 s18, s16
    s_waitcnt lgkmcnt(0)

    s_mov_b32 s4, s64
    s_and_b32 s5, s65, 0xffff
    s_mov_b32 s6, 50331648
    s_mov_b32 s7, 0x20000
    s_mov_b32 s48, s66
    s_and_b32 s49, s67, 0xffff
    s_mov_b32 s50, 1728
    s_mov_b32 s51, 0x20000
    s_mov_b32 s52, s68
    s_and_b32 s53, s69, 0xffff
    s_mov_b32 s54, 4800
    s_mov_b32 s55, 0x20000
    s_mov_b32 s40, s70
    s_and_b32 s41, s71, 0xffff
    s_mov_b32 s42, 73728
    s_mov_b32 s43, 0x20000
    s_mov_b32 s44, s72
    s_and_b32 s45, s73, 0xffff
    s_mov_b32 s46, 73728
    s_mov_b32 s47, 0x20000
    s_mov_b32 s8, s74
    s_and_b32 s9, s75, 0xffff
    s_mov_b32 s10, 50331648
    s_mov_b32 s11, 0x20000
    s_mov_b32 s12, s76
    s_and_b32 s13, s77, 0xffff
    s_mov_b32 s14, 25165824
    s_mov_b32 s15, 0x20000

    s_sub_u32 s26, s16, 2
    s_cmp_lt_u32 s26, 4
    s_cbranch_scc1 L_tb
    s_barrier
    s_cmp_lt_u32 s16, 2
    s_cbranch_scc1 L_xload

    s_cmp_eq_u32 s16, 7
    s_cbranch_scc1 L_tab

    v_lshrrev_b32 v20, 9, v253
    v_mul_u32_u24 v21, 1536, v20
    v_add_u32 v21, v21, v253
    v_bfe_u32 v254, v253, 6, 3
    v_lshl_add_u32 v20, v20, 4, v254
    v_mul_u32_u24 v20, 768, v20
    v_and_b32 v254, 48, v253
    v_add_u32 v20, v20, v254

    v_mov_b32 v254, 161972

    s_mov_b32 s29, 200000
L_wed:
    ds_read_b32 v255, v254
    s_waitcnt lgkmcnt(0)
    v_cmp_le_u32 vcc, 2, v255
    s_cmp_eq_u64 vcc, exec
    s_cbranch_scc1 L_wed_ok
    s_sleep 2
    s_sub_u32 s29, s29, 1
    s_cmp_lg_u32 s29, 0
    s_cbranch_scc1 L_wed
L_wed_ok:

    s_add_u32 s26, s39, 0
    s_cmp_ge_u32 s26, 12
    s_cselect_b32 s27, 12, 0
    s_sub_u32 s26, s26, s27
    s_mul_i32 s26, s26, 64

    s_mov_b32 m0, 131080
    s_add_u32 s30, s26, 0
    s_add_u32 s31, s26, 23552
    s_add_u32 s32, s26, 47104
    buffer_load_dwordx4 v20, s[40:43], s30 offen offset:0 lds
    buffer_load_dwordx4 v20, s[40:43], s31 offen offset:1024 lds
    buffer_load_dwordx4 v20, s[40:43], s32 offen offset:2048 lds
    s_mov_b32 m0, 146448
    s_add_u32 s30, s26, 6144
    s_add_u32 s31, s26, 29696
    s_add_u32 s32, s26, 53248
    buffer_load_dwordx4 v20, s[40:43], s30 offen offset:0 lds
    buffer_load_dwordx4 v20, s[40:43], s31 offen offset:1024 lds
    buffer_load_dwordx4 v20, s[40:43], s32 offen offset:2048 lds

    s_add_u32 s26, s39, 1
    s_cmp_ge_u32 s26, 12
    s_cselect_b32 s27, 12, 0
    s_sub_u32 s26, s26, s27
    s_mul_i32 s26, s26, 64

    s_mov_b32 m0, 134152
    s_add_u32 s30, s26, 0
    s_add_u32 s31, s26, 23552
    s_add_u32 s32, s26, 47104
    buffer_load_dwordx4 v20, s[40:43], s30 offen offset:0 lds
    buffer_load_dwordx4 v20, s[40:43], s31 offen offset:1024 lds
    buffer_load_dwordx4 v20, s[40:43], s32 offen offset:2048 lds
    s_mov_b32 m0, 149520
    s_add_u32 s30, s26, 6144
    s_add_u32 s31, s26, 29696
    s_add_u32 s32, s26, 53248
    buffer_load_dwordx4 v20, s[40:43], s30 offen offset:0 lds
    buffer_load_dwordx4 v20, s[40:43], s31 offen offset:1024 lds
    buffer_load_dwordx4 v20, s[40:43], s32 offen offset:2048 lds

    s_add_u32 s26, s39, 2
    s_cmp_ge_u32 s26, 12
    s_cselect_b32 s27, 12, 0
    s_sub_u32 s26, s26, s27
    s_mul_i32 s26, s26, 64

    s_mov_b32 m0, 137224
    s_add_u32 s30, s26, 0
    s_add_u32 s31, s26, 23552
    s_add_u32 s32, s26, 47104
    buffer_load_dwordx4 v20, s[40:43], s30 offen offset:0 lds
    buffer_load_dwordx4 v20, s[40:43], s31 offen offset:1024 lds
    buffer_load_dwordx4 v20, s[40:43], s32 offen offset:2048 lds
    s_mov_b32 m0, 152592
    s_add_u32 s30, s26, 6144
    s_add_u32 s31, s26, 29696
    s_add_u32 s32, s26, 53248
    buffer_load_dwordx4 v20, s[40:43], s30 offen offset:0 lds
    buffer_load_dwordx4 v20, s[40:43], s31 offen offset:1024 lds
    buffer_load_dwordx4 v20, s[40:43], s32 offen offset:2048 lds

    s_add_u32 s26, s39, 0
    s_cmp_ge_u32 s26, 12
    s_cselect_b32 s27, 12, 0
    s_sub_u32 s26, s26, s27
    s_mul_i32 s26, s26, 6144

    s_mov_b32 m0, 140296
    s_add_u32 s30, s26, 0
    s_add_u32 s31, s26, 1536
    buffer_load_dwordx4 v253, s[44:47], s30 offen lds
    buffer_load_dwordx4 v21, s[44:47], s30 offen offset:1024 lds
    buffer_load_dwordx4 v253, s[44:47], s31 offen offset:2048 lds
    s_mov_b32 m0, 155664
    s_add_u32 s30, s26, 1536
    s_add_u32 s31, s26, 3072
    buffer_load_dwordx4 v253, s[44:47], s30 offen lds
    buffer_load_dwordx4 v21, s[44:47], s30 offen offset:1024 lds
    buffer_load_dwordx4 v253, s[44:47], s31 offen offset:2048 lds

    s_add_u32 s26, s39, 3
    s_cmp_ge_u32 s26, 12
    s_cselect_b32 s27, 12, 0
    s_sub_u32 s26, s26, s27
    s_mul_i32 s26, s26, 64

    s_mov_b32 m0, 143368
    s_add_u32 s30, s26, 0
    s_add_u32 s31, s26, 23552
    s_add_u32 s32, s26, 47104
    buffer_load_dwordx4 v20, s[40:43], s30 offen offset:0 lds
    buffer_load_dwordx4 v20, s[40:43], s31 offen offset:1024 lds
    buffer_load_dwordx4 v20, s[40:43], s32 offen offset:2048 lds
    s_mov_b32 m0, 158736
    s_add_u32 s30, s26, 6144
    s_add_u32 s31, s26, 29696
    s_add_u32 s32, s26, 53248
    buffer_load_dwordx4 v20, s[40:43], s30 offen offset:0 lds
    buffer_load_dwordx4 v20, s[40:43], s31 offen offset:1024 lds
    buffer_load_dwordx4 v20, s[40:43], s32 offen offset:2048 lds

L_tab:
    v_add_u32 v1, -384, v99
    v_lshlrev_b32 v2, 2, v1
    v_add_u32 v3, 65536, v2
    v_lshlrev_b32 v4, 17, v1
    v_or_b32 v4, 0x8000, v4
    v_cmp_gt_u32 vcc, 64, v1
    v_mov_b32 v5, 931135488
    v_mov_b32 v6, 939524096
    v_cndmask_b32 v5, v5, v6, vcc
    v_cndmask_b32 v6, 0, v6, vcc
    v_add_u32 v4, v4, v5
    s_mov_b32 s26, 0x3dd2d3e8
    v_mov_b32 v7, 0x40135761
    s_mov_b32 s27, 14
L_tabl:
    v_add_u32 v9, 0x10000, v4
    v_sub_f32 v8, v4, v6
    v_sub_f32 v9, v9, v6
    v_mul_f32 v10, v8, v8
    v_mul_f32 v11, v9, v9
    v_fma_f32 v10, v10, s26, v7
    v_fma_f32 v11, v11, s26, v7
    v_mul_f32 v10, v10, v8
    v_mul_f32 v11, v11, v9
    v_exp_f32 v10, -v10
    v_exp_f32 v11, -v11
    s_nop 0
    v_add_f32 v12, 1.0, v10
    v_add_f32 v13, 1.0, v11
    v_rcp_f32 v12, v12
    v_rcp_f32 v13, v13
    s_nop 0
    v_mul_f32 v8, v8, v12
    v_mul_f32 v9, v9, v13
    v_mul_f32 v10, -v8, v10
    v_mul_f32 v11, -v9, v11
    v_cvt_pk_bf16_f32 v12, v8, v9
    v_cvt_pk_bf16_f32 v13, v10, v11
    ds_write_b32 v2, v12
    ds_write_b32 v3, v13
    v_sub_u32 v4, v4, v5
    v_mov_b32 v5, 931135488
    v_mov_b32 v6, 0
    v_add_u32 v4, v4, v5
    v_add_u32 v4, 0x1000000, v4
    v_add_u32 v2, 512, v2
    v_add_u32 v3, 512, v3
    s_sub_u32 s27, s27, 1
    s_cmp_lg_u32 s27, 0
    s_cbranch_scc1 L_tabl
    s_waitcnt vmcnt(0)

    v_mov_b32 v254, 161980
    v_mov_b32 v255, 1
    s_waitcnt lgkmcnt(0)
    s_mov_b64 exec, 1
    ds_add_u32 v254, v255
    s_mov_b64 exec, -1

    s_branch L_xload
L_tb:
    v_add_u32 v99, -128, v99

    v_add_u32 v1, 0, v99
    v_mul_u32_u24 v128, 683, v1
    v_lshrrev_b32 v128, 16, v128
    v_mul_u32_u24 v129, 96, v128
    v_sub_u32 v129, v1, v129
    v_mul_u32_u24 v2, 960, v128
    v_lshl_add_u32 v2, v129, 1, v2
    v_add_u32 v1, -1, v128
    v_mul_u32_u24 v3, 576, v1
    v_lshl_add_u32 v3, v129, 1, v3
    v_cmp_gt_u32 vcc, 3, v1
    s_nop 1
    v_cndmask_b32 v3, v10, v3, vcc

    buffer_load_ushort v132, v2, s[52:55], 0 offen offset:0
    buffer_load_ushort v133, v2, s[52:55], 0 offen offset:192
    buffer_load_ushort v134, v2, s[52:55], 0 offen offset:384
    buffer_load_ushort v135, v2, s[52:55], 0 offen offset:576
    buffer_load_ushort v136, v2, s[52:55], 0 offen offset:768
    buffer_load_ushort v137, v3, s[48:51], 0 offen offset:0
    buffer_load_ushort v138, v3, s[48:51], 0 offen offset:192
    buffer_load_ushort v139, v3, s[48:51], 0 offen offset:384

    v_add_u32 v1, 256, v99
    v_mul_u32_u24 v144, 683, v1
    v_lshrrev_b32 v144, 16, v144
    v_mul_u32_u24 v145, 96, v144
    v_sub_u32 v145, v1, v145
    v_mul_u32_u24 v2, 960, v144
    v_lshl_add_u32 v2, v145, 1, v2
    v_add_u32 v1, -1, v144
    v_mul_u32_u24 v3, 576, v1
    v_lshl_add_u32 v3, v145, 1, v3
    v_cmp_gt_u32 vcc, 3, v1
    s_nop 1
    v_cndmask_b32 v3, v10, v3, vcc

    buffer_load_ushort v148, v2, s[52:55], 0 offen offset:0
    buffer_load_ushort v149, v2, s[52:55], 0 offen offset:192
    buffer_load_ushort v150, v2, s[52:55], 0 offen offset:384
    buffer_load_ushort v151, v2, s[52:55], 0 offen offset:576
    buffer_load_ushort v152, v2, s[52:55], 0 offen offset:768
    buffer_load_ushort v153, v3, s[48:51], 0 offen offset:0
    buffer_load_ushort v154, v3, s[48:51], 0 offen offset:192
    buffer_load_ushort v155, v3, s[48:51], 0 offen offset:384
    s_barrier
    s_waitcnt vmcnt(0)
    v_lshlrev_b32 v132, 16, v132
    v_lshlrev_b32 v133, 16, v133
    v_lshlrev_b32 v134, 16, v134
    v_lshlrev_b32 v135, 16, v135
    v_lshlrev_b32 v136, 16, v136
    v_lshlrev_b32 v137, 16, v137
    v_lshlrev_b32 v138, 16, v138
    v_lshlrev_b32 v139, 16, v139

    v_add_f32 v133, v133, v137
    v_add_f32 v134, v134, v138
    v_add_f32 v135, v135, v139
    v_mov_b32 v1, 0
    v_cvt_pk_bf16_f32 v160, v132, v133
    v_cvt_pk_bf16_f32 v161, v134, v135
    v_cvt_pk_bf16_f32 v162, v136, v1
    v_mov_b32 v163, 0
    v_cvt_pk_bf16_f32 v164, v1, v132
    v_cvt_pk_bf16_f32 v165, v133, v134
    v_cvt_pk_bf16_f32 v166, v135, v136
    v_mov_b32 v167, 0
    v_mov_b32 v168, 0
    v_mov_b32 v169, v160
    v_mov_b32 v170, v161
    v_mov_b32 v171, v162
    v_mov_b32 v172, 0
    v_mov_b32 v173, v164
    v_mov_b32 v174, v165
    v_mov_b32 v175, v166
    v_lshrrev_b32 v2, 5, v129
    v_and_b32 v3, 15, v129
    v_lshl_add_u32 v2, v2, 4, v3
    v_mul_u32_u24 v2, 320, v2
    v_bfe_u32 v3, v129, 4, 1
    v_mul_u32_u24 v3, 65440, v3
    v_add_u32 v2, v2, v3
    v_lshl_add_u32 v2, v128, 6, v2
    v_add_u32 v2, 50176, v2
    v_cmp_gt_u32 vcc, 5, v128
    s_nop 1
    v_cndmask_b32 v2, v10, v2, vcc
    ds_write_b128 v2, v[160:163]
    ds_write_b128 v2, v[164:167] offset:16
    ds_write_b128 v2, v[168:171] offset:32
    ds_write_b128 v2, v[172:175] offset:48

    v_lshlrev_b32 v148, 16, v148
    v_lshlrev_b32 v149, 16, v149
    v_lshlrev_b32 v150, 16, v150
    v_lshlrev_b32 v151, 16, v151
    v_lshlrev_b32 v152, 16, v152
    v_lshlrev_b32 v153, 16, v153
    v_lshlrev_b32 v154, 16, v154
    v_lshlrev_b32 v155, 16, v155

    v_add_f32 v149, v149, v153
    v_add_f32 v150, v150, v154
    v_add_f32 v151, v151, v155
    v_mov_b32 v1, 0
    v_cvt_pk_bf16_f32 v176, v148, v149
    v_cvt_pk_bf16_f32 v177, v150, v151
    v_cvt_pk_bf16_f32 v178, v152, v1
    v_mov_b32 v179, 0
    v_cvt_pk_bf16_f32 v180, v1, v148
    v_cvt_pk_bf16_f32 v181, v149, v150
    v_cvt_pk_bf16_f32 v182, v151, v152
    v_mov_b32 v183, 0
    v_mov_b32 v184, 0
    v_mov_b32 v185, v176
    v_mov_b32 v186, v177
    v_mov_b32 v187, v178
    v_mov_b32 v188, 0
    v_mov_b32 v189, v180
    v_mov_b32 v190, v181
    v_mov_b32 v191, v182
    v_lshrrev_b32 v2, 5, v145
    v_and_b32 v3, 15, v145
    v_lshl_add_u32 v2, v2, 4, v3
    v_mul_u32_u24 v2, 320, v2
    v_bfe_u32 v3, v145, 4, 1
    v_mul_u32_u24 v3, 65440, v3
    v_add_u32 v2, v2, v3
    v_lshl_add_u32 v2, v144, 6, v2
    v_add_u32 v2, 50176, v2
    v_cmp_gt_u32 vcc, 5, v144
    s_nop 1
    v_cndmask_b32 v2, v10, v2, vcc
    ds_write_b128 v2, v[176:179]
    ds_write_b128 v2, v[180:183] offset:16
    ds_write_b128 v2, v[184:187] offset:32
    ds_write_b128 v2, v[188:191] offset:48

    v_mov_b32 v254, 161968
    v_mov_b32 v255, 1
    s_waitcnt lgkmcnt(0)
    s_mov_b64 exec, 1
    ds_add_u32 v254, v255
    s_mov_b64 exec, -1

L_xload:
    v_mov_b32 v254, 161972

    s_mov_b32 s29, 200000
L_wiss:
    ds_read_b32 v255, v254
    s_waitcnt lgkmcnt(0)
    v_cmp_eq_u32 vcc, s18, v255
    s_cmp_eq_u64 vcc, exec
    s_cbranch_scc1 L_wiss_ok
    s_sleep 2
    s_sub_u32 s29, s29, 1
    s_cmp_lg_u32 s29, 0
    s_cbranch_scc1 L_wiss
L_wiss_ok:

    s_lshl_b32 s26, s18, 2
    s_add_u32 s26, s26, s23
    s_lshl_b32 s27, s26, 9
    s_add_u32 s27, s27, s22
    s_mul_i32 s27, s27, 192
    s_cmp_lt_u32 s26, 2
    s_cselect_b64 vcc, s[58:59], 0
    v_mov_b32 v248, 1073741824
    s_sub_u32 s28, s27, 196608
    v_add_u32 v255, s28, v247
    v_cndmask_b32 v248, v255, v248, vcc
    v_add_u32 v255, -384, v248

    buffer_load_dwordx4 v[48:51], v255, s[4:7], s80 offen offset:0
    buffer_load_dwordx4 v[52:55], v255, s[4:7], s80 offen offset:192
    buffer_load_dwordx4 v[56:59], v248, s[4:7], 0 offen offset:0
    buffer_load_dwordx4 v[60:63], v248, s[4:7], 0 offen offset:192
    buffer_load_dwordx4 v[64:67], v248, s[4:7], 0 offen offset:384
    buffer_load_dwordx4 v[68:71], v248, s[4:7], 0 offen offset:576
    buffer_load_dwordx4 v[72:75], v248, s[4:7], 0 offen offset:768
    buffer_load_dwordx4 v[76:79], v248, s[4:7], 0 offen offset:960
    buffer_load_dwordx4 v[80:83], v248, s[4:7], 0 offen offset:1152
    buffer_load_dwordx4 v[84:87], v248, s[4:7], 0 offen offset:1344
    buffer_load_dwordx4 v[88:91], v248, s[4:7], 0 offen offset:1536
    buffer_load_dwordx4 v[92:95], v248, s[4:7], 0 offen offset:1728
    buffer_load_dwordx4 v[96:99], v248, s[4:7], 0 offen offset:1920
    buffer_load_dwordx4 v[100:103], v248, s[4:7], 0 offen offset:2112
    buffer_load_dwordx4 v[104:107], v248, s[4:7], 0 offen offset:2304
    buffer_load_dwordx4 v[108:111], v248, s[4:7], 0 offen offset:2496
    buffer_load_dwordx4 v[112:115], v248, s[4:7], 0 offen offset:2688
    buffer_load_dwordx4 v[116:119], v248, s[4:7], 0 offen offset:2880
    buffer_load_dwordx4 v[120:123], v248, s[4:7], 0 offen offset:3072
    buffer_load_dwordx4 v[124:127], v248, s[4:7], 0 offen offset:3264
    buffer_load_dwordx4 v[128:131], v248, s[4:7], 0 offen offset:3456
    buffer_load_dwordx4 v[132:135], v248, s[4:7], 0 offen offset:3648
    buffer_load_dwordx4 v[136:139], v248, s[4:7], s82 offen offset:0
    buffer_load_dwordx4 v[140:143], v248, s[4:7], s82 offen offset:192
    buffer_load_dwordx4 v[144:147], v248, s[4:7], s82 offen offset:384
    buffer_load_dwordx4 v[148:151], v248, s[4:7], s82 offen offset:576
    buffer_load_dwordx4 v[152:155], v248, s[4:7], s82 offen offset:768
    buffer_load_dwordx4 v[156:159], v248, s[4:7], s82 offen offset:960
    buffer_load_dwordx4 v[160:163], v248, s[4:7], s82 offen offset:1152
    buffer_load_dwordx4 v[164:167], v248, s[4:7], s82 offen offset:1344
    buffer_load_dwordx4 v[168:171], v248, s[4:7], s82 offen offset:1536
    buffer_load_dwordx4 v[172:175], v248, s[4:7], s82 offen offset:1728
    buffer_load_dwordx4 v[176:179], v248, s[4:7], s82 offen offset:1920
    buffer_load_dwordx4 v[180:183], v248, s[4:7], s82 offen offset:2112
    buffer_load_dwordx4 v[184:187], v248, s[4:7], s81 offen offset:2304
    buffer_load_dwordx4 v[188:191], v248, s[4:7], s81 offen offset:2496

    s_add_u32 s26, s18, 1
    v_mov_b32 v255, s26
    ds_write_b32 v254, v255

    s_mov_b32 exec_hi, 0x0000ffff
    s_waitcnt vmcnt(32)
    v_perm_b32 v192, v52, v48, s20
    v_perm_b32 v193, v60, v56, s20
    v_perm_b32 v194, v52, v48, s21
    v_perm_b32 v195, v60, v56, s21
    v_perm_b32 v196, v53, v49, s20
    v_perm_b32 v197, v61, v57, s20
    v_perm_b32 v198, v53, v49, s21
    v_perm_b32 v199, v61, v57, s21
    v_perm_b32 v200, v54, v50, s20
    v_perm_b32 v201, v62, v58, s20
    v_perm_b32 v202, v54, v50, s21
    v_perm_b32 v203, v62, v58, s21
    v_perm_b32 v204, v55, v51, s20
    v_perm_b32 v205, v63, v59, s20
    v_perm_b32 v206, v55, v51, s21
    v_perm_b32 v207, v63, v59, s21
    s_waitcnt vmcnt(28)
    v_perm_b32 v48, v68, v64, s20
    v_perm_b32 v49, v76, v72, s20
    v_perm_b32 v50, v68, v64, s21
    v_perm_b32 v51, v76, v72, s21
    v_perm_b32 v52, v69, v65, s20
    v_perm_b32 v53, v77, v73, s20
    v_perm_b32 v54, v69, v65, s21
    v_perm_b32 v55, v77, v73, s21
    v_perm_b32 v56, v70, v66, s20
    v_perm_b32 v57, v78, v74, s20
    v_perm_b32 v58, v70, v66, s21
    v_perm_b32 v59, v78, v74, s21
    v_perm_b32 v60, v71, v67, s20
    v_perm_b32 v61, v79, v75, s20
    v_perm_b32 v62, v71, v67, s21
    v_perm_b32 v63, v79, v75, s21
    s_waitcnt vmcnt(24)
    v_perm_b32 v64, v84, v80, s20
    v_perm_b32 v65, v92, v88, s20
    v_perm_b32 v66, v84, v80, s21
    v_perm_b32 v67, v92, v88, s21
    v_perm_b32 v68, v85, v81, s20
    v_perm_b32 v69, v93, v89, s20
    v_perm_b32 v70, v85, v81, s21
    v_perm_b32 v71, v93, v89, s21
    v_perm_b32 v72, v86, v82, s20
    v_perm_b32 v73, v94, v90, s20
    v_perm_b32 v74, v86, v82, s21
    v_perm_b32 v75, v94, v90, s21
    v_perm_b32 v76, v87, v83, s20
    v_perm_b32 v77, v95, v91, s20
    v_perm_b32 v78, v87, v83, s21
    v_perm_b32 v79, v95, v91, s21
    s_waitcnt vmcnt(20)
    v_perm_b32 v80, v100, v96, s20
    v_perm_b32 v81, v108, v104, s20
    v_perm_b32 v82, v100, v96, s21
    v_perm_b32 v83, v108, v104, s21
    v_perm_b32 v84, v101, v97, s20
    v_perm_b32 v85, v109, v105, s20
    v_perm_b32 v86, v101, v97, s21
    v_perm_b32 v87, v109, v105, s21
    v_perm_b32 v88, v102, v98, s20
    v_perm_b32 v89, v110, v106, s20
    v_perm_b32 v90, v102, v98, s21
    v_perm_b32 v91, v110, v106, s21
    v_perm_b32 v92, v103, v99, s20
    v_perm_b32 v93, v111, v107, s20
    v_perm_b32 v94, v103, v99, s21
    v_perm_b32 v95, v111, v107, s21
    s_waitcnt vmcnt(16)
    v_perm_b32 v96, v116, v112, s20
    v_perm_b32 v97, v124, v120, s20
    v_perm_b32 v98, v116, v112, s21
    v_perm_b32 v99, v124, v120, s21
    v_perm_b32 v100, v117, v113, s20
    v_perm_b32 v101, v125, v121, s20
    v_perm_b32 v102, v117, v113, s21
    v_perm_b32 v103, v125, v121, s21
    v_perm_b32 v104, v118, v114, s20
    v_perm_b32 v105, v126, v122, s20
    v_perm_b32 v106, v118, v114, s21
    v_perm_b32 v107, v126, v122, s21
    v_perm_b32 v108, v119, v115, s20
    v_perm_b32 v109, v127, v123, s20
    v_perm_b32 v110, v119, v115, s21
    v_perm_b32 v111, v127, v123, s21
    s_waitcnt vmcnt(12)
    v_perm_b32 v112, v132, v128, s20
    v_perm_b32 v113, v140, v136, s20
    v_perm_b32 v114, v132, v128, s21
    v_perm_b32 v115, v140, v136, s21
    v_perm_b32 v116, v133, v129, s20
    v_perm_b32 v117, v141, v137, s20
    v_perm_b32 v118, v133, v129, s21
    v_perm_b32 v119, v141, v137, s21
    v_perm_b32 v120, v134, v130, s20
    v_perm_b32 v121, v142, v138, s20
    v_perm_b32 v122, v134, v130, s21
    v_perm_b32 v123, v142, v138, s21
    v_perm_b32 v124, v135, v131, s20
    v_perm_b32 v125, v143, v139, s20
    v_perm_b32 v126, v135, v131, s21
    v_perm_b32 v127, v143, v139, s21
    s_waitcnt vmcnt(8)
    v_perm_b32 v128, v148, v144, s20
    v_perm_b32 v129, v156, v152, s20
    v_perm_b32 v130, v148, v144, s21
    v_perm_b32 v131, v156, v152, s21
    v_perm_b32 v132, v149, v145, s20
    v_perm_b32 v133, v157, v153, s20
    v_perm_b32 v134, v149, v145, s21
    v_perm_b32 v135, v157, v153, s21
    v_perm_b32 v136, v150, v146, s20
    v_perm_b32 v137, v158, v154, s20
    v_perm_b32 v138, v150, v146, s21
    v_perm_b32 v139, v158, v154, s21
    v_perm_b32 v140, v151, v147, s20
    v_perm_b32 v141, v159, v155, s20
    v_perm_b32 v142, v151, v147, s21
    v_perm_b32 v143, v159, v155, s21
    s_waitcnt vmcnt(4)
    v_perm_b32 v144, v164, v160, s20
    v_perm_b32 v145, v172, v168, s20
    v_perm_b32 v146, v164, v160, s21
    v_perm_b32 v147, v172, v168, s21
    v_perm_b32 v148, v165, v161, s20
    v_perm_b32 v149, v173, v169, s20
    v_perm_b32 v150, v165, v161, s21
    v_perm_b32 v151, v173, v169, s21
    v_perm_b32 v152, v166, v162, s20
    v_perm_b32 v153, v174, v170, s20
    v_perm_b32 v154, v166, v162, s21
    v_perm_b32 v155, v174, v170, s21
    v_perm_b32 v156, v167, v163, s20
    v_perm_b32 v157, v175, v171, s20
    v_perm_b32 v158, v167, v163, s21
    v_perm_b32 v159, v175, v171, s21
    s_waitcnt vmcnt(0)
    v_perm_b32 v160, v180, v176, s20
    v_perm_b32 v161, v188, v184, s20
    v_perm_b32 v162, v180, v176, s21
    v_perm_b32 v163, v188, v184, s21
    v_perm_b32 v164, v181, v177, s20
    v_perm_b32 v165, v189, v185, s20
    v_perm_b32 v166, v181, v177, s21
    v_perm_b32 v167, v189, v185, s21
    v_perm_b32 v168, v182, v178, s20
    v_perm_b32 v169, v190, v186, s20
    v_perm_b32 v170, v182, v178, s21
    v_perm_b32 v171, v190, v186, s21
    v_perm_b32 v172, v183, v179, s20
    v_perm_b32 v173, v191, v187, s20
    v_perm_b32 v174, v183, v179, s21
    v_perm_b32 v175, v191, v187, s21
    s_mov_b32 exec_hi, -1

    s_lshl_b32 s26, s18, 3
    s_add_u32 s26, s26, 161860

    v_add_u32 v254, s26, v240

    s_mov_b32 s29, 200000
L_wslot:
    ds_read_b32 v255, v254
    s_waitcnt lgkmcnt(0)
    v_cmp_ne_u32 vcc, 0, v255
    s_cmp_eq_u64 vcc, exec
    s_cbranch_scc1 L_wslot_ok
    s_sleep 2
    s_sub_u32 s29, s29, 1
    s_cmp_lg_u32 s29, 0
    s_cbranch_scc1 L_wslot
L_wslot_ok:

    s_setprio 3

    s_mul_i32 s30, s18, 11
    s_lshr_b32 s30, s30, 5
    s_mul_i32 s30, s30, 3
    s_sub_u32 s30, s18, s30
    s_mul_i32 s30, s30, 14336

    s_add_u32 s26, s30, 7168
    v_add_u32 v254, s26, v249
    s_mov_b32 exec_hi, 0x0000ffff

    ds_write_b64 v254, v[192:193] offset:0
    ds_write_b64 v254, v[194:195] offset:72
    ds_write_b64 v254, v[196:197] offset:144
    ds_write_b64 v254, v[198:199] offset:216
    ds_write_b64 v254, v[200:201] offset:288
    ds_write_b64 v254, v[202:203] offset:360
    ds_write_b64 v254, v[204:205] offset:432
    ds_write_b64 v254, v[206:207] offset:504
    ds_write_b64 v254, v[48:49] offset:8
    ds_write_b64 v254, v[50:51] offset:80
    ds_write_b64 v254, v[52:53] offset:152
    ds_write_b64 v254, v[54:55] offset:224
    ds_write_b64 v254, v[56:57] offset:296
    ds_write_b64 v254, v[58:59] offset:368
    ds_write_b64 v254, v[60:61] offset:440
    ds_write_b64 v254, v[62:63] offset:512
    ds_write_b64 v254, v[64:65] offset:16
    ds_write_b64 v254, v[66:67] offset:88
    ds_write_b64 v254, v[68:69] offset:160
    ds_write_b64 v254, v[70:71] offset:232
    ds_write_b64 v254, v[72:73] offset:304
    ds_write_b64 v254, v[74:75] offset:376
    ds_write_b64 v254, v[76:77] offset:448
    ds_write_b64 v254, v[78:79] offset:520
    ds_write_b64 v254, v[80:81] offset:24
    ds_write_b64 v254, v[82:83] offset:96
    ds_write_b64 v254, v[84:85] offset:168
    ds_write_b64 v254, v[86:87] offset:240
    ds_write_b64 v254, v[88:89] offset:312
    ds_write_b64 v254, v[90:91] offset:384
    ds_write_b64 v254, v[92:93] offset:456
    ds_write_b64 v254, v[94:95] offset:528
    ds_write_b64 v254, v[96:97] offset:32
    ds_write_b64 v254, v[98:99] offset:104
    ds_write_b64 v254, v[100:101] offset:176
    ds_write_b64 v254, v[102:103] offset:248
    ds_write_b64 v254, v[104:105] offset:320
    ds_write_b64 v254, v[106:107] offset:392
    ds_write_b64 v254, v[108:109] offset:464
    ds_write_b64 v254, v[110:111] offset:536
    ds_write_b64 v254, v[112:113] offset:40
    ds_write_b64 v254, v[114:115] offset:112
    ds_write_b64 v254, v[116:117] offset:184
    ds_write_b64 v254, v[118:119] offset:256
    ds_write_b64 v254, v[120:121] offset:328
    ds_write_b64 v254, v[122:123] offset:400
    ds_write_b64 v254, v[124:125] offset:472
    ds_write_b64 v254, v[126:127] offset:544
    ds_write_b64 v254, v[128:129] offset:48
    ds_write_b64 v254, v[130:131] offset:120
    ds_write_b64 v254, v[132:133] offset:192
    ds_write_b64 v254, v[134:135] offset:264
    ds_write_b64 v254, v[136:137] offset:336
    ds_write_b64 v254, v[138:139] offset:408
    ds_write_b64 v254, v[140:141] offset:480
    ds_write_b64 v254, v[142:143] offset:552
    ds_write_b64 v254, v[144:145] offset:56
    ds_write_b64 v254, v[146:147] offset:128
    ds_write_b64 v254, v[148:149] offset:200
    ds_write_b64 v254, v[150:151] offset:272
    ds_write_b64 v254, v[152:153] offset:344
    ds_write_b64 v254, v[154:155] offset:416
    ds_write_b64 v254, v[156:157] offset:488
    ds_write_b64 v254, v[158:159] offset:560
    ds_write_b64 v254, v[160:161] offset:64
    ds_write_b64 v254, v[162:163] offset:136
    ds_write_b64 v254, v[164:165] offset:208
    ds_write_b64 v254, v[166:167] offset:280
    ds_write_b64 v254, v[168:169] offset:352
    ds_write_b64 v254, v[170:171] offset:424
    ds_write_b64 v254, v[172:173] offset:496
    ds_write_b64 v254, v[174:175] offset:568

    s_mov_b32 exec_hi, -1
    s_lshl_b32 s26, s18, 2
    s_add_u32 s26, s26, 161808
    v_mov_b32 v254, s26
    v_mov_b32 v255, 1
    s_waitcnt lgkmcnt(0)
    ds_write_b32 v254, v255
    s_cmp_eq_u32 s18, 8
    s_cbranch_scc1 L_loader

    s_add_u32 s27, s18, 1

    s_mul_i32 s32, s27, 11
    s_lshr_b32 s32, s32, 5
    s_mul_i32 s32, s32, 3
    s_sub_u32 s32, s27, s32
    s_mul_i32 s32, s32, 14336

    s_add_u32 s31, s30, 72832
    s_add_u32 s30, s30, 7168
    s_add_u32 s33, s32, 72832
    s_add_u32 s32, s32, 7168

    v_add_u32 v232, s30, v250
    v_add_u32 v233, s31, v250
    v_add_u32 v234, s32, v250
    v_add_u32 v235, s33, v250
    v_cndmask_b32 v244, v232, v233, s[56:57]
    v_cndmask_b32 v245, v233, v234, s[56:57]
    v_cndmask_b32 v246, v234, v235, s[56:57]
    v_mov_b32 v254, 161968

    s_mov_b32 s29, 200000
L_wt:
    ds_read_b32 v255, v254
    s_waitcnt lgkmcnt(0)
    v_cmp_eq_u32 vcc, 4, v255
    s_cmp_eq_u64 vcc, exec
    s_cbranch_scc1 L_wt_ok
    s_sleep 2
    s_sub_u32 s29, s29, 1
    s_cmp_lg_u32 s29, 0
    s_cbranch_scc1 L_wt
L_wt_ok:

    ds_read_b128 v[192:195], v241 offset:0
    ds_read_b64 v[212:213], v244 offset:0
    ds_read_b64 v[214:215], v244 offset:8
    ds_read_b128 v[196:199], v241 offset:320
    ds_read_b64 v[216:217], v244 offset:72
    ds_read_b64 v[218:219], v244 offset:80
    ds_read_b128 v[200:203], v241 offset:640
    ds_read_b64 v[220:221], v244 offset:144
    ds_read_b64 v[222:223], v244 offset:152
    ds_read_b128 v[204:207], v241 offset:960
    ds_read_b64 v[224:225], v244 offset:216
    ds_read_b64 v[226:227], v244 offset:224
    ds_read_b128 v[208:211], v241 offset:1280
    ds_read_b64 v[228:229], v244 offset:288
    ds_read_b64 v[230:231], v244 offset:296
    s_waitcnt lgkmcnt(9)
    v_mfma_f32_16x16x32_bf16 v[0:3], v[192:195], v[212:215], 0
    ds_read_b128 v[192:195], v241 offset:1600
    ds_read_b64 v[212:213], v244 offset:360
    ds_read_b64 v[214:215], v244 offset:368
    v_mfma_f32_16x16x32_bf16 v[4:7], v[196:199], v[216:219], 0
    ds_read_b128 v[196:199], v241 offset:1920
    ds_read_b64 v[216:217], v244 offset:432
    ds_read_b64 v[218:219], v244 offset:440
    s_waitcnt lgkmcnt(9)
    v_mfma_f32_16x16x32_bf16 v[8:11], v[200:203], v[220:223], 0
    ds_read_b128 v[200:203], v241 offset:2240
    ds_read_b64 v[220:221], v244 offset:504
    ds_read_b64 v[222:223], v244 offset:512
    v_mfma_f32_16x16x32_bf16 v[12:15], v[204:207], v[224:227], 0
    ds_read_b128 v[204:207], v241 offset:2560
    ds_read_b64 v[224:225], v244 offset:584
    ds_read_b64 v[226:227], v244 offset:592
    s_waitcnt lgkmcnt(9)
    v_mfma_f32_16x16x32_bf16 v[16:19], v[208:211], v[228:231], 0
    ds_read_b128 v[208:211], v241 offset:2880
    ds_read_b64 v[228:229], v244 offset:656
    ds_read_b64 v[230:231], v244 offset:664
    v_mfma_f32_16x16x32_bf16 v[20:23], v[192:195], v[212:215], 0
    ds_read_b128 v[192:195], v241 offset:3200
    ds_read_b64 v[212:213], v244 offset:728
    ds_read_b64 v[214:215], v244 offset:736
    s_waitcnt lgkmcnt(9)
    v_mfma_f32_16x16x32_bf16 v[24:27], v[196:199], v[216:219], 0
    ds_read_b128 v[196:199], v241 offset:3520
    ds_read_b64 v[216:217], v244 offset:800
    ds_read_b64 v[218:219], v244 offset:808
    v_mfma_f32_16x16x32_bf16 v[28:31], v[200:203], v[220:223], 0
    ds_read_b128 v[200:203], v241 offset:3840
    ds_read_b64 v[220:221], v244 offset:872
    ds_read_b64 v[222:223], v244 offset:880
    s_waitcnt lgkmcnt(9)
    v_mfma_f32_16x16x32_bf16 v[32:35], v[204:207], v[224:227], 0
    ds_read_b128 v[204:207], v241 offset:4160
    ds_read_b64 v[224:225], v244 offset:944
    ds_read_b64 v[226:227], v244 offset:952
    v_mfma_f32_16x16x32_bf16 v[36:39], v[208:211], v[228:231], 0
    ds_read_b128 v[208:211], v241 offset:4480
    ds_read_b64 v[228:229], v244 offset:1016
    ds_read_b64 v[230:231], v244 offset:1024
    s_waitcnt lgkmcnt(9)
    v_mfma_f32_16x16x32_bf16 v[40:43], v[192:195], v[212:215], 0
    ds_read_b128 v[192:195], v241 offset:4800
    ds_read_b64 v[212:213], v244 offset:1088
    ds_read_b64 v[214:215], v244 offset:1096
    v_mfma_f32_16x16x32_bf16 v[44:47], v[196:199], v[216:219], 0
    ds_read_b128 v[196:199], v241 offset:5120
    ds_read_b64 v[216:217], v244 offset:2336
    ds_read_b64 v[218:219], v244 offset:2344
    s_waitcnt lgkmcnt(9)
    v_mfma_f32_16x16x32_bf16 v[48:51], v[200:203], v[220:223], 0
    ds_read_b128 v[200:203], v241 offset:5440
    ds_read_b64 v[220:221], v244 offset:2408
    ds_read_b64 v[222:223], v244 offset:2416
    v_mfma_f32_16x16x32_bf16 v[52:55], v[204:207], v[224:227], 0
    ds_read_b128 v[204:207], v241 offset:5760
    ds_read_b64 v[224:225], v244 offset:2480
    ds_read_b64 v[226:227], v244 offset:2488
    s_waitcnt lgkmcnt(9)
    v_mfma_f32_16x16x32_bf16 v[56:59], v[208:211], v[228:231], 0
    ds_read_b128 v[208:211], v241 offset:6080
    ds_read_b64 v[228:229], v244 offset:2552
    ds_read_b64 v[230:231], v244 offset:2560
    v_mfma_f32_16x16x32_bf16 v[60:63], v[192:195], v[212:215], 0
    ds_read_b128 v[192:195], v241 offset:6400
    ds_read_b64 v[212:213], v244 offset:2624
    ds_read_b64 v[214:215], v244 offset:2632
    s_waitcnt lgkmcnt(9)
    v_mfma_f32_16x16x32_bf16 v[64:67], v[196:199], v[216:219], 0
    ds_read_b128 v[196:199], v241 offset:6720
    ds_read_b64 v[216:217], v244 offset:2696
    ds_read_b64 v[218:219], v244 offset:2704
    v_mfma_f32_16x16x32_bf16 v[68:71], v[200:203], v[220:223], 0
    ds_read_b128 v[200:203], v241 offset:7040
    ds_read_b64 v[220:221], v244 offset:2768
    ds_read_b64 v[222:223], v244 offset:2776
    s_waitcnt lgkmcnt(9)
    v_mfma_f32_16x16x32_bf16 v[72:75], v[204:207], v[224:227], 0
    ds_read_b128 v[204:207], v241 offset:7360
    ds_read_b64 v[224:225], v244 offset:2840
    ds_read_b64 v[226:227], v244 offset:2848
    v_mfma_f32_16x16x32_bf16 v[76:79], v[208:211], v[228:231], 0
    ds_read_b128 v[208:211], v241 offset:7680
    ds_read_b64 v[228:229], v244 offset:2920
    ds_read_b64 v[230:231], v244 offset:2928
    s_waitcnt lgkmcnt(9)
    v_mfma_f32_16x16x32_bf16 v[80:83], v[192:195], v[212:215], 0
    ds_read_b128 v[192:195], v241 offset:8000
    ds_read_b64 v[212:213], v244 offset:2992
    ds_read_b64 v[214:215], v244 offset:3000
    v_mfma_f32_16x16x32_bf16 v[84:87], v[196:199], v[216:219], 0
    ds_read_b128 v[196:199], v241 offset:8320
    ds_read_b64 v[216:217], v244 offset:3064
    ds_read_b64 v[218:219], v244 offset:3072
    s_waitcnt lgkmcnt(9)
    v_mfma_f32_16x16x32_bf16 v[88:91], v[200:203], v[220:223], 0
    ds_read_b128 v[200:203], v241 offset:8640
    ds_read_b64 v[220:221], v244 offset:3136
    ds_read_b64 v[222:223], v244 offset:3144
    v_mfma_f32_16x16x32_bf16 v[92:95], v[204:207], v[224:227], 0
    ds_read_b128 v[204:207], v241 offset:8960
    ds_read_b64 v[224:225], v244 offset:3208
    ds_read_b64 v[226:227], v244 offset:3216
    s_waitcnt lgkmcnt(9)
    v_mfma_f32_16x16x32_bf16 v[96:99], v[208:211], v[228:231], 0
    ds_read_b128 v[208:211], v241 offset:9280
    ds_read_b64 v[228:229], v244 offset:3280
    ds_read_b64 v[230:231], v244 offset:3288
    v_mfma_f32_16x16x32_bf16 v[100:103], v[192:195], v[212:215], 0
    ds_read_b128 v[192:195], v241 offset:9600
    ds_read_b64 v[212:213], v244 offset:3352
    ds_read_b64 v[214:215], v244 offset:3360
    s_waitcnt lgkmcnt(9)
    v_mfma_f32_16x16x32_bf16 v[104:107], v[196:199], v[216:219], 0
    ds_read_b128 v[196:199], v241 offset:9920
    ds_read_b64 v[216:217], v244 offset:3424
    ds_read_b64 v[218:219], v244 offset:3432
    v_mfma_f32_16x16x32_bf16 v[108:111], v[200:203], v[220:223], 0
    ds_read_b128 v[200:203], v241 offset:10240
    ds_read_b64 v[220:221], v244 offset:4672
    ds_read_b64 v[222:223], v244 offset:4680
    s_waitcnt lgkmcnt(9)
    v_mfma_f32_16x16x32_bf16 v[112:115], v[204:207], v[224:227], 0
    ds_read_b128 v[204:207], v241 offset:10560
    ds_read_b64 v[224:225], v244 offset:4744
    ds_read_b64 v[226:227], v244 offset:4752
    v_mfma_f32_16x16x32_bf16 v[116:119], v[208:211], v[228:231], 0
    ds_read_b128 v[208:211], v241 offset:10880
    ds_read_b64 v[228:229], v244 offset:4816
    ds_read_b64 v[230:231], v244 offset:4824
    s_waitcnt lgkmcnt(9)
    v_mfma_f32_16x16x32_bf16 v[120:123], v[192:195], v[212:215], 0
    ds_read_b128 v[192:195], v241 offset:11200
    ds_read_b64 v[212:213], v244 offset:4888
    ds_read_b64 v[214:215], v244 offset:4896
    v_mfma_f32_16x16x32_bf16 v[124:127], v[196:199], v[216:219], 0
    ds_read_b128 v[196:199], v241 offset:11520
    ds_read_b64 v[216:217], v244 offset:4960
    ds_read_b64 v[218:219], v244 offset:4968
    s_waitcnt lgkmcnt(9)
    v_mfma_f32_16x16x32_bf16 v[128:131], v[200:203], v[220:223], 0
    ds_read_b128 v[200:203], v241 offset:11840
    ds_read_b64 v[220:221], v244 offset:5032
    ds_read_b64 v[222:223], v244 offset:5040
    v_mfma_f32_16x16x32_bf16 v[132:135], v[204:207], v[224:227], 0
    ds_read_b128 v[204:207], v241 offset:12160
    ds_read_b64 v[224:225], v244 offset:5104
    ds_read_b64 v[226:227], v244 offset:5112
    s_waitcnt lgkmcnt(9)
    v_mfma_f32_16x16x32_bf16 v[136:139], v[208:211], v[228:231], 0
    ds_read_b128 v[208:211], v241 offset:12480
    ds_read_b64 v[228:229], v244 offset:5176
    ds_read_b64 v[230:231], v244 offset:5184
    v_mfma_f32_16x16x32_bf16 v[140:143], v[192:195], v[212:215], 0
    ds_read_b128 v[192:195], v241 offset:12800
    ds_read_b64 v[212:213], v244 offset:5256
    ds_read_b64 v[214:215], v244 offset:5264
    s_waitcnt lgkmcnt(9)
    v_mfma_f32_16x16x32_bf16 v[144:147], v[196:199], v[216:219], 0
    ds_read_b128 v[196:199], v241 offset:13120
    ds_read_b64 v[216:217], v244 offset:5328
    ds_read_b64 v[218:219], v244 offset:5336
    v_mfma_f32_16x16x32_bf16 v[148:151], v[200:203], v[220:223], 0
    ds_read_b128 v[200:203], v241 offset:13440
    ds_read_b64 v[220:221], v244 offset:5400
    ds_read_b64 v[222:223], v244 offset:5408
    s_waitcnt lgkmcnt(9)
    v_mfma_f32_16x16x32_bf16 v[152:155], v[204:207], v[224:227], 0
    ds_read_b128 v[204:207], v241 offset:13760
    ds_read_b64 v[224:225], v244 offset:5472
    ds_read_b64 v[226:227], v244 offset:5480
    v_mfma_f32_16x16x32_bf16 v[156:159], v[208:211], v[228:231], 0
    ds_read_b128 v[208:211], v241 offset:14080
    ds_read_b64 v[228:229], v244 offset:5544
    ds_read_b64 v[230:231], v244 offset:5552
    s_waitcnt lgkmcnt(9)
    v_mfma_f32_16x16x32_bf16 v[160:163], v[192:195], v[212:215], 0
    ds_read_b128 v[192:195], v241 offset:14400
    ds_read_b64 v[212:213], v244 offset:5616
    ds_read_b64 v[214:215], v244 offset:5624
    v_mfma_f32_16x16x32_bf16 v[164:167], v[196:199], v[216:219], 0
    ds_read_b128 v[196:199], v241 offset:14720
    ds_read_b64 v[216:217], v244 offset:5688
    ds_read_b64 v[218:219], v244 offset:5696
    s_waitcnt lgkmcnt(9)
    v_mfma_f32_16x16x32_bf16 v[168:171], v[200:203], v[220:223], 0
    ds_read_b128 v[200:203], v241 offset:15040
    ds_read_b64 v[220:221], v244 offset:5760
    ds_read_b64 v[222:223], v244 offset:5768
    v_mfma_f32_16x16x32_bf16 v[172:175], v[204:207], v[224:227], 0
    s_setprio 0
    v_add_u32 v254, s26, v240

    s_mov_b32 s29, 200000
L_wrdy:
    ds_read_b32 v255, v254
    s_waitcnt lgkmcnt(0)
    v_cmp_ne_u32 vcc, 0, v255
    s_cmp_eq_u64 vcc, exec
    s_cbranch_scc1 L_wrdy_ok
    s_sleep 2
    s_sub_u32 s29, s29, 1
    s_cmp_lg_u32 s29, 0
    s_cbranch_scc1 L_wrdy
L_wrdy_ok:

    s_setprio 3
    s_lshl_b32 s26, s16, 3
    s_add_u32 s26, s26, 161888
    v_mov_b32 v254, s26
    v_mov_b32 v255, 1

    ds_read_b128 v[204:207], v242 offset:0
    ds_read_b64 v[224:225], v245 offset:0
    ds_read_b64 v[226:227], v245 offset:8
    s_waitcnt lgkmcnt(9)
    v_mfma_f32_16x16x32_bf16 v[176:179], v[208:211], v[228:231], 0
    ds_read_b128 v[208:211], v242 offset:320
    ds_read_b64 v[228:229], v245 offset:72
    ds_read_b64 v[230:231], v245 offset:80
    v_mfma_f32_16x16x32_bf16 v[180:183], v[192:195], v[212:215], 0
    ds_read_b128 v[192:195], v242 offset:640
    ds_read_b64 v[212:213], v245 offset:144
    ds_read_b64 v[214:215], v245 offset:152
    s_waitcnt lgkmcnt(9)
    v_mfma_f32_16x16x32_bf16 v[184:187], v[196:199], v[216:219], 0
    ds_read_b128 v[196:199], v242 offset:960
    ds_read_b64 v[216:217], v245 offset:216
    ds_read_b64 v[218:219], v245 offset:224
    v_mfma_f32_16x16x32_bf16 v[188:191], v[200:203], v[220:223], 0
    ds_read_b128 v[200:203], v242 offset:1280
    ds_read_b64 v[220:221], v245 offset:288
    ds_read_b64 v[222:223], v245 offset:296
    s_waitcnt lgkmcnt(9)
    v_mfma_f32_16x16x32_bf16 v[0:3], v[204:207], v[224:227], v[0:3]
    ds_read_b128 v[204:207], v242 offset:1600
    ds_read_b64 v[224:225], v245 offset:360
    ds_read_b64 v[226:227], v245 offset:368
    v_mfma_f32_16x16x32_bf16 v[4:7], v[208:211], v[228:231], v[4:7]
    ds_read_b128 v[208:211], v242 offset:1920
    ds_read_b64 v[228:229], v245 offset:432
    ds_read_b64 v[230:231], v245 offset:440
    s_waitcnt lgkmcnt(9)
    v_mfma_f32_16x16x32_bf16 v[8:11], v[192:195], v[212:215], v[8:11]
    ds_read_b128 v[192:195], v242 offset:2240
    ds_read_b64 v[212:213], v245 offset:504
    ds_read_b64 v[214:215], v245 offset:512
    v_mfma_f32_16x16x32_bf16 v[12:15], v[196:199], v[216:219], v[12:15]
    ds_read_b128 v[196:199], v242 offset:2560
    ds_read_b64 v[216:217], v245 offset:584
    ds_read_b64 v[218:219], v245 offset:592
    s_waitcnt lgkmcnt(9)
    v_mfma_f32_16x16x32_bf16 v[16:19], v[200:203], v[220:223], v[16:19]
    ds_read_b128 v[200:203], v242 offset:2880
    ds_read_b64 v[220:221], v245 offset:656
    ds_read_b64 v[222:223], v245 offset:664
    v_mfma_f32_16x16x32_bf16 v[20:23], v[204:207], v[224:227], v[20:23]
    ds_read_b128 v[204:207], v242 offset:3200
    ds_read_b64 v[224:225], v245 offset:728
    ds_read_b64 v[226:227], v245 offset:736
    s_waitcnt lgkmcnt(9)
    v_mfma_f32_16x16x32_bf16 v[24:27], v[208:211], v[228:231], v[24:27]
    ds_read_b128 v[208:211], v242 offset:3520
    ds_read_b64 v[228:229], v245 offset:800
    ds_read_b64 v[230:231], v245 offset:808
    v_mfma_f32_16x16x32_bf16 v[28:31], v[192:195], v[212:215], v[28:31]
    ds_read_b128 v[192:195], v242 offset:3840
    ds_read_b64 v[212:213], v245 offset:872
    ds_read_b64 v[214:215], v245 offset:880
    s_waitcnt lgkmcnt(9)
    v_mfma_f32_16x16x32_bf16 v[32:35], v[196:199], v[216:219], v[32:35]
    ds_read_b128 v[196:199], v242 offset:4160
    ds_read_b64 v[216:217], v245 offset:944
    ds_read_b64 v[218:219], v245 offset:952
    v_mfma_f32_16x16x32_bf16 v[36:39], v[200:203], v[220:223], v[36:39]
    ds_read_b128 v[200:203], v242 offset:4480
    ds_read_b64 v[220:221], v245 offset:1016
    ds_read_b64 v[222:223], v245 offset:1024
    s_waitcnt lgkmcnt(9)
    v_mfma_f32_16x16x32_bf16 v[40:43], v[204:207], v[224:227], v[40:43]
    ds_read_b128 v[204:207], v242 offset:4800
    ds_read_b64 v[224:225], v245 offset:1088
    ds_read_b64 v[226:227], v245 offset:1096
    v_mfma_f32_16x16x32_bf16 v[44:47], v[208:211], v[228:231], v[44:47]
    ds_read_b128 v[208:211], v242 offset:5120
    ds_read_b64 v[228:229], v245 offset:2336
    ds_read_b64 v[230:231], v245 offset:2344
    s_waitcnt lgkmcnt(9)
    v_mfma_f32_16x16x32_bf16 v[48:51], v[192:195], v[212:215], v[48:51]
    ds_read_b128 v[192:195], v242 offset:5440
    ds_read_b64 v[212:213], v245 offset:2408
    ds_read_b64 v[214:215], v245 offset:2416
    v_mfma_f32_16x16x32_bf16 v[52:55], v[196:199], v[216:219], v[52:55]
    ds_read_b128 v[196:199], v242 offset:5760
    ds_read_b64 v[216:217], v245 offset:2480
    ds_read_b64 v[218:219], v245 offset:2488
    s_waitcnt lgkmcnt(9)
    v_mfma_f32_16x16x32_bf16 v[56:59], v[200:203], v[220:223], v[56:59]
    ds_read_b128 v[200:203], v242 offset:6080
    ds_read_b64 v[220:221], v245 offset:2552
    ds_read_b64 v[222:223], v245 offset:2560
    v_mfma_f32_16x16x32_bf16 v[60:63], v[204:207], v[224:227], v[60:63]
    ds_read_b128 v[204:207], v242 offset:6400
    ds_read_b64 v[224:225], v245 offset:2624
    ds_read_b64 v[226:227], v245 offset:2632
    s_waitcnt lgkmcnt(9)
    v_mfma_f32_16x16x32_bf16 v[64:67], v[208:211], v[228:231], v[64:67]
    ds_read_b128 v[208:211], v242 offset:6720
    ds_read_b64 v[228:229], v245 offset:2696
    ds_read_b64 v[230:231], v245 offset:2704
    v_mfma_f32_16x16x32_bf16 v[68:71], v[192:195], v[212:215], v[68:71]
    ds_read_b128 v[192:195], v242 offset:7040
    ds_read_b64 v[212:213], v245 offset:2768
    ds_read_b64 v[214:215], v245 offset:2776
    s_waitcnt lgkmcnt(9)
    v_mfma_f32_16x16x32_bf16 v[72:75], v[196:199], v[216:219], v[72:75]
    ds_read_b128 v[196:199], v242 offset:7360
    ds_read_b64 v[216:217], v245 offset:2840
    ds_read_b64 v[218:219], v245 offset:2848
    v_mfma_f32_16x16x32_bf16 v[76:79], v[200:203], v[220:223], v[76:79]
    ds_read_b128 v[200:203], v242 offset:7680
    ds_read_b64 v[220:221], v245 offset:2920
    ds_read_b64 v[222:223], v245 offset:2928
    s_waitcnt lgkmcnt(9)
    v_mfma_f32_16x16x32_bf16 v[80:83], v[204:207], v[224:227], v[80:83]
    ds_read_b128 v[204:207], v242 offset:8000
    ds_read_b64 v[224:225], v245 offset:2992
    ds_read_b64 v[226:227], v245 offset:3000
    v_mfma_f32_16x16x32_bf16 v[84:87], v[208:211], v[228:231], v[84:87]
    ds_read_b128 v[208:211], v242 offset:8320
    ds_read_b64 v[228:229], v245 offset:3064
    ds_read_b64 v[230:231], v245 offset:3072
    s_waitcnt lgkmcnt(9)
    v_mfma_f32_16x16x32_bf16 v[88:91], v[192:195], v[212:215], v[88:91]
    ds_read_b128 v[192:195], v242 offset:8640
    ds_read_b64 v[212:213], v245 offset:3136
    ds_read_b64 v[214:215], v245 offset:3144
    v_mfma_f32_16x16x32_bf16 v[92:95], v[196:199], v[216:219], v[92:95]
    ds_read_b128 v[196:199], v242 offset:8960
    ds_read_b64 v[216:217], v245 offset:3208
    ds_read_b64 v[218:219], v245 offset:3216
    s_waitcnt lgkmcnt(9)
    v_mfma_f32_16x16x32_bf16 v[96:99], v[200:203], v[220:223], v[96:99]
    ds_read_b128 v[200:203], v242 offset:9280
    ds_read_b64 v[220:221], v245 offset:3280
    ds_read_b64 v[222:223], v245 offset:3288
    v_mfma_f32_16x16x32_bf16 v[100:103], v[204:207], v[224:227], v[100:103]
    ds_read_b128 v[204:207], v242 offset:9600
    ds_read_b64 v[224:225], v245 offset:3352
    ds_read_b64 v[226:227], v245 offset:3360
    s_waitcnt lgkmcnt(9)
    v_mfma_f32_16x16x32_bf16 v[104:107], v[208:211], v[228:231], v[104:107]
    ds_read_b128 v[208:211], v242 offset:9920
    ds_read_b64 v[228:229], v245 offset:3424
    ds_read_b64 v[230:231], v245 offset:3432
    v_mfma_f32_16x16x32_bf16 v[108:111], v[192:195], v[212:215], v[108:111]
    ds_read_b128 v[192:195], v242 offset:10240
    ds_read_b64 v[212:213], v245 offset:4672
    ds_read_b64 v[214:215], v245 offset:4680
    s_waitcnt lgkmcnt(9)
    v_mfma_f32_16x16x32_bf16 v[112:115], v[196:199], v[216:219], v[112:115]
    ds_read_b128 v[196:199], v242 offset:10560
    ds_read_b64 v[216:217], v245 offset:4744
    ds_read_b64 v[218:219], v245 offset:4752
    v_mfma_f32_16x16x32_bf16 v[116:119], v[200:203], v[220:223], v[116:119]
    ds_read_b128 v[200:203], v242 offset:10880
    ds_read_b64 v[220:221], v245 offset:4816
    ds_read_b64 v[222:223], v245 offset:4824
    s_waitcnt lgkmcnt(9)
    v_mfma_f32_16x16x32_bf16 v[120:123], v[204:207], v[224:227], v[120:123]
    ds_read_b128 v[204:207], v242 offset:11200
    ds_read_b64 v[224:225], v245 offset:4888
    ds_read_b64 v[226:227], v245 offset:4896
    v_mfma_f32_16x16x32_bf16 v[124:127], v[208:211], v[228:231], v[124:127]
    ds_read_b128 v[208:211], v242 offset:11520
    ds_read_b64 v[228:229], v245 offset:4960
    ds_read_b64 v[230:231], v245 offset:4968
    s_waitcnt lgkmcnt(9)
    v_mfma_f32_16x16x32_bf16 v[128:131], v[192:195], v[212:215], v[128:131]
    ds_read_b128 v[192:195], v242 offset:11840
    ds_read_b64 v[212:213], v245 offset:5032
    ds_read_b64 v[214:215], v245 offset:5040
    v_mfma_f32_16x16x32_bf16 v[132:135], v[196:199], v[216:219], v[132:135]
    ds_read_b128 v[196:199], v242 offset:12160
    ds_read_b64 v[216:217], v245 offset:5104
    ds_read_b64 v[218:219], v245 offset:5112
    s_waitcnt lgkmcnt(9)
    v_mfma_f32_16x16x32_bf16 v[136:139], v[200:203], v[220:223], v[136:139]
    ds_read_b128 v[200:203], v242 offset:12480
    ds_read_b64 v[220:221], v245 offset:5176
    ds_read_b64 v[222:223], v245 offset:5184
    v_mfma_f32_16x16x32_bf16 v[140:143], v[204:207], v[224:227], v[140:143]
    ds_read_b128 v[204:207], v242 offset:12800
    ds_read_b64 v[224:225], v245 offset:5256
    ds_read_b64 v[226:227], v245 offset:5264
    s_waitcnt lgkmcnt(9)
    v_mfma_f32_16x16x32_bf16 v[144:147], v[208:211], v[228:231], v[144:147]
    ds_read_b128 v[208:211], v242 offset:13120
    ds_read_b64 v[228:229], v245 offset:5328
    ds_read_b64 v[230:231], v245 offset:5336
    v_mfma_f32_16x16x32_bf16 v[148:151], v[192:195], v[212:215], v[148:151]
    ds_read_b128 v[192:195], v242 offset:13440
    ds_read_b64 v[212:213], v245 offset:5400
    ds_read_b64 v[214:215], v245 offset:5408
    s_waitcnt lgkmcnt(9)
    v_mfma_f32_16x16x32_bf16 v[152:155], v[196:199], v[216:219], v[152:155]
    ds_read_b128 v[196:199], v242 offset:13760
    ds_read_b64 v[216:217], v245 offset:5472
    ds_read_b64 v[218:219], v245 offset:5480
    v_mfma_f32_16x16x32_bf16 v[156:159], v[200:203], v[220:223], v[156:159]
    ds_read_b128 v[200:203], v242 offset:14080
    ds_read_b64 v[220:221], v245 offset:5544
    ds_read_b64 v[222:223], v245 offset:5552
    s_waitcnt lgkmcnt(9)
    v_mfma_f32_16x16x32_bf16 v[160:163], v[204:207], v[224:227], v[160:163]
    ds_read_b128 v[204:207], v242 offset:14400
    ds_read_b64 v[224:225], v245 offset:5616
    ds_read_b64 v[226:227], v245 offset:5624
    v_mfma_f32_16x16x32_bf16 v[164:167], v[208:211], v[228:231], v[164:167]
    ds_read_b128 v[208:211], v242 offset:14720
    ds_read_b64 v[228:229], v245 offset:5688
    ds_read_b64 v[230:231], v245 offset:5696
    s_waitcnt lgkmcnt(9)
    v_mfma_f32_16x16x32_bf16 v[168:171], v[192:195], v[212:215], v[168:171]
    ds_read_b128 v[192:195], v242 offset:15040
    ds_read_b64 v[212:213], v245 offset:5760
    ds_read_b64 v[214:215], v245 offset:5768
    v_mfma_f32_16x16x32_bf16 v[172:175], v[196:199], v[216:219], v[172:175]
    ds_read_b128 v[196:199], v243 offset:0
    ds_read_b64 v[216:217], v246 offset:0
    ds_read_b64 v[218:219], v246 offset:8
    s_waitcnt lgkmcnt(9)
    v_mfma_f32_16x16x32_bf16 v[176:179], v[200:203], v[220:223], v[176:179]
    ds_read_b128 v[200:203], v243 offset:320
    ds_read_b64 v[220:221], v246 offset:72
    ds_read_b64 v[222:223], v246 offset:80
    v_mfma_f32_16x16x32_bf16 v[180:183], v[204:207], v[224:227], v[180:183]
    ds_read_b128 v[204:207], v243 offset:640
    ds_read_b64 v[224:225], v246 offset:144
    ds_read_b64 v[226:227], v246 offset:152
    s_waitcnt lgkmcnt(9)
    v_mfma_f32_16x16x32_bf16 v[184:187], v[208:211], v[228:231], v[184:187]
    ds_read_b128 v[208:211], v243 offset:960
    ds_read_b64 v[228:229], v246 offset:216
    ds_read_b64 v[230:231], v246 offset:224
    v_mfma_f32_16x16x32_bf16 v[188:191], v[192:195], v[212:215], v[188:191]
    ds_read_b128 v[192:195], v243 offset:1280
    ds_read_b64 v[212:213], v246 offset:288
    ds_read_b64 v[214:215], v246 offset:296
    s_waitcnt lgkmcnt(9)
    ds_write_b32 v254, v255
    v_mfma_f32_16x16x32_bf16 v[0:3], v[196:199], v[216:219], v[0:3]
    ds_read_b128 v[196:199], v243 offset:1600
    ds_read_b64 v[216:217], v246 offset:360
    ds_read_b64 v[218:219], v246 offset:368
    v_mfma_f32_16x16x32_bf16 v[4:7], v[200:203], v[220:223], v[4:7]
    s_waitcnt lgkmcnt(12)
    ds_read_b128 v[200:203], v243 offset:1920
    ds_read_b64 v[220:221], v246 offset:432
    ds_read_b64 v[222:223], v246 offset:440
    s_waitcnt lgkmcnt(9)
    v_mfma_f32_16x16x32_bf16 v[8:11], v[204:207], v[224:227], v[8:11]
    ds_read_b128 v[204:207], v243 offset:2240
    ds_read_b64 v[224:225], v246 offset:504
    ds_read_b64 v[226:227], v246 offset:512
    v_mfma_f32_16x16x32_bf16 v[12:15], v[208:211], v[228:231], v[12:15]
    ds_read_b128 v[208:211], v243 offset:2560
    ds_read_b64 v[228:229], v246 offset:584
    ds_read_b64 v[230:231], v246 offset:592
    v_mov_b32 v232, v0
    v_mul_f32 v236, v0, v0
    v_mov_b32 v233, v1
    v_mul_f32 v237, v1, v1
    v_mov_b32 v234, v2
    v_mul_f32 v238, v2, v2
    v_mov_b32 v235, v3
    v_mul_f32 v239, v3, v3
    s_waitcnt lgkmcnt(9)
    v_mfma_f32_16x16x32_bf16 v[16:19], v[192:195], v[212:215], v[16:19]
    ds_read_b128 v[192:195], v243 offset:2880
    ds_read_b64 v[212:213], v246 offset:656
    ds_read_b64 v[214:215], v246 offset:664
    v_add_f32 v232, v232, v4
    v_fmac_f32 v236, v4, v4
    v_add_f32 v233, v233, v5
    v_fmac_f32 v237, v5, v5
    v_add_f32 v234, v234, v6
    v_fmac_f32 v238, v6, v6
    v_add_f32 v235, v235, v7
    v_fmac_f32 v239, v7, v7
    v_mfma_f32_16x16x32_bf16 v[20:23], v[196:199], v[216:219], v[20:23]
    ds_read_b128 v[196:199], v243 offset:3200
    ds_read_b64 v[216:217], v246 offset:728
    ds_read_b64 v[218:219], v246 offset:736
    v_add_f32 v232, v232, v8
    v_fmac_f32 v236, v8, v8
    v_add_f32 v233, v233, v9
    v_fmac_f32 v237, v9, v9
    v_add_f32 v234, v234, v10
    v_fmac_f32 v238, v10, v10
    v_add_f32 v235, v235, v11
    v_fmac_f32 v239, v11, v11
    s_waitcnt lgkmcnt(9)
    v_mfma_f32_16x16x32_bf16 v[24:27], v[200:203], v[220:223], v[24:27]
    ds_read_b128 v[200:203], v243 offset:3520
    ds_read_b64 v[220:221], v246 offset:800
    ds_read_b64 v[222:223], v246 offset:808
    v_add_f32 v232, v232, v12
    v_fmac_f32 v236, v12, v12
    v_add_f32 v233, v233, v13
    v_fmac_f32 v237, v13, v13
    v_add_f32 v234, v234, v14
    v_fmac_f32 v238, v14, v14
    v_add_f32 v235, v235, v15
    v_fmac_f32 v239, v15, v15
    v_mfma_f32_16x16x32_bf16 v[28:31], v[204:207], v[224:227], v[28:31]
    ds_read_b128 v[204:207], v243 offset:3840
    ds_read_b64 v[224:225], v246 offset:872
    ds_read_b64 v[226:227], v246 offset:880
    v_add_f32 v232, v232, v16
    v_fmac_f32 v236, v16, v16
    v_add_f32 v233, v233, v17
    v_fmac_f32 v237, v17, v17
    v_add_f32 v234, v234, v18
    v_fmac_f32 v238, v18, v18
    v_add_f32 v235, v235, v19
    v_fmac_f32 v239, v19, v19
    s_waitcnt lgkmcnt(9)
    v_mfma_f32_16x16x32_bf16 v[32:35], v[208:211], v[228:231], v[32:35]
    ds_read_b128 v[208:211], v243 offset:4160
    ds_read_b64 v[228:229], v246 offset:944
    ds_read_b64 v[230:231], v246 offset:952
    v_add_f32 v232, v232, v20
    v_fmac_f32 v236, v20, v20
    v_add_f32 v233, v233, v21
    v_fmac_f32 v237, v21, v21
    v_add_f32 v234, v234, v22
    v_fmac_f32 v238, v22, v22
    v_add_f32 v235, v235, v23
    v_fmac_f32 v239, v23, v23
    v_mfma_f32_16x16x32_bf16 v[36:39], v[192:195], v[212:215], v[36:39]
    ds_read_b128 v[192:195], v243 offset:4480
    ds_read_b64 v[212:213], v246 offset:1016
    ds_read_b64 v[214:215], v246 offset:1024
    v_add_f32 v232, v232, v24
    v_fmac_f32 v236, v24, v24
    v_add_f32 v233, v233, v25
    v_fmac_f32 v237, v25, v25
    v_add_f32 v234, v234, v26
    v_fmac_f32 v238, v26, v26
    v_add_f32 v235, v235, v27
    v_fmac_f32 v239, v27, v27
    s_waitcnt lgkmcnt(9)
    v_mfma_f32_16x16x32_bf16 v[40:43], v[196:199], v[216:219], v[40:43]
    ds_read_b128 v[196:199], v243 offset:4800
    ds_read_b64 v[216:217], v246 offset:1088
    ds_read_b64 v[218:219], v246 offset:1096
    v_add_f32 v232, v232, v28
    v_fmac_f32 v236, v28, v28
    v_add_f32 v233, v233, v29
    v_fmac_f32 v237, v29, v29
    v_add_f32 v234, v234, v30
    v_fmac_f32 v238, v30, v30
    v_add_f32 v235, v235, v31
    v_fmac_f32 v239, v31, v31
    v_mfma_f32_16x16x32_bf16 v[44:47], v[200:203], v[220:223], v[44:47]
    ds_read_b128 v[200:203], v243 offset:5120
    ds_read_b64 v[220:221], v246 offset:2336
    ds_read_b64 v[222:223], v246 offset:2344
    v_add_f32 v232, v232, v32
    v_fmac_f32 v236, v32, v32
    v_add_f32 v233, v233, v33
    v_fmac_f32 v237, v33, v33
    v_add_f32 v234, v234, v34
    v_fmac_f32 v238, v34, v34
    v_add_f32 v235, v235, v35
    v_fmac_f32 v239, v35, v35
    s_waitcnt lgkmcnt(9)
    v_mfma_f32_16x16x32_bf16 v[48:51], v[204:207], v[224:227], v[48:51]
    ds_read_b128 v[204:207], v243 offset:5440
    ds_read_b64 v[224:225], v246 offset:2408
    ds_read_b64 v[226:227], v246 offset:2416
    v_add_f32 v232, v232, v36
    v_fmac_f32 v236, v36, v36
    v_add_f32 v233, v233, v37
    v_fmac_f32 v237, v37, v37
    v_add_f32 v234, v234, v38
    v_fmac_f32 v238, v38, v38
    v_add_f32 v235, v235, v39
    v_fmac_f32 v239, v39, v39
    v_mfma_f32_16x16x32_bf16 v[52:55], v[208:211], v[228:231], v[52:55]
    ds_read_b128 v[208:211], v243 offset:5760
    ds_read_b64 v[228:229], v246 offset:2480
    ds_read_b64 v[230:231], v246 offset:2488
    v_add_f32 v232, v232, v40
    v_fmac_f32 v236, v40, v40
    v_add_f32 v233, v233, v41
    v_fmac_f32 v237, v41, v41
    v_add_f32 v234, v234, v42
    v_fmac_f32 v238, v42, v42
    v_add_f32 v235, v235, v43
    v_fmac_f32 v239, v43, v43
    s_waitcnt lgkmcnt(9)
    v_mfma_f32_16x16x32_bf16 v[56:59], v[192:195], v[212:215], v[56:59]
    ds_read_b128 v[192:195], v243 offset:6080
    ds_read_b64 v[212:213], v246 offset:2552
    ds_read_b64 v[214:215], v246 offset:2560
    v_add_f32 v232, v232, v44
    v_fmac_f32 v236, v44, v44
    v_add_f32 v233, v233, v45
    v_fmac_f32 v237, v45, v45
    v_add_f32 v234, v234, v46
    v_fmac_f32 v238, v46, v46
    v_add_f32 v235, v235, v47
    v_fmac_f32 v239, v47, v47
    v_mfma_f32_16x16x32_bf16 v[60:63], v[196:199], v[216:219], v[60:63]
    ds_read_b128 v[196:199], v243 offset:6400
    ds_read_b64 v[216:217], v246 offset:2624
    ds_read_b64 v[218:219], v246 offset:2632
    v_add_f32 v232, v232, v48
    v_fmac_f32 v236, v48, v48
    v_add_f32 v233, v233, v49
    v_fmac_f32 v237, v49, v49
    v_add_f32 v234, v234, v50
    v_fmac_f32 v238, v50, v50
    v_add_f32 v235, v235, v51
    v_fmac_f32 v239, v51, v51
    s_waitcnt lgkmcnt(9)
    v_mfma_f32_16x16x32_bf16 v[64:67], v[200:203], v[220:223], v[64:67]
    ds_read_b128 v[200:203], v243 offset:6720
    ds_read_b64 v[220:221], v246 offset:2696
    ds_read_b64 v[222:223], v246 offset:2704
    v_add_f32 v232, v232, v52
    v_fmac_f32 v236, v52, v52
    v_add_f32 v233, v233, v53
    v_fmac_f32 v237, v53, v53
    v_add_f32 v234, v234, v54
    v_fmac_f32 v238, v54, v54
    v_add_f32 v235, v235, v55
    v_fmac_f32 v239, v55, v55
    v_mfma_f32_16x16x32_bf16 v[68:71], v[204:207], v[224:227], v[68:71]
    ds_read_b128 v[204:207], v243 offset:7040
    ds_read_b64 v[224:225], v246 offset:2768
    ds_read_b64 v[226:227], v246 offset:2776
    v_add_f32 v232, v232, v56
    v_fmac_f32 v236, v56, v56
    v_add_f32 v233, v233, v57
    v_fmac_f32 v237, v57, v57
    v_add_f32 v234, v234, v58
    v_fmac_f32 v238, v58, v58
    v_add_f32 v235, v235, v59
    v_fmac_f32 v239, v59, v59
    s_waitcnt lgkmcnt(9)
    v_mfma_f32_16x16x32_bf16 v[72:75], v[208:211], v[228:231], v[72:75]
    ds_read_b128 v[208:211], v243 offset:7360
    ds_read_b64 v[228:229], v246 offset:2840
    ds_read_b64 v[230:231], v246 offset:2848
    v_add_f32 v232, v232, v60
    v_fmac_f32 v236, v60, v60
    v_add_f32 v233, v233, v61
    v_fmac_f32 v237, v61, v61
    v_add_f32 v234, v234, v62
    v_fmac_f32 v238, v62, v62
    v_add_f32 v235, v235, v63
    v_fmac_f32 v239, v63, v63
    v_mfma_f32_16x16x32_bf16 v[76:79], v[192:195], v[212:215], v[76:79]
    ds_read_b128 v[192:195], v243 offset:7680
    ds_read_b64 v[212:213], v246 offset:2920
    ds_read_b64 v[214:215], v246 offset:2928
    v_add_f32 v232, v232, v64
    v_fmac_f32 v236, v64, v64
    v_add_f32 v233, v233, v65
    v_fmac_f32 v237, v65, v65
    v_add_f32 v234, v234, v66
    v_fmac_f32 v238, v66, v66
    v_add_f32 v235, v235, v67
    v_fmac_f32 v239, v67, v67
    s_waitcnt lgkmcnt(9)
    v_mfma_f32_16x16x32_bf16 v[80:83], v[196:199], v[216:219], v[80:83]
    ds_read_b128 v[196:199], v243 offset:8000
    ds_read_b64 v[216:217], v246 offset:2992
    ds_read_b64 v[218:219], v246 offset:3000
    v_add_f32 v232, v232, v68
    v_fmac_f32 v236, v68, v68
    v_add_f32 v233, v233, v69
    v_fmac_f32 v237, v69, v69
    v_add_f32 v234, v234, v70
    v_fmac_f32 v238, v70, v70
    v_add_f32 v235, v235, v71
    v_fmac_f32 v239, v71, v71
    v_mfma_f32_16x16x32_bf16 v[84:87], v[200:203], v[220:223], v[84:87]
    ds_read_b128 v[200:203], v243 offset:8320
    ds_read_b64 v[220:221], v246 offset:3064
    ds_read_b64 v[222:223], v246 offset:3072
    v_add_f32 v232, v232, v72
    v_fmac_f32 v236, v72, v72
    v_add_f32 v233, v233, v73
    v_fmac_f32 v237, v73, v73
    v_add_f32 v234, v234, v74
    v_fmac_f32 v238, v74, v74
    v_add_f32 v235, v235, v75
    v_fmac_f32 v239, v75, v75
    s_waitcnt lgkmcnt(9)
    v_mfma_f32_16x16x32_bf16 v[88:91], v[204:207], v[224:227], v[88:91]
    ds_read_b128 v[204:207], v243 offset:8640
    ds_read_b64 v[224:225], v246 offset:3136
    ds_read_b64 v[226:227], v246 offset:3144
    v_add_f32 v232, v232, v76
    v_fmac_f32 v236, v76, v76
    v_add_f32 v233, v233, v77
    v_fmac_f32 v237, v77, v77
    v_add_f32 v234, v234, v78
    v_fmac_f32 v238, v78, v78
    v_add_f32 v235, v235, v79
    v_fmac_f32 v239, v79, v79
    v_mfma_f32_16x16x32_bf16 v[92:95], v[208:211], v[228:231], v[92:95]
    ds_read_b128 v[208:211], v243 offset:8960
    ds_read_b64 v[228:229], v246 offset:3208
    ds_read_b64 v[230:231], v246 offset:3216
    v_add_f32 v232, v232, v80
    v_fmac_f32 v236, v80, v80
    v_add_f32 v233, v233, v81
    v_fmac_f32 v237, v81, v81
    v_add_f32 v234, v234, v82
    v_fmac_f32 v238, v82, v82
    v_add_f32 v235, v235, v83
    v_fmac_f32 v239, v83, v83
    s_waitcnt lgkmcnt(9)
    v_mfma_f32_16x16x32_bf16 v[96:99], v[192:195], v[212:215], v[96:99]
    ds_read_b128 v[192:195], v243 offset:9280
    ds_read_b64 v[212:213], v246 offset:3280
    ds_read_b64 v[214:215], v246 offset:3288
    v_add_f32 v232, v232, v84
    v_fmac_f32 v236, v84, v84
    v_add_f32 v233, v233, v85
    v_fmac_f32 v237, v85, v85
    v_add_f32 v234, v234, v86
    v_fmac_f32 v238, v86, v86
    v_add_f32 v235, v235, v87
    v_fmac_f32 v239, v87, v87
    v_mfma_f32_16x16x32_bf16 v[100:103], v[196:199], v[216:219], v[100:103]
    ds_read_b128 v[196:199], v243 offset:9600
    ds_read_b64 v[216:217], v246 offset:3352
    ds_read_b64 v[218:219], v246 offset:3360
    v_add_f32 v232, v232, v88
    v_fmac_f32 v236, v88, v88
    v_add_f32 v233, v233, v89
    v_fmac_f32 v237, v89, v89
    v_add_f32 v234, v234, v90
    v_fmac_f32 v238, v90, v90
    v_add_f32 v235, v235, v91
    v_fmac_f32 v239, v91, v91
    s_waitcnt lgkmcnt(9)
    v_mfma_f32_16x16x32_bf16 v[104:107], v[200:203], v[220:223], v[104:107]
    ds_read_b128 v[200:203], v243 offset:9920
    ds_read_b64 v[220:221], v246 offset:3424
    ds_read_b64 v[222:223], v246 offset:3432
    v_add_f32 v232, v232, v92
    v_fmac_f32 v236, v92, v92
    v_add_f32 v233, v233, v93
    v_fmac_f32 v237, v93, v93
    v_add_f32 v234, v234, v94
    v_fmac_f32 v238, v94, v94
    v_add_f32 v235, v235, v95
    v_fmac_f32 v239, v95, v95
    v_mfma_f32_16x16x32_bf16 v[108:111], v[204:207], v[224:227], v[108:111]
    ds_read_b128 v[204:207], v243 offset:10240
    ds_read_b64 v[224:225], v246 offset:4672
    ds_read_b64 v[226:227], v246 offset:4680
    v_add_f32 v232, v232, v96
    v_fmac_f32 v236, v96, v96
    v_add_f32 v233, v233, v97
    v_fmac_f32 v237, v97, v97
    v_add_f32 v234, v234, v98
    v_fmac_f32 v238, v98, v98
    v_add_f32 v235, v235, v99
    v_fmac_f32 v239, v99, v99
    s_waitcnt lgkmcnt(9)
    v_mfma_f32_16x16x32_bf16 v[112:115], v[208:211], v[228:231], v[112:115]
    ds_read_b128 v[208:211], v243 offset:10560
    ds_read_b64 v[228:229], v246 offset:4744
    ds_read_b64 v[230:231], v246 offset:4752
    v_add_f32 v232, v232, v100
    v_fmac_f32 v236, v100, v100
    v_add_f32 v233, v233, v101
    v_fmac_f32 v237, v101, v101
    v_add_f32 v234, v234, v102
    v_fmac_f32 v238, v102, v102
    v_add_f32 v235, v235, v103
    v_fmac_f32 v239, v103, v103
    v_mfma_f32_16x16x32_bf16 v[116:119], v[192:195], v[212:215], v[116:119]
    ds_read_b128 v[192:195], v243 offset:10880
    ds_read_b64 v[212:213], v246 offset:4816
    ds_read_b64 v[214:215], v246 offset:4824
    v_add_f32 v232, v232, v104
    v_fmac_f32 v236, v104, v104
    v_add_f32 v233, v233, v105
    v_fmac_f32 v237, v105, v105
    v_add_f32 v234, v234, v106
    v_fmac_f32 v238, v106, v106
    v_add_f32 v235, v235, v107
    v_fmac_f32 v239, v107, v107
    s_waitcnt lgkmcnt(9)
    v_mfma_f32_16x16x32_bf16 v[120:123], v[196:199], v[216:219], v[120:123]
    ds_read_b128 v[196:199], v243 offset:11200
    ds_read_b64 v[216:217], v246 offset:4888
    ds_read_b64 v[218:219], v246 offset:4896
    v_add_f32 v232, v232, v108
    v_fmac_f32 v236, v108, v108
    v_add_f32 v233, v233, v109
    v_fmac_f32 v237, v109, v109
    v_add_f32 v234, v234, v110
    v_fmac_f32 v238, v110, v110
    v_add_f32 v235, v235, v111
    v_fmac_f32 v239, v111, v111
    v_mfma_f32_16x16x32_bf16 v[124:127], v[200:203], v[220:223], v[124:127]
    ds_read_b128 v[200:203], v243 offset:11520
    ds_read_b64 v[220:221], v246 offset:4960
    ds_read_b64 v[222:223], v246 offset:4968
    v_add_f32 v232, v232, v112
    v_fmac_f32 v236, v112, v112
    v_add_f32 v233, v233, v113
    v_fmac_f32 v237, v113, v113
    v_add_f32 v234, v234, v114
    v_fmac_f32 v238, v114, v114
    v_add_f32 v235, v235, v115
    v_fmac_f32 v239, v115, v115
    s_waitcnt lgkmcnt(9)
    v_mfma_f32_16x16x32_bf16 v[128:131], v[204:207], v[224:227], v[128:131]
    ds_read_b128 v[204:207], v243 offset:11840
    ds_read_b64 v[224:225], v246 offset:5032
    ds_read_b64 v[226:227], v246 offset:5040
    v_add_f32 v232, v232, v116
    v_fmac_f32 v236, v116, v116
    v_add_f32 v233, v233, v117
    v_fmac_f32 v237, v117, v117
    v_add_f32 v234, v234, v118
    v_fmac_f32 v238, v118, v118
    v_add_f32 v235, v235, v119
    v_fmac_f32 v239, v119, v119
    v_mfma_f32_16x16x32_bf16 v[132:135], v[208:211], v[228:231], v[132:135]
    ds_read_b128 v[208:211], v243 offset:12160
    ds_read_b64 v[228:229], v246 offset:5104
    ds_read_b64 v[230:231], v246 offset:5112
    v_add_f32 v232, v232, v120
    v_fmac_f32 v236, v120, v120
    v_add_f32 v233, v233, v121
    v_fmac_f32 v237, v121, v121
    v_add_f32 v234, v234, v122
    v_fmac_f32 v238, v122, v122
    v_add_f32 v235, v235, v123
    v_fmac_f32 v239, v123, v123
    s_waitcnt lgkmcnt(9)
    v_mfma_f32_16x16x32_bf16 v[136:139], v[192:195], v[212:215], v[136:139]
    ds_read_b128 v[192:195], v243 offset:12480
    ds_read_b64 v[212:213], v246 offset:5176
    ds_read_b64 v[214:215], v246 offset:5184
    v_add_f32 v232, v232, v124
    v_fmac_f32 v236, v124, v124
    v_add_f32 v233, v233, v125
    v_fmac_f32 v237, v125, v125
    v_add_f32 v234, v234, v126
    v_fmac_f32 v238, v126, v126
    v_add_f32 v235, v235, v127
    v_fmac_f32 v239, v127, v127
    v_mfma_f32_16x16x32_bf16 v[140:143], v[196:199], v[216:219], v[140:143]
    ds_read_b128 v[196:199], v243 offset:12800
    ds_read_b64 v[216:217], v246 offset:5256
    ds_read_b64 v[218:219], v246 offset:5264
    v_add_f32 v232, v232, v128
    v_fmac_f32 v236, v128, v128
    v_add_f32 v233, v233, v129
    v_fmac_f32 v237, v129, v129
    v_add_f32 v234, v234, v130
    v_fmac_f32 v238, v130, v130
    v_add_f32 v235, v235, v131
    v_fmac_f32 v239, v131, v131
    s_waitcnt lgkmcnt(9)
    v_mfma_f32_16x16x32_bf16 v[144:147], v[200:203], v[220:223], v[144:147]
    ds_read_b128 v[200:203], v243 offset:13120
    ds_read_b64 v[220:221], v246 offset:5328
    ds_read_b64 v[222:223], v246 offset:5336
    v_add_f32 v232, v232, v132
    v_fmac_f32 v236, v132, v132
    v_add_f32 v233, v233, v133
    v_fmac_f32 v237, v133, v133
    v_add_f32 v234, v234, v134
    v_fmac_f32 v238, v134, v134
    v_add_f32 v235, v235, v135
    v_fmac_f32 v239, v135, v135
    v_mfma_f32_16x16x32_bf16 v[148:151], v[204:207], v[224:227], v[148:151]
    ds_read_b128 v[204:207], v243 offset:13440
    ds_read_b64 v[224:225], v246 offset:5400
    ds_read_b64 v[226:227], v246 offset:5408
    v_add_f32 v232, v232, v136
    v_fmac_f32 v236, v136, v136
    v_add_f32 v233, v233, v137
    v_fmac_f32 v237, v137, v137
    v_add_f32 v234, v234, v138
    v_fmac_f32 v238, v138, v138
    v_add_f32 v235, v235, v139
    v_fmac_f32 v239, v139, v139
    s_waitcnt lgkmcnt(9)
    v_mfma_f32_16x16x32_bf16 v[152:155], v[208:211], v[228:231], v[152:155]
    ds_read_b128 v[208:211], v243 offset:13760
    ds_read_b64 v[228:229], v246 offset:5472
    ds_read_b64 v[230:231], v246 offset:5480
    v_add_f32 v232, v232, v140
    v_fmac_f32 v236, v140, v140
    v_add_f32 v233, v233, v141
    v_fmac_f32 v237, v141, v141
    v_add_f32 v234, v234, v142
    v_fmac_f32 v238, v142, v142
    v_add_f32 v235, v235, v143
    v_fmac_f32 v239, v143, v143
    v_mfma_f32_16x16x32_bf16 v[156:159], v[192:195], v[212:215], v[156:159]
    ds_read_b128 v[192:195], v243 offset:14080
    ds_read_b64 v[212:213], v246 offset:5544
    ds_read_b64 v[214:215], v246 offset:5552
    v_add_f32 v232, v232, v144
    v_fmac_f32 v236, v144, v144
    v_add_f32 v233, v233, v145
    v_fmac_f32 v237, v145, v145
    v_add_f32 v234, v234, v146
    v_fmac_f32 v238, v146, v146
    v_add_f32 v235, v235, v147
    v_fmac_f32 v239, v147, v147
    s_waitcnt lgkmcnt(9)
    v_mfma_f32_16x16x32_bf16 v[160:163], v[196:199], v[216:219], v[160:163]
    ds_read_b128 v[196:199], v243 offset:14400
    ds_read_b64 v[216:217], v246 offset:5616
    ds_read_b64 v[218:219], v246 offset:5624
    v_add_f32 v232, v232, v148
    v_fmac_f32 v236, v148, v148
    v_add_f32 v233, v233, v149
    v_fmac_f32 v237, v149, v149
    v_add_f32 v234, v234, v150
    v_fmac_f32 v238, v150, v150
    v_add_f32 v235, v235, v151
    v_fmac_f32 v239, v151, v151
    v_mfma_f32_16x16x32_bf16 v[164:167], v[200:203], v[220:223], v[164:167]
    ds_read_b128 v[200:203], v243 offset:14720
    ds_read_b64 v[220:221], v246 offset:5688
    ds_read_b64 v[222:223], v246 offset:5696
    v_add_f32 v232, v232, v152
    v_fmac_f32 v236, v152, v152
    v_add_f32 v233, v233, v153
    v_fmac_f32 v237, v153, v153
    v_add_f32 v234, v234, v154
    v_fmac_f32 v238, v154, v154
    v_add_f32 v235, v235, v155
    v_fmac_f32 v239, v155, v155
    s_waitcnt lgkmcnt(9)
    v_mfma_f32_16x16x32_bf16 v[168:171], v[204:207], v[224:227], v[168:171]
    ds_read_b128 v[204:207], v243 offset:15040
    ds_read_b64 v[224:225], v246 offset:5760
    ds_read_b64 v[226:227], v246 offset:5768
    v_add_f32 v232, v232, v156
    v_fmac_f32 v236, v156, v156
    v_add_f32 v233, v233, v157
    v_fmac_f32 v237, v157, v157
    v_add_f32 v234, v234, v158
    v_fmac_f32 v238, v158, v158
    v_add_f32 v235, v235, v159
    v_fmac_f32 v239, v159, v159
    v_mfma_f32_16x16x32_bf16 v[172:175], v[208:211], v[228:231], v[172:175]
    v_add_f32 v232, v232, v160
    v_fmac_f32 v236, v160, v160
    v_add_f32 v233, v233, v161
    v_fmac_f32 v237, v161, v161
    v_add_f32 v234, v234, v162
    v_fmac_f32 v238, v162, v162
    v_add_f32 v235, v235, v163
    v_fmac_f32 v239, v163, v163
    s_waitcnt lgkmcnt(6)
    v_mfma_f32_16x16x32_bf16 v[176:179], v[192:195], v[212:215], v[176:179]
    v_add_f32 v232, v232, v164
    v_fmac_f32 v236, v164, v164
    v_add_f32 v233, v233, v165
    v_fmac_f32 v237, v165, v165
    v_add_f32 v234, v234, v166
    v_fmac_f32 v238, v166, v166
    v_add_f32 v235, v235, v167
    v_fmac_f32 v239, v167, v167
    v_mfma_f32_16x16x32_bf16 v[180:183], v[196:199], v[216:219], v[180:183]
    v_add_f32 v232, v232, v168
    v_fmac_f32 v236, v168, v168
    v_add_f32 v233, v233, v169
    v_fmac_f32 v237, v169, v169
    v_add_f32 v234, v234, v170
    v_fmac_f32 v238, v170, v170
    v_add_f32 v235, v235, v171
    v_fmac_f32 v239, v171, v171
    s_waitcnt lgkmcnt(0)
    v_mfma_f32_16x16x32_bf16 v[184:187], v[200:203], v[220:223], v[184:187]
    ds_write_b32 v254, v255 offset:4
    v_add_f32 v232, v232, v172
    v_fmac_f32 v236, v172, v172
    v_add_f32 v233, v233, v173
    v_fmac_f32 v237, v173, v173
    v_add_f32 v234, v234, v174
    v_fmac_f32 v238, v174, v174
    v_add_f32 v235, v235, v175
    v_fmac_f32 v239, v175, v175
    v_mfma_f32_16x16x32_bf16 v[188:191], v[204:207], v[224:227], v[188:191]
    v_add_f32 v232, v232, v176
    v_fmac_f32 v236, v176, v176
    v_add_f32 v233, v233, v177
    v_fmac_f32 v237, v177, v177
    v_add_f32 v234, v234, v178
    v_fmac_f32 v238, v178, v178
    v_add_f32 v235, v235, v179
    v_fmac_f32 v239, v179, v179
    s_setprio 2
    v_add_f32 v232, v232, v180
    v_fmac_f32 v236, v180, v180
    v_add_f32 v233, v233, v181
    v_fmac_f32 v237, v181, v181
    v_add_f32 v234, v234, v182
    v_fmac_f32 v238, v182, v182
    v_add_f32 v235, v235, v183
    v_fmac_f32 v239, v183, v183
    v_add_f32 v232, v232, v184
    v_fmac_f32 v236, v184, v184
    v_add_f32 v233, v233, v185
    v_fmac_f32 v237, v185, v185
    v_add_f32 v234, v234, v186
    v_fmac_f32 v238, v186, v186
    v_add_f32 v235, v235, v187
    v_fmac_f32 v239, v187, v187
    v_add_f32 v232, v232, v188
    v_fmac_f32 v236, v188, v188
    v_add_f32 v233, v233, v189
    v_fmac_f32 v237, v189, v189
    v_add_f32 v234, v234, v190
    v_fmac_f32 v238, v190, v190
    v_add_f32 v235, v235, v191
    v_fmac_f32 v239, v191, v191

    s_nop 1
    v_permlane32_swap_b32 v232, v233
    v_permlane32_swap_b32 v234, v235
    v_permlane32_swap_b32 v236, v237
    v_permlane32_swap_b32 v238, v239

    v_add_f32 v232, v232, v233
    v_add_f32 v236, v236, v237
    v_mul_f32 v232, 0x3c2aaaab, v232
    v_mul_f32 v236, 0x3c2aaaab, v236
    v_fma_f32 v236, -v232, v232, v236
    v_max_f32 v236, 0, v236
    v_add_f32 v236, 0x3727c5ac, v236
    v_rsq_f32 v236, v236
    s_nop 0
    v_mul_f32 v232, v232, v236
    v_mul_f32 v236, 0x08000000, v236
    v_mul_f32 v232, 0x88000000, v232
    v_mov_b32 v237, v236
    v_mov_b32 v233, v232

    v_add_f32 v234, v234, v235
    v_add_f32 v238, v238, v239
    v_mul_f32 v234, 0x3c2aaaab, v234
    v_mul_f32 v238, 0x3c2aaaab, v238
    v_fma_f32 v238, -v234, v234, v238
    v_max_f32 v238, 0, v238
    v_add_f32 v238, 0x3727c5ac, v238
    v_rsq_f32 v238, v238
    s_nop 0
    v_mul_f32 v234, v234, v238
    v_mul_f32 v238, 0x08000000, v238
    v_mul_f32 v234, 0x88000000, v234
    v_mov_b32 v239, v238
    v_mov_b32 v235, v234

    s_nop 1
    v_permlane32_swap_b32 v232, v233
    v_permlane32_swap_b32 v234, v235
    v_permlane32_swap_b32 v236, v237
    v_permlane32_swap_b32 v238, v239
    s_lshl_b32 s26, s2, 3
    s_add_u32 s26, s26, s16
    s_mul_i32 s36, s26, 12288
    s_add_u32 s37, s36, 4096
    s_add_u32 s38, s36, 8192

    v_pk_fma_f32 v[0:1], v[0:1], v[236:237], v[232:233]
    v_pk_fma_f32 v[2:3], v[2:3], v[238:239], v[234:235]
    v_pk_fma_f32 v[4:5], v[4:5], v[236:237], v[232:233]
    v_pk_fma_f32 v[6:7], v[6:7], v[238:239], v[234:235]
    v_pk_fma_f32 v[8:9], v[8:9], v[236:237], v[232:233]
    v_pk_fma_f32 v[10:11], v[10:11], v[238:239], v[234:235]
    v_pk_fma_f32 v[12:13], v[12:13], v[236:237], v[232:233]
    v_pk_fma_f32 v[14:15], v[14:15], v[238:239], v[234:235]
    v_pk_fma_f32 v[16:17], v[16:17], v[236:237], v[232:233]
    v_pk_fma_f32 v[18:19], v[18:19], v[238:239], v[234:235]
    v_pk_fma_f32 v[20:21], v[20:21], v[236:237], v[232:233]
    v_pk_fma_f32 v[22:23], v[22:23], v[238:239], v[234:235]
    v_pk_fma_f32 v[24:25], v[24:25], v[236:237], v[232:233]
    v_pk_fma_f32 v[26:27], v[26:27], v[238:239], v[234:235]
    v_pk_fma_f32 v[28:29], v[28:29], v[236:237], v[232:233]
    v_pk_fma_f32 v[30:31], v[30:31], v[238:239], v[234:235]
    v_pk_fma_f32 v[32:33], v[32:33], v[236:237], v[232:233]
    v_pk_fma_f32 v[34:35], v[34:35], v[238:239], v[234:235]
    v_pk_fma_f32 v[36:37], v[36:37], v[236:237], v[232:233]
    v_pk_fma_f32 v[38:39], v[38:39], v[238:239], v[234:235]
    v_pk_fma_f32 v[40:41], v[40:41], v[236:237], v[232:233]
    v_pk_fma_f32 v[42:43], v[42:43], v[238:239], v[234:235]
    v_pk_fma_f32 v[44:45], v[44:45], v[236:237], v[232:233]
    v_pk_fma_f32 v[46:47], v[46:47], v[238:239], v[234:235]
    v_pk_fma_f32 v[48:49], v[48:49], v[236:237], v[232:233]
    v_pk_fma_f32 v[50:51], v[50:51], v[238:239], v[234:235]
    v_pk_fma_f32 v[52:53], v[52:53], v[236:237], v[232:233]
    v_pk_fma_f32 v[54:55], v[54:55], v[238:239], v[234:235]
    v_pk_fma_f32 v[56:57], v[56:57], v[236:237], v[232:233]
    v_pk_fma_f32 v[58:59], v[58:59], v[238:239], v[234:235]
    v_pk_fma_f32 v[60:61], v[60:61], v[236:237], v[232:233]
    v_pk_fma_f32 v[62:63], v[62:63], v[238:239], v[234:235]
    v_cvt_pk_bf16_f32 v192, v0, v4
    v_cvt_pk_bf16_f32 v193, v8, v12
    v_cvt_pk_bf16_f32 v194, v16, v20
    v_cvt_pk_bf16_f32 v195, v24, v28
    v_cvt_pk_bf16_f32 v200, v32, v36
    v_cvt_pk_bf16_f32 v201, v40, v44
    v_cvt_pk_bf16_f32 v202, v48, v52
    v_cvt_pk_bf16_f32 v203, v56, v60
    v_cvt_pk_bf16_f32 v196, v1, v5
    v_cvt_pk_bf16_f32 v197, v9, v13
    v_cvt_pk_bf16_f32 v198, v17, v21
    v_cvt_pk_bf16_f32 v199, v25, v29
    v_cvt_pk_bf16_f32 v204, v33, v37
    v_cvt_pk_bf16_f32 v205, v41, v45
    v_cvt_pk_bf16_f32 v206, v49, v53
    v_cvt_pk_bf16_f32 v207, v57, v61
    v_cvt_pk_bf16_f32 v208, v2, v6
    v_cvt_pk_bf16_f32 v209, v10, v14
    v_cvt_pk_bf16_f32 v210, v18, v22
    v_cvt_pk_bf16_f32 v211, v26, v30
    v_cvt_pk_bf16_f32 v216, v34, v38
    v_cvt_pk_bf16_f32 v217, v42, v46
    v_cvt_pk_bf16_f32 v218, v50, v54
    v_cvt_pk_bf16_f32 v219, v58, v62
    v_cvt_pk_bf16_f32 v212, v3, v7
    v_cvt_pk_bf16_f32 v213, v11, v15
    v_cvt_pk_bf16_f32 v214, v19, v23
    v_cvt_pk_bf16_f32 v215, v27, v31
    v_cvt_pk_bf16_f32 v220, v35, v39
    v_cvt_pk_bf16_f32 v221, v43, v47
    v_cvt_pk_bf16_f32 v222, v51, v55
    v_cvt_pk_bf16_f32 v223, v59, v63
    s_nop 0
    v_permlane16_swap_b32 v192, v200
    v_permlane16_swap_b32 v193, v201
    v_permlane16_swap_b32 v194, v202
    v_permlane16_swap_b32 v195, v203
    v_permlane16_swap_b32 v196, v204
    v_permlane16_swap_b32 v197, v205
    v_permlane16_swap_b32 v198, v206
    v_permlane16_swap_b32 v199, v207
    v_permlane16_swap_b32 v208, v216
    v_permlane16_swap_b32 v209, v217
    v_permlane16_swap_b32 v210, v218
    v_permlane16_swap_b32 v211, v219
    v_permlane16_swap_b32 v212, v220
    v_permlane16_swap_b32 v213, v221
    v_permlane16_swap_b32 v214, v222
    v_permlane16_swap_b32 v215, v223
    buffer_store_dwordx4 v[192:195], v253, s[12:15], s36 offen offset:0
    buffer_store_dwordx4 v[196:199], v253, s[12:15], s36 offen offset:1024
    buffer_store_dwordx4 v[200:203], v253, s[12:15], s36 offen offset:2048
    buffer_store_dwordx4 v[204:207], v253, s[12:15], s36 offen offset:3072
    v_mov_b32 v0, v208
    v_mov_b32 v1, v209
    v_mov_b32 v2, v210
    v_mov_b32 v3, v211
    v_mov_b32 v4, v212
    v_mov_b32 v5, v213
    v_mov_b32 v6, v214
    v_mov_b32 v7, v215
    v_mov_b32 v8, v216
    v_mov_b32 v9, v217
    v_mov_b32 v10, v218
    v_mov_b32 v11, v219
    v_mov_b32 v12, v220
    v_mov_b32 v13, v221
    v_mov_b32 v14, v222
    v_mov_b32 v15, v223
    v_pk_fma_f32 v[64:65], v[64:65], v[236:237], v[232:233]
    v_pk_fma_f32 v[66:67], v[66:67], v[238:239], v[234:235]
    v_pk_fma_f32 v[68:69], v[68:69], v[236:237], v[232:233]
    v_pk_fma_f32 v[70:71], v[70:71], v[238:239], v[234:235]
    v_pk_fma_f32 v[72:73], v[72:73], v[236:237], v[232:233]
    v_pk_fma_f32 v[74:75], v[74:75], v[238:239], v[234:235]
    v_pk_fma_f32 v[76:77], v[76:77], v[236:237], v[232:233]
    v_pk_fma_f32 v[78:79], v[78:79], v[238:239], v[234:235]
    v_pk_fma_f32 v[80:81], v[80:81], v[236:237], v[232:233]
    v_pk_fma_f32 v[82:83], v[82:83], v[238:239], v[234:235]
    v_pk_fma_f32 v[84:85], v[84:85], v[236:237], v[232:233]
    v_pk_fma_f32 v[86:87], v[86:87], v[238:239], v[234:235]
    v_pk_fma_f32 v[88:89], v[88:89], v[236:237], v[232:233]
    v_pk_fma_f32 v[90:91], v[90:91], v[238:239], v[234:235]
    v_pk_fma_f32 v[92:93], v[92:93], v[236:237], v[232:233]
    v_pk_fma_f32 v[94:95], v[94:95], v[238:239], v[234:235]
    v_pk_fma_f32 v[96:97], v[96:97], v[236:237], v[232:233]
    v_pk_fma_f32 v[98:99], v[98:99], v[238:239], v[234:235]
    v_pk_fma_f32 v[100:101], v[100:101], v[236:237], v[232:233]
    v_pk_fma_f32 v[102:103], v[102:103], v[238:239], v[234:235]
    v_pk_fma_f32 v[104:105], v[104:105], v[236:237], v[232:233]
    v_pk_fma_f32 v[106:107], v[106:107], v[238:239], v[234:235]
    v_pk_fma_f32 v[108:109], v[108:109], v[236:237], v[232:233]
    v_pk_fma_f32 v[110:111], v[110:111], v[238:239], v[234:235]
    v_pk_fma_f32 v[112:113], v[112:113], v[236:237], v[232:233]
    v_pk_fma_f32 v[114:115], v[114:115], v[238:239], v[234:235]
    v_pk_fma_f32 v[116:117], v[116:117], v[236:237], v[232:233]
    v_pk_fma_f32 v[118:119], v[118:119], v[238:239], v[234:235]
    v_pk_fma_f32 v[120:121], v[120:121], v[236:237], v[232:233]
    v_pk_fma_f32 v[122:123], v[122:123], v[238:239], v[234:235]
    v_pk_fma_f32 v[124:125], v[124:125], v[236:237], v[232:233]
    v_pk_fma_f32 v[126:127], v[126:127], v[238:239], v[234:235]
    v_cvt_pk_bf16_f32 v208, v64, v68
    v_cvt_pk_bf16_f32 v209, v72, v76
    v_cvt_pk_bf16_f32 v210, v80, v84
    v_cvt_pk_bf16_f32 v211, v88, v92
    v_cvt_pk_bf16_f32 v216, v96, v100
    v_cvt_pk_bf16_f32 v217, v104, v108
    v_cvt_pk_bf16_f32 v218, v112, v116
    v_cvt_pk_bf16_f32 v219, v120, v124
    v_cvt_pk_bf16_f32 v212, v65, v69
    v_cvt_pk_bf16_f32 v213, v73, v77
    v_cvt_pk_bf16_f32 v214, v81, v85
    v_cvt_pk_bf16_f32 v215, v89, v93
    v_cvt_pk_bf16_f32 v220, v97, v101
    v_cvt_pk_bf16_f32 v221, v105, v109
    v_cvt_pk_bf16_f32 v222, v113, v117
    v_cvt_pk_bf16_f32 v223, v121, v125
    v_cvt_pk_bf16_f32 v16, v66, v70
    v_cvt_pk_bf16_f32 v17, v74, v78
    v_cvt_pk_bf16_f32 v18, v82, v86
    v_cvt_pk_bf16_f32 v19, v90, v94
    v_cvt_pk_bf16_f32 v24, v98, v102
    v_cvt_pk_bf16_f32 v25, v106, v110
    v_cvt_pk_bf16_f32 v26, v114, v118
    v_cvt_pk_bf16_f32 v27, v122, v126
    v_cvt_pk_bf16_f32 v20, v67, v71
    v_cvt_pk_bf16_f32 v21, v75, v79
    v_cvt_pk_bf16_f32 v22, v83, v87
    v_cvt_pk_bf16_f32 v23, v91, v95
    v_cvt_pk_bf16_f32 v28, v99, v103
    v_cvt_pk_bf16_f32 v29, v107, v111
    v_cvt_pk_bf16_f32 v30, v115, v119
    v_cvt_pk_bf16_f32 v31, v123, v127
    s_nop 0
    v_permlane16_swap_b32 v208, v216
    v_permlane16_swap_b32 v209, v217
    v_permlane16_swap_b32 v210, v218
    v_permlane16_swap_b32 v211, v219
    v_permlane16_swap_b32 v212, v220
    v_permlane16_swap_b32 v213, v221
    v_permlane16_swap_b32 v214, v222
    v_permlane16_swap_b32 v215, v223
    v_permlane16_swap_b32 v16, v24
    v_permlane16_swap_b32 v17, v25
    v_permlane16_swap_b32 v18, v26
    v_permlane16_swap_b32 v19, v27
    v_permlane16_swap_b32 v20, v28
    v_permlane16_swap_b32 v21, v29
    v_permlane16_swap_b32 v22, v30
    v_permlane16_swap_b32 v23, v31
    buffer_store_dwordx4 v[208:211], v253, s[12:15], s37 offen offset:0
    buffer_store_dwordx4 v[212:215], v253, s[12:15], s37 offen offset:1024
    buffer_store_dwordx4 v[216:219], v253, s[12:15], s37 offen offset:2048
    buffer_store_dwordx4 v[220:223], v253, s[12:15], s37 offen offset:3072
    v_pk_fma_f32 v[128:129], v[128:129], v[236:237], v[232:233]
    v_pk_fma_f32 v[130:131], v[130:131], v[238:239], v[234:235]
    v_pk_fma_f32 v[132:133], v[132:133], v[236:237], v[232:233]
    v_pk_fma_f32 v[134:135], v[134:135], v[238:239], v[234:235]
    v_pk_fma_f32 v[136:137], v[136:137], v[236:237], v[232:233]
    v_pk_fma_f32 v[138:139], v[138:139], v[238:239], v[234:235]
    v_pk_fma_f32 v[140:141], v[140:141], v[236:237], v[232:233]
    v_pk_fma_f32 v[142:143], v[142:143], v[238:239], v[234:235]
    v_pk_fma_f32 v[144:145], v[144:145], v[236:237], v[232:233]
    v_pk_fma_f32 v[146:147], v[146:147], v[238:239], v[234:235]
    v_pk_fma_f32 v[148:149], v[148:149], v[236:237], v[232:233]
    v_pk_fma_f32 v[150:151], v[150:151], v[238:239], v[234:235]
    v_pk_fma_f32 v[152:153], v[152:153], v[236:237], v[232:233]
    v_pk_fma_f32 v[154:155], v[154:155], v[238:239], v[234:235]
    v_pk_fma_f32 v[156:157], v[156:157], v[236:237], v[232:233]
    v_pk_fma_f32 v[158:159], v[158:159], v[238:239], v[234:235]
    v_pk_fma_f32 v[160:161], v[160:161], v[236:237], v[232:233]
    v_pk_fma_f32 v[162:163], v[162:163], v[238:239], v[234:235]
    v_pk_fma_f32 v[164:165], v[164:165], v[236:237], v[232:233]
    v_pk_fma_f32 v[166:167], v[166:167], v[238:239], v[234:235]
    v_pk_fma_f32 v[168:169], v[168:169], v[236:237], v[232:233]
    v_pk_fma_f32 v[170:171], v[170:171], v[238:239], v[234:235]
    v_pk_fma_f32 v[172:173], v[172:173], v[236:237], v[232:233]
    v_pk_fma_f32 v[174:175], v[174:175], v[238:239], v[234:235]
    v_pk_fma_f32 v[176:177], v[176:177], v[236:237], v[232:233]
    v_pk_fma_f32 v[178:179], v[178:179], v[238:239], v[234:235]
    v_pk_fma_f32 v[180:181], v[180:181], v[236:237], v[232:233]
    v_pk_fma_f32 v[182:183], v[182:183], v[238:239], v[234:235]
    v_pk_fma_f32 v[184:185], v[184:185], v[236:237], v[232:233]
    v_pk_fma_f32 v[186:187], v[186:187], v[238:239], v[234:235]
    v_pk_fma_f32 v[188:189], v[188:189], v[236:237], v[232:233]
    v_pk_fma_f32 v[190:191], v[190:191], v[238:239], v[234:235]
    v_cvt_pk_bf16_f32 v192, v128, v132
    v_cvt_pk_bf16_f32 v193, v136, v140
    v_cvt_pk_bf16_f32 v194, v144, v148
    v_cvt_pk_bf16_f32 v195, v152, v156
    v_cvt_pk_bf16_f32 v200, v160, v164
    v_cvt_pk_bf16_f32 v201, v168, v172
    v_cvt_pk_bf16_f32 v202, v176, v180
    v_cvt_pk_bf16_f32 v203, v184, v188
    v_cvt_pk_bf16_f32 v196, v129, v133
    v_cvt_pk_bf16_f32 v197, v137, v141
    v_cvt_pk_bf16_f32 v198, v145, v149
    v_cvt_pk_bf16_f32 v199, v153, v157
    v_cvt_pk_bf16_f32 v204, v161, v165
    v_cvt_pk_bf16_f32 v205, v169, v173
    v_cvt_pk_bf16_f32 v206, v177, v181
    v_cvt_pk_bf16_f32 v207, v185, v189
    v_cvt_pk_bf16_f32 v32, v130, v134
    v_cvt_pk_bf16_f32 v33, v138, v142
    v_cvt_pk_bf16_f32 v34, v146, v150
    v_cvt_pk_bf16_f32 v35, v154, v158
    v_cvt_pk_bf16_f32 v40, v162, v166
    v_cvt_pk_bf16_f32 v41, v170, v174
    v_cvt_pk_bf16_f32 v42, v178, v182
    v_cvt_pk_bf16_f32 v43, v186, v190
    v_cvt_pk_bf16_f32 v36, v131, v135
    v_cvt_pk_bf16_f32 v37, v139, v143
    v_cvt_pk_bf16_f32 v38, v147, v151
    v_cvt_pk_bf16_f32 v39, v155, v159
    v_cvt_pk_bf16_f32 v44, v163, v167
    v_cvt_pk_bf16_f32 v45, v171, v175
    v_cvt_pk_bf16_f32 v46, v179, v183
    v_cvt_pk_bf16_f32 v47, v187, v191
    s_nop 0
    v_permlane16_swap_b32 v192, v200
    v_permlane16_swap_b32 v193, v201
    v_permlane16_swap_b32 v194, v202
    v_permlane16_swap_b32 v195, v203
    v_permlane16_swap_b32 v196, v204
    v_permlane16_swap_b32 v197, v205
    v_permlane16_swap_b32 v198, v206
    v_permlane16_swap_b32 v199, v207
    v_permlane16_swap_b32 v32, v40
    v_permlane16_swap_b32 v33, v41
    v_permlane16_swap_b32 v34, v42
    v_permlane16_swap_b32 v35, v43
    v_permlane16_swap_b32 v36, v44
    v_permlane16_swap_b32 v37, v45
    v_permlane16_swap_b32 v38, v46
    v_permlane16_swap_b32 v39, v47
    buffer_store_dwordx4 v[192:195], v253, s[12:15], s38 offen offset:0
    buffer_store_dwordx4 v[196:199], v253, s[12:15], s38 offen offset:1024
    buffer_store_dwordx4 v[200:203], v253, s[12:15], s38 offen offset:2048
    buffer_store_dwordx4 v[204:207], v253, s[12:15], s38 offen offset:3072

    s_mov_b32 s18, 8
    s_cmp_eq_u32 s16, 0
    s_cbranch_scc1 L_xload
    s_branch L_p2
L_loader:

    v_lshrrev_b32 v60, 9, v253
    v_mul_u32_u24 v61, 1536, v60
    v_add_u32 v61, v61, v253
    v_bfe_u32 v254, v253, 6, 3
    v_lshl_add_u32 v60, v60, 4, v254
    v_mul_u32_u24 v60, 768, v60
    v_and_b32 v254, 48, v253
    v_add_u32 v60, v60, v254

    s_setprio 0
    v_add_u32 v254, 161932, v240

    s_mov_b32 s29, 200000
L_wg0:
    ds_read_b32 v255, v254
    s_waitcnt lgkmcnt(0)
    v_cmp_ne_u32 vcc, 0, v255
    s_cmp_eq_u64 vcc, exec
    s_cbranch_scc1 L_wg0_ok
    s_sleep 2
    s_sub_u32 s29, s29, 1
    s_cmp_lg_u32 s29, 0
    s_cbranch_scc1 L_wg0
L_wg0_ok:

    s_setprio 3

    s_add_u32 s26, s39, 1
    s_cmp_ge_u32 s26, 12
    s_cselect_b32 s27, 12, 0
    s_sub_u32 s26, s26, s27
    s_mul_i32 s26, s26, 6144

    s_mov_b32 m0, 7168
    s_add_u32 s30, s26, 0
    s_add_u32 s31, s26, 1536
    buffer_load_dwordx4 v253, s[44:47], s30 offen lds
    buffer_load_dwordx4 v61, s[44:47], s30 offen offset:1024 lds
    buffer_load_dwordx4 v253, s[44:47], s31 offen offset:2048 lds
    s_mov_b32 m0, 72712
    s_add_u32 s30, s26, 1536
    s_add_u32 s31, s26, 3072
    buffer_load_dwordx4 v253, s[44:47], s30 offen lds
    buffer_load_dwordx4 v61, s[44:47], s30 offen offset:1024 lds
    buffer_load_dwordx4 v253, s[44:47], s31 offen offset:2048 lds

    s_add_u32 s26, s39, 4
    s_cmp_ge_u32 s26, 12
    s_cselect_b32 s27, 12, 0
    s_sub_u32 s26, s26, s27
    s_mul_i32 s26, s26, 64

    s_mov_b32 m0, 10240
    s_add_u32 s30, s26, 0
    s_add_u32 s31, s26, 23552
    s_add_u32 s32, s26, 47104
    buffer_load_dwordx4 v60, s[40:43], s30 offen offset:0 lds
    buffer_load_dwordx4 v60, s[40:43], s31 offen offset:1024 lds
    buffer_load_dwordx4 v60, s[40:43], s32 offen offset:2048 lds
    s_mov_b32 m0, 75784
    s_add_u32 s30, s26, 6144
    s_add_u32 s31, s26, 29696
    s_add_u32 s32, s26, 53248
    buffer_load_dwordx4 v60, s[40:43], s30 offen offset:0 lds
    buffer_load_dwordx4 v60, s[40:43], s31 offen offset:1024 lds
    buffer_load_dwordx4 v60, s[40:43], s32 offen offset:2048 lds

    s_add_u32 s26, s39, 2
    s_cmp_ge_u32 s26, 12
    s_cselect_b32 s27, 12, 0
    s_sub_u32 s26, s26, s27
    s_mul_i32 s26, s26, 6144

    s_mov_b32 m0, 13312
    s_add_u32 s30, s26, 0
    s_add_u32 s31, s26, 1536
    buffer_load_dwordx4 v253, s[44:47], s30 offen lds
    buffer_load_dwordx4 v61, s[44:47], s30 offen offset:1024 lds
    buffer_load_dwordx4 v253, s[44:47], s31 offen offset:2048 lds
    s_mov_b32 m0, 78856
    s_add_u32 s30, s26, 1536
    s_add_u32 s31, s26, 3072
    buffer_load_dwordx4 v253, s[44:47], s30 offen lds
    buffer_load_dwordx4 v61, s[44:47], s30 offen offset:1024 lds
    buffer_load_dwordx4 v253, s[44:47], s31 offen offset:2048 lds

    s_add_u32 s26, s39, 5
    s_cmp_ge_u32 s26, 12
    s_cselect_b32 s27, 12, 0
    s_sub_u32 s26, s26, s27
    s_mul_i32 s26, s26, 64

    s_mov_b32 m0, 16384
    s_add_u32 s30, s26, 0
    s_add_u32 s31, s26, 23552
    s_add_u32 s32, s26, 47104
    buffer_load_dwordx4 v60, s[40:43], s30 offen offset:0 lds
    buffer_load_dwordx4 v60, s[40:43], s31 offen offset:1024 lds
    buffer_load_dwordx4 v60, s[40:43], s32 offen offset:2048 lds
    s_mov_b32 m0, 81928
    s_add_u32 s30, s26, 6144
    s_add_u32 s31, s26, 29696
    s_add_u32 s32, s26, 53248
    buffer_load_dwordx4 v60, s[40:43], s30 offen offset:0 lds
    buffer_load_dwordx4 v60, s[40:43], s31 offen offset:1024 lds
    buffer_load_dwordx4 v60, s[40:43], s32 offen offset:2048 lds
    v_mov_b32 v254, 161976
    v_mov_b32 v64, 1
    s_waitcnt vmcnt(18)
    ds_write_b32 v254, v64
    v_mov_b32 v65, 2
    s_waitcnt vmcnt(12)
    ds_write_b32 v254, v65
    v_mov_b32 v66, 3
    s_waitcnt vmcnt(6)
    ds_write_b32 v254, v66
    v_mov_b32 v67, 4
    s_waitcnt vmcnt(0)
    ds_write_b32 v254, v67
    s_setprio 0
    v_add_u32 v254, 161940, v240

    s_mov_b32 s29, 200000
L_wg1:
    ds_read_b32 v255, v254
    s_waitcnt lgkmcnt(0)
    v_cmp_ne_u32 vcc, 0, v255
    s_cmp_eq_u64 vcc, exec
    s_cbranch_scc1 L_wg1_ok
    s_sleep 2
    s_sub_u32 s29, s29, 1
    s_cmp_lg_u32 s29, 0
    s_cbranch_scc1 L_wg1
L_wg1_ok:

    s_setprio 3

    s_add_u32 s26, s39, 3
    s_cmp_ge_u32 s26, 12
    s_cselect_b32 s27, 12, 0
    s_sub_u32 s26, s26, s27
    s_mul_i32 s26, s26, 6144

    s_mov_b32 m0, 19456
    s_add_u32 s30, s26, 0
    s_add_u32 s31, s26, 1536
    buffer_load_dwordx4 v253, s[44:47], s30 offen lds
    buffer_load_dwordx4 v61, s[44:47], s30 offen offset:1024 lds
    buffer_load_dwordx4 v253, s[44:47], s31 offen offset:2048 lds
    s_mov_b32 m0, 85000
    s_add_u32 s30, s26, 1536
    s_add_u32 s31, s26, 3072
    buffer_load_dwordx4 v253, s[44:47], s30 offen lds
    buffer_load_dwordx4 v61, s[44:47], s30 offen offset:1024 lds
    buffer_load_dwordx4 v253, s[44:47], s31 offen offset:2048 lds

    s_add_u32 s26, s39, 6
    s_cmp_ge_u32 s26, 12
    s_cselect_b32 s27, 12, 0
    s_sub_u32 s26, s26, s27
    s_mul_i32 s26, s26, 64

    s_mov_b32 m0, 22528
    s_add_u32 s30, s26, 0
    s_add_u32 s31, s26, 23552
    s_add_u32 s32, s26, 47104
    buffer_load_dwordx4 v60, s[40:43], s30 offen offset:0 lds
    buffer_load_dwordx4 v60, s[40:43], s31 offen offset:1024 lds
    buffer_load_dwordx4 v60, s[40:43], s32 offen offset:2048 lds
    s_mov_b32 m0, 88072
    s_add_u32 s30, s26, 6144
    s_add_u32 s31, s26, 29696
    s_add_u32 s32, s26, 53248
    buffer_load_dwordx4 v60, s[40:43], s30 offen offset:0 lds
    buffer_load_dwordx4 v60, s[40:43], s31 offen offset:1024 lds
    buffer_load_dwordx4 v60, s[40:43], s32 offen offset:2048 lds

    s_add_u32 s26, s39, 4
    s_cmp_ge_u32 s26, 12
    s_cselect_b32 s27, 12, 0
    s_sub_u32 s26, s26, s27
    s_mul_i32 s26, s26, 6144

    s_mov_b32 m0, 25600
    s_add_u32 s30, s26, 0
    s_add_u32 s31, s26, 1536
    buffer_load_dwordx4 v253, s[44:47], s30 offen lds
    buffer_load_dwordx4 v61, s[44:47], s30 offen offset:1024 lds
    buffer_load_dwordx4 v253, s[44:47], s31 offen offset:2048 lds
    s_mov_b32 m0, 91144
    s_add_u32 s30, s26, 1536
    s_add_u32 s31, s26, 3072
    buffer_load_dwordx4 v253, s[44:47], s30 offen lds
    buffer_load_dwordx4 v61, s[44:47], s30 offen offset:1024 lds
    buffer_load_dwordx4 v253, s[44:47], s31 offen offset:2048 lds

    s_add_u32 s26, s39, 7
    s_cmp_ge_u32 s26, 12
    s_cselect_b32 s27, 12, 0
    s_sub_u32 s26, s26, s27
    s_mul_i32 s26, s26, 64

    s_mov_b32 m0, 28672
    s_add_u32 s30, s26, 0
    s_add_u32 s31, s26, 23552
    s_add_u32 s32, s26, 47104
    buffer_load_dwordx4 v60, s[40:43], s30 offen offset:0 lds
    buffer_load_dwordx4 v60, s[40:43], s31 offen offset:1024 lds
    buffer_load_dwordx4 v60, s[40:43], s32 offen offset:2048 lds
    s_mov_b32 m0, 94216
    s_add_u32 s30, s26, 6144
    s_add_u32 s31, s26, 29696
    s_add_u32 s32, s26, 53248
    buffer_load_dwordx4 v60, s[40:43], s30 offen offset:0 lds
    buffer_load_dwordx4 v60, s[40:43], s31 offen offset:1024 lds
    buffer_load_dwordx4 v60, s[40:43], s32 offen offset:2048 lds

    s_add_u32 s26, s39, 5
    s_cmp_ge_u32 s26, 12
    s_cselect_b32 s27, 12, 0
    s_sub_u32 s26, s26, s27
    s_mul_i32 s26, s26, 6144

    s_mov_b32 m0, 31744
    s_add_u32 s30, s26, 0
    s_add_u32 s31, s26, 1536
    buffer_load_dwordx4 v253, s[44:47], s30 offen lds
    buffer_load_dwordx4 v61, s[44:47], s30 offen offset:1024 lds
    buffer_load_dwordx4 v253, s[44:47], s31 offen offset:2048 lds
    s_mov_b32 m0, 97288
    s_add_u32 s30, s26, 1536
    s_add_u32 s31, s26, 3072
    buffer_load_dwordx4 v253, s[44:47], s30 offen lds
    buffer_load_dwordx4 v61, s[44:47], s30 offen offset:1024 lds
    buffer_load_dwordx4 v253, s[44:47], s31 offen offset:2048 lds
    v_mov_b32 v254, 161976
    v_mov_b32 v68, 5
    s_waitcnt vmcnt(24)
    ds_write_b32 v254, v68
    v_mov_b32 v69, 6
    s_waitcnt vmcnt(18)
    ds_write_b32 v254, v69
    v_mov_b32 v70, 7
    s_waitcnt vmcnt(12)
    ds_write_b32 v254, v70
    v_mov_b32 v71, 8
    s_waitcnt vmcnt(6)
    ds_write_b32 v254, v71
    v_mov_b32 v72, 9
    s_waitcnt vmcnt(0)
    ds_write_b32 v254, v72
    s_setprio 0
    v_add_u32 v254, 161948, v240

    s_mov_b32 s29, 200000
L_wg2:
    ds_read_b32 v255, v254
    s_waitcnt lgkmcnt(0)
    v_cmp_ne_u32 vcc, 0, v255
    s_cmp_eq_u64 vcc, exec
    s_cbranch_scc1 L_wg2_ok
    s_sleep 2
    s_sub_u32 s29, s29, 1
    s_cmp_lg_u32 s29, 0
    s_cbranch_scc1 L_wg2
L_wg2_ok:

    s_setprio 3

    s_add_u32 s26, s39, 8
    s_cmp_ge_u32 s26, 12
    s_cselect_b32 s27, 12, 0
    s_sub_u32 s26, s26, s27
    s_mul_i32 s26, s26, 64

    s_mov_b32 m0, 34816
    s_add_u32 s30, s26, 0
    s_add_u32 s31, s26, 23552
    s_add_u32 s32, s26, 47104
    buffer_load_dwordx4 v60, s[40:43], s30 offen offset:0 lds
    buffer_load_dwordx4 v60, s[40:43], s31 offen offset:1024 lds
    buffer_load_dwordx4 v60, s[40:43], s32 offen offset:2048 lds
    s_mov_b32 m0, 100360
    s_add_u32 s30, s26, 6144
    s_add_u32 s31, s26, 29696
    s_add_u32 s32, s26, 53248
    buffer_load_dwordx4 v60, s[40:43], s30 offen offset:0 lds
    buffer_load_dwordx4 v60, s[40:43], s31 offen offset:1024 lds
    buffer_load_dwordx4 v60, s[40:43], s32 offen offset:2048 lds

    s_add_u32 s26, s39, 6
    s_cmp_ge_u32 s26, 12
    s_cselect_b32 s27, 12, 0
    s_sub_u32 s26, s26, s27
    s_mul_i32 s26, s26, 6144

    s_mov_b32 m0, 37888
    s_add_u32 s30, s26, 0
    s_add_u32 s31, s26, 1536
    buffer_load_dwordx4 v253, s[44:47], s30 offen lds
    buffer_load_dwordx4 v61, s[44:47], s30 offen offset:1024 lds
    buffer_load_dwordx4 v253, s[44:47], s31 offen offset:2048 lds
    s_mov_b32 m0, 103432
    s_add_u32 s30, s26, 1536
    s_add_u32 s31, s26, 3072
    buffer_load_dwordx4 v253, s[44:47], s30 offen lds
    buffer_load_dwordx4 v61, s[44:47], s30 offen offset:1024 lds
    buffer_load_dwordx4 v253, s[44:47], s31 offen offset:2048 lds

    s_add_u32 s26, s39, 9
    s_cmp_ge_u32 s26, 12
    s_cselect_b32 s27, 12, 0
    s_sub_u32 s26, s26, s27
    s_mul_i32 s26, s26, 64

    s_mov_b32 m0, 40960
    s_add_u32 s30, s26, 0
    s_add_u32 s31, s26, 23552
    s_add_u32 s32, s26, 47104
    buffer_load_dwordx4 v60, s[40:43], s30 offen offset:0 lds
    buffer_load_dwordx4 v60, s[40:43], s31 offen offset:1024 lds
    buffer_load_dwordx4 v60, s[40:43], s32 offen offset:2048 lds
    s_mov_b32 m0, 106504
    s_add_u32 s30, s26, 6144
    s_add_u32 s31, s26, 29696
    s_add_u32 s32, s26, 53248
    buffer_load_dwordx4 v60, s[40:43], s30 offen offset:0 lds
    buffer_load_dwordx4 v60, s[40:43], s31 offen offset:1024 lds
    buffer_load_dwordx4 v60, s[40:43], s32 offen offset:2048 lds

    s_add_u32 s26, s39, 7
    s_cmp_ge_u32 s26, 12
    s_cselect_b32 s27, 12, 0
    s_sub_u32 s26, s26, s27
    s_mul_i32 s26, s26, 6144

    s_mov_b32 m0, 44032
    s_add_u32 s30, s26, 0
    s_add_u32 s31, s26, 1536
    buffer_load_dwordx4 v253, s[44:47], s30 offen lds
    buffer_load_dwordx4 v61, s[44:47], s30 offen offset:1024 lds
    buffer_load_dwordx4 v253, s[44:47], s31 offen offset:2048 lds
    s_mov_b32 m0, 109576
    s_add_u32 s30, s26, 1536
    s_add_u32 s31, s26, 3072
    buffer_load_dwordx4 v253, s[44:47], s30 offen lds
    buffer_load_dwordx4 v61, s[44:47], s30 offen offset:1024 lds
    buffer_load_dwordx4 v253, s[44:47], s31 offen offset:2048 lds

    s_add_u32 s26, s39, 10
    s_cmp_ge_u32 s26, 12
    s_cselect_b32 s27, 12, 0
    s_sub_u32 s26, s26, s27
    s_mul_i32 s26, s26, 64

    s_mov_b32 m0, 47104
    s_add_u32 s30, s26, 0
    s_add_u32 s31, s26, 23552
    s_add_u32 s32, s26, 47104
    buffer_load_dwordx4 v60, s[40:43], s30 offen offset:0 lds
    buffer_load_dwordx4 v60, s[40:43], s31 offen offset:1024 lds
    buffer_load_dwordx4 v60, s[40:43], s32 offen offset:2048 lds
    s_mov_b32 m0, 112648
    s_add_u32 s30, s26, 6144
    s_add_u32 s31, s26, 29696
    s_add_u32 s32, s26, 53248
    buffer_load_dwordx4 v60, s[40:43], s30 offen offset:0 lds
    buffer_load_dwordx4 v60, s[40:43], s31 offen offset:1024 lds
    buffer_load_dwordx4 v60, s[40:43], s32 offen offset:2048 lds

    s_add_u32 s26, s39, 8
    s_cmp_ge_u32 s26, 12
    s_cselect_b32 s27, 12, 0
    s_sub_u32 s26, s26, s27
    s_mul_i32 s26, s26, 6144

    s_mov_b32 m0, 50176
    s_add_u32 s30, s26, 0
    s_add_u32 s31, s26, 1536
    buffer_load_dwordx4 v253, s[44:47], s30 offen lds
    buffer_load_dwordx4 v61, s[44:47], s30 offen offset:1024 lds
    buffer_load_dwordx4 v253, s[44:47], s31 offen offset:2048 lds
    s_mov_b32 m0, 115720
    s_add_u32 s30, s26, 1536
    s_add_u32 s31, s26, 3072
    buffer_load_dwordx4 v253, s[44:47], s30 offen lds
    buffer_load_dwordx4 v61, s[44:47], s30 offen offset:1024 lds
    buffer_load_dwordx4 v253, s[44:47], s31 offen offset:2048 lds

    s_add_u32 s26, s39, 11
    s_cmp_ge_u32 s26, 12
    s_cselect_b32 s27, 12, 0
    s_sub_u32 s26, s26, s27
    s_mul_i32 s26, s26, 64

    s_mov_b32 m0, 53248
    s_add_u32 s30, s26, 0
    s_add_u32 s31, s26, 23552
    s_add_u32 s32, s26, 47104
    buffer_load_dwordx4 v60, s[40:43], s30 offen offset:0 lds
    buffer_load_dwordx4 v60, s[40:43], s31 offen offset:1024 lds
    buffer_load_dwordx4 v60, s[40:43], s32 offen offset:2048 lds
    s_mov_b32 m0, 118792
    s_add_u32 s30, s26, 6144
    s_add_u32 s31, s26, 29696
    s_add_u32 s32, s26, 53248
    buffer_load_dwordx4 v60, s[40:43], s30 offen offset:0 lds
    buffer_load_dwordx4 v60, s[40:43], s31 offen offset:1024 lds
    buffer_load_dwordx4 v60, s[40:43], s32 offen offset:2048 lds

    s_add_u32 s26, s39, 9
    s_cmp_ge_u32 s26, 12
    s_cselect_b32 s27, 12, 0
    s_sub_u32 s26, s26, s27
    s_mul_i32 s26, s26, 6144

    s_mov_b32 m0, 56320
    s_add_u32 s30, s26, 0
    s_add_u32 s31, s26, 1536
    buffer_load_dwordx4 v253, s[44:47], s30 offen lds
    buffer_load_dwordx4 v61, s[44:47], s30 offen offset:1024 lds
    buffer_load_dwordx4 v253, s[44:47], s31 offen offset:2048 lds
    s_mov_b32 m0, 121864
    s_add_u32 s30, s26, 1536
    s_add_u32 s31, s26, 3072
    buffer_load_dwordx4 v253, s[44:47], s30 offen lds
    buffer_load_dwordx4 v61, s[44:47], s30 offen offset:1024 lds
    buffer_load_dwordx4 v253, s[44:47], s31 offen offset:2048 lds

    s_add_u32 s26, s39, 10
    s_cmp_ge_u32 s26, 12
    s_cselect_b32 s27, 12, 0
    s_sub_u32 s26, s26, s27
    s_mul_i32 s26, s26, 6144

    s_mov_b32 m0, 59392
    s_add_u32 s30, s26, 0
    s_add_u32 s31, s26, 1536
    buffer_load_dwordx4 v253, s[44:47], s30 offen lds
    buffer_load_dwordx4 v61, s[44:47], s30 offen offset:1024 lds
    buffer_load_dwordx4 v253, s[44:47], s31 offen offset:2048 lds
    s_mov_b32 m0, 124936
    s_add_u32 s30, s26, 1536
    s_add_u32 s31, s26, 3072
    buffer_load_dwordx4 v253, s[44:47], s30 offen lds
    buffer_load_dwordx4 v61, s[44:47], s30 offen offset:1024 lds
    buffer_load_dwordx4 v253, s[44:47], s31 offen offset:2048 lds

    s_add_u32 s26, s39, 11
    s_cmp_ge_u32 s26, 12
    s_cselect_b32 s27, 12, 0
    s_sub_u32 s26, s26, s27
    s_mul_i32 s26, s26, 6144

    s_mov_b32 m0, 62464
    s_add_u32 s30, s26, 0
    s_add_u32 s31, s26, 1536
    buffer_load_dwordx4 v253, s[44:47], s30 offen lds
    buffer_load_dwordx4 v61, s[44:47], s30 offen offset:1024 lds
    buffer_load_dwordx4 v253, s[44:47], s31 offen offset:2048 lds
    s_mov_b32 m0, 128008
    s_add_u32 s30, s26, 1536
    s_add_u32 s31, s26, 3072
    buffer_load_dwordx4 v253, s[44:47], s30 offen lds
    buffer_load_dwordx4 v61, s[44:47], s30 offen offset:1024 lds
    buffer_load_dwordx4 v253, s[44:47], s31 offen offset:2048 lds
    v_mov_b32 v254, 161976
    v_mov_b32 v73, 10
    s_waitcnt vmcnt(54)
    ds_write_b32 v254, v73
    v_mov_b32 v74, 11
    s_waitcnt vmcnt(48)
    ds_write_b32 v254, v74
    v_mov_b32 v75, 12
    s_waitcnt vmcnt(42)
    ds_write_b32 v254, v75
    v_mov_b32 v76, 13
    s_waitcnt vmcnt(36)
    ds_write_b32 v254, v76
    v_mov_b32 v77, 14
    s_waitcnt vmcnt(30)
    ds_write_b32 v254, v77
    v_mov_b32 v78, 15
    s_waitcnt vmcnt(24)
    ds_write_b32 v254, v78
    v_mov_b32 v79, 16
    s_waitcnt vmcnt(18)
    ds_write_b32 v254, v79
    v_mov_b32 v80, 17
    s_waitcnt vmcnt(12)
    ds_write_b32 v254, v80
    v_mov_b32 v81, 18
    s_waitcnt vmcnt(6)
    ds_write_b32 v254, v81
    v_mov_b32 v82, 19
    s_waitcnt vmcnt(0)
    ds_write_b32 v254, v82
    s_setprio 0
L_p2:
    s_setprio 0
    v_mov_b32 v254, 161980

    s_mov_b32 s29, 200000
L_wi:
    ds_read_b32 v255, v254
    s_waitcnt lgkmcnt(0)
    v_cmp_eq_u32 vcc, 2, v255
    s_cmp_eq_u64 vcc, exec
    s_cbranch_scc1 L_wi_ok
    s_sleep 2
    s_sub_u32 s29, s29, 1
    s_cmp_lg_u32 s29, 0
    s_cbranch_scc1 L_wi
L_wi_ok:

    v_bfe_u32 v176, v253, 6, 2
    v_and_b32 v177, 48, v253
    v_lshrrev_b32 v252, 9, v253
    v_lshl_add_u32 v176, v252, 3, v176
    v_lshl_add_u32 v254, v176, 6, v177
    v_mul_u32_u24 v176, 192, v176
    v_add_u32 v255, v176, v177
    v_bfe_u32 v176, v253, 8, 1
    v_mul_u32_u24 v177, 65544, v176
    v_add_u32 v254, v254, v177
    v_add_u32 v255, v255, v177
    v_bfe_u32 v176, v253, 7, 1
    v_mul_u32_u24 v176, 196608, v176
    v_bfe_u32 v177, v253, 4, 3
    v_mul_u32_u24 v177, 768, v177
    v_add_u32 v176, v176, v177
    v_lshrrev_b32 v177, 8, v253
    v_lshl_add_u32 v252, v177, 4, v176
    s_mov_b32 s86, 0x00003f80
    s_mov_b32 s87, 0x3f800000
    s_lshl_b32 s26, s16, 2
    s_add_u32 s26, s26, s23
    s_lshl_b32 s26, s26, 9
    s_add_u32 s26, s26, s22
    s_mul_i32 s24, s26, 192
    s_add_u32 s24, s24, 384
    s_add_u32 s25, s24, 98304
    s_mov_b32 s17, 0
    s_mov_b32 s19, 0
    s_setprio 0
    s_cmp_lt_u32 s16, 4
    s_cbranch_scc1 L_mtile
    s_setprio 1
L_mtile:

    v_bfe_u32 v224, v253, 8, 1
    v_mul_u32_u24 v224, 50176, v224
    v_subrev_u32 v224, 131080, v224
    v_sub_u32 v254, v254, v224
    ds_read_b64_tr_b16 v[224:225], v254 offset:0
    ds_read_b64_tr_b16 v[226:227], v254 offset:256
    ds_read_b64_tr_b16 v[228:229], v254 offset:1024
    ds_read_b64_tr_b16 v[230:231], v254 offset:1280
    ds_read_b64_tr_b16 v[232:233], v254 offset:2048
    ds_read_b64_tr_b16 v[234:235], v254 offset:2304
    ds_read_b64_tr_b16 v[236:237], v254 offset:8
    ds_read_b64_tr_b16 v[238:239], v254 offset:264
    ds_read_b64_tr_b16 v[240:241], v254 offset:1032
    ds_read_b64_tr_b16 v[242:243], v254 offset:1288
    s_waitcnt vmcnt(12)
    s_waitcnt lgkmcnt(8)
    v_mfma_f32_16x16x32_bf16 v[176:179], v[224:227], v[0:3], 0
    v_mfma_f32_16x16x32_bf16 v[180:183], v[224:227], v[4:7], 0
    v_mfma_f32_16x16x32_bf16 v[184:187], v[224:227], v[8:11], 0
    v_mfma_f32_16x16x32_bf16 v[188:191], v[224:227], v[12:15], 0
    ds_read_b64_tr_b16 v[224:225], v254 offset:2056
    ds_read_b64_tr_b16 v[226:227], v254 offset:2312
    s_waitcnt lgkmcnt(8)
    v_mfma_f32_16x16x32_bf16 v[176:179], v[228:231], v[16:19], v[176:179]
    v_mfma_f32_16x16x32_bf16 v[180:183], v[228:231], v[20:23], v[180:183]
    v_mfma_f32_16x16x32_bf16 v[184:187], v[228:231], v[24:27], v[184:187]
    v_mfma_f32_16x16x32_bf16 v[188:191], v[228:231], v[28:31], v[188:191]
    ds_read_b64_tr_b16 v[228:229], v254 offset:3072
    ds_read_b64_tr_b16 v[230:231], v254 offset:3328
    s_waitcnt lgkmcnt(8)
    v_mfma_f32_16x16x32_bf16 v[176:179], v[232:235], v[32:35], v[176:179]
    v_mfma_f32_16x16x32_bf16 v[180:183], v[232:235], v[36:39], v[180:183]
    v_mfma_f32_16x16x32_bf16 v[184:187], v[232:235], v[40:43], v[184:187]
    v_mfma_f32_16x16x32_bf16 v[188:191], v[232:235], v[44:47], v[188:191]
    ds_read_b64_tr_b16 v[232:233], v254 offset:4096
    ds_read_b64_tr_b16 v[234:235], v254 offset:4352
    s_waitcnt lgkmcnt(8)
    v_mfma_f32_16x16x32_bf16 v[192:195], v[236:239], v[0:3], 0
    v_mfma_f32_16x16x32_bf16 v[196:199], v[236:239], v[4:7], 0
    v_mfma_f32_16x16x32_bf16 v[200:203], v[236:239], v[8:11], 0
    v_mfma_f32_16x16x32_bf16 v[204:207], v[236:239], v[12:15], 0
    ds_read_b64_tr_b16 v[236:237], v254 offset:5120
    ds_read_b64_tr_b16 v[238:239], v254 offset:5376
    s_waitcnt lgkmcnt(8)
    v_mfma_f32_16x16x32_bf16 v[192:195], v[240:243], v[16:19], v[192:195]
    v_lshlrev_b32_sdwa v176, 1, v176 dst_sel:DWORD dst_unused:UNUSED_PAD src0_sel:DWORD src1_sel:WORD_1
    v_lshlrev_b32_sdwa v177, 1, v177 dst_sel:DWORD dst_unused:UNUSED_PAD src0_sel:DWORD src1_sel:WORD_1
    ds_read_u16_d16 v176, v176
    ds_read_u16_d16_hi v177, v177
    v_lshlrev_b32_sdwa v178, 1, v178 dst_sel:DWORD dst_unused:UNUSED_PAD src0_sel:DWORD src1_sel:WORD_1
    v_mfma_f32_16x16x32_bf16 v[196:199], v[240:243], v[20:23], v[196:199]
    v_lshlrev_b32_sdwa v179, 1, v179 dst_sel:DWORD dst_unused:UNUSED_PAD src0_sel:DWORD src1_sel:WORD_1
    ds_read_u16_d16 v178, v178
    ds_read_u16_d16_hi v179, v179
    v_lshlrev_b32_sdwa v180, 1, v180 dst_sel:DWORD dst_unused:UNUSED_PAD src0_sel:DWORD src1_sel:WORD_1
    v_lshlrev_b32_sdwa v181, 1, v181 dst_sel:DWORD dst_unused:UNUSED_PAD src0_sel:DWORD src1_sel:WORD_1
    ds_read_u16_d16 v180, v180
    ds_read_u16_d16_hi v181, v181
    v_mfma_f32_16x16x32_bf16 v[200:203], v[240:243], v[24:27], v[200:203]
    v_lshlrev_b32_sdwa v182, 1, v182 dst_sel:DWORD dst_unused:UNUSED_PAD src0_sel:DWORD src1_sel:WORD_1
    v_lshlrev_b32_sdwa v183, 1, v183 dst_sel:DWORD dst_unused:UNUSED_PAD src0_sel:DWORD src1_sel:WORD_1
    ds_read_u16_d16 v182, v182
    ds_read_u16_d16_hi v183, v183
    v_mfma_f32_16x16x32_bf16 v[204:207], v[240:243], v[28:31], v[204:207]
    ds_read_b64_tr_b16 v[240:241], v254 offset:3080
    ds_read_b64_tr_b16 v[242:243], v254 offset:3336
    v_lshlrev_b32_sdwa v184, 1, v184 dst_sel:DWORD dst_unused:UNUSED_PAD src0_sel:DWORD src1_sel:WORD_1
    v_lshlrev_b32_sdwa v185, 1, v185 dst_sel:DWORD dst_unused:UNUSED_PAD src0_sel:DWORD src1_sel:WORD_1
    ds_read_u16_d16 v184, v184
    ds_read_u16_d16_hi v185, v185
    v_lshlrev_b32_sdwa v186, 1, v186 dst_sel:DWORD dst_unused:UNUSED_PAD src0_sel:DWORD src1_sel:WORD_1
    s_waitcnt lgkmcnt(14)
    v_mfma_f32_16x16x32_bf16 v[192:195], v[224:227], v[32:35], v[192:195]
    v_lshlrev_b32_sdwa v187, 1, v187 dst_sel:DWORD dst_unused:UNUSED_PAD src0_sel:DWORD src1_sel:WORD_1
    ds_read_u16_d16 v186, v186
    ds_read_u16_d16_hi v187, v187
    v_lshlrev_b32_sdwa v188, 1, v188 dst_sel:DWORD dst_unused:UNUSED_PAD src0_sel:DWORD src1_sel:WORD_1
    v_lshlrev_b32_sdwa v189, 1, v189 dst_sel:DWORD dst_unused:UNUSED_PAD src0_sel:DWORD src1_sel:WORD_1
    ds_read_u16_d16 v188, v188
    ds_read_u16_d16_hi v189, v189
    v_mfma_f32_16x16x32_bf16 v[196:199], v[224:227], v[36:39], v[196:199]
    v_lshlrev_b32_sdwa v190, 1, v190 dst_sel:DWORD dst_unused:UNUSED_PAD src0_sel:DWORD src1_sel:WORD_1
    v_lshlrev_b32_sdwa v191, 1, v191 dst_sel:DWORD dst_unused:UNUSED_PAD src0_sel:DWORD src1_sel:WORD_1
    ds_read_u16_d16 v190, v190
    ds_read_u16_d16_hi v191, v191
    v_mfma_f32_16x16x32_bf16 v[200:203], v[224:227], v[40:43], v[200:203]
    v_mfma_f32_16x16x32_bf16 v[204:207], v[224:227], v[44:47], v[204:207]
    ds_read_b64_tr_b16 v[224:225], v254 offset:4104
    ds_read_b64_tr_b16 v[226:227], v254 offset:4360
    v_mfma_f32_16x16x32_bf16 v[208:211], v[228:231], v[0:3], 0
    v_mfma_f32_16x16x32_bf16 v[212:215], v[228:231], v[4:7], 0
    v_mfma_f32_16x16x32_bf16 v[216:219], v[228:231], v[8:11], 0
    v_mfma_f32_16x16x32_bf16 v[220:223], v[228:231], v[12:15], 0
    ds_read_b64_tr_b16 v[228:229], v254 offset:5128
    ds_read_b64_tr_b16 v[230:231], v254 offset:5384
    v_mfma_f32_16x16x32_bf16 v[208:211], v[232:235], v[16:19], v[208:211]
    s_waitcnt lgkmcnt(14)
    v_or_b32 v144, v176, v177
    v_lshlrev_b32_sdwa v192, 1, v192 dst_sel:DWORD dst_unused:UNUSED_PAD src0_sel:DWORD src1_sel:WORD_1
    v_lshlrev_b32_sdwa v193, 1, v193 dst_sel:DWORD dst_unused:UNUSED_PAD src0_sel:DWORD src1_sel:WORD_1
    ds_read_u16_d16 v192, v192
    ds_read_u16_d16_hi v193, v193
    v_or_b32 v145, v178, v179
    v_mfma_f32_16x16x32_bf16 v[212:215], v[232:235], v[20:23], v[212:215]
    v_lshlrev_b32_sdwa v194, 1, v194 dst_sel:DWORD dst_unused:UNUSED_PAD src0_sel:DWORD src1_sel:WORD_1
    v_lshlrev_b32_sdwa v195, 1, v195 dst_sel:DWORD dst_unused:UNUSED_PAD src0_sel:DWORD src1_sel:WORD_1
    ds_read_u16_d16 v194, v194
    ds_read_u16_d16_hi v195, v195
    v_or_b32 v148, v180, v181
    v_lshlrev_b32_sdwa v196, 1, v196 dst_sel:DWORD dst_unused:UNUSED_PAD src0_sel:DWORD src1_sel:WORD_1
    v_mfma_f32_16x16x32_bf16 v[216:219], v[232:235], v[24:27], v[216:219]
    v_lshlrev_b32_sdwa v197, 1, v197 dst_sel:DWORD dst_unused:UNUSED_PAD src0_sel:DWORD src1_sel:WORD_1
    ds_read_u16_d16 v196, v196
    ds_read_u16_d16_hi v197, v197
    v_or_b32 v149, v182, v183
    v_lshlrev_b32_sdwa v198, 1, v198 dst_sel:DWORD dst_unused:UNUSED_PAD src0_sel:DWORD src1_sel:WORD_1
    v_lshlrev_b32_sdwa v199, 1, v199 dst_sel:DWORD dst_unused:UNUSED_PAD src0_sel:DWORD src1_sel:WORD_1
    ds_read_u16_d16 v198, v198
    ds_read_u16_d16_hi v199, v199
    v_mfma_f32_16x16x32_bf16 v[220:223], v[232:235], v[28:31], v[220:223]
    ds_read_b64_tr_b16 v[232:233], v254 offset:6144
    ds_read_b64_tr_b16 v[234:235], v254 offset:6400
    s_waitcnt lgkmcnt(14)
    v_or_b32 v152, v184, v185
    v_lshlrev_b32_sdwa v200, 1, v200 dst_sel:DWORD dst_unused:UNUSED_PAD src0_sel:DWORD src1_sel:WORD_1
    v_lshlrev_b32_sdwa v201, 1, v201 dst_sel:DWORD dst_unused:UNUSED_PAD src0_sel:DWORD src1_sel:WORD_1
    ds_read_u16_d16 v200, v200
    ds_read_u16_d16_hi v201, v201
    v_or_b32 v153, v186, v187
    v_mfma_f32_16x16x32_bf16 v[208:211], v[236:239], v[32:35], v[208:211]
    v_lshlrev_b32_sdwa v202, 1, v202 dst_sel:DWORD dst_unused:UNUSED_PAD src0_sel:DWORD src1_sel:WORD_1
    v_lshlrev_b32_sdwa v203, 1, v203 dst_sel:DWORD dst_unused:UNUSED_PAD src0_sel:DWORD src1_sel:WORD_1
    ds_read_u16_d16 v202, v202
    ds_read_u16_d16_hi v203, v203
    v_or_b32 v156, v188, v189
    v_lshlrev_b32_sdwa v204, 1, v204 dst_sel:DWORD dst_unused:UNUSED_PAD src0_sel:DWORD src1_sel:WORD_1
    v_mfma_f32_16x16x32_bf16 v[212:215], v[236:239], v[36:39], v[212:215]
    v_lshlrev_b32_sdwa v205, 1, v205 dst_sel:DWORD dst_unused:UNUSED_PAD src0_sel:DWORD src1_sel:WORD_1
    ds_read_u16_d16 v204, v204
    ds_read_u16_d16_hi v205, v205
    v_or_b32 v157, v190, v191
    v_lshlrev_b32_sdwa v206, 1, v206 dst_sel:DWORD dst_unused:UNUSED_PAD src0_sel:DWORD src1_sel:WORD_1
    v_lshlrev_b32_sdwa v207, 1, v207 dst_sel:DWORD dst_unused:UNUSED_PAD src0_sel:DWORD src1_sel:WORD_1
    ds_read_u16_d16 v206, v206
    ds_read_u16_d16_hi v207, v207
    v_mfma_f32_16x16x32_bf16 v[216:219], v[236:239], v[40:43], v[216:219]
    v_mfma_f32_16x16x32_bf16 v[220:223], v[236:239], v[44:47], v[220:223]
    v_bfe_u32 v236, v253, 8, 1
    v_mul_u32_u24 v236, 50176, v236
    v_subrev_u32 v236, 131080, v236
    v_sub_u32 v255, v255, v236
    ds_read_b64_tr_b16 v[236:237], v255 offset:9216
    ds_read_b64_tr_b16 v[238:239], v255 offset:9984
    v_mfma_f32_16x16x32_bf16 v[176:179], v[240:243], v[0:3], 0
    v_mfma_f32_16x16x32_bf16 v[180:183], v[240:243], v[4:7], 0
    v_mfma_f32_16x16x32_bf16 v[184:187], v[240:243], v[8:11], 0
    v_mfma_f32_16x16x32_bf16 v[188:191], v[240:243], v[12:15], 0
    ds_read_b64_tr_b16 v[240:241], v254 offset:7168
    ds_read_b64_tr_b16 v[242:243], v254 offset:7424
    s_waitcnt lgkmcnt(14)
    v_mfma_f32_16x16x32_bf16 v[176:179], v[224:227], v[16:19], v[176:179]
    v_or_b32 v146, v192, v193
    v_lshlrev_b32_sdwa v208, 1, v208 dst_sel:DWORD dst_unused:UNUSED_PAD src0_sel:DWORD src1_sel:WORD_1
    v_lshlrev_b32_sdwa v209, 1, v209 dst_sel:DWORD dst_unused:UNUSED_PAD src0_sel:DWORD src1_sel:WORD_1
    ds_read_u16_d16 v208, v208
    ds_read_u16_d16_hi v209, v209
    v_or_b32 v147, v194, v195
    v_mfma_f32_16x16x32_bf16 v[180:183], v[224:227], v[20:23], v[180:183]
    v_lshlrev_b32_sdwa v210, 1, v210 dst_sel:DWORD dst_unused:UNUSED_PAD src0_sel:DWORD src1_sel:WORD_1
    v_lshlrev_b32_sdwa v211, 1, v211 dst_sel:DWORD dst_unused:UNUSED_PAD src0_sel:DWORD src1_sel:WORD_1
    ds_read_u16_d16 v210, v210
    ds_read_u16_d16_hi v211, v211
    v_or_b32 v150, v196, v197
    v_lshlrev_b32_sdwa v212, 1, v212 dst_sel:DWORD dst_unused:UNUSED_PAD src0_sel:DWORD src1_sel:WORD_1
    v_mfma_f32_16x16x32_bf16 v[184:187], v[224:227], v[24:27], v[184:187]
    v_lshlrev_b32_sdwa v213, 1, v213 dst_sel:DWORD dst_unused:UNUSED_PAD src0_sel:DWORD src1_sel:WORD_1
    ds_read_u16_d16 v212, v212
    ds_read_u16_d16_hi v213, v213
    v_or_b32 v151, v198, v199
    v_lshlrev_b32_sdwa v214, 1, v214 dst_sel:DWORD dst_unused:UNUSED_PAD src0_sel:DWORD src1_sel:WORD_1
    v_lshlrev_b32_sdwa v215, 1, v215 dst_sel:DWORD dst_unused:UNUSED_PAD src0_sel:DWORD src1_sel:WORD_1
    ds_read_u16_d16 v214, v214
    ds_read_u16_d16_hi v215, v215
    v_mfma_f32_16x16x32_bf16 v[188:191], v[224:227], v[28:31], v[188:191]
    ds_read_b64_tr_b16 v[224:225], v255 offset:9224
    ds_read_b64_tr_b16 v[226:227], v255 offset:9992
    s_waitcnt lgkmcnt(14)
    v_or_b32 v154, v200, v201
    v_lshlrev_b32_sdwa v216, 1, v216 dst_sel:DWORD dst_unused:UNUSED_PAD src0_sel:DWORD src1_sel:WORD_1
    v_lshlrev_b32_sdwa v217, 1, v217 dst_sel:DWORD dst_unused:UNUSED_PAD src0_sel:DWORD src1_sel:WORD_1
    ds_read_u16_d16 v216, v216
    ds_read_u16_d16_hi v217, v217
    v_or_b32 v155, v202, v203
    v_mfma_f32_16x16x32_bf16 v[176:179], v[228:231], v[32:35], v[176:179]
    v_lshlrev_b32_sdwa v218, 1, v218 dst_sel:DWORD dst_unused:UNUSED_PAD src0_sel:DWORD src1_sel:WORD_1
    v_lshlrev_b32_sdwa v219, 1, v219 dst_sel:DWORD dst_unused:UNUSED_PAD src0_sel:DWORD src1_sel:WORD_1
    ds_read_u16_d16 v218, v218
    ds_read_u16_d16_hi v219, v219
    v_or_b32 v158, v204, v205
    v_lshlrev_b32_sdwa v220, 1, v220 dst_sel:DWORD dst_unused:UNUSED_PAD src0_sel:DWORD src1_sel:WORD_1
    v_mfma_f32_16x16x32_bf16 v[180:183], v[228:231], v[36:39], v[180:183]
    v_lshlrev_b32_sdwa v221, 1, v221 dst_sel:DWORD dst_unused:UNUSED_PAD src0_sel:DWORD src1_sel:WORD_1
    ds_read_u16_d16 v220, v220
    ds_read_u16_d16_hi v221, v221
    v_or_b32 v159, v206, v207
    v_lshlrev_b32_sdwa v222, 1, v222 dst_sel:DWORD dst_unused:UNUSED_PAD src0_sel:DWORD src1_sel:WORD_1
    v_lshlrev_b32_sdwa v223, 1, v223 dst_sel:DWORD dst_unused:UNUSED_PAD src0_sel:DWORD src1_sel:WORD_1
    ds_read_u16_d16 v222, v222
    ds_read_u16_d16_hi v223, v223
    v_mfma_f32_16x16x32_bf16 v[184:187], v[228:231], v[40:43], v[184:187]
    v_mfma_f32_16x16x32_bf16 v[188:191], v[228:231], v[44:47], v[188:191]
    ds_read_b64_tr_b16 v[228:229], v254 offset:8192
    ds_read_b64_tr_b16 v[230:231], v254 offset:8448
    v_mfma_f32_16x16x32_bf16 v[192:195], v[232:235], v[0:3], 0
    v_mfma_f32_16x16x32_bf16 v[196:199], v[232:235], v[4:7], 0
    v_mfma_f32_16x16x32_bf16 v[200:203], v[232:235], v[8:11], 0
    v_mfma_f32_16x16x32_bf16 v[204:207], v[232:235], v[12:15], 0
    ds_read_b64_tr_b16 v[232:233], v255 offset:9280
    ds_read_b64_tr_b16 v[234:235], v255 offset:10048
    s_waitcnt lgkmcnt(14)
    v_mfma_f32_16x16x32_bf16 v[48:51], v[236:239], v[144:147], 0
    v_or_b32 v160, v208, v209
    v_lshlrev_b32_sdwa v176, 1, v176 dst_sel:DWORD dst_unused:UNUSED_PAD src0_sel:DWORD src1_sel:WORD_1
    v_mfma_f32_16x16x32_bf16 v[72:75], v[236:239], v[148:151], 0
    v_lshlrev_b32_sdwa v177, 1, v177 dst_sel:DWORD dst_unused:UNUSED_PAD src0_sel:DWORD src1_sel:WORD_1
    ds_read_u16_d16 v176, v176
    ds_read_u16_d16_hi v177, v177
    v_mfma_f32_16x16x32_bf16 v[96:99], v[236:239], v[152:155], 0
    v_or_b32 v161, v210, v211
    v_mfma_f32_16x16x32_bf16 v[120:123], v[236:239], v[156:159], 0
    ds_read_b64_tr_b16 v[236:237], v254 offset:6152
    ds_read_b64_tr_b16 v[238:239], v254 offset:6408
    v_lshlrev_b32_sdwa v178, 1, v178 dst_sel:DWORD dst_unused:UNUSED_PAD src0_sel:DWORD src1_sel:WORD_1
    v_lshlrev_b32_sdwa v179, 1, v179 dst_sel:DWORD dst_unused:UNUSED_PAD src0_sel:DWORD src1_sel:WORD_1
    ds_read_u16_d16 v178, v178
    ds_read_u16_d16_hi v179, v179
    v_mfma_f32_16x16x32_bf16 v[192:195], v[240:243], v[16:19], v[192:195]
    v_or_b32 v164, v212, v213
    v_mfma_f32_16x16x32_bf16 v[196:199], v[240:243], v[20:23], v[196:199]
    v_lshlrev_b32_sdwa v180, 1, v180 dst_sel:DWORD dst_unused:UNUSED_PAD src0_sel:DWORD src1_sel:WORD_1
    v_mfma_f32_16x16x32_bf16 v[200:203], v[240:243], v[24:27], v[200:203]
    v_lshlrev_b32_sdwa v181, 1, v181 dst_sel:DWORD dst_unused:UNUSED_PAD src0_sel:DWORD src1_sel:WORD_1
    ds_read_u16_d16 v180, v180
    ds_read_u16_d16_hi v181, v181
    v_or_b32 v165, v214, v215
    v_mfma_f32_16x16x32_bf16 v[204:207], v[240:243], v[28:31], v[204:207]
    ds_read_b64_tr_b16 v[240:241], v255 offset:9288
    ds_read_b64_tr_b16 v[242:243], v255 offset:10056
    v_lshlrev_b32_sdwa v182, 1, v182 dst_sel:DWORD dst_unused:UNUSED_PAD src0_sel:DWORD src1_sel:WORD_1
    s_waitcnt lgkmcnt(14)
    v_mfma_f32_16x16x32_bf16 v[52:55], v[224:227], v[144:147], 0
    v_lshlrev_b32_sdwa v183, 1, v183 dst_sel:DWORD dst_unused:UNUSED_PAD src0_sel:DWORD src1_sel:WORD_1
    ds_read_u16_d16 v182, v182
    ds_read_u16_d16_hi v183, v183
    v_mfma_f32_16x16x32_bf16 v[76:79], v[224:227], v[148:151], 0
    v_or_b32 v168, v216, v217
    v_lshlrev_b32_sdwa v184, 1, v184 dst_sel:DWORD dst_unused:UNUSED_PAD src0_sel:DWORD src1_sel:WORD_1
    v_mfma_f32_16x16x32_bf16 v[100:103], v[224:227], v[152:155], 0
    v_lshlrev_b32_sdwa v185, 1, v185 dst_sel:DWORD dst_unused:UNUSED_PAD src0_sel:DWORD src1_sel:WORD_1
    ds_read_u16_d16 v184, v184
    ds_read_u16_d16_hi v185, v185
    v_mfma_f32_16x16x32_bf16 v[124:127], v[224:227], v[156:159], 0
    ds_read_b64_tr_b16 v[224:225], v254 offset:7176
    ds_read_b64_tr_b16 v[226:227], v254 offset:7432
    v_or_b32 v169, v218, v219
    s_waitcnt lgkmcnt(14)
    v_mfma_f32_16x16x32_bf16 v[192:195], v[228:231], v[32:35], v[192:195]
    v_lshlrev_b32_sdwa v186, 1, v186 dst_sel:DWORD dst_unused:UNUSED_PAD src0_sel:DWORD src1_sel:WORD_1
    v_lshlrev_b32_sdwa v187, 1, v187 dst_sel:DWORD dst_unused:UNUSED_PAD src0_sel:DWORD src1_sel:WORD_1
    ds_read_u16_d16 v186, v186
    ds_read_u16_d16_hi v187, v187
    v_mfma_f32_16x16x32_bf16 v[196:199], v[228:231], v[36:39], v[196:199]
    v_or_b32 v172, v220, v221
    v_mfma_f32_16x16x32_bf16 v[200:203], v[228:231], v[40:43], v[200:203]
    v_lshlrev_b32_sdwa v188, 1, v188 dst_sel:DWORD dst_unused:UNUSED_PAD src0_sel:DWORD src1_sel:WORD_1
    v_mfma_f32_16x16x32_bf16 v[204:207], v[228:231], v[44:47], v[204:207]
    ds_read_b64_tr_b16 v[228:229], v255 offset:9344
    ds_read_b64_tr_b16 v[230:231], v255 offset:10112
    v_lshlrev_b32_sdwa v189, 1, v189 dst_sel:DWORD dst_unused:UNUSED_PAD src0_sel:DWORD src1_sel:WORD_1
    ds_read_u16_d16 v188, v188
    ds_read_u16_d16_hi v189, v189
    v_or_b32 v173, v222, v223
    v_mfma_f32_16x16x32_bf16 v[56:59], v[232:235], v[144:147], 0
    v_lshlrev_b32_sdwa v190, 1, v190 dst_sel:DWORD dst_unused:UNUSED_PAD src0_sel:DWORD src1_sel:WORD_1
    v_mfma_f32_16x16x32_bf16 v[80:83], v[232:235], v[148:151], 0
    v_lshlrev_b32_sdwa v191, 1, v191 dst_sel:DWORD dst_unused:UNUSED_PAD src0_sel:DWORD src1_sel:WORD_1
    ds_read_u16_d16 v190, v190
    ds_read_u16_d16_hi v191, v191
    v_mfma_f32_16x16x32_bf16 v[104:107], v[232:235], v[152:155], 0
    v_mfma_f32_16x16x32_bf16 v[128:131], v[232:235], v[156:159], 0
    ds_read_b64_tr_b16 v[232:233], v254 offset:8200
    ds_read_b64_tr_b16 v[234:235], v254 offset:8456
    s_waitcnt lgkmcnt(14)
    v_mfma_f32_16x16x32_bf16 v[208:211], v[236:239], v[0:3], 0
    v_or_b32 v162, v176, v177
    v_lshlrev_b32_sdwa v192, 1, v192 dst_sel:DWORD dst_unused:UNUSED_PAD src0_sel:DWORD src1_sel:WORD_1
    v_mfma_f32_16x16x32_bf16 v[212:215], v[236:239], v[4:7], 0
    v_lshlrev_b32_sdwa v193, 1, v193 dst_sel:DWORD dst_unused:UNUSED_PAD src0_sel:DWORD src1_sel:WORD_1
    ds_read_u16_d16 v192, v192
    ds_read_u16_d16_hi v193, v193
    v_mfma_f32_16x16x32_bf16 v[216:219], v[236:239], v[8:11], 0
    v_or_b32 v163, v178, v179
    v_mfma_f32_16x16x32_bf16 v[220:223], v[236:239], v[12:15], 0
    ds_read_b64_tr_b16 v[236:237], v255 offset:9352
    ds_read_b64_tr_b16 v[238:239], v255 offset:10120
    v_lshlrev_b32_sdwa v194, 1, v194 dst_sel:DWORD dst_unused:UNUSED_PAD src0_sel:DWORD src1_sel:WORD_1
    v_mfma_f32_16x16x32_bf16 v[60:63], v[240:243], v[144:147], 0
    v_lshlrev_b32_sdwa v195, 1, v195 dst_sel:DWORD dst_unused:UNUSED_PAD src0_sel:DWORD src1_sel:WORD_1
    ds_read_u16_d16 v194, v194
    ds_read_u16_d16_hi v195, v195
    v_mfma_f32_16x16x32_bf16 v[84:87], v[240:243], v[148:151], 0
    v_or_b32 v166, v180, v181
    v_mfma_f32_16x16x32_bf16 v[108:111], v[240:243], v[152:155], 0
    v_lshlrev_b32_sdwa v196, 1, v196 dst_sel:DWORD dst_unused:UNUSED_PAD src0_sel:DWORD src1_sel:WORD_1
    v_mfma_f32_16x16x32_bf16 v[132:135], v[240:243], v[156:159], 0
    ds_read_b64_tr_b16 v[240:241], v254 offset:12288
    ds_read_b64_tr_b16 v[242:243], v254 offset:12544
    v_lshlrev_b32_sdwa v197, 1, v197 dst_sel:DWORD dst_unused:UNUSED_PAD src0_sel:DWORD src1_sel:WORD_1
    ds_read_u16_d16 v196, v196
    ds_read_u16_d16_hi v197, v197
    s_waitcnt lgkmcnt(14)
    v_mfma_f32_16x16x32_bf16 v[208:211], v[224:227], v[16:19], v[208:211]
    v_or_b32 v167, v182, v183
    v_mfma_f32_16x16x32_bf16 v[212:215], v[224:227], v[20:23], v[212:215]
    v_lshlrev_b32_sdwa v198, 1, v198 dst_sel:DWORD dst_unused:UNUSED_PAD src0_sel:DWORD src1_sel:WORD_1
    v_mfma_f32_16x16x32_bf16 v[216:219], v[224:227], v[24:27], v[216:219]
    v_lshlrev_b32_sdwa v199, 1, v199 dst_sel:DWORD dst_unused:UNUSED_PAD src0_sel:DWORD src1_sel:WORD_1
    ds_read_u16_d16 v198, v198
    ds_read_u16_d16_hi v199, v199
    v_mfma_f32_16x16x32_bf16 v[220:223], v[224:227], v[28:31], v[220:223]
    v_bfe_u32 v224, v253, 8, 1
    v_mul_u32_u24 v224, 50176, v224
    v_subrev_u32 v224, 131080, v224
    v_add_u32 v255, v255, v224

    s_cmp_ge_u32 s19, 1
    s_cbranch_scc1 L_rd1_go
    v_mov_b32 v224, 161976

    s_mov_b32 s29, 200000
L_rd1:
    ds_read_b32 v225, v224
    s_waitcnt lgkmcnt(0)
    v_cmp_le_u32 vcc, 1, v225
    s_cmp_eq_u64 vcc, exec
    s_cbranch_scc1 L_rd1_ok
    s_sleep 2
    s_sub_u32 s29, s29, 1
    s_cmp_lg_u32 s29, 0
    s_cbranch_scc1 L_rd1
L_rd1_ok:

    v_readfirstlane_b32 s19, v225
L_rd1_go:

    ds_read_b64_tr_b16 v[224:225], v255 offset:7168
    ds_read_b64_tr_b16 v[226:227], v255 offset:7936
    v_or_b32 v170, v184, v185
    v_lshlrev_b32_sdwa v200, 1, v200 dst_sel:DWORD dst_unused:UNUSED_PAD src0_sel:DWORD src1_sel:WORD_1
    v_mfma_f32_16x16x32_bf16 v[64:67], v[228:231], v[144:147], 0
    v_lshlrev_b32_sdwa v201, 1, v201 dst_sel:DWORD dst_unused:UNUSED_PAD src0_sel:DWORD src1_sel:WORD_1
    ds_read_u16_d16 v200, v200
    ds_read_u16_d16_hi v201, v201
    v_mfma_f32_16x16x32_bf16 v[88:91], v[228:231], v[148:151], 0
    v_or_b32 v171, v186, v187
    v_mfma_f32_16x16x32_bf16 v[112:115], v[228:231], v[152:155], 0
    v_lshlrev_b32_sdwa v202, 1, v202 dst_sel:DWORD dst_unused:UNUSED_PAD src0_sel:DWORD src1_sel:WORD_1
    v_mfma_f32_16x16x32_bf16 v[136:139], v[228:231], v[156:159], 0
    ds_read_b64_tr_b16 v[228:229], v254 offset:13312
    ds_read_b64_tr_b16 v[230:231], v254 offset:13568
    v_lshlrev_b32_sdwa v203, 1, v203 dst_sel:DWORD dst_unused:UNUSED_PAD src0_sel:DWORD src1_sel:WORD_1
    ds_read_u16_d16 v202, v202
    ds_read_u16_d16_hi v203, v203
    s_waitcnt lgkmcnt(14)
    v_mfma_f32_16x16x32_bf16 v[208:211], v[232:235], v[32:35], v[208:211]
    v_or_b32 v174, v188, v189
    v_mfma_f32_16x16x32_bf16 v[212:215], v[232:235], v[36:39], v[212:215]
    v_lshlrev_b32_sdwa v204, 1, v204 dst_sel:DWORD dst_unused:UNUSED_PAD src0_sel:DWORD src1_sel:WORD_1
    v_mfma_f32_16x16x32_bf16 v[216:219], v[232:235], v[40:43], v[216:219]
    v_lshlrev_b32_sdwa v205, 1, v205 dst_sel:DWORD dst_unused:UNUSED_PAD src0_sel:DWORD src1_sel:WORD_1
    ds_read_u16_d16 v204, v204
    ds_read_u16_d16_hi v205, v205
    v_mfma_f32_16x16x32_bf16 v[220:223], v[232:235], v[44:47], v[220:223]
    ds_read_b64_tr_b16 v[232:233], v255 offset:7176
    ds_read_b64_tr_b16 v[234:235], v255 offset:7944
    v_or_b32 v175, v190, v191
    v_mfma_f32_16x16x32_bf16 v[68:71], v[236:239], v[144:147], 0
    v_lshlrev_b32_sdwa v206, 1, v206 dst_sel:DWORD dst_unused:UNUSED_PAD src0_sel:DWORD src1_sel:WORD_1
    v_mfma_f32_16x16x32_bf16 v[92:95], v[236:239], v[148:151], 0
    v_lshlrev_b32_sdwa v207, 1, v207 dst_sel:DWORD dst_unused:UNUSED_PAD src0_sel:DWORD src1_sel:WORD_1
    ds_read_u16_d16 v206, v206
    ds_read_u16_d16_hi v207, v207
    v_mfma_f32_16x16x32_bf16 v[116:119], v[236:239], v[152:155], 0
    v_mfma_f32_16x16x32_bf16 v[140:143], v[236:239], v[156:159], 0
    ds_read_b64_tr_b16 v[236:237], v254 offset:14336
    ds_read_b64_tr_b16 v[238:239], v254 offset:14592
    s_waitcnt lgkmcnt(14)
    v_mfma_f32_16x16x32_bf16 v[176:179], v[240:243], v[0:3], 0
    v_or_b32 v144, v192, v193
    v_lshlrev_b32_sdwa v208, 1, v208 dst_sel:DWORD dst_unused:UNUSED_PAD src0_sel:DWORD src1_sel:WORD_1
    v_mfma_f32_16x16x32_bf16 v[180:183], v[240:243], v[4:7], 0
    v_lshlrev_b32_sdwa v209, 1, v209 dst_sel:DWORD dst_unused:UNUSED_PAD src0_sel:DWORD src1_sel:WORD_1
    ds_read_u16_d16 v208, v208
    ds_read_u16_d16_hi v209, v209
    v_mfma_f32_16x16x32_bf16 v[184:187], v[240:243], v[8:11], 0
    v_or_b32 v145, v194, v195
    v_mfma_f32_16x16x32_bf16 v[188:191], v[240:243], v[12:15], 0
    ds_read_b64_tr_b16 v[240:241], v255 offset:7232
    ds_read_b64_tr_b16 v[242:243], v255 offset:8000
    v_lshlrev_b32_sdwa v210, 1, v210 dst_sel:DWORD dst_unused:UNUSED_PAD src0_sel:DWORD src1_sel:WORD_1
    v_mfma_f32_16x16x32_bf16 v[48:51], v[224:227], v[160:163], v[48:51]
    v_lshlrev_b32_sdwa v211, 1, v211 dst_sel:DWORD dst_unused:UNUSED_PAD src0_sel:DWORD src1_sel:WORD_1
    ds_read_u16_d16 v210, v210
    ds_read_u16_d16_hi v211, v211
    v_mfma_f32_16x16x32_bf16 v[72:75], v[224:227], v[164:167], v[72:75]
    v_or_b32 v148, v196, v197
    v_mfma_f32_16x16x32_bf16 v[96:99], v[224:227], v[168:171], v[96:99]
    v_lshlrev_b32_sdwa v212, 1, v212 dst_sel:DWORD dst_unused:UNUSED_PAD src0_sel:DWORD src1_sel:WORD_1
    v_mfma_f32_16x16x32_bf16 v[120:123], v[224:227], v[172:175], v[120:123]
    ds_read_b64_tr_b16 v[224:225], v254 offset:12296
    ds_read_b64_tr_b16 v[226:227], v254 offset:12552
    v_lshlrev_b32_sdwa v213, 1, v213 dst_sel:DWORD dst_unused:UNUSED_PAD src0_sel:DWORD src1_sel:WORD_1
    ds_read_u16_d16 v212, v212
    ds_read_u16_d16_hi v213, v213
    s_waitcnt lgkmcnt(14)
    v_mfma_f32_16x16x32_bf16 v[176:179], v[228:231], v[16:19], v[176:179]
    v_or_b32 v149, v198, v199
    v_mfma_f32_16x16x32_bf16 v[180:183], v[228:231], v[20:23], v[180:183]
    v_lshlrev_b32_sdwa v214, 1, v214 dst_sel:DWORD dst_unused:UNUSED_PAD src0_sel:DWORD src1_sel:WORD_1
    v_mfma_f32_16x16x32_bf16 v[184:187], v[228:231], v[24:27], v[184:187]
    v_lshlrev_b32_sdwa v215, 1, v215 dst_sel:DWORD dst_unused:UNUSED_PAD src0_sel:DWORD src1_sel:WORD_1
    ds_read_u16_d16 v214, v214
    ds_read_u16_d16_hi v215, v215
    v_mfma_f32_16x16x32_bf16 v[188:191], v[228:231], v[28:31], v[188:191]
    ds_read_b64_tr_b16 v[228:229], v255 offset:7240
    ds_read_b64_tr_b16 v[230:231], v255 offset:8008
    v_or_b32 v152, v200, v201
    v_lshlrev_b32_sdwa v216, 1, v216 dst_sel:DWORD dst_unused:UNUSED_PAD src0_sel:DWORD src1_sel:WORD_1
    v_mfma_f32_16x16x32_bf16 v[52:55], v[232:235], v[160:163], v[52:55]
    v_lshlrev_b32_sdwa v217, 1, v217 dst_sel:DWORD dst_unused:UNUSED_PAD src0_sel:DWORD src1_sel:WORD_1
    ds_read_u16_d16 v216, v216
    ds_read_u16_d16_hi v217, v217
    v_mfma_f32_16x16x32_bf16 v[76:79], v[232:235], v[164:167], v[76:79]
    v_or_b32 v153, v202, v203
    v_mfma_f32_16x16x32_bf16 v[100:103], v[232:235], v[168:171], v[100:103]
    v_lshlrev_b32_sdwa v218, 1, v218 dst_sel:DWORD dst_unused:UNUSED_PAD src0_sel:DWORD src1_sel:WORD_1
    v_mfma_f32_16x16x32_bf16 v[124:127], v[232:235], v[172:175], v[124:127]
    ds_read_b64_tr_b16 v[232:233], v254 offset:13320
    ds_read_b64_tr_b16 v[234:235], v254 offset:13576
    v_lshlrev_b32_sdwa v219, 1, v219 dst_sel:DWORD dst_unused:UNUSED_PAD src0_sel:DWORD src1_sel:WORD_1
    ds_read_u16_d16 v218, v218
    ds_read_u16_d16_hi v219, v219
    s_waitcnt lgkmcnt(14)
    v_mfma_f32_16x16x32_bf16 v[176:179], v[236:239], v[32:35], v[176:179]
    v_or_b32 v156, v204, v205
    v_mfma_f32_16x16x32_bf16 v[180:183], v[236:239], v[36:39], v[180:183]
    v_lshlrev_b32_sdwa v220, 1, v220 dst_sel:DWORD dst_unused:UNUSED_PAD src0_sel:DWORD src1_sel:WORD_1
    v_mfma_f32_16x16x32_bf16 v[184:187], v[236:239], v[40:43], v[184:187]
    v_lshlrev_b32_sdwa v221, 1, v221 dst_sel:DWORD dst_unused:UNUSED_PAD src0_sel:DWORD src1_sel:WORD_1
    ds_read_u16_d16 v220, v220
    ds_read_u16_d16_hi v221, v221
    v_mfma_f32_16x16x32_bf16 v[188:191], v[236:239], v[44:47], v[188:191]
    ds_read_b64_tr_b16 v[236:237], v255 offset:7296
    ds_read_b64_tr_b16 v[238:239], v255 offset:8064
    v_or_b32 v157, v206, v207
    v_mfma_f32_16x16x32_bf16 v[56:59], v[240:243], v[160:163], v[56:59]
    v_lshlrev_b32_sdwa v222, 1, v222 dst_sel:DWORD dst_unused:UNUSED_PAD src0_sel:DWORD src1_sel:WORD_1
    v_mfma_f32_16x16x32_bf16 v[80:83], v[240:243], v[164:167], v[80:83]
    v_lshlrev_b32_sdwa v223, 1, v223 dst_sel:DWORD dst_unused:UNUSED_PAD src0_sel:DWORD src1_sel:WORD_1
    ds_read_u16_d16 v222, v222
    ds_read_u16_d16_hi v223, v223
    v_mfma_f32_16x16x32_bf16 v[104:107], v[240:243], v[168:171], v[104:107]
    v_mfma_f32_16x16x32_bf16 v[128:131], v[240:243], v[172:175], v[128:131]
    ds_read_b64_tr_b16 v[240:241], v254 offset:14344
    ds_read_b64_tr_b16 v[242:243], v254 offset:14600
    s_waitcnt lgkmcnt(14)
    v_mfma_f32_16x16x32_bf16 v[192:195], v[224:227], v[0:3], 0
    v_or_b32 v146, v208, v209
    v_lshlrev_b32_sdwa v176, 1, v176 dst_sel:DWORD dst_unused:UNUSED_PAD src0_sel:DWORD src1_sel:WORD_1
    v_mfma_f32_16x16x32_bf16 v[196:199], v[224:227], v[4:7], 0
    v_lshlrev_b32_sdwa v177, 1, v177 dst_sel:DWORD dst_unused:UNUSED_PAD src0_sel:DWORD src1_sel:WORD_1
    ds_read_u16_d16 v176, v176
    ds_read_u16_d16_hi v177, v177
    v_mfma_f32_16x16x32_bf16 v[200:203], v[224:227], v[8:11], 0
    v_or_b32 v147, v210, v211
    v_mfma_f32_16x16x32_bf16 v[204:207], v[224:227], v[12:15], 0
    ds_read_b64_tr_b16 v[224:225], v255 offset:7304
    ds_read_b64_tr_b16 v[226:227], v255 offset:8072
    v_lshlrev_b32_sdwa v178, 1, v178 dst_sel:DWORD dst_unused:UNUSED_PAD src0_sel:DWORD src1_sel:WORD_1
    v_mfma_f32_16x16x32_bf16 v[60:63], v[228:231], v[160:163], v[60:63]
    v_lshlrev_b32_sdwa v179, 1, v179 dst_sel:DWORD dst_unused:UNUSED_PAD src0_sel:DWORD src1_sel:WORD_1
    ds_read_u16_d16 v178, v178
    ds_read_u16_d16_hi v179, v179
    v_mfma_f32_16x16x32_bf16 v[84:87], v[228:231], v[164:167], v[84:87]
    v_or_b32 v150, v212, v213
    v_mfma_f32_16x16x32_bf16 v[108:111], v[228:231], v[168:171], v[108:111]
    v_lshlrev_b32_sdwa v180, 1, v180 dst_sel:DWORD dst_unused:UNUSED_PAD src0_sel:DWORD src1_sel:WORD_1
    v_mfma_f32_16x16x32_bf16 v[132:135], v[228:231], v[172:175], v[132:135]
    v_bfe_u32 v228, v253, 8, 1
    v_mul_u32_u24 v228, 50176, v228
    v_subrev_u32 v228, 131080, v228
    v_add_u32 v254, v254, v228

    s_cmp_ge_u32 s19, 2
    s_cbranch_scc1 L_rd2_go
    v_mov_b32 v228, 161976

    s_mov_b32 s29, 200000
L_rd2:
    ds_read_b32 v229, v228
    s_waitcnt lgkmcnt(0)
    v_cmp_le_u32 vcc, 2, v229
    s_cmp_eq_u64 vcc, exec
    s_cbranch_scc1 L_rd2_ok
    s_sleep 2
    s_sub_u32 s29, s29, 1
    s_cmp_lg_u32 s29, 0
    s_cbranch_scc1 L_rd2
L_rd2_ok:

    v_readfirstlane_b32 s19, v229
L_rd2_go:

    ds_read_b64_tr_b16 v[228:229], v254 offset:10240
    ds_read_b64_tr_b16 v[230:231], v254 offset:10496
    v_lshlrev_b32_sdwa v181, 1, v181 dst_sel:DWORD dst_unused:UNUSED_PAD src0_sel:DWORD src1_sel:WORD_1
    ds_read_u16_d16 v180, v180
    ds_read_u16_d16_hi v181, v181
    s_waitcnt lgkmcnt(14)
    v_mfma_f32_16x16x32_bf16 v[192:195], v[232:235], v[16:19], v[192:195]
    v_or_b32 v151, v214, v215
    v_mfma_f32_16x16x32_bf16 v[196:199], v[232:235], v[20:23], v[196:199]
    v_lshlrev_b32_sdwa v182, 1, v182 dst_sel:DWORD dst_unused:UNUSED_PAD src0_sel:DWORD src1_sel:WORD_1
    v_mfma_f32_16x16x32_bf16 v[200:203], v[232:235], v[24:27], v[200:203]
    v_lshlrev_b32_sdwa v183, 1, v183 dst_sel:DWORD dst_unused:UNUSED_PAD src0_sel:DWORD src1_sel:WORD_1
    ds_read_u16_d16 v182, v182
    ds_read_u16_d16_hi v183, v183
    v_mfma_f32_16x16x32_bf16 v[204:207], v[232:235], v[28:31], v[204:207]

    s_cmp_ge_u32 s19, 3
    s_cbranch_scc1 L_rd3_go
    v_mov_b32 v232, 161976

    s_mov_b32 s29, 200000
L_rd3:
    ds_read_b32 v233, v232
    s_waitcnt lgkmcnt(0)
    v_cmp_le_u32 vcc, 3, v233
    s_cmp_eq_u64 vcc, exec
    s_cbranch_scc1 L_rd3_ok
    s_sleep 2
    s_sub_u32 s29, s29, 1
    s_cmp_lg_u32 s29, 0
    s_cbranch_scc1 L_rd3
L_rd3_ok:

    v_readfirstlane_b32 s19, v233
L_rd3_go:

    ds_read_b64_tr_b16 v[232:233], v255 offset:13312
    ds_read_b64_tr_b16 v[234:235], v255 offset:14080
    v_or_b32 v154, v216, v217
    v_lshlrev_b32_sdwa v184, 1, v184 dst_sel:DWORD dst_unused:UNUSED_PAD src0_sel:DWORD src1_sel:WORD_1
    v_mfma_f32_16x16x32_bf16 v[64:67], v[236:239], v[160:163], v[64:67]
    v_lshlrev_b32_sdwa v185, 1, v185 dst_sel:DWORD dst_unused:UNUSED_PAD src0_sel:DWORD src1_sel:WORD_1
    ds_read_u16_d16 v184, v184
    ds_read_u16_d16_hi v185, v185
    v_mfma_f32_16x16x32_bf16 v[88:91], v[236:239], v[164:167], v[88:91]
    v_or_b32 v155, v218, v219
    v_mfma_f32_16x16x32_bf16 v[112:115], v[236:239], v[168:171], v[112:115]
    v_lshlrev_b32_sdwa v186, 1, v186 dst_sel:DWORD dst_unused:UNUSED_PAD src0_sel:DWORD src1_sel:WORD_1
    v_mfma_f32_16x16x32_bf16 v[136:139], v[236:239], v[172:175], v[136:139]
    ds_read_b64_tr_b16 v[236:237], v254 offset:11264
    ds_read_b64_tr_b16 v[238:239], v254 offset:11520
    v_lshlrev_b32_sdwa v187, 1, v187 dst_sel:DWORD dst_unused:UNUSED_PAD src0_sel:DWORD src1_sel:WORD_1
    ds_read_u16_d16 v186, v186
    ds_read_u16_d16_hi v187, v187
    s_waitcnt lgkmcnt(14)
    v_mfma_f32_16x16x32_bf16 v[192:195], v[240:243], v[32:35], v[192:195]
    v_or_b32 v158, v220, v221
    v_mfma_f32_16x16x32_bf16 v[196:199], v[240:243], v[36:39], v[196:199]
    v_lshlrev_b32_sdwa v188, 1, v188 dst_sel:DWORD dst_unused:UNUSED_PAD src0_sel:DWORD src1_sel:WORD_1
    v_mfma_f32_16x16x32_bf16 v[200:203], v[240:243], v[40:43], v[200:203]
    v_lshlrev_b32_sdwa v189, 1, v189 dst_sel:DWORD dst_unused:UNUSED_PAD src0_sel:DWORD src1_sel:WORD_1
    ds_read_u16_d16 v188, v188
    ds_read_u16_d16_hi v189, v189
    v_mfma_f32_16x16x32_bf16 v[204:207], v[240:243], v[44:47], v[204:207]
    ds_read_b64_tr_b16 v[240:241], v255 offset:13320
    ds_read_b64_tr_b16 v[242:243], v255 offset:14088
    v_or_b32 v159, v222, v223
    v_mfma_f32_16x16x32_bf16 v[68:71], v[224:227], v[160:163], v[68:71]
    v_lshlrev_b32_sdwa v190, 1, v190 dst_sel:DWORD dst_unused:UNUSED_PAD src0_sel:DWORD src1_sel:WORD_1
    v_mfma_f32_16x16x32_bf16 v[92:95], v[224:227], v[164:167], v[92:95]
    v_lshlrev_b32_sdwa v191, 1, v191 dst_sel:DWORD dst_unused:UNUSED_PAD src0_sel:DWORD src1_sel:WORD_1
    ds_read_u16_d16 v190, v190
    ds_read_u16_d16_hi v191, v191
    v_mfma_f32_16x16x32_bf16 v[116:119], v[224:227], v[168:171], v[116:119]
    v_mfma_f32_16x16x32_bf16 v[140:143], v[224:227], v[172:175], v[140:143]
    ds_read_b64_tr_b16 v[224:225], v254 offset:12288
    ds_read_b64_tr_b16 v[226:227], v254 offset:12544
    s_waitcnt lgkmcnt(14)
    v_mfma_f32_16x16x32_bf16 v[208:211], v[228:231], v[0:3], 0
    v_or_b32 v160, v176, v177
    v_lshlrev_b32_sdwa v192, 1, v192 dst_sel:DWORD dst_unused:UNUSED_PAD src0_sel:DWORD src1_sel:WORD_1
    v_mfma_f32_16x16x32_bf16 v[212:215], v[228:231], v[4:7], 0
    v_lshlrev_b32_sdwa v193, 1, v193 dst_sel:DWORD dst_unused:UNUSED_PAD src0_sel:DWORD src1_sel:WORD_1
    ds_read_u16_d16 v192, v192
    ds_read_u16_d16_hi v193, v193
    v_mfma_f32_16x16x32_bf16 v[216:219], v[228:231], v[8:11], 0
    v_or_b32 v161, v178, v179
    v_mfma_f32_16x16x32_bf16 v[220:223], v[228:231], v[12:15], 0
    ds_read_b64_tr_b16 v[228:229], v255 offset:13376
    ds_read_b64_tr_b16 v[230:231], v255 offset:14144
    v_lshlrev_b32_sdwa v194, 1, v194 dst_sel:DWORD dst_unused:UNUSED_PAD src0_sel:DWORD src1_sel:WORD_1
    v_mfma_f32_16x16x32_bf16 v[48:51], v[232:235], v[144:147], v[48:51]
    v_lshlrev_b32_sdwa v195, 1, v195 dst_sel:DWORD dst_unused:UNUSED_PAD src0_sel:DWORD src1_sel:WORD_1
    ds_read_u16_d16 v194, v194
    ds_read_u16_d16_hi v195, v195
    v_mfma_f32_16x16x32_bf16 v[72:75], v[232:235], v[148:151], v[72:75]
    v_or_b32 v164, v180, v181
    v_mfma_f32_16x16x32_bf16 v[96:99], v[232:235], v[152:155], v[96:99]
    v_lshlrev_b32_sdwa v196, 1, v196 dst_sel:DWORD dst_unused:UNUSED_PAD src0_sel:DWORD src1_sel:WORD_1
    v_mfma_f32_16x16x32_bf16 v[120:123], v[232:235], v[156:159], v[120:123]
    ds_read_b64_tr_b16 v[232:233], v254 offset:10248
    ds_read_b64_tr_b16 v[234:235], v254 offset:10504
    v_lshlrev_b32_sdwa v197, 1, v197 dst_sel:DWORD dst_unused:UNUSED_PAD src0_sel:DWORD src1_sel:WORD_1
    ds_read_u16_d16 v196, v196
    ds_read_u16_d16_hi v197, v197
    s_waitcnt lgkmcnt(14)
    v_mfma_f32_16x16x32_bf16 v[208:211], v[236:239], v[16:19], v[208:211]
    v_or_b32 v165, v182, v183
    v_mfma_f32_16x16x32_bf16 v[212:215], v[236:239], v[20:23], v[212:215]
    v_lshlrev_b32_sdwa v198, 1, v198 dst_sel:DWORD dst_unused:UNUSED_PAD src0_sel:DWORD src1_sel:WORD_1
    v_mfma_f32_16x16x32_bf16 v[216:219], v[236:239], v[24:27], v[216:219]
    v_lshlrev_b32_sdwa v199, 1, v199 dst_sel:DWORD dst_unused:UNUSED_PAD src0_sel:DWORD src1_sel:WORD_1
    ds_read_u16_d16 v198, v198
    ds_read_u16_d16_hi v199, v199
    v_mfma_f32_16x16x32_bf16 v[220:223], v[236:239], v[28:31], v[220:223]
    ds_read_b64_tr_b16 v[236:237], v255 offset:13384
    ds_read_b64_tr_b16 v[238:239], v255 offset:14152
    v_or_b32 v168, v184, v185
    v_lshlrev_b32_sdwa v200, 1, v200 dst_sel:DWORD dst_unused:UNUSED_PAD src0_sel:DWORD src1_sel:WORD_1
    v_mfma_f32_16x16x32_bf16 v[52:55], v[240:243], v[144:147], v[52:55]
    v_lshlrev_b32_sdwa v201, 1, v201 dst_sel:DWORD dst_unused:UNUSED_PAD src0_sel:DWORD src1_sel:WORD_1
    ds_read_u16_d16 v200, v200
    ds_read_u16_d16_hi v201, v201
    buffer_load_dwordx4 v[244:247], v252, s[4:7], s24 offen offset:0
    v_mfma_f32_16x16x32_bf16 v[76:79], v[240:243], v[148:151], v[76:79]
    v_or_b32 v169, v186, v187
    v_mfma_f32_16x16x32_bf16 v[100:103], v[240:243], v[152:155], v[100:103]
    v_lshlrev_b32_sdwa v202, 1, v202 dst_sel:DWORD dst_unused:UNUSED_PAD src0_sel:DWORD src1_sel:WORD_1
    v_mfma_f32_16x16x32_bf16 v[124:127], v[240:243], v[156:159], v[124:127]
    ds_read_b64_tr_b16 v[240:241], v254 offset:11272
    ds_read_b64_tr_b16 v[242:243], v254 offset:11528
    v_lshlrev_b32_sdwa v203, 1, v203 dst_sel:DWORD dst_unused:UNUSED_PAD src0_sel:DWORD src1_sel:WORD_1
    ds_read_u16_d16 v202, v202
    ds_read_u16_d16_hi v203, v203
    s_waitcnt lgkmcnt(14)
    v_mfma_f32_16x16x32_bf16 v[208:211], v[224:227], v[32:35], v[208:211]
    v_or_b32 v172, v188, v189
    v_mfma_f32_16x16x32_bf16 v[212:215], v[224:227], v[36:39], v[212:215]
    v_lshlrev_b32_sdwa v204, 1, v204 dst_sel:DWORD dst_unused:UNUSED_PAD src0_sel:DWORD src1_sel:WORD_1
    v_mfma_f32_16x16x32_bf16 v[216:219], v[224:227], v[40:43], v[216:219]
    v_lshlrev_b32_sdwa v205, 1, v205 dst_sel:DWORD dst_unused:UNUSED_PAD src0_sel:DWORD src1_sel:WORD_1
    ds_read_u16_d16 v204, v204
    ds_read_u16_d16_hi v205, v205
    v_mfma_f32_16x16x32_bf16 v[220:223], v[224:227], v[44:47], v[220:223]
    ds_read_b64_tr_b16 v[224:225], v255 offset:13440
    ds_read_b64_tr_b16 v[226:227], v255 offset:14208
    v_or_b32 v173, v190, v191
    v_mfma_f32_16x16x32_bf16 v[56:59], v[228:231], v[144:147], v[56:59]
    v_lshlrev_b32_sdwa v206, 1, v206 dst_sel:DWORD dst_unused:UNUSED_PAD src0_sel:DWORD src1_sel:WORD_1
    v_mfma_f32_16x16x32_bf16 v[80:83], v[228:231], v[148:151], v[80:83]
    v_lshlrev_b32_sdwa v207, 1, v207 dst_sel:DWORD dst_unused:UNUSED_PAD src0_sel:DWORD src1_sel:WORD_1
    ds_read_u16_d16 v206, v206
    ds_read_u16_d16_hi v207, v207
    v_mfma_f32_16x16x32_bf16 v[104:107], v[228:231], v[152:155], v[104:107]
    v_mfma_f32_16x16x32_bf16 v[128:131], v[228:231], v[156:159], v[128:131]
    ds_read_b64_tr_b16 v[228:229], v254 offset:12296
    ds_read_b64_tr_b16 v[230:231], v254 offset:12552
    s_waitcnt lgkmcnt(14)
    v_mfma_f32_16x16x32_bf16 v[176:179], v[232:235], v[0:3], 0
    v_or_b32 v162, v192, v193
    v_lshlrev_b32_sdwa v208, 1, v208 dst_sel:DWORD dst_unused:UNUSED_PAD src0_sel:DWORD src1_sel:WORD_1
    v_mfma_f32_16x16x32_bf16 v[180:183], v[232:235], v[4:7], 0
    v_lshlrev_b32_sdwa v209, 1, v209 dst_sel:DWORD dst_unused:UNUSED_PAD src0_sel:DWORD src1_sel:WORD_1
    ds_read_u16_d16 v208, v208
    ds_read_u16_d16_hi v209, v209
    v_mfma_f32_16x16x32_bf16 v[184:187], v[232:235], v[8:11], 0
    v_or_b32 v163, v194, v195
    v_mfma_f32_16x16x32_bf16 v[188:191], v[232:235], v[12:15], 0
    ds_read_b64_tr_b16 v[232:233], v255 offset:13448
    ds_read_b64_tr_b16 v[234:235], v255 offset:14216
    v_lshlrev_b32_sdwa v210, 1, v210 dst_sel:DWORD dst_unused:UNUSED_PAD src0_sel:DWORD src1_sel:WORD_1
    v_mfma_f32_16x16x32_bf16 v[60:63], v[236:239], v[144:147], v[60:63]
    v_lshlrev_b32_sdwa v211, 1, v211 dst_sel:DWORD dst_unused:UNUSED_PAD src0_sel:DWORD src1_sel:WORD_1
    ds_read_u16_d16 v210, v210
    ds_read_u16_d16_hi v211, v211
    v_mfma_f32_16x16x32_bf16 v[84:87], v[236:239], v[148:151], v[84:87]
    v_or_b32 v166, v196, v197
    v_mfma_f32_16x16x32_bf16 v[108:111], v[236:239], v[152:155], v[108:111]
    v_lshlrev_b32_sdwa v212, 1, v212 dst_sel:DWORD dst_unused:UNUSED_PAD src0_sel:DWORD src1_sel:WORD_1
    v_mfma_f32_16x16x32_bf16 v[132:135], v[236:239], v[156:159], v[132:135]

    s_cmp_ge_u32 s19, 4
    s_cbranch_scc1 L_rd4_go
    v_mov_b32 v236, 161976

    s_mov_b32 s29, 200000
L_rd4:
    ds_read_b32 v237, v236
    s_waitcnt lgkmcnt(0)
    v_cmp_le_u32 vcc, 4, v237
    s_cmp_eq_u64 vcc, exec
    s_cbranch_scc1 L_rd4_ok
    s_sleep 2
    s_sub_u32 s29, s29, 1
    s_cmp_lg_u32 s29, 0
    s_cbranch_scc1 L_rd4
L_rd4_ok:

    v_readfirstlane_b32 s19, v237
L_rd4_go:

    ds_read_b64_tr_b16 v[236:237], v254 offset:16384
    ds_read_b64_tr_b16 v[238:239], v254 offset:16640
    v_lshlrev_b32_sdwa v213, 1, v213 dst_sel:DWORD dst_unused:UNUSED_PAD src0_sel:DWORD src1_sel:WORD_1
    ds_read_u16_d16 v212, v212
    ds_read_u16_d16_hi v213, v213
    s_waitcnt lgkmcnt(14)
    v_mfma_f32_16x16x32_bf16 v[176:179], v[240:243], v[16:19], v[176:179]
    v_or_b32 v167, v198, v199
    v_mfma_f32_16x16x32_bf16 v[180:183], v[240:243], v[20:23], v[180:183]
    v_lshlrev_b32_sdwa v214, 1, v214 dst_sel:DWORD dst_unused:UNUSED_PAD src0_sel:DWORD src1_sel:WORD_1
    v_mfma_f32_16x16x32_bf16 v[184:187], v[240:243], v[24:27], v[184:187]
    v_lshlrev_b32_sdwa v215, 1, v215 dst_sel:DWORD dst_unused:UNUSED_PAD src0_sel:DWORD src1_sel:WORD_1
    ds_read_u16_d16 v214, v214
    ds_read_u16_d16_hi v215, v215
    v_mfma_f32_16x16x32_bf16 v[188:191], v[240:243], v[28:31], v[188:191]

    s_cmp_ge_u32 s19, 5
    s_cbranch_scc1 L_rd5_go
    v_mov_b32 v240, 161976

    s_mov_b32 s29, 200000
L_rd5:
    ds_read_b32 v241, v240
    s_waitcnt lgkmcnt(0)
    v_cmp_le_u32 vcc, 5, v241
    s_cmp_eq_u64 vcc, exec
    s_cbranch_scc1 L_rd5_ok
    s_sleep 2
    s_sub_u32 s29, s29, 1
    s_cmp_lg_u32 s29, 0
    s_cbranch_scc1 L_rd5
L_rd5_ok:

    v_readfirstlane_b32 s19, v241
L_rd5_go:

    ds_read_b64_tr_b16 v[240:241], v255 offset:19456
    ds_read_b64_tr_b16 v[242:243], v255 offset:20224
    v_or_b32 v170, v200, v201
    v_lshlrev_b32_sdwa v216, 1, v216 dst_sel:DWORD dst_unused:UNUSED_PAD src0_sel:DWORD src1_sel:WORD_1
    v_mfma_f32_16x16x32_bf16 v[64:67], v[224:227], v[144:147], v[64:67]
    v_lshlrev_b32_sdwa v217, 1, v217 dst_sel:DWORD dst_unused:UNUSED_PAD src0_sel:DWORD src1_sel:WORD_1
    ds_read_u16_d16 v216, v216
    ds_read_u16_d16_hi v217, v217
    buffer_load_dwordx4 v[248:251], v252, s[4:7], s24 offen offset:128
    v_mfma_f32_16x16x32_bf16 v[88:91], v[224:227], v[148:151], v[88:91]
    v_or_b32 v171, v202, v203
    v_mfma_f32_16x16x32_bf16 v[112:115], v[224:227], v[152:155], v[112:115]
    v_lshlrev_b32_sdwa v218, 1, v218 dst_sel:DWORD dst_unused:UNUSED_PAD src0_sel:DWORD src1_sel:WORD_1
    v_mfma_f32_16x16x32_bf16 v[136:139], v[224:227], v[156:159], v[136:139]
    ds_read_b64_tr_b16 v[224:225], v254 offset:17408
    ds_read_b64_tr_b16 v[226:227], v254 offset:17664
    v_lshlrev_b32_sdwa v219, 1, v219 dst_sel:DWORD dst_unused:UNUSED_PAD src0_sel:DWORD src1_sel:WORD_1
    ds_read_u16_d16 v218, v218
    ds_read_u16_d16_hi v219, v219
    s_waitcnt lgkmcnt(14)
    v_mfma_f32_16x16x32_bf16 v[176:179], v[228:231], v[32:35], v[176:179]
    v_or_b32 v174, v204, v205
    v_mfma_f32_16x16x32_bf16 v[180:183], v[228:231], v[36:39], v[180:183]
    v_lshlrev_b32_sdwa v220, 1, v220 dst_sel:DWORD dst_unused:UNUSED_PAD src0_sel:DWORD src1_sel:WORD_1
    v_mfma_f32_16x16x32_bf16 v[184:187], v[228:231], v[40:43], v[184:187]
    v_lshlrev_b32_sdwa v221, 1, v221 dst_sel:DWORD dst_unused:UNUSED_PAD src0_sel:DWORD src1_sel:WORD_1
    ds_read_u16_d16 v220, v220
    ds_read_u16_d16_hi v221, v221
    v_mfma_f32_16x16x32_bf16 v[188:191], v[228:231], v[44:47], v[188:191]
    ds_read_b64_tr_b16 v[228:229], v255 offset:19464
    ds_read_b64_tr_b16 v[230:231], v255 offset:20232
    v_or_b32 v175, v206, v207
    v_mfma_f32_16x16x32_bf16 v[68:71], v[232:235], v[144:147], v[68:71]
    v_lshlrev_b32_sdwa v222, 1, v222 dst_sel:DWORD dst_unused:UNUSED_PAD src0_sel:DWORD src1_sel:WORD_1
    v_mfma_f32_16x16x32_bf16 v[92:95], v[232:235], v[148:151], v[92:95]
    v_lshlrev_b32_sdwa v223, 1, v223 dst_sel:DWORD dst_unused:UNUSED_PAD src0_sel:DWORD src1_sel:WORD_1
    ds_read_u16_d16 v222, v222
    ds_read_u16_d16_hi v223, v223
    v_mfma_f32_16x16x32_bf16 v[116:119], v[232:235], v[152:155], v[116:119]
    v_mfma_f32_16x16x32_bf16 v[140:143], v[232:235], v[156:159], v[140:143]
    ds_read_b64_tr_b16 v[232:233], v254 offset:18432
    ds_read_b64_tr_b16 v[234:235], v254 offset:18688
    s_waitcnt lgkmcnt(14)
    v_mfma_f32_16x16x32_bf16 v[192:195], v[236:239], v[0:3], 0
    v_or_b32 v144, v208, v209
    v_lshlrev_b32_sdwa v176, 1, v176 dst_sel:DWORD dst_unused:UNUSED_PAD src0_sel:DWORD src1_sel:WORD_1
    v_mfma_f32_16x16x32_bf16 v[196:199], v[236:239], v[4:7], 0
    v_lshlrev_b32_sdwa v177, 1, v177 dst_sel:DWORD dst_unused:UNUSED_PAD src0_sel:DWORD src1_sel:WORD_1
    ds_read_u16_d16 v176, v176
    ds_read_u16_d16_hi v177, v177
    v_mfma_f32_16x16x32_bf16 v[200:203], v[236:239], v[8:11], 0
    v_or_b32 v145, v210, v211
    v_mfma_f32_16x16x32_bf16 v[204:207], v[236:239], v[12:15], 0
    ds_read_b64_tr_b16 v[236:237], v255 offset:19520
    ds_read_b64_tr_b16 v[238:239], v255 offset:20288
    v_lshlrev_b32_sdwa v178, 1, v178 dst_sel:DWORD dst_unused:UNUSED_PAD src0_sel:DWORD src1_sel:WORD_1
    v_mfma_f32_16x16x32_bf16 v[48:51], v[240:243], v[160:163], v[48:51]
    v_lshlrev_b32_sdwa v179, 1, v179 dst_sel:DWORD dst_unused:UNUSED_PAD src0_sel:DWORD src1_sel:WORD_1
    ds_read_u16_d16 v178, v178
    ds_read_u16_d16_hi v179, v179
    v_mfma_f32_16x16x32_bf16 v[72:75], v[240:243], v[164:167], v[72:75]
    v_or_b32 v148, v212, v213
    v_mfma_f32_16x16x32_bf16 v[96:99], v[240:243], v[168:171], v[96:99]
    v_lshlrev_b32_sdwa v180, 1, v180 dst_sel:DWORD dst_unused:UNUSED_PAD src0_sel:DWORD src1_sel:WORD_1
    v_mfma_f32_16x16x32_bf16 v[120:123], v[240:243], v[172:175], v[120:123]
    ds_read_b64_tr_b16 v[240:241], v254 offset:16392
    ds_read_b64_tr_b16 v[242:243], v254 offset:16648
    v_lshlrev_b32_sdwa v181, 1, v181 dst_sel:DWORD dst_unused:UNUSED_PAD src0_sel:DWORD src1_sel:WORD_1
    ds_read_u16_d16 v180, v180
    ds_read_u16_d16_hi v181, v181
    s_waitcnt lgkmcnt(14)
    v_mfma_f32_16x16x32_bf16 v[192:195], v[224:227], v[16:19], v[192:195]
    v_or_b32 v149, v214, v215
    v_mfma_f32_16x16x32_bf16 v[196:199], v[224:227], v[20:23], v[196:199]
    v_lshlrev_b32_sdwa v182, 1, v182 dst_sel:DWORD dst_unused:UNUSED_PAD src0_sel:DWORD src1_sel:WORD_1
    v_mfma_f32_16x16x32_bf16 v[200:203], v[224:227], v[24:27], v[200:203]
    v_lshlrev_b32_sdwa v183, 1, v183 dst_sel:DWORD dst_unused:UNUSED_PAD src0_sel:DWORD src1_sel:WORD_1
    ds_read_u16_d16 v182, v182
    ds_read_u16_d16_hi v183, v183
    v_mfma_f32_16x16x32_bf16 v[204:207], v[224:227], v[28:31], v[204:207]
    ds_read_b64_tr_b16 v[224:225], v255 offset:19528
    ds_read_b64_tr_b16 v[226:227], v255 offset:20296
    v_or_b32 v152, v216, v217
    v_lshlrev_b32_sdwa v184, 1, v184 dst_sel:DWORD dst_unused:UNUSED_PAD src0_sel:DWORD src1_sel:WORD_1
    v_mfma_f32_16x16x32_bf16 v[52:55], v[228:231], v[160:163], v[52:55]
    v_lshlrev_b32_sdwa v185, 1, v185 dst_sel:DWORD dst_unused:UNUSED_PAD src0_sel:DWORD src1_sel:WORD_1
    ds_read_u16_d16 v184, v184
    ds_read_u16_d16_hi v185, v185
    v_mfma_f32_16x16x32_bf16 v[76:79], v[228:231], v[164:167], v[76:79]
    v_or_b32 v153, v218, v219
    v_mfma_f32_16x16x32_bf16 v[100:103], v[228:231], v[168:171], v[100:103]
    v_lshlrev_b32_sdwa v186, 1, v186 dst_sel:DWORD dst_unused:UNUSED_PAD src0_sel:DWORD src1_sel:WORD_1
    v_mfma_f32_16x16x32_bf16 v[124:127], v[228:231], v[172:175], v[124:127]
    ds_read_b64_tr_b16 v[228:229], v254 offset:17416
    ds_read_b64_tr_b16 v[230:231], v254 offset:17672
    v_lshlrev_b32_sdwa v187, 1, v187 dst_sel:DWORD dst_unused:UNUSED_PAD src0_sel:DWORD src1_sel:WORD_1
    ds_read_u16_d16 v186, v186
    ds_read_u16_d16_hi v187, v187
    s_waitcnt lgkmcnt(14)
    v_mfma_f32_16x16x32_bf16 v[192:195], v[232:235], v[32:35], v[192:195]
    v_or_b32 v156, v220, v221
    v_mfma_f32_16x16x32_bf16 v[196:199], v[232:235], v[36:39], v[196:199]
    v_lshlrev_b32_sdwa v188, 1, v188 dst_sel:DWORD dst_unused:UNUSED_PAD src0_sel:DWORD src1_sel:WORD_1
    v_mfma_f32_16x16x32_bf16 v[200:203], v[232:235], v[40:43], v[200:203]
    v_lshlrev_b32_sdwa v189, 1, v189 dst_sel:DWORD dst_unused:UNUSED_PAD src0_sel:DWORD src1_sel:WORD_1
    ds_read_u16_d16 v188, v188
    ds_read_u16_d16_hi v189, v189
    v_mfma_f32_16x16x32_bf16 v[204:207], v[232:235], v[44:47], v[204:207]
    ds_read_b64_tr_b16 v[232:233], v255 offset:19584
    ds_read_b64_tr_b16 v[234:235], v255 offset:20352
    v_or_b32 v157, v222, v223
    v_mfma_f32_16x16x32_bf16 v[56:59], v[236:239], v[160:163], v[56:59]
    v_lshlrev_b32_sdwa v190, 1, v190 dst_sel:DWORD dst_unused:UNUSED_PAD src0_sel:DWORD src1_sel:WORD_1
    v_mfma_f32_16x16x32_bf16 v[80:83], v[236:239], v[164:167], v[80:83]
    v_lshlrev_b32_sdwa v191, 1, v191 dst_sel:DWORD dst_unused:UNUSED_PAD src0_sel:DWORD src1_sel:WORD_1
    ds_read_u16_d16 v190, v190
    ds_read_u16_d16_hi v191, v191
    v_mfma_f32_16x16x32_bf16 v[104:107], v[236:239], v[168:171], v[104:107]
    v_mfma_f32_16x16x32_bf16 v[128:131], v[236:239], v[172:175], v[128:131]
    ds_read_b64_tr_b16 v[236:237], v254 offset:18440
    ds_read_b64_tr_b16 v[238:239], v254 offset:18696
    s_waitcnt lgkmcnt(14)
    v_mfma_f32_16x16x32_bf16 v[208:211], v[240:243], v[0:3], 0
    v_or_b32 v146, v176, v177
    v_lshlrev_b32_sdwa v192, 1, v192 dst_sel:DWORD dst_unused:UNUSED_PAD src0_sel:DWORD src1_sel:WORD_1
    v_mfma_f32_16x16x32_bf16 v[212:215], v[240:243], v[4:7], 0
    v_lshlrev_b32_sdwa v193, 1, v193 dst_sel:DWORD dst_unused:UNUSED_PAD src0_sel:DWORD src1_sel:WORD_1
    ds_read_u16_d16 v192, v192
    ds_read_u16_d16_hi v193, v193
    v_mfma_f32_16x16x32_bf16 v[216:219], v[240:243], v[8:11], 0
    v_or_b32 v147, v178, v179
    v_mfma_f32_16x16x32_bf16 v[220:223], v[240:243], v[12:15], 0
    ds_read_b64_tr_b16 v[240:241], v255 offset:19592
    ds_read_b64_tr_b16 v[242:243], v255 offset:20360
    v_lshlrev_b32_sdwa v194, 1, v194 dst_sel:DWORD dst_unused:UNUSED_PAD src0_sel:DWORD src1_sel:WORD_1
    v_mfma_f32_16x16x32_bf16 v[60:63], v[224:227], v[160:163], v[60:63]
    v_lshlrev_b32_sdwa v195, 1, v195 dst_sel:DWORD dst_unused:UNUSED_PAD src0_sel:DWORD src1_sel:WORD_1
    ds_read_u16_d16 v194, v194
    ds_read_u16_d16_hi v195, v195
    v_mfma_f32_16x16x32_bf16 v[84:87], v[224:227], v[164:167], v[84:87]
    v_or_b32 v150, v180, v181
    v_mfma_f32_16x16x32_bf16 v[108:111], v[224:227], v[168:171], v[108:111]
    v_lshlrev_b32_sdwa v196, 1, v196 dst_sel:DWORD dst_unused:UNUSED_PAD src0_sel:DWORD src1_sel:WORD_1
    s_waitcnt vmcnt(1)
    v_dot2_f32_bf16 v48, v244, s86, v48
    v_mfma_f32_16x16x32_bf16 v[132:135], v[224:227], v[172:175], v[132:135]

    s_cmp_ge_u32 s19, 6
    s_cbranch_scc1 L_rd6_go
    v_mov_b32 v224, 161976

    s_mov_b32 s29, 200000
L_rd6:
    ds_read_b32 v225, v224
    s_waitcnt lgkmcnt(0)
    v_cmp_le_u32 vcc, 6, v225
    s_cmp_eq_u64 vcc, exec
    s_cbranch_scc1 L_rd6_ok
    s_sleep 2
    s_sub_u32 s29, s29, 1
    s_cmp_lg_u32 s29, 0
    s_cbranch_scc1 L_rd6
L_rd6_ok:

    v_readfirstlane_b32 s19, v225
L_rd6_go:

    ds_read_b64_tr_b16 v[224:225], v254 offset:22528
    ds_read_b64_tr_b16 v[226:227], v254 offset:22784
    v_lshlrev_b32_sdwa v197, 1, v197 dst_sel:DWORD dst_unused:UNUSED_PAD src0_sel:DWORD src1_sel:WORD_1
    ds_read_u16_d16 v196, v196
    ds_read_u16_d16_hi v197, v197
    v_dot2_f32_bf16 v49, v244, s87, v49
    s_waitcnt lgkmcnt(14)
    v_mfma_f32_16x16x32_bf16 v[208:211], v[228:231], v[16:19], v[208:211]
    v_or_b32 v151, v182, v183
    v_dot2_f32_bf16 v50, v245, s86, v50
    v_mfma_f32_16x16x32_bf16 v[212:215], v[228:231], v[20:23], v[212:215]
    v_lshlrev_b32_sdwa v198, 1, v198 dst_sel:DWORD dst_unused:UNUSED_PAD src0_sel:DWORD src1_sel:WORD_1
    v_dot2_f32_bf16 v51, v245, s87, v51
    v_mfma_f32_16x16x32_bf16 v[216:219], v[228:231], v[24:27], v[216:219]
    v_lshlrev_b32_sdwa v199, 1, v199 dst_sel:DWORD dst_unused:UNUSED_PAD src0_sel:DWORD src1_sel:WORD_1
    ds_read_u16_d16 v198, v198
    ds_read_u16_d16_hi v199, v199
    v_dot2_f32_bf16 v52, v246, s86, v52
    v_mfma_f32_16x16x32_bf16 v[220:223], v[228:231], v[28:31], v[220:223]

    s_cmp_ge_u32 s19, 7
    s_cbranch_scc1 L_rd7_go
    v_mov_b32 v228, 161976

    s_mov_b32 s29, 200000
L_rd7:
    ds_read_b32 v229, v228
    s_waitcnt lgkmcnt(0)
    v_cmp_le_u32 vcc, 7, v229
    s_cmp_eq_u64 vcc, exec
    s_cbranch_scc1 L_rd7_ok
    s_sleep 2
    s_sub_u32 s29, s29, 1
    s_cmp_lg_u32 s29, 0
    s_cbranch_scc1 L_rd7
L_rd7_ok:

    v_readfirstlane_b32 s19, v229
L_rd7_go:

    ds_read_b64_tr_b16 v[228:229], v255 offset:25600
    ds_read_b64_tr_b16 v[230:231], v255 offset:26368
    v_or_b32 v154, v184, v185
    v_lshlrev_b32_sdwa v200, 1, v200 dst_sel:DWORD dst_unused:UNUSED_PAD src0_sel:DWORD src1_sel:WORD_1
    v_dot2_f32_bf16 v53, v246, s87, v53
    v_mfma_f32_16x16x32_bf16 v[64:67], v[232:235], v[160:163], v[64:67]
    v_lshlrev_b32_sdwa v201, 1, v201 dst_sel:DWORD dst_unused:UNUSED_PAD src0_sel:DWORD src1_sel:WORD_1
    ds_read_u16_d16 v200, v200
    ds_read_u16_d16_hi v201, v201
    v_dot2_f32_bf16 v54, v247, s86, v54
    v_mfma_f32_16x16x32_bf16 v[88:91], v[232:235], v[164:167], v[88:91]
    v_or_b32 v155, v186, v187
    v_dot2_f32_bf16 v55, v247, s87, v55
    buffer_load_dwordx4 v[244:247], v252, s[4:7], s24 offen offset:192
    v_mfma_f32_16x16x32_bf16 v[112:115], v[232:235], v[168:171], v[112:115]
    v_lshlrev_b32_sdwa v202, 1, v202 dst_sel:DWORD dst_unused:UNUSED_PAD src0_sel:DWORD src1_sel:WORD_1
    v_mfma_f32_16x16x32_bf16 v[136:139], v[232:235], v[172:175], v[136:139]
    ds_read_b64_tr_b16 v[232:233], v254 offset:23552
    ds_read_b64_tr_b16 v[234:235], v254 offset:23808
    v_lshlrev_b32_sdwa v203, 1, v203 dst_sel:DWORD dst_unused:UNUSED_PAD src0_sel:DWORD src1_sel:WORD_1
    ds_read_u16_d16 v202, v202
    ds_read_u16_d16_hi v203, v203
    s_waitcnt lgkmcnt(14)
    v_mfma_f32_16x16x32_bf16 v[208:211], v[236:239], v[32:35], v[208:211]
    v_or_b32 v158, v188, v189
    v_mfma_f32_16x16x32_bf16 v[212:215], v[236:239], v[36:39], v[212:215]
    v_lshlrev_b32_sdwa v204, 1, v204 dst_sel:DWORD dst_unused:UNUSED_PAD src0_sel:DWORD src1_sel:WORD_1
    v_mfma_f32_16x16x32_bf16 v[216:219], v[236:239], v[40:43], v[216:219]
    v_lshlrev_b32_sdwa v205, 1, v205 dst_sel:DWORD dst_unused:UNUSED_PAD src0_sel:DWORD src1_sel:WORD_1
    ds_read_u16_d16 v204, v204
    ds_read_u16_d16_hi v205, v205
    v_mfma_f32_16x16x32_bf16 v[220:223], v[236:239], v[44:47], v[220:223]
    ds_read_b64_tr_b16 v[236:237], v255 offset:25608
    ds_read_b64_tr_b16 v[238:239], v255 offset:26376
    v_or_b32 v159, v190, v191
    v_mfma_f32_16x16x32_bf16 v[68:71], v[240:243], v[160:163], v[68:71]
    v_lshlrev_b32_sdwa v206, 1, v206 dst_sel:DWORD dst_unused:UNUSED_PAD src0_sel:DWORD src1_sel:WORD_1
    v_mfma_f32_16x16x32_bf16 v[92:95], v[240:243], v[164:167], v[92:95]
    v_lshlrev_b32_sdwa v207, 1, v207 dst_sel:DWORD dst_unused:UNUSED_PAD src0_sel:DWORD src1_sel:WORD_1
    ds_read_u16_d16 v206, v206
    ds_read_u16_d16_hi v207, v207
    v_mfma_f32_16x16x32_bf16 v[116:119], v[240:243], v[168:171], v[116:119]
    v_mfma_f32_16x16x32_bf16 v[140:143], v[240:243], v[172:175], v[140:143]
    ds_read_b64_tr_b16 v[240:241], v254 offset:24576
    ds_read_b64_tr_b16 v[242:243], v254 offset:24832
    s_waitcnt lgkmcnt(14)
    v_mfma_f32_16x16x32_bf16 v[176:179], v[224:227], v[0:3], 0
    v_or_b32 v160, v192, v193
    v_lshlrev_b32_sdwa v208, 1, v208 dst_sel:DWORD dst_unused:UNUSED_PAD src0_sel:DWORD src1_sel:WORD_1
    v_mfma_f32_16x16x32_bf16 v[180:183], v[224:227], v[4:7], 0
    v_lshlrev_b32_sdwa v209, 1, v209 dst_sel:DWORD dst_unused:UNUSED_PAD src0_sel:DWORD src1_sel:WORD_1
    ds_read_u16_d16 v208, v208
    ds_read_u16_d16_hi v209, v209
    v_mfma_f32_16x16x32_bf16 v[184:187], v[224:227], v[8:11], 0
    v_or_b32 v161, v194, v195
    v_mfma_f32_16x16x32_bf16 v[188:191], v[224:227], v[12:15], 0
    ds_read_b64_tr_b16 v[224:225], v255 offset:25664
    ds_read_b64_tr_b16 v[226:227], v255 offset:26432
    v_lshlrev_b32_sdwa v210, 1, v210 dst_sel:DWORD dst_unused:UNUSED_PAD src0_sel:DWORD src1_sel:WORD_1
    v_mfma_f32_16x16x32_bf16 v[48:51], v[228:231], v[144:147], v[48:51]
    v_lshlrev_b32_sdwa v211, 1, v211 dst_sel:DWORD dst_unused:UNUSED_PAD src0_sel:DWORD src1_sel:WORD_1
    ds_read_u16_d16 v210, v210
    ds_read_u16_d16_hi v211, v211
    v_mfma_f32_16x16x32_bf16 v[72:75], v[228:231], v[148:151], v[72:75]
    v_or_b32 v164, v196, v197
    v_mfma_f32_16x16x32_bf16 v[96:99], v[228:231], v[152:155], v[96:99]
    v_lshlrev_b32_sdwa v212, 1, v212 dst_sel:DWORD dst_unused:UNUSED_PAD src0_sel:DWORD src1_sel:WORD_1
    s_waitcnt vmcnt(1)
    v_dot2_f32_bf16 v64, v248, s86, v64
    v_mfma_f32_16x16x32_bf16 v[120:123], v[228:231], v[156:159], v[120:123]
    ds_read_b64_tr_b16 v[228:229], v254 offset:22536
    ds_read_b64_tr_b16 v[230:231], v254 offset:22792
    v_lshlrev_b32_sdwa v213, 1, v213 dst_sel:DWORD dst_unused:UNUSED_PAD src0_sel:DWORD src1_sel:WORD_1
    ds_read_u16_d16 v212, v212
    ds_read_u16_d16_hi v213, v213
    v_dot2_f32_bf16 v65, v248, s87, v65
    s_waitcnt lgkmcnt(14)
    v_mfma_f32_16x16x32_bf16 v[176:179], v[232:235], v[16:19], v[176:179]
    v_or_b32 v165, v198, v199
    v_dot2_f32_bf16 v66, v249, s86, v66
    v_mfma_f32_16x16x32_bf16 v[180:183], v[232:235], v[20:23], v[180:183]
    v_lshlrev_b32_sdwa v214, 1, v214 dst_sel:DWORD dst_unused:UNUSED_PAD src0_sel:DWORD src1_sel:WORD_1
    v_dot2_f32_bf16 v67, v249, s87, v67
    v_mfma_f32_16x16x32_bf16 v[184:187], v[232:235], v[24:27], v[184:187]
    v_lshlrev_b32_sdwa v215, 1, v215 dst_sel:DWORD dst_unused:UNUSED_PAD src0_sel:DWORD src1_sel:WORD_1
    ds_read_u16_d16 v214, v214
    ds_read_u16_d16_hi v215, v215
    v_dot2_f32_bf16 v68, v250, s86, v68
    v_mfma_f32_16x16x32_bf16 v[188:191], v[232:235], v[28:31], v[188:191]
    ds_read_b64_tr_b16 v[232:233], v255 offset:25672
    ds_read_b64_tr_b16 v[234:235], v255 offset:26440
    v_or_b32 v168, v200, v201
    v_lshlrev_b32_sdwa v216, 1, v216 dst_sel:DWORD dst_unused:UNUSED_PAD src0_sel:DWORD src1_sel:WORD_1
    v_dot2_f32_bf16 v69, v250, s87, v69
    v_mfma_f32_16x16x32_bf16 v[52:55], v[236:239], v[144:147], v[52:55]
    v_lshlrev_b32_sdwa v217, 1, v217 dst_sel:DWORD dst_unused:UNUSED_PAD src0_sel:DWORD src1_sel:WORD_1
    ds_read_u16_d16 v216, v216
    ds_read_u16_d16_hi v217, v217
    v_dot2_f32_bf16 v70, v251, s86, v70
    v_mfma_f32_16x16x32_bf16 v[76:79], v[236:239], v[148:151], v[76:79]
    v_or_b32 v169, v202, v203
    v_dot2_f32_bf16 v71, v251, s87, v71
    buffer_load_dwordx4 v[248:251], v252, s[4:7], s24 offen offset:320
    v_mfma_f32_16x16x32_bf16 v[100:103], v[236:239], v[152:155], v[100:103]
    v_lshlrev_b32_sdwa v218, 1, v218 dst_sel:DWORD dst_unused:UNUSED_PAD src0_sel:DWORD src1_sel:WORD_1
    v_mfma_f32_16x16x32_bf16 v[124:127], v[236:239], v[156:159], v[124:127]
    ds_read_b64_tr_b16 v[236:237], v254 offset:23560
    ds_read_b64_tr_b16 v[238:239], v254 offset:23816
    v_lshlrev_b32_sdwa v219, 1, v219 dst_sel:DWORD dst_unused:UNUSED_PAD src0_sel:DWORD src1_sel:WORD_1
    ds_read_u16_d16 v218, v218
    ds_read_u16_d16_hi v219, v219
    s_waitcnt lgkmcnt(14)
    v_mfma_f32_16x16x32_bf16 v[176:179], v[240:243], v[32:35], v[176:179]
    v_or_b32 v172, v204, v205
    v_mfma_f32_16x16x32_bf16 v[180:183], v[240:243], v[36:39], v[180:183]
    v_lshlrev_b32_sdwa v220, 1, v220 dst_sel:DWORD dst_unused:UNUSED_PAD src0_sel:DWORD src1_sel:WORD_1
    v_mfma_f32_16x16x32_bf16 v[184:187], v[240:243], v[40:43], v[184:187]
    v_lshlrev_b32_sdwa v221, 1, v221 dst_sel:DWORD dst_unused:UNUSED_PAD src0_sel:DWORD src1_sel:WORD_1
    ds_read_u16_d16 v220, v220
    ds_read_u16_d16_hi v221, v221
    v_mfma_f32_16x16x32_bf16 v[188:191], v[240:243], v[44:47], v[188:191]
    ds_read_b64_tr_b16 v[240:241], v255 offset:25728
    ds_read_b64_tr_b16 v[242:243], v255 offset:26496
    v_or_b32 v173, v206, v207
    v_mfma_f32_16x16x32_bf16 v[56:59], v[224:227], v[144:147], v[56:59]
    v_lshlrev_b32_sdwa v222, 1, v222 dst_sel:DWORD dst_unused:UNUSED_PAD src0_sel:DWORD src1_sel:WORD_1
    v_mfma_f32_16x16x32_bf16 v[80:83], v[224:227], v[148:151], v[80:83]
    v_lshlrev_b32_sdwa v223, 1, v223 dst_sel:DWORD dst_unused:UNUSED_PAD src0_sel:DWORD src1_sel:WORD_1
    ds_read_u16_d16 v222, v222
    ds_read_u16_d16_hi v223, v223
    v_mfma_f32_16x16x32_bf16 v[104:107], v[224:227], v[152:155], v[104:107]
    v_mfma_f32_16x16x32_bf16 v[128:131], v[224:227], v[156:159], v[128:131]
    ds_read_b64_tr_b16 v[224:225], v254 offset:24584
    ds_read_b64_tr_b16 v[226:227], v254 offset:24840
    s_waitcnt lgkmcnt(14)
    v_mfma_f32_16x16x32_bf16 v[192:195], v[228:231], v[0:3], 0
    v_or_b32 v162, v208, v209
    v_lshlrev_b32_sdwa v176, 1, v176 dst_sel:DWORD dst_unused:UNUSED_PAD src0_sel:DWORD src1_sel:WORD_1
    v_mfma_f32_16x16x32_bf16 v[196:199], v[228:231], v[4:7], 0
    v_lshlrev_b32_sdwa v177, 1, v177 dst_sel:DWORD dst_unused:UNUSED_PAD src0_sel:DWORD src1_sel:WORD_1
    ds_read_u16_d16 v176, v176
    ds_read_u16_d16_hi v177, v177
    v_mfma_f32_16x16x32_bf16 v[200:203], v[228:231], v[8:11], 0
    v_or_b32 v163, v210, v211
    v_mfma_f32_16x16x32_bf16 v[204:207], v[228:231], v[12:15], 0
    ds_read_b64_tr_b16 v[228:229], v255 offset:25736
    ds_read_b64_tr_b16 v[230:231], v255 offset:26504
    v_lshlrev_b32_sdwa v178, 1, v178 dst_sel:DWORD dst_unused:UNUSED_PAD src0_sel:DWORD src1_sel:WORD_1
    v_mfma_f32_16x16x32_bf16 v[60:63], v[232:235], v[144:147], v[60:63]
    v_lshlrev_b32_sdwa v179, 1, v179 dst_sel:DWORD dst_unused:UNUSED_PAD src0_sel:DWORD src1_sel:WORD_1
    ds_read_u16_d16 v178, v178
    ds_read_u16_d16_hi v179, v179
    v_mfma_f32_16x16x32_bf16 v[84:87], v[232:235], v[148:151], v[84:87]
    v_or_b32 v166, v212, v213
    v_mfma_f32_16x16x32_bf16 v[108:111], v[232:235], v[152:155], v[108:111]
    v_lshlrev_b32_sdwa v180, 1, v180 dst_sel:DWORD dst_unused:UNUSED_PAD src0_sel:DWORD src1_sel:WORD_1
    s_waitcnt vmcnt(1)
    v_dot2_f32_bf16 v72, v244, s86, v72
    v_mfma_f32_16x16x32_bf16 v[132:135], v[232:235], v[156:159], v[132:135]

    s_cmp_ge_u32 s19, 8
    s_cbranch_scc1 L_rd8_go
    v_mov_b32 v232, 161976

    s_mov_b32 s29, 200000
L_rd8:
    ds_read_b32 v233, v232
    s_waitcnt lgkmcnt(0)
    v_cmp_le_u32 vcc, 8, v233
    s_cmp_eq_u64 vcc, exec
    s_cbranch_scc1 L_rd8_ok
    s_sleep 2
    s_sub_u32 s29, s29, 1
    s_cmp_lg_u32 s29, 0
    s_cbranch_scc1 L_rd8
L_rd8_ok:

    v_readfirstlane_b32 s19, v233
L_rd8_go:

    ds_read_b64_tr_b16 v[232:233], v254 offset:28672
    ds_read_b64_tr_b16 v[234:235], v254 offset:28928
    v_lshlrev_b32_sdwa v181, 1, v181 dst_sel:DWORD dst_unused:UNUSED_PAD src0_sel:DWORD src1_sel:WORD_1
    ds_read_u16_d16 v180, v180
    ds_read_u16_d16_hi v181, v181
    v_dot2_f32_bf16 v73, v244, s87, v73
    s_waitcnt lgkmcnt(14)
    v_mfma_f32_16x16x32_bf16 v[192:195], v[236:239], v[16:19], v[192:195]
    v_or_b32 v167, v214, v215
    v_dot2_f32_bf16 v74, v245, s86, v74
    v_mfma_f32_16x16x32_bf16 v[196:199], v[236:239], v[20:23], v[196:199]
    v_lshlrev_b32_sdwa v182, 1, v182 dst_sel:DWORD dst_unused:UNUSED_PAD src0_sel:DWORD src1_sel:WORD_1
    v_dot2_f32_bf16 v75, v245, s87, v75
    v_mfma_f32_16x16x32_bf16 v[200:203], v[236:239], v[24:27], v[200:203]
    v_lshlrev_b32_sdwa v183, 1, v183 dst_sel:DWORD dst_unused:UNUSED_PAD src0_sel:DWORD src1_sel:WORD_1
    ds_read_u16_d16 v182, v182
    ds_read_u16_d16_hi v183, v183
    v_dot2_f32_bf16 v76, v246, s86, v76
    v_mfma_f32_16x16x32_bf16 v[204:207], v[236:239], v[28:31], v[204:207]

    s_cmp_ge_u32 s19, 9
    s_cbranch_scc1 L_rd9_go
    v_mov_b32 v236, 161976

    s_mov_b32 s29, 200000
L_rd9:
    ds_read_b32 v237, v236
    s_waitcnt lgkmcnt(0)
    v_cmp_le_u32 vcc, 9, v237
    s_cmp_eq_u64 vcc, exec
    s_cbranch_scc1 L_rd9_ok
    s_sleep 2
    s_sub_u32 s29, s29, 1
    s_cmp_lg_u32 s29, 0
    s_cbranch_scc1 L_rd9
L_rd9_ok:

    v_readfirstlane_b32 s19, v237
L_rd9_go:

    ds_read_b64_tr_b16 v[236:237], v255 offset:31744
    ds_read_b64_tr_b16 v[238:239], v255 offset:32512
    v_or_b32 v170, v216, v217
    v_lshlrev_b32_sdwa v184, 1, v184 dst_sel:DWORD dst_unused:UNUSED_PAD src0_sel:DWORD src1_sel:WORD_1
    v_dot2_f32_bf16 v77, v246, s87, v77
    v_mfma_f32_16x16x32_bf16 v[64:67], v[240:243], v[144:147], v[64:67]
    v_lshlrev_b32_sdwa v185, 1, v185 dst_sel:DWORD dst_unused:UNUSED_PAD src0_sel:DWORD src1_sel:WORD_1
    ds_read_u16_d16 v184, v184
    ds_read_u16_d16_hi v185, v185
    v_dot2_f32_bf16 v78, v247, s86, v78
    v_mfma_f32_16x16x32_bf16 v[88:91], v[240:243], v[148:151], v[88:91]
    v_or_b32 v171, v218, v219
    v_dot2_f32_bf16 v79, v247, s87, v79
    buffer_load_dwordx4 v[244:247], v252, s[4:7], s25 offen offset:0
    v_mfma_f32_16x16x32_bf16 v[112:115], v[240:243], v[152:155], v[112:115]
    v_lshlrev_b32_sdwa v186, 1, v186 dst_sel:DWORD dst_unused:UNUSED_PAD src0_sel:DWORD src1_sel:WORD_1
    v_mfma_f32_16x16x32_bf16 v[136:139], v[240:243], v[156:159], v[136:139]
    ds_read_b64_tr_b16 v[240:241], v254 offset:29696
    ds_read_b64_tr_b16 v[242:243], v254 offset:29952
    v_lshlrev_b32_sdwa v187, 1, v187 dst_sel:DWORD dst_unused:UNUSED_PAD src0_sel:DWORD src1_sel:WORD_1
    ds_read_u16_d16 v186, v186
    ds_read_u16_d16_hi v187, v187
    s_waitcnt lgkmcnt(14)
    v_mfma_f32_16x16x32_bf16 v[192:195], v[224:227], v[32:35], v[192:195]
    v_or_b32 v174, v220, v221
    v_mfma_f32_16x16x32_bf16 v[196:199], v[224:227], v[36:39], v[196:199]
    v_lshlrev_b32_sdwa v188, 1, v188 dst_sel:DWORD dst_unused:UNUSED_PAD src0_sel:DWORD src1_sel:WORD_1
    v_mfma_f32_16x16x32_bf16 v[200:203], v[224:227], v[40:43], v[200:203]
    v_lshlrev_b32_sdwa v189, 1, v189 dst_sel:DWORD dst_unused:UNUSED_PAD src0_sel:DWORD src1_sel:WORD_1
    ds_read_u16_d16 v188, v188
    ds_read_u16_d16_hi v189, v189
    v_mfma_f32_16x16x32_bf16 v[204:207], v[224:227], v[44:47], v[204:207]
    ds_read_b64_tr_b16 v[224:225], v255 offset:31752
    ds_read_b64_tr_b16 v[226:227], v255 offset:32520
    v_or_b32 v175, v222, v223
    v_mfma_f32_16x16x32_bf16 v[68:71], v[228:231], v[144:147], v[68:71]
    v_lshlrev_b32_sdwa v190, 1, v190 dst_sel:DWORD dst_unused:UNUSED_PAD src0_sel:DWORD src1_sel:WORD_1
    v_mfma_f32_16x16x32_bf16 v[92:95], v[228:231], v[148:151], v[92:95]
    v_lshlrev_b32_sdwa v191, 1, v191 dst_sel:DWORD dst_unused:UNUSED_PAD src0_sel:DWORD src1_sel:WORD_1
    ds_read_u16_d16 v190, v190
    ds_read_u16_d16_hi v191, v191
    v_mfma_f32_16x16x32_bf16 v[116:119], v[228:231], v[152:155], v[116:119]
    v_mfma_f32_16x16x32_bf16 v[140:143], v[228:231], v[156:159], v[140:143]
    ds_read_b64_tr_b16 v[228:229], v254 offset:30720
    ds_read_b64_tr_b16 v[230:231], v254 offset:30976
    s_waitcnt lgkmcnt(14)
    v_mfma_f32_16x16x32_bf16 v[208:211], v[232:235], v[0:3], 0
    v_or_b32 v144, v176, v177
    v_lshlrev_b32_sdwa v192, 1, v192 dst_sel:DWORD dst_unused:UNUSED_PAD src0_sel:DWORD src1_sel:WORD_1
    v_mfma_f32_16x16x32_bf16 v[212:215], v[232:235], v[4:7], 0
    v_lshlrev_b32_sdwa v193, 1, v193 dst_sel:DWORD dst_unused:UNUSED_PAD src0_sel:DWORD src1_sel:WORD_1
    ds_read_u16_d16 v192, v192
    ds_read_u16_d16_hi v193, v193
    v_mfma_f32_16x16x32_bf16 v[216:219], v[232:235], v[8:11], 0
    v_or_b32 v145, v178, v179
    v_mfma_f32_16x16x32_bf16 v[220:223], v[232:235], v[12:15], 0
    ds_read_b64_tr_b16 v[232:233], v255 offset:31808
    ds_read_b64_tr_b16 v[234:235], v255 offset:32576
    v_lshlrev_b32_sdwa v194, 1, v194 dst_sel:DWORD dst_unused:UNUSED_PAD src0_sel:DWORD src1_sel:WORD_1
    v_mfma_f32_16x16x32_bf16 v[48:51], v[236:239], v[160:163], v[48:51]
    v_lshlrev_b32_sdwa v195, 1, v195 dst_sel:DWORD dst_unused:UNUSED_PAD src0_sel:DWORD src1_sel:WORD_1
    ds_read_u16_d16 v194, v194
    ds_read_u16_d16_hi v195, v195
    v_mfma_f32_16x16x32_bf16 v[72:75], v[236:239], v[164:167], v[72:75]
    v_or_b32 v148, v180, v181
    v_mfma_f32_16x16x32_bf16 v[96:99], v[236:239], v[168:171], v[96:99]
    v_lshlrev_b32_sdwa v196, 1, v196 dst_sel:DWORD dst_unused:UNUSED_PAD src0_sel:DWORD src1_sel:WORD_1
    s_waitcnt vmcnt(1)
    v_dot2_f32_bf16 v88, v248, s86, v88
    v_mfma_f32_16x16x32_bf16 v[120:123], v[236:239], v[172:175], v[120:123]
    ds_read_b64_tr_b16 v[236:237], v254 offset:28680
    ds_read_b64_tr_b16 v[238:239], v254 offset:28936
    v_lshlrev_b32_sdwa v197, 1, v197 dst_sel:DWORD dst_unused:UNUSED_PAD src0_sel:DWORD src1_sel:WORD_1
    ds_read_u16_d16 v196, v196
    ds_read_u16_d16_hi v197, v197
    v_dot2_f32_bf16 v89, v248, s87, v89
    s_waitcnt lgkmcnt(14)
    v_mfma_f32_16x16x32_bf16 v[208:211], v[240:243], v[16:19], v[208:211]
    v_or_b32 v149, v182, v183
    v_dot2_f32_bf16 v90, v249, s86, v90
    v_mfma_f32_16x16x32_bf16 v[212:215], v[240:243], v[20:23], v[212:215]
    v_lshlrev_b32_sdwa v198, 1, v198 dst_sel:DWORD dst_unused:UNUSED_PAD src0_sel:DWORD src1_sel:WORD_1
    v_dot2_f32_bf16 v91, v249, s87, v91
    v_mfma_f32_16x16x32_bf16 v[216:219], v[240:243], v[24:27], v[216:219]
    v_lshlrev_b32_sdwa v199, 1, v199 dst_sel:DWORD dst_unused:UNUSED_PAD src0_sel:DWORD src1_sel:WORD_1
    ds_read_u16_d16 v198, v198
    ds_read_u16_d16_hi v199, v199
    v_dot2_f32_bf16 v92, v250, s86, v92
    v_mfma_f32_16x16x32_bf16 v[220:223], v[240:243], v[28:31], v[220:223]
    ds_read_b64_tr_b16 v[240:241], v255 offset:31816
    ds_read_b64_tr_b16 v[242:243], v255 offset:32584
    v_or_b32 v152, v184, v185
    v_lshlrev_b32_sdwa v200, 1, v200 dst_sel:DWORD dst_unused:UNUSED_PAD src0_sel:DWORD src1_sel:WORD_1
    v_dot2_f32_bf16 v93, v250, s87, v93
    v_mfma_f32_16x16x32_bf16 v[52:55], v[224:227], v[160:163], v[52:55]
    v_lshlrev_b32_sdwa v201, 1, v201 dst_sel:DWORD dst_unused:UNUSED_PAD src0_sel:DWORD src1_sel:WORD_1
    ds_read_u16_d16 v200, v200
    ds_read_u16_d16_hi v201, v201
    v_dot2_f32_bf16 v94, v251, s86, v94
    v_mfma_f32_16x16x32_bf16 v[76:79], v[224:227], v[164:167], v[76:79]
    v_or_b32 v153, v186, v187
    v_dot2_f32_bf16 v95, v251, s87, v95
    buffer_load_dwordx4 v[248:251], v252, s[4:7], s25 offen offset:128
    v_mfma_f32_16x16x32_bf16 v[100:103], v[224:227], v[168:171], v[100:103]
    v_lshlrev_b32_sdwa v202, 1, v202 dst_sel:DWORD dst_unused:UNUSED_PAD src0_sel:DWORD src1_sel:WORD_1
    v_mfma_f32_16x16x32_bf16 v[124:127], v[224:227], v[172:175], v[124:127]
    ds_read_b64_tr_b16 v[224:225], v254 offset:29704
    ds_read_b64_tr_b16 v[226:227], v254 offset:29960
    v_lshlrev_b32_sdwa v203, 1, v203 dst_sel:DWORD dst_unused:UNUSED_PAD src0_sel:DWORD src1_sel:WORD_1
    ds_read_u16_d16 v202, v202
    ds_read_u16_d16_hi v203, v203
    s_waitcnt lgkmcnt(14)
    v_mfma_f32_16x16x32_bf16 v[208:211], v[228:231], v[32:35], v[208:211]
    v_or_b32 v156, v188, v189
    v_mfma_f32_16x16x32_bf16 v[212:215], v[228:231], v[36:39], v[212:215]
    v_lshlrev_b32_sdwa v204, 1, v204 dst_sel:DWORD dst_unused:UNUSED_PAD src0_sel:DWORD src1_sel:WORD_1
    v_mfma_f32_16x16x32_bf16 v[216:219], v[228:231], v[40:43], v[216:219]
    v_lshlrev_b32_sdwa v205, 1, v205 dst_sel:DWORD dst_unused:UNUSED_PAD src0_sel:DWORD src1_sel:WORD_1
    ds_read_u16_d16 v204, v204
    ds_read_u16_d16_hi v205, v205
    v_mfma_f32_16x16x32_bf16 v[220:223], v[228:231], v[44:47], v[220:223]
    ds_read_b64_tr_b16 v[228:229], v255 offset:31872
    ds_read_b64_tr_b16 v[230:231], v255 offset:32640
    v_or_b32 v157, v190, v191
    v_mfma_f32_16x16x32_bf16 v[56:59], v[232:235], v[160:163], v[56:59]
    v_lshlrev_b32_sdwa v206, 1, v206 dst_sel:DWORD dst_unused:UNUSED_PAD src0_sel:DWORD src1_sel:WORD_1
    v_mfma_f32_16x16x32_bf16 v[80:83], v[232:235], v[164:167], v[80:83]
    v_lshlrev_b32_sdwa v207, 1, v207 dst_sel:DWORD dst_unused:UNUSED_PAD src0_sel:DWORD src1_sel:WORD_1
    ds_read_u16_d16 v206, v206
    ds_read_u16_d16_hi v207, v207
    v_mfma_f32_16x16x32_bf16 v[104:107], v[232:235], v[168:171], v[104:107]
    v_mfma_f32_16x16x32_bf16 v[128:131], v[232:235], v[172:175], v[128:131]
    ds_read_b64_tr_b16 v[232:233], v254 offset:30728
    ds_read_b64_tr_b16 v[234:235], v254 offset:30984
    s_waitcnt lgkmcnt(14)
    v_mfma_f32_16x16x32_bf16 v[176:179], v[236:239], v[0:3], 0
    v_or_b32 v146, v192, v193
    v_lshlrev_b32_sdwa v208, 1, v208 dst_sel:DWORD dst_unused:UNUSED_PAD src0_sel:DWORD src1_sel:WORD_1
    v_mfma_f32_16x16x32_bf16 v[180:183], v[236:239], v[4:7], 0
    v_lshlrev_b32_sdwa v209, 1, v209 dst_sel:DWORD dst_unused:UNUSED_PAD src0_sel:DWORD src1_sel:WORD_1
    ds_read_u16_d16 v208, v208
    ds_read_u16_d16_hi v209, v209
    v_mfma_f32_16x16x32_bf16 v[184:187], v[236:239], v[8:11], 0
    v_or_b32 v147, v194, v195
    v_mfma_f32_16x16x32_bf16 v[188:191], v[236:239], v[12:15], 0
    ds_read_b64_tr_b16 v[236:237], v255 offset:31880
    ds_read_b64_tr_b16 v[238:239], v255 offset:32648
    v_lshlrev_b32_sdwa v210, 1, v210 dst_sel:DWORD dst_unused:UNUSED_PAD src0_sel:DWORD src1_sel:WORD_1
    v_mfma_f32_16x16x32_bf16 v[60:63], v[240:243], v[160:163], v[60:63]
    v_lshlrev_b32_sdwa v211, 1, v211 dst_sel:DWORD dst_unused:UNUSED_PAD src0_sel:DWORD src1_sel:WORD_1
    ds_read_u16_d16 v210, v210
    ds_read_u16_d16_hi v211, v211
    v_mfma_f32_16x16x32_bf16 v[84:87], v[240:243], v[164:167], v[84:87]
    v_or_b32 v150, v196, v197
    v_mfma_f32_16x16x32_bf16 v[108:111], v[240:243], v[168:171], v[108:111]
    v_lshlrev_b32_sdwa v212, 1, v212 dst_sel:DWORD dst_unused:UNUSED_PAD src0_sel:DWORD src1_sel:WORD_1
    s_waitcnt vmcnt(1)
    v_dot2_f32_bf16 v96, v244, s86, v96
    v_mfma_f32_16x16x32_bf16 v[132:135], v[240:243], v[172:175], v[132:135]

    s_cmp_ge_u32 s19, 10
    s_cbranch_scc1 L_rd10_go
    v_mov_b32 v240, 161976

    s_mov_b32 s29, 200000
L_rd10:
    ds_read_b32 v241, v240
    s_waitcnt lgkmcnt(0)
    v_cmp_le_u32 vcc, 10, v241
    s_cmp_eq_u64 vcc, exec
    s_cbranch_scc1 L_rd10_ok
    s_sleep 2
    s_sub_u32 s29, s29, 1
    s_cmp_lg_u32 s29, 0
    s_cbranch_scc1 L_rd10
L_rd10_ok:

    v_readfirstlane_b32 s19, v241
L_rd10_go:

    ds_read_b64_tr_b16 v[240:241], v254 offset:34816
    ds_read_b64_tr_b16 v[242:243], v254 offset:35072
    v_lshlrev_b32_sdwa v213, 1, v213 dst_sel:DWORD dst_unused:UNUSED_PAD src0_sel:DWORD src1_sel:WORD_1
    ds_read_u16_d16 v212, v212
    ds_read_u16_d16_hi v213, v213
    v_dot2_f32_bf16 v97, v244, s87, v97
    s_waitcnt lgkmcnt(14)
    v_mfma_f32_16x16x32_bf16 v[176:179], v[224:227], v[16:19], v[176:179]
    v_or_b32 v151, v198, v199
    v_dot2_f32_bf16 v98, v245, s86, v98
    v_mfma_f32_16x16x32_bf16 v[180:183], v[224:227], v[20:23], v[180:183]
    v_lshlrev_b32_sdwa v214, 1, v214 dst_sel:DWORD dst_unused:UNUSED_PAD src0_sel:DWORD src1_sel:WORD_1
    v_dot2_f32_bf16 v99, v245, s87, v99
    v_mfma_f32_16x16x32_bf16 v[184:187], v[224:227], v[24:27], v[184:187]
    v_lshlrev_b32_sdwa v215, 1, v215 dst_sel:DWORD dst_unused:UNUSED_PAD src0_sel:DWORD src1_sel:WORD_1
    ds_read_u16_d16 v214, v214
    ds_read_u16_d16_hi v215, v215
    v_dot2_f32_bf16 v100, v246, s86, v100
    v_mfma_f32_16x16x32_bf16 v[188:191], v[224:227], v[28:31], v[188:191]

    s_cmp_ge_u32 s19, 11
    s_cbranch_scc1 L_rd11_go
    v_mov_b32 v224, 161976

    s_mov_b32 s29, 200000
L_rd11:
    ds_read_b32 v225, v224
    s_waitcnt lgkmcnt(0)
    v_cmp_le_u32 vcc, 11, v225
    s_cmp_eq_u64 vcc, exec
    s_cbranch_scc1 L_rd11_ok
    s_sleep 2
    s_sub_u32 s29, s29, 1
    s_cmp_lg_u32 s29, 0
    s_cbranch_scc1 L_rd11
L_rd11_ok:

    v_readfirstlane_b32 s19, v225
L_rd11_go:

    ds_read_b64_tr_b16 v[224:225], v255 offset:37888
    ds_read_b64_tr_b16 v[226:227], v255 offset:38656
    v_or_b32 v154, v200, v201
    v_lshlrev_b32_sdwa v216, 1, v216 dst_sel:DWORD dst_unused:UNUSED_PAD src0_sel:DWORD src1_sel:WORD_1
    v_dot2_f32_bf16 v101, v246, s87, v101
    v_mfma_f32_16x16x32_bf16 v[64:67], v[228:231], v[160:163], v[64:67]
    v_lshlrev_b32_sdwa v217, 1, v217 dst_sel:DWORD dst_unused:UNUSED_PAD src0_sel:DWORD src1_sel:WORD_1
    ds_read_u16_d16 v216, v216
    ds_read_u16_d16_hi v217, v217
    v_dot2_f32_bf16 v102, v247, s86, v102
    v_mfma_f32_16x16x32_bf16 v[88:91], v[228:231], v[164:167], v[88:91]
    v_or_b32 v155, v202, v203
    v_dot2_f32_bf16 v103, v247, s87, v103
    buffer_load_dwordx4 v[244:247], v252, s[4:7], s25 offen offset:192
    v_mfma_f32_16x16x32_bf16 v[112:115], v[228:231], v[168:171], v[112:115]
    v_lshlrev_b32_sdwa v218, 1, v218 dst_sel:DWORD dst_unused:UNUSED_PAD src0_sel:DWORD src1_sel:WORD_1
    v_mfma_f32_16x16x32_bf16 v[136:139], v[228:231], v[172:175], v[136:139]
    ds_read_b64_tr_b16 v[228:229], v254 offset:35840
    ds_read_b64_tr_b16 v[230:231], v254 offset:36096
    v_lshlrev_b32_sdwa v219, 1, v219 dst_sel:DWORD dst_unused:UNUSED_PAD src0_sel:DWORD src1_sel:WORD_1
    ds_read_u16_d16 v218, v218
    ds_read_u16_d16_hi v219, v219
    s_waitcnt lgkmcnt(14)
    v_mfma_f32_16x16x32_bf16 v[176:179], v[232:235], v[32:35], v[176:179]
    v_or_b32 v158, v204, v205
    v_mfma_f32_16x16x32_bf16 v[180:183], v[232:235], v[36:39], v[180:183]
    v_lshlrev_b32_sdwa v220, 1, v220 dst_sel:DWORD dst_unused:UNUSED_PAD src0_sel:DWORD src1_sel:WORD_1
    v_mfma_f32_16x16x32_bf16 v[184:187], v[232:235], v[40:43], v[184:187]
    v_lshlrev_b32_sdwa v221, 1, v221 dst_sel:DWORD dst_unused:UNUSED_PAD src0_sel:DWORD src1_sel:WORD_1
    ds_read_u16_d16 v220, v220
    ds_read_u16_d16_hi v221, v221
    v_mfma_f32_16x16x32_bf16 v[188:191], v[232:235], v[44:47], v[188:191]
    ds_read_b64_tr_b16 v[232:233], v255 offset:37896
    ds_read_b64_tr_b16 v[234:235], v255 offset:38664
    v_or_b32 v159, v206, v207
    v_mfma_f32_16x16x32_bf16 v[68:71], v[236:239], v[160:163], v[68:71]
    v_lshlrev_b32_sdwa v222, 1, v222 dst_sel:DWORD dst_unused:UNUSED_PAD src0_sel:DWORD src1_sel:WORD_1
    v_mfma_f32_16x16x32_bf16 v[92:95], v[236:239], v[164:167], v[92:95]
    v_lshlrev_b32_sdwa v223, 1, v223 dst_sel:DWORD dst_unused:UNUSED_PAD src0_sel:DWORD src1_sel:WORD_1
    ds_read_u16_d16 v222, v222
    ds_read_u16_d16_hi v223, v223
    v_mfma_f32_16x16x32_bf16 v[116:119], v[236:239], v[168:171], v[116:119]
    v_mfma_f32_16x16x32_bf16 v[140:143], v[236:239], v[172:175], v[140:143]
    ds_read_b64_tr_b16 v[236:237], v254 offset:36864
    ds_read_b64_tr_b16 v[238:239], v254 offset:37120
    s_waitcnt lgkmcnt(14)
    v_mfma_f32_16x16x32_bf16 v[192:195], v[240:243], v[0:3], 0
    v_or_b32 v160, v208, v209
    v_lshlrev_b32_sdwa v176, 1, v176 dst_sel:DWORD dst_unused:UNUSED_PAD src0_sel:DWORD src1_sel:WORD_1
    v_mfma_f32_16x16x32_bf16 v[196:199], v[240:243], v[4:7], 0
    v_lshlrev_b32_sdwa v177, 1, v177 dst_sel:DWORD dst_unused:UNUSED_PAD src0_sel:DWORD src1_sel:WORD_1
    ds_read_u16_d16 v176, v176
    ds_read_u16_d16_hi v177, v177
    v_mfma_f32_16x16x32_bf16 v[200:203], v[240:243], v[8:11], 0
    v_or_b32 v161, v210, v211
    v_mfma_f32_16x16x32_bf16 v[204:207], v[240:243], v[12:15], 0
    ds_read_b64_tr_b16 v[240:241], v255 offset:37952
    ds_read_b64_tr_b16 v[242:243], v255 offset:38720
    v_lshlrev_b32_sdwa v178, 1, v178 dst_sel:DWORD dst_unused:UNUSED_PAD src0_sel:DWORD src1_sel:WORD_1
    v_mfma_f32_16x16x32_bf16 v[48:51], v[224:227], v[144:147], v[48:51]
    v_lshlrev_b32_sdwa v179, 1, v179 dst_sel:DWORD dst_unused:UNUSED_PAD src0_sel:DWORD src1_sel:WORD_1
    ds_read_u16_d16 v178, v178
    ds_read_u16_d16_hi v179, v179
    v_mfma_f32_16x16x32_bf16 v[72:75], v[224:227], v[148:151], v[72:75]
    v_or_b32 v164, v212, v213
    v_mfma_f32_16x16x32_bf16 v[96:99], v[224:227], v[152:155], v[96:99]
    v_lshlrev_b32_sdwa v180, 1, v180 dst_sel:DWORD dst_unused:UNUSED_PAD src0_sel:DWORD src1_sel:WORD_1
    s_waitcnt vmcnt(1)
    v_dot2_f32_bf16 v112, v248, s86, v112
    v_mfma_f32_16x16x32_bf16 v[120:123], v[224:227], v[156:159], v[120:123]
    ds_read_b64_tr_b16 v[224:225], v254 offset:34824
    ds_read_b64_tr_b16 v[226:227], v254 offset:35080
    v_lshlrev_b32_sdwa v181, 1, v181 dst_sel:DWORD dst_unused:UNUSED_PAD src0_sel:DWORD src1_sel:WORD_1
    ds_read_u16_d16 v180, v180
    ds_read_u16_d16_hi v181, v181
    v_dot2_f32_bf16 v113, v248, s87, v113
    s_waitcnt lgkmcnt(14)
    v_mfma_f32_16x16x32_bf16 v[192:195], v[228:231], v[16:19], v[192:195]
    v_or_b32 v165, v214, v215
    v_dot2_f32_bf16 v114, v249, s86, v114
    v_mfma_f32_16x16x32_bf16 v[196:199], v[228:231], v[20:23], v[196:199]
    v_lshlrev_b32_sdwa v182, 1, v182 dst_sel:DWORD dst_unused:UNUSED_PAD src0_sel:DWORD src1_sel:WORD_1
    v_dot2_f32_bf16 v115, v249, s87, v115
    v_mfma_f32_16x16x32_bf16 v[200:203], v[228:231], v[24:27], v[200:203]
    v_lshlrev_b32_sdwa v183, 1, v183 dst_sel:DWORD dst_unused:UNUSED_PAD src0_sel:DWORD src1_sel:WORD_1
    ds_read_u16_d16 v182, v182
    ds_read_u16_d16_hi v183, v183
    v_dot2_f32_bf16 v116, v250, s86, v116
    v_mfma_f32_16x16x32_bf16 v[204:207], v[228:231], v[28:31], v[204:207]
    ds_read_b64_tr_b16 v[228:229], v255 offset:37960
    ds_read_b64_tr_b16 v[230:231], v255 offset:38728
    v_or_b32 v168, v216, v217
    v_lshlrev_b32_sdwa v184, 1, v184 dst_sel:DWORD dst_unused:UNUSED_PAD src0_sel:DWORD src1_sel:WORD_1
    v_dot2_f32_bf16 v117, v250, s87, v117
    v_mfma_f32_16x16x32_bf16 v[52:55], v[232:235], v[144:147], v[52:55]
    v_lshlrev_b32_sdwa v185, 1, v185 dst_sel:DWORD dst_unused:UNUSED_PAD src0_sel:DWORD src1_sel:WORD_1
    ds_read_u16_d16 v184, v184
    ds_read_u16_d16_hi v185, v185
    v_dot2_f32_bf16 v118, v251, s86, v118
    v_mfma_f32_16x16x32_bf16 v[76:79], v[232:235], v[148:151], v[76:79]
    v_or_b32 v169, v218, v219
    v_dot2_f32_bf16 v119, v251, s87, v119
    buffer_load_dwordx4 v[248:251], v252, s[4:7], s25 offen offset:320
    v_mfma_f32_16x16x32_bf16 v[100:103], v[232:235], v[152:155], v[100:103]
    v_lshlrev_b32_sdwa v186, 1, v186 dst_sel:DWORD dst_unused:UNUSED_PAD src0_sel:DWORD src1_sel:WORD_1
    v_mfma_f32_16x16x32_bf16 v[124:127], v[232:235], v[156:159], v[124:127]
    ds_read_b64_tr_b16 v[232:233], v254 offset:35848
    ds_read_b64_tr_b16 v[234:235], v254 offset:36104
    v_lshlrev_b32_sdwa v187, 1, v187 dst_sel:DWORD dst_unused:UNUSED_PAD src0_sel:DWORD src1_sel:WORD_1
    ds_read_u16_d16 v186, v186
    ds_read_u16_d16_hi v187, v187
    s_waitcnt lgkmcnt(14)
    v_mfma_f32_16x16x32_bf16 v[192:195], v[236:239], v[32:35], v[192:195]
    v_or_b32 v172, v220, v221
    v_mfma_f32_16x16x32_bf16 v[196:199], v[236:239], v[36:39], v[196:199]
    v_lshlrev_b32_sdwa v188, 1, v188 dst_sel:DWORD dst_unused:UNUSED_PAD src0_sel:DWORD src1_sel:WORD_1
    v_mfma_f32_16x16x32_bf16 v[200:203], v[236:239], v[40:43], v[200:203]
    v_lshlrev_b32_sdwa v189, 1, v189 dst_sel:DWORD dst_unused:UNUSED_PAD src0_sel:DWORD src1_sel:WORD_1
    ds_read_u16_d16 v188, v188
    ds_read_u16_d16_hi v189, v189
    v_mfma_f32_16x16x32_bf16 v[204:207], v[236:239], v[44:47], v[204:207]
    ds_read_b64_tr_b16 v[236:237], v255 offset:38016
    ds_read_b64_tr_b16 v[238:239], v255 offset:38784
    v_or_b32 v173, v222, v223
    v_mfma_f32_16x16x32_bf16 v[56:59], v[240:243], v[144:147], v[56:59]
    v_lshlrev_b32_sdwa v190, 1, v190 dst_sel:DWORD dst_unused:UNUSED_PAD src0_sel:DWORD src1_sel:WORD_1
    v_mfma_f32_16x16x32_bf16 v[80:83], v[240:243], v[148:151], v[80:83]
    v_lshlrev_b32_sdwa v191, 1, v191 dst_sel:DWORD dst_unused:UNUSED_PAD src0_sel:DWORD src1_sel:WORD_1
    ds_read_u16_d16 v190, v190
    ds_read_u16_d16_hi v191, v191
    v_mfma_f32_16x16x32_bf16 v[104:107], v[240:243], v[152:155], v[104:107]
    v_mfma_f32_16x16x32_bf16 v[128:131], v[240:243], v[156:159], v[128:131]
    ds_read_b64_tr_b16 v[240:241], v254 offset:36872
    ds_read_b64_tr_b16 v[242:243], v254 offset:37128
    s_waitcnt lgkmcnt(14)
    v_mfma_f32_16x16x32_bf16 v[208:211], v[224:227], v[0:3], 0
    v_or_b32 v162, v176, v177
    v_lshlrev_b32_sdwa v192, 1, v192 dst_sel:DWORD dst_unused:UNUSED_PAD src0_sel:DWORD src1_sel:WORD_1
    v_mfma_f32_16x16x32_bf16 v[212:215], v[224:227], v[4:7], 0
    v_lshlrev_b32_sdwa v193, 1, v193 dst_sel:DWORD dst_unused:UNUSED_PAD src0_sel:DWORD src1_sel:WORD_1
    ds_read_u16_d16 v192, v192
    ds_read_u16_d16_hi v193, v193
    v_mfma_f32_16x16x32_bf16 v[216:219], v[224:227], v[8:11], 0
    v_or_b32 v163, v178, v179
    v_mfma_f32_16x16x32_bf16 v[220:223], v[224:227], v[12:15], 0
    ds_read_b64_tr_b16 v[224:225], v255 offset:38024
    ds_read_b64_tr_b16 v[226:227], v255 offset:38792
    v_lshlrev_b32_sdwa v194, 1, v194 dst_sel:DWORD dst_unused:UNUSED_PAD src0_sel:DWORD src1_sel:WORD_1
    v_mfma_f32_16x16x32_bf16 v[60:63], v[228:231], v[144:147], v[60:63]
    v_lshlrev_b32_sdwa v195, 1, v195 dst_sel:DWORD dst_unused:UNUSED_PAD src0_sel:DWORD src1_sel:WORD_1
    ds_read_u16_d16 v194, v194
    ds_read_u16_d16_hi v195, v195
    v_mfma_f32_16x16x32_bf16 v[84:87], v[228:231], v[148:151], v[84:87]
    v_or_b32 v166, v180, v181
    v_mfma_f32_16x16x32_bf16 v[108:111], v[228:231], v[152:155], v[108:111]
    v_lshlrev_b32_sdwa v196, 1, v196 dst_sel:DWORD dst_unused:UNUSED_PAD src0_sel:DWORD src1_sel:WORD_1
    s_waitcnt vmcnt(1)
    v_dot2_f32_bf16 v120, v244, s86, v120
    v_mfma_f32_16x16x32_bf16 v[132:135], v[228:231], v[156:159], v[132:135]

    s_cmp_ge_u32 s19, 12
    s_cbranch_scc1 L_rd12_go
    v_mov_b32 v228, 161976

    s_mov_b32 s29, 200000
L_rd12:
    ds_read_b32 v229, v228
    s_waitcnt lgkmcnt(0)
    v_cmp_le_u32 vcc, 12, v229
    s_cmp_eq_u64 vcc, exec
    s_cbranch_scc1 L_rd12_ok
    s_sleep 2
    s_sub_u32 s29, s29, 1
    s_cmp_lg_u32 s29, 0
    s_cbranch_scc1 L_rd12
L_rd12_ok:

    v_readfirstlane_b32 s19, v229
L_rd12_go:

    ds_read_b64_tr_b16 v[228:229], v254 offset:40960
    ds_read_b64_tr_b16 v[230:231], v254 offset:41216
    v_lshlrev_b32_sdwa v197, 1, v197 dst_sel:DWORD dst_unused:UNUSED_PAD src0_sel:DWORD src1_sel:WORD_1
    ds_read_u16_d16 v196, v196
    ds_read_u16_d16_hi v197, v197
    v_dot2_f32_bf16 v121, v244, s87, v121
    s_waitcnt lgkmcnt(14)
    v_mfma_f32_16x16x32_bf16 v[208:211], v[232:235], v[16:19], v[208:211]
    v_or_b32 v167, v182, v183
    v_dot2_f32_bf16 v122, v245, s86, v122
    v_mfma_f32_16x16x32_bf16 v[212:215], v[232:235], v[20:23], v[212:215]
    v_lshlrev_b32_sdwa v198, 1, v198 dst_sel:DWORD dst_unused:UNUSED_PAD src0_sel:DWORD src1_sel:WORD_1
    v_dot2_f32_bf16 v123, v245, s87, v123
    v_mfma_f32_16x16x32_bf16 v[216:219], v[232:235], v[24:27], v[216:219]
    v_lshlrev_b32_sdwa v199, 1, v199 dst_sel:DWORD dst_unused:UNUSED_PAD src0_sel:DWORD src1_sel:WORD_1
    ds_read_u16_d16 v198, v198
    ds_read_u16_d16_hi v199, v199
    v_dot2_f32_bf16 v124, v246, s86, v124
    v_mfma_f32_16x16x32_bf16 v[220:223], v[232:235], v[28:31], v[220:223]

    s_cmp_ge_u32 s19, 13
    s_cbranch_scc1 L_rd13_go
    v_mov_b32 v232, 161976

    s_mov_b32 s29, 200000
L_rd13:
    ds_read_b32 v233, v232
    s_waitcnt lgkmcnt(0)
    v_cmp_le_u32 vcc, 13, v233
    s_cmp_eq_u64 vcc, exec
    s_cbranch_scc1 L_rd13_ok
    s_sleep 2
    s_sub_u32 s29, s29, 1
    s_cmp_lg_u32 s29, 0
    s_cbranch_scc1 L_rd13
L_rd13_ok:

    v_readfirstlane_b32 s19, v233
L_rd13_go:

    ds_read_b64_tr_b16 v[232:233], v255 offset:44032
    ds_read_b64_tr_b16 v[234:235], v255 offset:44800
    v_or_b32 v170, v184, v185
    v_lshlrev_b32_sdwa v200, 1, v200 dst_sel:DWORD dst_unused:UNUSED_PAD src0_sel:DWORD src1_sel:WORD_1
    v_dot2_f32_bf16 v125, v246, s87, v125
    v_mfma_f32_16x16x32_bf16 v[64:67], v[236:239], v[144:147], v[64:67]
    v_lshlrev_b32_sdwa v201, 1, v201 dst_sel:DWORD dst_unused:UNUSED_PAD src0_sel:DWORD src1_sel:WORD_1
    ds_read_u16_d16 v200, v200
    ds_read_u16_d16_hi v201, v201
    v_dot2_f32_bf16 v126, v247, s86, v126
    v_mfma_f32_16x16x32_bf16 v[88:91], v[236:239], v[148:151], v[88:91]
    v_or_b32 v171, v186, v187
    v_dot2_f32_bf16 v127, v247, s87, v127
    buffer_load_dwordx4 v[244:247], v252, s[4:7], s24 offen offset:64
    v_mfma_f32_16x16x32_bf16 v[112:115], v[236:239], v[152:155], v[112:115]
    v_lshlrev_b32_sdwa v202, 1, v202 dst_sel:DWORD dst_unused:UNUSED_PAD src0_sel:DWORD src1_sel:WORD_1
    v_mfma_f32_16x16x32_bf16 v[136:139], v[236:239], v[156:159], v[136:139]
    ds_read_b64_tr_b16 v[236:237], v254 offset:41984
    ds_read_b64_tr_b16 v[238:239], v254 offset:42240
    v_lshlrev_b32_sdwa v203, 1, v203 dst_sel:DWORD dst_unused:UNUSED_PAD src0_sel:DWORD src1_sel:WORD_1
    ds_read_u16_d16 v202, v202
    ds_read_u16_d16_hi v203, v203
    s_waitcnt lgkmcnt(14)
    v_mfma_f32_16x16x32_bf16 v[208:211], v[240:243], v[32:35], v[208:211]
    v_or_b32 v174, v188, v189
    v_mfma_f32_16x16x32_bf16 v[212:215], v[240:243], v[36:39], v[212:215]
    v_lshlrev_b32_sdwa v204, 1, v204 dst_sel:DWORD dst_unused:UNUSED_PAD src0_sel:DWORD src1_sel:WORD_1
    v_mfma_f32_16x16x32_bf16 v[216:219], v[240:243], v[40:43], v[216:219]
    v_lshlrev_b32_sdwa v205, 1, v205 dst_sel:DWORD dst_unused:UNUSED_PAD src0_sel:DWORD src1_sel:WORD_1
    ds_read_u16_d16 v204, v204
    ds_read_u16_d16_hi v205, v205
    v_mfma_f32_16x16x32_bf16 v[220:223], v[240:243], v[44:47], v[220:223]
    ds_read_b64_tr_b16 v[240:241], v255 offset:44040
    ds_read_b64_tr_b16 v[242:243], v255 offset:44808
    v_or_b32 v175, v190, v191
    v_mfma_f32_16x16x32_bf16 v[68:71], v[224:227], v[144:147], v[68:71]
    v_lshlrev_b32_sdwa v206, 1, v206 dst_sel:DWORD dst_unused:UNUSED_PAD src0_sel:DWORD src1_sel:WORD_1
    v_mfma_f32_16x16x32_bf16 v[92:95], v[224:227], v[148:151], v[92:95]
    v_lshlrev_b32_sdwa v207, 1, v207 dst_sel:DWORD dst_unused:UNUSED_PAD src0_sel:DWORD src1_sel:WORD_1
    ds_read_u16_d16 v206, v206
    ds_read_u16_d16_hi v207, v207
    v_mfma_f32_16x16x32_bf16 v[116:119], v[224:227], v[152:155], v[116:119]
    v_mfma_f32_16x16x32_bf16 v[140:143], v[224:227], v[156:159], v[140:143]
    ds_read_b64_tr_b16 v[224:225], v254 offset:43008
    ds_read_b64_tr_b16 v[226:227], v254 offset:43264
    s_waitcnt lgkmcnt(14)
    v_mfma_f32_16x16x32_bf16 v[176:179], v[228:231], v[0:3], 0
    v_or_b32 v144, v192, v193
    v_lshlrev_b32_sdwa v208, 1, v208 dst_sel:DWORD dst_unused:UNUSED_PAD src0_sel:DWORD src1_sel:WORD_1
    v_mfma_f32_16x16x32_bf16 v[180:183], v[228:231], v[4:7], 0
    v_lshlrev_b32_sdwa v209, 1, v209 dst_sel:DWORD dst_unused:UNUSED_PAD src0_sel:DWORD src1_sel:WORD_1
    ds_read_u16_d16 v208, v208
    ds_read_u16_d16_hi v209, v209
    v_mfma_f32_16x16x32_bf16 v[184:187], v[228:231], v[8:11], 0
    v_or_b32 v145, v194, v195
    v_mfma_f32_16x16x32_bf16 v[188:191], v[228:231], v[12:15], 0
    ds_read_b64_tr_b16 v[228:229], v255 offset:44096
    ds_read_b64_tr_b16 v[230:231], v255 offset:44864
    v_lshlrev_b32_sdwa v210, 1, v210 dst_sel:DWORD dst_unused:UNUSED_PAD src0_sel:DWORD src1_sel:WORD_1
    v_mfma_f32_16x16x32_bf16 v[48:51], v[232:235], v[160:163], v[48:51]
    v_lshlrev_b32_sdwa v211, 1, v211 dst_sel:DWORD dst_unused:UNUSED_PAD src0_sel:DWORD src1_sel:WORD_1
    ds_read_u16_d16 v210, v210
    ds_read_u16_d16_hi v211, v211
    v_mfma_f32_16x16x32_bf16 v[72:75], v[232:235], v[164:167], v[72:75]
    v_or_b32 v148, v196, v197
    v_mfma_f32_16x16x32_bf16 v[96:99], v[232:235], v[168:171], v[96:99]
    v_lshlrev_b32_sdwa v212, 1, v212 dst_sel:DWORD dst_unused:UNUSED_PAD src0_sel:DWORD src1_sel:WORD_1
    s_waitcnt vmcnt(1)
    v_dot2_f32_bf16 v136, v248, s86, v136
    v_mfma_f32_16x16x32_bf16 v[120:123], v[232:235], v[172:175], v[120:123]
    ds_read_b64_tr_b16 v[232:233], v254 offset:40968
    ds_read_b64_tr_b16 v[234:235], v254 offset:41224
    v_lshlrev_b32_sdwa v213, 1, v213 dst_sel:DWORD dst_unused:UNUSED_PAD src0_sel:DWORD src1_sel:WORD_1
    ds_read_u16_d16 v212, v212
    ds_read_u16_d16_hi v213, v213
    v_dot2_f32_bf16 v137, v248, s87, v137
    s_waitcnt lgkmcnt(14)
    v_mfma_f32_16x16x32_bf16 v[176:179], v[236:239], v[16:19], v[176:179]
    v_or_b32 v149, v198, v199
    v_dot2_f32_bf16 v138, v249, s86, v138
    v_mfma_f32_16x16x32_bf16 v[180:183], v[236:239], v[20:23], v[180:183]
    v_lshlrev_b32_sdwa v214, 1, v214 dst_sel:DWORD dst_unused:UNUSED_PAD src0_sel:DWORD src1_sel:WORD_1
    v_dot2_f32_bf16 v139, v249, s87, v139
    v_mfma_f32_16x16x32_bf16 v[184:187], v[236:239], v[24:27], v[184:187]
    v_lshlrev_b32_sdwa v215, 1, v215 dst_sel:DWORD dst_unused:UNUSED_PAD src0_sel:DWORD src1_sel:WORD_1
    ds_read_u16_d16 v214, v214
    ds_read_u16_d16_hi v215, v215
    v_dot2_f32_bf16 v140, v250, s86, v140
    v_mfma_f32_16x16x32_bf16 v[188:191], v[236:239], v[28:31], v[188:191]
    ds_read_b64_tr_b16 v[236:237], v255 offset:44104
    ds_read_b64_tr_b16 v[238:239], v255 offset:44872
    v_or_b32 v152, v200, v201
    v_lshlrev_b32_sdwa v216, 1, v216 dst_sel:DWORD dst_unused:UNUSED_PAD src0_sel:DWORD src1_sel:WORD_1
    v_dot2_f32_bf16 v141, v250, s87, v141
    v_mfma_f32_16x16x32_bf16 v[52:55], v[240:243], v[160:163], v[52:55]
    v_lshlrev_b32_sdwa v217, 1, v217 dst_sel:DWORD dst_unused:UNUSED_PAD src0_sel:DWORD src1_sel:WORD_1
    ds_read_u16_d16 v216, v216
    ds_read_u16_d16_hi v217, v217
    v_dot2_f32_bf16 v142, v251, s86, v142
    v_mfma_f32_16x16x32_bf16 v[76:79], v[240:243], v[164:167], v[76:79]
    v_or_b32 v153, v202, v203
    v_dot2_f32_bf16 v143, v251, s87, v143
    buffer_load_dwordx4 v[248:251], v252, s[4:7], s25 offen offset:64
    v_mfma_f32_16x16x32_bf16 v[100:103], v[240:243], v[168:171], v[100:103]
    v_lshlrev_b32_sdwa v218, 1, v218 dst_sel:DWORD dst_unused:UNUSED_PAD src0_sel:DWORD src1_sel:WORD_1
    v_mfma_f32_16x16x32_bf16 v[124:127], v[240:243], v[172:175], v[124:127]
    ds_read_b64_tr_b16 v[240:241], v254 offset:41992
    ds_read_b64_tr_b16 v[242:243], v254 offset:42248
    v_lshlrev_b32_sdwa v219, 1, v219 dst_sel:DWORD dst_unused:UNUSED_PAD src0_sel:DWORD src1_sel:WORD_1
    ds_read_u16_d16 v218, v218
    ds_read_u16_d16_hi v219, v219
    s_waitcnt lgkmcnt(14)
    v_mfma_f32_16x16x32_bf16 v[176:179], v[224:227], v[32:35], v[176:179]
    v_or_b32 v156, v204, v205
    v_mfma_f32_16x16x32_bf16 v[180:183], v[224:227], v[36:39], v[180:183]
    v_lshlrev_b32_sdwa v220, 1, v220 dst_sel:DWORD dst_unused:UNUSED_PAD src0_sel:DWORD src1_sel:WORD_1
    v_mfma_f32_16x16x32_bf16 v[184:187], v[224:227], v[40:43], v[184:187]
    v_lshlrev_b32_sdwa v221, 1, v221 dst_sel:DWORD dst_unused:UNUSED_PAD src0_sel:DWORD src1_sel:WORD_1
    ds_read_u16_d16 v220, v220
    ds_read_u16_d16_hi v221, v221
    v_mfma_f32_16x16x32_bf16 v[188:191], v[224:227], v[44:47], v[188:191]
    ds_read_b64_tr_b16 v[224:225], v255 offset:44160
    ds_read_b64_tr_b16 v[226:227], v255 offset:44928
    v_or_b32 v157, v206, v207
    v_mfma_f32_16x16x32_bf16 v[56:59], v[228:231], v[160:163], v[56:59]
    v_lshlrev_b32_sdwa v222, 1, v222 dst_sel:DWORD dst_unused:UNUSED_PAD src0_sel:DWORD src1_sel:WORD_1
    v_mfma_f32_16x16x32_bf16 v[80:83], v[228:231], v[164:167], v[80:83]
    v_lshlrev_b32_sdwa v223, 1, v223 dst_sel:DWORD dst_unused:UNUSED_PAD src0_sel:DWORD src1_sel:WORD_1
    ds_read_u16_d16 v222, v222
    ds_read_u16_d16_hi v223, v223
    v_mfma_f32_16x16x32_bf16 v[104:107], v[228:231], v[168:171], v[104:107]
    v_mfma_f32_16x16x32_bf16 v[128:131], v[228:231], v[172:175], v[128:131]
    ds_read_b64_tr_b16 v[228:229], v254 offset:43016
    ds_read_b64_tr_b16 v[230:231], v254 offset:43272
    s_waitcnt lgkmcnt(14)
    v_mfma_f32_16x16x32_bf16 v[192:195], v[232:235], v[0:3], 0
    v_or_b32 v146, v208, v209
    v_lshlrev_b32_sdwa v176, 1, v176 dst_sel:DWORD dst_unused:UNUSED_PAD src0_sel:DWORD src1_sel:WORD_1
    v_mfma_f32_16x16x32_bf16 v[196:199], v[232:235], v[4:7], 0
    v_lshlrev_b32_sdwa v177, 1, v177 dst_sel:DWORD dst_unused:UNUSED_PAD src0_sel:DWORD src1_sel:WORD_1
    ds_read_u16_d16 v176, v176
    ds_read_u16_d16_hi v177, v177
    v_mfma_f32_16x16x32_bf16 v[200:203], v[232:235], v[8:11], 0
    v_or_b32 v147, v210, v211
    v_mfma_f32_16x16x32_bf16 v[204:207], v[232:235], v[12:15], 0
    ds_read_b64_tr_b16 v[232:233], v255 offset:44168
    ds_read_b64_tr_b16 v[234:235], v255 offset:44936
    v_lshlrev_b32_sdwa v178, 1, v178 dst_sel:DWORD dst_unused:UNUSED_PAD src0_sel:DWORD src1_sel:WORD_1
    v_mfma_f32_16x16x32_bf16 v[60:63], v[236:239], v[160:163], v[60:63]
    v_lshlrev_b32_sdwa v179, 1, v179 dst_sel:DWORD dst_unused:UNUSED_PAD src0_sel:DWORD src1_sel:WORD_1
    ds_read_u16_d16 v178, v178
    ds_read_u16_d16_hi v179, v179
    v_mfma_f32_16x16x32_bf16 v[84:87], v[236:239], v[164:167], v[84:87]
    v_or_b32 v150, v212, v213
    v_mfma_f32_16x16x32_bf16 v[108:111], v[236:239], v[168:171], v[108:111]
    v_lshlrev_b32_sdwa v180, 1, v180 dst_sel:DWORD dst_unused:UNUSED_PAD src0_sel:DWORD src1_sel:WORD_1
    v_mfma_f32_16x16x32_bf16 v[132:135], v[236:239], v[172:175], v[132:135]

    s_cmp_ge_u32 s19, 14
    s_cbranch_scc1 L_rd14_go
    v_mov_b32 v236, 161976

    s_mov_b32 s29, 200000
L_rd14:
    ds_read_b32 v237, v236
    s_waitcnt lgkmcnt(0)
    v_cmp_le_u32 vcc, 14, v237
    s_cmp_eq_u64 vcc, exec
    s_cbranch_scc1 L_rd14_ok
    s_sleep 2
    s_sub_u32 s29, s29, 1
    s_cmp_lg_u32 s29, 0
    s_cbranch_scc1 L_rd14
L_rd14_ok:

    v_readfirstlane_b32 s19, v237
L_rd14_go:

    ds_read_b64_tr_b16 v[236:237], v254 offset:47104
    ds_read_b64_tr_b16 v[238:239], v254 offset:47360
    v_lshlrev_b32_sdwa v181, 1, v181 dst_sel:DWORD dst_unused:UNUSED_PAD src0_sel:DWORD src1_sel:WORD_1
    ds_read_u16_d16 v180, v180
    ds_read_u16_d16_hi v181, v181
    s_waitcnt lgkmcnt(14)
    v_mfma_f32_16x16x32_bf16 v[192:195], v[240:243], v[16:19], v[192:195]
    v_or_b32 v151, v214, v215
    v_mfma_f32_16x16x32_bf16 v[196:199], v[240:243], v[20:23], v[196:199]
    v_lshlrev_b32_sdwa v182, 1, v182 dst_sel:DWORD dst_unused:UNUSED_PAD src0_sel:DWORD src1_sel:WORD_1
    v_mfma_f32_16x16x32_bf16 v[200:203], v[240:243], v[24:27], v[200:203]
    v_lshlrev_b32_sdwa v183, 1, v183 dst_sel:DWORD dst_unused:UNUSED_PAD src0_sel:DWORD src1_sel:WORD_1
    ds_read_u16_d16 v182, v182
    ds_read_u16_d16_hi v183, v183
    v_mfma_f32_16x16x32_bf16 v[204:207], v[240:243], v[28:31], v[204:207]

    s_cmp_ge_u32 s19, 15
    s_cbranch_scc1 L_rd15_go
    v_mov_b32 v240, 161976

    s_mov_b32 s29, 200000
L_rd15:
    ds_read_b32 v241, v240
    s_waitcnt lgkmcnt(0)
    v_cmp_le_u32 vcc, 15, v241
    s_cmp_eq_u64 vcc, exec
    s_cbranch_scc1 L_rd15_ok
    s_sleep 2
    s_sub_u32 s29, s29, 1
    s_cmp_lg_u32 s29, 0
    s_cbranch_scc1 L_rd15
L_rd15_ok:

    v_readfirstlane_b32 s19, v241
L_rd15_go:

    ds_read_b64_tr_b16 v[240:241], v255 offset:50176
    ds_read_b64_tr_b16 v[242:243], v255 offset:50944
    v_or_b32 v154, v216, v217
    v_lshlrev_b32_sdwa v184, 1, v184 dst_sel:DWORD dst_unused:UNUSED_PAD src0_sel:DWORD src1_sel:WORD_1
    v_mfma_f32_16x16x32_bf16 v[64:67], v[224:227], v[160:163], v[64:67]
    v_lshlrev_b32_sdwa v185, 1, v185 dst_sel:DWORD dst_unused:UNUSED_PAD src0_sel:DWORD src1_sel:WORD_1
    ds_read_u16_d16 v184, v184
    ds_read_u16_d16_hi v185, v185
    v_mfma_f32_16x16x32_bf16 v[88:91], v[224:227], v[164:167], v[88:91]
    v_or_b32 v155, v218, v219
    v_mfma_f32_16x16x32_bf16 v[112:115], v[224:227], v[168:171], v[112:115]
    v_lshlrev_b32_sdwa v186, 1, v186 dst_sel:DWORD dst_unused:UNUSED_PAD src0_sel:DWORD src1_sel:WORD_1
    s_waitcnt vmcnt(1)
    v_dot2_f32_bf16 v56, v244, s86, v56
    v_mfma_f32_16x16x32_bf16 v[136:139], v[224:227], v[172:175], v[136:139]
    ds_read_b64_tr_b16 v[224:225], v254 offset:48128
    ds_read_b64_tr_b16 v[226:227], v254 offset:48384
    v_lshlrev_b32_sdwa v187, 1, v187 dst_sel:DWORD dst_unused:UNUSED_PAD src0_sel:DWORD src1_sel:WORD_1
    ds_read_u16_d16 v186, v186
    ds_read_u16_d16_hi v187, v187
    v_dot2_f32_bf16 v57, v244, s87, v57
    s_waitcnt lgkmcnt(14)
    v_mfma_f32_16x16x32_bf16 v[192:195], v[228:231], v[32:35], v[192:195]
    v_or_b32 v158, v220, v221
    v_dot2_f32_bf16 v58, v245, s86, v58
    v_mfma_f32_16x16x32_bf16 v[196:199], v[228:231], v[36:39], v[196:199]
    v_lshlrev_b32_sdwa v188, 1, v188 dst_sel:DWORD dst_unused:UNUSED_PAD src0_sel:DWORD src1_sel:WORD_1
    v_dot2_f32_bf16 v59, v245, s87, v59
    v_mfma_f32_16x16x32_bf16 v[200:203], v[228:231], v[40:43], v[200:203]
    v_lshlrev_b32_sdwa v189, 1, v189 dst_sel:DWORD dst_unused:UNUSED_PAD src0_sel:DWORD src1_sel:WORD_1
    ds_read_u16_d16 v188, v188
    ds_read_u16_d16_hi v189, v189
    v_dot2_f32_bf16 v60, v246, s86, v60
    v_mfma_f32_16x16x32_bf16 v[204:207], v[228:231], v[44:47], v[204:207]
    ds_read_b64_tr_b16 v[228:229], v255 offset:50184
    ds_read_b64_tr_b16 v[230:231], v255 offset:50952
    v_or_b32 v159, v222, v223
    v_dot2_f32_bf16 v61, v246, s87, v61
    v_mfma_f32_16x16x32_bf16 v[68:71], v[232:235], v[160:163], v[68:71]
    v_lshlrev_b32_sdwa v190, 1, v190 dst_sel:DWORD dst_unused:UNUSED_PAD src0_sel:DWORD src1_sel:WORD_1
    v_dot2_f32_bf16 v62, v247, s86, v62
    v_mfma_f32_16x16x32_bf16 v[92:95], v[232:235], v[164:167], v[92:95]
    v_lshlrev_b32_sdwa v191, 1, v191 dst_sel:DWORD dst_unused:UNUSED_PAD src0_sel:DWORD src1_sel:WORD_1
    ds_read_u16_d16 v190, v190
    ds_read_u16_d16_hi v191, v191
    v_dot2_f32_bf16 v63, v247, s87, v63
    buffer_load_dwordx4 v[244:247], v252, s[4:7], s24 offen offset:256
    v_mfma_f32_16x16x32_bf16 v[116:119], v[232:235], v[168:171], v[116:119]
    v_mfma_f32_16x16x32_bf16 v[140:143], v[232:235], v[172:175], v[140:143]
    ds_read_b64_tr_b16 v[232:233], v254 offset:49152
    ds_read_b64_tr_b16 v[234:235], v254 offset:49408
    s_waitcnt lgkmcnt(14)
    v_mfma_f32_16x16x32_bf16 v[208:211], v[236:239], v[0:3], 0
    v_or_b32 v160, v176, v177
    v_lshlrev_b32_sdwa v192, 1, v192 dst_sel:DWORD dst_unused:UNUSED_PAD src0_sel:DWORD src1_sel:WORD_1
    v_mfma_f32_16x16x32_bf16 v[212:215], v[236:239], v[4:7], 0
    v_lshlrev_b32_sdwa v193, 1, v193 dst_sel:DWORD dst_unused:UNUSED_PAD src0_sel:DWORD src1_sel:WORD_1
    ds_read_u16_d16 v192, v192
    ds_read_u16_d16_hi v193, v193
    v_mfma_f32_16x16x32_bf16 v[216:219], v[236:239], v[8:11], 0
    v_or_b32 v161, v178, v179
    v_mfma_f32_16x16x32_bf16 v[220:223], v[236:239], v[12:15], 0
    ds_read_b64_tr_b16 v[236:237], v255 offset:50240
    ds_read_b64_tr_b16 v[238:239], v255 offset:51008
    v_lshlrev_b32_sdwa v194, 1, v194 dst_sel:DWORD dst_unused:UNUSED_PAD src0_sel:DWORD src1_sel:WORD_1
    v_mfma_f32_16x16x32_bf16 v[48:51], v[240:243], v[144:147], v[48:51]
    v_lshlrev_b32_sdwa v195, 1, v195 dst_sel:DWORD dst_unused:UNUSED_PAD src0_sel:DWORD src1_sel:WORD_1
    ds_read_u16_d16 v194, v194
    ds_read_u16_d16_hi v195, v195
    v_mfma_f32_16x16x32_bf16 v[72:75], v[240:243], v[148:151], v[72:75]
    v_or_b32 v164, v180, v181
    v_mfma_f32_16x16x32_bf16 v[96:99], v[240:243], v[152:155], v[96:99]
    v_lshlrev_b32_sdwa v196, 1, v196 dst_sel:DWORD dst_unused:UNUSED_PAD src0_sel:DWORD src1_sel:WORD_1
    s_waitcnt vmcnt(1)
    v_dot2_f32_bf16 v104, v248, s86, v104
    v_mfma_f32_16x16x32_bf16 v[120:123], v[240:243], v[156:159], v[120:123]
    ds_read_b64_tr_b16 v[240:241], v254 offset:47112
    ds_read_b64_tr_b16 v[242:243], v254 offset:47368
    v_lshlrev_b32_sdwa v197, 1, v197 dst_sel:DWORD dst_unused:UNUSED_PAD src0_sel:DWORD src1_sel:WORD_1
    ds_read_u16_d16 v196, v196
    ds_read_u16_d16_hi v197, v197
    v_dot2_f32_bf16 v105, v248, s87, v105
    s_waitcnt lgkmcnt(14)
    v_mfma_f32_16x16x32_bf16 v[208:211], v[224:227], v[16:19], v[208:211]
    v_or_b32 v165, v182, v183
    v_dot2_f32_bf16 v106, v249, s86, v106
    v_mfma_f32_16x16x32_bf16 v[212:215], v[224:227], v[20:23], v[212:215]
    v_lshlrev_b32_sdwa v198, 1, v198 dst_sel:DWORD dst_unused:UNUSED_PAD src0_sel:DWORD src1_sel:WORD_1
    v_dot2_f32_bf16 v107, v249, s87, v107
    v_mfma_f32_16x16x32_bf16 v[216:219], v[224:227], v[24:27], v[216:219]
    v_lshlrev_b32_sdwa v199, 1, v199 dst_sel:DWORD dst_unused:UNUSED_PAD src0_sel:DWORD src1_sel:WORD_1
    ds_read_u16_d16 v198, v198
    ds_read_u16_d16_hi v199, v199
    v_dot2_f32_bf16 v108, v250, s86, v108
    v_mfma_f32_16x16x32_bf16 v[220:223], v[224:227], v[28:31], v[220:223]
    ds_read_b64_tr_b16 v[224:225], v255 offset:50248
    ds_read_b64_tr_b16 v[226:227], v255 offset:51016
    v_or_b32 v168, v184, v185
    v_lshlrev_b32_sdwa v200, 1, v200 dst_sel:DWORD dst_unused:UNUSED_PAD src0_sel:DWORD src1_sel:WORD_1
    v_dot2_f32_bf16 v109, v250, s87, v109
    v_mfma_f32_16x16x32_bf16 v[52:55], v[228:231], v[144:147], v[52:55]
    v_lshlrev_b32_sdwa v201, 1, v201 dst_sel:DWORD dst_unused:UNUSED_PAD src0_sel:DWORD src1_sel:WORD_1
    ds_read_u16_d16 v200, v200
    ds_read_u16_d16_hi v201, v201
    v_dot2_f32_bf16 v110, v251, s86, v110
    v_mfma_f32_16x16x32_bf16 v[76:79], v[228:231], v[148:151], v[76:79]
    v_or_b32 v169, v186, v187
    v_dot2_f32_bf16 v111, v251, s87, v111
    buffer_load_dwordx4 v[248:251], v252, s[4:7], s25 offen offset:256
    v_mfma_f32_16x16x32_bf16 v[100:103], v[228:231], v[152:155], v[100:103]
    v_lshlrev_b32_sdwa v202, 1, v202 dst_sel:DWORD dst_unused:UNUSED_PAD src0_sel:DWORD src1_sel:WORD_1
    v_mfma_f32_16x16x32_bf16 v[124:127], v[228:231], v[156:159], v[124:127]
    ds_read_b64_tr_b16 v[228:229], v254 offset:48136
    ds_read_b64_tr_b16 v[230:231], v254 offset:48392
    v_lshlrev_b32_sdwa v203, 1, v203 dst_sel:DWORD dst_unused:UNUSED_PAD src0_sel:DWORD src1_sel:WORD_1
    ds_read_u16_d16 v202, v202
    ds_read_u16_d16_hi v203, v203
    s_waitcnt lgkmcnt(14)
    v_mfma_f32_16x16x32_bf16 v[208:211], v[232:235], v[32:35], v[208:211]
    v_or_b32 v172, v188, v189
    v_mfma_f32_16x16x32_bf16 v[212:215], v[232:235], v[36:39], v[212:215]
    v_lshlrev_b32_sdwa v204, 1, v204 dst_sel:DWORD dst_unused:UNUSED_PAD src0_sel:DWORD src1_sel:WORD_1
    v_mfma_f32_16x16x32_bf16 v[216:219], v[232:235], v[40:43], v[216:219]
    v_lshlrev_b32_sdwa v205, 1, v205 dst_sel:DWORD dst_unused:UNUSED_PAD src0_sel:DWORD src1_sel:WORD_1
    ds_read_u16_d16 v204, v204
    ds_read_u16_d16_hi v205, v205
    v_mfma_f32_16x16x32_bf16 v[220:223], v[232:235], v[44:47], v[220:223]
    ds_read_b64_tr_b16 v[232:233], v255 offset:50304
    ds_read_b64_tr_b16 v[234:235], v255 offset:51072
    v_or_b32 v173, v190, v191
    v_mfma_f32_16x16x32_bf16 v[56:59], v[236:239], v[144:147], v[56:59]
    v_lshlrev_b32_sdwa v206, 1, v206 dst_sel:DWORD dst_unused:UNUSED_PAD src0_sel:DWORD src1_sel:WORD_1
    v_mfma_f32_16x16x32_bf16 v[80:83], v[236:239], v[148:151], v[80:83]
    v_lshlrev_b32_sdwa v207, 1, v207 dst_sel:DWORD dst_unused:UNUSED_PAD src0_sel:DWORD src1_sel:WORD_1
    ds_read_u16_d16 v206, v206
    ds_read_u16_d16_hi v207, v207
    v_mfma_f32_16x16x32_bf16 v[104:107], v[236:239], v[152:155], v[104:107]
    v_mfma_f32_16x16x32_bf16 v[128:131], v[236:239], v[156:159], v[128:131]
    ds_read_b64_tr_b16 v[236:237], v254 offset:49160
    ds_read_b64_tr_b16 v[238:239], v254 offset:49416
    s_waitcnt lgkmcnt(14)
    v_mfma_f32_16x16x32_bf16 v[176:179], v[240:243], v[0:3], 0
    v_or_b32 v162, v192, v193
    v_lshlrev_b32_sdwa v208, 1, v208 dst_sel:DWORD dst_unused:UNUSED_PAD src0_sel:DWORD src1_sel:WORD_1
    v_mfma_f32_16x16x32_bf16 v[180:183], v[240:243], v[4:7], 0
    v_lshlrev_b32_sdwa v209, 1, v209 dst_sel:DWORD dst_unused:UNUSED_PAD src0_sel:DWORD src1_sel:WORD_1
    ds_read_u16_d16 v208, v208
    ds_read_u16_d16_hi v209, v209
    v_mfma_f32_16x16x32_bf16 v[184:187], v[240:243], v[8:11], 0
    v_or_b32 v163, v194, v195
    v_mfma_f32_16x16x32_bf16 v[188:191], v[240:243], v[12:15], 0
    ds_read_b64_tr_b16 v[240:241], v255 offset:50312
    ds_read_b64_tr_b16 v[242:243], v255 offset:51080
    v_lshlrev_b32_sdwa v210, 1, v210 dst_sel:DWORD dst_unused:UNUSED_PAD src0_sel:DWORD src1_sel:WORD_1
    v_mfma_f32_16x16x32_bf16 v[60:63], v[224:227], v[144:147], v[60:63]
    v_lshlrev_b32_sdwa v211, 1, v211 dst_sel:DWORD dst_unused:UNUSED_PAD src0_sel:DWORD src1_sel:WORD_1
    ds_read_u16_d16 v210, v210
    ds_read_u16_d16_hi v211, v211
    v_mfma_f32_16x16x32_bf16 v[84:87], v[224:227], v[148:151], v[84:87]
    v_or_b32 v166, v196, v197
    v_mfma_f32_16x16x32_bf16 v[108:111], v[224:227], v[152:155], v[108:111]
    v_lshlrev_b32_sdwa v212, 1, v212 dst_sel:DWORD dst_unused:UNUSED_PAD src0_sel:DWORD src1_sel:WORD_1
    v_mfma_f32_16x16x32_bf16 v[132:135], v[224:227], v[156:159], v[132:135]

    s_cmp_ge_u32 s19, 16
    s_cbranch_scc1 L_rd16_go
    v_mov_b32 v224, 161976

    s_mov_b32 s29, 200000
L_rd16:
    ds_read_b32 v225, v224
    s_waitcnt lgkmcnt(0)
    v_cmp_le_u32 vcc, 16, v225
    s_cmp_eq_u64 vcc, exec
    s_cbranch_scc1 L_rd16_ok
    s_sleep 2
    s_sub_u32 s29, s29, 1
    s_cmp_lg_u32 s29, 0
    s_cbranch_scc1 L_rd16
L_rd16_ok:

    v_readfirstlane_b32 s19, v225
L_rd16_go:

    ds_read_b64_tr_b16 v[224:225], v254 offset:53248
    ds_read_b64_tr_b16 v[226:227], v254 offset:53504
    v_lshlrev_b32_sdwa v213, 1, v213 dst_sel:DWORD dst_unused:UNUSED_PAD src0_sel:DWORD src1_sel:WORD_1
    ds_read_u16_d16 v212, v212
    ds_read_u16_d16_hi v213, v213
    s_waitcnt lgkmcnt(14)
    v_mfma_f32_16x16x32_bf16 v[176:179], v[228:231], v[16:19], v[176:179]
    v_or_b32 v167, v198, v199
    v_mfma_f32_16x16x32_bf16 v[180:183], v[228:231], v[20:23], v[180:183]
    v_lshlrev_b32_sdwa v214, 1, v214 dst_sel:DWORD dst_unused:UNUSED_PAD src0_sel:DWORD src1_sel:WORD_1
    v_mfma_f32_16x16x32_bf16 v[184:187], v[228:231], v[24:27], v[184:187]
    v_lshlrev_b32_sdwa v215, 1, v215 dst_sel:DWORD dst_unused:UNUSED_PAD src0_sel:DWORD src1_sel:WORD_1
    ds_read_u16_d16 v214, v214
    ds_read_u16_d16_hi v215, v215
    v_mfma_f32_16x16x32_bf16 v[188:191], v[228:231], v[28:31], v[188:191]

    s_cmp_ge_u32 s19, 17
    s_cbranch_scc1 L_rd17_go
    v_mov_b32 v228, 161976

    s_mov_b32 s29, 200000
L_rd17:
    ds_read_b32 v229, v228
    s_waitcnt lgkmcnt(0)
    v_cmp_le_u32 vcc, 17, v229
    s_cmp_eq_u64 vcc, exec
    s_cbranch_scc1 L_rd17_ok
    s_sleep 2
    s_sub_u32 s29, s29, 1
    s_cmp_lg_u32 s29, 0
    s_cbranch_scc1 L_rd17
L_rd17_ok:

    v_readfirstlane_b32 s19, v229
L_rd17_go:

    ds_read_b64_tr_b16 v[228:229], v255 offset:56320
    ds_read_b64_tr_b16 v[230:231], v255 offset:57088
    v_or_b32 v170, v200, v201
    v_lshlrev_b32_sdwa v216, 1, v216 dst_sel:DWORD dst_unused:UNUSED_PAD src0_sel:DWORD src1_sel:WORD_1
    v_mfma_f32_16x16x32_bf16 v[64:67], v[232:235], v[144:147], v[64:67]
    v_lshlrev_b32_sdwa v217, 1, v217 dst_sel:DWORD dst_unused:UNUSED_PAD src0_sel:DWORD src1_sel:WORD_1
    ds_read_u16_d16 v216, v216
    ds_read_u16_d16_hi v217, v217
    v_mfma_f32_16x16x32_bf16 v[88:91], v[232:235], v[148:151], v[88:91]
    v_or_b32 v171, v202, v203
    v_mfma_f32_16x16x32_bf16 v[112:115], v[232:235], v[152:155], v[112:115]
    v_lshlrev_b32_sdwa v218, 1, v218 dst_sel:DWORD dst_unused:UNUSED_PAD src0_sel:DWORD src1_sel:WORD_1
    s_waitcnt vmcnt(1)
    v_dot2_f32_bf16 v80, v244, s86, v80
    v_mfma_f32_16x16x32_bf16 v[136:139], v[232:235], v[156:159], v[136:139]
    ds_read_b64_tr_b16 v[232:233], v254 offset:54272
    ds_read_b64_tr_b16 v[234:235], v254 offset:54528
    v_lshlrev_b32_sdwa v219, 1, v219 dst_sel:DWORD dst_unused:UNUSED_PAD src0_sel:DWORD src1_sel:WORD_1
    ds_read_u16_d16 v218, v218
    ds_read_u16_d16_hi v219, v219
    v_dot2_f32_bf16 v81, v244, s87, v81
    s_waitcnt lgkmcnt(14)
    v_mfma_f32_16x16x32_bf16 v[176:179], v[236:239], v[32:35], v[176:179]
    v_or_b32 v174, v204, v205
    v_dot2_f32_bf16 v82, v245, s86, v82
    v_mfma_f32_16x16x32_bf16 v[180:183], v[236:239], v[36:39], v[180:183]
    v_lshlrev_b32_sdwa v220, 1, v220 dst_sel:DWORD dst_unused:UNUSED_PAD src0_sel:DWORD src1_sel:WORD_1
    v_dot2_f32_bf16 v83, v245, s87, v83
    v_mfma_f32_16x16x32_bf16 v[184:187], v[236:239], v[40:43], v[184:187]
    v_lshlrev_b32_sdwa v221, 1, v221 dst_sel:DWORD dst_unused:UNUSED_PAD src0_sel:DWORD src1_sel:WORD_1
    ds_read_u16_d16 v220, v220
    ds_read_u16_d16_hi v221, v221
    v_dot2_f32_bf16 v84, v246, s86, v84
    v_mfma_f32_16x16x32_bf16 v[188:191], v[236:239], v[44:47], v[188:191]
    ds_read_b64_tr_b16 v[236:237], v255 offset:56328
    ds_read_b64_tr_b16 v[238:239], v255 offset:57096
    v_or_b32 v175, v206, v207
    v_dot2_f32_bf16 v85, v246, s87, v85
    v_mfma_f32_16x16x32_bf16 v[68:71], v[240:243], v[144:147], v[68:71]
    v_lshlrev_b32_sdwa v222, 1, v222 dst_sel:DWORD dst_unused:UNUSED_PAD src0_sel:DWORD src1_sel:WORD_1
    v_dot2_f32_bf16 v86, v247, s86, v86
    v_mfma_f32_16x16x32_bf16 v[92:95], v[240:243], v[148:151], v[92:95]
    v_lshlrev_b32_sdwa v223, 1, v223 dst_sel:DWORD dst_unused:UNUSED_PAD src0_sel:DWORD src1_sel:WORD_1
    ds_read_u16_d16 v222, v222
    ds_read_u16_d16_hi v223, v223
    v_dot2_f32_bf16 v87, v247, s87, v87
    v_mfma_f32_16x16x32_bf16 v[116:119], v[240:243], v[152:155], v[116:119]
    v_mfma_f32_16x16x32_bf16 v[140:143], v[240:243], v[156:159], v[140:143]
    ds_read_b64_tr_b16 v[240:241], v254 offset:55296
    ds_read_b64_tr_b16 v[242:243], v254 offset:55552
    s_waitcnt lgkmcnt(14)
    v_mfma_f32_16x16x32_bf16 v[192:195], v[224:227], v[0:3], 0
    v_or_b32 v144, v208, v209
    v_lshlrev_b32_sdwa v176, 1, v176 dst_sel:DWORD dst_unused:UNUSED_PAD src0_sel:DWORD src1_sel:WORD_1
    v_mfma_f32_16x16x32_bf16 v[196:199], v[224:227], v[4:7], 0
    v_lshlrev_b32_sdwa v177, 1, v177 dst_sel:DWORD dst_unused:UNUSED_PAD src0_sel:DWORD src1_sel:WORD_1
    ds_read_u16_d16 v176, v176
    ds_read_u16_d16_hi v177, v177
    v_mfma_f32_16x16x32_bf16 v[200:203], v[224:227], v[8:11], 0
    v_or_b32 v145, v210, v211
    v_mfma_f32_16x16x32_bf16 v[204:207], v[224:227], v[12:15], 0
    ds_read_b64_tr_b16 v[224:225], v255 offset:56384
    ds_read_b64_tr_b16 v[226:227], v255 offset:57152
    v_lshlrev_b32_sdwa v178, 1, v178 dst_sel:DWORD dst_unused:UNUSED_PAD src0_sel:DWORD src1_sel:WORD_1
    v_mfma_f32_16x16x32_bf16 v[48:51], v[228:231], v[160:163], v[48:51]
    v_lshlrev_b32_sdwa v179, 1, v179 dst_sel:DWORD dst_unused:UNUSED_PAD src0_sel:DWORD src1_sel:WORD_1
    ds_read_u16_d16 v178, v178
    ds_read_u16_d16_hi v179, v179
    v_mfma_f32_16x16x32_bf16 v[72:75], v[228:231], v[164:167], v[72:75]
    v_or_b32 v148, v212, v213
    v_mfma_f32_16x16x32_bf16 v[96:99], v[228:231], v[168:171], v[96:99]
    v_lshlrev_b32_sdwa v180, 1, v180 dst_sel:DWORD dst_unused:UNUSED_PAD src0_sel:DWORD src1_sel:WORD_1
    s_waitcnt vmcnt(0)
    v_dot2_f32_bf16 v128, v248, s86, v128
    v_mfma_f32_16x16x32_bf16 v[120:123], v[228:231], v[172:175], v[120:123]
    ds_read_b64_tr_b16 v[228:229], v254 offset:53256
    ds_read_b64_tr_b16 v[230:231], v254 offset:53512
    v_lshlrev_b32_sdwa v181, 1, v181 dst_sel:DWORD dst_unused:UNUSED_PAD src0_sel:DWORD src1_sel:WORD_1
    ds_read_u16_d16 v180, v180
    ds_read_u16_d16_hi v181, v181
    v_dot2_f32_bf16 v129, v248, s87, v129
    s_waitcnt lgkmcnt(14)
    v_mfma_f32_16x16x32_bf16 v[192:195], v[232:235], v[16:19], v[192:195]
    v_or_b32 v149, v214, v215
    v_dot2_f32_bf16 v130, v249, s86, v130
    v_mfma_f32_16x16x32_bf16 v[196:199], v[232:235], v[20:23], v[196:199]
    v_lshlrev_b32_sdwa v182, 1, v182 dst_sel:DWORD dst_unused:UNUSED_PAD src0_sel:DWORD src1_sel:WORD_1
    v_dot2_f32_bf16 v131, v249, s87, v131
    v_mfma_f32_16x16x32_bf16 v[200:203], v[232:235], v[24:27], v[200:203]
    v_lshlrev_b32_sdwa v183, 1, v183 dst_sel:DWORD dst_unused:UNUSED_PAD src0_sel:DWORD src1_sel:WORD_1
    ds_read_u16_d16 v182, v182
    ds_read_u16_d16_hi v183, v183
    v_dot2_f32_bf16 v132, v250, s86, v132
    v_mfma_f32_16x16x32_bf16 v[204:207], v[232:235], v[28:31], v[204:207]
    ds_read_b64_tr_b16 v[232:233], v255 offset:56392
    ds_read_b64_tr_b16 v[234:235], v255 offset:57160
    v_or_b32 v152, v216, v217
    v_lshlrev_b32_sdwa v184, 1, v184 dst_sel:DWORD dst_unused:UNUSED_PAD src0_sel:DWORD src1_sel:WORD_1
    v_dot2_f32_bf16 v133, v250, s87, v133
    v_mfma_f32_16x16x32_bf16 v[52:55], v[236:239], v[160:163], v[52:55]
    v_lshlrev_b32_sdwa v185, 1, v185 dst_sel:DWORD dst_unused:UNUSED_PAD src0_sel:DWORD src1_sel:WORD_1
    ds_read_u16_d16 v184, v184
    ds_read_u16_d16_hi v185, v185
    v_dot2_f32_bf16 v134, v251, s86, v134
    v_mfma_f32_16x16x32_bf16 v[76:79], v[236:239], v[164:167], v[76:79]
    v_or_b32 v153, v218, v219
    v_dot2_f32_bf16 v135, v251, s87, v135
    v_mfma_f32_16x16x32_bf16 v[100:103], v[236:239], v[168:171], v[100:103]
    v_lshlrev_b32_sdwa v186, 1, v186 dst_sel:DWORD dst_unused:UNUSED_PAD src0_sel:DWORD src1_sel:WORD_1
    v_mfma_f32_16x16x32_bf16 v[124:127], v[236:239], v[172:175], v[124:127]
    ds_read_b64_tr_b16 v[236:237], v254 offset:54280
    ds_read_b64_tr_b16 v[238:239], v254 offset:54536
    v_lshlrev_b32_sdwa v187, 1, v187 dst_sel:DWORD dst_unused:UNUSED_PAD src0_sel:DWORD src1_sel:WORD_1
    ds_read_u16_d16 v186, v186
    ds_read_u16_d16_hi v187, v187
    s_waitcnt lgkmcnt(14)
    v_mfma_f32_16x16x32_bf16 v[192:195], v[240:243], v[32:35], v[192:195]
    v_or_b32 v156, v220, v221
    v_mfma_f32_16x16x32_bf16 v[196:199], v[240:243], v[36:39], v[196:199]
    v_lshlrev_b32_sdwa v188, 1, v188 dst_sel:DWORD dst_unused:UNUSED_PAD src0_sel:DWORD src1_sel:WORD_1
    v_mfma_f32_16x16x32_bf16 v[200:203], v[240:243], v[40:43], v[200:203]
    v_lshlrev_b32_sdwa v189, 1, v189 dst_sel:DWORD dst_unused:UNUSED_PAD src0_sel:DWORD src1_sel:WORD_1
    ds_read_u16_d16 v188, v188
    ds_read_u16_d16_hi v189, v189
    v_mfma_f32_16x16x32_bf16 v[204:207], v[240:243], v[44:47], v[204:207]
    ds_read_b64_tr_b16 v[240:241], v255 offset:56448
    ds_read_b64_tr_b16 v[242:243], v255 offset:57216
    v_or_b32 v157, v222, v223
    v_mfma_f32_16x16x32_bf16 v[56:59], v[224:227], v[160:163], v[56:59]
    v_lshlrev_b32_sdwa v190, 1, v190 dst_sel:DWORD dst_unused:UNUSED_PAD src0_sel:DWORD src1_sel:WORD_1
    v_mfma_f32_16x16x32_bf16 v[80:83], v[224:227], v[164:167], v[80:83]
    v_lshlrev_b32_sdwa v191, 1, v191 dst_sel:DWORD dst_unused:UNUSED_PAD src0_sel:DWORD src1_sel:WORD_1
    ds_read_u16_d16 v190, v190
    ds_read_u16_d16_hi v191, v191
    v_mfma_f32_16x16x32_bf16 v[104:107], v[224:227], v[168:171], v[104:107]
    v_mfma_f32_16x16x32_bf16 v[128:131], v[224:227], v[172:175], v[128:131]
    ds_read_b64_tr_b16 v[224:225], v254 offset:55304
    ds_read_b64_tr_b16 v[226:227], v254 offset:55560
    s_waitcnt lgkmcnt(14)
    v_mfma_f32_16x16x32_bf16 v[208:211], v[228:231], v[0:3], 0
    v_or_b32 v146, v176, v177
    v_lshlrev_b32_sdwa v192, 1, v192 dst_sel:DWORD dst_unused:UNUSED_PAD src0_sel:DWORD src1_sel:WORD_1
    v_mfma_f32_16x16x32_bf16 v[212:215], v[228:231], v[4:7], 0
    v_lshlrev_b32_sdwa v193, 1, v193 dst_sel:DWORD dst_unused:UNUSED_PAD src0_sel:DWORD src1_sel:WORD_1
    ds_read_u16_d16 v192, v192
    ds_read_u16_d16_hi v193, v193
    v_mfma_f32_16x16x32_bf16 v[216:219], v[228:231], v[8:11], 0
    v_or_b32 v147, v178, v179
    v_mfma_f32_16x16x32_bf16 v[220:223], v[228:231], v[12:15], 0
    ds_read_b64_tr_b16 v[228:229], v255 offset:56456
    ds_read_b64_tr_b16 v[230:231], v255 offset:57224
    v_lshlrev_b32_sdwa v194, 1, v194 dst_sel:DWORD dst_unused:UNUSED_PAD src0_sel:DWORD src1_sel:WORD_1
    v_mfma_f32_16x16x32_bf16 v[60:63], v[232:235], v[160:163], v[60:63]
    v_lshlrev_b32_sdwa v195, 1, v195 dst_sel:DWORD dst_unused:UNUSED_PAD src0_sel:DWORD src1_sel:WORD_1
    ds_read_u16_d16 v194, v194
    ds_read_u16_d16_hi v195, v195
    v_mfma_f32_16x16x32_bf16 v[84:87], v[232:235], v[164:167], v[84:87]
    v_or_b32 v150, v180, v181
    v_mfma_f32_16x16x32_bf16 v[108:111], v[232:235], v[168:171], v[108:111]
    v_lshlrev_b32_sdwa v196, 1, v196 dst_sel:DWORD dst_unused:UNUSED_PAD src0_sel:DWORD src1_sel:WORD_1
    v_mfma_f32_16x16x32_bf16 v[132:135], v[232:235], v[172:175], v[132:135]

    s_cmp_ge_u32 s19, 18
    s_cbranch_scc1 L_rd18_go
    v_mov_b32 v232, 161976

    s_mov_b32 s29, 200000
L_rd18:
    ds_read_b32 v233, v232
    s_waitcnt lgkmcnt(0)
    v_cmp_le_u32 vcc, 18, v233
    s_cmp_eq_u64 vcc, exec
    s_cbranch_scc1 L_rd18_ok
    s_sleep 2
    s_sub_u32 s29, s29, 1
    s_cmp_lg_u32 s29, 0
    s_cbranch_scc1 L_rd18
L_rd18_ok:

    v_readfirstlane_b32 s19, v233
L_rd18_go:

    ds_read_b64_tr_b16 v[232:233], v255 offset:59392
    ds_read_b64_tr_b16 v[234:235], v255 offset:60160
    v_lshlrev_b32_sdwa v197, 1, v197 dst_sel:DWORD dst_unused:UNUSED_PAD src0_sel:DWORD src1_sel:WORD_1
    ds_read_u16_d16 v196, v196
    ds_read_u16_d16_hi v197, v197
    s_waitcnt lgkmcnt(14)
    v_mfma_f32_16x16x32_bf16 v[208:211], v[236:239], v[16:19], v[208:211]
    v_or_b32 v151, v182, v183
    v_mfma_f32_16x16x32_bf16 v[212:215], v[236:239], v[20:23], v[212:215]
    v_lshlrev_b32_sdwa v198, 1, v198 dst_sel:DWORD dst_unused:UNUSED_PAD src0_sel:DWORD src1_sel:WORD_1
    v_mfma_f32_16x16x32_bf16 v[216:219], v[236:239], v[24:27], v[216:219]
    v_lshlrev_b32_sdwa v199, 1, v199 dst_sel:DWORD dst_unused:UNUSED_PAD src0_sel:DWORD src1_sel:WORD_1
    ds_read_u16_d16 v198, v198
    ds_read_u16_d16_hi v199, v199
    v_mfma_f32_16x16x32_bf16 v[220:223], v[236:239], v[28:31], v[220:223]
    ds_read_b64_tr_b16 v[236:237], v255 offset:59400
    ds_read_b64_tr_b16 v[238:239], v255 offset:60168
    v_or_b32 v154, v184, v185
    v_lshlrev_b32_sdwa v200, 1, v200 dst_sel:DWORD dst_unused:UNUSED_PAD src0_sel:DWORD src1_sel:WORD_1
    v_mfma_f32_16x16x32_bf16 v[64:67], v[240:243], v[160:163], v[64:67]
    v_lshlrev_b32_sdwa v201, 1, v201 dst_sel:DWORD dst_unused:UNUSED_PAD src0_sel:DWORD src1_sel:WORD_1
    ds_read_u16_d16 v200, v200
    ds_read_u16_d16_hi v201, v201
    v_mfma_f32_16x16x32_bf16 v[88:91], v[240:243], v[164:167], v[88:91]
    v_or_b32 v155, v186, v187
    v_mfma_f32_16x16x32_bf16 v[112:115], v[240:243], v[168:171], v[112:115]
    v_lshlrev_b32_sdwa v202, 1, v202 dst_sel:DWORD dst_unused:UNUSED_PAD src0_sel:DWORD src1_sel:WORD_1
    v_mfma_f32_16x16x32_bf16 v[136:139], v[240:243], v[172:175], v[136:139]
    ds_read_b64_tr_b16 v[240:241], v255 offset:59456
    ds_read_b64_tr_b16 v[242:243], v255 offset:60224
    v_lshlrev_b32_sdwa v203, 1, v203 dst_sel:DWORD dst_unused:UNUSED_PAD src0_sel:DWORD src1_sel:WORD_1
    ds_read_u16_d16 v202, v202
    ds_read_u16_d16_hi v203, v203
    s_waitcnt lgkmcnt(14)
    v_mfma_f32_16x16x32_bf16 v[208:211], v[224:227], v[32:35], v[208:211]
    v_or_b32 v158, v188, v189
    v_mfma_f32_16x16x32_bf16 v[212:215], v[224:227], v[36:39], v[212:215]
    v_lshlrev_b32_sdwa v204, 1, v204 dst_sel:DWORD dst_unused:UNUSED_PAD src0_sel:DWORD src1_sel:WORD_1
    v_mfma_f32_16x16x32_bf16 v[216:219], v[224:227], v[40:43], v[216:219]
    v_lshlrev_b32_sdwa v205, 1, v205 dst_sel:DWORD dst_unused:UNUSED_PAD src0_sel:DWORD src1_sel:WORD_1
    ds_read_u16_d16 v204, v204
    ds_read_u16_d16_hi v205, v205
    v_mfma_f32_16x16x32_bf16 v[220:223], v[224:227], v[44:47], v[220:223]
    ds_read_b64_tr_b16 v[224:225], v255 offset:59464
    ds_read_b64_tr_b16 v[226:227], v255 offset:60232
    v_or_b32 v159, v190, v191
    v_mfma_f32_16x16x32_bf16 v[68:71], v[228:231], v[160:163], v[68:71]
    v_lshlrev_b32_sdwa v206, 1, v206 dst_sel:DWORD dst_unused:UNUSED_PAD src0_sel:DWORD src1_sel:WORD_1
    v_mfma_f32_16x16x32_bf16 v[92:95], v[228:231], v[164:167], v[92:95]
    v_lshlrev_b32_sdwa v207, 1, v207 dst_sel:DWORD dst_unused:UNUSED_PAD src0_sel:DWORD src1_sel:WORD_1
    ds_read_u16_d16 v206, v206
    ds_read_u16_d16_hi v207, v207
    v_mfma_f32_16x16x32_bf16 v[116:119], v[228:231], v[168:171], v[116:119]
    v_mfma_f32_16x16x32_bf16 v[140:143], v[228:231], v[172:175], v[140:143]
    ds_read_b64_tr_b16 v[228:229], v255 offset:59520
    ds_read_b64_tr_b16 v[230:231], v255 offset:60288
    s_waitcnt lgkmcnt(14)
    v_mfma_f32_16x16x32_bf16 v[48:51], v[232:235], v[144:147], v[48:51]
    v_or_b32 v160, v192, v193
    v_lshlrev_b32_sdwa v208, 1, v208 dst_sel:DWORD dst_unused:UNUSED_PAD src0_sel:DWORD src1_sel:WORD_1
    v_lshlrev_b32_sdwa v209, 1, v209 dst_sel:DWORD dst_unused:UNUSED_PAD src0_sel:DWORD src1_sel:WORD_1
    ds_read_u16_d16 v208, v208
    ds_read_u16_d16_hi v209, v209
    buffer_load_dwordx4 v[0:3], v253, s[12:15], s36 offen offset:0
    v_mfma_f32_16x16x32_bf16 v[72:75], v[232:235], v[148:151], v[72:75]
    v_or_b32 v161, v194, v195
    v_lshlrev_b32_sdwa v210, 1, v210 dst_sel:DWORD dst_unused:UNUSED_PAD src0_sel:DWORD src1_sel:WORD_1
    buffer_load_dwordx4 v[4:7], v253, s[12:15], s36 offen offset:1024
    v_mfma_f32_16x16x32_bf16 v[96:99], v[232:235], v[152:155], v[96:99]
    v_lshlrev_b32_sdwa v211, 1, v211 dst_sel:DWORD dst_unused:UNUSED_PAD src0_sel:DWORD src1_sel:WORD_1
    ds_read_u16_d16 v210, v210
    ds_read_u16_d16_hi v211, v211
    v_or_b32 v164, v196, v197
    v_lshlrev_b32_sdwa v212, 1, v212 dst_sel:DWORD dst_unused:UNUSED_PAD src0_sel:DWORD src1_sel:WORD_1
    buffer_load_dwordx4 v[8:11], v253, s[12:15], s36 offen offset:2048
    v_mfma_f32_16x16x32_bf16 v[120:123], v[232:235], v[156:159], v[120:123]
    ds_read_b64_tr_b16 v[232:233], v255 offset:59528
    ds_read_b64_tr_b16 v[234:235], v255 offset:60296
    v_lshlrev_b32_sdwa v213, 1, v213 dst_sel:DWORD dst_unused:UNUSED_PAD src0_sel:DWORD src1_sel:WORD_1
    ds_read_u16_d16 v212, v212
    ds_read_u16_d16_hi v213, v213
    v_or_b32 v165, v198, v199
    buffer_load_dwordx4 v[12:15], v253, s[12:15], s36 offen offset:3072
    v_mfma_f32_16x16x32_bf16 v[52:55], v[236:239], v[144:147], v[52:55]
    v_lshlrev_b32_sdwa v214, 1, v214 dst_sel:DWORD dst_unused:UNUSED_PAD src0_sel:DWORD src1_sel:WORD_1
    v_lshlrev_b32_sdwa v215, 1, v215 dst_sel:DWORD dst_unused:UNUSED_PAD src0_sel:DWORD src1_sel:WORD_1
    ds_read_u16_d16 v214, v214
    ds_read_u16_d16_hi v215, v215
    buffer_load_dwordx4 v[16:19], v253, s[12:15], s37 offen offset:0
    v_mfma_f32_16x16x32_bf16 v[76:79], v[236:239], v[148:151], v[76:79]
    s_waitcnt lgkmcnt(14)
    v_or_b32 v168, v200, v201
    v_lshlrev_b32_sdwa v216, 1, v216 dst_sel:DWORD dst_unused:UNUSED_PAD src0_sel:DWORD src1_sel:WORD_1
    v_lshlrev_b32_sdwa v217, 1, v217 dst_sel:DWORD dst_unused:UNUSED_PAD src0_sel:DWORD src1_sel:WORD_1
    ds_read_u16_d16 v216, v216
    ds_read_u16_d16_hi v217, v217
    buffer_load_dwordx4 v[20:23], v253, s[12:15], s37 offen offset:1024
    v_mfma_f32_16x16x32_bf16 v[100:103], v[236:239], v[152:155], v[100:103]
    v_or_b32 v169, v202, v203
    v_lshlrev_b32_sdwa v218, 1, v218 dst_sel:DWORD dst_unused:UNUSED_PAD src0_sel:DWORD src1_sel:WORD_1
    buffer_load_dwordx4 v[24:27], v253, s[12:15], s37 offen offset:2048
    v_mfma_f32_16x16x32_bf16 v[124:127], v[236:239], v[156:159], v[124:127]

    s_cmp_ge_u32 s19, 19
    s_cbranch_scc1 L_rd19_go
    v_mov_b32 v236, 161976

    s_mov_b32 s29, 200000
L_rd19:
    ds_read_b32 v237, v236
    s_waitcnt lgkmcnt(0)
    v_cmp_le_u32 vcc, 19, v237
    s_cmp_eq_u64 vcc, exec
    s_cbranch_scc1 L_rd19_ok
    s_sleep 2
    s_sub_u32 s29, s29, 1
    s_cmp_lg_u32 s29, 0
    s_cbranch_scc1 L_rd19
L_rd19_ok:

    v_readfirstlane_b32 s19, v237
L_rd19_go:

    ds_read_b64_tr_b16 v[236:237], v255 offset:62464
    ds_read_b64_tr_b16 v[238:239], v255 offset:63232
    v_lshlrev_b32_sdwa v219, 1, v219 dst_sel:DWORD dst_unused:UNUSED_PAD src0_sel:DWORD src1_sel:WORD_1
    ds_read_u16_d16 v218, v218
    ds_read_u16_d16_hi v219, v219
    v_or_b32 v172, v204, v205
    v_lshlrev_b32_sdwa v220, 1, v220 dst_sel:DWORD dst_unused:UNUSED_PAD src0_sel:DWORD src1_sel:WORD_1
    buffer_load_dwordx4 v[28:31], v253, s[12:15], s37 offen offset:3072
    v_mfma_f32_16x16x32_bf16 v[56:59], v[240:243], v[144:147], v[56:59]
    v_lshlrev_b32_sdwa v221, 1, v221 dst_sel:DWORD dst_unused:UNUSED_PAD src0_sel:DWORD src1_sel:WORD_1
    ds_read_u16_d16 v220, v220
    ds_read_u16_d16_hi v221, v221
    s_waitcnt lgkmcnt(14)
    v_or_b32 v173, v206, v207
    buffer_load_dwordx4 v[32:35], v253, s[12:15], s38 offen offset:0
    v_mfma_f32_16x16x32_bf16 v[80:83], v[240:243], v[148:151], v[80:83]
    v_lshlrev_b32_sdwa v222, 1, v222 dst_sel:DWORD dst_unused:UNUSED_PAD src0_sel:DWORD src1_sel:WORD_1
    v_lshlrev_b32_sdwa v223, 1, v223 dst_sel:DWORD dst_unused:UNUSED_PAD src0_sel:DWORD src1_sel:WORD_1
    ds_read_u16_d16 v222, v222
    ds_read_u16_d16_hi v223, v223
    buffer_load_dwordx4 v[36:39], v253, s[12:15], s38 offen offset:1024
    v_mfma_f32_16x16x32_bf16 v[104:107], v[240:243], v[152:155], v[104:107]
    buffer_load_dwordx4 v[40:43], v253, s[12:15], s38 offen offset:2048
    v_mfma_f32_16x16x32_bf16 v[128:131], v[240:243], v[156:159], v[128:131]
    ds_read_b64_tr_b16 v[240:241], v255 offset:62472
    ds_read_b64_tr_b16 v[242:243], v255 offset:63240
    buffer_load_dwordx4 v[44:47], v253, s[12:15], s38 offen offset:3072
    v_mfma_f32_16x16x32_bf16 v[60:63], v[224:227], v[144:147], v[60:63]
    v_or_b32 v162, v208, v209
    v_mfma_f32_16x16x32_bf16 v[84:87], v[224:227], v[148:151], v[84:87]
    v_or_b32 v163, v210, v211
    v_mfma_f32_16x16x32_bf16 v[108:111], v[224:227], v[152:155], v[108:111]
    s_waitcnt lgkmcnt(14)
    v_or_b32 v166, v212, v213
    v_mfma_f32_16x16x32_bf16 v[132:135], v[224:227], v[156:159], v[132:135]
    ds_read_b64_tr_b16 v[224:225], v255 offset:62528
    ds_read_b64_tr_b16 v[226:227], v255 offset:63296
    s_waitcnt lgkmcnt(14)
    v_or_b32 v167, v214, v215
    v_mfma_f32_16x16x32_bf16 v[64:67], v[228:231], v[144:147], v[64:67]
    v_mfma_f32_16x16x32_bf16 v[88:91], v[228:231], v[148:151], v[88:91]
    s_waitcnt lgkmcnt(12)
    v_or_b32 v170, v216, v217
    v_mfma_f32_16x16x32_bf16 v[112:115], v[228:231], v[152:155], v[112:115]
    s_waitcnt lgkmcnt(8)
    v_or_b32 v171, v218, v219
    v_mfma_f32_16x16x32_bf16 v[136:139], v[228:231], v[156:159], v[136:139]
    ds_read_b64_tr_b16 v[228:229], v255 offset:62536
    ds_read_b64_tr_b16 v[230:231], v255 offset:63304
    s_waitcnt lgkmcnt(8)
    v_or_b32 v174, v220, v221
    v_mfma_f32_16x16x32_bf16 v[68:71], v[232:235], v[144:147], v[68:71]
    s_waitcnt lgkmcnt(6)
    v_or_b32 v175, v222, v223
    v_mfma_f32_16x16x32_bf16 v[92:95], v[232:235], v[148:151], v[92:95]
    v_mfma_f32_16x16x32_bf16 v[116:119], v[232:235], v[152:155], v[116:119]
    v_mfma_f32_16x16x32_bf16 v[140:143], v[232:235], v[156:159], v[140:143]
    ds_read_b64_tr_b16 v[232:233], v255 offset:62592
    ds_read_b64_tr_b16 v[234:235], v255 offset:63360
    v_mfma_f32_16x16x32_bf16 v[48:51], v[236:239], v[160:163], v[48:51]
    v_mfma_f32_16x16x32_bf16 v[72:75], v[236:239], v[164:167], v[72:75]
    v_mfma_f32_16x16x32_bf16 v[96:99], v[236:239], v[168:171], v[96:99]
    v_mfma_f32_16x16x32_bf16 v[120:123], v[236:239], v[172:175], v[120:123]
    ds_read_b64_tr_b16 v[236:237], v255 offset:62600
    ds_read_b64_tr_b16 v[238:239], v255 offset:63368
    s_waitcnt lgkmcnt(8)
    v_mfma_f32_16x16x32_bf16 v[52:55], v[240:243], v[160:163], v[52:55]
    v_mfma_f32_16x16x32_bf16 v[76:79], v[240:243], v[164:167], v[76:79]
    v_mfma_f32_16x16x32_bf16 v[100:103], v[240:243], v[168:171], v[100:103]
    v_mfma_f32_16x16x32_bf16 v[124:127], v[240:243], v[172:175], v[124:127]
    s_waitcnt lgkmcnt(6)
    v_mfma_f32_16x16x32_bf16 v[56:59], v[224:227], v[160:163], v[56:59]
    v_mfma_f32_16x16x32_bf16 v[80:83], v[224:227], v[164:167], v[80:83]
    v_mfma_f32_16x16x32_bf16 v[104:107], v[224:227], v[168:171], v[104:107]
    v_mfma_f32_16x16x32_bf16 v[128:131], v[224:227], v[172:175], v[128:131]
    s_waitcnt lgkmcnt(4)
    v_mfma_f32_16x16x32_bf16 v[60:63], v[228:231], v[160:163], v[60:63]
    v_cvt_pk_bf16_f32 v48, v48, v49
    v_cvt_pk_bf16_f32 v49, v50, v51
    v_cvt_pk_bf16_f32 v50, v52, v53
    v_cvt_pk_bf16_f32 v51, v54, v55
    buffer_store_dwordx4 v[48:51], v252, s[8:11], s24 offen offset:0 sc1
    v_mfma_f32_16x16x32_bf16 v[84:87], v[228:231], v[164:167], v[84:87]
    v_cvt_pk_bf16_f32 v72, v72, v73
    v_cvt_pk_bf16_f32 v73, v74, v75
    v_cvt_pk_bf16_f32 v74, v76, v77
    v_cvt_pk_bf16_f32 v75, v78, v79
    buffer_store_dwordx4 v[72:75], v252, s[8:11], s24 offen offset:192 sc1
    v_mfma_f32_16x16x32_bf16 v[108:111], v[228:231], v[168:171], v[108:111]
    v_cvt_pk_bf16_f32 v96, v96, v97
    v_cvt_pk_bf16_f32 v97, v98, v99
    v_cvt_pk_bf16_f32 v98, v100, v101
    v_cvt_pk_bf16_f32 v99, v102, v103
    buffer_store_dwordx4 v[96:99], v252, s[8:11], s25 offen offset:0 sc1
    v_mfma_f32_16x16x32_bf16 v[132:135], v[228:231], v[172:175], v[132:135]
    v_cvt_pk_bf16_f32 v120, v120, v121
    v_cvt_pk_bf16_f32 v121, v122, v123
    v_cvt_pk_bf16_f32 v122, v124, v125
    v_cvt_pk_bf16_f32 v123, v126, v127
    buffer_store_dwordx4 v[120:123], v252, s[8:11], s25 offen offset:192 sc1
    s_waitcnt lgkmcnt(2)
    v_mfma_f32_16x16x32_bf16 v[64:67], v[232:235], v[160:163], v[64:67]
    v_mfma_f32_16x16x32_bf16 v[88:91], v[232:235], v[164:167], v[88:91]
    v_mfma_f32_16x16x32_bf16 v[112:115], v[232:235], v[168:171], v[112:115]
    v_mfma_f32_16x16x32_bf16 v[136:139], v[232:235], v[172:175], v[136:139]
    s_waitcnt lgkmcnt(0)
    v_mfma_f32_16x16x32_bf16 v[68:71], v[236:239], v[160:163], v[68:71]
    v_cvt_pk_bf16_f32 v56, v56, v57
    v_cvt_pk_bf16_f32 v57, v58, v59
    v_cvt_pk_bf16_f32 v58, v60, v61
    v_cvt_pk_bf16_f32 v59, v62, v63
    buffer_store_dwordx4 v[56:59], v252, s[8:11], s24 offen offset:64 sc1
    v_mfma_f32_16x16x32_bf16 v[92:95], v[236:239], v[164:167], v[92:95]
    v_cvt_pk_bf16_f32 v80, v80, v81
    v_cvt_pk_bf16_f32 v81, v82, v83
    v_cvt_pk_bf16_f32 v82, v84, v85
    v_cvt_pk_bf16_f32 v83, v86, v87
    buffer_store_dwordx4 v[80:83], v252, s[8:11], s24 offen offset:256 sc1
    v_mfma_f32_16x16x32_bf16 v[116:119], v[236:239], v[168:171], v[116:119]
    v_cvt_pk_bf16_f32 v104, v104, v105
    v_cvt_pk_bf16_f32 v105, v106, v107
    v_cvt_pk_bf16_f32 v106, v108, v109
    v_cvt_pk_bf16_f32 v107, v110, v111
    buffer_store_dwordx4 v[104:107], v252, s[8:11], s25 offen offset:64 sc1
    v_mfma_f32_16x16x32_bf16 v[140:143], v[236:239], v[172:175], v[140:143]
    v_cvt_pk_bf16_f32 v128, v128, v129
    v_cvt_pk_bf16_f32 v129, v130, v131
    v_cvt_pk_bf16_f32 v130, v132, v133
    v_cvt_pk_bf16_f32 v131, v134, v135
    buffer_store_dwordx4 v[128:131], v252, s[8:11], s25 offen offset:256 sc1
    s_nop 3
    v_cvt_pk_bf16_f32 v64, v64, v65
    v_cvt_pk_bf16_f32 v65, v66, v67
    v_cvt_pk_bf16_f32 v66, v68, v69
    v_cvt_pk_bf16_f32 v67, v70, v71
    buffer_store_dwordx4 v[64:67], v252, s[8:11], s24 offen offset:128 sc1
    v_cvt_pk_bf16_f32 v88, v88, v89
    v_cvt_pk_bf16_f32 v89, v90, v91
    v_cvt_pk_bf16_f32 v90, v92, v93
    v_cvt_pk_bf16_f32 v91, v94, v95
    buffer_store_dwordx4 v[88:91], v252, s[8:11], s24 offen offset:320 sc1
    v_cvt_pk_bf16_f32 v112, v112, v113
    v_cvt_pk_bf16_f32 v113, v114, v115
    v_cvt_pk_bf16_f32 v114, v116, v117
    v_cvt_pk_bf16_f32 v115, v118, v119
    buffer_store_dwordx4 v[112:115], v252, s[8:11], s25 offen offset:128 sc1
    v_cvt_pk_bf16_f32 v136, v136, v137
    v_cvt_pk_bf16_f32 v137, v138, v139
    v_cvt_pk_bf16_f32 v138, v140, v141
    v_cvt_pk_bf16_f32 v139, v142, v143
    buffer_store_dwordx4 v[136:139], v252, s[8:11], s25 offen offset:320 sc1

    s_cmp_lg_u32 s17, 0
    s_cbranch_scc1 L_end
    s_mov_b32 s17, 1
    s_sub_u32 s24, s24, 384
    s_sub_u32 s25, s25, 384
    s_mov_b32 s36, 1073741824
    s_mov_b32 s37, 1073741824
    s_mov_b32 s38, 1073741824
    s_branch L_mtile
L_end:
    s_endpgm

.section .rodata,"a"

.p2align 6
.amdhsa_kernel standalone__modern_conv_block_replknet__vision_kernel
.amdhsa_next_free_vgpr 256
.amdhsa_next_free_sgpr 100
.amdhsa_accum_offset 256
.amdhsa_group_segment_fixed_size 0
.amdhsa_kernarg_size 64
.amdhsa_user_sgpr_count 2
.amdhsa_user_sgpr_kernarg_segment_ptr 1
.amdhsa_system_sgpr_workgroup_id_x 1
.amdhsa_float_denorm_mode_32 3
.end_amdhsa_kernel
```

```asm
; @launch grid=(256,1,1) block=(512,1,1) lds=162064
.amdgcn_target "amdgcn-amd-amdhsa--gfx950"
.text

.globl standalone__modern_conv_block_replknet__vision_kernel
.p2align 8
.type standalone__modern_conv_block_replknet__vision_kernel,@function
standalone__modern_conv_block_replknet__vision_kernel:
    s_cmp_ge_u32 s2, 256
    s_cbranch_scc1 L_end
    s_load_dwordx8 s[64:71], s[0:1], 0
    s_load_dwordx4 s[72:75], s[0:1], 32

    s_setprio 3
    v_mov_b32 v14, v0
    v_lshrrev_b32 v1, 6, v0
    v_and_b32 v0, 63, v0
    v_mov_b32 v10, 1073741824
    v_readfirstlane_b32 s16, v1
    v_lshlrev_b32 v2, 2, v0
    v_add_u32 v2, 161808, v2
    v_add_u32 v3, -10, v0
    v_cmp_gt_u32 vcc, 10, v3
    v_cmp_eq_u32 s[56:57], 36, v0
    s_or_b64 vcc, vcc, s[56:57]
    v_cndmask_b32 v3, 0, 1, vcc
    v_lshlrev_b32 v253, 4, v0
    v_min_u32 v240, 1, v0
    ds_write_b32 v2, v3
    v_lshlrev_b32 v240, 2, v240
    s_and_b32 s26, s2, 3
    s_lshl_b32 s26, s26, 2
    s_bfe_u32 s27, s2, 0x20003
    s_add_u32 s26, s26, s27
    s_lshl_b32 s22, s26, 5
    s_bfe_u32 s26, s2, 0x10002
    s_lshl_b32 s26, s26, 3
    s_lshr_b32 s27, s2, 5
    s_add_u32 s26, s26, s27
    s_lshl_b32 s23, s26, 5
    v_mul_u32_u24 v12, 43, v0
    v_lshrrev_b32 v12, 9, v12
    v_mul_u32_u24 v13, 12, v12
    v_sub_u32 v13, v0, v13
    v_mul_u32_u24 v5, 98304, v12
    v_lshl_add_u32 v5, v13, 4, v5
    v_cmp_gt_u32 vcc, 48, v0
    v_cmp_gt_u32 s[58:59], 24, v0
    s_cmp_eq_u32 s22, 0
    s_cselect_b32 s80, 1073741824, 0
    v_cndmask_b32 v247, v10, v5, vcc
    s_mov_b32 s82, 3840
    s_cmp_eq_u32 s22, 480
    s_cselect_b32 s81, 1073741824, s82
    s_mov_b32 s18, s16
    v_add_u32 v15, -256, v14
    s_waitcnt lgkmcnt(0)
    s_barrier

    s_mov_b32 s4, s64
    s_and_b32 s5, s65, 0xffff
    s_mov_b32 s6, 50331648
    s_mov_b32 s7, 0x20000
    s_mov_b32 s48, s66
    s_and_b32 s49, s67, 0xffff
    s_mov_b32 s50, 1728
    s_mov_b32 s51, 0x20000
    s_mov_b32 s52, s68
    s_and_b32 s53, s69, 0xffff
    s_mov_b32 s54, 4800
    s_mov_b32 s55, 0x20000
    s_mov_b32 s40, s70
    s_and_b32 s41, s71, 0xffff
    s_mov_b32 s42, 73728
    s_mov_b32 s43, 0x20000
    s_mov_b32 s44, s72
    s_and_b32 s45, s73, 0xffff
    s_mov_b32 s46, 73728
    s_mov_b32 s47, 0x20000
    s_mov_b32 s8, s74
    s_and_b32 s9, s75, 0xffff
    s_mov_b32 s10, 50331648
    s_mov_b32 s11, 0x20000

    s_cmp_lg_u32 s16, 0
    s_cbranch_scc1 L_pb
    s_mov_b32 m0, 21504
    s_mov_b32 s26, 4096

    buffer_load_dwordx4 v253, s[52:55], 0 offen offset:0 lds
    buffer_load_dwordx4 v253, s[52:55], 0 offen offset:1024 lds
    buffer_load_dwordx4 v253, s[52:55], 0 offen offset:2048 lds
    buffer_load_dwordx4 v253, s[52:55], 0 offen offset:3072 lds
    s_mov_b32 m0, 25600
    s_nop 0
    buffer_load_dwordx4 v253, s[52:55], s26 offen lds
    s_mov_b32 m0, 26624
    s_nop 0
    buffer_load_dwordx4 v253, s[48:51], 0 offen offset:0 lds
    buffer_load_dwordx4 v253, s[48:51], 0 offen offset:1024 lds

    s_lshl_b32 s26, s18, 2
    s_add_u32 s26, s26, s23
    s_lshl_b32 s27, s26, 9
    s_add_u32 s27, s27, s22
    s_mul_i32 s27, s27, 192
    s_cmp_lt_u32 s26, 2
    s_cselect_b64 vcc, s[58:59], 0
    v_mov_b32 v248, 1073741824
    s_sub_u32 s28, s27, 196608
    v_add_u32 v255, s28, v247
    v_cndmask_b32 v248, v255, v248, vcc
    v_add_u32 v255, -384, v248

    buffer_load_dwordx4 v[48:51], v255, s[4:7], s80 offen offset:0 sc1
    buffer_load_dwordx4 v[52:55], v255, s[4:7], s80 offen offset:192 sc1
    buffer_load_dwordx4 v[56:59], v248, s[4:7], 0 offen offset:0 sc1
    buffer_load_dwordx4 v[60:63], v248, s[4:7], 0 offen offset:192 sc1
    buffer_load_dwordx4 v[64:67], v248, s[4:7], 0 offen offset:384 sc1
    buffer_load_dwordx4 v[68:71], v248, s[4:7], 0 offen offset:576 sc1
    buffer_load_dwordx4 v[72:75], v248, s[4:7], 0 offen offset:768 sc1
    buffer_load_dwordx4 v[76:79], v248, s[4:7], 0 offen offset:960 sc1
    buffer_load_dwordx4 v[80:83], v248, s[4:7], 0 offen offset:1152 sc1
    buffer_load_dwordx4 v[84:87], v248, s[4:7], 0 offen offset:1344 sc1
    buffer_load_dwordx4 v[88:91], v248, s[4:7], 0 offen offset:1536 sc1
    buffer_load_dwordx4 v[92:95], v248, s[4:7], 0 offen offset:1728 sc1
    buffer_load_dwordx4 v[96:99], v248, s[4:7], 0 offen offset:1920 sc1
    buffer_load_dwordx4 v[100:103], v248, s[4:7], 0 offen offset:2112 sc1
    buffer_load_dwordx4 v[104:107], v248, s[4:7], 0 offen offset:2304 sc1
    buffer_load_dwordx4 v[108:111], v248, s[4:7], 0 offen offset:2496 sc1
    buffer_load_dwordx4 v[112:115], v248, s[4:7], 0 offen offset:2688 sc1
    buffer_load_dwordx4 v[116:119], v248, s[4:7], 0 offen offset:2880 sc1
    buffer_load_dwordx4 v[120:123], v248, s[4:7], 0 offen offset:3072 sc1
    buffer_load_dwordx4 v[124:127], v248, s[4:7], 0 offen offset:3264 sc1
    buffer_load_dwordx4 v[128:131], v248, s[4:7], 0 offen offset:3456 sc1
    buffer_load_dwordx4 v[132:135], v248, s[4:7], 0 offen offset:3648 sc1
    buffer_load_dwordx4 v[136:139], v248, s[4:7], s82 offen offset:0 sc1
    buffer_load_dwordx4 v[140:143], v248, s[4:7], s82 offen offset:192 sc1
    buffer_load_dwordx4 v[144:147], v248, s[4:7], s82 offen offset:384 sc1
    buffer_load_dwordx4 v[148:151], v248, s[4:7], s82 offen offset:576 sc1
    buffer_load_dwordx4 v[152:155], v248, s[4:7], s82 offen offset:768 sc1
    buffer_load_dwordx4 v[156:159], v248, s[4:7], s82 offen offset:960 sc1
    buffer_load_dwordx4 v[160:163], v248, s[4:7], s82 offen offset:1152 sc1
    buffer_load_dwordx4 v[164:167], v248, s[4:7], s82 offen offset:1344 sc1
    buffer_load_dwordx4 v[168:171], v248, s[4:7], s82 offen offset:1536 sc1
    buffer_load_dwordx4 v[172:175], v248, s[4:7], s82 offen offset:1728 sc1
    buffer_load_dwordx4 v[176:179], v248, s[4:7], s82 offen offset:1920 sc1
    buffer_load_dwordx4 v[180:183], v248, s[4:7], s82 offen offset:2112 sc1
    buffer_load_dwordx4 v[184:187], v248, s[4:7], s81 offen offset:2304 sc1
    buffer_load_dwordx4 v[188:191], v248, s[4:7], s81 offen offset:2496 sc1

    v_mov_b32 v254, 161972
    v_mov_b32 v255, 1
    ds_write_b32 v254, v255
    s_waitcnt vmcnt(36)
    ds_write_b32 v254, v255 offset:12

L_pb:
    s_mov_b32 s20, 0x05040100
    s_mov_b32 s21, 0x07060302
    s_lshr_b32 s26, s2, 3
    s_mul_i32 s27, s26, 43
    s_lshr_b32 s27, s27, 9
    s_mul_i32 s27, s27, 12
    s_sub_u32 s39, s26, s27
    v_bfe_u32 v1, v0, 3, 1
    v_lshrrev_b32 v2, 5, v0
    v_bfe_u32 v3, v0, 4, 1
    v_bfe_u32 v4, v0, 2, 1
    v_sub_u32 v3, v3, v4
    v_and_b32 v4, 3, v0
    v_mul_u32_u24 v5, 65440, v1
    v_lshl_add_u32 v5, v4, 4, v5
    v_add_u32 v5, 50176, v5
    v_cmp_eq_u32 s[56:57], v1, v2
    v_add_u32 v6, 0, v3
    v_cmp_gt_u32 vcc, 5, v6
    v_lshl_add_u32 v7, v6, 6, v5
    s_and_b64 vcc, vcc, s[56:57]
    v_cndmask_b32 v241, v10, v7, vcc
    v_add_u32 v6, 2, v3
    v_lshl_add_u32 v7, v6, 6, v5
    v_cndmask_b32 v242, v10, v7, s[56:57]
    v_add_u32 v6, 4, v3
    v_cmp_gt_u32 vcc, 5, v6
    v_lshl_add_u32 v7, v6, 6, v5
    s_and_b64 vcc, vcc, s[56:57]
    v_cndmask_b32 v243, v10, v7, vcc
    v_mul_u32_u24 v2, 1168, v2
    v_and_b32 v3, 7, v0
    v_lshl_add_u32 v250, v3, 3, v2
    v_mul_u32_u24 v3, 768, v3
    v_mul_u32_u24 v4, 196608, v1
    v_add_u32 v3, v3, v4
    v_lshrrev_b32 v4, 4, v0
    v_lshl_add_u32 v252, v4, 4, v3

    v_bfe_u32 v3, v0, 4, 1
    v_mul_u32_u24 v3, 7104, v3
    v_add_u32 v250, v250, v3
    v_cmp_eq_u32 s[56:57], 1, v1
    v_and_b32 v5, 1, v12
    v_mul_u32_u24 v5, 7104, v5
    v_mul_u32_u24 v6, 584, v13
    v_add_u32 v249, v5, v6
    s_lshl_b32 s26, s16, 2
    s_add_u32 s26, s26, s23
    s_lshl_b32 s26, s26, 9
    s_add_u32 s26, s26, s22
    s_mul_i32 s36, s26, 192
    s_add_u32 s37, s36, 98304
    s_add_u32 s24, s36, 384
    s_add_u32 s25, s24, 98304
    s_cmp_lt_u32 s16, 1
    s_cbranch_scc1 L_perm
    s_cmp_lt_u32 s16, 4
    s_cbranch_scc1 L_xload

    v_mov_b32 v254, 161984

    s_mov_b32 s29, 200000
L_wraw:
    ds_read_b32 v255, v254
    s_waitcnt lgkmcnt(0)
    v_cmp_eq_u32 vcc, 1, v255
    s_cmp_eq_u64 vcc, exec
    s_cbranch_scc1 L_wraw_ok
    s_sleep 2
    s_sub_u32 s29, s29, 1
    s_cmp_lg_u32 s29, 0
    s_cbranch_scc1 L_wraw
L_wraw_ok:

    v_add_u32 v1, 0, v15
    v_mul_u32_u24 v128, 683, v1
    v_lshrrev_b32 v128, 16, v128
    v_mul_u32_u24 v129, 96, v128
    v_sub_u32 v129, v1, v129
    v_mul_u32_u24 v2, 960, v128
    v_lshl_add_u32 v2, v129, 1, v2
    v_add_u32 v1, -1, v128
    v_mul_u32_u24 v3, 576, v1
    v_lshl_add_u32 v3, v129, 1, v3
    v_cmp_gt_u32 vcc, 3, v1
    s_nop 1
    v_cndmask_b32 v3, v10, v3, vcc

    ds_read_u16 v132, v2 offset:21504
    ds_read_u16 v133, v2 offset:21696
    ds_read_u16 v134, v2 offset:21888
    ds_read_u16 v135, v2 offset:22080
    ds_read_u16 v136, v2 offset:22272
    ds_read_u16 v137, v3 offset:26624
    ds_read_u16 v138, v3 offset:26816
    ds_read_u16 v139, v3 offset:27008

    v_add_u32 v1, 256, v15
    v_mul_u32_u24 v144, 683, v1
    v_lshrrev_b32 v144, 16, v144
    v_mul_u32_u24 v145, 96, v144
    v_sub_u32 v145, v1, v145
    v_mul_u32_u24 v2, 960, v144
    v_lshl_add_u32 v2, v145, 1, v2
    v_add_u32 v1, -1, v144
    v_mul_u32_u24 v3, 576, v1
    v_lshl_add_u32 v3, v145, 1, v3
    v_cmp_gt_u32 vcc, 3, v1
    s_nop 1
    v_cndmask_b32 v3, v10, v3, vcc

    ds_read_u16 v148, v2 offset:21504
    ds_read_u16 v149, v2 offset:21696
    ds_read_u16 v150, v2 offset:21888
    ds_read_u16 v151, v2 offset:22080
    ds_read_u16 v152, v2 offset:22272
    ds_read_u16 v153, v3 offset:26624
    ds_read_u16 v154, v3 offset:26816
    ds_read_u16 v155, v3 offset:27008
    s_waitcnt lgkmcnt(0)
    v_lshlrev_b32 v132, 16, v132
    v_lshlrev_b32 v133, 16, v133
    v_lshlrev_b32 v134, 16, v134
    v_lshlrev_b32 v135, 16, v135
    v_lshlrev_b32 v136, 16, v136
    v_lshlrev_b32 v137, 16, v137
    v_lshlrev_b32 v138, 16, v138
    v_lshlrev_b32 v139, 16, v139

    v_add_f32 v133, v133, v137
    v_add_f32 v134, v134, v138
    v_add_f32 v135, v135, v139
    v_mov_b32 v1, 0
    v_cvt_pk_bf16_f32 v160, v132, v133
    v_cvt_pk_bf16_f32 v161, v134, v135
    v_cvt_pk_bf16_f32 v162, v136, v1
    v_mov_b32 v163, 0
    v_cvt_pk_bf16_f32 v164, v1, v132
    v_cvt_pk_bf16_f32 v165, v133, v134
    v_cvt_pk_bf16_f32 v166, v135, v136
    v_mov_b32 v167, 0
    v_mov_b32 v168, 0
    v_mov_b32 v169, v160
    v_mov_b32 v170, v161
    v_mov_b32 v171, v162
    v_mov_b32 v172, 0
    v_mov_b32 v173, v164
    v_mov_b32 v174, v165
    v_mov_b32 v175, v166
    v_lshrrev_b32 v2, 5, v129
    v_and_b32 v3, 15, v129
    v_lshl_add_u32 v2, v2, 4, v3
    v_mul_u32_u24 v2, 320, v2
    v_bfe_u32 v3, v129, 4, 1
    v_mul_u32_u24 v3, 65440, v3
    v_add_u32 v2, v2, v3
    v_lshl_add_u32 v2, v128, 6, v2
    v_add_u32 v2, 50176, v2
    v_cmp_gt_u32 vcc, 5, v128
    s_nop 1
    v_cndmask_b32 v2, v10, v2, vcc
    ds_write_b128 v2, v[160:163]
    ds_write_b128 v2, v[164:167] offset:16
    ds_write_b128 v2, v[168:171] offset:32
    ds_write_b128 v2, v[172:175] offset:48

    v_lshlrev_b32 v148, 16, v148
    v_lshlrev_b32 v149, 16, v149
    v_lshlrev_b32 v150, 16, v150
    v_lshlrev_b32 v151, 16, v151
    v_lshlrev_b32 v152, 16, v152
    v_lshlrev_b32 v153, 16, v153
    v_lshlrev_b32 v154, 16, v154
    v_lshlrev_b32 v155, 16, v155

    v_add_f32 v149, v149, v153
    v_add_f32 v150, v150, v154
    v_add_f32 v151, v151, v155
    v_mov_b32 v1, 0
    v_cvt_pk_bf16_f32 v176, v148, v149
    v_cvt_pk_bf16_f32 v177, v150, v151
    v_cvt_pk_bf16_f32 v178, v152, v1
    v_mov_b32 v179, 0
    v_cvt_pk_bf16_f32 v180, v1, v148
    v_cvt_pk_bf16_f32 v181, v149, v150
    v_cvt_pk_bf16_f32 v182, v151, v152
    v_mov_b32 v183, 0
    v_mov_b32 v184, 0
    v_mov_b32 v185, v176
    v_mov_b32 v186, v177
    v_mov_b32 v187, v178
    v_mov_b32 v188, 0
    v_mov_b32 v189, v180
    v_mov_b32 v190, v181
    v_mov_b32 v191, v182
    v_lshrrev_b32 v2, 5, v145
    v_and_b32 v3, 15, v145
    v_lshl_add_u32 v2, v2, 4, v3
    v_mul_u32_u24 v2, 320, v2
    v_bfe_u32 v3, v145, 4, 1
    v_mul_u32_u24 v3, 65440, v3
    v_add_u32 v2, v2, v3
    v_lshl_add_u32 v2, v144, 6, v2
    v_add_u32 v2, 50176, v2
    v_cmp_gt_u32 vcc, 5, v144
    s_nop 1
    v_cndmask_b32 v2, v10, v2, vcc
    ds_write_b128 v2, v[176:179]
    ds_write_b128 v2, v[180:183] offset:16
    ds_write_b128 v2, v[184:187] offset:32
    ds_write_b128 v2, v[188:191] offset:48

    v_mov_b32 v254, 161968
    v_mov_b32 v255, 1
    s_waitcnt lgkmcnt(0)
    s_mov_b64 exec, 1
    ds_add_u32 v254, v255
    s_mov_b64 exec, -1

    s_cmp_lt_u32 s16, 6
    s_cbranch_scc1 L_xload
L_tab:
    v_add_u32 v1, -384, v14
    v_lshlrev_b32 v2, 2, v1
    v_add_u32 v3, 65536, v2
    v_lshlrev_b32 v4, 17, v1
    v_or_b32 v4, 0x8000, v4
    v_cmp_gt_u32 vcc, 64, v1
    v_mov_b32 v5, 931135488
    v_mov_b32 v6, 939524096
    v_cndmask_b32 v5, v5, v6, vcc
    v_cndmask_b32 v6, 0, v6, vcc
    v_add_u32 v4, v4, v5
    s_mov_b32 s26, 0x3dd2d3e8
    v_mov_b32 v7, 0x40135761
    s_mov_b32 s27, 14
L_tabl:
    v_add_u32 v9, 0x10000, v4
    v_sub_f32 v8, v4, v6
    v_sub_f32 v9, v9, v6
    v_mul_f32 v10, v8, v8
    v_mul_f32 v11, v9, v9
    v_fma_f32 v10, v10, s26, v7
    v_fma_f32 v11, v11, s26, v7
    v_mul_f32 v10, v10, v8
    v_mul_f32 v11, v11, v9
    v_exp_f32 v10, -v10
    v_exp_f32 v11, -v11
    s_nop 0
    v_add_f32 v12, 1.0, v10
    v_add_f32 v13, 1.0, v11
    v_rcp_f32 v12, v12
    v_rcp_f32 v13, v13
    s_nop 0
    v_mul_f32 v8, v8, v12
    v_mul_f32 v9, v9, v13
    v_mul_f32 v10, -v8, v10
    v_mul_f32 v11, -v9, v11
    v_cvt_pk_bf16_f32 v12, v8, v9
    v_cvt_pk_bf16_f32 v13, v10, v11
    ds_write_b32 v2, v12
    ds_write_b32 v3, v13
    v_sub_u32 v4, v4, v5
    v_mov_b32 v5, 931135488
    v_mov_b32 v6, 0
    v_add_u32 v4, v4, v5
    v_add_u32 v4, 0x1000000, v4
    v_add_u32 v2, 512, v2
    v_add_u32 v3, 512, v3
    s_sub_u32 s27, s27, 1
    s_cmp_lg_u32 s27, 0
    s_cbranch_scc1 L_tabl

    v_mov_b32 v254, 161980
    v_mov_b32 v255, 1
    s_waitcnt lgkmcnt(0)
    s_mov_b64 exec, 1
    ds_add_u32 v254, v255
    s_mov_b64 exec, -1

L_xload:
    v_mov_b32 v254, 161972

    s_mov_b32 s29, 200000
L_wiss:
    ds_read_b32 v255, v254
    s_waitcnt lgkmcnt(0)
    v_cmp_eq_u32 vcc, s18, v255
    s_cmp_eq_u64 vcc, exec
    s_cbranch_scc1 L_wiss_ok
    s_sleep 2
    s_sub_u32 s29, s29, 1
    s_cmp_lg_u32 s29, 0
    s_cbranch_scc1 L_wiss
L_wiss_ok:

    s_lshl_b32 s26, s18, 2
    s_add_u32 s26, s26, s23
    s_lshl_b32 s27, s26, 9
    s_add_u32 s27, s27, s22
    s_mul_i32 s27, s27, 192
    s_cmp_lt_u32 s26, 2
    s_cselect_b64 vcc, s[58:59], 0
    v_mov_b32 v248, 1073741824
    s_sub_u32 s28, s27, 196608
    v_add_u32 v255, s28, v247
    v_cndmask_b32 v248, v255, v248, vcc
    v_add_u32 v255, -384, v248

    buffer_load_dwordx4 v[48:51], v255, s[4:7], s80 offen offset:0 sc1
    buffer_load_dwordx4 v[52:55], v255, s[4:7], s80 offen offset:192 sc1
    buffer_load_dwordx4 v[56:59], v248, s[4:7], 0 offen offset:0 sc1
    buffer_load_dwordx4 v[60:63], v248, s[4:7], 0 offen offset:192 sc1
    buffer_load_dwordx4 v[64:67], v248, s[4:7], 0 offen offset:384 sc1
    buffer_load_dwordx4 v[68:71], v248, s[4:7], 0 offen offset:576 sc1
    buffer_load_dwordx4 v[72:75], v248, s[4:7], 0 offen offset:768 sc1
    buffer_load_dwordx4 v[76:79], v248, s[4:7], 0 offen offset:960 sc1
    buffer_load_dwordx4 v[80:83], v248, s[4:7], 0 offen offset:1152 sc1
    buffer_load_dwordx4 v[84:87], v248, s[4:7], 0 offen offset:1344 sc1
    buffer_load_dwordx4 v[88:91], v248, s[4:7], 0 offen offset:1536 sc1
    buffer_load_dwordx4 v[92:95], v248, s[4:7], 0 offen offset:1728 sc1
    buffer_load_dwordx4 v[96:99], v248, s[4:7], 0 offen offset:1920 sc1
    buffer_load_dwordx4 v[100:103], v248, s[4:7], 0 offen offset:2112 sc1
    buffer_load_dwordx4 v[104:107], v248, s[4:7], 0 offen offset:2304 sc1
    buffer_load_dwordx4 v[108:111], v248, s[4:7], 0 offen offset:2496 sc1
    buffer_load_dwordx4 v[112:115], v248, s[4:7], 0 offen offset:2688 sc1
    buffer_load_dwordx4 v[116:119], v248, s[4:7], 0 offen offset:2880 sc1
    buffer_load_dwordx4 v[120:123], v248, s[4:7], 0 offen offset:3072 sc1
    buffer_load_dwordx4 v[124:127], v248, s[4:7], 0 offen offset:3264 sc1
    buffer_load_dwordx4 v[128:131], v248, s[4:7], 0 offen offset:3456 sc1
    buffer_load_dwordx4 v[132:135], v248, s[4:7], 0 offen offset:3648 sc1
    buffer_load_dwordx4 v[136:139], v248, s[4:7], s82 offen offset:0 sc1
    buffer_load_dwordx4 v[140:143], v248, s[4:7], s82 offen offset:192 sc1
    buffer_load_dwordx4 v[144:147], v248, s[4:7], s82 offen offset:384 sc1
    buffer_load_dwordx4 v[148:151], v248, s[4:7], s82 offen offset:576 sc1
    buffer_load_dwordx4 v[152:155], v248, s[4:7], s82 offen offset:768 sc1
    buffer_load_dwordx4 v[156:159], v248, s[4:7], s82 offen offset:960 sc1
    buffer_load_dwordx4 v[160:163], v248, s[4:7], s82 offen offset:1152 sc1
    buffer_load_dwordx4 v[164:167], v248, s[4:7], s82 offen offset:1344 sc1
    buffer_load_dwordx4 v[168:171], v248, s[4:7], s82 offen offset:1536 sc1
    buffer_load_dwordx4 v[172:175], v248, s[4:7], s82 offen offset:1728 sc1
    buffer_load_dwordx4 v[176:179], v248, s[4:7], s82 offen offset:1920 sc1
    buffer_load_dwordx4 v[180:183], v248, s[4:7], s82 offen offset:2112 sc1
    buffer_load_dwordx4 v[184:187], v248, s[4:7], s81 offen offset:2304 sc1
    buffer_load_dwordx4 v[188:191], v248, s[4:7], s81 offen offset:2496 sc1

    s_add_u32 s26, s18, 1
    v_mov_b32 v255, s26
    ds_write_b32 v254, v255

L_perm:
    s_mov_b32 exec_hi, 0x0000ffff
    s_waitcnt vmcnt(32)
    v_perm_b32 v192, v52, v48, s20
    v_perm_b32 v193, v60, v56, s20
    v_perm_b32 v194, v52, v48, s21
    v_perm_b32 v195, v60, v56, s21
    v_perm_b32 v196, v53, v49, s20
    v_perm_b32 v197, v61, v57, s20
    v_perm_b32 v198, v53, v49, s21
    v_perm_b32 v199, v61, v57, s21
    v_perm_b32 v200, v54, v50, s20
    v_perm_b32 v201, v62, v58, s20
    v_perm_b32 v202, v54, v50, s21
    v_perm_b32 v203, v62, v58, s21
    v_perm_b32 v204, v55, v51, s20
    v_perm_b32 v205, v63, v59, s20
    v_perm_b32 v206, v55, v51, s21
    v_perm_b32 v207, v63, v59, s21
    s_waitcnt vmcnt(28)
    v_perm_b32 v48, v68, v64, s20
    v_perm_b32 v49, v76, v72, s20
    v_perm_b32 v50, v68, v64, s21
    v_perm_b32 v51, v76, v72, s21
    v_perm_b32 v52, v69, v65, s20
    v_perm_b32 v53, v77, v73, s20
    v_perm_b32 v54, v69, v65, s21
    v_perm_b32 v55, v77, v73, s21
    v_perm_b32 v56, v70, v66, s20
    v_perm_b32 v57, v78, v74, s20
    v_perm_b32 v58, v70, v66, s21
    v_perm_b32 v59, v78, v74, s21
    v_perm_b32 v60, v71, v67, s20
    v_perm_b32 v61, v79, v75, s20
    v_perm_b32 v62, v71, v67, s21
    v_perm_b32 v63, v79, v75, s21
    s_waitcnt vmcnt(24)
    v_perm_b32 v64, v84, v80, s20
    v_perm_b32 v65, v92, v88, s20
    v_perm_b32 v66, v84, v80, s21
    v_perm_b32 v67, v92, v88, s21
    v_perm_b32 v68, v85, v81, s20
    v_perm_b32 v69, v93, v89, s20
    v_perm_b32 v70, v85, v81, s21
    v_perm_b32 v71, v93, v89, s21
    v_perm_b32 v72, v86, v82, s20
    v_perm_b32 v73, v94, v90, s20
    v_perm_b32 v74, v86, v82, s21
    v_perm_b32 v75, v94, v90, s21
    v_perm_b32 v76, v87, v83, s20
    v_perm_b32 v77, v95, v91, s20
    v_perm_b32 v78, v87, v83, s21
    v_perm_b32 v79, v95, v91, s21
    s_waitcnt vmcnt(20)
    v_perm_b32 v80, v100, v96, s20
    v_perm_b32 v81, v108, v104, s20
    v_perm_b32 v82, v100, v96, s21
    v_perm_b32 v83, v108, v104, s21
    v_perm_b32 v84, v101, v97, s20
    v_perm_b32 v85, v109, v105, s20
    v_perm_b32 v86, v101, v97, s21
    v_perm_b32 v87, v109, v105, s21
    v_perm_b32 v88, v102, v98, s20
    v_perm_b32 v89, v110, v106, s20
    v_perm_b32 v90, v102, v98, s21
    v_perm_b32 v91, v110, v106, s21
    v_perm_b32 v92, v103, v99, s20
    v_perm_b32 v93, v111, v107, s20
    v_perm_b32 v94, v103, v99, s21
    v_perm_b32 v95, v111, v107, s21
    s_waitcnt vmcnt(16)
    v_perm_b32 v96, v116, v112, s20
    v_perm_b32 v97, v124, v120, s20
    v_perm_b32 v98, v116, v112, s21
    v_perm_b32 v99, v124, v120, s21
    v_perm_b32 v100, v117, v113, s20
    v_perm_b32 v101, v125, v121, s20
    v_perm_b32 v102, v117, v113, s21
    v_perm_b32 v103, v125, v121, s21
    v_perm_b32 v104, v118, v114, s20
    v_perm_b32 v105, v126, v122, s20
    v_perm_b32 v106, v118, v114, s21
    v_perm_b32 v107, v126, v122, s21
    v_perm_b32 v108, v119, v115, s20
    v_perm_b32 v109, v127, v123, s20
    v_perm_b32 v110, v119, v115, s21
    v_perm_b32 v111, v127, v123, s21
    s_waitcnt vmcnt(12)
    v_perm_b32 v112, v132, v128, s20
    v_perm_b32 v113, v140, v136, s20
    v_perm_b32 v114, v132, v128, s21
    v_perm_b32 v115, v140, v136, s21
    v_perm_b32 v116, v133, v129, s20
    v_perm_b32 v117, v141, v137, s20
    v_perm_b32 v118, v133, v129, s21
    v_perm_b32 v119, v141, v137, s21
    v_perm_b32 v120, v134, v130, s20
    v_perm_b32 v121, v142, v138, s20
    v_perm_b32 v122, v134, v130, s21
    v_perm_b32 v123, v142, v138, s21
    v_perm_b32 v124, v135, v131, s20
    v_perm_b32 v125, v143, v139, s20
    v_perm_b32 v126, v135, v131, s21
    v_perm_b32 v127, v143, v139, s21
    s_waitcnt vmcnt(8)
    v_perm_b32 v128, v148, v144, s20
    v_perm_b32 v129, v156, v152, s20
    v_perm_b32 v130, v148, v144, s21
    v_perm_b32 v131, v156, v152, s21
    v_perm_b32 v132, v149, v145, s20
    v_perm_b32 v133, v157, v153, s20
    v_perm_b32 v134, v149, v145, s21
    v_perm_b32 v135, v157, v153, s21
    v_perm_b32 v136, v150, v146, s20
    v_perm_b32 v137, v158, v154, s20
    v_perm_b32 v138, v150, v146, s21
    v_perm_b32 v139, v158, v154, s21
    v_perm_b32 v140, v151, v147, s20
    v_perm_b32 v141, v159, v155, s20
    v_perm_b32 v142, v151, v147, s21
    v_perm_b32 v143, v159, v155, s21
    s_waitcnt vmcnt(4)
    v_perm_b32 v144, v164, v160, s20
    v_perm_b32 v145, v172, v168, s20
    v_perm_b32 v146, v164, v160, s21
    v_perm_b32 v147, v172, v168, s21
    v_perm_b32 v148, v165, v161, s20
    v_perm_b32 v149, v173, v169, s20
    v_perm_b32 v150, v165, v161, s21
    v_perm_b32 v151, v173, v169, s21
    v_perm_b32 v152, v166, v162, s20
    v_perm_b32 v153, v174, v170, s20
    v_perm_b32 v154, v166, v162, s21
    v_perm_b32 v155, v174, v170, s21
    v_perm_b32 v156, v167, v163, s20
    v_perm_b32 v157, v175, v171, s20
    v_perm_b32 v158, v167, v163, s21
    v_perm_b32 v159, v175, v171, s21
    s_waitcnt vmcnt(0)
    v_perm_b32 v160, v180, v176, s20
    v_perm_b32 v161, v188, v184, s20
    v_perm_b32 v162, v180, v176, s21
    v_perm_b32 v163, v188, v184, s21
    v_perm_b32 v164, v181, v177, s20
    v_perm_b32 v165, v189, v185, s20
    v_perm_b32 v166, v181, v177, s21
    v_perm_b32 v167, v189, v185, s21
    v_perm_b32 v168, v182, v178, s20
    v_perm_b32 v169, v190, v186, s20
    v_perm_b32 v170, v182, v178, s21
    v_perm_b32 v171, v190, v186, s21
    v_perm_b32 v172, v183, v179, s20
    v_perm_b32 v173, v191, v187, s20
    v_perm_b32 v174, v183, v179, s21
    v_perm_b32 v175, v191, v187, s21
    s_mov_b32 exec_hi, -1
    s_cmp_lg_u32 s18, 3
    s_cbranch_scc1 L_wt3_ok
    v_mov_b32 v254, 161968

    s_mov_b32 s29, 200000
L_wt3:
    ds_read_b32 v255, v254
    s_waitcnt lgkmcnt(0)
    v_cmp_eq_u32 vcc, 4, v255
    s_cmp_eq_u64 vcc, exec
    s_cbranch_scc1 L_wt3_ok
    s_sleep 2
    s_sub_u32 s29, s29, 1
    s_cmp_lg_u32 s29, 0
    s_cbranch_scc1 L_wt3
L_wt3_ok:

    s_lshl_b32 s26, s18, 3
    s_add_u32 s26, s26, 161852

    v_add_u32 v254, s26, v240

    s_mov_b32 s29, 200000
L_wslot:
    ds_read_b32 v255, v254
    s_waitcnt lgkmcnt(0)
    v_cmp_ne_u32 vcc, 0, v255
    s_cmp_eq_u64 vcc, exec
    s_cbranch_scc1 L_wslot_ok
    s_sleep 2
    s_sub_u32 s29, s29, 1
    s_cmp_lg_u32 s29, 0
    s_cbranch_scc1 L_wslot
L_wslot_ok:

    s_add_u32 s30, s18, 2
    s_and_b32 s30, s30, 3
    s_cmp_eq_u32 s30, 3
    s_mul_i32 s30, s30, 14336
    s_cselect_b32 s31, 72704, s30
    s_cselect_b32 s30, 124160, s30
    s_add_u32 s30, s30, 7168
    s_add_u32 s31, s31, 72832

    v_add_u32 v254, s30, v249
    v_add_u32 v255, s31, v249
    v_cndmask_b32 v254, v255, v254, s[58:59]
    s_mov_b32 exec_hi, 0x0000ffff

    ds_write_b64 v254, v[192:193] offset:0
    ds_write_b64 v254, v[194:195] offset:72
    ds_write_b64 v254, v[196:197] offset:144
    ds_write_b64 v254, v[198:199] offset:216
    ds_write_b64 v254, v[200:201] offset:288
    ds_write_b64 v254, v[202:203] offset:360
    ds_write_b64 v254, v[204:205] offset:432
    ds_write_b64 v254, v[206:207] offset:504
    ds_write_b64 v254, v[48:49] offset:8
    ds_write_b64 v254, v[50:51] offset:80
    ds_write_b64 v254, v[52:53] offset:152
    ds_write_b64 v254, v[54:55] offset:224
    ds_write_b64 v254, v[56:57] offset:296
    ds_write_b64 v254, v[58:59] offset:368
    ds_write_b64 v254, v[60:61] offset:440
    ds_write_b64 v254, v[62:63] offset:512
    ds_write_b64 v254, v[64:65] offset:16
    ds_write_b64 v254, v[66:67] offset:88
    ds_write_b64 v254, v[68:69] offset:160
    ds_write_b64 v254, v[70:71] offset:232
    ds_write_b64 v254, v[72:73] offset:304
    ds_write_b64 v254, v[74:75] offset:376
    ds_write_b64 v254, v[76:77] offset:448
    ds_write_b64 v254, v[78:79] offset:520
    ds_write_b64 v254, v[80:81] offset:24
    ds_write_b64 v254, v[82:83] offset:96
    ds_write_b64 v254, v[84:85] offset:168
    ds_write_b64 v254, v[86:87] offset:240
    ds_write_b64 v254, v[88:89] offset:312
    ds_write_b64 v254, v[90:91] offset:384
    ds_write_b64 v254, v[92:93] offset:456
    ds_write_b64 v254, v[94:95] offset:528
    ds_write_b64 v254, v[96:97] offset:32
    ds_write_b64 v254, v[98:99] offset:104
    ds_write_b64 v254, v[100:101] offset:176
    ds_write_b64 v254, v[102:103] offset:248
    ds_write_b64 v254, v[104:105] offset:320
    ds_write_b64 v254, v[106:107] offset:392
    ds_write_b64 v254, v[108:109] offset:464
    ds_write_b64 v254, v[110:111] offset:536
    ds_write_b64 v254, v[112:113] offset:40
    ds_write_b64 v254, v[114:115] offset:112
    ds_write_b64 v254, v[116:117] offset:184
    ds_write_b64 v254, v[118:119] offset:256
    ds_write_b64 v254, v[120:121] offset:328
    ds_write_b64 v254, v[122:123] offset:400
    ds_write_b64 v254, v[124:125] offset:472
    ds_write_b64 v254, v[126:127] offset:544
    ds_write_b64 v254, v[128:129] offset:48
    ds_write_b64 v254, v[130:131] offset:120
    ds_write_b64 v254, v[132:133] offset:192
    ds_write_b64 v254, v[134:135] offset:264
    ds_write_b64 v254, v[136:137] offset:336
    ds_write_b64 v254, v[138:139] offset:408
    ds_write_b64 v254, v[140:141] offset:480
    ds_write_b64 v254, v[142:143] offset:552
    ds_write_b64 v254, v[144:145] offset:56
    ds_write_b64 v254, v[146:147] offset:128
    ds_write_b64 v254, v[148:149] offset:200
    ds_write_b64 v254, v[150:151] offset:272
    ds_write_b64 v254, v[152:153] offset:344
    ds_write_b64 v254, v[154:155] offset:416
    ds_write_b64 v254, v[156:157] offset:488
    ds_write_b64 v254, v[158:159] offset:560
    ds_write_b64 v254, v[160:161] offset:64
    ds_write_b64 v254, v[162:163] offset:136
    ds_write_b64 v254, v[164:165] offset:208
    ds_write_b64 v254, v[166:167] offset:280
    ds_write_b64 v254, v[168:169] offset:352
    ds_write_b64 v254, v[170:171] offset:424
    ds_write_b64 v254, v[172:173] offset:496
    ds_write_b64 v254, v[174:175] offset:568

    s_mov_b32 exec_hi, -1
    s_lshl_b32 s26, s18, 2
    s_add_u32 s26, s26, 161808
    v_mov_b32 v254, s26
    v_mov_b32 v255, 1
    s_waitcnt lgkmcnt(0)
    ds_write_b32 v254, v255
    s_cmp_eq_u32 s18, 8
    s_cbranch_scc1 L_loader

    s_setprio 2
    s_add_u32 s27, s18, 1

    s_add_u32 s32, s27, 2
    s_and_b32 s32, s32, 3
    s_cmp_eq_u32 s32, 3
    s_mul_i32 s32, s32, 14336
    s_cselect_b32 s33, 72704, s32
    s_cselect_b32 s32, 124160, s32
    s_add_u32 s32, s32, 7168
    s_add_u32 s33, s33, 72832

    v_add_u32 v232, s30, v250
    v_add_u32 v233, s31, v250
    v_add_u32 v234, s32, v250
    v_add_u32 v235, s33, v250
    v_cndmask_b32 v244, v232, v233, s[56:57]
    v_cndmask_b32 v245, v233, v234, s[56:57]
    v_cndmask_b32 v246, v234, v235, s[56:57]
    v_mov_b32 v254, 161968

    s_mov_b32 s29, 200000
L_wt:
    ds_read_b32 v255, v254
    s_waitcnt lgkmcnt(0)
    v_cmp_eq_u32 vcc, 4, v255
    s_cmp_eq_u64 vcc, exec
    s_cbranch_scc1 L_wt_ok
    s_sleep 2
    s_sub_u32 s29, s29, 1
    s_cmp_lg_u32 s29, 0
    s_cbranch_scc1 L_wt
L_wt_ok:

    ds_read_b128 v[192:195], v241 offset:0
    ds_read_b64 v[212:213], v244 offset:0
    ds_read_b64 v[214:215], v244 offset:8
    ds_read_b128 v[196:199], v241 offset:320
    ds_read_b64 v[216:217], v244 offset:72
    ds_read_b64 v[218:219], v244 offset:80
    ds_read_b128 v[200:203], v241 offset:640
    ds_read_b64 v[220:221], v244 offset:144
    ds_read_b64 v[222:223], v244 offset:152
    ds_read_b128 v[204:207], v241 offset:960
    ds_read_b64 v[224:225], v244 offset:216
    ds_read_b64 v[226:227], v244 offset:224
    ds_read_b128 v[208:211], v241 offset:1280
    ds_read_b64 v[228:229], v244 offset:288
    ds_read_b64 v[230:231], v244 offset:296
    s_waitcnt lgkmcnt(9)
    v_mfma_f32_16x16x32_bf16 v[0:3], v[192:195], v[212:215], 0
    ds_read_b128 v[192:195], v241 offset:1600
    ds_read_b64 v[212:213], v244 offset:360
    ds_read_b64 v[214:215], v244 offset:368
    v_mfma_f32_16x16x32_bf16 v[4:7], v[196:199], v[216:219], 0
    ds_read_b128 v[196:199], v241 offset:1920
    ds_read_b64 v[216:217], v244 offset:432
    ds_read_b64 v[218:219], v244 offset:440
    s_waitcnt lgkmcnt(9)
    v_mfma_f32_16x16x32_bf16 v[8:11], v[200:203], v[220:223], 0
    ds_read_b128 v[200:203], v241 offset:2240
    ds_read_b64 v[220:221], v244 offset:504
    ds_read_b64 v[222:223], v244 offset:512
    v_mfma_f32_16x16x32_bf16 v[12:15], v[204:207], v[224:227], 0
    ds_read_b128 v[204:207], v241 offset:2560
    ds_read_b64 v[224:225], v244 offset:584
    ds_read_b64 v[226:227], v244 offset:592
    s_waitcnt lgkmcnt(9)
    v_mfma_f32_16x16x32_bf16 v[16:19], v[208:211], v[228:231], 0
    ds_read_b128 v[208:211], v241 offset:2880
    ds_read_b64 v[228:229], v244 offset:656
    ds_read_b64 v[230:231], v244 offset:664
    v_mfma_f32_16x16x32_bf16 v[20:23], v[192:195], v[212:215], 0
    ds_read_b128 v[192:195], v241 offset:3200
    ds_read_b64 v[212:213], v244 offset:728
    ds_read_b64 v[214:215], v244 offset:736
    s_waitcnt lgkmcnt(9)
    v_mfma_f32_16x16x32_bf16 v[24:27], v[196:199], v[216:219], 0
    ds_read_b128 v[196:199], v241 offset:3520
    ds_read_b64 v[216:217], v244 offset:800
    ds_read_b64 v[218:219], v244 offset:808
    v_mfma_f32_16x16x32_bf16 v[28:31], v[200:203], v[220:223], 0
    ds_read_b128 v[200:203], v241 offset:3840
    ds_read_b64 v[220:221], v244 offset:872
    ds_read_b64 v[222:223], v244 offset:880
    s_waitcnt lgkmcnt(9)
    v_mfma_f32_16x16x32_bf16 v[32:35], v[204:207], v[224:227], 0
    ds_read_b128 v[204:207], v241 offset:4160
    ds_read_b64 v[224:225], v244 offset:944
    ds_read_b64 v[226:227], v244 offset:952
    v_mfma_f32_16x16x32_bf16 v[36:39], v[208:211], v[228:231], 0
    ds_read_b128 v[208:211], v241 offset:4480
    ds_read_b64 v[228:229], v244 offset:1016
    ds_read_b64 v[230:231], v244 offset:1024
    s_waitcnt lgkmcnt(9)
    v_mfma_f32_16x16x32_bf16 v[40:43], v[192:195], v[212:215], 0
    ds_read_b128 v[192:195], v241 offset:4800
    ds_read_b64 v[212:213], v244 offset:1088
    ds_read_b64 v[214:215], v244 offset:1096
    v_mfma_f32_16x16x32_bf16 v[44:47], v[196:199], v[216:219], 0
    ds_read_b128 v[196:199], v241 offset:5120
    ds_read_b64 v[216:217], v244 offset:2336
    ds_read_b64 v[218:219], v244 offset:2344
    s_waitcnt lgkmcnt(9)
    v_mfma_f32_16x16x32_bf16 v[48:51], v[200:203], v[220:223], 0
    ds_read_b128 v[200:203], v241 offset:5440
    ds_read_b64 v[220:221], v244 offset:2408
    ds_read_b64 v[222:223], v244 offset:2416
    v_mfma_f32_16x16x32_bf16 v[52:55], v[204:207], v[224:227], 0
    ds_read_b128 v[204:207], v241 offset:5760
    ds_read_b64 v[224:225], v244 offset:2480
    ds_read_b64 v[226:227], v244 offset:2488
    s_waitcnt lgkmcnt(9)
    v_mfma_f32_16x16x32_bf16 v[56:59], v[208:211], v[228:231], 0
    ds_read_b128 v[208:211], v241 offset:6080
    ds_read_b64 v[228:229], v244 offset:2552
    ds_read_b64 v[230:231], v244 offset:2560
    v_mfma_f32_16x16x32_bf16 v[60:63], v[192:195], v[212:215], 0
    ds_read_b128 v[192:195], v241 offset:6400
    ds_read_b64 v[212:213], v244 offset:2624
    ds_read_b64 v[214:215], v244 offset:2632
    s_waitcnt lgkmcnt(9)
    v_mfma_f32_16x16x32_bf16 v[64:67], v[196:199], v[216:219], 0
    ds_read_b128 v[196:199], v241 offset:6720
    ds_read_b64 v[216:217], v244 offset:2696
    ds_read_b64 v[218:219], v244 offset:2704
    v_mfma_f32_16x16x32_bf16 v[68:71], v[200:203], v[220:223], 0
    ds_read_b128 v[200:203], v241 offset:7040
    ds_read_b64 v[220:221], v244 offset:2768
    ds_read_b64 v[222:223], v244 offset:2776
    s_waitcnt lgkmcnt(9)
    v_mfma_f32_16x16x32_bf16 v[72:75], v[204:207], v[224:227], 0
    ds_read_b128 v[204:207], v241 offset:7360
    ds_read_b64 v[224:225], v244 offset:2840
    ds_read_b64 v[226:227], v244 offset:2848
    v_mfma_f32_16x16x32_bf16 v[76:79], v[208:211], v[228:231], 0
    ds_read_b128 v[208:211], v241 offset:7680
    ds_read_b64 v[228:229], v244 offset:2920
    ds_read_b64 v[230:231], v244 offset:2928
    s_waitcnt lgkmcnt(9)
    v_mfma_f32_16x16x32_bf16 v[80:83], v[192:195], v[212:215], 0
    ds_read_b128 v[192:195], v241 offset:8000
    ds_read_b64 v[212:213], v244 offset:2992
    ds_read_b64 v[214:215], v244 offset:3000
    v_mfma_f32_16x16x32_bf16 v[84:87], v[196:199], v[216:219], 0
    ds_read_b128 v[196:199], v241 offset:8320
    ds_read_b64 v[216:217], v244 offset:3064
    ds_read_b64 v[218:219], v244 offset:3072
    s_waitcnt lgkmcnt(9)
    v_mfma_f32_16x16x32_bf16 v[88:91], v[200:203], v[220:223], 0
    ds_read_b128 v[200:203], v241 offset:8640
    ds_read_b64 v[220:221], v244 offset:3136
    ds_read_b64 v[222:223], v244 offset:3144
    v_mfma_f32_16x16x32_bf16 v[92:95], v[204:207], v[224:227], 0
    ds_read_b128 v[204:207], v241 offset:8960
    ds_read_b64 v[224:225], v244 offset:3208
    ds_read_b64 v[226:227], v244 offset:3216
    s_waitcnt lgkmcnt(9)
    v_mfma_f32_16x16x32_bf16 v[96:99], v[208:211], v[228:231], 0
    ds_read_b128 v[208:211], v241 offset:9280
    ds_read_b64 v[228:229], v244 offset:3280
    ds_read_b64 v[230:231], v244 offset:3288
    v_mfma_f32_16x16x32_bf16 v[100:103], v[192:195], v[212:215], 0
    ds_read_b128 v[192:195], v241 offset:9600
    ds_read_b64 v[212:213], v244 offset:3352
    ds_read_b64 v[214:215], v244 offset:3360
    s_waitcnt lgkmcnt(9)
    v_mfma_f32_16x16x32_bf16 v[104:107], v[196:199], v[216:219], 0
    ds_read_b128 v[196:199], v241 offset:9920
    ds_read_b64 v[216:217], v244 offset:3424
    ds_read_b64 v[218:219], v244 offset:3432
    v_mfma_f32_16x16x32_bf16 v[108:111], v[200:203], v[220:223], 0
    ds_read_b128 v[200:203], v241 offset:10240
    ds_read_b64 v[220:221], v244 offset:4672
    ds_read_b64 v[222:223], v244 offset:4680
    s_waitcnt lgkmcnt(9)
    v_mfma_f32_16x16x32_bf16 v[112:115], v[204:207], v[224:227], 0
    ds_read_b128 v[204:207], v241 offset:10560
    ds_read_b64 v[224:225], v244 offset:4744
    ds_read_b64 v[226:227], v244 offset:4752
    v_mfma_f32_16x16x32_bf16 v[116:119], v[208:211], v[228:231], 0
    ds_read_b128 v[208:211], v241 offset:10880
    ds_read_b64 v[228:229], v244 offset:4816
    ds_read_b64 v[230:231], v244 offset:4824
    s_waitcnt lgkmcnt(9)
    v_mfma_f32_16x16x32_bf16 v[120:123], v[192:195], v[212:215], 0
    ds_read_b128 v[192:195], v241 offset:11200
    ds_read_b64 v[212:213], v244 offset:4888
    ds_read_b64 v[214:215], v244 offset:4896
    v_mfma_f32_16x16x32_bf16 v[124:127], v[196:199], v[216:219], 0
    ds_read_b128 v[196:199], v241 offset:11520
    ds_read_b64 v[216:217], v244 offset:4960
    ds_read_b64 v[218:219], v244 offset:4968
    s_waitcnt lgkmcnt(9)
    v_mfma_f32_16x16x32_bf16 v[128:131], v[200:203], v[220:223], 0
    ds_read_b128 v[200:203], v241 offset:11840
    ds_read_b64 v[220:221], v244 offset:5032
    ds_read_b64 v[222:223], v244 offset:5040
    v_mfma_f32_16x16x32_bf16 v[132:135], v[204:207], v[224:227], 0
    ds_read_b128 v[204:207], v241 offset:12160
    ds_read_b64 v[224:225], v244 offset:5104
    ds_read_b64 v[226:227], v244 offset:5112
    s_waitcnt lgkmcnt(9)
    v_mfma_f32_16x16x32_bf16 v[136:139], v[208:211], v[228:231], 0
    ds_read_b128 v[208:211], v241 offset:12480
    ds_read_b64 v[228:229], v244 offset:5176
    ds_read_b64 v[230:231], v244 offset:5184
    v_mfma_f32_16x16x32_bf16 v[140:143], v[192:195], v[212:215], 0
    ds_read_b128 v[192:195], v241 offset:12800
    ds_read_b64 v[212:213], v244 offset:5256
    ds_read_b64 v[214:215], v244 offset:5264
    s_waitcnt lgkmcnt(9)
    v_mfma_f32_16x16x32_bf16 v[144:147], v[196:199], v[216:219], 0
    ds_read_b128 v[196:199], v241 offset:13120
    ds_read_b64 v[216:217], v244 offset:5328
    ds_read_b64 v[218:219], v244 offset:5336
    v_mfma_f32_16x16x32_bf16 v[148:151], v[200:203], v[220:223], 0
    ds_read_b128 v[200:203], v241 offset:13440
    ds_read_b64 v[220:221], v244 offset:5400
    ds_read_b64 v[222:223], v244 offset:5408
    s_waitcnt lgkmcnt(9)
    v_mfma_f32_16x16x32_bf16 v[152:155], v[204:207], v[224:227], 0
    ds_read_b128 v[204:207], v241 offset:13760
    ds_read_b64 v[224:225], v244 offset:5472
    ds_read_b64 v[226:227], v244 offset:5480
    v_mfma_f32_16x16x32_bf16 v[156:159], v[208:211], v[228:231], 0
    ds_read_b128 v[208:211], v241 offset:14080
    ds_read_b64 v[228:229], v244 offset:5544
    ds_read_b64 v[230:231], v244 offset:5552
    s_waitcnt lgkmcnt(9)
    v_mfma_f32_16x16x32_bf16 v[160:163], v[192:195], v[212:215], 0
    ds_read_b128 v[192:195], v241 offset:14400
    ds_read_b64 v[212:213], v244 offset:5616
    ds_read_b64 v[214:215], v244 offset:5624
    v_mfma_f32_16x16x32_bf16 v[164:167], v[196:199], v[216:219], 0
    ds_read_b128 v[196:199], v241 offset:14720
    ds_read_b64 v[216:217], v244 offset:5688
    ds_read_b64 v[218:219], v244 offset:5696
    s_waitcnt lgkmcnt(9)
    v_mfma_f32_16x16x32_bf16 v[168:171], v[200:203], v[220:223], 0
    ds_read_b128 v[200:203], v241 offset:15040
    ds_read_b64 v[220:221], v244 offset:5760
    ds_read_b64 v[222:223], v244 offset:5768
    v_mfma_f32_16x16x32_bf16 v[172:175], v[204:207], v[224:227], 0
    v_add_u32 v254, s26, v240

    s_mov_b32 s29, 200000
L_wrdy:
    ds_read_b32 v255, v254
    s_waitcnt lgkmcnt(0)
    v_cmp_ne_u32 vcc, 0, v255
    s_cmp_eq_u64 vcc, exec
    s_cbranch_scc1 L_wrdy_ok
    s_sleep 2
    s_sub_u32 s29, s29, 1
    s_cmp_lg_u32 s29, 0
    s_cbranch_scc1 L_wrdy
L_wrdy_ok:

    s_lshl_b32 s26, s16, 3
    s_add_u32 s26, s26, 161888
    v_mov_b32 v254, s26
    v_mov_b32 v255, 1

    ds_read_b128 v[204:207], v242 offset:0
    ds_read_b64 v[224:225], v245 offset:0
    ds_read_b64 v[226:227], v245 offset:8
    s_waitcnt lgkmcnt(9)
    v_mfma_f32_16x16x32_bf16 v[176:179], v[208:211], v[228:231], 0
    ds_read_b128 v[208:211], v242 offset:320
    ds_read_b64 v[228:229], v245 offset:72
    ds_read_b64 v[230:231], v245 offset:80
    v_mfma_f32_16x16x32_bf16 v[180:183], v[192:195], v[212:215], 0
    ds_read_b128 v[192:195], v242 offset:640
    ds_read_b64 v[212:213], v245 offset:144
    ds_read_b64 v[214:215], v245 offset:152
    s_waitcnt lgkmcnt(9)
    v_mfma_f32_16x16x32_bf16 v[184:187], v[196:199], v[216:219], 0
    ds_read_b128 v[196:199], v242 offset:960
    ds_read_b64 v[216:217], v245 offset:216
    ds_read_b64 v[218:219], v245 offset:224
    v_mfma_f32_16x16x32_bf16 v[188:191], v[200:203], v[220:223], 0
    ds_read_b128 v[200:203], v242 offset:1280
    ds_read_b64 v[220:221], v245 offset:288
    ds_read_b64 v[222:223], v245 offset:296
    s_waitcnt lgkmcnt(9)
    v_mfma_f32_16x16x32_bf16 v[0:3], v[204:207], v[224:227], v[0:3]
    ds_read_b128 v[204:207], v242 offset:1600
    ds_read_b64 v[224:225], v245 offset:360
    ds_read_b64 v[226:227], v245 offset:368
    v_mfma_f32_16x16x32_bf16 v[4:7], v[208:211], v[228:231], v[4:7]
    ds_read_b128 v[208:211], v242 offset:1920
    ds_read_b64 v[228:229], v245 offset:432
    ds_read_b64 v[230:231], v245 offset:440
    s_waitcnt lgkmcnt(9)
    v_mfma_f32_16x16x32_bf16 v[8:11], v[192:195], v[212:215], v[8:11]
    ds_read_b128 v[192:195], v242 offset:2240
    ds_read_b64 v[212:213], v245 offset:504
    ds_read_b64 v[214:215], v245 offset:512
    v_mfma_f32_16x16x32_bf16 v[12:15], v[196:199], v[216:219], v[12:15]
    ds_read_b128 v[196:199], v242 offset:2560
    ds_read_b64 v[216:217], v245 offset:584
    ds_read_b64 v[218:219], v245 offset:592
    s_waitcnt lgkmcnt(9)
    v_mfma_f32_16x16x32_bf16 v[16:19], v[200:203], v[220:223], v[16:19]
    ds_read_b128 v[200:203], v242 offset:2880
    ds_read_b64 v[220:221], v245 offset:656
    ds_read_b64 v[222:223], v245 offset:664
    v_mfma_f32_16x16x32_bf16 v[20:23], v[204:207], v[224:227], v[20:23]
    ds_read_b128 v[204:207], v242 offset:3200
    ds_read_b64 v[224:225], v245 offset:728
    ds_read_b64 v[226:227], v245 offset:736
    s_waitcnt lgkmcnt(9)
    v_mfma_f32_16x16x32_bf16 v[24:27], v[208:211], v[228:231], v[24:27]
    ds_read_b128 v[208:211], v242 offset:3520
    ds_read_b64 v[228:229], v245 offset:800
    ds_read_b64 v[230:231], v245 offset:808
    v_mfma_f32_16x16x32_bf16 v[28:31], v[192:195], v[212:215], v[28:31]
    ds_read_b128 v[192:195], v242 offset:3840
    ds_read_b64 v[212:213], v245 offset:872
    ds_read_b64 v[214:215], v245 offset:880
    s_waitcnt lgkmcnt(9)
    v_mfma_f32_16x16x32_bf16 v[32:35], v[196:199], v[216:219], v[32:35]
    ds_read_b128 v[196:199], v242 offset:4160
    ds_read_b64 v[216:217], v245 offset:944
    ds_read_b64 v[218:219], v245 offset:952
    v_mfma_f32_16x16x32_bf16 v[36:39], v[200:203], v[220:223], v[36:39]
    ds_read_b128 v[200:203], v242 offset:4480
    ds_read_b64 v[220:221], v245 offset:1016
    ds_read_b64 v[222:223], v245 offset:1024
    s_waitcnt lgkmcnt(9)
    v_mfma_f32_16x16x32_bf16 v[40:43], v[204:207], v[224:227], v[40:43]
    ds_read_b128 v[204:207], v242 offset:4800
    ds_read_b64 v[224:225], v245 offset:1088
    ds_read_b64 v[226:227], v245 offset:1096
    v_mfma_f32_16x16x32_bf16 v[44:47], v[208:211], v[228:231], v[44:47]
    ds_read_b128 v[208:211], v242 offset:5120
    ds_read_b64 v[228:229], v245 offset:2336
    ds_read_b64 v[230:231], v245 offset:2344
    s_waitcnt lgkmcnt(9)
    v_mfma_f32_16x16x32_bf16 v[48:51], v[192:195], v[212:215], v[48:51]
    ds_read_b128 v[192:195], v242 offset:5440
    ds_read_b64 v[212:213], v245 offset:2408
    ds_read_b64 v[214:215], v245 offset:2416
    v_mfma_f32_16x16x32_bf16 v[52:55], v[196:199], v[216:219], v[52:55]
    ds_read_b128 v[196:199], v242 offset:5760
    ds_read_b64 v[216:217], v245 offset:2480
    ds_read_b64 v[218:219], v245 offset:2488
    s_waitcnt lgkmcnt(9)
    v_mfma_f32_16x16x32_bf16 v[56:59], v[200:203], v[220:223], v[56:59]
    ds_read_b128 v[200:203], v242 offset:6080
    ds_read_b64 v[220:221], v245 offset:2552
    ds_read_b64 v[222:223], v245 offset:2560
    v_mfma_f32_16x16x32_bf16 v[60:63], v[204:207], v[224:227], v[60:63]
    ds_read_b128 v[204:207], v242 offset:6400
    ds_read_b64 v[224:225], v245 offset:2624
    ds_read_b64 v[226:227], v245 offset:2632
    s_waitcnt lgkmcnt(9)
    v_mfma_f32_16x16x32_bf16 v[64:67], v[208:211], v[228:231], v[64:67]
    ds_read_b128 v[208:211], v242 offset:6720
    ds_read_b64 v[228:229], v245 offset:2696
    ds_read_b64 v[230:231], v245 offset:2704
    v_mfma_f32_16x16x32_bf16 v[68:71], v[192:195], v[212:215], v[68:71]
    ds_read_b128 v[192:195], v242 offset:7040
    ds_read_b64 v[212:213], v245 offset:2768
    ds_read_b64 v[214:215], v245 offset:2776
    s_waitcnt lgkmcnt(9)
    v_mfma_f32_16x16x32_bf16 v[72:75], v[196:199], v[216:219], v[72:75]
    ds_read_b128 v[196:199], v242 offset:7360
    ds_read_b64 v[216:217], v245 offset:2840
    ds_read_b64 v[218:219], v245 offset:2848
    v_mfma_f32_16x16x32_bf16 v[76:79], v[200:203], v[220:223], v[76:79]
    ds_read_b128 v[200:203], v242 offset:7680
    ds_read_b64 v[220:221], v245 offset:2920
    ds_read_b64 v[222:223], v245 offset:2928
    s_waitcnt lgkmcnt(9)
    v_mfma_f32_16x16x32_bf16 v[80:83], v[204:207], v[224:227], v[80:83]
    ds_read_b128 v[204:207], v242 offset:8000
    ds_read_b64 v[224:225], v245 offset:2992
    ds_read_b64 v[226:227], v245 offset:3000
    v_mfma_f32_16x16x32_bf16 v[84:87], v[208:211], v[228:231], v[84:87]
    ds_read_b128 v[208:211], v242 offset:8320
    ds_read_b64 v[228:229], v245 offset:3064
    ds_read_b64 v[230:231], v245 offset:3072
    s_waitcnt lgkmcnt(9)
    v_mfma_f32_16x16x32_bf16 v[88:91], v[192:195], v[212:215], v[88:91]
    ds_read_b128 v[192:195], v242 offset:8640
    ds_read_b64 v[212:213], v245 offset:3136
    ds_read_b64 v[214:215], v245 offset:3144
    v_mfma_f32_16x16x32_bf16 v[92:95], v[196:199], v[216:219], v[92:95]
    ds_read_b128 v[196:199], v242 offset:8960
    ds_read_b64 v[216:217], v245 offset:3208
    ds_read_b64 v[218:219], v245 offset:3216
    s_waitcnt lgkmcnt(9)
    v_mfma_f32_16x16x32_bf16 v[96:99], v[200:203], v[220:223], v[96:99]
    ds_read_b128 v[200:203], v242 offset:9280
    ds_read_b64 v[220:221], v245 offset:3280
    ds_read_b64 v[222:223], v245 offset:3288
    v_mfma_f32_16x16x32_bf16 v[100:103], v[204:207], v[224:227], v[100:103]
    ds_read_b128 v[204:207], v242 offset:9600
    ds_read_b64 v[224:225], v245 offset:3352
    ds_read_b64 v[226:227], v245 offset:3360
    s_waitcnt lgkmcnt(9)
    v_mfma_f32_16x16x32_bf16 v[104:107], v[208:211], v[228:231], v[104:107]
    ds_read_b128 v[208:211], v242 offset:9920
    ds_read_b64 v[228:229], v245 offset:3424
    ds_read_b64 v[230:231], v245 offset:3432
    v_mfma_f32_16x16x32_bf16 v[108:111], v[192:195], v[212:215], v[108:111]
    ds_read_b128 v[192:195], v242 offset:10240
    ds_read_b64 v[212:213], v245 offset:4672
    ds_read_b64 v[214:215], v245 offset:4680
    s_waitcnt lgkmcnt(9)
    v_mfma_f32_16x16x32_bf16 v[112:115], v[196:199], v[216:219], v[112:115]
    ds_read_b128 v[196:199], v242 offset:10560
    ds_read_b64 v[216:217], v245 offset:4744
    ds_read_b64 v[218:219], v245 offset:4752
    v_mfma_f32_16x16x32_bf16 v[116:119], v[200:203], v[220:223], v[116:119]
    ds_read_b128 v[200:203], v242 offset:10880
    ds_read_b64 v[220:221], v245 offset:4816
    ds_read_b64 v[222:223], v245 offset:4824
    s_waitcnt lgkmcnt(9)
    v_mfma_f32_16x16x32_bf16 v[120:123], v[204:207], v[224:227], v[120:123]
    ds_read_b128 v[204:207], v242 offset:11200
    ds_read_b64 v[224:225], v245 offset:4888
    ds_read_b64 v[226:227], v245 offset:4896
    v_mfma_f32_16x16x32_bf16 v[124:127], v[208:211], v[228:231], v[124:127]
    ds_read_b128 v[208:211], v242 offset:11520
    ds_read_b64 v[228:229], v245 offset:4960
    ds_read_b64 v[230:231], v245 offset:4968
    s_waitcnt lgkmcnt(9)
    v_mfma_f32_16x16x32_bf16 v[128:131], v[192:195], v[212:215], v[128:131]
    ds_read_b128 v[192:195], v242 offset:11840
    ds_read_b64 v[212:213], v245 offset:5032
    ds_read_b64 v[214:215], v245 offset:5040
    v_mfma_f32_16x16x32_bf16 v[132:135], v[196:199], v[216:219], v[132:135]
    ds_read_b128 v[196:199], v242 offset:12160
    ds_read_b64 v[216:217], v245 offset:5104
    ds_read_b64 v[218:219], v245 offset:5112
    s_waitcnt lgkmcnt(9)
    v_mfma_f32_16x16x32_bf16 v[136:139], v[200:203], v[220:223], v[136:139]
    ds_read_b128 v[200:203], v242 offset:12480
    ds_read_b64 v[220:221], v245 offset:5176
    ds_read_b64 v[222:223], v245 offset:5184
    v_mfma_f32_16x16x32_bf16 v[140:143], v[204:207], v[224:227], v[140:143]
    ds_read_b128 v[204:207], v242 offset:12800
    ds_read_b64 v[224:225], v245 offset:5256
    ds_read_b64 v[226:227], v245 offset:5264
    s_waitcnt lgkmcnt(9)
    v_mfma_f32_16x16x32_bf16 v[144:147], v[208:211], v[228:231], v[144:147]
    ds_read_b128 v[208:211], v242 offset:13120
    ds_read_b64 v[228:229], v245 offset:5328
    ds_read_b64 v[230:231], v245 offset:5336
    v_mfma_f32_16x16x32_bf16 v[148:151], v[192:195], v[212:215], v[148:151]
    ds_read_b128 v[192:195], v242 offset:13440
    ds_read_b64 v[212:213], v245 offset:5400
    ds_read_b64 v[214:215], v245 offset:5408
    s_waitcnt lgkmcnt(9)
    v_mfma_f32_16x16x32_bf16 v[152:155], v[196:199], v[216:219], v[152:155]
    ds_read_b128 v[196:199], v242 offset:13760
    ds_read_b64 v[216:217], v245 offset:5472
    ds_read_b64 v[218:219], v245 offset:5480
    v_mfma_f32_16x16x32_bf16 v[156:159], v[200:203], v[220:223], v[156:159]
    ds_read_b128 v[200:203], v242 offset:14080
    ds_read_b64 v[220:221], v245 offset:5544
    ds_read_b64 v[222:223], v245 offset:5552
    s_waitcnt lgkmcnt(9)
    v_mfma_f32_16x16x32_bf16 v[160:163], v[204:207], v[224:227], v[160:163]
    ds_read_b128 v[204:207], v242 offset:14400
    ds_read_b64 v[224:225], v245 offset:5616
    ds_read_b64 v[226:227], v245 offset:5624
    v_mfma_f32_16x16x32_bf16 v[164:167], v[208:211], v[228:231], v[164:167]
    ds_read_b128 v[208:211], v242 offset:14720
    ds_read_b64 v[228:229], v245 offset:5688
    ds_read_b64 v[230:231], v245 offset:5696
    s_waitcnt lgkmcnt(9)
    v_mfma_f32_16x16x32_bf16 v[168:171], v[192:195], v[212:215], v[168:171]
    ds_read_b128 v[192:195], v242 offset:15040
    ds_read_b64 v[212:213], v245 offset:5760
    ds_read_b64 v[214:215], v245 offset:5768
    v_mfma_f32_16x16x32_bf16 v[172:175], v[196:199], v[216:219], v[172:175]
    ds_read_b128 v[196:199], v243 offset:0
    ds_read_b64 v[216:217], v246 offset:0
    ds_read_b64 v[218:219], v246 offset:8
    s_waitcnt lgkmcnt(9)
    v_mfma_f32_16x16x32_bf16 v[176:179], v[200:203], v[220:223], v[176:179]
    ds_read_b128 v[200:203], v243 offset:320
    ds_read_b64 v[220:221], v246 offset:72
    ds_read_b64 v[222:223], v246 offset:80
    v_mfma_f32_16x16x32_bf16 v[180:183], v[204:207], v[224:227], v[180:183]
    ds_read_b128 v[204:207], v243 offset:640
    ds_read_b64 v[224:225], v246 offset:144
    ds_read_b64 v[226:227], v246 offset:152
    s_waitcnt lgkmcnt(9)
    v_mfma_f32_16x16x32_bf16 v[184:187], v[208:211], v[228:231], v[184:187]
    ds_read_b128 v[208:211], v243 offset:960
    ds_read_b64 v[228:229], v246 offset:216
    ds_read_b64 v[230:231], v246 offset:224
    v_mfma_f32_16x16x32_bf16 v[188:191], v[192:195], v[212:215], v[188:191]
    ds_read_b128 v[192:195], v243 offset:1280
    ds_read_b64 v[212:213], v246 offset:288
    ds_read_b64 v[214:215], v246 offset:296
    s_waitcnt lgkmcnt(9)
    ds_write_b32 v254, v255
    v_mfma_f32_16x16x32_bf16 v[0:3], v[196:199], v[216:219], v[0:3]
    ds_read_b128 v[196:199], v243 offset:1600
    ds_read_b64 v[216:217], v246 offset:360
    ds_read_b64 v[218:219], v246 offset:368
    v_mfma_f32_16x16x32_bf16 v[4:7], v[200:203], v[220:223], v[4:7]
    s_waitcnt lgkmcnt(12)
    ds_read_b128 v[200:203], v243 offset:1920
    ds_read_b64 v[220:221], v246 offset:432
    ds_read_b64 v[222:223], v246 offset:440
    s_waitcnt lgkmcnt(9)
    v_mfma_f32_16x16x32_bf16 v[8:11], v[204:207], v[224:227], v[8:11]
    ds_read_b128 v[204:207], v243 offset:2240
    ds_read_b64 v[224:225], v246 offset:504
    ds_read_b64 v[226:227], v246 offset:512
    v_mfma_f32_16x16x32_bf16 v[12:15], v[208:211], v[228:231], v[12:15]
    ds_read_b128 v[208:211], v243 offset:2560
    ds_read_b64 v[228:229], v246 offset:584
    ds_read_b64 v[230:231], v246 offset:592
    s_waitcnt lgkmcnt(9)
    v_mfma_f32_16x16x32_bf16 v[16:19], v[192:195], v[212:215], v[16:19]
    ds_read_b128 v[192:195], v243 offset:2880
    ds_read_b64 v[212:213], v246 offset:656
    ds_read_b64 v[214:215], v246 offset:664
    v_mfma_f32_16x16x32_bf16 v[20:23], v[196:199], v[216:219], v[20:23]
    ds_read_b128 v[196:199], v243 offset:3200
    ds_read_b64 v[216:217], v246 offset:728
    ds_read_b64 v[218:219], v246 offset:736
    s_waitcnt lgkmcnt(9)
    v_mfma_f32_16x16x32_bf16 v[24:27], v[200:203], v[220:223], v[24:27]
    ds_read_b128 v[200:203], v243 offset:3520
    ds_read_b64 v[220:221], v246 offset:800
    ds_read_b64 v[222:223], v246 offset:808
    v_mfma_f32_16x16x32_bf16 v[28:31], v[204:207], v[224:227], v[28:31]
    ds_read_b128 v[204:207], v243 offset:3840
    ds_read_b64 v[224:225], v246 offset:872
    ds_read_b64 v[226:227], v246 offset:880
    s_waitcnt lgkmcnt(9)
    v_mfma_f32_16x16x32_bf16 v[32:35], v[208:211], v[228:231], v[32:35]
    ds_read_b128 v[208:211], v243 offset:4160
    ds_read_b64 v[228:229], v246 offset:944
    ds_read_b64 v[230:231], v246 offset:952
    v_mfma_f32_16x16x32_bf16 v[36:39], v[192:195], v[212:215], v[36:39]
    ds_read_b128 v[192:195], v243 offset:4480
    ds_read_b64 v[212:213], v246 offset:1016
    ds_read_b64 v[214:215], v246 offset:1024
    s_waitcnt lgkmcnt(9)
    v_mfma_f32_16x16x32_bf16 v[40:43], v[196:199], v[216:219], v[40:43]
    ds_read_b128 v[196:199], v243 offset:4800
    ds_read_b64 v[216:217], v246 offset:1088
    ds_read_b64 v[218:219], v246 offset:1096
    v_mfma_f32_16x16x32_bf16 v[44:47], v[200:203], v[220:223], v[44:47]
    ds_read_b128 v[200:203], v243 offset:5120
    ds_read_b64 v[220:221], v246 offset:2336
    ds_read_b64 v[222:223], v246 offset:2344
    s_waitcnt lgkmcnt(9)
    v_mfma_f32_16x16x32_bf16 v[48:51], v[204:207], v[224:227], v[48:51]
    ds_read_b128 v[204:207], v243 offset:5440
    ds_read_b64 v[224:225], v246 offset:2408
    ds_read_b64 v[226:227], v246 offset:2416
    v_mfma_f32_16x16x32_bf16 v[52:55], v[208:211], v[228:231], v[52:55]
    ds_read_b128 v[208:211], v243 offset:5760
    ds_read_b64 v[228:229], v246 offset:2480
    ds_read_b64 v[230:231], v246 offset:2488
    s_waitcnt lgkmcnt(9)
    v_mfma_f32_16x16x32_bf16 v[56:59], v[192:195], v[212:215], v[56:59]
    ds_read_b128 v[192:195], v243 offset:6080
    ds_read_b64 v[212:213], v246 offset:2552
    ds_read_b64 v[214:215], v246 offset:2560
    v_mfma_f32_16x16x32_bf16 v[60:63], v[196:199], v[216:219], v[60:63]
    ds_read_b128 v[196:199], v243 offset:6400
    ds_read_b64 v[216:217], v246 offset:2624
    ds_read_b64 v[218:219], v246 offset:2632
    s_waitcnt lgkmcnt(9)
    v_mfma_f32_16x16x32_bf16 v[64:67], v[200:203], v[220:223], v[64:67]
    ds_read_b128 v[200:203], v243 offset:6720
    ds_read_b64 v[220:221], v246 offset:2696
    ds_read_b64 v[222:223], v246 offset:2704
    v_mfma_f32_16x16x32_bf16 v[68:71], v[204:207], v[224:227], v[68:71]
    ds_read_b128 v[204:207], v243 offset:7040
    ds_read_b64 v[224:225], v246 offset:2768
    ds_read_b64 v[226:227], v246 offset:2776
    s_waitcnt lgkmcnt(9)
    v_mfma_f32_16x16x32_bf16 v[72:75], v[208:211], v[228:231], v[72:75]
    ds_read_b128 v[208:211], v243 offset:7360
    ds_read_b64 v[228:229], v246 offset:2840
    ds_read_b64 v[230:231], v246 offset:2848
    v_mfma_f32_16x16x32_bf16 v[76:79], v[192:195], v[212:215], v[76:79]
    ds_read_b128 v[192:195], v243 offset:7680
    ds_read_b64 v[212:213], v246 offset:2920
    ds_read_b64 v[214:215], v246 offset:2928
    s_waitcnt lgkmcnt(9)
    v_mfma_f32_16x16x32_bf16 v[80:83], v[196:199], v[216:219], v[80:83]
    ds_read_b128 v[196:199], v243 offset:8000
    ds_read_b64 v[216:217], v246 offset:2992
    ds_read_b64 v[218:219], v246 offset:3000
    v_mfma_f32_16x16x32_bf16 v[84:87], v[200:203], v[220:223], v[84:87]
    ds_read_b128 v[200:203], v243 offset:8320
    ds_read_b64 v[220:221], v246 offset:3064
    ds_read_b64 v[222:223], v246 offset:3072
    s_waitcnt lgkmcnt(9)
    v_mfma_f32_16x16x32_bf16 v[88:91], v[204:207], v[224:227], v[88:91]
    ds_read_b128 v[204:207], v243 offset:8640
    ds_read_b64 v[224:225], v246 offset:3136
    ds_read_b64 v[226:227], v246 offset:3144
    v_mfma_f32_16x16x32_bf16 v[92:95], v[208:211], v[228:231], v[92:95]
    ds_read_b128 v[208:211], v243 offset:8960
    ds_read_b64 v[228:229], v246 offset:3208
    ds_read_b64 v[230:231], v246 offset:3216
    s_waitcnt lgkmcnt(9)
    v_mfma_f32_16x16x32_bf16 v[96:99], v[192:195], v[212:215], v[96:99]
    ds_read_b128 v[192:195], v243 offset:9280
    ds_read_b64 v[212:213], v246 offset:3280
    ds_read_b64 v[214:215], v246 offset:3288
    v_mfma_f32_16x16x32_bf16 v[100:103], v[196:199], v[216:219], v[100:103]
    ds_read_b128 v[196:199], v243 offset:9600
    ds_read_b64 v[216:217], v246 offset:3352
    ds_read_b64 v[218:219], v246 offset:3360
    s_waitcnt lgkmcnt(9)
    v_mfma_f32_16x16x32_bf16 v[104:107], v[200:203], v[220:223], v[104:107]
    ds_read_b128 v[200:203], v243 offset:9920
    ds_read_b64 v[220:221], v246 offset:3424
    ds_read_b64 v[222:223], v246 offset:3432
    v_mfma_f32_16x16x32_bf16 v[108:111], v[204:207], v[224:227], v[108:111]
    ds_read_b128 v[204:207], v243 offset:10240
    ds_read_b64 v[224:225], v246 offset:4672
    ds_read_b64 v[226:227], v246 offset:4680
    s_waitcnt lgkmcnt(9)
    v_mfma_f32_16x16x32_bf16 v[112:115], v[208:211], v[228:231], v[112:115]
    ds_read_b128 v[208:211], v243 offset:10560
    ds_read_b64 v[228:229], v246 offset:4744
    ds_read_b64 v[230:231], v246 offset:4752
    v_mfma_f32_16x16x32_bf16 v[116:119], v[192:195], v[212:215], v[116:119]
    ds_read_b128 v[192:195], v243 offset:10880
    ds_read_b64 v[212:213], v246 offset:4816
    ds_read_b64 v[214:215], v246 offset:4824
    s_waitcnt lgkmcnt(9)
    v_mfma_f32_16x16x32_bf16 v[120:123], v[196:199], v[216:219], v[120:123]
    ds_read_b128 v[196:199], v243 offset:11200
    ds_read_b64 v[216:217], v246 offset:4888
    ds_read_b64 v[218:219], v246 offset:4896
    v_mfma_f32_16x16x32_bf16 v[124:127], v[200:203], v[220:223], v[124:127]
    ds_read_b128 v[200:203], v243 offset:11520
    ds_read_b64 v[220:221], v246 offset:4960
    ds_read_b64 v[222:223], v246 offset:4968
    s_waitcnt lgkmcnt(9)
    v_mfma_f32_16x16x32_bf16 v[128:131], v[204:207], v[224:227], v[128:131]
    ds_read_b128 v[204:207], v243 offset:11840
    ds_read_b64 v[224:225], v246 offset:5032
    ds_read_b64 v[226:227], v246 offset:5040
    v_mfma_f32_16x16x32_bf16 v[132:135], v[208:211], v[228:231], v[132:135]
    ds_read_b128 v[208:211], v243 offset:12160
    ds_read_b64 v[228:229], v246 offset:5104
    ds_read_b64 v[230:231], v246 offset:5112
    s_waitcnt lgkmcnt(9)
    v_mfma_f32_16x16x32_bf16 v[136:139], v[192:195], v[212:215], v[136:139]
    ds_read_b128 v[192:195], v243 offset:12480
    ds_read_b64 v[212:213], v246 offset:5176
    ds_read_b64 v[214:215], v246 offset:5184
    v_mfma_f32_16x16x32_bf16 v[140:143], v[196:199], v[216:219], v[140:143]
    ds_read_b128 v[196:199], v243 offset:12800
    ds_read_b64 v[216:217], v246 offset:5256
    ds_read_b64 v[218:219], v246 offset:5264
    s_waitcnt lgkmcnt(9)
    v_mfma_f32_16x16x32_bf16 v[144:147], v[200:203], v[220:223], v[144:147]
    ds_read_b128 v[200:203], v243 offset:13120
    ds_read_b64 v[220:221], v246 offset:5328
    ds_read_b64 v[222:223], v246 offset:5336
    v_mfma_f32_16x16x32_bf16 v[148:151], v[204:207], v[224:227], v[148:151]
    ds_read_b128 v[204:207], v243 offset:13440
    ds_read_b64 v[224:225], v246 offset:5400
    ds_read_b64 v[226:227], v246 offset:5408
    s_waitcnt lgkmcnt(9)
    v_mfma_f32_16x16x32_bf16 v[152:155], v[208:211], v[228:231], v[152:155]
    ds_read_b128 v[208:211], v243 offset:13760
    ds_read_b64 v[228:229], v246 offset:5472
    ds_read_b64 v[230:231], v246 offset:5480
    v_mfma_f32_16x16x32_bf16 v[156:159], v[192:195], v[212:215], v[156:159]
    ds_read_b128 v[192:195], v243 offset:14080
    ds_read_b64 v[212:213], v246 offset:5544
    ds_read_b64 v[214:215], v246 offset:5552
    s_waitcnt lgkmcnt(9)
    v_mfma_f32_16x16x32_bf16 v[160:163], v[196:199], v[216:219], v[160:163]
    ds_read_b128 v[196:199], v243 offset:14400
    ds_read_b64 v[216:217], v246 offset:5616
    ds_read_b64 v[218:219], v246 offset:5624
    v_mfma_f32_16x16x32_bf16 v[164:167], v[200:203], v[220:223], v[164:167]
    ds_read_b128 v[200:203], v243 offset:14720
    ds_read_b64 v[220:221], v246 offset:5688
    ds_read_b64 v[222:223], v246 offset:5696
    s_waitcnt lgkmcnt(9)
    v_mfma_f32_16x16x32_bf16 v[168:171], v[204:207], v[224:227], v[168:171]
    ds_read_b128 v[204:207], v243 offset:15040
    ds_read_b64 v[224:225], v246 offset:5760
    ds_read_b64 v[226:227], v246 offset:5768
    v_mfma_f32_16x16x32_bf16 v[172:175], v[208:211], v[228:231], v[172:175]
    s_waitcnt lgkmcnt(6)
    v_mfma_f32_16x16x32_bf16 v[176:179], v[192:195], v[212:215], v[176:179]
    v_mfma_f32_16x16x32_bf16 v[180:183], v[196:199], v[216:219], v[180:183]
    s_waitcnt lgkmcnt(0)
    v_mfma_f32_16x16x32_bf16 v[184:187], v[200:203], v[220:223], v[184:187]
    ds_write_b32 v254, v255 offset:4
    v_mfma_f32_16x16x32_bf16 v[188:191], v[204:207], v[224:227], v[188:191]
    s_setprio 2
    v_pk_add_f32 v[232:233], v[0:1], v[4:5]
    v_pk_mul_f32 v[236:237], v[0:1], v[0:1]
    v_pk_add_f32 v[234:235], v[2:3], v[6:7]
    v_pk_mul_f32 v[238:239], v[2:3], v[2:3]
    v_pk_fma_f32 v[236:237], v[4:5], v[4:5], v[236:237]
    v_pk_fma_f32 v[238:239], v[6:7], v[6:7], v[238:239]
    v_pk_add_f32 v[232:233], v[232:233], v[8:9]
    v_pk_fma_f32 v[236:237], v[8:9], v[8:9], v[236:237]
    v_pk_add_f32 v[234:235], v[234:235], v[10:11]
    v_pk_fma_f32 v[238:239], v[10:11], v[10:11], v[238:239]
    v_pk_add_f32 v[232:233], v[232:233], v[12:13]
    v_pk_fma_f32 v[236:237], v[12:13], v[12:13], v[236:237]
    v_pk_add_f32 v[234:235], v[234:235], v[14:15]
    v_pk_fma_f32 v[238:239], v[14:15], v[14:15], v[238:239]
    v_pk_add_f32 v[232:233], v[232:233], v[16:17]
    v_pk_fma_f32 v[236:237], v[16:17], v[16:17], v[236:237]
    v_pk_add_f32 v[234:235], v[234:235], v[18:19]
    v_pk_fma_f32 v[238:239], v[18:19], v[18:19], v[238:239]
    v_pk_add_f32 v[232:233], v[232:233], v[20:21]
    v_pk_fma_f32 v[236:237], v[20:21], v[20:21], v[236:237]
    v_pk_add_f32 v[234:235], v[234:235], v[22:23]
    v_pk_fma_f32 v[238:239], v[22:23], v[22:23], v[238:239]
    v_pk_add_f32 v[232:233], v[232:233], v[24:25]
    v_pk_fma_f32 v[236:237], v[24:25], v[24:25], v[236:237]
    v_pk_add_f32 v[234:235], v[234:235], v[26:27]
    v_pk_fma_f32 v[238:239], v[26:27], v[26:27], v[238:239]
    v_pk_add_f32 v[232:233], v[232:233], v[28:29]
    v_pk_fma_f32 v[236:237], v[28:29], v[28:29], v[236:237]
    v_pk_add_f32 v[234:235], v[234:235], v[30:31]
    v_pk_fma_f32 v[238:239], v[30:31], v[30:31], v[238:239]
    v_pk_add_f32 v[232:233], v[232:233], v[32:33]
    v_pk_fma_f32 v[236:237], v[32:33], v[32:33], v[236:237]
    v_pk_add_f32 v[234:235], v[234:235], v[34:35]
    v_pk_fma_f32 v[238:239], v[34:35], v[34:35], v[238:239]
    v_pk_add_f32 v[232:233], v[232:233], v[36:37]
    v_pk_fma_f32 v[236:237], v[36:37], v[36:37], v[236:237]
    v_pk_add_f32 v[234:235], v[234:235], v[38:39]
    v_pk_fma_f32 v[238:239], v[38:39], v[38:39], v[238:239]
    v_pk_add_f32 v[232:233], v[232:233], v[40:41]
    v_pk_fma_f32 v[236:237], v[40:41], v[40:41], v[236:237]
    v_pk_add_f32 v[234:235], v[234:235], v[42:43]
    v_pk_fma_f32 v[238:239], v[42:43], v[42:43], v[238:239]
    v_pk_add_f32 v[232:233], v[232:233], v[44:45]
    v_pk_fma_f32 v[236:237], v[44:45], v[44:45], v[236:237]
    v_pk_add_f32 v[234:235], v[234:235], v[46:47]
    v_pk_fma_f32 v[238:239], v[46:47], v[46:47], v[238:239]
    v_pk_add_f32 v[232:233], v[232:233], v[48:49]
    v_pk_fma_f32 v[236:237], v[48:49], v[48:49], v[236:237]
    v_pk_add_f32 v[234:235], v[234:235], v[50:51]
    v_pk_fma_f32 v[238:239], v[50:51], v[50:51], v[238:239]
    v_pk_add_f32 v[232:233], v[232:233], v[52:53]
    v_pk_fma_f32 v[236:237], v[52:53], v[52:53], v[236:237]
    v_pk_add_f32 v[234:235], v[234:235], v[54:55]
    v_pk_fma_f32 v[238:239], v[54:55], v[54:55], v[238:239]
    v_pk_add_f32 v[232:233], v[232:233], v[56:57]
    v_pk_fma_f32 v[236:237], v[56:57], v[56:57], v[236:237]
    v_pk_add_f32 v[234:235], v[234:235], v[58:59]
    v_pk_fma_f32 v[238:239], v[58:59], v[58:59], v[238:239]
    v_pk_add_f32 v[232:233], v[232:233], v[60:61]
    v_pk_fma_f32 v[236:237], v[60:61], v[60:61], v[236:237]
    v_pk_add_f32 v[234:235], v[234:235], v[62:63]
    v_pk_fma_f32 v[238:239], v[62:63], v[62:63], v[238:239]
    v_pk_add_f32 v[232:233], v[232:233], v[64:65]
    v_pk_fma_f32 v[236:237], v[64:65], v[64:65], v[236:237]
    v_pk_add_f32 v[234:235], v[234:235], v[66:67]
    v_pk_fma_f32 v[238:239], v[66:67], v[66:67], v[238:239]
    v_pk_add_f32 v[232:233], v[232:233], v[68:69]
    v_pk_fma_f32 v[236:237], v[68:69], v[68:69], v[236:237]
    v_pk_add_f32 v[234:235], v[234:235], v[70:71]
    v_pk_fma_f32 v[238:239], v[70:71], v[70:71], v[238:239]
    v_pk_add_f32 v[232:233], v[232:233], v[72:73]
    v_pk_fma_f32 v[236:237], v[72:73], v[72:73], v[236:237]
    v_pk_add_f32 v[234:235], v[234:235], v[74:75]
    v_pk_fma_f32 v[238:239], v[74:75], v[74:75], v[238:239]
    v_pk_add_f32 v[232:233], v[232:233], v[76:77]
    v_pk_fma_f32 v[236:237], v[76:77], v[76:77], v[236:237]
    v_pk_add_f32 v[234:235], v[234:235], v[78:79]
    v_pk_fma_f32 v[238:239], v[78:79], v[78:79], v[238:239]
    v_pk_add_f32 v[232:233], v[232:233], v[80:81]
    v_pk_fma_f32 v[236:237], v[80:81], v[80:81], v[236:237]
    v_pk_add_f32 v[234:235], v[234:235], v[82:83]
    v_pk_fma_f32 v[238:239], v[82:83], v[82:83], v[238:239]
    v_pk_add_f32 v[232:233], v[232:233], v[84:85]
    v_pk_fma_f32 v[236:237], v[84:85], v[84:85], v[236:237]
    v_pk_add_f32 v[234:235], v[234:235], v[86:87]
    v_pk_fma_f32 v[238:239], v[86:87], v[86:87], v[238:239]
    v_pk_add_f32 v[232:233], v[232:233], v[88:89]
    v_pk_fma_f32 v[236:237], v[88:89], v[88:89], v[236:237]
    v_pk_add_f32 v[234:235], v[234:235], v[90:91]
    v_pk_fma_f32 v[238:239], v[90:91], v[90:91], v[238:239]
    v_pk_add_f32 v[232:233], v[232:233], v[92:93]
    v_pk_fma_f32 v[236:237], v[92:93], v[92:93], v[236:237]
    v_pk_add_f32 v[234:235], v[234:235], v[94:95]
    v_pk_fma_f32 v[238:239], v[94:95], v[94:95], v[238:239]
    v_pk_add_f32 v[232:233], v[232:233], v[96:97]
    v_pk_fma_f32 v[236:237], v[96:97], v[96:97], v[236:237]
    v_pk_add_f32 v[234:235], v[234:235], v[98:99]
    v_pk_fma_f32 v[238:239], v[98:99], v[98:99], v[238:239]
    v_pk_add_f32 v[232:233], v[232:233], v[100:101]
    v_pk_fma_f32 v[236:237], v[100:101], v[100:101], v[236:237]
    v_pk_add_f32 v[234:235], v[234:235], v[102:103]
    v_pk_fma_f32 v[238:239], v[102:103], v[102:103], v[238:239]
    v_pk_add_f32 v[232:233], v[232:233], v[104:105]
    v_pk_fma_f32 v[236:237], v[104:105], v[104:105], v[236:237]
    v_pk_add_f32 v[234:235], v[234:235], v[106:107]
    v_pk_fma_f32 v[238:239], v[106:107], v[106:107], v[238:239]
    v_pk_add_f32 v[232:233], v[232:233], v[108:109]
    v_pk_fma_f32 v[236:237], v[108:109], v[108:109], v[236:237]
    v_pk_add_f32 v[234:235], v[234:235], v[110:111]
    v_pk_fma_f32 v[238:239], v[110:111], v[110:111], v[238:239]
    v_pk_add_f32 v[232:233], v[232:233], v[112:113]
    v_pk_fma_f32 v[236:237], v[112:113], v[112:113], v[236:237]
    v_pk_add_f32 v[234:235], v[234:235], v[114:115]
    v_pk_fma_f32 v[238:239], v[114:115], v[114:115], v[238:239]
    v_pk_add_f32 v[232:233], v[232:233], v[116:117]
    v_pk_fma_f32 v[236:237], v[116:117], v[116:117], v[236:237]
    v_pk_add_f32 v[234:235], v[234:235], v[118:119]
    v_pk_fma_f32 v[238:239], v[118:119], v[118:119], v[238:239]
    v_pk_add_f32 v[232:233], v[232:233], v[120:121]
    v_pk_fma_f32 v[236:237], v[120:121], v[120:121], v[236:237]
    v_pk_add_f32 v[234:235], v[234:235], v[122:123]
    v_pk_fma_f32 v[238:239], v[122:123], v[122:123], v[238:239]
    v_pk_add_f32 v[232:233], v[232:233], v[124:125]
    v_pk_fma_f32 v[236:237], v[124:125], v[124:125], v[236:237]
    v_pk_add_f32 v[234:235], v[234:235], v[126:127]
    v_pk_fma_f32 v[238:239], v[126:127], v[126:127], v[238:239]
    v_pk_add_f32 v[232:233], v[232:233], v[128:129]
    v_pk_fma_f32 v[236:237], v[128:129], v[128:129], v[236:237]
    v_pk_add_f32 v[234:235], v[234:235], v[130:131]
    v_pk_fma_f32 v[238:239], v[130:131], v[130:131], v[238:239]
    v_pk_add_f32 v[232:233], v[232:233], v[132:133]
    v_pk_fma_f32 v[236:237], v[132:133], v[132:133], v[236:237]
    v_pk_add_f32 v[234:235], v[234:235], v[134:135]
    v_pk_fma_f32 v[238:239], v[134:135], v[134:135], v[238:239]
    v_pk_add_f32 v[232:233], v[232:233], v[136:137]
    v_pk_fma_f32 v[236:237], v[136:137], v[136:137], v[236:237]
    v_pk_add_f32 v[234:235], v[234:235], v[138:139]
    v_pk_fma_f32 v[238:239], v[138:139], v[138:139], v[238:239]
    v_pk_add_f32 v[232:233], v[232:233], v[140:141]
    v_pk_fma_f32 v[236:237], v[140:141], v[140:141], v[236:237]
    v_pk_add_f32 v[234:235], v[234:235], v[142:143]
    v_pk_fma_f32 v[238:239], v[142:143], v[142:143], v[238:239]
    v_pk_add_f32 v[232:233], v[232:233], v[144:145]
    v_pk_fma_f32 v[236:237], v[144:145], v[144:145], v[236:237]
    v_pk_add_f32 v[234:235], v[234:235], v[146:147]
    v_pk_fma_f32 v[238:239], v[146:147], v[146:147], v[238:239]
    v_pk_add_f32 v[232:233], v[232:233], v[148:149]
    v_pk_fma_f32 v[236:237], v[148:149], v[148:149], v[236:237]
    v_pk_add_f32 v[234:235], v[234:235], v[150:151]
    v_pk_fma_f32 v[238:239], v[150:151], v[150:151], v[238:239]
    v_pk_add_f32 v[232:233], v[232:233], v[152:153]
    v_pk_fma_f32 v[236:237], v[152:153], v[152:153], v[236:237]
    v_pk_add_f32 v[234:235], v[234:235], v[154:155]
    v_pk_fma_f32 v[238:239], v[154:155], v[154:155], v[238:239]
    v_pk_add_f32 v[232:233], v[232:233], v[156:157]
    v_pk_fma_f32 v[236:237], v[156:157], v[156:157], v[236:237]
    v_pk_add_f32 v[234:235], v[234:235], v[158:159]
    v_pk_fma_f32 v[238:239], v[158:159], v[158:159], v[238:239]
    v_pk_add_f32 v[232:233], v[232:233], v[160:161]
    v_pk_fma_f32 v[236:237], v[160:161], v[160:161], v[236:237]
    v_pk_add_f32 v[234:235], v[234:235], v[162:163]
    v_pk_fma_f32 v[238:239], v[162:163], v[162:163], v[238:239]
    v_pk_add_f32 v[232:233], v[232:233], v[164:165]
    v_pk_fma_f32 v[236:237], v[164:165], v[164:165], v[236:237]
    v_pk_add_f32 v[234:235], v[234:235], v[166:167]
    v_pk_fma_f32 v[238:239], v[166:167], v[166:167], v[238:239]
    v_pk_add_f32 v[232:233], v[232:233], v[168:169]
    v_pk_fma_f32 v[236:237], v[168:169], v[168:169], v[236:237]
    v_pk_add_f32 v[234:235], v[234:235], v[170:171]
    v_pk_fma_f32 v[238:239], v[170:171], v[170:171], v[238:239]
    v_pk_add_f32 v[232:233], v[232:233], v[172:173]
    v_pk_fma_f32 v[236:237], v[172:173], v[172:173], v[236:237]
    v_pk_add_f32 v[234:235], v[234:235], v[174:175]
    v_pk_fma_f32 v[238:239], v[174:175], v[174:175], v[238:239]
    v_pk_add_f32 v[232:233], v[232:233], v[176:177]
    v_pk_fma_f32 v[236:237], v[176:177], v[176:177], v[236:237]
    v_pk_add_f32 v[234:235], v[234:235], v[178:179]
    v_pk_fma_f32 v[238:239], v[178:179], v[178:179], v[238:239]
    v_pk_add_f32 v[232:233], v[232:233], v[180:181]
    v_pk_fma_f32 v[236:237], v[180:181], v[180:181], v[236:237]
    v_pk_add_f32 v[234:235], v[234:235], v[182:183]
    v_pk_fma_f32 v[238:239], v[182:183], v[182:183], v[238:239]
    v_pk_add_f32 v[232:233], v[232:233], v[184:185]
    v_pk_fma_f32 v[236:237], v[184:185], v[184:185], v[236:237]
    v_pk_add_f32 v[234:235], v[234:235], v[186:187]
    v_pk_fma_f32 v[238:239], v[186:187], v[186:187], v[238:239]
    v_pk_add_f32 v[232:233], v[232:233], v[188:189]
    v_pk_fma_f32 v[236:237], v[188:189], v[188:189], v[236:237]
    v_pk_add_f32 v[234:235], v[234:235], v[190:191]
    v_pk_fma_f32 v[238:239], v[190:191], v[190:191], v[238:239]

    s_nop 1
    v_permlane32_swap_b32 v232, v233
    v_permlane32_swap_b32 v234, v235
    v_permlane32_swap_b32 v236, v237
    v_permlane32_swap_b32 v238, v239

    v_add_f32 v232, v232, v233
    v_add_f32 v236, v236, v237
    v_mul_f32 v232, 0x3c2aaaab, v232
    v_mul_f32 v236, 0x3c2aaaab, v236
    v_fma_f32 v236, -v232, v232, v236
    v_max_f32 v236, 0, v236
    v_add_f32 v236, 0x3727c5ac, v236
    v_rsq_f32 v236, v236
    s_nop 0
    v_mul_f32 v232, v232, v236
    v_mul_f32 v236, 0x08000000, v236
    v_mul_f32 v232, 0x88000000, v232
    v_mov_b32 v237, v236
    v_mov_b32 v233, v232

    v_add_f32 v234, v234, v235
    v_add_f32 v238, v238, v239
    v_mul_f32 v234, 0x3c2aaaab, v234
    v_mul_f32 v238, 0x3c2aaaab, v238
    v_fma_f32 v238, -v234, v234, v238
    v_max_f32 v238, 0, v238
    v_add_f32 v238, 0x3727c5ac, v238
    v_rsq_f32 v238, v238
    s_nop 0
    v_mul_f32 v234, v234, v238
    v_mul_f32 v238, 0x08000000, v238
    v_mul_f32 v234, 0x88000000, v234
    v_mov_b32 v239, v238
    v_mov_b32 v235, v234

    s_nop 1
    v_permlane32_swap_b32 v232, v233
    v_permlane32_swap_b32 v234, v235
    v_permlane32_swap_b32 v236, v237
    v_permlane32_swap_b32 v238, v239

    v_pk_fma_f32 v[0:1], v[0:1], v[236:237], v[232:233]
    v_pk_fma_f32 v[2:3], v[2:3], v[238:239], v[234:235]
    v_pk_fma_f32 v[4:5], v[4:5], v[236:237], v[232:233]
    v_pk_fma_f32 v[6:7], v[6:7], v[238:239], v[234:235]
    v_pk_fma_f32 v[8:9], v[8:9], v[236:237], v[232:233]
    v_pk_fma_f32 v[10:11], v[10:11], v[238:239], v[234:235]
    v_pk_fma_f32 v[12:13], v[12:13], v[236:237], v[232:233]
    v_pk_fma_f32 v[14:15], v[14:15], v[238:239], v[234:235]
    v_pk_fma_f32 v[16:17], v[16:17], v[236:237], v[232:233]
    v_pk_fma_f32 v[18:19], v[18:19], v[238:239], v[234:235]
    v_pk_fma_f32 v[20:21], v[20:21], v[236:237], v[232:233]
    v_pk_fma_f32 v[22:23], v[22:23], v[238:239], v[234:235]
    v_pk_fma_f32 v[24:25], v[24:25], v[236:237], v[232:233]
    v_pk_fma_f32 v[26:27], v[26:27], v[238:239], v[234:235]
    v_pk_fma_f32 v[28:29], v[28:29], v[236:237], v[232:233]
    v_pk_fma_f32 v[30:31], v[30:31], v[238:239], v[234:235]
    v_pk_fma_f32 v[32:33], v[32:33], v[236:237], v[232:233]
    v_pk_fma_f32 v[34:35], v[34:35], v[238:239], v[234:235]
    v_pk_fma_f32 v[36:37], v[36:37], v[236:237], v[232:233]
    v_pk_fma_f32 v[38:39], v[38:39], v[238:239], v[234:235]
    v_pk_fma_f32 v[40:41], v[40:41], v[236:237], v[232:233]
    v_pk_fma_f32 v[42:43], v[42:43], v[238:239], v[234:235]
    v_pk_fma_f32 v[44:45], v[44:45], v[236:237], v[232:233]
    v_pk_fma_f32 v[46:47], v[46:47], v[238:239], v[234:235]
    v_pk_fma_f32 v[48:49], v[48:49], v[236:237], v[232:233]
    v_pk_fma_f32 v[50:51], v[50:51], v[238:239], v[234:235]
    v_pk_fma_f32 v[52:53], v[52:53], v[236:237], v[232:233]
    v_pk_fma_f32 v[54:55], v[54:55], v[238:239], v[234:235]
    v_pk_fma_f32 v[56:57], v[56:57], v[236:237], v[232:233]
    v_pk_fma_f32 v[58:59], v[58:59], v[238:239], v[234:235]
    v_pk_fma_f32 v[60:61], v[60:61], v[236:237], v[232:233]
    v_pk_fma_f32 v[62:63], v[62:63], v[238:239], v[234:235]
    v_cvt_pk_bf16_f32 v192, v0, v4
    v_cvt_pk_bf16_f32 v193, v8, v12
    v_cvt_pk_bf16_f32 v194, v16, v20
    v_cvt_pk_bf16_f32 v195, v24, v28
    v_cvt_pk_bf16_f32 v200, v32, v36
    v_cvt_pk_bf16_f32 v201, v40, v44
    v_cvt_pk_bf16_f32 v202, v48, v52
    v_cvt_pk_bf16_f32 v203, v56, v60
    v_cvt_pk_bf16_f32 v196, v1, v5
    v_cvt_pk_bf16_f32 v197, v9, v13
    v_cvt_pk_bf16_f32 v198, v17, v21
    v_cvt_pk_bf16_f32 v199, v25, v29
    v_cvt_pk_bf16_f32 v204, v33, v37
    v_cvt_pk_bf16_f32 v205, v41, v45
    v_cvt_pk_bf16_f32 v206, v49, v53
    v_cvt_pk_bf16_f32 v207, v57, v61
    v_cvt_pk_bf16_f32 v208, v2, v6
    v_cvt_pk_bf16_f32 v209, v10, v14
    v_cvt_pk_bf16_f32 v210, v18, v22
    v_cvt_pk_bf16_f32 v211, v26, v30
    v_cvt_pk_bf16_f32 v216, v34, v38
    v_cvt_pk_bf16_f32 v217, v42, v46
    v_cvt_pk_bf16_f32 v218, v50, v54
    v_cvt_pk_bf16_f32 v219, v58, v62
    v_cvt_pk_bf16_f32 v212, v3, v7
    v_cvt_pk_bf16_f32 v213, v11, v15
    v_cvt_pk_bf16_f32 v214, v19, v23
    v_cvt_pk_bf16_f32 v215, v27, v31
    v_cvt_pk_bf16_f32 v220, v35, v39
    v_cvt_pk_bf16_f32 v221, v43, v47
    v_cvt_pk_bf16_f32 v222, v51, v55
    v_cvt_pk_bf16_f32 v223, v59, v63
    s_nop 0
    v_permlane16_swap_b32 v192, v200
    v_permlane16_swap_b32 v193, v201
    v_permlane16_swap_b32 v194, v202
    v_permlane16_swap_b32 v195, v203
    v_permlane16_swap_b32 v196, v204
    v_permlane16_swap_b32 v197, v205
    v_permlane16_swap_b32 v198, v206
    v_permlane16_swap_b32 v199, v207
    v_permlane16_swap_b32 v208, v216
    v_permlane16_swap_b32 v209, v217
    v_permlane16_swap_b32 v210, v218
    v_permlane16_swap_b32 v211, v219
    v_permlane16_swap_b32 v212, v220
    v_permlane16_swap_b32 v213, v221
    v_permlane16_swap_b32 v214, v222
    v_permlane16_swap_b32 v215, v223
    v_mov_b32 v0, v208
    v_mov_b32 v1, v209
    v_mov_b32 v2, v210
    v_mov_b32 v3, v211
    v_mov_b32 v4, v212
    v_mov_b32 v5, v213
    v_mov_b32 v6, v214
    v_mov_b32 v7, v215
    v_mov_b32 v8, v216
    v_mov_b32 v9, v217
    v_mov_b32 v10, v218
    v_mov_b32 v11, v219
    v_mov_b32 v12, v220
    v_mov_b32 v13, v221
    v_mov_b32 v14, v222
    v_mov_b32 v15, v223
    v_pk_fma_f32 v[64:65], v[64:65], v[236:237], v[232:233]
    v_pk_fma_f32 v[66:67], v[66:67], v[238:239], v[234:235]
    v_pk_fma_f32 v[68:69], v[68:69], v[236:237], v[232:233]
    v_pk_fma_f32 v[70:71], v[70:71], v[238:239], v[234:235]
    v_pk_fma_f32 v[72:73], v[72:73], v[236:237], v[232:233]
    v_pk_fma_f32 v[74:75], v[74:75], v[238:239], v[234:235]
    v_pk_fma_f32 v[76:77], v[76:77], v[236:237], v[232:233]
    v_pk_fma_f32 v[78:79], v[78:79], v[238:239], v[234:235]
    v_pk_fma_f32 v[80:81], v[80:81], v[236:237], v[232:233]
    v_pk_fma_f32 v[82:83], v[82:83], v[238:239], v[234:235]
    v_pk_fma_f32 v[84:85], v[84:85], v[236:237], v[232:233]
    v_pk_fma_f32 v[86:87], v[86:87], v[238:239], v[234:235]
    v_pk_fma_f32 v[88:89], v[88:89], v[236:237], v[232:233]
    v_pk_fma_f32 v[90:91], v[90:91], v[238:239], v[234:235]
    v_pk_fma_f32 v[92:93], v[92:93], v[236:237], v[232:233]
    v_pk_fma_f32 v[94:95], v[94:95], v[238:239], v[234:235]
    v_pk_fma_f32 v[96:97], v[96:97], v[236:237], v[232:233]
    v_pk_fma_f32 v[98:99], v[98:99], v[238:239], v[234:235]
    v_pk_fma_f32 v[100:101], v[100:101], v[236:237], v[232:233]
    v_pk_fma_f32 v[102:103], v[102:103], v[238:239], v[234:235]
    v_pk_fma_f32 v[104:105], v[104:105], v[236:237], v[232:233]
    v_pk_fma_f32 v[106:107], v[106:107], v[238:239], v[234:235]
    v_pk_fma_f32 v[108:109], v[108:109], v[236:237], v[232:233]
    v_pk_fma_f32 v[110:111], v[110:111], v[238:239], v[234:235]
    v_pk_fma_f32 v[112:113], v[112:113], v[236:237], v[232:233]
    v_pk_fma_f32 v[114:115], v[114:115], v[238:239], v[234:235]
    v_pk_fma_f32 v[116:117], v[116:117], v[236:237], v[232:233]
    v_pk_fma_f32 v[118:119], v[118:119], v[238:239], v[234:235]
    v_pk_fma_f32 v[120:121], v[120:121], v[236:237], v[232:233]
    v_pk_fma_f32 v[122:123], v[122:123], v[238:239], v[234:235]
    v_pk_fma_f32 v[124:125], v[124:125], v[236:237], v[232:233]
    v_pk_fma_f32 v[126:127], v[126:127], v[238:239], v[234:235]
    v_cvt_pk_bf16_f32 v48, v64, v68
    v_cvt_pk_bf16_f32 v49, v72, v76
    v_cvt_pk_bf16_f32 v50, v80, v84
    v_cvt_pk_bf16_f32 v51, v88, v92
    v_cvt_pk_bf16_f32 v56, v96, v100
    v_cvt_pk_bf16_f32 v57, v104, v108
    v_cvt_pk_bf16_f32 v58, v112, v116
    v_cvt_pk_bf16_f32 v59, v120, v124
    v_cvt_pk_bf16_f32 v52, v65, v69
    v_cvt_pk_bf16_f32 v53, v73, v77
    v_cvt_pk_bf16_f32 v54, v81, v85
    v_cvt_pk_bf16_f32 v55, v89, v93
    v_cvt_pk_bf16_f32 v60, v97, v101
    v_cvt_pk_bf16_f32 v61, v105, v109
    v_cvt_pk_bf16_f32 v62, v113, v117
    v_cvt_pk_bf16_f32 v63, v121, v125
    v_cvt_pk_bf16_f32 v16, v66, v70
    v_cvt_pk_bf16_f32 v17, v74, v78
    v_cvt_pk_bf16_f32 v18, v82, v86
    v_cvt_pk_bf16_f32 v19, v90, v94
    v_cvt_pk_bf16_f32 v24, v98, v102
    v_cvt_pk_bf16_f32 v25, v106, v110
    v_cvt_pk_bf16_f32 v26, v114, v118
    v_cvt_pk_bf16_f32 v27, v122, v126
    v_cvt_pk_bf16_f32 v20, v67, v71
    v_cvt_pk_bf16_f32 v21, v75, v79
    v_cvt_pk_bf16_f32 v22, v83, v87
    v_cvt_pk_bf16_f32 v23, v91, v95
    v_cvt_pk_bf16_f32 v28, v99, v103
    v_cvt_pk_bf16_f32 v29, v107, v111
    v_cvt_pk_bf16_f32 v30, v115, v119
    v_cvt_pk_bf16_f32 v31, v123, v127
    s_nop 0
    v_permlane16_swap_b32 v48, v56
    v_permlane16_swap_b32 v49, v57
    v_permlane16_swap_b32 v50, v58
    v_permlane16_swap_b32 v51, v59
    v_permlane16_swap_b32 v52, v60
    v_permlane16_swap_b32 v53, v61
    v_permlane16_swap_b32 v54, v62
    v_permlane16_swap_b32 v55, v63
    v_permlane16_swap_b32 v16, v24
    v_permlane16_swap_b32 v17, v25
    v_permlane16_swap_b32 v18, v26
    v_permlane16_swap_b32 v19, v27
    v_permlane16_swap_b32 v20, v28
    v_permlane16_swap_b32 v21, v29
    v_permlane16_swap_b32 v22, v30
    v_permlane16_swap_b32 v23, v31
    v_mov_b32 v80, v192
    v_mov_b32 v81, v193
    v_mov_b32 v82, v194
    v_mov_b32 v83, v195
    v_mov_b32 v84, v196
    v_mov_b32 v85, v197
    v_mov_b32 v86, v198
    v_mov_b32 v87, v199
    v_mov_b32 v88, v200
    v_mov_b32 v89, v201
    v_mov_b32 v90, v202
    v_mov_b32 v91, v203
    v_mov_b32 v92, v204
    v_mov_b32 v93, v205
    v_mov_b32 v94, v206
    v_mov_b32 v95, v207
    v_pk_fma_f32 v[128:129], v[128:129], v[236:237], v[232:233]
    v_pk_fma_f32 v[130:131], v[130:131], v[238:239], v[234:235]
    v_pk_fma_f32 v[132:133], v[132:133], v[236:237], v[232:233]
    v_pk_fma_f32 v[134:135], v[134:135], v[238:239], v[234:235]
    v_pk_fma_f32 v[136:137], v[136:137], v[236:237], v[232:233]
    v_pk_fma_f32 v[138:139], v[138:139], v[238:239], v[234:235]
    v_pk_fma_f32 v[140:141], v[140:141], v[236:237], v[232:233]
    v_pk_fma_f32 v[142:143], v[142:143], v[238:239], v[234:235]
    v_pk_fma_f32 v[144:145], v[144:145], v[236:237], v[232:233]
    v_pk_fma_f32 v[146:147], v[146:147], v[238:239], v[234:235]
    v_pk_fma_f32 v[148:149], v[148:149], v[236:237], v[232:233]
    v_pk_fma_f32 v[150:151], v[150:151], v[238:239], v[234:235]
    v_pk_fma_f32 v[152:153], v[152:153], v[236:237], v[232:233]
    v_pk_fma_f32 v[154:155], v[154:155], v[238:239], v[234:235]
    v_pk_fma_f32 v[156:157], v[156:157], v[236:237], v[232:233]
    v_pk_fma_f32 v[158:159], v[158:159], v[238:239], v[234:235]
    v_pk_fma_f32 v[160:161], v[160:161], v[236:237], v[232:233]
    v_pk_fma_f32 v[162:163], v[162:163], v[238:239], v[234:235]
    v_pk_fma_f32 v[164:165], v[164:165], v[236:237], v[232:233]
    v_pk_fma_f32 v[166:167], v[166:167], v[238:239], v[234:235]
    v_pk_fma_f32 v[168:169], v[168:169], v[236:237], v[232:233]
    v_pk_fma_f32 v[170:171], v[170:171], v[238:239], v[234:235]
    v_pk_fma_f32 v[172:173], v[172:173], v[236:237], v[232:233]
    v_pk_fma_f32 v[174:175], v[174:175], v[238:239], v[234:235]
    v_pk_fma_f32 v[176:177], v[176:177], v[236:237], v[232:233]
    v_pk_fma_f32 v[178:179], v[178:179], v[238:239], v[234:235]
    v_pk_fma_f32 v[180:181], v[180:181], v[236:237], v[232:233]
    v_pk_fma_f32 v[182:183], v[182:183], v[238:239], v[234:235]
    v_pk_fma_f32 v[184:185], v[184:185], v[236:237], v[232:233]
    v_pk_fma_f32 v[186:187], v[186:187], v[238:239], v[234:235]
    v_pk_fma_f32 v[188:189], v[188:189], v[236:237], v[232:233]
    v_pk_fma_f32 v[190:191], v[190:191], v[238:239], v[234:235]
    v_cvt_pk_bf16_f32 v64, v128, v132
    v_cvt_pk_bf16_f32 v65, v136, v140
    v_cvt_pk_bf16_f32 v66, v144, v148
    v_cvt_pk_bf16_f32 v67, v152, v156
    v_cvt_pk_bf16_f32 v72, v160, v164
    v_cvt_pk_bf16_f32 v73, v168, v172
    v_cvt_pk_bf16_f32 v74, v176, v180
    v_cvt_pk_bf16_f32 v75, v184, v188
    v_cvt_pk_bf16_f32 v68, v129, v133
    v_cvt_pk_bf16_f32 v69, v137, v141
    v_cvt_pk_bf16_f32 v70, v145, v149
    v_cvt_pk_bf16_f32 v71, v153, v157
    v_cvt_pk_bf16_f32 v76, v161, v165
    v_cvt_pk_bf16_f32 v77, v169, v173
    v_cvt_pk_bf16_f32 v78, v177, v181
    v_cvt_pk_bf16_f32 v79, v185, v189
    v_cvt_pk_bf16_f32 v32, v130, v134
    v_cvt_pk_bf16_f32 v33, v138, v142
    v_cvt_pk_bf16_f32 v34, v146, v150
    v_cvt_pk_bf16_f32 v35, v154, v158
    v_cvt_pk_bf16_f32 v40, v162, v166
    v_cvt_pk_bf16_f32 v41, v170, v174
    v_cvt_pk_bf16_f32 v42, v178, v182
    v_cvt_pk_bf16_f32 v43, v186, v190
    v_cvt_pk_bf16_f32 v36, v131, v135
    v_cvt_pk_bf16_f32 v37, v139, v143
    v_cvt_pk_bf16_f32 v38, v147, v151
    v_cvt_pk_bf16_f32 v39, v155, v159
    v_cvt_pk_bf16_f32 v44, v163, v167
    v_cvt_pk_bf16_f32 v45, v171, v175
    v_cvt_pk_bf16_f32 v46, v179, v183
    v_cvt_pk_bf16_f32 v47, v187, v191
    s_nop 0
    v_permlane16_swap_b32 v64, v72
    v_permlane16_swap_b32 v65, v73
    v_permlane16_swap_b32 v66, v74
    v_permlane16_swap_b32 v67, v75
    v_permlane16_swap_b32 v68, v76
    v_permlane16_swap_b32 v69, v77
    v_permlane16_swap_b32 v70, v78
    v_permlane16_swap_b32 v71, v79
    v_permlane16_swap_b32 v32, v40
    v_permlane16_swap_b32 v33, v41
    v_permlane16_swap_b32 v34, v42
    v_permlane16_swap_b32 v35, v43
    v_permlane16_swap_b32 v36, v44
    v_permlane16_swap_b32 v37, v45
    v_permlane16_swap_b32 v38, v46
    v_permlane16_swap_b32 v39, v47

    s_mov_b32 s18, 8
    s_mov_b32 s38, 1
    s_sub_u32 s26, s16, 1
    s_cmp_lt_u32 s26, 0
    s_cbranch_scc1 L_p2
    s_mov_b32 s38, 0

    v_lshrrev_b32 v232, 7, v253
    v_mul_u32_u24 v232, 640, v232
    v_add_u32 v232, v232, v253
    v_add_u32 v233, 196608, v232
    buffer_store_dwordx4 v[48:51], v232, s[8:11], s36 offen offset:0 sc1
    buffer_store_dwordx4 v[52:55], v232, s[8:11], s36 offen offset:128 sc1
    buffer_store_dwordx4 v[56:59], v232, s[8:11], s36 offen offset:256 sc1
    buffer_store_dwordx4 v[60:63], v232, s[8:11], s37 offen offset:0 sc1
    buffer_store_dwordx4 v[64:67], v232, s[8:11], s37 offen offset:128 sc1
    buffer_store_dwordx4 v[68:71], v232, s[8:11], s37 offen offset:256 sc1
    buffer_store_dwordx4 v[72:75], v233, s[8:11], s36 offen offset:0 sc1
    buffer_store_dwordx4 v[76:79], v233, s[8:11], s36 offen offset:128 sc1
    buffer_store_dwordx4 v[80:83], v233, s[8:11], s36 offen offset:256 sc1
    buffer_store_dwordx4 v[84:87], v233, s[8:11], s37 offen offset:0 sc1
    buffer_store_dwordx4 v[88:91], v233, s[8:11], s37 offen offset:128 sc1
    buffer_store_dwordx4 v[92:95], v233, s[8:11], s37 offen offset:256 sc1

    s_cmp_lg_u32 s16, 0
    s_cbranch_scc1 L_p2
    s_setprio 3
    s_branch L_xload
L_loader:

    v_lshrrev_b32 v60, 9, v253
    v_mul_u32_u24 v61, 1536, v60
    v_add_u32 v61, v61, v253
    v_bfe_u32 v254, v253, 6, 3
    v_lshl_add_u32 v60, v60, 4, v254
    v_mul_u32_u24 v60, 768, v60
    v_and_b32 v254, 48, v253
    v_add_u32 v60, v60, v254

    v_add_u32 v254, 161932, v240

    s_mov_b32 s29, 200000
L_wg1:
    ds_read_b32 v255, v254
    s_waitcnt lgkmcnt(0)
    v_cmp_ne_u32 vcc, 0, v255
    s_cmp_eq_u64 vcc, exec
    s_cbranch_scc1 L_wg1_ok
    s_sleep 2
    s_sub_u32 s29, s29, 1
    s_cmp_lg_u32 s29, 0
    s_cbranch_scc1 L_wg1
L_wg1_ok:

    s_add_u32 s26, s39, 1
    s_cmp_ge_u32 s26, 12
    s_cselect_b32 s27, 12, 0
    s_sub_u32 s26, s26, s27
    s_mul_i32 s26, s26, 6144

    s_mov_b32 m0, 7168
    s_add_u32 s30, s26, 0
    s_add_u32 s31, s26, 1536
    buffer_load_dwordx4 v253, s[44:47], s30 offen lds
    buffer_load_dwordx4 v61, s[44:47], s30 offen offset:1024 lds
    buffer_load_dwordx4 v253, s[44:47], s31 offen offset:2048 lds
    s_mov_b32 m0, 72712
    s_add_u32 s30, s26, 1536
    s_add_u32 s31, s26, 3072
    buffer_load_dwordx4 v253, s[44:47], s30 offen lds
    buffer_load_dwordx4 v61, s[44:47], s30 offen offset:1024 lds
    buffer_load_dwordx4 v253, s[44:47], s31 offen offset:2048 lds

    s_add_u32 s26, s39, 4
    s_cmp_ge_u32 s26, 12
    s_cselect_b32 s27, 12, 0
    s_sub_u32 s26, s26, s27
    s_mul_i32 s26, s26, 64

    s_mov_b32 m0, 10240
    s_add_u32 s30, s26, 0
    s_add_u32 s31, s26, 23552
    s_add_u32 s32, s26, 47104
    buffer_load_dwordx4 v60, s[40:43], s30 offen offset:0 lds
    buffer_load_dwordx4 v60, s[40:43], s31 offen offset:1024 lds
    buffer_load_dwordx4 v60, s[40:43], s32 offen offset:2048 lds
    s_mov_b32 m0, 75784
    s_add_u32 s30, s26, 6144
    s_add_u32 s31, s26, 29696
    s_add_u32 s32, s26, 53248
    buffer_load_dwordx4 v60, s[40:43], s30 offen offset:0 lds
    buffer_load_dwordx4 v60, s[40:43], s31 offen offset:1024 lds
    buffer_load_dwordx4 v60, s[40:43], s32 offen offset:2048 lds

    s_add_u32 s26, s39, 2
    s_cmp_ge_u32 s26, 12
    s_cselect_b32 s27, 12, 0
    s_sub_u32 s26, s26, s27
    s_mul_i32 s26, s26, 6144

    s_mov_b32 m0, 13312
    s_add_u32 s30, s26, 0
    s_add_u32 s31, s26, 1536
    buffer_load_dwordx4 v253, s[44:47], s30 offen lds
    buffer_load_dwordx4 v61, s[44:47], s30 offen offset:1024 lds
    buffer_load_dwordx4 v253, s[44:47], s31 offen offset:2048 lds
    s_mov_b32 m0, 78856
    s_add_u32 s30, s26, 1536
    s_add_u32 s31, s26, 3072
    buffer_load_dwordx4 v253, s[44:47], s30 offen lds
    buffer_load_dwordx4 v61, s[44:47], s30 offen offset:1024 lds
    buffer_load_dwordx4 v253, s[44:47], s31 offen offset:2048 lds

    s_add_u32 s26, s39, 5
    s_cmp_ge_u32 s26, 12
    s_cselect_b32 s27, 12, 0
    s_sub_u32 s26, s26, s27
    s_mul_i32 s26, s26, 64

    s_mov_b32 m0, 16384
    s_add_u32 s30, s26, 0
    s_add_u32 s31, s26, 23552
    s_add_u32 s32, s26, 47104
    buffer_load_dwordx4 v60, s[40:43], s30 offen offset:0 lds
    buffer_load_dwordx4 v60, s[40:43], s31 offen offset:1024 lds
    buffer_load_dwordx4 v60, s[40:43], s32 offen offset:2048 lds
    s_mov_b32 m0, 81928
    s_add_u32 s30, s26, 6144
    s_add_u32 s31, s26, 29696
    s_add_u32 s32, s26, 53248
    buffer_load_dwordx4 v60, s[40:43], s30 offen offset:0 lds
    buffer_load_dwordx4 v60, s[40:43], s31 offen offset:1024 lds
    buffer_load_dwordx4 v60, s[40:43], s32 offen offset:2048 lds
    v_mov_b32 v254, 161976

    s_mov_b32 s29, 200000
L_wo1:
    ds_read_b32 v255, v254
    s_waitcnt lgkmcnt(0)
    v_cmp_eq_u32 vcc, 5, v255
    s_cmp_eq_u64 vcc, exec
    s_cbranch_scc1 L_wo1_ok
    s_sleep 2
    s_sub_u32 s29, s29, 1
    s_cmp_lg_u32 s29, 0
    s_cbranch_scc1 L_wo1
L_wo1_ok:

    v_mov_b32 v254, 161976
    v_mov_b32 v64, 6
    s_waitcnt vmcnt(18)
    ds_write_b32 v254, v64
    v_mov_b32 v65, 7
    s_waitcnt vmcnt(12)
    ds_write_b32 v254, v65
    v_mov_b32 v66, 8
    s_waitcnt vmcnt(6)
    ds_write_b32 v254, v66
    v_mov_b32 v67, 9
    s_waitcnt vmcnt(0)
    ds_write_b32 v254, v67
    v_add_u32 v254, 161940, v240

    s_mov_b32 s29, 200000
L_wg2:
    ds_read_b32 v255, v254
    s_waitcnt lgkmcnt(0)
    v_cmp_ne_u32 vcc, 0, v255
    s_cmp_eq_u64 vcc, exec
    s_cbranch_scc1 L_wg2_ok
    s_sleep 2
    s_sub_u32 s29, s29, 1
    s_cmp_lg_u32 s29, 0
    s_cbranch_scc1 L_wg2
L_wg2_ok:

    s_add_u32 s26, s39, 3
    s_cmp_ge_u32 s26, 12
    s_cselect_b32 s27, 12, 0
    s_sub_u32 s26, s26, s27
    s_mul_i32 s26, s26, 6144

    s_mov_b32 m0, 19456
    s_add_u32 s30, s26, 0
    s_add_u32 s31, s26, 1536
    buffer_load_dwordx4 v253, s[44:47], s30 offen lds
    buffer_load_dwordx4 v61, s[44:47], s30 offen offset:1024 lds
    buffer_load_dwordx4 v253, s[44:47], s31 offen offset:2048 lds
    s_mov_b32 m0, 85000
    s_add_u32 s30, s26, 1536
    s_add_u32 s31, s26, 3072
    buffer_load_dwordx4 v253, s[44:47], s30 offen lds
    buffer_load_dwordx4 v61, s[44:47], s30 offen offset:1024 lds
    buffer_load_dwordx4 v253, s[44:47], s31 offen offset:2048 lds

    s_add_u32 s26, s39, 6
    s_cmp_ge_u32 s26, 12
    s_cselect_b32 s27, 12, 0
    s_sub_u32 s26, s26, s27
    s_mul_i32 s26, s26, 64

    s_mov_b32 m0, 22528
    s_add_u32 s30, s26, 0
    s_add_u32 s31, s26, 23552
    s_add_u32 s32, s26, 47104
    buffer_load_dwordx4 v60, s[40:43], s30 offen offset:0 lds
    buffer_load_dwordx4 v60, s[40:43], s31 offen offset:1024 lds
    buffer_load_dwordx4 v60, s[40:43], s32 offen offset:2048 lds
    s_mov_b32 m0, 88072
    s_add_u32 s30, s26, 6144
    s_add_u32 s31, s26, 29696
    s_add_u32 s32, s26, 53248
    buffer_load_dwordx4 v60, s[40:43], s30 offen offset:0 lds
    buffer_load_dwordx4 v60, s[40:43], s31 offen offset:1024 lds
    buffer_load_dwordx4 v60, s[40:43], s32 offen offset:2048 lds

    s_add_u32 s26, s39, 4
    s_cmp_ge_u32 s26, 12
    s_cselect_b32 s27, 12, 0
    s_sub_u32 s26, s26, s27
    s_mul_i32 s26, s26, 6144

    s_mov_b32 m0, 25600
    s_add_u32 s30, s26, 0
    s_add_u32 s31, s26, 1536
    buffer_load_dwordx4 v253, s[44:47], s30 offen lds
    buffer_load_dwordx4 v61, s[44:47], s30 offen offset:1024 lds
    buffer_load_dwordx4 v253, s[44:47], s31 offen offset:2048 lds
    s_mov_b32 m0, 91144
    s_add_u32 s30, s26, 1536
    s_add_u32 s31, s26, 3072
    buffer_load_dwordx4 v253, s[44:47], s30 offen lds
    buffer_load_dwordx4 v61, s[44:47], s30 offen offset:1024 lds
    buffer_load_dwordx4 v253, s[44:47], s31 offen offset:2048 lds

    s_add_u32 s26, s39, 7
    s_cmp_ge_u32 s26, 12
    s_cselect_b32 s27, 12, 0
    s_sub_u32 s26, s26, s27
    s_mul_i32 s26, s26, 64

    s_mov_b32 m0, 28672
    s_add_u32 s30, s26, 0
    s_add_u32 s31, s26, 23552
    s_add_u32 s32, s26, 47104
    buffer_load_dwordx4 v60, s[40:43], s30 offen offset:0 lds
    buffer_load_dwordx4 v60, s[40:43], s31 offen offset:1024 lds
    buffer_load_dwordx4 v60, s[40:43], s32 offen offset:2048 lds
    s_mov_b32 m0, 94216
    s_add_u32 s30, s26, 6144
    s_add_u32 s31, s26, 29696
    s_add_u32 s32, s26, 53248
    buffer_load_dwordx4 v60, s[40:43], s30 offen offset:0 lds
    buffer_load_dwordx4 v60, s[40:43], s31 offen offset:1024 lds
    buffer_load_dwordx4 v60, s[40:43], s32 offen offset:2048 lds

    s_add_u32 s26, s39, 5
    s_cmp_ge_u32 s26, 12
    s_cselect_b32 s27, 12, 0
    s_sub_u32 s26, s26, s27
    s_mul_i32 s26, s26, 6144

    s_mov_b32 m0, 31744
    s_add_u32 s30, s26, 0
    s_add_u32 s31, s26, 1536
    buffer_load_dwordx4 v253, s[44:47], s30 offen lds
    buffer_load_dwordx4 v61, s[44:47], s30 offen offset:1024 lds
    buffer_load_dwordx4 v253, s[44:47], s31 offen offset:2048 lds
    s_mov_b32 m0, 97288
    s_add_u32 s30, s26, 1536
    s_add_u32 s31, s26, 3072
    buffer_load_dwordx4 v253, s[44:47], s30 offen lds
    buffer_load_dwordx4 v61, s[44:47], s30 offen offset:1024 lds
    buffer_load_dwordx4 v253, s[44:47], s31 offen offset:2048 lds
    v_mov_b32 v254, 161976
    v_mov_b32 v64, 10
    s_waitcnt vmcnt(24)
    ds_write_b32 v254, v64
    v_mov_b32 v65, 11
    s_waitcnt vmcnt(18)
    ds_write_b32 v254, v65
    v_mov_b32 v66, 12
    s_waitcnt vmcnt(12)
    ds_write_b32 v254, v66
    v_mov_b32 v67, 13
    s_waitcnt vmcnt(6)
    ds_write_b32 v254, v67
    v_mov_b32 v68, 14
    s_waitcnt vmcnt(0)
    ds_write_b32 v254, v68
    v_add_u32 v254, 161948, v240

    s_mov_b32 s29, 200000
L_wg3:
    ds_read_b32 v255, v254
    s_waitcnt lgkmcnt(0)
    v_cmp_ne_u32 vcc, 0, v255
    s_cmp_eq_u64 vcc, exec
    s_cbranch_scc1 L_wg3_ok
    s_sleep 2
    s_sub_u32 s29, s29, 1
    s_cmp_lg_u32 s29, 0
    s_cbranch_scc1 L_wg3
L_wg3_ok:

    s_add_u32 s26, s39, 8
    s_cmp_ge_u32 s26, 12
    s_cselect_b32 s27, 12, 0
    s_sub_u32 s26, s26, s27
    s_mul_i32 s26, s26, 64

    s_mov_b32 m0, 34816
    s_add_u32 s30, s26, 0
    s_add_u32 s31, s26, 23552
    s_add_u32 s32, s26, 47104
    buffer_load_dwordx4 v60, s[40:43], s30 offen offset:0 lds
    buffer_load_dwordx4 v60, s[40:43], s31 offen offset:1024 lds
    buffer_load_dwordx4 v60, s[40:43], s32 offen offset:2048 lds
    s_mov_b32 m0, 100360
    s_add_u32 s30, s26, 6144
    s_add_u32 s31, s26, 29696
    s_add_u32 s32, s26, 53248
    buffer_load_dwordx4 v60, s[40:43], s30 offen offset:0 lds
    buffer_load_dwordx4 v60, s[40:43], s31 offen offset:1024 lds
    buffer_load_dwordx4 v60, s[40:43], s32 offen offset:2048 lds

    s_add_u32 s26, s39, 6
    s_cmp_ge_u32 s26, 12
    s_cselect_b32 s27, 12, 0
    s_sub_u32 s26, s26, s27
    s_mul_i32 s26, s26, 6144

    s_mov_b32 m0, 37888
    s_add_u32 s30, s26, 0
    s_add_u32 s31, s26, 1536
    buffer_load_dwordx4 v253, s[44:47], s30 offen lds
    buffer_load_dwordx4 v61, s[44:47], s30 offen offset:1024 lds
    buffer_load_dwordx4 v253, s[44:47], s31 offen offset:2048 lds
    s_mov_b32 m0, 103432
    s_add_u32 s30, s26, 1536
    s_add_u32 s31, s26, 3072
    buffer_load_dwordx4 v253, s[44:47], s30 offen lds
    buffer_load_dwordx4 v61, s[44:47], s30 offen offset:1024 lds
    buffer_load_dwordx4 v253, s[44:47], s31 offen offset:2048 lds

    s_add_u32 s26, s39, 9
    s_cmp_ge_u32 s26, 12
    s_cselect_b32 s27, 12, 0
    s_sub_u32 s26, s26, s27
    s_mul_i32 s26, s26, 64

    s_mov_b32 m0, 40960
    s_add_u32 s30, s26, 0
    s_add_u32 s31, s26, 23552
    s_add_u32 s32, s26, 47104
    buffer_load_dwordx4 v60, s[40:43], s30 offen offset:0 lds
    buffer_load_dwordx4 v60, s[40:43], s31 offen offset:1024 lds
    buffer_load_dwordx4 v60, s[40:43], s32 offen offset:2048 lds
    s_mov_b32 m0, 106504
    s_add_u32 s30, s26, 6144
    s_add_u32 s31, s26, 29696
    s_add_u32 s32, s26, 53248
    buffer_load_dwordx4 v60, s[40:43], s30 offen offset:0 lds
    buffer_load_dwordx4 v60, s[40:43], s31 offen offset:1024 lds
    buffer_load_dwordx4 v60, s[40:43], s32 offen offset:2048 lds

    s_add_u32 s26, s39, 7
    s_cmp_ge_u32 s26, 12
    s_cselect_b32 s27, 12, 0
    s_sub_u32 s26, s26, s27
    s_mul_i32 s26, s26, 6144

    s_mov_b32 m0, 44032
    s_add_u32 s30, s26, 0
    s_add_u32 s31, s26, 1536
    buffer_load_dwordx4 v253, s[44:47], s30 offen lds
    buffer_load_dwordx4 v61, s[44:47], s30 offen offset:1024 lds
    buffer_load_dwordx4 v253, s[44:47], s31 offen offset:2048 lds
    s_mov_b32 m0, 109576
    s_add_u32 s30, s26, 1536
    s_add_u32 s31, s26, 3072
    buffer_load_dwordx4 v253, s[44:47], s30 offen lds
    buffer_load_dwordx4 v61, s[44:47], s30 offen offset:1024 lds
    buffer_load_dwordx4 v253, s[44:47], s31 offen offset:2048 lds

    s_add_u32 s26, s39, 10
    s_cmp_ge_u32 s26, 12
    s_cselect_b32 s27, 12, 0
    s_sub_u32 s26, s26, s27
    s_mul_i32 s26, s26, 64

    s_mov_b32 m0, 47104
    s_add_u32 s30, s26, 0
    s_add_u32 s31, s26, 23552
    s_add_u32 s32, s26, 47104
    buffer_load_dwordx4 v60, s[40:43], s30 offen offset:0 lds
    buffer_load_dwordx4 v60, s[40:43], s31 offen offset:1024 lds
    buffer_load_dwordx4 v60, s[40:43], s32 offen offset:2048 lds
    s_mov_b32 m0, 112648
    s_add_u32 s30, s26, 6144
    s_add_u32 s31, s26, 29696
    s_add_u32 s32, s26, 53248
    buffer_load_dwordx4 v60, s[40:43], s30 offen offset:0 lds
    buffer_load_dwordx4 v60, s[40:43], s31 offen offset:1024 lds
    buffer_load_dwordx4 v60, s[40:43], s32 offen offset:2048 lds

    s_add_u32 s26, s39, 8
    s_cmp_ge_u32 s26, 12
    s_cselect_b32 s27, 12, 0
    s_sub_u32 s26, s26, s27
    s_mul_i32 s26, s26, 6144

    s_mov_b32 m0, 50176
    s_add_u32 s30, s26, 0
    s_add_u32 s31, s26, 1536
    buffer_load_dwordx4 v253, s[44:47], s30 offen lds
    buffer_load_dwordx4 v61, s[44:47], s30 offen offset:1024 lds
    buffer_load_dwordx4 v253, s[44:47], s31 offen offset:2048 lds
    s_mov_b32 m0, 115720
    s_add_u32 s30, s26, 1536
    s_add_u32 s31, s26, 3072
    buffer_load_dwordx4 v253, s[44:47], s30 offen lds
    buffer_load_dwordx4 v61, s[44:47], s30 offen offset:1024 lds
    buffer_load_dwordx4 v253, s[44:47], s31 offen offset:2048 lds

    s_add_u32 s26, s39, 11
    s_cmp_ge_u32 s26, 12
    s_cselect_b32 s27, 12, 0
    s_sub_u32 s26, s26, s27
    s_mul_i32 s26, s26, 64

    s_mov_b32 m0, 53248
    s_add_u32 s30, s26, 0
    s_add_u32 s31, s26, 23552
    s_add_u32 s32, s26, 47104
    buffer_load_dwordx4 v60, s[40:43], s30 offen offset:0 lds
    buffer_load_dwordx4 v60, s[40:43], s31 offen offset:1024 lds
    buffer_load_dwordx4 v60, s[40:43], s32 offen offset:2048 lds
    s_mov_b32 m0, 118792
    s_add_u32 s30, s26, 6144
    s_add_u32 s31, s26, 29696
    s_add_u32 s32, s26, 53248
    buffer_load_dwordx4 v60, s[40:43], s30 offen offset:0 lds
    buffer_load_dwordx4 v60, s[40:43], s31 offen offset:1024 lds
    buffer_load_dwordx4 v60, s[40:43], s32 offen offset:2048 lds

    s_add_u32 s26, s39, 9
    s_cmp_ge_u32 s26, 12
    s_cselect_b32 s27, 12, 0
    s_sub_u32 s26, s26, s27
    s_mul_i32 s26, s26, 6144

    s_mov_b32 m0, 56320
    s_add_u32 s30, s26, 0
    s_add_u32 s31, s26, 1536
    buffer_load_dwordx4 v253, s[44:47], s30 offen lds
    buffer_load_dwordx4 v61, s[44:47], s30 offen offset:1024 lds
    buffer_load_dwordx4 v253, s[44:47], s31 offen offset:2048 lds
    s_mov_b32 m0, 121864
    s_add_u32 s30, s26, 1536
    s_add_u32 s31, s26, 3072
    buffer_load_dwordx4 v253, s[44:47], s30 offen lds
    buffer_load_dwordx4 v61, s[44:47], s30 offen offset:1024 lds
    buffer_load_dwordx4 v253, s[44:47], s31 offen offset:2048 lds

    s_add_u32 s26, s39, 10
    s_cmp_ge_u32 s26, 12
    s_cselect_b32 s27, 12, 0
    s_sub_u32 s26, s26, s27
    s_mul_i32 s26, s26, 6144

    s_mov_b32 m0, 59392
    s_add_u32 s30, s26, 0
    s_add_u32 s31, s26, 1536
    buffer_load_dwordx4 v253, s[44:47], s30 offen lds
    buffer_load_dwordx4 v61, s[44:47], s30 offen offset:1024 lds
    buffer_load_dwordx4 v253, s[44:47], s31 offen offset:2048 lds
    s_mov_b32 m0, 124936
    s_add_u32 s30, s26, 1536
    s_add_u32 s31, s26, 3072
    buffer_load_dwordx4 v253, s[44:47], s30 offen lds
    buffer_load_dwordx4 v61, s[44:47], s30 offen offset:1024 lds
    buffer_load_dwordx4 v253, s[44:47], s31 offen offset:2048 lds

    s_add_u32 s26, s39, 11
    s_cmp_ge_u32 s26, 12
    s_cselect_b32 s27, 12, 0
    s_sub_u32 s26, s26, s27
    s_mul_i32 s26, s26, 6144

    s_mov_b32 m0, 62464
    s_add_u32 s30, s26, 0
    s_add_u32 s31, s26, 1536
    buffer_load_dwordx4 v253, s[44:47], s30 offen lds
    buffer_load_dwordx4 v61, s[44:47], s30 offen offset:1024 lds
    buffer_load_dwordx4 v253, s[44:47], s31 offen offset:2048 lds
    s_mov_b32 m0, 128008
    s_add_u32 s30, s26, 1536
    s_add_u32 s31, s26, 3072
    buffer_load_dwordx4 v253, s[44:47], s30 offen lds
    buffer_load_dwordx4 v61, s[44:47], s30 offen offset:1024 lds
    buffer_load_dwordx4 v253, s[44:47], s31 offen offset:2048 lds
    v_mov_b32 v254, 161976
    v_mov_b32 v64, 15
    s_waitcnt vmcnt(54)
    ds_write_b32 v254, v64
    v_mov_b32 v65, 16
    s_waitcnt vmcnt(48)
    ds_write_b32 v254, v65
    v_mov_b32 v66, 17
    s_waitcnt vmcnt(42)
    ds_write_b32 v254, v66
    v_mov_b32 v67, 18
    s_waitcnt vmcnt(36)
    ds_write_b32 v254, v67
    v_mov_b32 v68, 19
    s_waitcnt vmcnt(30)
    ds_write_b32 v254, v68
    v_mov_b32 v69, 20
    s_waitcnt vmcnt(24)
    ds_write_b32 v254, v69
    v_mov_b32 v70, 21
    s_waitcnt vmcnt(18)
    ds_write_b32 v254, v70
    v_mov_b32 v71, 22
    s_waitcnt vmcnt(12)
    ds_write_b32 v254, v71
    v_mov_b32 v72, 23
    s_waitcnt vmcnt(6)
    ds_write_b32 v254, v72
    v_mov_b32 v73, 24
    s_waitcnt vmcnt(0)
    ds_write_b32 v254, v73
L_p2:
    s_cmp_lg_u32 s16, 1
    s_cbranch_scc1 L_nodma0
    s_setprio 3

    v_lshrrev_b32 v176, 9, v253
    v_mul_u32_u24 v177, 1536, v176
    v_add_u32 v177, v177, v253
    v_bfe_u32 v254, v253, 6, 3
    v_lshl_add_u32 v176, v176, 4, v254
    v_mul_u32_u24 v176, 768, v176
    v_and_b32 v254, 48, v253
    v_add_u32 v176, v176, v254

    v_add_u32 v254, 161924, v240

    s_mov_b32 s29, 200000
L_wg0:
    ds_read_b32 v255, v254
    s_waitcnt lgkmcnt(0)
    v_cmp_ne_u32 vcc, 0, v255
    s_cmp_eq_u64 vcc, exec
    s_cbranch_scc1 L_wg0_ok
    s_sleep 2
    s_sub_u32 s29, s29, 1
    s_cmp_lg_u32 s29, 0
    s_cbranch_scc1 L_wg0
L_wg0_ok:

    s_add_u32 s26, s39, 0
    s_cmp_ge_u32 s26, 12
    s_cselect_b32 s27, 12, 0
    s_sub_u32 s26, s26, s27
    s_mul_i32 s26, s26, 64

    s_mov_b32 m0, 131080
    s_add_u32 s30, s26, 0
    s_add_u32 s31, s26, 23552
    s_add_u32 s32, s26, 47104
    buffer_load_dwordx4 v176, s[40:43], s30 offen offset:0 lds
    buffer_load_dwordx4 v176, s[40:43], s31 offen offset:1024 lds
    buffer_load_dwordx4 v176, s[40:43], s32 offen offset:2048 lds
    s_mov_b32 m0, 146448
    s_add_u32 s30, s26, 6144
    s_add_u32 s31, s26, 29696
    s_add_u32 s32, s26, 53248
    buffer_load_dwordx4 v176, s[40:43], s30 offen offset:0 lds
    buffer_load_dwordx4 v176, s[40:43], s31 offen offset:1024 lds
    buffer_load_dwordx4 v176, s[40:43], s32 offen offset:2048 lds

    s_add_u32 s26, s39, 1
    s_cmp_ge_u32 s26, 12
    s_cselect_b32 s27, 12, 0
    s_sub_u32 s26, s26, s27
    s_mul_i32 s26, s26, 64

    s_mov_b32 m0, 134152
    s_add_u32 s30, s26, 0
    s_add_u32 s31, s26, 23552
    s_add_u32 s32, s26, 47104
    buffer_load_dwordx4 v176, s[40:43], s30 offen offset:0 lds
    buffer_load_dwordx4 v176, s[40:43], s31 offen offset:1024 lds
    buffer_load_dwordx4 v176, s[40:43], s32 offen offset:2048 lds
    s_mov_b32 m0, 149520
    s_add_u32 s30, s26, 6144
    s_add_u32 s31, s26, 29696
    s_add_u32 s32, s26, 53248
    buffer_load_dwordx4 v176, s[40:43], s30 offen offset:0 lds
    buffer_load_dwordx4 v176, s[40:43], s31 offen offset:1024 lds
    buffer_load_dwordx4 v176, s[40:43], s32 offen offset:2048 lds

    s_add_u32 s26, s39, 2
    s_cmp_ge_u32 s26, 12
    s_cselect_b32 s27, 12, 0
    s_sub_u32 s26, s26, s27
    s_mul_i32 s26, s26, 64

    s_mov_b32 m0, 137224
    s_add_u32 s30, s26, 0
    s_add_u32 s31, s26, 23552
    s_add_u32 s32, s26, 47104
    buffer_load_dwordx4 v176, s[40:43], s30 offen offset:0 lds
    buffer_load_dwordx4 v176, s[40:43], s31 offen offset:1024 lds
    buffer_load_dwordx4 v176, s[40:43], s32 offen offset:2048 lds
    s_mov_b32 m0, 152592
    s_add_u32 s30, s26, 6144
    s_add_u32 s31, s26, 29696
    s_add_u32 s32, s26, 53248
    buffer_load_dwordx4 v176, s[40:43], s30 offen offset:0 lds
    buffer_load_dwordx4 v176, s[40:43], s31 offen offset:1024 lds
    buffer_load_dwordx4 v176, s[40:43], s32 offen offset:2048 lds

    s_add_u32 s26, s39, 0
    s_cmp_ge_u32 s26, 12
    s_cselect_b32 s27, 12, 0
    s_sub_u32 s26, s26, s27
    s_mul_i32 s26, s26, 6144

    s_mov_b32 m0, 140296
    s_add_u32 s30, s26, 0
    s_add_u32 s31, s26, 1536
    buffer_load_dwordx4 v253, s[44:47], s30 offen lds
    buffer_load_dwordx4 v177, s[44:47], s30 offen offset:1024 lds
    buffer_load_dwordx4 v253, s[44:47], s31 offen offset:2048 lds
    s_mov_b32 m0, 155664
    s_add_u32 s30, s26, 1536
    s_add_u32 s31, s26, 3072
    buffer_load_dwordx4 v253, s[44:47], s30 offen lds
    buffer_load_dwordx4 v177, s[44:47], s30 offen offset:1024 lds
    buffer_load_dwordx4 v253, s[44:47], s31 offen offset:2048 lds

    s_add_u32 s26, s39, 3
    s_cmp_ge_u32 s26, 12
    s_cselect_b32 s27, 12, 0
    s_sub_u32 s26, s26, s27
    s_mul_i32 s26, s26, 64

    s_mov_b32 m0, 143368
    s_add_u32 s30, s26, 0
    s_add_u32 s31, s26, 23552
    s_add_u32 s32, s26, 47104
    buffer_load_dwordx4 v176, s[40:43], s30 offen offset:0 lds
    buffer_load_dwordx4 v176, s[40:43], s31 offen offset:1024 lds
    buffer_load_dwordx4 v176, s[40:43], s32 offen offset:2048 lds
    s_mov_b32 m0, 158736
    s_add_u32 s30, s26, 6144
    s_add_u32 s31, s26, 29696
    s_add_u32 s32, s26, 53248
    buffer_load_dwordx4 v176, s[40:43], s30 offen offset:0 lds
    buffer_load_dwordx4 v176, s[40:43], s31 offen offset:1024 lds
    buffer_load_dwordx4 v176, s[40:43], s32 offen offset:2048 lds
    v_mov_b32 v254, 161976
    v_mov_b32 v180, 1
    s_waitcnt vmcnt(24)
    ds_write_b32 v254, v180
    v_mov_b32 v181, 2
    s_waitcnt vmcnt(18)
    ds_write_b32 v254, v181
    v_mov_b32 v182, 3
    s_waitcnt vmcnt(12)
    ds_write_b32 v254, v182
    v_mov_b32 v183, 4
    s_waitcnt vmcnt(6)
    ds_write_b32 v254, v183
    v_mov_b32 v184, 5
    s_waitcnt vmcnt(0)
    ds_write_b32 v254, v184
L_nodma0:
    v_mov_b32 v254, 161980

    s_mov_b32 s29, 200000
L_wi:
    ds_read_b32 v255, v254
    s_waitcnt lgkmcnt(0)
    v_cmp_eq_u32 vcc, 2, v255
    s_cmp_eq_u64 vcc, exec
    s_cbranch_scc1 L_wi_ok
    s_sleep 2
    s_sub_u32 s29, s29, 1
    s_cmp_lg_u32 s29, 0
    s_cbranch_scc1 L_wi
L_wi_ok:

    v_bfe_u32 v176, v253, 6, 2
    v_and_b32 v177, 48, v253
    v_lshrrev_b32 v178, 9, v253
    v_lshl_add_u32 v176, v178, 3, v176
    v_lshl_add_u32 v254, v176, 6, v177
    v_mul_u32_u24 v176, 192, v176
    v_add_u32 v255, v176, v177
    v_bfe_u32 v176, v253, 8, 1
    v_mul_u32_u24 v177, 65544, v176
    v_add_u32 v254, v254, v177
    v_add_u32 v255, v255, v177
    s_mov_b32 s84, 0xc4eac4ea
    s_mov_b32 s85, 0x377f377f
    s_mov_b32 s83, 0x766fde6e
    s_mov_b32 s86, 0x00003f80
    s_mov_b32 s87, 0x3f800000
    s_mov_b32 s17, 0
    s_mov_b32 s19, 0
    s_setprio 1
L_mtile:

    v_bfe_u32 v224, v253, 8, 1
    v_mul_u32_u24 v224, 50176, v224
    v_subrev_u32 v224, 131080, v224
    v_sub_u32 v254, v254, v224

    s_cmp_ge_u32 s19, 1
    s_cbranch_scc1 L_rd1_go
    v_mov_b32 v224, 161976

    s_mov_b32 s29, 200000
L_rd1:
    ds_read_b32 v225, v224
    s_waitcnt lgkmcnt(0)
    v_cmp_le_u32 vcc, 1, v225
    s_cmp_eq_u64 vcc, exec
    s_cbranch_scc1 L_rd1_ok
    s_sleep 2
    s_sub_u32 s29, s29, 1
    s_cmp_lg_u32 s29, 0
    s_cbranch_scc1 L_rd1
L_rd1_ok:

    v_readfirstlane_b32 s19, v225
L_rd1_go:

    ds_read_b64_tr_b16 v[224:225], v254 offset:0
    ds_read_b64_tr_b16 v[226:227], v254 offset:256
    ds_read_b64_tr_b16 v[228:229], v254 offset:1024
    ds_read_b64_tr_b16 v[230:231], v254 offset:1280
    ds_read_b64_tr_b16 v[232:233], v254 offset:2048
    ds_read_b64_tr_b16 v[234:235], v254 offset:2304
    ds_read_b64_tr_b16 v[236:237], v254 offset:8
    ds_read_b64_tr_b16 v[238:239], v254 offset:264
    ds_read_b64_tr_b16 v[240:241], v254 offset:1032
    ds_read_b64_tr_b16 v[242:243], v254 offset:1288
    s_waitcnt vmcnt(12)
    s_waitcnt lgkmcnt(8)
    v_mfma_f32_16x16x32_bf16 v[176:179], v[224:227], v[0:3], 0
    v_mfma_f32_16x16x32_bf16 v[180:183], v[224:227], v[4:7], 0
    v_mfma_f32_16x16x32_bf16 v[184:187], v[224:227], v[8:11], 0
    v_mfma_f32_16x16x32_bf16 v[188:191], v[224:227], v[12:15], 0
    ds_read_b64_tr_b16 v[224:225], v254 offset:2056
    ds_read_b64_tr_b16 v[226:227], v254 offset:2312
    s_waitcnt lgkmcnt(8)
    v_mfma_f32_16x16x32_bf16 v[176:179], v[228:231], v[16:19], v[176:179]
    v_mfma_f32_16x16x32_bf16 v[180:183], v[228:231], v[20:23], v[180:183]
    v_mfma_f32_16x16x32_bf16 v[184:187], v[228:231], v[24:27], v[184:187]
    v_mfma_f32_16x16x32_bf16 v[188:191], v[228:231], v[28:31], v[188:191]

    s_cmp_ge_u32 s19, 2
    s_cbranch_scc1 L_rd2_go
    v_mov_b32 v228, 161976

    s_mov_b32 s29, 200000
L_rd2:
    ds_read_b32 v229, v228
    s_waitcnt lgkmcnt(0)
    v_cmp_le_u32 vcc, 2, v229
    s_cmp_eq_u64 vcc, exec
    s_cbranch_scc1 L_rd2_ok
    s_sleep 2
    s_sub_u32 s29, s29, 1
    s_cmp_lg_u32 s29, 0
    s_cbranch_scc1 L_rd2
L_rd2_ok:

    v_readfirstlane_b32 s19, v229
L_rd2_go:

    ds_read_b64_tr_b16 v[228:229], v254 offset:3072
    ds_read_b64_tr_b16 v[230:231], v254 offset:3328
    s_waitcnt lgkmcnt(8)
    v_mfma_f32_16x16x32_bf16 v[176:179], v[232:235], v[32:35], v[176:179]
    v_mfma_f32_16x16x32_bf16 v[180:183], v[232:235], v[36:39], v[180:183]
    v_mfma_f32_16x16x32_bf16 v[184:187], v[232:235], v[40:43], v[184:187]
    v_mfma_f32_16x16x32_bf16 v[188:191], v[232:235], v[44:47], v[188:191]
    ds_read_b64_tr_b16 v[232:233], v254 offset:4096
    ds_read_b64_tr_b16 v[234:235], v254 offset:4352
    s_waitcnt lgkmcnt(8)
    v_mfma_f32_16x16x32_bf16 v[192:195], v[236:239], v[0:3], 0
    v_mfma_f32_16x16x32_bf16 v[196:199], v[236:239], v[4:7], 0
    v_mfma_f32_16x16x32_bf16 v[200:203], v[236:239], v[8:11], 0
    v_mfma_f32_16x16x32_bf16 v[204:207], v[236:239], v[12:15], 0
    ds_read_b64_tr_b16 v[236:237], v254 offset:5120
    ds_read_b64_tr_b16 v[238:239], v254 offset:5376
    s_waitcnt lgkmcnt(8)
    v_mfma_f32_16x16x32_bf16 v[192:195], v[240:243], v[16:19], v[192:195]
    v_lshlrev_b32_sdwa v176, 1, v176 dst_sel:DWORD dst_unused:UNUSED_PAD src0_sel:DWORD src1_sel:WORD_1
    v_lshlrev_b32_sdwa v177, 1, v177 dst_sel:DWORD dst_unused:UNUSED_PAD src0_sel:DWORD src1_sel:WORD_1
    ds_read_u16_d16 v176, v176
    ds_read_u16_d16_hi v177, v177
    v_lshlrev_b32_sdwa v178, 1, v178 dst_sel:DWORD dst_unused:UNUSED_PAD src0_sel:DWORD src1_sel:WORD_1
    v_mfma_f32_16x16x32_bf16 v[196:199], v[240:243], v[20:23], v[196:199]
    v_lshlrev_b32_sdwa v179, 1, v179 dst_sel:DWORD dst_unused:UNUSED_PAD src0_sel:DWORD src1_sel:WORD_1
    ds_read_u16_d16 v178, v178
    ds_read_u16_d16_hi v179, v179
    v_lshlrev_b32_sdwa v180, 1, v180 dst_sel:DWORD dst_unused:UNUSED_PAD src0_sel:DWORD src1_sel:WORD_1
    v_lshlrev_b32_sdwa v181, 1, v181 dst_sel:DWORD dst_unused:UNUSED_PAD src0_sel:DWORD src1_sel:WORD_1
    ds_read_u16_d16 v180, v180
    ds_read_u16_d16_hi v181, v181
    v_mfma_f32_16x16x32_bf16 v[200:203], v[240:243], v[24:27], v[200:203]
    v_lshlrev_b32_sdwa v182, 1, v182 dst_sel:DWORD dst_unused:UNUSED_PAD src0_sel:DWORD src1_sel:WORD_1
    v_lshlrev_b32_sdwa v183, 1, v183 dst_sel:DWORD dst_unused:UNUSED_PAD src0_sel:DWORD src1_sel:WORD_1
    ds_read_u16_d16 v182, v182
    ds_read_u16_d16_hi v183, v183
    v_mfma_f32_16x16x32_bf16 v[204:207], v[240:243], v[28:31], v[204:207]
    ds_read_b64_tr_b16 v[240:241], v254 offset:3080
    ds_read_b64_tr_b16 v[242:243], v254 offset:3336
    v_lshlrev_b32_sdwa v184, 1, v184 dst_sel:DWORD dst_unused:UNUSED_PAD src0_sel:DWORD src1_sel:WORD_1
    v_lshlrev_b32_sdwa v185, 1, v185 dst_sel:DWORD dst_unused:UNUSED_PAD src0_sel:DWORD src1_sel:WORD_1
    ds_read_u16_d16 v184, v184
    ds_read_u16_d16_hi v185, v185
    v_lshlrev_b32_sdwa v186, 1, v186 dst_sel:DWORD dst_unused:UNUSED_PAD src0_sel:DWORD src1_sel:WORD_1
    s_waitcnt lgkmcnt(14)
    v_mfma_f32_16x16x32_bf16 v[192:195], v[224:227], v[32:35], v[192:195]
    v_lshlrev_b32_sdwa v187, 1, v187 dst_sel:DWORD dst_unused:UNUSED_PAD src0_sel:DWORD src1_sel:WORD_1
    ds_read_u16_d16 v186, v186
    ds_read_u16_d16_hi v187, v187
    v_lshlrev_b32_sdwa v188, 1, v188 dst_sel:DWORD dst_unused:UNUSED_PAD src0_sel:DWORD src1_sel:WORD_1
    v_lshlrev_b32_sdwa v189, 1, v189 dst_sel:DWORD dst_unused:UNUSED_PAD src0_sel:DWORD src1_sel:WORD_1
    ds_read_u16_d16 v188, v188
    ds_read_u16_d16_hi v189, v189
    v_mfma_f32_16x16x32_bf16 v[196:199], v[224:227], v[36:39], v[196:199]
    v_lshlrev_b32_sdwa v190, 1, v190 dst_sel:DWORD dst_unused:UNUSED_PAD src0_sel:DWORD src1_sel:WORD_1
    v_lshlrev_b32_sdwa v191, 1, v191 dst_sel:DWORD dst_unused:UNUSED_PAD src0_sel:DWORD src1_sel:WORD_1
    ds_read_u16_d16 v190, v190
    ds_read_u16_d16_hi v191, v191
    v_mfma_f32_16x16x32_bf16 v[200:203], v[224:227], v[40:43], v[200:203]
    v_mfma_f32_16x16x32_bf16 v[204:207], v[224:227], v[44:47], v[204:207]
    ds_read_b64_tr_b16 v[224:225], v254 offset:4104
    ds_read_b64_tr_b16 v[226:227], v254 offset:4360
    v_mfma_f32_16x16x32_bf16 v[208:211], v[228:231], v[0:3], 0
    v_mfma_f32_16x16x32_bf16 v[212:215], v[228:231], v[4:7], 0
    v_mfma_f32_16x16x32_bf16 v[216:219], v[228:231], v[8:11], 0
    v_mfma_f32_16x16x32_bf16 v[220:223], v[228:231], v[12:15], 0
    ds_read_b64_tr_b16 v[228:229], v254 offset:5128
    ds_read_b64_tr_b16 v[230:231], v254 offset:5384
    v_mfma_f32_16x16x32_bf16 v[208:211], v[232:235], v[16:19], v[208:211]
    s_waitcnt lgkmcnt(14)
    v_or_b32 v144, v176, v177
    v_lshlrev_b32_sdwa v192, 1, v192 dst_sel:DWORD dst_unused:UNUSED_PAD src0_sel:DWORD src1_sel:WORD_1
    v_lshlrev_b32_sdwa v193, 1, v193 dst_sel:DWORD dst_unused:UNUSED_PAD src0_sel:DWORD src1_sel:WORD_1
    ds_read_u16_d16 v192, v192
    ds_read_u16_d16_hi v193, v193
    v_or_b32 v145, v178, v179
    v_mfma_f32_16x16x32_bf16 v[212:215], v[232:235], v[20:23], v[212:215]
    v_lshlrev_b32_sdwa v194, 1, v194 dst_sel:DWORD dst_unused:UNUSED_PAD src0_sel:DWORD src1_sel:WORD_1
    v_lshlrev_b32_sdwa v195, 1, v195 dst_sel:DWORD dst_unused:UNUSED_PAD src0_sel:DWORD src1_sel:WORD_1
    ds_read_u16_d16 v194, v194
    ds_read_u16_d16_hi v195, v195
    v_or_b32 v148, v180, v181
    v_lshlrev_b32_sdwa v196, 1, v196 dst_sel:DWORD dst_unused:UNUSED_PAD src0_sel:DWORD src1_sel:WORD_1
    v_mfma_f32_16x16x32_bf16 v[216:219], v[232:235], v[24:27], v[216:219]
    v_lshlrev_b32_sdwa v197, 1, v197 dst_sel:DWORD dst_unused:UNUSED_PAD src0_sel:DWORD src1_sel:WORD_1
    ds_read_u16_d16 v196, v196
    ds_read_u16_d16_hi v197, v197
    v_or_b32 v149, v182, v183
    v_lshlrev_b32_sdwa v198, 1, v198 dst_sel:DWORD dst_unused:UNUSED_PAD src0_sel:DWORD src1_sel:WORD_1
    v_lshlrev_b32_sdwa v199, 1, v199 dst_sel:DWORD dst_unused:UNUSED_PAD src0_sel:DWORD src1_sel:WORD_1
    ds_read_u16_d16 v198, v198
    ds_read_u16_d16_hi v199, v199
    v_mfma_f32_16x16x32_bf16 v[220:223], v[232:235], v[28:31], v[220:223]

    s_cmp_ge_u32 s19, 3
    s_cbranch_scc1 L_rd3_go
    v_mov_b32 v232, 161976

    s_mov_b32 s29, 200000
L_rd3:
    ds_read_b32 v233, v232
    s_waitcnt lgkmcnt(0)
    v_cmp_le_u32 vcc, 3, v233
    s_cmp_eq_u64 vcc, exec
    s_cbranch_scc1 L_rd3_ok
    s_sleep 2
    s_sub_u32 s29, s29, 1
    s_cmp_lg_u32 s29, 0
    s_cbranch_scc1 L_rd3
L_rd3_ok:

    v_readfirstlane_b32 s19, v233
L_rd3_go:

    ds_read_b64_tr_b16 v[232:233], v254 offset:6144
    ds_read_b64_tr_b16 v[234:235], v254 offset:6400
    s_waitcnt lgkmcnt(14)
    v_or_b32 v152, v184, v185
    v_lshlrev_b32_sdwa v200, 1, v200 dst_sel:DWORD dst_unused:UNUSED_PAD src0_sel:DWORD src1_sel:WORD_1
    v_lshlrev_b32_sdwa v201, 1, v201 dst_sel:DWORD dst_unused:UNUSED_PAD src0_sel:DWORD src1_sel:WORD_1
    ds_read_u16_d16 v200, v200
    ds_read_u16_d16_hi v201, v201
    v_or_b32 v153, v186, v187
    v_mfma_f32_16x16x32_bf16 v[208:211], v[236:239], v[32:35], v[208:211]
    v_lshlrev_b32_sdwa v202, 1, v202 dst_sel:DWORD dst_unused:UNUSED_PAD src0_sel:DWORD src1_sel:WORD_1
    v_lshlrev_b32_sdwa v203, 1, v203 dst_sel:DWORD dst_unused:UNUSED_PAD src0_sel:DWORD src1_sel:WORD_1
    ds_read_u16_d16 v202, v202
    ds_read_u16_d16_hi v203, v203
    v_or_b32 v156, v188, v189
    v_lshlrev_b32_sdwa v204, 1, v204 dst_sel:DWORD dst_unused:UNUSED_PAD src0_sel:DWORD src1_sel:WORD_1
    v_mfma_f32_16x16x32_bf16 v[212:215], v[236:239], v[36:39], v[212:215]
    v_lshlrev_b32_sdwa v205, 1, v205 dst_sel:DWORD dst_unused:UNUSED_PAD src0_sel:DWORD src1_sel:WORD_1
    ds_read_u16_d16 v204, v204
    ds_read_u16_d16_hi v205, v205
    v_or_b32 v157, v190, v191
    v_lshlrev_b32_sdwa v206, 1, v206 dst_sel:DWORD dst_unused:UNUSED_PAD src0_sel:DWORD src1_sel:WORD_1
    v_lshlrev_b32_sdwa v207, 1, v207 dst_sel:DWORD dst_unused:UNUSED_PAD src0_sel:DWORD src1_sel:WORD_1
    ds_read_u16_d16 v206, v206
    ds_read_u16_d16_hi v207, v207
    v_mfma_f32_16x16x32_bf16 v[216:219], v[236:239], v[40:43], v[216:219]
    v_mfma_f32_16x16x32_bf16 v[220:223], v[236:239], v[44:47], v[220:223]
    v_bfe_u32 v236, v253, 8, 1
    v_mul_u32_u24 v236, 50176, v236
    v_subrev_u32 v236, 131080, v236
    v_sub_u32 v255, v255, v236

    s_cmp_ge_u32 s19, 4
    s_cbranch_scc1 L_rd4_go
    v_mov_b32 v236, 161976

    s_mov_b32 s29, 200000
L_rd4:
    ds_read_b32 v237, v236
    s_waitcnt lgkmcnt(0)
    v_cmp_le_u32 vcc, 4, v237
    s_cmp_eq_u64 vcc, exec
    s_cbranch_scc1 L_rd4_ok
    s_sleep 2
    s_sub_u32 s29, s29, 1
    s_cmp_lg_u32 s29, 0
    s_cbranch_scc1 L_rd4
L_rd4_ok:

    v_readfirstlane_b32 s19, v237
L_rd4_go:

    ds_read_b64_tr_b16 v[236:237], v255 offset:9216
    ds_read_b64_tr_b16 v[238:239], v255 offset:9984
    v_mfma_f32_16x16x32_bf16 v[176:179], v[240:243], v[0:3], 0
    v_mfma_f32_16x16x32_bf16 v[180:183], v[240:243], v[4:7], 0
    v_mfma_f32_16x16x32_bf16 v[184:187], v[240:243], v[8:11], 0
    v_mfma_f32_16x16x32_bf16 v[188:191], v[240:243], v[12:15], 0
    ds_read_b64_tr_b16 v[240:241], v254 offset:7168
    ds_read_b64_tr_b16 v[242:243], v254 offset:7424
    s_waitcnt lgkmcnt(14)
    v_mfma_f32_16x16x32_bf16 v[176:179], v[224:227], v[16:19], v[176:179]
    v_or_b32 v146, v192, v193
    v_lshlrev_b32_sdwa v208, 1, v208 dst_sel:DWORD dst_unused:UNUSED_PAD src0_sel:DWORD src1_sel:WORD_1
    v_lshlrev_b32_sdwa v209, 1, v209 dst_sel:DWORD dst_unused:UNUSED_PAD src0_sel:DWORD src1_sel:WORD_1
    ds_read_u16_d16 v208, v208
    ds_read_u16_d16_hi v209, v209
    v_or_b32 v147, v194, v195
    v_mfma_f32_16x16x32_bf16 v[180:183], v[224:227], v[20:23], v[180:183]
    v_lshlrev_b32_sdwa v210, 1, v210 dst_sel:DWORD dst_unused:UNUSED_PAD src0_sel:DWORD src1_sel:WORD_1
    v_lshlrev_b32_sdwa v211, 1, v211 dst_sel:DWORD dst_unused:UNUSED_PAD src0_sel:DWORD src1_sel:WORD_1
    ds_read_u16_d16 v210, v210
    ds_read_u16_d16_hi v211, v211
    v_or_b32 v150, v196, v197
    v_lshlrev_b32_sdwa v212, 1, v212 dst_sel:DWORD dst_unused:UNUSED_PAD src0_sel:DWORD src1_sel:WORD_1
    v_mfma_f32_16x16x32_bf16 v[184:187], v[224:227], v[24:27], v[184:187]
    v_lshlrev_b32_sdwa v213, 1, v213 dst_sel:DWORD dst_unused:UNUSED_PAD src0_sel:DWORD src1_sel:WORD_1
    ds_read_u16_d16 v212, v212
    ds_read_u16_d16_hi v213, v213
    v_or_b32 v151, v198, v199
    v_lshlrev_b32_sdwa v214, 1, v214 dst_sel:DWORD dst_unused:UNUSED_PAD src0_sel:DWORD src1_sel:WORD_1
    v_lshlrev_b32_sdwa v215, 1, v215 dst_sel:DWORD dst_unused:UNUSED_PAD src0_sel:DWORD src1_sel:WORD_1
    ds_read_u16_d16 v214, v214
    ds_read_u16_d16_hi v215, v215
    v_mfma_f32_16x16x32_bf16 v[188:191], v[224:227], v[28:31], v[188:191]
    ds_read_b64_tr_b16 v[224:225], v255 offset:9224
    ds_read_b64_tr_b16 v[226:227], v255 offset:9992
    s_waitcnt lgkmcnt(14)
    v_or_b32 v154, v200, v201
    v_lshlrev_b32_sdwa v216, 1, v216 dst_sel:DWORD dst_unused:UNUSED_PAD src0_sel:DWORD src1_sel:WORD_1
    v_lshlrev_b32_sdwa v217, 1, v217 dst_sel:DWORD dst_unused:UNUSED_PAD src0_sel:DWORD src1_sel:WORD_1
    ds_read_u16_d16 v216, v216
    ds_read_u16_d16_hi v217, v217
    v_or_b32 v155, v202, v203
    v_mfma_f32_16x16x32_bf16 v[176:179], v[228:231], v[32:35], v[176:179]
    v_lshlrev_b32_sdwa v218, 1, v218 dst_sel:DWORD dst_unused:UNUSED_PAD src0_sel:DWORD src1_sel:WORD_1
    v_lshlrev_b32_sdwa v219, 1, v219 dst_sel:DWORD dst_unused:UNUSED_PAD src0_sel:DWORD src1_sel:WORD_1
    ds_read_u16_d16 v218, v218
    ds_read_u16_d16_hi v219, v219
    v_or_b32 v158, v204, v205
    v_lshlrev_b32_sdwa v220, 1, v220 dst_sel:DWORD dst_unused:UNUSED_PAD src0_sel:DWORD src1_sel:WORD_1
    v_mfma_f32_16x16x32_bf16 v[180:183], v[228:231], v[36:39], v[180:183]
    v_lshlrev_b32_sdwa v221, 1, v221 dst_sel:DWORD dst_unused:UNUSED_PAD src0_sel:DWORD src1_sel:WORD_1
    ds_read_u16_d16 v220, v220
    ds_read_u16_d16_hi v221, v221
    v_or_b32 v159, v206, v207
    v_lshlrev_b32_sdwa v222, 1, v222 dst_sel:DWORD dst_unused:UNUSED_PAD src0_sel:DWORD src1_sel:WORD_1
    v_lshlrev_b32_sdwa v223, 1, v223 dst_sel:DWORD dst_unused:UNUSED_PAD src0_sel:DWORD src1_sel:WORD_1
    ds_read_u16_d16 v222, v222
    ds_read_u16_d16_hi v223, v223

    s_cmp_eq_u32 s38, 0
    s_cbranch_scc1 L_rdh_go
    v_mov_b32 v244, 161972

    s_mov_b32 s29, 200000
L_wi9:
    ds_read_b32 v245, v244
    s_waitcnt lgkmcnt(0)
    v_cmp_eq_u32 vcc, 9, v245
    s_cmp_eq_u64 vcc, exec
    s_cbranch_scc1 L_wi9_ok
    s_sleep 2
    s_sub_u32 s29, s29, 1
    s_cmp_lg_u32 s29, 0
    s_cbranch_scc1 L_wi9
L_wi9_ok:

    v_lshrrev_b32 v244, 7, v253
    v_mul_u32_u24 v244, 640, v244
    v_add_u32 v244, v244, v253
    v_add_u32 v245, 196608, v244
    buffer_store_dwordx4 v[48:51], v244, s[8:11], s36 offen offset:0 sc1
    buffer_store_dwordx4 v[52:55], v244, s[8:11], s36 offen offset:128 sc1
    buffer_store_dwordx4 v[56:59], v244, s[8:11], s36 offen offset:256 sc1
    buffer_store_dwordx4 v[60:63], v244, s[8:11], s37 offen offset:0 sc1
    buffer_store_dwordx4 v[64:67], v244, s[8:11], s37 offen offset:128 sc1
    buffer_store_dwordx4 v[68:71], v244, s[8:11], s37 offen offset:256 sc1
    buffer_store_dwordx4 v[72:75], v245, s[8:11], s36 offen offset:0 sc1
    buffer_store_dwordx4 v[76:79], v245, s[8:11], s36 offen offset:128 sc1
    buffer_store_dwordx4 v[80:83], v245, s[8:11], s36 offen offset:256 sc1
    buffer_store_dwordx4 v[84:87], v245, s[8:11], s37 offen offset:0 sc1
    buffer_store_dwordx4 v[88:91], v245, s[8:11], s37 offen offset:128 sc1
    buffer_store_dwordx4 v[92:95], v245, s[8:11], s37 offen offset:256 sc1
    s_mov_b32 s38, 0
L_rdh_go:
    v_mfma_f32_16x16x32_bf16 v[184:187], v[228:231], v[40:43], v[184:187]
    v_mfma_f32_16x16x32_bf16 v[188:191], v[228:231], v[44:47], v[188:191]
    ds_read_b64_tr_b16 v[228:229], v254 offset:8192
    ds_read_b64_tr_b16 v[230:231], v254 offset:8448
    v_mfma_f32_16x16x32_bf16 v[192:195], v[232:235], v[0:3], 0
    v_mfma_f32_16x16x32_bf16 v[196:199], v[232:235], v[4:7], 0
    v_mfma_f32_16x16x32_bf16 v[200:203], v[232:235], v[8:11], 0
    v_mfma_f32_16x16x32_bf16 v[204:207], v[232:235], v[12:15], 0
    ds_read_b64_tr_b16 v[232:233], v255 offset:9280
    ds_read_b64_tr_b16 v[234:235], v255 offset:10048
    s_waitcnt lgkmcnt(14)
    v_mfma_f32_16x16x32_bf16 v[48:51], v[236:239], v[144:147], 0
    v_or_b32 v160, v208, v209
    v_lshlrev_b32_sdwa v176, 1, v176 dst_sel:DWORD dst_unused:UNUSED_PAD src0_sel:DWORD src1_sel:WORD_1
    v_mfma_f32_16x16x32_bf16 v[56:59], v[236:239], v[148:151], 0
    v_lshlrev_b32_sdwa v177, 1, v177 dst_sel:DWORD dst_unused:UNUSED_PAD src0_sel:DWORD src1_sel:WORD_1
    ds_read_u16_d16 v176, v176
    ds_read_u16_d16_hi v177, v177
    v_mfma_f32_16x16x32_bf16 v[64:67], v[236:239], v[152:155], 0
    v_or_b32 v161, v210, v211
    v_mfma_f32_16x16x32_bf16 v[72:75], v[236:239], v[156:159], 0
    ds_read_b64_tr_b16 v[236:237], v254 offset:6152
    ds_read_b64_tr_b16 v[238:239], v254 offset:6408
    v_lshlrev_b32_sdwa v178, 1, v178 dst_sel:DWORD dst_unused:UNUSED_PAD src0_sel:DWORD src1_sel:WORD_1
    v_lshlrev_b32_sdwa v179, 1, v179 dst_sel:DWORD dst_unused:UNUSED_PAD src0_sel:DWORD src1_sel:WORD_1
    ds_read_u16_d16 v178, v178
    ds_read_u16_d16_hi v179, v179
    v_mfma_f32_16x16x32_bf16 v[192:195], v[240:243], v[16:19], v[192:195]
    v_or_b32 v164, v212, v213
    v_mfma_f32_16x16x32_bf16 v[196:199], v[240:243], v[20:23], v[196:199]
    v_lshlrev_b32_sdwa v180, 1, v180 dst_sel:DWORD dst_unused:UNUSED_PAD src0_sel:DWORD src1_sel:WORD_1
    v_mfma_f32_16x16x32_bf16 v[200:203], v[240:243], v[24:27], v[200:203]
    v_lshlrev_b32_sdwa v181, 1, v181 dst_sel:DWORD dst_unused:UNUSED_PAD src0_sel:DWORD src1_sel:WORD_1
    ds_read_u16_d16 v180, v180
    ds_read_u16_d16_hi v181, v181
    v_or_b32 v165, v214, v215
    v_mfma_f32_16x16x32_bf16 v[204:207], v[240:243], v[28:31], v[204:207]
    ds_read_b64_tr_b16 v[240:241], v255 offset:9288
    ds_read_b64_tr_b16 v[242:243], v255 offset:10056
    v_lshlrev_b32_sdwa v182, 1, v182 dst_sel:DWORD dst_unused:UNUSED_PAD src0_sel:DWORD src1_sel:WORD_1
    s_waitcnt lgkmcnt(14)
    v_mfma_f32_16x16x32_bf16 v[52:55], v[224:227], v[144:147], 0
    v_lshlrev_b32_sdwa v183, 1, v183 dst_sel:DWORD dst_unused:UNUSED_PAD src0_sel:DWORD src1_sel:WORD_1
    ds_read_u16_d16 v182, v182
    ds_read_u16_d16_hi v183, v183
    v_mfma_f32_16x16x32_bf16 v[60:63], v[224:227], v[148:151], 0
    v_or_b32 v168, v216, v217
    v_lshlrev_b32_sdwa v184, 1, v184 dst_sel:DWORD dst_unused:UNUSED_PAD src0_sel:DWORD src1_sel:WORD_1
    v_mfma_f32_16x16x32_bf16 v[68:71], v[224:227], v[152:155], 0
    v_lshlrev_b32_sdwa v185, 1, v185 dst_sel:DWORD dst_unused:UNUSED_PAD src0_sel:DWORD src1_sel:WORD_1
    ds_read_u16_d16 v184, v184
    ds_read_u16_d16_hi v185, v185
    v_mfma_f32_16x16x32_bf16 v[76:79], v[224:227], v[156:159], 0
    ds_read_b64_tr_b16 v[224:225], v254 offset:7176
    ds_read_b64_tr_b16 v[226:227], v254 offset:7432
    v_or_b32 v169, v218, v219
    s_waitcnt lgkmcnt(14)
    v_mfma_f32_16x16x32_bf16 v[192:195], v[228:231], v[32:35], v[192:195]
    v_lshlrev_b32_sdwa v186, 1, v186 dst_sel:DWORD dst_unused:UNUSED_PAD src0_sel:DWORD src1_sel:WORD_1
    v_lshlrev_b32_sdwa v187, 1, v187 dst_sel:DWORD dst_unused:UNUSED_PAD src0_sel:DWORD src1_sel:WORD_1
    ds_read_u16_d16 v186, v186
    ds_read_u16_d16_hi v187, v187
    v_mfma_f32_16x16x32_bf16 v[196:199], v[228:231], v[36:39], v[196:199]
    v_or_b32 v172, v220, v221
    v_mfma_f32_16x16x32_bf16 v[200:203], v[228:231], v[40:43], v[200:203]
    v_lshlrev_b32_sdwa v188, 1, v188 dst_sel:DWORD dst_unused:UNUSED_PAD src0_sel:DWORD src1_sel:WORD_1
    v_mfma_f32_16x16x32_bf16 v[204:207], v[228:231], v[44:47], v[204:207]
    ds_read_b64_tr_b16 v[228:229], v255 offset:9344
    ds_read_b64_tr_b16 v[230:231], v255 offset:10112
    v_lshlrev_b32_sdwa v189, 1, v189 dst_sel:DWORD dst_unused:UNUSED_PAD src0_sel:DWORD src1_sel:WORD_1
    ds_read_u16_d16 v188, v188
    ds_read_u16_d16_hi v189, v189
    v_or_b32 v173, v222, v223
    v_mfma_f32_16x16x32_bf16 v[80:83], v[232:235], v[144:147], 0
    v_lshlrev_b32_sdwa v190, 1, v190 dst_sel:DWORD dst_unused:UNUSED_PAD src0_sel:DWORD src1_sel:WORD_1
    v_mfma_f32_16x16x32_bf16 v[88:91], v[232:235], v[148:151], 0
    v_lshlrev_b32_sdwa v191, 1, v191 dst_sel:DWORD dst_unused:UNUSED_PAD src0_sel:DWORD src1_sel:WORD_1
    ds_read_u16_d16 v190, v190
    ds_read_u16_d16_hi v191, v191
    v_mfma_f32_16x16x32_bf16 v[96:99], v[232:235], v[152:155], 0
    v_mfma_f32_16x16x32_bf16 v[104:107], v[232:235], v[156:159], 0
    ds_read_b64_tr_b16 v[232:233], v254 offset:8200
    ds_read_b64_tr_b16 v[234:235], v254 offset:8456
    s_waitcnt lgkmcnt(14)
    v_mfma_f32_16x16x32_bf16 v[208:211], v[236:239], v[0:3], 0
    v_or_b32 v162, v176, v177
    v_lshlrev_b32_sdwa v192, 1, v192 dst_sel:DWORD dst_unused:UNUSED_PAD src0_sel:DWORD src1_sel:WORD_1
    v_mfma_f32_16x16x32_bf16 v[212:215], v[236:239], v[4:7], 0
    v_lshlrev_b32_sdwa v193, 1, v193 dst_sel:DWORD dst_unused:UNUSED_PAD src0_sel:DWORD src1_sel:WORD_1
    ds_read_u16_d16 v192, v192
    ds_read_u16_d16_hi v193, v193
    v_mfma_f32_16x16x32_bf16 v[216:219], v[236:239], v[8:11], 0
    v_or_b32 v163, v178, v179
    v_mfma_f32_16x16x32_bf16 v[220:223], v[236:239], v[12:15], 0
    ds_read_b64_tr_b16 v[236:237], v255 offset:9352
    ds_read_b64_tr_b16 v[238:239], v255 offset:10120
    v_lshlrev_b32_sdwa v194, 1, v194 dst_sel:DWORD dst_unused:UNUSED_PAD src0_sel:DWORD src1_sel:WORD_1
    v_mfma_f32_16x16x32_bf16 v[84:87], v[240:243], v[144:147], 0
    v_lshlrev_b32_sdwa v195, 1, v195 dst_sel:DWORD dst_unused:UNUSED_PAD src0_sel:DWORD src1_sel:WORD_1
    ds_read_u16_d16 v194, v194
    ds_read_u16_d16_hi v195, v195
    v_mfma_f32_16x16x32_bf16 v[92:95], v[240:243], v[148:151], 0
    v_or_b32 v166, v180, v181
    v_mfma_f32_16x16x32_bf16 v[100:103], v[240:243], v[152:155], 0
    v_lshlrev_b32_sdwa v196, 1, v196 dst_sel:DWORD dst_unused:UNUSED_PAD src0_sel:DWORD src1_sel:WORD_1
    v_mfma_f32_16x16x32_bf16 v[108:111], v[240:243], v[156:159], 0

    s_cmp_ge_u32 s19, 5
    s_cbranch_scc1 L_rd5_go
    v_mov_b32 v240, 161976

    s_mov_b32 s29, 200000
L_rd5:
    ds_read_b32 v241, v240
    s_waitcnt lgkmcnt(0)
    v_cmp_le_u32 vcc, 5, v241
    s_cmp_eq_u64 vcc, exec
    s_cbranch_scc1 L_rd5_ok
    s_sleep 2
    s_sub_u32 s29, s29, 1
    s_cmp_lg_u32 s29, 0
    s_cbranch_scc1 L_rd5
L_rd5_ok:

    v_readfirstlane_b32 s19, v241
L_rd5_go:

    ds_read_b64_tr_b16 v[240:241], v254 offset:12288
    ds_read_b64_tr_b16 v[242:243], v254 offset:12544
    v_lshlrev_b32_sdwa v197, 1, v197 dst_sel:DWORD dst_unused:UNUSED_PAD src0_sel:DWORD src1_sel:WORD_1
    ds_read_u16_d16 v196, v196
    ds_read_u16_d16_hi v197, v197
    s_waitcnt lgkmcnt(14)
    v_mfma_f32_16x16x32_bf16 v[208:211], v[224:227], v[16:19], v[208:211]
    v_or_b32 v167, v182, v183
    v_mfma_f32_16x16x32_bf16 v[212:215], v[224:227], v[20:23], v[212:215]
    v_lshlrev_b32_sdwa v198, 1, v198 dst_sel:DWORD dst_unused:UNUSED_PAD src0_sel:DWORD src1_sel:WORD_1
    v_mfma_f32_16x16x32_bf16 v[216:219], v[224:227], v[24:27], v[216:219]
    v_lshlrev_b32_sdwa v199, 1, v199 dst_sel:DWORD dst_unused:UNUSED_PAD src0_sel:DWORD src1_sel:WORD_1
    ds_read_u16_d16 v198, v198
    ds_read_u16_d16_hi v199, v199
    v_mfma_f32_16x16x32_bf16 v[220:223], v[224:227], v[28:31], v[220:223]
    v_bfe_u32 v224, v253, 8, 1
    v_mul_u32_u24 v224, 50176, v224
    v_subrev_u32 v224, 131080, v224
    v_add_u32 v255, v255, v224

    s_cmp_ge_u32 s19, 6
    s_cbranch_scc1 L_rd6_go
    v_mov_b32 v224, 161976

    s_mov_b32 s29, 200000
L_rd6:
    ds_read_b32 v225, v224
    s_waitcnt lgkmcnt(0)
    v_cmp_le_u32 vcc, 6, v225
    s_cmp_eq_u64 vcc, exec
    s_cbranch_scc1 L_rd6_ok
    s_sleep 2
    s_sub_u32 s29, s29, 1
    s_cmp_lg_u32 s29, 0
    s_cbranch_scc1 L_rd6
L_rd6_ok:

    v_readfirstlane_b32 s19, v225
L_rd6_go:

    ds_read_b64_tr_b16 v[224:225], v255 offset:7168
    ds_read_b64_tr_b16 v[226:227], v255 offset:7936
    v_or_b32 v170, v184, v185
    v_lshlrev_b32_sdwa v200, 1, v200 dst_sel:DWORD dst_unused:UNUSED_PAD src0_sel:DWORD src1_sel:WORD_1
    v_mfma_f32_16x16x32_bf16 v[112:115], v[228:231], v[144:147], 0
    v_lshlrev_b32_sdwa v201, 1, v201 dst_sel:DWORD dst_unused:UNUSED_PAD src0_sel:DWORD src1_sel:WORD_1
    ds_read_u16_d16 v200, v200
    ds_read_u16_d16_hi v201, v201
    v_mfma_f32_16x16x32_bf16 v[120:123], v[228:231], v[148:151], 0
    v_or_b32 v171, v186, v187
    v_mfma_f32_16x16x32_bf16 v[128:131], v[228:231], v[152:155], 0
    v_lshlrev_b32_sdwa v202, 1, v202 dst_sel:DWORD dst_unused:UNUSED_PAD src0_sel:DWORD src1_sel:WORD_1
    v_mfma_f32_16x16x32_bf16 v[136:139], v[228:231], v[156:159], 0
    ds_read_b64_tr_b16 v[228:229], v254 offset:13312
    ds_read_b64_tr_b16 v[230:231], v254 offset:13568
    v_lshlrev_b32_sdwa v203, 1, v203 dst_sel:DWORD dst_unused:UNUSED_PAD src0_sel:DWORD src1_sel:WORD_1
    ds_read_u16_d16 v202, v202
    ds_read_u16_d16_hi v203, v203
    s_waitcnt lgkmcnt(14)
    v_mfma_f32_16x16x32_bf16 v[208:211], v[232:235], v[32:35], v[208:211]
    v_or_b32 v174, v188, v189
    v_mfma_f32_16x16x32_bf16 v[212:215], v[232:235], v[36:39], v[212:215]
    v_lshlrev_b32_sdwa v204, 1, v204 dst_sel:DWORD dst_unused:UNUSED_PAD src0_sel:DWORD src1_sel:WORD_1
    v_mfma_f32_16x16x32_bf16 v[216:219], v[232:235], v[40:43], v[216:219]
    v_lshlrev_b32_sdwa v205, 1, v205 dst_sel:DWORD dst_unused:UNUSED_PAD src0_sel:DWORD src1_sel:WORD_1
    ds_read_u16_d16 v204, v204
    ds_read_u16_d16_hi v205, v205
    v_mfma_f32_16x16x32_bf16 v[220:223], v[232:235], v[44:47], v[220:223]
    ds_read_b64_tr_b16 v[232:233], v255 offset:7176
    ds_read_b64_tr_b16 v[234:235], v255 offset:7944
    v_or_b32 v175, v190, v191
    v_mfma_f32_16x16x32_bf16 v[116:119], v[236:239], v[144:147], 0
    v_lshlrev_b32_sdwa v206, 1, v206 dst_sel:DWORD dst_unused:UNUSED_PAD src0_sel:DWORD src1_sel:WORD_1
    v_mfma_f32_16x16x32_bf16 v[124:127], v[236:239], v[148:151], 0
    v_lshlrev_b32_sdwa v207, 1, v207 dst_sel:DWORD dst_unused:UNUSED_PAD src0_sel:DWORD src1_sel:WORD_1
    ds_read_u16_d16 v206, v206
    ds_read_u16_d16_hi v207, v207
    v_mfma_f32_16x16x32_bf16 v[132:135], v[236:239], v[152:155], 0
    buffer_load_dwordx4 v[244:247], v252, s[4:7], s24 offen offset:0 sc1
    buffer_load_dwordx4 v[248:251], v252, s[4:7], s24 offen offset:64 sc1
    v_mfma_f32_16x16x32_bf16 v[140:143], v[236:239], v[156:159], 0
    ds_read_b64_tr_b16 v[236:237], v254 offset:14336
    ds_read_b64_tr_b16 v[238:239], v254 offset:14592
    s_waitcnt lgkmcnt(14)
    v_mfma_f32_16x16x32_bf16 v[176:179], v[240:243], v[0:3], 0
    v_or_b32 v144, v192, v193
    v_lshlrev_b32_sdwa v208, 1, v208 dst_sel:DWORD dst_unused:UNUSED_PAD src0_sel:DWORD src1_sel:WORD_1
    v_mfma_f32_16x16x32_bf16 v[180:183], v[240:243], v[4:7], 0
    v_lshlrev_b32_sdwa v209, 1, v209 dst_sel:DWORD dst_unused:UNUSED_PAD src0_sel:DWORD src1_sel:WORD_1
    ds_read_u16_d16 v208, v208
    ds_read_u16_d16_hi v209, v209
    v_mfma_f32_16x16x32_bf16 v[184:187], v[240:243], v[8:11], 0
    v_or_b32 v145, v194, v195
    v_mfma_f32_16x16x32_bf16 v[188:191], v[240:243], v[12:15], 0
    ds_read_b64_tr_b16 v[240:241], v255 offset:7232
    ds_read_b64_tr_b16 v[242:243], v255 offset:8000
    v_lshlrev_b32_sdwa v210, 1, v210 dst_sel:DWORD dst_unused:UNUSED_PAD src0_sel:DWORD src1_sel:WORD_1
    v_mfma_f32_16x16x32_bf16 v[48:51], v[224:227], v[160:163], v[48:51]
    v_lshlrev_b32_sdwa v211, 1, v211 dst_sel:DWORD dst_unused:UNUSED_PAD src0_sel:DWORD src1_sel:WORD_1
    ds_read_u16_d16 v210, v210
    ds_read_u16_d16_hi v211, v211
    v_mfma_f32_16x16x32_bf16 v[56:59], v[224:227], v[164:167], v[56:59]
    v_or_b32 v148, v196, v197
    v_mfma_f32_16x16x32_bf16 v[64:67], v[224:227], v[168:171], v[64:67]
    v_lshlrev_b32_sdwa v212, 1, v212 dst_sel:DWORD dst_unused:UNUSED_PAD src0_sel:DWORD src1_sel:WORD_1
    v_mfma_f32_16x16x32_bf16 v[72:75], v[224:227], v[172:175], v[72:75]
    ds_read_b64_tr_b16 v[224:225], v254 offset:12296
    ds_read_b64_tr_b16 v[226:227], v254 offset:12552
    v_lshlrev_b32_sdwa v213, 1, v213 dst_sel:DWORD dst_unused:UNUSED_PAD src0_sel:DWORD src1_sel:WORD_1
    ds_read_u16_d16 v212, v212
    ds_read_u16_d16_hi v213, v213
    s_waitcnt lgkmcnt(14)
    v_mfma_f32_16x16x32_bf16 v[176:179], v[228:231], v[16:19], v[176:179]
    v_or_b32 v149, v198, v199
    v_mfma_f32_16x16x32_bf16 v[180:183], v[228:231], v[20:23], v[180:183]
    v_lshlrev_b32_sdwa v214, 1, v214 dst_sel:DWORD dst_unused:UNUSED_PAD src0_sel:DWORD src1_sel:WORD_1
    v_mfma_f32_16x16x32_bf16 v[184:187], v[228:231], v[24:27], v[184:187]
    v_lshlrev_b32_sdwa v215, 1, v215 dst_sel:DWORD dst_unused:UNUSED_PAD src0_sel:DWORD src1_sel:WORD_1
    ds_read_u16_d16 v214, v214
    ds_read_u16_d16_hi v215, v215
    v_mfma_f32_16x16x32_bf16 v[188:191], v[228:231], v[28:31], v[188:191]
    ds_read_b64_tr_b16 v[228:229], v255 offset:7240
    ds_read_b64_tr_b16 v[230:231], v255 offset:8008
    v_or_b32 v152, v200, v201
    v_lshlrev_b32_sdwa v216, 1, v216 dst_sel:DWORD dst_unused:UNUSED_PAD src0_sel:DWORD src1_sel:WORD_1
    v_mfma_f32_16x16x32_bf16 v[52:55], v[232:235], v[160:163], v[52:55]
    v_lshlrev_b32_sdwa v217, 1, v217 dst_sel:DWORD dst_unused:UNUSED_PAD src0_sel:DWORD src1_sel:WORD_1
    ds_read_u16_d16 v216, v216
    ds_read_u16_d16_hi v217, v217
    v_mfma_f32_16x16x32_bf16 v[60:63], v[232:235], v[164:167], v[60:63]
    v_or_b32 v153, v202, v203
    v_mfma_f32_16x16x32_bf16 v[68:71], v[232:235], v[168:171], v[68:71]
    v_lshlrev_b32_sdwa v218, 1, v218 dst_sel:DWORD dst_unused:UNUSED_PAD src0_sel:DWORD src1_sel:WORD_1
    v_mfma_f32_16x16x32_bf16 v[76:79], v[232:235], v[172:175], v[76:79]
    ds_read_b64_tr_b16 v[232:233], v254 offset:13320
    ds_read_b64_tr_b16 v[234:235], v254 offset:13576
    v_lshlrev_b32_sdwa v219, 1, v219 dst_sel:DWORD dst_unused:UNUSED_PAD src0_sel:DWORD src1_sel:WORD_1
    ds_read_u16_d16 v218, v218
    ds_read_u16_d16_hi v219, v219
    s_waitcnt lgkmcnt(14)
    v_mfma_f32_16x16x32_bf16 v[176:179], v[236:239], v[32:35], v[176:179]
    v_or_b32 v156, v204, v205
    v_mfma_f32_16x16x32_bf16 v[180:183], v[236:239], v[36:39], v[180:183]
    v_lshlrev_b32_sdwa v220, 1, v220 dst_sel:DWORD dst_unused:UNUSED_PAD src0_sel:DWORD src1_sel:WORD_1
    v_mfma_f32_16x16x32_bf16 v[184:187], v[236:239], v[40:43], v[184:187]
    v_lshlrev_b32_sdwa v221, 1, v221 dst_sel:DWORD dst_unused:UNUSED_PAD src0_sel:DWORD src1_sel:WORD_1
    ds_read_u16_d16 v220, v220
    ds_read_u16_d16_hi v221, v221
    v_mfma_f32_16x16x32_bf16 v[188:191], v[236:239], v[44:47], v[188:191]
    ds_read_b64_tr_b16 v[236:237], v255 offset:7296
    ds_read_b64_tr_b16 v[238:239], v255 offset:8064
    v_or_b32 v157, v206, v207
    v_mfma_f32_16x16x32_bf16 v[80:83], v[240:243], v[160:163], v[80:83]
    v_lshlrev_b32_sdwa v222, 1, v222 dst_sel:DWORD dst_unused:UNUSED_PAD src0_sel:DWORD src1_sel:WORD_1
    v_mfma_f32_16x16x32_bf16 v[88:91], v[240:243], v[164:167], v[88:91]
    v_lshlrev_b32_sdwa v223, 1, v223 dst_sel:DWORD dst_unused:UNUSED_PAD src0_sel:DWORD src1_sel:WORD_1
    ds_read_u16_d16 v222, v222
    ds_read_u16_d16_hi v223, v223
    v_mfma_f32_16x16x32_bf16 v[96:99], v[240:243], v[168:171], v[96:99]
    v_mfma_f32_16x16x32_bf16 v[104:107], v[240:243], v[172:175], v[104:107]
    ds_read_b64_tr_b16 v[240:241], v254 offset:14344
    ds_read_b64_tr_b16 v[242:243], v254 offset:14600
    s_waitcnt lgkmcnt(14)
    v_mfma_f32_16x16x32_bf16 v[192:195], v[224:227], v[0:3], 0
    v_or_b32 v146, v208, v209
    v_lshlrev_b32_sdwa v176, 1, v176 dst_sel:DWORD dst_unused:UNUSED_PAD src0_sel:DWORD src1_sel:WORD_1
    v_mfma_f32_16x16x32_bf16 v[196:199], v[224:227], v[4:7], 0
    v_lshlrev_b32_sdwa v177, 1, v177 dst_sel:DWORD dst_unused:UNUSED_PAD src0_sel:DWORD src1_sel:WORD_1
    ds_read_u16_d16 v176, v176
    ds_read_u16_d16_hi v177, v177
    v_mfma_f32_16x16x32_bf16 v[200:203], v[224:227], v[8:11], 0
    v_or_b32 v147, v210, v211
    v_mfma_f32_16x16x32_bf16 v[204:207], v[224:227], v[12:15], 0
    ds_read_b64_tr_b16 v[224:225], v255 offset:7304
    ds_read_b64_tr_b16 v[226:227], v255 offset:8072
    v_lshlrev_b32_sdwa v178, 1, v178 dst_sel:DWORD dst_unused:UNUSED_PAD src0_sel:DWORD src1_sel:WORD_1
    v_mfma_f32_16x16x32_bf16 v[84:87], v[228:231], v[160:163], v[84:87]
    v_lshlrev_b32_sdwa v179, 1, v179 dst_sel:DWORD dst_unused:UNUSED_PAD src0_sel:DWORD src1_sel:WORD_1
    ds_read_u16_d16 v178, v178
    ds_read_u16_d16_hi v179, v179
    v_mfma_f32_16x16x32_bf16 v[92:95], v[228:231], v[164:167], v[92:95]
    v_or_b32 v150, v212, v213
    v_mfma_f32_16x16x32_bf16 v[100:103], v[228:231], v[168:171], v[100:103]
    v_lshlrev_b32_sdwa v180, 1, v180 dst_sel:DWORD dst_unused:UNUSED_PAD src0_sel:DWORD src1_sel:WORD_1
    v_mfma_f32_16x16x32_bf16 v[108:111], v[228:231], v[172:175], v[108:111]
    v_bfe_u32 v228, v253, 8, 1
    v_mul_u32_u24 v228, 50176, v228
    v_subrev_u32 v228, 131080, v228
    v_add_u32 v254, v254, v228

    s_cmp_ge_u32 s19, 7
    s_cbranch_scc1 L_rd7_go
    v_mov_b32 v228, 161976

    s_mov_b32 s29, 200000
L_rd7:
    ds_read_b32 v229, v228
    s_waitcnt lgkmcnt(0)
    v_cmp_le_u32 vcc, 7, v229
    s_cmp_eq_u64 vcc, exec
    s_cbranch_scc1 L_rd7_ok
    s_sleep 2
    s_sub_u32 s29, s29, 1
    s_cmp_lg_u32 s29, 0
    s_cbranch_scc1 L_rd7
L_rd7_ok:

    v_readfirstlane_b32 s19, v229
L_rd7_go:

    ds_read_b64_tr_b16 v[228:229], v254 offset:10240
    ds_read_b64_tr_b16 v[230:231], v254 offset:10496
    v_lshlrev_b32_sdwa v181, 1, v181 dst_sel:DWORD dst_unused:UNUSED_PAD src0_sel:DWORD src1_sel:WORD_1
    ds_read_u16_d16 v180, v180
    ds_read_u16_d16_hi v181, v181
    s_waitcnt lgkmcnt(14)
    v_mfma_f32_16x16x32_bf16 v[192:195], v[232:235], v[16:19], v[192:195]
    v_or_b32 v151, v214, v215
    v_mfma_f32_16x16x32_bf16 v[196:199], v[232:235], v[20:23], v[196:199]
    v_lshlrev_b32_sdwa v182, 1, v182 dst_sel:DWORD dst_unused:UNUSED_PAD src0_sel:DWORD src1_sel:WORD_1
    v_mfma_f32_16x16x32_bf16 v[200:203], v[232:235], v[24:27], v[200:203]
    v_lshlrev_b32_sdwa v183, 1, v183 dst_sel:DWORD dst_unused:UNUSED_PAD src0_sel:DWORD src1_sel:WORD_1
    ds_read_u16_d16 v182, v182
    ds_read_u16_d16_hi v183, v183
    v_mfma_f32_16x16x32_bf16 v[204:207], v[232:235], v[28:31], v[204:207]

    s_cmp_ge_u32 s19, 8
    s_cbranch_scc1 L_rd8_go
    v_mov_b32 v232, 161976

    s_mov_b32 s29, 200000
L_rd8:
    ds_read_b32 v233, v232
    s_waitcnt lgkmcnt(0)
    v_cmp_le_u32 vcc, 8, v233
    s_cmp_eq_u64 vcc, exec
    s_cbranch_scc1 L_rd8_ok
    s_sleep 2
    s_sub_u32 s29, s29, 1
    s_cmp_lg_u32 s29, 0
    s_cbranch_scc1 L_rd8
L_rd8_ok:

    v_readfirstlane_b32 s19, v233
L_rd8_go:

    ds_read_b64_tr_b16 v[232:233], v255 offset:13312
    ds_read_b64_tr_b16 v[234:235], v255 offset:14080
    v_or_b32 v154, v216, v217
    v_lshlrev_b32_sdwa v184, 1, v184 dst_sel:DWORD dst_unused:UNUSED_PAD src0_sel:DWORD src1_sel:WORD_1
    v_mfma_f32_16x16x32_bf16 v[112:115], v[236:239], v[160:163], v[112:115]
    v_lshlrev_b32_sdwa v185, 1, v185 dst_sel:DWORD dst_unused:UNUSED_PAD src0_sel:DWORD src1_sel:WORD_1
    ds_read_u16_d16 v184, v184
    ds_read_u16_d16_hi v185, v185
    v_mfma_f32_16x16x32_bf16 v[120:123], v[236:239], v[164:167], v[120:123]
    v_or_b32 v155, v218, v219
    v_mfma_f32_16x16x32_bf16 v[128:131], v[236:239], v[168:171], v[128:131]
    v_lshlrev_b32_sdwa v186, 1, v186 dst_sel:DWORD dst_unused:UNUSED_PAD src0_sel:DWORD src1_sel:WORD_1
    v_mfma_f32_16x16x32_bf16 v[136:139], v[236:239], v[172:175], v[136:139]
    ds_read_b64_tr_b16 v[236:237], v254 offset:11264
    ds_read_b64_tr_b16 v[238:239], v254 offset:11520
    v_lshlrev_b32_sdwa v187, 1, v187 dst_sel:DWORD dst_unused:UNUSED_PAD src0_sel:DWORD src1_sel:WORD_1
    ds_read_u16_d16 v186, v186
    ds_read_u16_d16_hi v187, v187
    s_waitcnt lgkmcnt(14)
    v_mfma_f32_16x16x32_bf16 v[192:195], v[240:243], v[32:35], v[192:195]
    v_or_b32 v158, v220, v221
    v_mfma_f32_16x16x32_bf16 v[196:199], v[240:243], v[36:39], v[196:199]
    v_lshlrev_b32_sdwa v188, 1, v188 dst_sel:DWORD dst_unused:UNUSED_PAD src0_sel:DWORD src1_sel:WORD_1
    v_mfma_f32_16x16x32_bf16 v[200:203], v[240:243], v[40:43], v[200:203]
    v_lshlrev_b32_sdwa v189, 1, v189 dst_sel:DWORD dst_unused:UNUSED_PAD src0_sel:DWORD src1_sel:WORD_1
    ds_read_u16_d16 v188, v188
    ds_read_u16_d16_hi v189, v189
    v_mfma_f32_16x16x32_bf16 v[204:207], v[240:243], v[44:47], v[204:207]
    ds_read_b64_tr_b16 v[240:241], v255 offset:13320
    ds_read_b64_tr_b16 v[242:243], v255 offset:14088
    v_or_b32 v159, v222, v223
    v_mfma_f32_16x16x32_bf16 v[116:119], v[224:227], v[160:163], v[116:119]
    v_lshlrev_b32_sdwa v190, 1, v190 dst_sel:DWORD dst_unused:UNUSED_PAD src0_sel:DWORD src1_sel:WORD_1
    v_mfma_f32_16x16x32_bf16 v[124:127], v[224:227], v[164:167], v[124:127]
    v_lshlrev_b32_sdwa v191, 1, v191 dst_sel:DWORD dst_unused:UNUSED_PAD src0_sel:DWORD src1_sel:WORD_1
    ds_read_u16_d16 v190, v190
    ds_read_u16_d16_hi v191, v191
    v_mfma_f32_16x16x32_bf16 v[132:135], v[224:227], v[168:171], v[132:135]
    v_mfma_f32_16x16x32_bf16 v[140:143], v[224:227], v[172:175], v[140:143]
    ds_read_b64_tr_b16 v[224:225], v254 offset:12288
    ds_read_b64_tr_b16 v[226:227], v254 offset:12544
    s_waitcnt lgkmcnt(14)
    v_mfma_f32_16x16x32_bf16 v[208:211], v[228:231], v[0:3], 0
    v_or_b32 v160, v176, v177
    v_lshlrev_b32_sdwa v192, 1, v192 dst_sel:DWORD dst_unused:UNUSED_PAD src0_sel:DWORD src1_sel:WORD_1
    v_mfma_f32_16x16x32_bf16 v[212:215], v[228:231], v[4:7], 0
    v_lshlrev_b32_sdwa v193, 1, v193 dst_sel:DWORD dst_unused:UNUSED_PAD src0_sel:DWORD src1_sel:WORD_1
    ds_read_u16_d16 v192, v192
    ds_read_u16_d16_hi v193, v193
    v_mfma_f32_16x16x32_bf16 v[216:219], v[228:231], v[8:11], 0
    v_or_b32 v161, v178, v179
    v_mfma_f32_16x16x32_bf16 v[220:223], v[228:231], v[12:15], 0
    ds_read_b64_tr_b16 v[228:229], v255 offset:13376
    ds_read_b64_tr_b16 v[230:231], v255 offset:14144
    v_lshlrev_b32_sdwa v194, 1, v194 dst_sel:DWORD dst_unused:UNUSED_PAD src0_sel:DWORD src1_sel:WORD_1
    v_mfma_f32_16x16x32_bf16 v[48:51], v[232:235], v[144:147], v[48:51]
    v_lshlrev_b32_sdwa v195, 1, v195 dst_sel:DWORD dst_unused:UNUSED_PAD src0_sel:DWORD src1_sel:WORD_1
    ds_read_u16_d16 v194, v194
    ds_read_u16_d16_hi v195, v195
    v_mfma_f32_16x16x32_bf16 v[56:59], v[232:235], v[148:151], v[56:59]
    v_or_b32 v164, v180, v181
    s_waitcnt vmcnt(0)
    v_dot2_f32_bf16 v52, v246, s86, v52
    v_dot2_f32_bf16 v53, v246, s87, v53
    v_mfma_f32_16x16x32_bf16 v[64:67], v[232:235], v[152:155], v[64:67]
    v_lshlrev_b32_sdwa v196, 1, v196 dst_sel:DWORD dst_unused:UNUSED_PAD src0_sel:DWORD src1_sel:WORD_1
    v_dot2_f32_bf16 v54, v247, s86, v54
    v_dot2_f32_bf16 v55, v247, s87, v55
    v_mfma_f32_16x16x32_bf16 v[72:75], v[232:235], v[156:159], v[72:75]
    ds_read_b64_tr_b16 v[232:233], v254 offset:10248
    ds_read_b64_tr_b16 v[234:235], v254 offset:10504
    v_lshlrev_b32_sdwa v197, 1, v197 dst_sel:DWORD dst_unused:UNUSED_PAD src0_sel:DWORD src1_sel:WORD_1
    ds_read_u16_d16 v196, v196
    ds_read_u16_d16_hi v197, v197
    v_dot2_f32_bf16 v80, v248, s86, v80
    v_dot2_f32_bf16 v81, v248, s87, v81
    s_waitcnt lgkmcnt(14)
    v_mfma_f32_16x16x32_bf16 v[208:211], v[236:239], v[16:19], v[208:211]
    v_or_b32 v165, v182, v183
    v_dot2_f32_bf16 v82, v249, s86, v82
    v_dot2_f32_bf16 v83, v249, s87, v83
    v_mfma_f32_16x16x32_bf16 v[212:215], v[236:239], v[20:23], v[212:215]
    v_lshlrev_b32_sdwa v198, 1, v198 dst_sel:DWORD dst_unused:UNUSED_PAD src0_sel:DWORD src1_sel:WORD_1
    v_dot2_f32_bf16 v48, v244, s86, v48
    v_dot2_f32_bf16 v49, v244, s87, v49
    v_mfma_f32_16x16x32_bf16 v[216:219], v[236:239], v[24:27], v[216:219]
    v_lshlrev_b32_sdwa v199, 1, v199 dst_sel:DWORD dst_unused:UNUSED_PAD src0_sel:DWORD src1_sel:WORD_1
    ds_read_u16_d16 v198, v198
    ds_read_u16_d16_hi v199, v199
    v_dot2_f32_bf16 v50, v245, s86, v50
    v_dot2_f32_bf16 v51, v245, s87, v51
    v_mfma_f32_16x16x32_bf16 v[220:223], v[236:239], v[28:31], v[220:223]
    ds_read_b64_tr_b16 v[236:237], v255 offset:13384
    ds_read_b64_tr_b16 v[238:239], v255 offset:14152
    v_or_b32 v168, v184, v185
    v_lshlrev_b32_sdwa v200, 1, v200 dst_sel:DWORD dst_unused:UNUSED_PAD src0_sel:DWORD src1_sel:WORD_1
    v_dot2_f32_bf16 v84, v250, s86, v84
    v_dot2_f32_bf16 v85, v250, s87, v85
    v_mfma_f32_16x16x32_bf16 v[52:55], v[240:243], v[144:147], v[52:55]
    v_lshlrev_b32_sdwa v201, 1, v201 dst_sel:DWORD dst_unused:UNUSED_PAD src0_sel:DWORD src1_sel:WORD_1
    ds_read_u16_d16 v200, v200
    ds_read_u16_d16_hi v201, v201
    v_dot2_f32_bf16 v86, v251, s86, v86
    v_dot2_f32_bf16 v87, v251, s87, v87
    buffer_load_dwordx4 v[244:247], v252, s[4:7], s24 offen offset:128 sc1
    buffer_load_dwordx4 v[248:251], v252, s[4:7], s24 offen offset:192 sc1
    v_mfma_f32_16x16x32_bf16 v[60:63], v[240:243], v[148:151], v[60:63]
    v_or_b32 v169, v186, v187
    v_mfma_f32_16x16x32_bf16 v[68:71], v[240:243], v[152:155], v[68:71]
    v_lshlrev_b32_sdwa v202, 1, v202 dst_sel:DWORD dst_unused:UNUSED_PAD src0_sel:DWORD src1_sel:WORD_1
    v_mfma_f32_16x16x32_bf16 v[76:79], v[240:243], v[156:159], v[76:79]
    ds_read_b64_tr_b16 v[240:241], v254 offset:11272
    ds_read_b64_tr_b16 v[242:243], v254 offset:11528
    v_lshlrev_b32_sdwa v203, 1, v203 dst_sel:DWORD dst_unused:UNUSED_PAD src0_sel:DWORD src1_sel:WORD_1
    ds_read_u16_d16 v202, v202
    ds_read_u16_d16_hi v203, v203
    s_waitcnt lgkmcnt(14)
    v_mfma_f32_16x16x32_bf16 v[208:211], v[224:227], v[32:35], v[208:211]
    v_or_b32 v172, v188, v189
    v_mfma_f32_16x16x32_bf16 v[212:215], v[224:227], v[36:39], v[212:215]
    v_lshlrev_b32_sdwa v204, 1, v204 dst_sel:DWORD dst_unused:UNUSED_PAD src0_sel:DWORD src1_sel:WORD_1
    v_mfma_f32_16x16x32_bf16 v[216:219], v[224:227], v[40:43], v[216:219]
    v_lshlrev_b32_sdwa v205, 1, v205 dst_sel:DWORD dst_unused:UNUSED_PAD src0_sel:DWORD src1_sel:WORD_1
    ds_read_u16_d16 v204, v204
    ds_read_u16_d16_hi v205, v205
    v_mfma_f32_16x16x32_bf16 v[220:223], v[224:227], v[44:47], v[220:223]
    ds_read_b64_tr_b16 v[224:225], v255 offset:13440
    ds_read_b64_tr_b16 v[226:227], v255 offset:14208
    v_or_b32 v173, v190, v191
    v_mfma_f32_16x16x32_bf16 v[80:83], v[228:231], v[144:147], v[80:83]
    v_lshlrev_b32_sdwa v206, 1, v206 dst_sel:DWORD dst_unused:UNUSED_PAD src0_sel:DWORD src1_sel:WORD_1
    v_mfma_f32_16x16x32_bf16 v[88:91], v[228:231], v[148:151], v[88:91]
    v_lshlrev_b32_sdwa v207, 1, v207 dst_sel:DWORD dst_unused:UNUSED_PAD src0_sel:DWORD src1_sel:WORD_1
    ds_read_u16_d16 v206, v206
    ds_read_u16_d16_hi v207, v207
    v_mfma_f32_16x16x32_bf16 v[96:99], v[228:231], v[152:155], v[96:99]
    v_mfma_f32_16x16x32_bf16 v[104:107], v[228:231], v[156:159], v[104:107]
    ds_read_b64_tr_b16 v[228:229], v254 offset:12296
    ds_read_b64_tr_b16 v[230:231], v254 offset:12552
    s_waitcnt lgkmcnt(14)
    v_mfma_f32_16x16x32_bf16 v[176:179], v[232:235], v[0:3], 0
    v_or_b32 v162, v192, v193
    v_lshlrev_b32_sdwa v208, 1, v208 dst_sel:DWORD dst_unused:UNUSED_PAD src0_sel:DWORD src1_sel:WORD_1
    v_mfma_f32_16x16x32_bf16 v[180:183], v[232:235], v[4:7], 0
    v_lshlrev_b32_sdwa v209, 1, v209 dst_sel:DWORD dst_unused:UNUSED_PAD src0_sel:DWORD src1_sel:WORD_1
    ds_read_u16_d16 v208, v208
    ds_read_u16_d16_hi v209, v209
    v_mfma_f32_16x16x32_bf16 v[184:187], v[232:235], v[8:11], 0
    v_or_b32 v163, v194, v195
    v_mfma_f32_16x16x32_bf16 v[188:191], v[232:235], v[12:15], 0
    ds_read_b64_tr_b16 v[232:233], v255 offset:13448
    ds_read_b64_tr_b16 v[234:235], v255 offset:14216
    v_lshlrev_b32_sdwa v210, 1, v210 dst_sel:DWORD dst_unused:UNUSED_PAD src0_sel:DWORD src1_sel:WORD_1
    v_mfma_f32_16x16x32_bf16 v[84:87], v[236:239], v[144:147], v[84:87]
    v_lshlrev_b32_sdwa v211, 1, v211 dst_sel:DWORD dst_unused:UNUSED_PAD src0_sel:DWORD src1_sel:WORD_1
    ds_read_u16_d16 v210, v210
    ds_read_u16_d16_hi v211, v211
    v_mfma_f32_16x16x32_bf16 v[92:95], v[236:239], v[148:151], v[92:95]
    v_or_b32 v166, v196, v197
    v_mfma_f32_16x16x32_bf16 v[100:103], v[236:239], v[152:155], v[100:103]
    v_lshlrev_b32_sdwa v212, 1, v212 dst_sel:DWORD dst_unused:UNUSED_PAD src0_sel:DWORD src1_sel:WORD_1
    v_mfma_f32_16x16x32_bf16 v[108:111], v[236:239], v[156:159], v[108:111]

    s_cmp_ge_u32 s19, 9
    s_cbranch_scc1 L_rd9_go
    v_mov_b32 v236, 161976

    s_mov_b32 s29, 200000
L_rd9:
    ds_read_b32 v237, v236
    s_waitcnt lgkmcnt(0)
    v_cmp_le_u32 vcc, 9, v237
    s_cmp_eq_u64 vcc, exec
    s_cbranch_scc1 L_rd9_ok
    s_sleep 2
    s_sub_u32 s29, s29, 1
    s_cmp_lg_u32 s29, 0
    s_cbranch_scc1 L_rd9
L_rd9_ok:

    v_readfirstlane_b32 s19, v237
L_rd9_go:

    ds_read_b64_tr_b16 v[236:237], v254 offset:16384
    ds_read_b64_tr_b16 v[238:239], v254 offset:16640
    v_lshlrev_b32_sdwa v213, 1, v213 dst_sel:DWORD dst_unused:UNUSED_PAD src0_sel:DWORD src1_sel:WORD_1
    ds_read_u16_d16 v212, v212
    ds_read_u16_d16_hi v213, v213
    s_waitcnt lgkmcnt(14)
    v_mfma_f32_16x16x32_bf16 v[176:179], v[240:243], v[16:19], v[176:179]
    v_or_b32 v167, v198, v199
    v_mfma_f32_16x16x32_bf16 v[180:183], v[240:243], v[20:23], v[180:183]
    v_lshlrev_b32_sdwa v214, 1, v214 dst_sel:DWORD dst_unused:UNUSED_PAD src0_sel:DWORD src1_sel:WORD_1
    v_mfma_f32_16x16x32_bf16 v[184:187], v[240:243], v[24:27], v[184:187]
    v_lshlrev_b32_sdwa v215, 1, v215 dst_sel:DWORD dst_unused:UNUSED_PAD src0_sel:DWORD src1_sel:WORD_1
    ds_read_u16_d16 v214, v214
    ds_read_u16_d16_hi v215, v215
    v_mfma_f32_16x16x32_bf16 v[188:191], v[240:243], v[28:31], v[188:191]

    s_cmp_ge_u32 s19, 10
    s_cbranch_scc1 L_rd10_go
    v_mov_b32 v240, 161976

    s_mov_b32 s29, 200000
L_rd10:
    ds_read_b32 v241, v240
    s_waitcnt lgkmcnt(0)
    v_cmp_le_u32 vcc, 10, v241
    s_cmp_eq_u64 vcc, exec
    s_cbranch_scc1 L_rd10_ok
    s_sleep 2
    s_sub_u32 s29, s29, 1
    s_cmp_lg_u32 s29, 0
    s_cbranch_scc1 L_rd10
L_rd10_ok:

    v_readfirstlane_b32 s19, v241
L_rd10_go:

    ds_read_b64_tr_b16 v[240:241], v255 offset:19456
    ds_read_b64_tr_b16 v[242:243], v255 offset:20224
    v_or_b32 v170, v200, v201
    v_lshlrev_b32_sdwa v216, 1, v216 dst_sel:DWORD dst_unused:UNUSED_PAD src0_sel:DWORD src1_sel:WORD_1
    v_mfma_f32_16x16x32_bf16 v[112:115], v[224:227], v[144:147], v[112:115]
    v_lshlrev_b32_sdwa v217, 1, v217 dst_sel:DWORD dst_unused:UNUSED_PAD src0_sel:DWORD src1_sel:WORD_1
    ds_read_u16_d16 v216, v216
    ds_read_u16_d16_hi v217, v217
    v_mfma_f32_16x16x32_bf16 v[120:123], v[224:227], v[148:151], v[120:123]
    v_or_b32 v171, v202, v203
    v_mfma_f32_16x16x32_bf16 v[128:131], v[224:227], v[152:155], v[128:131]
    v_lshlrev_b32_sdwa v218, 1, v218 dst_sel:DWORD dst_unused:UNUSED_PAD src0_sel:DWORD src1_sel:WORD_1
    v_mfma_f32_16x16x32_bf16 v[136:139], v[224:227], v[156:159], v[136:139]
    ds_read_b64_tr_b16 v[224:225], v254 offset:17408
    ds_read_b64_tr_b16 v[226:227], v254 offset:17664
    v_lshlrev_b32_sdwa v219, 1, v219 dst_sel:DWORD dst_unused:UNUSED_PAD src0_sel:DWORD src1_sel:WORD_1
    ds_read_u16_d16 v218, v218
    ds_read_u16_d16_hi v219, v219
    s_waitcnt lgkmcnt(14)
    v_mfma_f32_16x16x32_bf16 v[176:179], v[228:231], v[32:35], v[176:179]
    v_or_b32 v174, v204, v205
    v_mfma_f32_16x16x32_bf16 v[180:183], v[228:231], v[36:39], v[180:183]
    v_lshlrev_b32_sdwa v220, 1, v220 dst_sel:DWORD dst_unused:UNUSED_PAD src0_sel:DWORD src1_sel:WORD_1
    v_mfma_f32_16x16x32_bf16 v[184:187], v[228:231], v[40:43], v[184:187]
    v_lshlrev_b32_sdwa v221, 1, v221 dst_sel:DWORD dst_unused:UNUSED_PAD src0_sel:DWORD src1_sel:WORD_1
    ds_read_u16_d16 v220, v220
    ds_read_u16_d16_hi v221, v221
    v_mfma_f32_16x16x32_bf16 v[188:191], v[228:231], v[44:47], v[188:191]
    ds_read_b64_tr_b16 v[228:229], v255 offset:19464
    ds_read_b64_tr_b16 v[230:231], v255 offset:20232
    v_or_b32 v175, v206, v207
    v_mfma_f32_16x16x32_bf16 v[116:119], v[232:235], v[144:147], v[116:119]
    v_lshlrev_b32_sdwa v222, 1, v222 dst_sel:DWORD dst_unused:UNUSED_PAD src0_sel:DWORD src1_sel:WORD_1
    v_mfma_f32_16x16x32_bf16 v[124:127], v[232:235], v[148:151], v[124:127]
    v_lshlrev_b32_sdwa v223, 1, v223 dst_sel:DWORD dst_unused:UNUSED_PAD src0_sel:DWORD src1_sel:WORD_1
    ds_read_u16_d16 v222, v222
    ds_read_u16_d16_hi v223, v223
    v_mfma_f32_16x16x32_bf16 v[132:135], v[232:235], v[152:155], v[132:135]
    v_mfma_f32_16x16x32_bf16 v[140:143], v[232:235], v[156:159], v[140:143]
    ds_read_b64_tr_b16 v[232:233], v254 offset:18432
    ds_read_b64_tr_b16 v[234:235], v254 offset:18688
    s_waitcnt lgkmcnt(14)
    v_mfma_f32_16x16x32_bf16 v[192:195], v[236:239], v[0:3], 0
    v_or_b32 v144, v208, v209
    v_lshlrev_b32_sdwa v176, 1, v176 dst_sel:DWORD dst_unused:UNUSED_PAD src0_sel:DWORD src1_sel:WORD_1
    v_mfma_f32_16x16x32_bf16 v[196:199], v[236:239], v[4:7], 0
    v_lshlrev_b32_sdwa v177, 1, v177 dst_sel:DWORD dst_unused:UNUSED_PAD src0_sel:DWORD src1_sel:WORD_1
    ds_read_u16_d16 v176, v176
    ds_read_u16_d16_hi v177, v177
    v_mfma_f32_16x16x32_bf16 v[200:203], v[236:239], v[8:11], 0
    v_or_b32 v145, v210, v211
    v_mfma_f32_16x16x32_bf16 v[204:207], v[236:239], v[12:15], 0
    ds_read_b64_tr_b16 v[236:237], v255 offset:19520
    ds_read_b64_tr_b16 v[238:239], v255 offset:20288
    v_lshlrev_b32_sdwa v178, 1, v178 dst_sel:DWORD dst_unused:UNUSED_PAD src0_sel:DWORD src1_sel:WORD_1
    v_mfma_f32_16x16x32_bf16 v[48:51], v[240:243], v[160:163], v[48:51]
    v_lshlrev_b32_sdwa v179, 1, v179 dst_sel:DWORD dst_unused:UNUSED_PAD src0_sel:DWORD src1_sel:WORD_1
    ds_read_u16_d16 v178, v178
    ds_read_u16_d16_hi v179, v179
    v_mfma_f32_16x16x32_bf16 v[56:59], v[240:243], v[164:167], v[56:59]
    v_or_b32 v148, v212, v213
    v_mfma_f32_16x16x32_bf16 v[64:67], v[240:243], v[168:171], v[64:67]
    v_lshlrev_b32_sdwa v180, 1, v180 dst_sel:DWORD dst_unused:UNUSED_PAD src0_sel:DWORD src1_sel:WORD_1
    v_mfma_f32_16x16x32_bf16 v[72:75], v[240:243], v[172:175], v[72:75]
    ds_read_b64_tr_b16 v[240:241], v254 offset:16392
    ds_read_b64_tr_b16 v[242:243], v254 offset:16648
    v_lshlrev_b32_sdwa v181, 1, v181 dst_sel:DWORD dst_unused:UNUSED_PAD src0_sel:DWORD src1_sel:WORD_1
    ds_read_u16_d16 v180, v180
    ds_read_u16_d16_hi v181, v181
    s_waitcnt lgkmcnt(14)
    v_mfma_f32_16x16x32_bf16 v[192:195], v[224:227], v[16:19], v[192:195]
    v_or_b32 v149, v214, v215
    v_mfma_f32_16x16x32_bf16 v[196:199], v[224:227], v[20:23], v[196:199]
    v_lshlrev_b32_sdwa v182, 1, v182 dst_sel:DWORD dst_unused:UNUSED_PAD src0_sel:DWORD src1_sel:WORD_1
    v_mfma_f32_16x16x32_bf16 v[200:203], v[224:227], v[24:27], v[200:203]
    v_lshlrev_b32_sdwa v183, 1, v183 dst_sel:DWORD dst_unused:UNUSED_PAD src0_sel:DWORD src1_sel:WORD_1
    ds_read_u16_d16 v182, v182
    ds_read_u16_d16_hi v183, v183
    v_mfma_f32_16x16x32_bf16 v[204:207], v[224:227], v[28:31], v[204:207]
    ds_read_b64_tr_b16 v[224:225], v255 offset:19528
    ds_read_b64_tr_b16 v[226:227], v255 offset:20296
    v_or_b32 v152, v216, v217
    v_lshlrev_b32_sdwa v184, 1, v184 dst_sel:DWORD dst_unused:UNUSED_PAD src0_sel:DWORD src1_sel:WORD_1
    v_mfma_f32_16x16x32_bf16 v[52:55], v[228:231], v[160:163], v[52:55]
    v_lshlrev_b32_sdwa v185, 1, v185 dst_sel:DWORD dst_unused:UNUSED_PAD src0_sel:DWORD src1_sel:WORD_1
    ds_read_u16_d16 v184, v184
    ds_read_u16_d16_hi v185, v185
    v_mfma_f32_16x16x32_bf16 v[60:63], v[228:231], v[164:167], v[60:63]
    v_or_b32 v153, v218, v219
    v_mfma_f32_16x16x32_bf16 v[68:71], v[228:231], v[168:171], v[68:71]
    v_lshlrev_b32_sdwa v186, 1, v186 dst_sel:DWORD dst_unused:UNUSED_PAD src0_sel:DWORD src1_sel:WORD_1
    v_mfma_f32_16x16x32_bf16 v[76:79], v[228:231], v[172:175], v[76:79]
    ds_read_b64_tr_b16 v[228:229], v254 offset:17416
    ds_read_b64_tr_b16 v[230:231], v254 offset:17672
    v_lshlrev_b32_sdwa v187, 1, v187 dst_sel:DWORD dst_unused:UNUSED_PAD src0_sel:DWORD src1_sel:WORD_1
    ds_read_u16_d16 v186, v186
    ds_read_u16_d16_hi v187, v187
    s_waitcnt lgkmcnt(14)
    v_mfma_f32_16x16x32_bf16 v[192:195], v[232:235], v[32:35], v[192:195]
    v_or_b32 v156, v220, v221
    v_mfma_f32_16x16x32_bf16 v[196:199], v[232:235], v[36:39], v[196:199]
    v_lshlrev_b32_sdwa v188, 1, v188 dst_sel:DWORD dst_unused:UNUSED_PAD src0_sel:DWORD src1_sel:WORD_1
    v_mfma_f32_16x16x32_bf16 v[200:203], v[232:235], v[40:43], v[200:203]
    v_lshlrev_b32_sdwa v189, 1, v189 dst_sel:DWORD dst_unused:UNUSED_PAD src0_sel:DWORD src1_sel:WORD_1
    ds_read_u16_d16 v188, v188
    ds_read_u16_d16_hi v189, v189
    v_mfma_f32_16x16x32_bf16 v[204:207], v[232:235], v[44:47], v[204:207]
    ds_read_b64_tr_b16 v[232:233], v255 offset:19584
    ds_read_b64_tr_b16 v[234:235], v255 offset:20352
    v_or_b32 v157, v222, v223
    v_mfma_f32_16x16x32_bf16 v[80:83], v[236:239], v[160:163], v[80:83]
    v_lshlrev_b32_sdwa v190, 1, v190 dst_sel:DWORD dst_unused:UNUSED_PAD src0_sel:DWORD src1_sel:WORD_1
    v_mfma_f32_16x16x32_bf16 v[88:91], v[236:239], v[164:167], v[88:91]
    v_lshlrev_b32_sdwa v191, 1, v191 dst_sel:DWORD dst_unused:UNUSED_PAD src0_sel:DWORD src1_sel:WORD_1
    ds_read_u16_d16 v190, v190
    ds_read_u16_d16_hi v191, v191
    v_mfma_f32_16x16x32_bf16 v[96:99], v[236:239], v[168:171], v[96:99]
    v_mfma_f32_16x16x32_bf16 v[104:107], v[236:239], v[172:175], v[104:107]
    ds_read_b64_tr_b16 v[236:237], v254 offset:18440
    ds_read_b64_tr_b16 v[238:239], v254 offset:18696
    s_waitcnt lgkmcnt(14)
    v_mfma_f32_16x16x32_bf16 v[208:211], v[240:243], v[0:3], 0
    v_or_b32 v146, v176, v177
    v_lshlrev_b32_sdwa v192, 1, v192 dst_sel:DWORD dst_unused:UNUSED_PAD src0_sel:DWORD src1_sel:WORD_1
    v_mfma_f32_16x16x32_bf16 v[212:215], v[240:243], v[4:7], 0
    v_lshlrev_b32_sdwa v193, 1, v193 dst_sel:DWORD dst_unused:UNUSED_PAD src0_sel:DWORD src1_sel:WORD_1
    ds_read_u16_d16 v192, v192
    ds_read_u16_d16_hi v193, v193
    v_mfma_f32_16x16x32_bf16 v[216:219], v[240:243], v[8:11], 0
    v_or_b32 v147, v178, v179
    v_mfma_f32_16x16x32_bf16 v[220:223], v[240:243], v[12:15], 0
    ds_read_b64_tr_b16 v[240:241], v255 offset:19592
    ds_read_b64_tr_b16 v[242:243], v255 offset:20360
    v_lshlrev_b32_sdwa v194, 1, v194 dst_sel:DWORD dst_unused:UNUSED_PAD src0_sel:DWORD src1_sel:WORD_1
    v_mfma_f32_16x16x32_bf16 v[84:87], v[224:227], v[160:163], v[84:87]
    v_lshlrev_b32_sdwa v195, 1, v195 dst_sel:DWORD dst_unused:UNUSED_PAD src0_sel:DWORD src1_sel:WORD_1
    ds_read_u16_d16 v194, v194
    ds_read_u16_d16_hi v195, v195
    v_mfma_f32_16x16x32_bf16 v[92:95], v[224:227], v[164:167], v[92:95]
    v_or_b32 v150, v180, v181
    s_waitcnt vmcnt(0)
    v_dot2_f32_bf16 v112, v244, s86, v112
    v_dot2_f32_bf16 v113, v244, s87, v113
    v_mfma_f32_16x16x32_bf16 v[100:103], v[224:227], v[168:171], v[100:103]
    v_lshlrev_b32_sdwa v196, 1, v196 dst_sel:DWORD dst_unused:UNUSED_PAD src0_sel:DWORD src1_sel:WORD_1
    v_dot2_f32_bf16 v114, v245, s86, v114
    v_dot2_f32_bf16 v115, v245, s87, v115
    v_mfma_f32_16x16x32_bf16 v[108:111], v[224:227], v[172:175], v[108:111]

    s_cmp_ge_u32 s19, 11
    s_cbranch_scc1 L_rd11_go
    v_mov_b32 v224, 161976

    s_mov_b32 s29, 200000
L_rd11:
    ds_read_b32 v225, v224
    s_waitcnt lgkmcnt(0)
    v_cmp_le_u32 vcc, 11, v225
    s_cmp_eq_u64 vcc, exec
    s_cbranch_scc1 L_rd11_ok
    s_sleep 2
    s_sub_u32 s29, s29, 1
    s_cmp_lg_u32 s29, 0
    s_cbranch_scc1 L_rd11
L_rd11_ok:

    v_readfirstlane_b32 s19, v225
L_rd11_go:

    ds_read_b64_tr_b16 v[224:225], v254 offset:22528
    ds_read_b64_tr_b16 v[226:227], v254 offset:22784
    v_lshlrev_b32_sdwa v197, 1, v197 dst_sel:DWORD dst_unused:UNUSED_PAD src0_sel:DWORD src1_sel:WORD_1
    ds_read_u16_d16 v196, v196
    ds_read_u16_d16_hi v197, v197
    v_dot2_f32_bf16 v116, v246, s86, v116
    v_dot2_f32_bf16 v117, v246, s87, v117
    s_waitcnt lgkmcnt(14)
    v_mfma_f32_16x16x32_bf16 v[208:211], v[228:231], v[16:19], v[208:211]
    v_or_b32 v151, v182, v183
    v_dot2_f32_bf16 v118, v247, s86, v118
    v_dot2_f32_bf16 v119, v247, s87, v119
    v_mfma_f32_16x16x32_bf16 v[212:215], v[228:231], v[20:23], v[212:215]
    v_lshlrev_b32_sdwa v198, 1, v198 dst_sel:DWORD dst_unused:UNUSED_PAD src0_sel:DWORD src1_sel:WORD_1
    v_dot2_f32_bf16 v56, v248, s86, v56
    v_dot2_f32_bf16 v57, v248, s87, v57
    v_mfma_f32_16x16x32_bf16 v[216:219], v[228:231], v[24:27], v[216:219]
    v_lshlrev_b32_sdwa v199, 1, v199 dst_sel:DWORD dst_unused:UNUSED_PAD src0_sel:DWORD src1_sel:WORD_1
    ds_read_u16_d16 v198, v198
    ds_read_u16_d16_hi v199, v199
    v_dot2_f32_bf16 v58, v249, s86, v58
    v_dot2_f32_bf16 v59, v249, s87, v59
    v_mfma_f32_16x16x32_bf16 v[220:223], v[228:231], v[28:31], v[220:223]

    s_cmp_ge_u32 s19, 12
    s_cbranch_scc1 L_rd12_go
    v_mov_b32 v228, 161976

    s_mov_b32 s29, 200000
L_rd12:
    ds_read_b32 v229, v228
    s_waitcnt lgkmcnt(0)
    v_cmp_le_u32 vcc, 12, v229
    s_cmp_eq_u64 vcc, exec
    s_cbranch_scc1 L_rd12_ok
    s_sleep 2
    s_sub_u32 s29, s29, 1
    s_cmp_lg_u32 s29, 0
    s_cbranch_scc1 L_rd12
L_rd12_ok:

    v_readfirstlane_b32 s19, v229
L_rd12_go:

    ds_read_b64_tr_b16 v[228:229], v255 offset:25600
    ds_read_b64_tr_b16 v[230:231], v255 offset:26368
    v_or_b32 v154, v184, v185
    v_lshlrev_b32_sdwa v200, 1, v200 dst_sel:DWORD dst_unused:UNUSED_PAD src0_sel:DWORD src1_sel:WORD_1
    v_dot2_f32_bf16 v60, v250, s86, v60
    v_dot2_f32_bf16 v61, v250, s87, v61
    v_mfma_f32_16x16x32_bf16 v[112:115], v[232:235], v[160:163], v[112:115]
    v_lshlrev_b32_sdwa v201, 1, v201 dst_sel:DWORD dst_unused:UNUSED_PAD src0_sel:DWORD src1_sel:WORD_1
    ds_read_u16_d16 v200, v200
    ds_read_u16_d16_hi v201, v201
    v_dot2_f32_bf16 v62, v251, s86, v62
    v_dot2_f32_bf16 v63, v251, s87, v63
    buffer_load_dwordx4 v[244:247], v252, s[4:7], s24 offen offset:256 sc1
    buffer_load_dwordx4 v[248:251], v252, s[4:7], s24 offen offset:320 sc1
    v_mfma_f32_16x16x32_bf16 v[120:123], v[232:235], v[164:167], v[120:123]
    v_or_b32 v155, v186, v187
    v_mfma_f32_16x16x32_bf16 v[128:131], v[232:235], v[168:171], v[128:131]
    v_lshlrev_b32_sdwa v202, 1, v202 dst_sel:DWORD dst_unused:UNUSED_PAD src0_sel:DWORD src1_sel:WORD_1
    v_mfma_f32_16x16x32_bf16 v[136:139], v[232:235], v[172:175], v[136:139]
    ds_read_b64_tr_b16 v[232:233], v254 offset:23552
    ds_read_b64_tr_b16 v[234:235], v254 offset:23808
    v_lshlrev_b32_sdwa v203, 1, v203 dst_sel:DWORD dst_unused:UNUSED_PAD src0_sel:DWORD src1_sel:WORD_1
    ds_read_u16_d16 v202, v202
    ds_read_u16_d16_hi v203, v203
    s_waitcnt lgkmcnt(14)
    v_mfma_f32_16x16x32_bf16 v[208:211], v[236:239], v[32:35], v[208:211]
    v_or_b32 v158, v188, v189
    v_mfma_f32_16x16x32_bf16 v[212:215], v[236:239], v[36:39], v[212:215]
    v_lshlrev_b32_sdwa v204, 1, v204 dst_sel:DWORD dst_unused:UNUSED_PAD src0_sel:DWORD src1_sel:WORD_1
    v_mfma_f32_16x16x32_bf16 v[216:219], v[236:239], v[40:43], v[216:219]
    v_lshlrev_b32_sdwa v205, 1, v205 dst_sel:DWORD dst_unused:UNUSED_PAD src0_sel:DWORD src1_sel:WORD_1
    ds_read_u16_d16 v204, v204
    ds_read_u16_d16_hi v205, v205
    v_mfma_f32_16x16x32_bf16 v[220:223], v[236:239], v[44:47], v[220:223]
    ds_read_b64_tr_b16 v[236:237], v255 offset:25608
    ds_read_b64_tr_b16 v[238:239], v255 offset:26376
    v_or_b32 v159, v190, v191
    v_mfma_f32_16x16x32_bf16 v[116:119], v[240:243], v[160:163], v[116:119]
    v_lshlrev_b32_sdwa v206, 1, v206 dst_sel:DWORD dst_unused:UNUSED_PAD src0_sel:DWORD src1_sel:WORD_1
    v_mfma_f32_16x16x32_bf16 v[124:127], v[240:243], v[164:167], v[124:127]
    v_lshlrev_b32_sdwa v207, 1, v207 dst_sel:DWORD dst_unused:UNUSED_PAD src0_sel:DWORD src1_sel:WORD_1
    ds_read_u16_d16 v206, v206
    ds_read_u16_d16_hi v207, v207
    v_mfma_f32_16x16x32_bf16 v[132:135], v[240:243], v[168:171], v[132:135]
    v_mfma_f32_16x16x32_bf16 v[140:143], v[240:243], v[172:175], v[140:143]
    ds_read_b64_tr_b16 v[240:241], v254 offset:24576
    ds_read_b64_tr_b16 v[242:243], v254 offset:24832
    s_waitcnt lgkmcnt(14)
    v_mfma_f32_16x16x32_bf16 v[176:179], v[224:227], v[0:3], 0
    v_or_b32 v160, v192, v193
    v_lshlrev_b32_sdwa v208, 1, v208 dst_sel:DWORD dst_unused:UNUSED_PAD src0_sel:DWORD src1_sel:WORD_1
    v_mfma_f32_16x16x32_bf16 v[180:183], v[224:227], v[4:7], 0
    v_lshlrev_b32_sdwa v209, 1, v209 dst_sel:DWORD dst_unused:UNUSED_PAD src0_sel:DWORD src1_sel:WORD_1
    ds_read_u16_d16 v208, v208
    ds_read_u16_d16_hi v209, v209
    v_mfma_f32_16x16x32_bf16 v[184:187], v[224:227], v[8:11], 0
    v_or_b32 v161, v194, v195
    v_mfma_f32_16x16x32_bf16 v[188:191], v[224:227], v[12:15], 0
    ds_read_b64_tr_b16 v[224:225], v255 offset:25664
    ds_read_b64_tr_b16 v[226:227], v255 offset:26432
    v_lshlrev_b32_sdwa v210, 1, v210 dst_sel:DWORD dst_unused:UNUSED_PAD src0_sel:DWORD src1_sel:WORD_1
    v_mfma_f32_16x16x32_bf16 v[48:51], v[228:231], v[144:147], v[48:51]
    v_lshlrev_b32_sdwa v211, 1, v211 dst_sel:DWORD dst_unused:UNUSED_PAD src0_sel:DWORD src1_sel:WORD_1
    ds_read_u16_d16 v210, v210
    ds_read_u16_d16_hi v211, v211
    v_mfma_f32_16x16x32_bf16 v[56:59], v[228:231], v[148:151], v[56:59]
    v_or_b32 v164, v196, v197
    v_mfma_f32_16x16x32_bf16 v[64:67], v[228:231], v[152:155], v[64:67]
    v_lshlrev_b32_sdwa v212, 1, v212 dst_sel:DWORD dst_unused:UNUSED_PAD src0_sel:DWORD src1_sel:WORD_1
    v_mfma_f32_16x16x32_bf16 v[72:75], v[228:231], v[156:159], v[72:75]
    ds_read_b64_tr_b16 v[228:229], v254 offset:22536
    ds_read_b64_tr_b16 v[230:231], v254 offset:22792
    v_lshlrev_b32_sdwa v213, 1, v213 dst_sel:DWORD dst_unused:UNUSED_PAD src0_sel:DWORD src1_sel:WORD_1
    ds_read_u16_d16 v212, v212
    ds_read_u16_d16_hi v213, v213
    s_waitcnt lgkmcnt(14)
    v_mfma_f32_16x16x32_bf16 v[176:179], v[232:235], v[16:19], v[176:179]
    v_or_b32 v165, v198, v199
    v_mfma_f32_16x16x32_bf16 v[180:183], v[232:235], v[20:23], v[180:183]
    v_lshlrev_b32_sdwa v214, 1, v214 dst_sel:DWORD dst_unused:UNUSED_PAD src0_sel:DWORD src1_sel:WORD_1
    v_mfma_f32_16x16x32_bf16 v[184:187], v[232:235], v[24:27], v[184:187]
    v_lshlrev_b32_sdwa v215, 1, v215 dst_sel:DWORD dst_unused:UNUSED_PAD src0_sel:DWORD src1_sel:WORD_1
    ds_read_u16_d16 v214, v214
    ds_read_u16_d16_hi v215, v215
    v_mfma_f32_16x16x32_bf16 v[188:191], v[232:235], v[28:31], v[188:191]
    ds_read_b64_tr_b16 v[232:233], v255 offset:25672
    ds_read_b64_tr_b16 v[234:235], v255 offset:26440
    v_or_b32 v168, v200, v201
    v_lshlrev_b32_sdwa v216, 1, v216 dst_sel:DWORD dst_unused:UNUSED_PAD src0_sel:DWORD src1_sel:WORD_1
    v_mfma_f32_16x16x32_bf16 v[52:55], v[236:239], v[144:147], v[52:55]
    v_lshlrev_b32_sdwa v217, 1, v217 dst_sel:DWORD dst_unused:UNUSED_PAD src0_sel:DWORD src1_sel:WORD_1
    ds_read_u16_d16 v216, v216
    ds_read_u16_d16_hi v217, v217
    v_mfma_f32_16x16x32_bf16 v[60:63], v[236:239], v[148:151], v[60:63]
    v_or_b32 v169, v202, v203
    v_mfma_f32_16x16x32_bf16 v[68:71], v[236:239], v[152:155], v[68:71]
    v_lshlrev_b32_sdwa v218, 1, v218 dst_sel:DWORD dst_unused:UNUSED_PAD src0_sel:DWORD src1_sel:WORD_1
    v_mfma_f32_16x16x32_bf16 v[76:79], v[236:239], v[156:159], v[76:79]
    ds_read_b64_tr_b16 v[236:237], v254 offset:23560
    ds_read_b64_tr_b16 v[238:239], v254 offset:23816
    v_lshlrev_b32_sdwa v219, 1, v219 dst_sel:DWORD dst_unused:UNUSED_PAD src0_sel:DWORD src1_sel:WORD_1
    ds_read_u16_d16 v218, v218
    ds_read_u16_d16_hi v219, v219
    s_waitcnt lgkmcnt(14)
    v_mfma_f32_16x16x32_bf16 v[176:179], v[240:243], v[32:35], v[176:179]
    v_or_b32 v172, v204, v205
    v_mfma_f32_16x16x32_bf16 v[180:183], v[240:243], v[36:39], v[180:183]
    v_lshlrev_b32_sdwa v220, 1, v220 dst_sel:DWORD dst_unused:UNUSED_PAD src0_sel:DWORD src1_sel:WORD_1
    v_mfma_f32_16x16x32_bf16 v[184:187], v[240:243], v[40:43], v[184:187]
    v_lshlrev_b32_sdwa v221, 1, v221 dst_sel:DWORD dst_unused:UNUSED_PAD src0_sel:DWORD src1_sel:WORD_1
    ds_read_u16_d16 v220, v220
    ds_read_u16_d16_hi v221, v221
    v_mfma_f32_16x16x32_bf16 v[188:191], v[240:243], v[44:47], v[188:191]
    ds_read_b64_tr_b16 v[240:241], v255 offset:25728
    ds_read_b64_tr_b16 v[242:243], v255 offset:26496
    v_or_b32 v173, v206, v207
    v_mfma_f32_16x16x32_bf16 v[80:83], v[224:227], v[144:147], v[80:83]
    v_lshlrev_b32_sdwa v222, 1, v222 dst_sel:DWORD dst_unused:UNUSED_PAD src0_sel:DWORD src1_sel:WORD_1
    v_mfma_f32_16x16x32_bf16 v[88:91], v[224:227], v[148:151], v[88:91]
    v_lshlrev_b32_sdwa v223, 1, v223 dst_sel:DWORD dst_unused:UNUSED_PAD src0_sel:DWORD src1_sel:WORD_1
    ds_read_u16_d16 v222, v222
    ds_read_u16_d16_hi v223, v223
    v_mfma_f32_16x16x32_bf16 v[96:99], v[224:227], v[152:155], v[96:99]
    v_mfma_f32_16x16x32_bf16 v[104:107], v[224:227], v[156:159], v[104:107]
    ds_read_b64_tr_b16 v[224:225], v254 offset:24584
    ds_read_b64_tr_b16 v[226:227], v254 offset:24840
    s_cmp_eq_u32 s17, 0
    s_cbranch_scc1 L_pu
    s_setprio 0
L_pu:
    s_waitcnt lgkmcnt(14)
    v_mfma_f32_16x16x32_bf16 v[192:195], v[228:231], v[0:3], 0
    v_or_b32 v162, v208, v209
    v_lshlrev_b32_sdwa v176, 1, v176 dst_sel:DWORD dst_unused:UNUSED_PAD src0_sel:DWORD src1_sel:WORD_1
    v_mfma_f32_16x16x32_bf16 v[196:199], v[228:231], v[4:7], 0
    v_lshlrev_b32_sdwa v177, 1, v177 dst_sel:DWORD dst_unused:UNUSED_PAD src0_sel:DWORD src1_sel:WORD_1
    ds_read_u16_d16 v176, v176
    ds_read_u16_d16_hi v177, v177
    v_mfma_f32_16x16x32_bf16 v[200:203], v[228:231], v[8:11], 0
    v_or_b32 v163, v210, v211
    v_mfma_f32_16x16x32_bf16 v[204:207], v[228:231], v[12:15], 0
    ds_read_b64_tr_b16 v[228:229], v255 offset:25736
    ds_read_b64_tr_b16 v[230:231], v255 offset:26504
    v_lshlrev_b32_sdwa v178, 1, v178 dst_sel:DWORD dst_unused:UNUSED_PAD src0_sel:DWORD src1_sel:WORD_1
    v_mfma_f32_16x16x32_bf16 v[84:87], v[232:235], v[144:147], v[84:87]
    v_lshlrev_b32_sdwa v179, 1, v179 dst_sel:DWORD dst_unused:UNUSED_PAD src0_sel:DWORD src1_sel:WORD_1
    ds_read_u16_d16 v178, v178
    ds_read_u16_d16_hi v179, v179
    v_mfma_f32_16x16x32_bf16 v[92:95], v[232:235], v[148:151], v[92:95]
    v_or_b32 v166, v212, v213
    v_mfma_f32_16x16x32_bf16 v[100:103], v[232:235], v[152:155], v[100:103]
    v_lshlrev_b32_sdwa v180, 1, v180 dst_sel:DWORD dst_unused:UNUSED_PAD src0_sel:DWORD src1_sel:WORD_1
    v_mfma_f32_16x16x32_bf16 v[108:111], v[232:235], v[156:159], v[108:111]

    s_cmp_ge_u32 s19, 13
    s_cbranch_scc1 L_rd13_go
    v_mov_b32 v232, 161976

    s_mov_b32 s29, 200000
L_rd13:
    ds_read_b32 v233, v232
    s_waitcnt lgkmcnt(0)
    v_cmp_le_u32 vcc, 13, v233
    s_cmp_eq_u64 vcc, exec
    s_cbranch_scc1 L_rd13_ok
    s_sleep 2
    s_sub_u32 s29, s29, 1
    s_cmp_lg_u32 s29, 0
    s_cbranch_scc1 L_rd13
L_rd13_ok:

    v_readfirstlane_b32 s19, v233
L_rd13_go:

    ds_read_b64_tr_b16 v[232:233], v254 offset:28672
    ds_read_b64_tr_b16 v[234:235], v254 offset:28928
    v_lshlrev_b32_sdwa v181, 1, v181 dst_sel:DWORD dst_unused:UNUSED_PAD src0_sel:DWORD src1_sel:WORD_1
    ds_read_u16_d16 v180, v180
    ds_read_u16_d16_hi v181, v181
    s_waitcnt lgkmcnt(14)
    v_mfma_f32_16x16x32_bf16 v[192:195], v[236:239], v[16:19], v[192:195]
    v_or_b32 v167, v214, v215
    v_mfma_f32_16x16x32_bf16 v[196:199], v[236:239], v[20:23], v[196:199]
    v_lshlrev_b32_sdwa v182, 1, v182 dst_sel:DWORD dst_unused:UNUSED_PAD src0_sel:DWORD src1_sel:WORD_1
    v_mfma_f32_16x16x32_bf16 v[200:203], v[236:239], v[24:27], v[200:203]
    v_lshlrev_b32_sdwa v183, 1, v183 dst_sel:DWORD dst_unused:UNUSED_PAD src0_sel:DWORD src1_sel:WORD_1
    ds_read_u16_d16 v182, v182
    ds_read_u16_d16_hi v183, v183
    v_mfma_f32_16x16x32_bf16 v[204:207], v[236:239], v[28:31], v[204:207]

    s_cmp_ge_u32 s19, 14
    s_cbranch_scc1 L_rd14_go
    v_mov_b32 v236, 161976

    s_mov_b32 s29, 200000
L_rd14:
    ds_read_b32 v237, v236
    s_waitcnt lgkmcnt(0)
    v_cmp_le_u32 vcc, 14, v237
    s_cmp_eq_u64 vcc, exec
    s_cbranch_scc1 L_rd14_ok
    s_sleep 2
    s_sub_u32 s29, s29, 1
    s_cmp_lg_u32 s29, 0
    s_cbranch_scc1 L_rd14
L_rd14_ok:

    v_readfirstlane_b32 s19, v237
L_rd14_go:

    ds_read_b64_tr_b16 v[236:237], v255 offset:31744
    ds_read_b64_tr_b16 v[238:239], v255 offset:32512
    v_or_b32 v170, v216, v217
    v_lshlrev_b32_sdwa v184, 1, v184 dst_sel:DWORD dst_unused:UNUSED_PAD src0_sel:DWORD src1_sel:WORD_1
    v_mfma_f32_16x16x32_bf16 v[112:115], v[240:243], v[144:147], v[112:115]
    v_lshlrev_b32_sdwa v185, 1, v185 dst_sel:DWORD dst_unused:UNUSED_PAD src0_sel:DWORD src1_sel:WORD_1
    ds_read_u16_d16 v184, v184
    ds_read_u16_d16_hi v185, v185
    v_mfma_f32_16x16x32_bf16 v[120:123], v[240:243], v[148:151], v[120:123]
    v_or_b32 v171, v218, v219
    v_mfma_f32_16x16x32_bf16 v[128:131], v[240:243], v[152:155], v[128:131]
    v_lshlrev_b32_sdwa v186, 1, v186 dst_sel:DWORD dst_unused:UNUSED_PAD src0_sel:DWORD src1_sel:WORD_1
    v_mfma_f32_16x16x32_bf16 v[136:139], v[240:243], v[156:159], v[136:139]
    ds_read_b64_tr_b16 v[240:241], v254 offset:29696
    ds_read_b64_tr_b16 v[242:243], v254 offset:29952
    v_lshlrev_b32_sdwa v187, 1, v187 dst_sel:DWORD dst_unused:UNUSED_PAD src0_sel:DWORD src1_sel:WORD_1
    ds_read_u16_d16 v186, v186
    ds_read_u16_d16_hi v187, v187
    s_waitcnt lgkmcnt(14)
    v_mfma_f32_16x16x32_bf16 v[192:195], v[224:227], v[32:35], v[192:195]
    v_or_b32 v174, v220, v221
    v_mfma_f32_16x16x32_bf16 v[196:199], v[224:227], v[36:39], v[196:199]
    v_lshlrev_b32_sdwa v188, 1, v188 dst_sel:DWORD dst_unused:UNUSED_PAD src0_sel:DWORD src1_sel:WORD_1
    v_mfma_f32_16x16x32_bf16 v[200:203], v[224:227], v[40:43], v[200:203]
    v_lshlrev_b32_sdwa v189, 1, v189 dst_sel:DWORD dst_unused:UNUSED_PAD src0_sel:DWORD src1_sel:WORD_1
    ds_read_u16_d16 v188, v188
    ds_read_u16_d16_hi v189, v189
    v_mfma_f32_16x16x32_bf16 v[204:207], v[224:227], v[44:47], v[204:207]
    ds_read_b64_tr_b16 v[224:225], v255 offset:31752
    ds_read_b64_tr_b16 v[226:227], v255 offset:32520
    v_or_b32 v175, v222, v223
    v_mfma_f32_16x16x32_bf16 v[116:119], v[228:231], v[144:147], v[116:119]
    v_lshlrev_b32_sdwa v190, 1, v190 dst_sel:DWORD dst_unused:UNUSED_PAD src0_sel:DWORD src1_sel:WORD_1
    v_mfma_f32_16x16x32_bf16 v[124:127], v[228:231], v[148:151], v[124:127]
    v_lshlrev_b32_sdwa v191, 1, v191 dst_sel:DWORD dst_unused:UNUSED_PAD src0_sel:DWORD src1_sel:WORD_1
    ds_read_u16_d16 v190, v190
    ds_read_u16_d16_hi v191, v191
    v_mfma_f32_16x16x32_bf16 v[132:135], v[228:231], v[152:155], v[132:135]
    v_mfma_f32_16x16x32_bf16 v[140:143], v[228:231], v[156:159], v[140:143]
    ds_read_b64_tr_b16 v[228:229], v254 offset:30720
    ds_read_b64_tr_b16 v[230:231], v254 offset:30976
    s_waitcnt lgkmcnt(14)
    v_mfma_f32_16x16x32_bf16 v[208:211], v[232:235], v[0:3], 0
    v_or_b32 v144, v176, v177
    v_lshlrev_b32_sdwa v192, 1, v192 dst_sel:DWORD dst_unused:UNUSED_PAD src0_sel:DWORD src1_sel:WORD_1
    v_mfma_f32_16x16x32_bf16 v[212:215], v[232:235], v[4:7], 0
    v_lshlrev_b32_sdwa v193, 1, v193 dst_sel:DWORD dst_unused:UNUSED_PAD src0_sel:DWORD src1_sel:WORD_1
    ds_read_u16_d16 v192, v192
    ds_read_u16_d16_hi v193, v193
    v_mfma_f32_16x16x32_bf16 v[216:219], v[232:235], v[8:11], 0
    v_or_b32 v145, v178, v179
    v_mfma_f32_16x16x32_bf16 v[220:223], v[232:235], v[12:15], 0
    ds_read_b64_tr_b16 v[232:233], v255 offset:31808
    ds_read_b64_tr_b16 v[234:235], v255 offset:32576
    v_lshlrev_b32_sdwa v194, 1, v194 dst_sel:DWORD dst_unused:UNUSED_PAD src0_sel:DWORD src1_sel:WORD_1
    v_mfma_f32_16x16x32_bf16 v[48:51], v[236:239], v[160:163], v[48:51]
    v_lshlrev_b32_sdwa v195, 1, v195 dst_sel:DWORD dst_unused:UNUSED_PAD src0_sel:DWORD src1_sel:WORD_1
    ds_read_u16_d16 v194, v194
    ds_read_u16_d16_hi v195, v195
    v_mfma_f32_16x16x32_bf16 v[56:59], v[236:239], v[164:167], v[56:59]
    v_or_b32 v148, v180, v181
    s_waitcnt vmcnt(0)
    v_dot2_f32_bf16 v88, v244, s86, v88
    v_dot2_f32_bf16 v89, v244, s87, v89
    v_mfma_f32_16x16x32_bf16 v[64:67], v[236:239], v[168:171], v[64:67]
    v_lshlrev_b32_sdwa v196, 1, v196 dst_sel:DWORD dst_unused:UNUSED_PAD src0_sel:DWORD src1_sel:WORD_1
    v_dot2_f32_bf16 v90, v245, s86, v90
    v_dot2_f32_bf16 v91, v245, s87, v91
    v_mfma_f32_16x16x32_bf16 v[72:75], v[236:239], v[172:175], v[72:75]
    ds_read_b64_tr_b16 v[236:237], v254 offset:28680
    ds_read_b64_tr_b16 v[238:239], v254 offset:28936
    v_lshlrev_b32_sdwa v197, 1, v197 dst_sel:DWORD dst_unused:UNUSED_PAD src0_sel:DWORD src1_sel:WORD_1
    ds_read_u16_d16 v196, v196
    ds_read_u16_d16_hi v197, v197
    v_dot2_f32_bf16 v92, v246, s86, v92
    v_dot2_f32_bf16 v93, v246, s87, v93
    s_waitcnt lgkmcnt(14)
    v_mfma_f32_16x16x32_bf16 v[208:211], v[240:243], v[16:19], v[208:211]
    v_or_b32 v149, v182, v183
    v_dot2_f32_bf16 v94, v247, s86, v94
    v_dot2_f32_bf16 v95, v247, s87, v95
    v_mfma_f32_16x16x32_bf16 v[212:215], v[240:243], v[20:23], v[212:215]
    v_lshlrev_b32_sdwa v198, 1, v198 dst_sel:DWORD dst_unused:UNUSED_PAD src0_sel:DWORD src1_sel:WORD_1
    v_dot2_f32_bf16 v120, v248, s86, v120
    v_dot2_f32_bf16 v121, v248, s87, v121
    v_mfma_f32_16x16x32_bf16 v[216:219], v[240:243], v[24:27], v[216:219]
    v_lshlrev_b32_sdwa v199, 1, v199 dst_sel:DWORD dst_unused:UNUSED_PAD src0_sel:DWORD src1_sel:WORD_1
    ds_read_u16_d16 v198, v198
    ds_read_u16_d16_hi v199, v199
    v_dot2_f32_bf16 v122, v249, s86, v122
    v_dot2_f32_bf16 v123, v249, s87, v123
    v_mfma_f32_16x16x32_bf16 v[220:223], v[240:243], v[28:31], v[220:223]
    ds_read_b64_tr_b16 v[240:241], v255 offset:31816
    ds_read_b64_tr_b16 v[242:243], v255 offset:32584
    v_or_b32 v152, v184, v185
    v_lshlrev_b32_sdwa v200, 1, v200 dst_sel:DWORD dst_unused:UNUSED_PAD src0_sel:DWORD src1_sel:WORD_1
    v_dot2_f32_bf16 v124, v250, s86, v124
    v_dot2_f32_bf16 v125, v250, s87, v125
    v_mfma_f32_16x16x32_bf16 v[52:55], v[224:227], v[160:163], v[52:55]
    v_lshlrev_b32_sdwa v201, 1, v201 dst_sel:DWORD dst_unused:UNUSED_PAD src0_sel:DWORD src1_sel:WORD_1
    ds_read_u16_d16 v200, v200
    ds_read_u16_d16_hi v201, v201
    v_dot2_f32_bf16 v126, v251, s86, v126
    v_dot2_f32_bf16 v127, v251, s87, v127
    buffer_load_dwordx4 v[244:247], v252, s[4:7], s25 offen offset:0 sc1
    buffer_load_dwordx4 v[248:251], v252, s[4:7], s25 offen offset:64 sc1
    v_mfma_f32_16x16x32_bf16 v[60:63], v[224:227], v[164:167], v[60:63]
    v_or_b32 v153, v186, v187
    v_mfma_f32_16x16x32_bf16 v[68:71], v[224:227], v[168:171], v[68:71]
    v_lshlrev_b32_sdwa v202, 1, v202 dst_sel:DWORD dst_unused:UNUSED_PAD src0_sel:DWORD src1_sel:WORD_1
    v_mfma_f32_16x16x32_bf16 v[76:79], v[224:227], v[172:175], v[76:79]
    ds_read_b64_tr_b16 v[224:225], v254 offset:29704
    ds_read_b64_tr_b16 v[226:227], v254 offset:29960
    v_lshlrev_b32_sdwa v203, 1, v203 dst_sel:DWORD dst_unused:UNUSED_PAD src0_sel:DWORD src1_sel:WORD_1
    ds_read_u16_d16 v202, v202
    ds_read_u16_d16_hi v203, v203
    s_waitcnt lgkmcnt(14)
    v_mfma_f32_16x16x32_bf16 v[208:211], v[228:231], v[32:35], v[208:211]
    v_or_b32 v156, v188, v189
    v_mfma_f32_16x16x32_bf16 v[212:215], v[228:231], v[36:39], v[212:215]
    v_lshlrev_b32_sdwa v204, 1, v204 dst_sel:DWORD dst_unused:UNUSED_PAD src0_sel:DWORD src1_sel:WORD_1
    v_mfma_f32_16x16x32_bf16 v[216:219], v[228:231], v[40:43], v[216:219]
    v_lshlrev_b32_sdwa v205, 1, v205 dst_sel:DWORD dst_unused:UNUSED_PAD src0_sel:DWORD src1_sel:WORD_1
    ds_read_u16_d16 v204, v204
    ds_read_u16_d16_hi v205, v205
    v_mfma_f32_16x16x32_bf16 v[220:223], v[228:231], v[44:47], v[220:223]
    ds_read_b64_tr_b16 v[228:229], v255 offset:31872
    ds_read_b64_tr_b16 v[230:231], v255 offset:32640
    v_or_b32 v157, v190, v191
    v_mfma_f32_16x16x32_bf16 v[80:83], v[232:235], v[160:163], v[80:83]
    v_lshlrev_b32_sdwa v206, 1, v206 dst_sel:DWORD dst_unused:UNUSED_PAD src0_sel:DWORD src1_sel:WORD_1
    v_mfma_f32_16x16x32_bf16 v[88:91], v[232:235], v[164:167], v[88:91]
    v_lshlrev_b32_sdwa v207, 1, v207 dst_sel:DWORD dst_unused:UNUSED_PAD src0_sel:DWORD src1_sel:WORD_1
    ds_read_u16_d16 v206, v206
    ds_read_u16_d16_hi v207, v207
    v_mfma_f32_16x16x32_bf16 v[96:99], v[232:235], v[168:171], v[96:99]
    v_mfma_f32_16x16x32_bf16 v[104:107], v[232:235], v[172:175], v[104:107]
    ds_read_b64_tr_b16 v[232:233], v254 offset:30728
    ds_read_b64_tr_b16 v[234:235], v254 offset:30984
    s_waitcnt lgkmcnt(14)
    v_mfma_f32_16x16x32_bf16 v[176:179], v[236:239], v[0:3], 0
    v_or_b32 v146, v192, v193
    v_lshlrev_b32_sdwa v208, 1, v208 dst_sel:DWORD dst_unused:UNUSED_PAD src0_sel:DWORD src1_sel:WORD_1
    v_mfma_f32_16x16x32_bf16 v[180:183], v[236:239], v[4:7], 0
    v_lshlrev_b32_sdwa v209, 1, v209 dst_sel:DWORD dst_unused:UNUSED_PAD src0_sel:DWORD src1_sel:WORD_1
    ds_read_u16_d16 v208, v208
    ds_read_u16_d16_hi v209, v209
    v_mfma_f32_16x16x32_bf16 v[184:187], v[236:239], v[8:11], 0
    v_or_b32 v147, v194, v195
    v_mfma_f32_16x16x32_bf16 v[188:191], v[236:239], v[12:15], 0
    ds_read_b64_tr_b16 v[236:237], v255 offset:31880
    ds_read_b64_tr_b16 v[238:239], v255 offset:32648
    v_lshlrev_b32_sdwa v210, 1, v210 dst_sel:DWORD dst_unused:UNUSED_PAD src0_sel:DWORD src1_sel:WORD_1
    v_mfma_f32_16x16x32_bf16 v[84:87], v[240:243], v[160:163], v[84:87]
    v_lshlrev_b32_sdwa v211, 1, v211 dst_sel:DWORD dst_unused:UNUSED_PAD src0_sel:DWORD src1_sel:WORD_1
    ds_read_u16_d16 v210, v210
    ds_read_u16_d16_hi v211, v211
    v_mfma_f32_16x16x32_bf16 v[92:95], v[240:243], v[164:167], v[92:95]
    v_or_b32 v150, v196, v197
    v_mfma_f32_16x16x32_bf16 v[100:103], v[240:243], v[168:171], v[100:103]
    v_lshlrev_b32_sdwa v212, 1, v212 dst_sel:DWORD dst_unused:UNUSED_PAD src0_sel:DWORD src1_sel:WORD_1
    v_mfma_f32_16x16x32_bf16 v[108:111], v[240:243], v[172:175], v[108:111]

    s_cmp_ge_u32 s19, 15
    s_cbranch_scc1 L_rd15_go
    v_mov_b32 v240, 161976

    s_mov_b32 s29, 200000
L_rd15:
    ds_read_b32 v241, v240
    s_waitcnt lgkmcnt(0)
    v_cmp_le_u32 vcc, 15, v241
    s_cmp_eq_u64 vcc, exec
    s_cbranch_scc1 L_rd15_ok
    s_sleep 2
    s_sub_u32 s29, s29, 1
    s_cmp_lg_u32 s29, 0
    s_cbranch_scc1 L_rd15
L_rd15_ok:

    v_readfirstlane_b32 s19, v241
L_rd15_go:

    ds_read_b64_tr_b16 v[240:241], v254 offset:34816
    ds_read_b64_tr_b16 v[242:243], v254 offset:35072
    v_lshlrev_b32_sdwa v213, 1, v213 dst_sel:DWORD dst_unused:UNUSED_PAD src0_sel:DWORD src1_sel:WORD_1
    ds_read_u16_d16 v212, v212
    ds_read_u16_d16_hi v213, v213
    s_waitcnt lgkmcnt(14)
    v_mfma_f32_16x16x32_bf16 v[176:179], v[224:227], v[16:19], v[176:179]
    v_or_b32 v151, v198, v199
    v_mfma_f32_16x16x32_bf16 v[180:183], v[224:227], v[20:23], v[180:183]
    v_lshlrev_b32_sdwa v214, 1, v214 dst_sel:DWORD dst_unused:UNUSED_PAD src0_sel:DWORD src1_sel:WORD_1
    v_mfma_f32_16x16x32_bf16 v[184:187], v[224:227], v[24:27], v[184:187]
    v_lshlrev_b32_sdwa v215, 1, v215 dst_sel:DWORD dst_unused:UNUSED_PAD src0_sel:DWORD src1_sel:WORD_1
    ds_read_u16_d16 v214, v214
    ds_read_u16_d16_hi v215, v215
    v_mfma_f32_16x16x32_bf16 v[188:191], v[224:227], v[28:31], v[188:191]

    s_cmp_ge_u32 s19, 16
    s_cbranch_scc1 L_rd16_go
    v_mov_b32 v224, 161976

    s_mov_b32 s29, 200000
L_rd16:
    ds_read_b32 v225, v224
    s_waitcnt lgkmcnt(0)
    v_cmp_le_u32 vcc, 16, v225
    s_cmp_eq_u64 vcc, exec
    s_cbranch_scc1 L_rd16_ok
    s_sleep 2
    s_sub_u32 s29, s29, 1
    s_cmp_lg_u32 s29, 0
    s_cbranch_scc1 L_rd16
L_rd16_ok:

    v_readfirstlane_b32 s19, v225
L_rd16_go:

    ds_read_b64_tr_b16 v[224:225], v255 offset:37888
    ds_read_b64_tr_b16 v[226:227], v255 offset:38656
    v_or_b32 v154, v200, v201
    v_lshlrev_b32_sdwa v216, 1, v216 dst_sel:DWORD dst_unused:UNUSED_PAD src0_sel:DWORD src1_sel:WORD_1
    v_mfma_f32_16x16x32_bf16 v[112:115], v[228:231], v[160:163], v[112:115]
    v_lshlrev_b32_sdwa v217, 1, v217 dst_sel:DWORD dst_unused:UNUSED_PAD src0_sel:DWORD src1_sel:WORD_1
    ds_read_u16_d16 v216, v216
    ds_read_u16_d16_hi v217, v217
    v_mfma_f32_16x16x32_bf16 v[120:123], v[228:231], v[164:167], v[120:123]
    v_or_b32 v155, v202, v203
    v_mfma_f32_16x16x32_bf16 v[128:131], v[228:231], v[168:171], v[128:131]
    v_lshlrev_b32_sdwa v218, 1, v218 dst_sel:DWORD dst_unused:UNUSED_PAD src0_sel:DWORD src1_sel:WORD_1
    v_mfma_f32_16x16x32_bf16 v[136:139], v[228:231], v[172:175], v[136:139]
    ds_read_b64_tr_b16 v[228:229], v254 offset:35840
    ds_read_b64_tr_b16 v[230:231], v254 offset:36096
    v_lshlrev_b32_sdwa v219, 1, v219 dst_sel:DWORD dst_unused:UNUSED_PAD src0_sel:DWORD src1_sel:WORD_1
    ds_read_u16_d16 v218, v218
    ds_read_u16_d16_hi v219, v219
    s_waitcnt lgkmcnt(14)
    v_mfma_f32_16x16x32_bf16 v[176:179], v[232:235], v[32:35], v[176:179]
    v_or_b32 v158, v204, v205
    v_mfma_f32_16x16x32_bf16 v[180:183], v[232:235], v[36:39], v[180:183]
    v_lshlrev_b32_sdwa v220, 1, v220 dst_sel:DWORD dst_unused:UNUSED_PAD src0_sel:DWORD src1_sel:WORD_1
    v_mfma_f32_16x16x32_bf16 v[184:187], v[232:235], v[40:43], v[184:187]
    v_lshlrev_b32_sdwa v221, 1, v221 dst_sel:DWORD dst_unused:UNUSED_PAD src0_sel:DWORD src1_sel:WORD_1
    ds_read_u16_d16 v220, v220
    ds_read_u16_d16_hi v221, v221
    v_mfma_f32_16x16x32_bf16 v[188:191], v[232:235], v[44:47], v[188:191]
    ds_read_b64_tr_b16 v[232:233], v255 offset:37896
    ds_read_b64_tr_b16 v[234:235], v255 offset:38664
    v_or_b32 v159, v206, v207
    v_mfma_f32_16x16x32_bf16 v[116:119], v[236:239], v[160:163], v[116:119]
    v_lshlrev_b32_sdwa v222, 1, v222 dst_sel:DWORD dst_unused:UNUSED_PAD src0_sel:DWORD src1_sel:WORD_1
    v_mfma_f32_16x16x32_bf16 v[124:127], v[236:239], v[164:167], v[124:127]
    v_lshlrev_b32_sdwa v223, 1, v223 dst_sel:DWORD dst_unused:UNUSED_PAD src0_sel:DWORD src1_sel:WORD_1
    ds_read_u16_d16 v222, v222
    ds_read_u16_d16_hi v223, v223
    v_mfma_f32_16x16x32_bf16 v[132:135], v[236:239], v[168:171], v[132:135]
    v_mfma_f32_16x16x32_bf16 v[140:143], v[236:239], v[172:175], v[140:143]
    ds_read_b64_tr_b16 v[236:237], v254 offset:36864
    ds_read_b64_tr_b16 v[238:239], v254 offset:37120
    s_waitcnt lgkmcnt(14)
    v_mfma_f32_16x16x32_bf16 v[192:195], v[240:243], v[0:3], 0
    v_or_b32 v160, v208, v209
    v_lshlrev_b32_sdwa v176, 1, v176 dst_sel:DWORD dst_unused:UNUSED_PAD src0_sel:DWORD src1_sel:WORD_1
    v_mfma_f32_16x16x32_bf16 v[196:199], v[240:243], v[4:7], 0
    v_lshlrev_b32_sdwa v177, 1, v177 dst_sel:DWORD dst_unused:UNUSED_PAD src0_sel:DWORD src1_sel:WORD_1
    ds_read_u16_d16 v176, v176
    ds_read_u16_d16_hi v177, v177
    v_mfma_f32_16x16x32_bf16 v[200:203], v[240:243], v[8:11], 0
    v_or_b32 v161, v210, v211
    v_mfma_f32_16x16x32_bf16 v[204:207], v[240:243], v[12:15], 0
    ds_read_b64_tr_b16 v[240:241], v255 offset:37952
    ds_read_b64_tr_b16 v[242:243], v255 offset:38720
    v_lshlrev_b32_sdwa v178, 1, v178 dst_sel:DWORD dst_unused:UNUSED_PAD src0_sel:DWORD src1_sel:WORD_1
    v_mfma_f32_16x16x32_bf16 v[48:51], v[224:227], v[144:147], v[48:51]
    v_lshlrev_b32_sdwa v179, 1, v179 dst_sel:DWORD dst_unused:UNUSED_PAD src0_sel:DWORD src1_sel:WORD_1
    ds_read_u16_d16 v178, v178
    ds_read_u16_d16_hi v179, v179
    v_mfma_f32_16x16x32_bf16 v[56:59], v[224:227], v[148:151], v[56:59]
    v_or_b32 v164, v212, v213
    v_mfma_f32_16x16x32_bf16 v[64:67], v[224:227], v[152:155], v[64:67]
    v_lshlrev_b32_sdwa v180, 1, v180 dst_sel:DWORD dst_unused:UNUSED_PAD src0_sel:DWORD src1_sel:WORD_1
    v_mfma_f32_16x16x32_bf16 v[72:75], v[224:227], v[156:159], v[72:75]
    ds_read_b64_tr_b16 v[224:225], v254 offset:34824
    ds_read_b64_tr_b16 v[226:227], v254 offset:35080
    v_lshlrev_b32_sdwa v181, 1, v181 dst_sel:DWORD dst_unused:UNUSED_PAD src0_sel:DWORD src1_sel:WORD_1
    ds_read_u16_d16 v180, v180
    ds_read_u16_d16_hi v181, v181
    s_waitcnt lgkmcnt(14)
    v_mfma_f32_16x16x32_bf16 v[192:195], v[228:231], v[16:19], v[192:195]
    v_or_b32 v165, v214, v215
    v_mfma_f32_16x16x32_bf16 v[196:199], v[228:231], v[20:23], v[196:199]
    v_lshlrev_b32_sdwa v182, 1, v182 dst_sel:DWORD dst_unused:UNUSED_PAD src0_sel:DWORD src1_sel:WORD_1
    v_mfma_f32_16x16x32_bf16 v[200:203], v[228:231], v[24:27], v[200:203]
    v_lshlrev_b32_sdwa v183, 1, v183 dst_sel:DWORD dst_unused:UNUSED_PAD src0_sel:DWORD src1_sel:WORD_1
    ds_read_u16_d16 v182, v182
    ds_read_u16_d16_hi v183, v183
    v_mfma_f32_16x16x32_bf16 v[204:207], v[228:231], v[28:31], v[204:207]
    ds_read_b64_tr_b16 v[228:229], v255 offset:37960
    ds_read_b64_tr_b16 v[230:231], v255 offset:38728
    v_or_b32 v168, v216, v217
    v_lshlrev_b32_sdwa v184, 1, v184 dst_sel:DWORD dst_unused:UNUSED_PAD src0_sel:DWORD src1_sel:WORD_1
    v_mfma_f32_16x16x32_bf16 v[52:55], v[232:235], v[144:147], v[52:55]
    v_lshlrev_b32_sdwa v185, 1, v185 dst_sel:DWORD dst_unused:UNUSED_PAD src0_sel:DWORD src1_sel:WORD_1
    ds_read_u16_d16 v184, v184
    ds_read_u16_d16_hi v185, v185
    v_mfma_f32_16x16x32_bf16 v[60:63], v[232:235], v[148:151], v[60:63]
    v_or_b32 v169, v218, v219
    v_mfma_f32_16x16x32_bf16 v[68:71], v[232:235], v[152:155], v[68:71]
    v_lshlrev_b32_sdwa v186, 1, v186 dst_sel:DWORD dst_unused:UNUSED_PAD src0_sel:DWORD src1_sel:WORD_1
    v_mfma_f32_16x16x32_bf16 v[76:79], v[232:235], v[156:159], v[76:79]
    ds_read_b64_tr_b16 v[232:233], v254 offset:35848
    ds_read_b64_tr_b16 v[234:235], v254 offset:36104
    v_lshlrev_b32_sdwa v187, 1, v187 dst_sel:DWORD dst_unused:UNUSED_PAD src0_sel:DWORD src1_sel:WORD_1
    ds_read_u16_d16 v186, v186
    ds_read_u16_d16_hi v187, v187
    s_waitcnt lgkmcnt(14)
    v_mfma_f32_16x16x32_bf16 v[192:195], v[236:239], v[32:35], v[192:195]
    v_or_b32 v172, v220, v221
    v_mfma_f32_16x16x32_bf16 v[196:199], v[236:239], v[36:39], v[196:199]
    v_lshlrev_b32_sdwa v188, 1, v188 dst_sel:DWORD dst_unused:UNUSED_PAD src0_sel:DWORD src1_sel:WORD_1
    v_mfma_f32_16x16x32_bf16 v[200:203], v[236:239], v[40:43], v[200:203]
    v_lshlrev_b32_sdwa v189, 1, v189 dst_sel:DWORD dst_unused:UNUSED_PAD src0_sel:DWORD src1_sel:WORD_1
    ds_read_u16_d16 v188, v188
    ds_read_u16_d16_hi v189, v189
    v_mfma_f32_16x16x32_bf16 v[204:207], v[236:239], v[44:47], v[204:207]
    ds_read_b64_tr_b16 v[236:237], v255 offset:38016
    ds_read_b64_tr_b16 v[238:239], v255 offset:38784
    v_or_b32 v173, v222, v223
    v_mfma_f32_16x16x32_bf16 v[80:83], v[240:243], v[144:147], v[80:83]
    v_lshlrev_b32_sdwa v190, 1, v190 dst_sel:DWORD dst_unused:UNUSED_PAD src0_sel:DWORD src1_sel:WORD_1
    v_mfma_f32_16x16x32_bf16 v[88:91], v[240:243], v[148:151], v[88:91]
    v_lshlrev_b32_sdwa v191, 1, v191 dst_sel:DWORD dst_unused:UNUSED_PAD src0_sel:DWORD src1_sel:WORD_1
    ds_read_u16_d16 v190, v190
    ds_read_u16_d16_hi v191, v191
    v_mfma_f32_16x16x32_bf16 v[96:99], v[240:243], v[152:155], v[96:99]
    v_mfma_f32_16x16x32_bf16 v[104:107], v[240:243], v[156:159], v[104:107]
    ds_read_b64_tr_b16 v[240:241], v254 offset:36872
    ds_read_b64_tr_b16 v[242:243], v254 offset:37128
    s_waitcnt lgkmcnt(14)
    v_mfma_f32_16x16x32_bf16 v[208:211], v[224:227], v[0:3], 0
    v_or_b32 v162, v176, v177
    v_lshlrev_b32_sdwa v192, 1, v192 dst_sel:DWORD dst_unused:UNUSED_PAD src0_sel:DWORD src1_sel:WORD_1
    v_mfma_f32_16x16x32_bf16 v[212:215], v[224:227], v[4:7], 0
    v_lshlrev_b32_sdwa v193, 1, v193 dst_sel:DWORD dst_unused:UNUSED_PAD src0_sel:DWORD src1_sel:WORD_1
    ds_read_u16_d16 v192, v192
    ds_read_u16_d16_hi v193, v193
    v_mfma_f32_16x16x32_bf16 v[216:219], v[224:227], v[8:11], 0
    v_or_b32 v163, v178, v179
    v_mfma_f32_16x16x32_bf16 v[220:223], v[224:227], v[12:15], 0
    ds_read_b64_tr_b16 v[224:225], v255 offset:38024
    ds_read_b64_tr_b16 v[226:227], v255 offset:38792
    v_lshlrev_b32_sdwa v194, 1, v194 dst_sel:DWORD dst_unused:UNUSED_PAD src0_sel:DWORD src1_sel:WORD_1
    v_mfma_f32_16x16x32_bf16 v[84:87], v[228:231], v[144:147], v[84:87]
    v_lshlrev_b32_sdwa v195, 1, v195 dst_sel:DWORD dst_unused:UNUSED_PAD src0_sel:DWORD src1_sel:WORD_1
    ds_read_u16_d16 v194, v194
    ds_read_u16_d16_hi v195, v195
    v_mfma_f32_16x16x32_bf16 v[92:95], v[228:231], v[148:151], v[92:95]
    v_or_b32 v166, v180, v181
    s_waitcnt vmcnt(0)
    v_dot2_f32_bf16 v64, v244, s86, v64
    v_dot2_f32_bf16 v65, v244, s87, v65
    v_mfma_f32_16x16x32_bf16 v[100:103], v[228:231], v[152:155], v[100:103]
    v_lshlrev_b32_sdwa v196, 1, v196 dst_sel:DWORD dst_unused:UNUSED_PAD src0_sel:DWORD src1_sel:WORD_1
    v_dot2_f32_bf16 v66, v245, s86, v66
    v_dot2_f32_bf16 v67, v245, s87, v67
    v_mfma_f32_16x16x32_bf16 v[108:111], v[228:231], v[156:159], v[108:111]

    s_cmp_ge_u32 s19, 17
    s_cbranch_scc1 L_rd17_go
    v_mov_b32 v228, 161976

    s_mov_b32 s29, 200000
L_rd17:
    ds_read_b32 v229, v228
    s_waitcnt lgkmcnt(0)
    v_cmp_le_u32 vcc, 17, v229
    s_cmp_eq_u64 vcc, exec
    s_cbranch_scc1 L_rd17_ok
    s_sleep 2
    s_sub_u32 s29, s29, 1
    s_cmp_lg_u32 s29, 0
    s_cbranch_scc1 L_rd17
L_rd17_ok:

    v_readfirstlane_b32 s19, v229
L_rd17_go:

    ds_read_b64_tr_b16 v[228:229], v254 offset:40960
    ds_read_b64_tr_b16 v[230:231], v254 offset:41216
    v_lshlrev_b32_sdwa v197, 1, v197 dst_sel:DWORD dst_unused:UNUSED_PAD src0_sel:DWORD src1_sel:WORD_1
    ds_read_u16_d16 v196, v196
    ds_read_u16_d16_hi v197, v197
    v_dot2_f32_bf16 v68, v246, s86, v68
    v_dot2_f32_bf16 v69, v246, s87, v69
    s_waitcnt lgkmcnt(14)
    v_mfma_f32_16x16x32_bf16 v[208:211], v[232:235], v[16:19], v[208:211]
    v_or_b32 v167, v182, v183
    v_dot2_f32_bf16 v70, v247, s86, v70
    v_dot2_f32_bf16 v71, v247, s87, v71
    v_mfma_f32_16x16x32_bf16 v[212:215], v[232:235], v[20:23], v[212:215]
    v_lshlrev_b32_sdwa v198, 1, v198 dst_sel:DWORD dst_unused:UNUSED_PAD src0_sel:DWORD src1_sel:WORD_1
    v_dot2_f32_bf16 v96, v248, s86, v96
    v_dot2_f32_bf16 v97, v248, s87, v97
    v_mfma_f32_16x16x32_bf16 v[216:219], v[232:235], v[24:27], v[216:219]
    v_lshlrev_b32_sdwa v199, 1, v199 dst_sel:DWORD dst_unused:UNUSED_PAD src0_sel:DWORD src1_sel:WORD_1
    ds_read_u16_d16 v198, v198
    ds_read_u16_d16_hi v199, v199
    v_dot2_f32_bf16 v98, v249, s86, v98
    v_dot2_f32_bf16 v99, v249, s87, v99
    v_mfma_f32_16x16x32_bf16 v[220:223], v[232:235], v[28:31], v[220:223]

    s_cmp_ge_u32 s19, 18
    s_cbranch_scc1 L_rd18_go
    v_mov_b32 v232, 161976

    s_mov_b32 s29, 200000
L_rd18:
    ds_read_b32 v233, v232
    s_waitcnt lgkmcnt(0)
    v_cmp_le_u32 vcc, 18, v233
    s_cmp_eq_u64 vcc, exec
    s_cbranch_scc1 L_rd18_ok
    s_sleep 2
    s_sub_u32 s29, s29, 1
    s_cmp_lg_u32 s29, 0
    s_cbranch_scc1 L_rd18
L_rd18_ok:

    v_readfirstlane_b32 s19, v233
L_rd18_go:

    ds_read_b64_tr_b16 v[232:233], v255 offset:44032
    ds_read_b64_tr_b16 v[234:235], v255 offset:44800
    v_or_b32 v170, v184, v185
    v_lshlrev_b32_sdwa v200, 1, v200 dst_sel:DWORD dst_unused:UNUSED_PAD src0_sel:DWORD src1_sel:WORD_1
    v_dot2_f32_bf16 v100, v250, s86, v100
    v_dot2_f32_bf16 v101, v250, s87, v101
    v_mfma_f32_16x16x32_bf16 v[112:115], v[236:239], v[144:147], v[112:115]
    v_lshlrev_b32_sdwa v201, 1, v201 dst_sel:DWORD dst_unused:UNUSED_PAD src0_sel:DWORD src1_sel:WORD_1
    ds_read_u16_d16 v200, v200
    ds_read_u16_d16_hi v201, v201
    v_dot2_f32_bf16 v102, v251, s86, v102
    v_dot2_f32_bf16 v103, v251, s87, v103
    buffer_load_dwordx4 v[244:247], v252, s[4:7], s25 offen offset:128 sc1
    buffer_load_dwordx4 v[248:251], v252, s[4:7], s25 offen offset:192 sc1
    v_mfma_f32_16x16x32_bf16 v[120:123], v[236:239], v[148:151], v[120:123]
    v_or_b32 v171, v186, v187
    v_mfma_f32_16x16x32_bf16 v[128:131], v[236:239], v[152:155], v[128:131]
    v_lshlrev_b32_sdwa v202, 1, v202 dst_sel:DWORD dst_unused:UNUSED_PAD src0_sel:DWORD src1_sel:WORD_1
    v_mfma_f32_16x16x32_bf16 v[136:139], v[236:239], v[156:159], v[136:139]
    ds_read_b64_tr_b16 v[236:237], v254 offset:41984
    ds_read_b64_tr_b16 v[238:239], v254 offset:42240
    v_lshlrev_b32_sdwa v203, 1, v203 dst_sel:DWORD dst_unused:UNUSED_PAD src0_sel:DWORD src1_sel:WORD_1
    ds_read_u16_d16 v202, v202
    ds_read_u16_d16_hi v203, v203
    s_waitcnt lgkmcnt(14)
    v_mfma_f32_16x16x32_bf16 v[208:211], v[240:243], v[32:35], v[208:211]
    v_or_b32 v174, v188, v189
    v_mfma_f32_16x16x32_bf16 v[212:215], v[240:243], v[36:39], v[212:215]
    v_lshlrev_b32_sdwa v204, 1, v204 dst_sel:DWORD dst_unused:UNUSED_PAD src0_sel:DWORD src1_sel:WORD_1
    v_mfma_f32_16x16x32_bf16 v[216:219], v[240:243], v[40:43], v[216:219]
    v_lshlrev_b32_sdwa v205, 1, v205 dst_sel:DWORD dst_unused:UNUSED_PAD src0_sel:DWORD src1_sel:WORD_1
    ds_read_u16_d16 v204, v204
    ds_read_u16_d16_hi v205, v205
    v_mfma_f32_16x16x32_bf16 v[220:223], v[240:243], v[44:47], v[220:223]
    ds_read_b64_tr_b16 v[240:241], v255 offset:44040
    ds_read_b64_tr_b16 v[242:243], v255 offset:44808
    v_or_b32 v175, v190, v191
    v_mfma_f32_16x16x32_bf16 v[116:119], v[224:227], v[144:147], v[116:119]
    v_lshlrev_b32_sdwa v206, 1, v206 dst_sel:DWORD dst_unused:UNUSED_PAD src0_sel:DWORD src1_sel:WORD_1
    v_mfma_f32_16x16x32_bf16 v[124:127], v[224:227], v[148:151], v[124:127]
    v_lshlrev_b32_sdwa v207, 1, v207 dst_sel:DWORD dst_unused:UNUSED_PAD src0_sel:DWORD src1_sel:WORD_1
    ds_read_u16_d16 v206, v206
    ds_read_u16_d16_hi v207, v207
    v_mfma_f32_16x16x32_bf16 v[132:135], v[224:227], v[152:155], v[132:135]
    v_mfma_f32_16x16x32_bf16 v[140:143], v[224:227], v[156:159], v[140:143]
    ds_read_b64_tr_b16 v[224:225], v254 offset:43008
    ds_read_b64_tr_b16 v[226:227], v254 offset:43264
    s_waitcnt lgkmcnt(14)
    v_mfma_f32_16x16x32_bf16 v[176:179], v[228:231], v[0:3], 0
    v_or_b32 v144, v192, v193
    v_lshlrev_b32_sdwa v208, 1, v208 dst_sel:DWORD dst_unused:UNUSED_PAD src0_sel:DWORD src1_sel:WORD_1
    v_mfma_f32_16x16x32_bf16 v[180:183], v[228:231], v[4:7], 0
    v_lshlrev_b32_sdwa v209, 1, v209 dst_sel:DWORD dst_unused:UNUSED_PAD src0_sel:DWORD src1_sel:WORD_1
    ds_read_u16_d16 v208, v208
    ds_read_u16_d16_hi v209, v209
    v_mfma_f32_16x16x32_bf16 v[184:187], v[228:231], v[8:11], 0
    v_or_b32 v145, v194, v195
    v_mfma_f32_16x16x32_bf16 v[188:191], v[228:231], v[12:15], 0
    ds_read_b64_tr_b16 v[228:229], v255 offset:44096
    ds_read_b64_tr_b16 v[230:231], v255 offset:44864
    v_lshlrev_b32_sdwa v210, 1, v210 dst_sel:DWORD dst_unused:UNUSED_PAD src0_sel:DWORD src1_sel:WORD_1
    v_mfma_f32_16x16x32_bf16 v[48:51], v[232:235], v[160:163], v[48:51]
    v_lshlrev_b32_sdwa v211, 1, v211 dst_sel:DWORD dst_unused:UNUSED_PAD src0_sel:DWORD src1_sel:WORD_1
    ds_read_u16_d16 v210, v210
    ds_read_u16_d16_hi v211, v211
    v_mfma_f32_16x16x32_bf16 v[56:59], v[232:235], v[164:167], v[56:59]
    v_or_b32 v148, v196, v197
    v_mfma_f32_16x16x32_bf16 v[64:67], v[232:235], v[168:171], v[64:67]
    v_lshlrev_b32_sdwa v212, 1, v212 dst_sel:DWORD dst_unused:UNUSED_PAD src0_sel:DWORD src1_sel:WORD_1
    v_mfma_f32_16x16x32_bf16 v[72:75], v[232:235], v[172:175], v[72:75]
    ds_read_b64_tr_b16 v[232:233], v254 offset:40968
    ds_read_b64_tr_b16 v[234:235], v254 offset:41224
    v_lshlrev_b32_sdwa v213, 1, v213 dst_sel:DWORD dst_unused:UNUSED_PAD src0_sel:DWORD src1_sel:WORD_1
    ds_read_u16_d16 v212, v212
    ds_read_u16_d16_hi v213, v213
    s_waitcnt lgkmcnt(14)
    v_mfma_f32_16x16x32_bf16 v[176:179], v[236:239], v[16:19], v[176:179]
    v_or_b32 v149, v198, v199
    v_mfma_f32_16x16x32_bf16 v[180:183], v[236:239], v[20:23], v[180:183]
    v_lshlrev_b32_sdwa v214, 1, v214 dst_sel:DWORD dst_unused:UNUSED_PAD src0_sel:DWORD src1_sel:WORD_1
    v_mfma_f32_16x16x32_bf16 v[184:187], v[236:239], v[24:27], v[184:187]
    v_lshlrev_b32_sdwa v215, 1, v215 dst_sel:DWORD dst_unused:UNUSED_PAD src0_sel:DWORD src1_sel:WORD_1
    ds_read_u16_d16 v214, v214
    ds_read_u16_d16_hi v215, v215
    v_mfma_f32_16x16x32_bf16 v[188:191], v[236:239], v[28:31], v[188:191]
    ds_read_b64_tr_b16 v[236:237], v255 offset:44104
    ds_read_b64_tr_b16 v[238:239], v255 offset:44872
    v_or_b32 v152, v200, v201
    v_lshlrev_b32_sdwa v216, 1, v216 dst_sel:DWORD dst_unused:UNUSED_PAD src0_sel:DWORD src1_sel:WORD_1
    v_mfma_f32_16x16x32_bf16 v[52:55], v[240:243], v[160:163], v[52:55]
    v_lshlrev_b32_sdwa v217, 1, v217 dst_sel:DWORD dst_unused:UNUSED_PAD src0_sel:DWORD src1_sel:WORD_1
    ds_read_u16_d16 v216, v216
    ds_read_u16_d16_hi v217, v217
    v_mfma_f32_16x16x32_bf16 v[60:63], v[240:243], v[164:167], v[60:63]
    v_or_b32 v153, v202, v203
    v_mfma_f32_16x16x32_bf16 v[68:71], v[240:243], v[168:171], v[68:71]
    v_lshlrev_b32_sdwa v218, 1, v218 dst_sel:DWORD dst_unused:UNUSED_PAD src0_sel:DWORD src1_sel:WORD_1
    v_mfma_f32_16x16x32_bf16 v[76:79], v[240:243], v[172:175], v[76:79]
    ds_read_b64_tr_b16 v[240:241], v254 offset:41992
    ds_read_b64_tr_b16 v[242:243], v254 offset:42248
    v_lshlrev_b32_sdwa v219, 1, v219 dst_sel:DWORD dst_unused:UNUSED_PAD src0_sel:DWORD src1_sel:WORD_1
    ds_read_u16_d16 v218, v218
    ds_read_u16_d16_hi v219, v219
    s_waitcnt lgkmcnt(14)
    v_mfma_f32_16x16x32_bf16 v[176:179], v[224:227], v[32:35], v[176:179]
    v_or_b32 v156, v204, v205
    v_mfma_f32_16x16x32_bf16 v[180:183], v[224:227], v[36:39], v[180:183]
    v_lshlrev_b32_sdwa v220, 1, v220 dst_sel:DWORD dst_unused:UNUSED_PAD src0_sel:DWORD src1_sel:WORD_1
    v_mfma_f32_16x16x32_bf16 v[184:187], v[224:227], v[40:43], v[184:187]
    v_lshlrev_b32_sdwa v221, 1, v221 dst_sel:DWORD dst_unused:UNUSED_PAD src0_sel:DWORD src1_sel:WORD_1
    ds_read_u16_d16 v220, v220
    ds_read_u16_d16_hi v221, v221
    v_mfma_f32_16x16x32_bf16 v[188:191], v[224:227], v[44:47], v[188:191]
    ds_read_b64_tr_b16 v[224:225], v255 offset:44160
    ds_read_b64_tr_b16 v[226:227], v255 offset:44928
    v_or_b32 v157, v206, v207
    v_mfma_f32_16x16x32_bf16 v[80:83], v[228:231], v[160:163], v[80:83]
    v_lshlrev_b32_sdwa v222, 1, v222 dst_sel:DWORD dst_unused:UNUSED_PAD src0_sel:DWORD src1_sel:WORD_1
    v_mfma_f32_16x16x32_bf16 v[88:91], v[228:231], v[164:167], v[88:91]
    v_lshlrev_b32_sdwa v223, 1, v223 dst_sel:DWORD dst_unused:UNUSED_PAD src0_sel:DWORD src1_sel:WORD_1
    ds_read_u16_d16 v222, v222
    ds_read_u16_d16_hi v223, v223
    v_mfma_f32_16x16x32_bf16 v[96:99], v[228:231], v[168:171], v[96:99]
    v_mfma_f32_16x16x32_bf16 v[104:107], v[228:231], v[172:175], v[104:107]
    ds_read_b64_tr_b16 v[228:229], v254 offset:43016
    ds_read_b64_tr_b16 v[230:231], v254 offset:43272
    s_waitcnt lgkmcnt(14)
    v_mfma_f32_16x16x32_bf16 v[192:195], v[232:235], v[0:3], 0
    v_or_b32 v146, v208, v209
    v_lshlrev_b32_sdwa v176, 1, v176 dst_sel:DWORD dst_unused:UNUSED_PAD src0_sel:DWORD src1_sel:WORD_1
    v_mfma_f32_16x16x32_bf16 v[196:199], v[232:235], v[4:7], 0
    v_lshlrev_b32_sdwa v177, 1, v177 dst_sel:DWORD dst_unused:UNUSED_PAD src0_sel:DWORD src1_sel:WORD_1
    ds_read_u16_d16 v176, v176
    ds_read_u16_d16_hi v177, v177
    v_mfma_f32_16x16x32_bf16 v[200:203], v[232:235], v[8:11], 0
    v_or_b32 v147, v210, v211
    v_mfma_f32_16x16x32_bf16 v[204:207], v[232:235], v[12:15], 0
    ds_read_b64_tr_b16 v[232:233], v255 offset:44168
    ds_read_b64_tr_b16 v[234:235], v255 offset:44936
    v_lshlrev_b32_sdwa v178, 1, v178 dst_sel:DWORD dst_unused:UNUSED_PAD src0_sel:DWORD src1_sel:WORD_1
    v_mfma_f32_16x16x32_bf16 v[84:87], v[236:239], v[160:163], v[84:87]
    v_lshlrev_b32_sdwa v179, 1, v179 dst_sel:DWORD dst_unused:UNUSED_PAD src0_sel:DWORD src1_sel:WORD_1
    ds_read_u16_d16 v178, v178
    ds_read_u16_d16_hi v179, v179
    v_mfma_f32_16x16x32_bf16 v[92:95], v[236:239], v[164:167], v[92:95]
    v_or_b32 v150, v212, v213
    v_mfma_f32_16x16x32_bf16 v[100:103], v[236:239], v[168:171], v[100:103]
    v_lshlrev_b32_sdwa v180, 1, v180 dst_sel:DWORD dst_unused:UNUSED_PAD src0_sel:DWORD src1_sel:WORD_1
    v_mfma_f32_16x16x32_bf16 v[108:111], v[236:239], v[172:175], v[108:111]

    s_cmp_ge_u32 s19, 19
    s_cbranch_scc1 L_rd19_go
    v_mov_b32 v236, 161976

    s_mov_b32 s29, 200000
L_rd19:
    ds_read_b32 v237, v236
    s_waitcnt lgkmcnt(0)
    v_cmp_le_u32 vcc, 19, v237
    s_cmp_eq_u64 vcc, exec
    s_cbranch_scc1 L_rd19_ok
    s_sleep 2
    s_sub_u32 s29, s29, 1
    s_cmp_lg_u32 s29, 0
    s_cbranch_scc1 L_rd19
L_rd19_ok:

    v_readfirstlane_b32 s19, v237
L_rd19_go:

    ds_read_b64_tr_b16 v[236:237], v254 offset:47104
    ds_read_b64_tr_b16 v[238:239], v254 offset:47360
    v_lshlrev_b32_sdwa v181, 1, v181 dst_sel:DWORD dst_unused:UNUSED_PAD src0_sel:DWORD src1_sel:WORD_1
    ds_read_u16_d16 v180, v180
    ds_read_u16_d16_hi v181, v181
    s_waitcnt lgkmcnt(14)
    v_mfma_f32_16x16x32_bf16 v[192:195], v[240:243], v[16:19], v[192:195]
    v_or_b32 v151, v214, v215
    v_mfma_f32_16x16x32_bf16 v[196:199], v[240:243], v[20:23], v[196:199]
    v_lshlrev_b32_sdwa v182, 1, v182 dst_sel:DWORD dst_unused:UNUSED_PAD src0_sel:DWORD src1_sel:WORD_1
    v_mfma_f32_16x16x32_bf16 v[200:203], v[240:243], v[24:27], v[200:203]
    v_lshlrev_b32_sdwa v183, 1, v183 dst_sel:DWORD dst_unused:UNUSED_PAD src0_sel:DWORD src1_sel:WORD_1
    ds_read_u16_d16 v182, v182
    ds_read_u16_d16_hi v183, v183
    v_mfma_f32_16x16x32_bf16 v[204:207], v[240:243], v[28:31], v[204:207]

    s_cmp_ge_u32 s19, 20
    s_cbranch_scc1 L_rd20_go
    v_mov_b32 v240, 161976

    s_mov_b32 s29, 200000
L_rd20:
    ds_read_b32 v241, v240
    s_waitcnt lgkmcnt(0)
    v_cmp_le_u32 vcc, 20, v241
    s_cmp_eq_u64 vcc, exec
    s_cbranch_scc1 L_rd20_ok
    s_sleep 2
    s_sub_u32 s29, s29, 1
    s_cmp_lg_u32 s29, 0
    s_cbranch_scc1 L_rd20
L_rd20_ok:

    v_readfirstlane_b32 s19, v241
L_rd20_go:

    ds_read_b64_tr_b16 v[240:241], v255 offset:50176
    ds_read_b64_tr_b16 v[242:243], v255 offset:50944
    v_or_b32 v154, v216, v217
    v_lshlrev_b32_sdwa v184, 1, v184 dst_sel:DWORD dst_unused:UNUSED_PAD src0_sel:DWORD src1_sel:WORD_1
    v_mfma_f32_16x16x32_bf16 v[112:115], v[224:227], v[160:163], v[112:115]
    v_lshlrev_b32_sdwa v185, 1, v185 dst_sel:DWORD dst_unused:UNUSED_PAD src0_sel:DWORD src1_sel:WORD_1
    ds_read_u16_d16 v184, v184
    ds_read_u16_d16_hi v185, v185
    v_mfma_f32_16x16x32_bf16 v[120:123], v[224:227], v[164:167], v[120:123]
    v_or_b32 v155, v218, v219
    v_mfma_f32_16x16x32_bf16 v[128:131], v[224:227], v[168:171], v[128:131]
    v_lshlrev_b32_sdwa v186, 1, v186 dst_sel:DWORD dst_unused:UNUSED_PAD src0_sel:DWORD src1_sel:WORD_1
    v_mfma_f32_16x16x32_bf16 v[136:139], v[224:227], v[172:175], v[136:139]
    ds_read_b64_tr_b16 v[224:225], v254 offset:48128
    ds_read_b64_tr_b16 v[226:227], v254 offset:48384
    v_lshlrev_b32_sdwa v187, 1, v187 dst_sel:DWORD dst_unused:UNUSED_PAD src0_sel:DWORD src1_sel:WORD_1
    ds_read_u16_d16 v186, v186
    ds_read_u16_d16_hi v187, v187
    s_waitcnt lgkmcnt(14)
    v_mfma_f32_16x16x32_bf16 v[192:195], v[228:231], v[32:35], v[192:195]
    v_or_b32 v158, v220, v221
    v_mfma_f32_16x16x32_bf16 v[196:199], v[228:231], v[36:39], v[196:199]
    v_lshlrev_b32_sdwa v188, 1, v188 dst_sel:DWORD dst_unused:UNUSED_PAD src0_sel:DWORD src1_sel:WORD_1
    v_mfma_f32_16x16x32_bf16 v[200:203], v[228:231], v[40:43], v[200:203]
    v_lshlrev_b32_sdwa v189, 1, v189 dst_sel:DWORD dst_unused:UNUSED_PAD src0_sel:DWORD src1_sel:WORD_1
    ds_read_u16_d16 v188, v188
    ds_read_u16_d16_hi v189, v189
    v_mfma_f32_16x16x32_bf16 v[204:207], v[228:231], v[44:47], v[204:207]
    ds_read_b64_tr_b16 v[228:229], v255 offset:50184
    ds_read_b64_tr_b16 v[230:231], v255 offset:50952
    v_or_b32 v159, v222, v223
    v_mfma_f32_16x16x32_bf16 v[116:119], v[232:235], v[160:163], v[116:119]
    v_lshlrev_b32_sdwa v190, 1, v190 dst_sel:DWORD dst_unused:UNUSED_PAD src0_sel:DWORD src1_sel:WORD_1
    v_mfma_f32_16x16x32_bf16 v[124:127], v[232:235], v[164:167], v[124:127]
    v_lshlrev_b32_sdwa v191, 1, v191 dst_sel:DWORD dst_unused:UNUSED_PAD src0_sel:DWORD src1_sel:WORD_1
    ds_read_u16_d16 v190, v190
    ds_read_u16_d16_hi v191, v191
    v_mfma_f32_16x16x32_bf16 v[132:135], v[232:235], v[168:171], v[132:135]
    v_mfma_f32_16x16x32_bf16 v[140:143], v[232:235], v[172:175], v[140:143]
    ds_read_b64_tr_b16 v[232:233], v254 offset:49152
    ds_read_b64_tr_b16 v[234:235], v254 offset:49408
    s_waitcnt lgkmcnt(14)
    v_mfma_f32_16x16x32_bf16 v[208:211], v[236:239], v[0:3], 0
    v_or_b32 v160, v176, v177
    v_lshlrev_b32_sdwa v192, 1, v192 dst_sel:DWORD dst_unused:UNUSED_PAD src0_sel:DWORD src1_sel:WORD_1
    v_mfma_f32_16x16x32_bf16 v[212:215], v[236:239], v[4:7], 0
    v_lshlrev_b32_sdwa v193, 1, v193 dst_sel:DWORD dst_unused:UNUSED_PAD src0_sel:DWORD src1_sel:WORD_1
    ds_read_u16_d16 v192, v192
    ds_read_u16_d16_hi v193, v193
    v_mfma_f32_16x16x32_bf16 v[216:219], v[236:239], v[8:11], 0
    v_or_b32 v161, v178, v179
    v_mfma_f32_16x16x32_bf16 v[220:223], v[236:239], v[12:15], 0
    ds_read_b64_tr_b16 v[236:237], v255 offset:50240
    ds_read_b64_tr_b16 v[238:239], v255 offset:51008
    v_lshlrev_b32_sdwa v194, 1, v194 dst_sel:DWORD dst_unused:UNUSED_PAD src0_sel:DWORD src1_sel:WORD_1
    v_mfma_f32_16x16x32_bf16 v[48:51], v[240:243], v[144:147], v[48:51]
    v_lshlrev_b32_sdwa v195, 1, v195 dst_sel:DWORD dst_unused:UNUSED_PAD src0_sel:DWORD src1_sel:WORD_1
    ds_read_u16_d16 v194, v194
    ds_read_u16_d16_hi v195, v195
    v_mfma_f32_16x16x32_bf16 v[56:59], v[240:243], v[148:151], v[56:59]
    v_or_b32 v164, v180, v181
    s_waitcnt vmcnt(0)
    v_dot2_f32_bf16 v128, v244, s86, v128
    v_dot2_f32_bf16 v129, v244, s87, v129
    v_mfma_f32_16x16x32_bf16 v[64:67], v[240:243], v[152:155], v[64:67]
    v_lshlrev_b32_sdwa v196, 1, v196 dst_sel:DWORD dst_unused:UNUSED_PAD src0_sel:DWORD src1_sel:WORD_1
    v_dot2_f32_bf16 v130, v245, s86, v130
    v_dot2_f32_bf16 v131, v245, s87, v131
    v_mfma_f32_16x16x32_bf16 v[72:75], v[240:243], v[156:159], v[72:75]
    ds_read_b64_tr_b16 v[240:241], v254 offset:47112
    ds_read_b64_tr_b16 v[242:243], v254 offset:47368
    v_lshlrev_b32_sdwa v197, 1, v197 dst_sel:DWORD dst_unused:UNUSED_PAD src0_sel:DWORD src1_sel:WORD_1
    ds_read_u16_d16 v196, v196
    ds_read_u16_d16_hi v197, v197
    v_dot2_f32_bf16 v132, v246, s86, v132
    v_dot2_f32_bf16 v133, v246, s87, v133
    s_waitcnt lgkmcnt(14)
    v_mfma_f32_16x16x32_bf16 v[208:211], v[224:227], v[16:19], v[208:211]
    v_or_b32 v165, v182, v183
    v_dot2_f32_bf16 v134, v247, s86, v134
    v_dot2_f32_bf16 v135, v247, s87, v135
    v_mfma_f32_16x16x32_bf16 v[212:215], v[224:227], v[20:23], v[212:215]
    v_lshlrev_b32_sdwa v198, 1, v198 dst_sel:DWORD dst_unused:UNUSED_PAD src0_sel:DWORD src1_sel:WORD_1
    v_dot2_f32_bf16 v76, v250, s86, v76
    v_dot2_f32_bf16 v77, v250, s87, v77
    v_mfma_f32_16x16x32_bf16 v[216:219], v[224:227], v[24:27], v[216:219]
    v_lshlrev_b32_sdwa v199, 1, v199 dst_sel:DWORD dst_unused:UNUSED_PAD src0_sel:DWORD src1_sel:WORD_1
    ds_read_u16_d16 v198, v198
    ds_read_u16_d16_hi v199, v199
    v_dot2_f32_bf16 v78, v251, s86, v78
    v_dot2_f32_bf16 v79, v251, s87, v79
    v_mfma_f32_16x16x32_bf16 v[220:223], v[224:227], v[28:31], v[220:223]
    ds_read_b64_tr_b16 v[224:225], v255 offset:50248
    ds_read_b64_tr_b16 v[226:227], v255 offset:51016
    v_or_b32 v168, v184, v185
    v_lshlrev_b32_sdwa v200, 1, v200 dst_sel:DWORD dst_unused:UNUSED_PAD src0_sel:DWORD src1_sel:WORD_1
    v_mfma_f32_16x16x32_bf16 v[52:55], v[228:231], v[144:147], v[52:55]
    v_lshlrev_b32_sdwa v201, 1, v201 dst_sel:DWORD dst_unused:UNUSED_PAD src0_sel:DWORD src1_sel:WORD_1
    ds_read_u16_d16 v200, v200
    ds_read_u16_d16_hi v201, v201
    v_dot2_f32_bf16 v72, v248, s86, v72
    v_dot2_f32_bf16 v73, v248, s87, v73
    v_mfma_f32_16x16x32_bf16 v[60:63], v[228:231], v[148:151], v[60:63]
    v_or_b32 v169, v186, v187
    v_dot2_f32_bf16 v74, v249, s86, v74
    v_dot2_f32_bf16 v75, v249, s87, v75
    buffer_load_dwordx4 v[244:247], v252, s[4:7], s25 offen offset:256 sc1
    buffer_load_dwordx4 v[248:251], v252, s[4:7], s25 offen offset:320 sc1
    v_mfma_f32_16x16x32_bf16 v[68:71], v[228:231], v[152:155], v[68:71]
    v_lshlrev_b32_sdwa v202, 1, v202 dst_sel:DWORD dst_unused:UNUSED_PAD src0_sel:DWORD src1_sel:WORD_1
    v_mfma_f32_16x16x32_bf16 v[76:79], v[228:231], v[156:159], v[76:79]
    ds_read_b64_tr_b16 v[228:229], v254 offset:48136
    ds_read_b64_tr_b16 v[230:231], v254 offset:48392
    v_lshlrev_b32_sdwa v203, 1, v203 dst_sel:DWORD dst_unused:UNUSED_PAD src0_sel:DWORD src1_sel:WORD_1
    ds_read_u16_d16 v202, v202
    ds_read_u16_d16_hi v203, v203
    s_waitcnt lgkmcnt(14)
    v_mfma_f32_16x16x32_bf16 v[208:211], v[232:235], v[32:35], v[208:211]
    v_or_b32 v172, v188, v189
    v_mfma_f32_16x16x32_bf16 v[212:215], v[232:235], v[36:39], v[212:215]
    v_lshlrev_b32_sdwa v204, 1, v204 dst_sel:DWORD dst_unused:UNUSED_PAD src0_sel:DWORD src1_sel:WORD_1
    v_mfma_f32_16x16x32_bf16 v[216:219], v[232:235], v[40:43], v[216:219]
    v_lshlrev_b32_sdwa v205, 1, v205 dst_sel:DWORD dst_unused:UNUSED_PAD src0_sel:DWORD src1_sel:WORD_1
    ds_read_u16_d16 v204, v204
    ds_read_u16_d16_hi v205, v205
    v_mfma_f32_16x16x32_bf16 v[220:223], v[232:235], v[44:47], v[220:223]
    ds_read_b64_tr_b16 v[232:233], v255 offset:50304
    ds_read_b64_tr_b16 v[234:235], v255 offset:51072
    v_or_b32 v173, v190, v191
    v_mfma_f32_16x16x32_bf16 v[80:83], v[236:239], v[144:147], v[80:83]
    v_lshlrev_b32_sdwa v206, 1, v206 dst_sel:DWORD dst_unused:UNUSED_PAD src0_sel:DWORD src1_sel:WORD_1
    v_mfma_f32_16x16x32_bf16 v[88:91], v[236:239], v[148:151], v[88:91]
    v_lshlrev_b32_sdwa v207, 1, v207 dst_sel:DWORD dst_unused:UNUSED_PAD src0_sel:DWORD src1_sel:WORD_1
    ds_read_u16_d16 v206, v206
    ds_read_u16_d16_hi v207, v207
    v_mfma_f32_16x16x32_bf16 v[96:99], v[236:239], v[152:155], v[96:99]
    v_mfma_f32_16x16x32_bf16 v[104:107], v[236:239], v[156:159], v[104:107]
    ds_read_b64_tr_b16 v[236:237], v254 offset:49160
    ds_read_b64_tr_b16 v[238:239], v254 offset:49416
    s_waitcnt lgkmcnt(14)
    v_mfma_f32_16x16x32_bf16 v[176:179], v[240:243], v[0:3], 0
    v_or_b32 v162, v192, v193
    v_lshlrev_b32_sdwa v208, 1, v208 dst_sel:DWORD dst_unused:UNUSED_PAD src0_sel:DWORD src1_sel:WORD_1
    v_mfma_f32_16x16x32_bf16 v[180:183], v[240:243], v[4:7], 0
    v_lshlrev_b32_sdwa v209, 1, v209 dst_sel:DWORD dst_unused:UNUSED_PAD src0_sel:DWORD src1_sel:WORD_1
    ds_read_u16_d16 v208, v208
    ds_read_u16_d16_hi v209, v209
    v_mfma_f32_16x16x32_bf16 v[184:187], v[240:243], v[8:11], 0
    v_or_b32 v163, v194, v195
    v_mfma_f32_16x16x32_bf16 v[188:191], v[240:243], v[12:15], 0
    ds_read_b64_tr_b16 v[240:241], v255 offset:50312
    ds_read_b64_tr_b16 v[242:243], v255 offset:51080
    v_lshlrev_b32_sdwa v210, 1, v210 dst_sel:DWORD dst_unused:UNUSED_PAD src0_sel:DWORD src1_sel:WORD_1
    v_mfma_f32_16x16x32_bf16 v[84:87], v[224:227], v[144:147], v[84:87]
    v_lshlrev_b32_sdwa v211, 1, v211 dst_sel:DWORD dst_unused:UNUSED_PAD src0_sel:DWORD src1_sel:WORD_1
    ds_read_u16_d16 v210, v210
    ds_read_u16_d16_hi v211, v211
    v_mfma_f32_16x16x32_bf16 v[92:95], v[224:227], v[148:151], v[92:95]
    v_or_b32 v166, v196, v197
    v_mfma_f32_16x16x32_bf16 v[100:103], v[224:227], v[152:155], v[100:103]
    v_lshlrev_b32_sdwa v212, 1, v212 dst_sel:DWORD dst_unused:UNUSED_PAD src0_sel:DWORD src1_sel:WORD_1
    v_mfma_f32_16x16x32_bf16 v[108:111], v[224:227], v[156:159], v[108:111]

    s_cmp_ge_u32 s19, 21
    s_cbranch_scc1 L_rd21_go
    v_mov_b32 v224, 161976

    s_mov_b32 s29, 200000
L_rd21:
    ds_read_b32 v225, v224
    s_waitcnt lgkmcnt(0)
    v_cmp_le_u32 vcc, 21, v225
    s_cmp_eq_u64 vcc, exec
    s_cbranch_scc1 L_rd21_ok
    s_sleep 2
    s_sub_u32 s29, s29, 1
    s_cmp_lg_u32 s29, 0
    s_cbranch_scc1 L_rd21
L_rd21_ok:

    v_readfirstlane_b32 s19, v225
L_rd21_go:

    ds_read_b64_tr_b16 v[224:225], v254 offset:53248
    ds_read_b64_tr_b16 v[226:227], v254 offset:53504
    v_lshlrev_b32_sdwa v213, 1, v213 dst_sel:DWORD dst_unused:UNUSED_PAD src0_sel:DWORD src1_sel:WORD_1
    ds_read_u16_d16 v212, v212
    ds_read_u16_d16_hi v213, v213
    s_waitcnt lgkmcnt(14)
    v_mfma_f32_16x16x32_bf16 v[176:179], v[228:231], v[16:19], v[176:179]
    v_or_b32 v167, v198, v199
    v_mfma_f32_16x16x32_bf16 v[180:183], v[228:231], v[20:23], v[180:183]
    v_lshlrev_b32_sdwa v214, 1, v214 dst_sel:DWORD dst_unused:UNUSED_PAD src0_sel:DWORD src1_sel:WORD_1
    v_mfma_f32_16x16x32_bf16 v[184:187], v[228:231], v[24:27], v[184:187]
    v_lshlrev_b32_sdwa v215, 1, v215 dst_sel:DWORD dst_unused:UNUSED_PAD src0_sel:DWORD src1_sel:WORD_1
    ds_read_u16_d16 v214, v214
    ds_read_u16_d16_hi v215, v215
    v_mfma_f32_16x16x32_bf16 v[188:191], v[228:231], v[28:31], v[188:191]

    s_cmp_ge_u32 s19, 22
    s_cbranch_scc1 L_rd22_go
    v_mov_b32 v228, 161976

    s_mov_b32 s29, 200000
L_rd22:
    ds_read_b32 v229, v228
    s_waitcnt lgkmcnt(0)
    v_cmp_le_u32 vcc, 22, v229
    s_cmp_eq_u64 vcc, exec
    s_cbranch_scc1 L_rd22_ok
    s_sleep 2
    s_sub_u32 s29, s29, 1
    s_cmp_lg_u32 s29, 0
    s_cbranch_scc1 L_rd22
L_rd22_ok:

    v_readfirstlane_b32 s19, v229
L_rd22_go:

    ds_read_b64_tr_b16 v[228:229], v255 offset:56320
    ds_read_b64_tr_b16 v[230:231], v255 offset:57088
    v_or_b32 v170, v200, v201
    v_lshlrev_b32_sdwa v216, 1, v216 dst_sel:DWORD dst_unused:UNUSED_PAD src0_sel:DWORD src1_sel:WORD_1
    v_mfma_f32_16x16x32_bf16 v[112:115], v[232:235], v[144:147], v[112:115]
    v_lshlrev_b32_sdwa v217, 1, v217 dst_sel:DWORD dst_unused:UNUSED_PAD src0_sel:DWORD src1_sel:WORD_1
    ds_read_u16_d16 v216, v216
    ds_read_u16_d16_hi v217, v217
    v_mfma_f32_16x16x32_bf16 v[120:123], v[232:235], v[148:151], v[120:123]
    v_or_b32 v171, v202, v203
    v_mfma_f32_16x16x32_bf16 v[128:131], v[232:235], v[152:155], v[128:131]
    v_lshlrev_b32_sdwa v218, 1, v218 dst_sel:DWORD dst_unused:UNUSED_PAD src0_sel:DWORD src1_sel:WORD_1
    v_mfma_f32_16x16x32_bf16 v[136:139], v[232:235], v[156:159], v[136:139]
    ds_read_b64_tr_b16 v[232:233], v254 offset:54272
    ds_read_b64_tr_b16 v[234:235], v254 offset:54528
    v_lshlrev_b32_sdwa v219, 1, v219 dst_sel:DWORD dst_unused:UNUSED_PAD src0_sel:DWORD src1_sel:WORD_1
    ds_read_u16_d16 v218, v218
    ds_read_u16_d16_hi v219, v219
    s_waitcnt lgkmcnt(14)
    v_mfma_f32_16x16x32_bf16 v[176:179], v[236:239], v[32:35], v[176:179]
    v_or_b32 v174, v204, v205
    v_mfma_f32_16x16x32_bf16 v[180:183], v[236:239], v[36:39], v[180:183]
    v_lshlrev_b32_sdwa v220, 1, v220 dst_sel:DWORD dst_unused:UNUSED_PAD src0_sel:DWORD src1_sel:WORD_1
    v_mfma_f32_16x16x32_bf16 v[184:187], v[236:239], v[40:43], v[184:187]
    v_lshlrev_b32_sdwa v221, 1, v221 dst_sel:DWORD dst_unused:UNUSED_PAD src0_sel:DWORD src1_sel:WORD_1
    ds_read_u16_d16 v220, v220
    ds_read_u16_d16_hi v221, v221
    v_mfma_f32_16x16x32_bf16 v[188:191], v[236:239], v[44:47], v[188:191]
    ds_read_b64_tr_b16 v[236:237], v255 offset:56328
    ds_read_b64_tr_b16 v[238:239], v255 offset:57096
    v_or_b32 v175, v206, v207
    v_mfma_f32_16x16x32_bf16 v[116:119], v[240:243], v[144:147], v[116:119]
    v_lshlrev_b32_sdwa v222, 1, v222 dst_sel:DWORD dst_unused:UNUSED_PAD src0_sel:DWORD src1_sel:WORD_1
    v_mfma_f32_16x16x32_bf16 v[124:127], v[240:243], v[148:151], v[124:127]
    v_lshlrev_b32_sdwa v223, 1, v223 dst_sel:DWORD dst_unused:UNUSED_PAD src0_sel:DWORD src1_sel:WORD_1
    ds_read_u16_d16 v222, v222
    ds_read_u16_d16_hi v223, v223
    v_mfma_f32_16x16x32_bf16 v[132:135], v[240:243], v[152:155], v[132:135]
    v_mfma_f32_16x16x32_bf16 v[140:143], v[240:243], v[156:159], v[140:143]
    ds_read_b64_tr_b16 v[240:241], v254 offset:55296
    ds_read_b64_tr_b16 v[242:243], v254 offset:55552
    s_waitcnt lgkmcnt(14)
    v_mfma_f32_16x16x32_bf16 v[192:195], v[224:227], v[0:3], 0
    v_or_b32 v144, v208, v209
    v_lshlrev_b32_sdwa v176, 1, v176 dst_sel:DWORD dst_unused:UNUSED_PAD src0_sel:DWORD src1_sel:WORD_1
    v_mfma_f32_16x16x32_bf16 v[196:199], v[224:227], v[4:7], 0
    v_lshlrev_b32_sdwa v177, 1, v177 dst_sel:DWORD dst_unused:UNUSED_PAD src0_sel:DWORD src1_sel:WORD_1
    ds_read_u16_d16 v176, v176
    ds_read_u16_d16_hi v177, v177
    v_mfma_f32_16x16x32_bf16 v[200:203], v[224:227], v[8:11], 0
    v_or_b32 v145, v210, v211
    v_mfma_f32_16x16x32_bf16 v[204:207], v[224:227], v[12:15], 0
    ds_read_b64_tr_b16 v[224:225], v255 offset:56384
    ds_read_b64_tr_b16 v[226:227], v255 offset:57152
    v_lshlrev_b32_sdwa v178, 1, v178 dst_sel:DWORD dst_unused:UNUSED_PAD src0_sel:DWORD src1_sel:WORD_1
    v_mfma_f32_16x16x32_bf16 v[48:51], v[228:231], v[160:163], v[48:51]
    v_lshlrev_b32_sdwa v179, 1, v179 dst_sel:DWORD dst_unused:UNUSED_PAD src0_sel:DWORD src1_sel:WORD_1
    ds_read_u16_d16 v178, v178
    ds_read_u16_d16_hi v179, v179
    v_mfma_f32_16x16x32_bf16 v[56:59], v[228:231], v[164:167], v[56:59]
    v_or_b32 v148, v212, v213
    v_mfma_f32_16x16x32_bf16 v[64:67], v[228:231], v[168:171], v[64:67]
    v_lshlrev_b32_sdwa v180, 1, v180 dst_sel:DWORD dst_unused:UNUSED_PAD src0_sel:DWORD src1_sel:WORD_1
    v_mfma_f32_16x16x32_bf16 v[72:75], v[228:231], v[172:175], v[72:75]
    ds_read_b64_tr_b16 v[228:229], v254 offset:53256
    ds_read_b64_tr_b16 v[230:231], v254 offset:53512
    v_lshlrev_b32_sdwa v181, 1, v181 dst_sel:DWORD dst_unused:UNUSED_PAD src0_sel:DWORD src1_sel:WORD_1
    ds_read_u16_d16 v180, v180
    ds_read_u16_d16_hi v181, v181
    s_waitcnt lgkmcnt(14)
    v_mfma_f32_16x16x32_bf16 v[192:195], v[232:235], v[16:19], v[192:195]
    v_or_b32 v149, v214, v215
    v_mfma_f32_16x16x32_bf16 v[196:199], v[232:235], v[20:23], v[196:199]
    v_lshlrev_b32_sdwa v182, 1, v182 dst_sel:DWORD dst_unused:UNUSED_PAD src0_sel:DWORD src1_sel:WORD_1
    v_mfma_f32_16x16x32_bf16 v[200:203], v[232:235], v[24:27], v[200:203]
    v_lshlrev_b32_sdwa v183, 1, v183 dst_sel:DWORD dst_unused:UNUSED_PAD src0_sel:DWORD src1_sel:WORD_1
    ds_read_u16_d16 v182, v182
    ds_read_u16_d16_hi v183, v183
    v_mfma_f32_16x16x32_bf16 v[204:207], v[232:235], v[28:31], v[204:207]
    ds_read_b64_tr_b16 v[232:233], v255 offset:56392
    ds_read_b64_tr_b16 v[234:235], v255 offset:57160
    v_or_b32 v152, v216, v217
    v_lshlrev_b32_sdwa v184, 1, v184 dst_sel:DWORD dst_unused:UNUSED_PAD src0_sel:DWORD src1_sel:WORD_1
    v_mfma_f32_16x16x32_bf16 v[52:55], v[236:239], v[160:163], v[52:55]
    v_lshlrev_b32_sdwa v185, 1, v185 dst_sel:DWORD dst_unused:UNUSED_PAD src0_sel:DWORD src1_sel:WORD_1
    ds_read_u16_d16 v184, v184
    ds_read_u16_d16_hi v185, v185
    v_mfma_f32_16x16x32_bf16 v[60:63], v[236:239], v[164:167], v[60:63]
    v_or_b32 v153, v218, v219
    v_mfma_f32_16x16x32_bf16 v[68:71], v[236:239], v[168:171], v[68:71]
    v_lshlrev_b32_sdwa v186, 1, v186 dst_sel:DWORD dst_unused:UNUSED_PAD src0_sel:DWORD src1_sel:WORD_1
    v_mfma_f32_16x16x32_bf16 v[76:79], v[236:239], v[172:175], v[76:79]
    ds_read_b64_tr_b16 v[236:237], v254 offset:54280
    ds_read_b64_tr_b16 v[238:239], v254 offset:54536
    v_lshlrev_b32_sdwa v187, 1, v187 dst_sel:DWORD dst_unused:UNUSED_PAD src0_sel:DWORD src1_sel:WORD_1
    ds_read_u16_d16 v186, v186
    ds_read_u16_d16_hi v187, v187
    s_waitcnt lgkmcnt(14)
    v_mfma_f32_16x16x32_bf16 v[192:195], v[240:243], v[32:35], v[192:195]
    v_or_b32 v156, v220, v221
    v_mfma_f32_16x16x32_bf16 v[196:199], v[240:243], v[36:39], v[196:199]
    v_lshlrev_b32_sdwa v188, 1, v188 dst_sel:DWORD dst_unused:UNUSED_PAD src0_sel:DWORD src1_sel:WORD_1
    v_mfma_f32_16x16x32_bf16 v[200:203], v[240:243], v[40:43], v[200:203]
    v_lshlrev_b32_sdwa v189, 1, v189 dst_sel:DWORD dst_unused:UNUSED_PAD src0_sel:DWORD src1_sel:WORD_1
    ds_read_u16_d16 v188, v188
    ds_read_u16_d16_hi v189, v189
    v_mfma_f32_16x16x32_bf16 v[204:207], v[240:243], v[44:47], v[204:207]
    ds_read_b64_tr_b16 v[240:241], v255 offset:56448
    ds_read_b64_tr_b16 v[242:243], v255 offset:57216
    v_or_b32 v157, v222, v223
    v_mfma_f32_16x16x32_bf16 v[80:83], v[224:227], v[160:163], v[80:83]
    v_lshlrev_b32_sdwa v190, 1, v190 dst_sel:DWORD dst_unused:UNUSED_PAD src0_sel:DWORD src1_sel:WORD_1
    v_mfma_f32_16x16x32_bf16 v[88:91], v[224:227], v[164:167], v[88:91]
    v_lshlrev_b32_sdwa v191, 1, v191 dst_sel:DWORD dst_unused:UNUSED_PAD src0_sel:DWORD src1_sel:WORD_1
    ds_read_u16_d16 v190, v190
    ds_read_u16_d16_hi v191, v191
    v_mfma_f32_16x16x32_bf16 v[96:99], v[224:227], v[168:171], v[96:99]
    v_mfma_f32_16x16x32_bf16 v[104:107], v[224:227], v[172:175], v[104:107]
    ds_read_b64_tr_b16 v[224:225], v254 offset:55304
    ds_read_b64_tr_b16 v[226:227], v254 offset:55560
    s_waitcnt lgkmcnt(14)
    v_mfma_f32_16x16x32_bf16 v[208:211], v[228:231], v[0:3], 0
    v_or_b32 v146, v176, v177
    v_lshlrev_b32_sdwa v192, 1, v192 dst_sel:DWORD dst_unused:UNUSED_PAD src0_sel:DWORD src1_sel:WORD_1
    v_mfma_f32_16x16x32_bf16 v[212:215], v[228:231], v[4:7], 0
    v_lshlrev_b32_sdwa v193, 1, v193 dst_sel:DWORD dst_unused:UNUSED_PAD src0_sel:DWORD src1_sel:WORD_1
    ds_read_u16_d16 v192, v192
    ds_read_u16_d16_hi v193, v193
    v_mfma_f32_16x16x32_bf16 v[216:219], v[228:231], v[8:11], 0
    v_or_b32 v147, v178, v179
    v_mfma_f32_16x16x32_bf16 v[220:223], v[228:231], v[12:15], 0
    ds_read_b64_tr_b16 v[228:229], v255 offset:56456
    ds_read_b64_tr_b16 v[230:231], v255 offset:57224
    v_lshlrev_b32_sdwa v194, 1, v194 dst_sel:DWORD dst_unused:UNUSED_PAD src0_sel:DWORD src1_sel:WORD_1
    v_mfma_f32_16x16x32_bf16 v[84:87], v[232:235], v[160:163], v[84:87]
    v_lshlrev_b32_sdwa v195, 1, v195 dst_sel:DWORD dst_unused:UNUSED_PAD src0_sel:DWORD src1_sel:WORD_1
    ds_read_u16_d16 v194, v194
    ds_read_u16_d16_hi v195, v195
    v_mfma_f32_16x16x32_bf16 v[92:95], v[232:235], v[164:167], v[92:95]
    v_or_b32 v150, v180, v181
    s_waitcnt vmcnt(0)
    v_dot2_f32_bf16 v104, v244, s86, v104
    v_dot2_f32_bf16 v105, v244, s87, v105
    v_mfma_f32_16x16x32_bf16 v[100:103], v[232:235], v[168:171], v[100:103]
    v_lshlrev_b32_sdwa v196, 1, v196 dst_sel:DWORD dst_unused:UNUSED_PAD src0_sel:DWORD src1_sel:WORD_1
    v_dot2_f32_bf16 v106, v245, s86, v106
    v_dot2_f32_bf16 v107, v245, s87, v107
    v_mfma_f32_16x16x32_bf16 v[108:111], v[232:235], v[172:175], v[108:111]

    s_cmp_ge_u32 s19, 23
    s_cbranch_scc1 L_rd23_go
    v_mov_b32 v232, 161976

    s_mov_b32 s29, 200000
L_rd23:
    ds_read_b32 v233, v232
    s_waitcnt lgkmcnt(0)
    v_cmp_le_u32 vcc, 23, v233
    s_cmp_eq_u64 vcc, exec
    s_cbranch_scc1 L_rd23_ok
    s_sleep 2
    s_sub_u32 s29, s29, 1
    s_cmp_lg_u32 s29, 0
    s_cbranch_scc1 L_rd23
L_rd23_ok:

    v_readfirstlane_b32 s19, v233
L_rd23_go:

    ds_read_b64_tr_b16 v[232:233], v255 offset:59392
    ds_read_b64_tr_b16 v[234:235], v255 offset:60160
    v_lshlrev_b32_sdwa v197, 1, v197 dst_sel:DWORD dst_unused:UNUSED_PAD src0_sel:DWORD src1_sel:WORD_1
    ds_read_u16_d16 v196, v196
    ds_read_u16_d16_hi v197, v197
    v_dot2_f32_bf16 v136, v248, s86, v136
    v_dot2_f32_bf16 v137, v248, s87, v137
    s_waitcnt lgkmcnt(14)
    v_mfma_f32_16x16x32_bf16 v[208:211], v[236:239], v[16:19], v[208:211]
    v_or_b32 v151, v182, v183
    v_dot2_f32_bf16 v138, v249, s86, v138
    v_dot2_f32_bf16 v139, v249, s87, v139
    v_mfma_f32_16x16x32_bf16 v[212:215], v[236:239], v[20:23], v[212:215]
    v_lshlrev_b32_sdwa v198, 1, v198 dst_sel:DWORD dst_unused:UNUSED_PAD src0_sel:DWORD src1_sel:WORD_1
    v_dot2_f32_bf16 v140, v250, s86, v140
    v_dot2_f32_bf16 v141, v250, s87, v141
    v_mfma_f32_16x16x32_bf16 v[216:219], v[236:239], v[24:27], v[216:219]
    v_lshlrev_b32_sdwa v199, 1, v199 dst_sel:DWORD dst_unused:UNUSED_PAD src0_sel:DWORD src1_sel:WORD_1
    ds_read_u16_d16 v198, v198
    ds_read_u16_d16_hi v199, v199
    v_dot2_f32_bf16 v142, v251, s86, v142
    v_dot2_f32_bf16 v143, v251, s87, v143
    v_mfma_f32_16x16x32_bf16 v[220:223], v[236:239], v[28:31], v[220:223]
    ds_read_b64_tr_b16 v[236:237], v255 offset:59400
    ds_read_b64_tr_b16 v[238:239], v255 offset:60168
    v_or_b32 v154, v184, v185
    v_lshlrev_b32_sdwa v200, 1, v200 dst_sel:DWORD dst_unused:UNUSED_PAD src0_sel:DWORD src1_sel:WORD_1
    v_mfma_f32_16x16x32_bf16 v[112:115], v[240:243], v[160:163], v[112:115]
    v_lshlrev_b32_sdwa v201, 1, v201 dst_sel:DWORD dst_unused:UNUSED_PAD src0_sel:DWORD src1_sel:WORD_1
    ds_read_u16_d16 v200, v200
    ds_read_u16_d16_hi v201, v201
    v_dot2_f32_bf16 v108, v246, s86, v108
    v_dot2_f32_bf16 v109, v246, s87, v109
    v_mfma_f32_16x16x32_bf16 v[120:123], v[240:243], v[164:167], v[120:123]
    v_or_b32 v155, v186, v187
    v_dot2_f32_bf16 v110, v247, s86, v110
    v_dot2_f32_bf16 v111, v247, s87, v111
    v_mfma_f32_16x16x32_bf16 v[128:131], v[240:243], v[168:171], v[128:131]
    v_lshlrev_b32_sdwa v202, 1, v202 dst_sel:DWORD dst_unused:UNUSED_PAD src0_sel:DWORD src1_sel:WORD_1
    v_mfma_f32_16x16x32_bf16 v[136:139], v[240:243], v[172:175], v[136:139]
    ds_read_b64_tr_b16 v[240:241], v255 offset:59456
    ds_read_b64_tr_b16 v[242:243], v255 offset:60224
    v_lshlrev_b32_sdwa v203, 1, v203 dst_sel:DWORD dst_unused:UNUSED_PAD src0_sel:DWORD src1_sel:WORD_1
    ds_read_u16_d16 v202, v202
    ds_read_u16_d16_hi v203, v203
    s_waitcnt lgkmcnt(14)
    v_mfma_f32_16x16x32_bf16 v[208:211], v[224:227], v[32:35], v[208:211]
    v_or_b32 v158, v188, v189
    v_mfma_f32_16x16x32_bf16 v[212:215], v[224:227], v[36:39], v[212:215]
    v_lshlrev_b32_sdwa v204, 1, v204 dst_sel:DWORD dst_unused:UNUSED_PAD src0_sel:DWORD src1_sel:WORD_1
    v_mfma_f32_16x16x32_bf16 v[216:219], v[224:227], v[40:43], v[216:219]
    v_lshlrev_b32_sdwa v205, 1, v205 dst_sel:DWORD dst_unused:UNUSED_PAD src0_sel:DWORD src1_sel:WORD_1
    ds_read_u16_d16 v204, v204
    ds_read_u16_d16_hi v205, v205
    v_mfma_f32_16x16x32_bf16 v[220:223], v[224:227], v[44:47], v[220:223]
    ds_read_b64_tr_b16 v[224:225], v255 offset:59464
    ds_read_b64_tr_b16 v[226:227], v255 offset:60232
    v_or_b32 v159, v190, v191
    v_mfma_f32_16x16x32_bf16 v[116:119], v[228:231], v[160:163], v[116:119]
    v_lshlrev_b32_sdwa v206, 1, v206 dst_sel:DWORD dst_unused:UNUSED_PAD src0_sel:DWORD src1_sel:WORD_1
    v_mfma_f32_16x16x32_bf16 v[124:127], v[228:231], v[164:167], v[124:127]
    v_lshlrev_b32_sdwa v207, 1, v207 dst_sel:DWORD dst_unused:UNUSED_PAD src0_sel:DWORD src1_sel:WORD_1
    ds_read_u16_d16 v206, v206
    ds_read_u16_d16_hi v207, v207
    v_mfma_f32_16x16x32_bf16 v[132:135], v[228:231], v[168:171], v[132:135]
    v_mfma_f32_16x16x32_bf16 v[140:143], v[228:231], v[172:175], v[140:143]
    ds_read_b64_tr_b16 v[228:229], v255 offset:59520
    ds_read_b64_tr_b16 v[230:231], v255 offset:60288
    s_waitcnt lgkmcnt(14)
    v_mfma_f32_16x16x32_bf16 v[48:51], v[232:235], v[144:147], v[48:51]
    v_or_b32 v160, v192, v193
    v_lshlrev_b32_sdwa v208, 1, v208 dst_sel:DWORD dst_unused:UNUSED_PAD src0_sel:DWORD src1_sel:WORD_1
    v_lshlrev_b32_sdwa v209, 1, v209 dst_sel:DWORD dst_unused:UNUSED_PAD src0_sel:DWORD src1_sel:WORD_1
    ds_read_u16_d16 v208, v208
    ds_read_u16_d16_hi v209, v209
    s_waitcnt vmcnt(0)
    v_lshrrev_b32 v244, 7, v253
    v_mul_u32_u24 v244, 640, v244
    v_add_u32 v244, v244, v253
    v_add_u32 v245, 196608, v244
    buffer_load_dwordx4 v[16:19], v244, s[8:11], s36 offen offset:0
    v_mfma_f32_16x16x32_bf16 v[56:59], v[232:235], v[148:151], v[56:59]
    v_or_b32 v161, v194, v195
    v_lshlrev_b32_sdwa v210, 1, v210 dst_sel:DWORD dst_unused:UNUSED_PAD src0_sel:DWORD src1_sel:WORD_1
    buffer_load_dwordx4 v[20:23], v244, s[8:11], s36 offen offset:128
    v_mfma_f32_16x16x32_bf16 v[64:67], v[232:235], v[152:155], v[64:67]
    v_lshlrev_b32_sdwa v211, 1, v211 dst_sel:DWORD dst_unused:UNUSED_PAD src0_sel:DWORD src1_sel:WORD_1
    ds_read_u16_d16 v210, v210
    ds_read_u16_d16_hi v211, v211
    v_or_b32 v164, v196, v197
    v_lshlrev_b32_sdwa v212, 1, v212 dst_sel:DWORD dst_unused:UNUSED_PAD src0_sel:DWORD src1_sel:WORD_1
    buffer_load_dwordx4 v[24:27], v244, s[8:11], s36 offen offset:256
    v_mfma_f32_16x16x32_bf16 v[72:75], v[232:235], v[156:159], v[72:75]
    ds_read_b64_tr_b16 v[232:233], v255 offset:59528
    ds_read_b64_tr_b16 v[234:235], v255 offset:60296
    v_lshlrev_b32_sdwa v213, 1, v213 dst_sel:DWORD dst_unused:UNUSED_PAD src0_sel:DWORD src1_sel:WORD_1
    ds_read_u16_d16 v212, v212
    ds_read_u16_d16_hi v213, v213
    v_or_b32 v165, v198, v199
    buffer_load_dwordx4 v[28:31], v244, s[8:11], s37 offen offset:0
    v_mfma_f32_16x16x32_bf16 v[52:55], v[236:239], v[144:147], v[52:55]
    v_lshlrev_b32_sdwa v214, 1, v214 dst_sel:DWORD dst_unused:UNUSED_PAD src0_sel:DWORD src1_sel:WORD_1
    v_lshlrev_b32_sdwa v215, 1, v215 dst_sel:DWORD dst_unused:UNUSED_PAD src0_sel:DWORD src1_sel:WORD_1
    ds_read_u16_d16 v214, v214
    ds_read_u16_d16_hi v215, v215
    buffer_load_dwordx4 v[32:35], v244, s[8:11], s37 offen offset:128
    v_mfma_f32_16x16x32_bf16 v[60:63], v[236:239], v[148:151], v[60:63]
    s_waitcnt lgkmcnt(14)
    v_or_b32 v168, v200, v201
    v_lshlrev_b32_sdwa v216, 1, v216 dst_sel:DWORD dst_unused:UNUSED_PAD src0_sel:DWORD src1_sel:WORD_1
    v_lshlrev_b32_sdwa v217, 1, v217 dst_sel:DWORD dst_unused:UNUSED_PAD src0_sel:DWORD src1_sel:WORD_1
    ds_read_u16_d16 v216, v216
    ds_read_u16_d16_hi v217, v217
    buffer_load_dwordx4 v[36:39], v244, s[8:11], s37 offen offset:256
    v_mfma_f32_16x16x32_bf16 v[68:71], v[236:239], v[152:155], v[68:71]
    v_or_b32 v169, v202, v203
    v_lshlrev_b32_sdwa v218, 1, v218 dst_sel:DWORD dst_unused:UNUSED_PAD src0_sel:DWORD src1_sel:WORD_1
    buffer_load_dwordx4 v[40:43], v245, s[8:11], s36 offen offset:0
    v_mfma_f32_16x16x32_bf16 v[76:79], v[236:239], v[156:159], v[76:79]

    s_cmp_ge_u32 s19, 24
    s_cbranch_scc1 L_rd24_go
    v_mov_b32 v236, 161976

    s_mov_b32 s29, 200000
L_rd24:
    ds_read_b32 v237, v236
    s_waitcnt lgkmcnt(0)
    v_cmp_le_u32 vcc, 24, v237
    s_cmp_eq_u64 vcc, exec
    s_cbranch_scc1 L_rd24_ok
    s_sleep 2
    s_sub_u32 s29, s29, 1
    s_cmp_lg_u32 s29, 0
    s_cbranch_scc1 L_rd24
L_rd24_ok:

    v_readfirstlane_b32 s19, v237
L_rd24_go:

    ds_read_b64_tr_b16 v[236:237], v255 offset:62464
    ds_read_b64_tr_b16 v[238:239], v255 offset:63232
    v_lshlrev_b32_sdwa v219, 1, v219 dst_sel:DWORD dst_unused:UNUSED_PAD src0_sel:DWORD src1_sel:WORD_1
    ds_read_u16_d16 v218, v218
    ds_read_u16_d16_hi v219, v219
    v_or_b32 v172, v204, v205
    v_lshlrev_b32_sdwa v220, 1, v220 dst_sel:DWORD dst_unused:UNUSED_PAD src0_sel:DWORD src1_sel:WORD_1
    buffer_load_dwordx4 v[44:47], v245, s[8:11], s36 offen offset:128
    v_mfma_f32_16x16x32_bf16 v[80:83], v[240:243], v[144:147], v[80:83]
    v_lshlrev_b32_sdwa v221, 1, v221 dst_sel:DWORD dst_unused:UNUSED_PAD src0_sel:DWORD src1_sel:WORD_1
    ds_read_u16_d16 v220, v220
    ds_read_u16_d16_hi v221, v221
    s_waitcnt lgkmcnt(14)
    v_or_b32 v173, v206, v207
    buffer_load_dwordx4 v[0:3], v245, s[8:11], s36 offen offset:256
    v_mfma_f32_16x16x32_bf16 v[88:91], v[240:243], v[148:151], v[88:91]
    v_lshlrev_b32_sdwa v222, 1, v222 dst_sel:DWORD dst_unused:UNUSED_PAD src0_sel:DWORD src1_sel:WORD_1
    v_lshlrev_b32_sdwa v223, 1, v223 dst_sel:DWORD dst_unused:UNUSED_PAD src0_sel:DWORD src1_sel:WORD_1
    ds_read_u16_d16 v222, v222
    ds_read_u16_d16_hi v223, v223
    buffer_load_dwordx4 v[4:7], v245, s[8:11], s37 offen offset:0
    v_mfma_f32_16x16x32_bf16 v[96:99], v[240:243], v[152:155], v[96:99]
    buffer_load_dwordx4 v[8:11], v245, s[8:11], s37 offen offset:128
    v_mfma_f32_16x16x32_bf16 v[104:107], v[240:243], v[156:159], v[104:107]
    ds_read_b64_tr_b16 v[240:241], v255 offset:62472
    ds_read_b64_tr_b16 v[242:243], v255 offset:63240
    buffer_load_dwordx4 v[12:15], v245, s[8:11], s37 offen offset:256
    v_mfma_f32_16x16x32_bf16 v[84:87], v[224:227], v[144:147], v[84:87]
    v_or_b32 v162, v208, v209
    v_mfma_f32_16x16x32_bf16 v[92:95], v[224:227], v[148:151], v[92:95]
    v_or_b32 v163, v210, v211
    v_mfma_f32_16x16x32_bf16 v[100:103], v[224:227], v[152:155], v[100:103]
    s_waitcnt lgkmcnt(14)
    v_or_b32 v166, v212, v213
    v_bfe_u32 v244, v253, 4, 3
    v_mul_u32_u24 v244, 768, v244
    v_bfe_u32 v245, v253, 7, 1
    v_lshl_add_u32 v244, v245, 6, v244
    v_lshrrev_b32 v245, 8, v253
    v_lshl_add_u32 v244, v245, 4, v244
    v_add_u32 v245, 196608, v244
    v_mfma_f32_16x16x32_bf16 v[108:111], v[224:227], v[156:159], v[108:111]
    ds_read_b64_tr_b16 v[224:225], v255 offset:62528
    ds_read_b64_tr_b16 v[226:227], v255 offset:63296
    s_waitcnt lgkmcnt(14)
    v_or_b32 v167, v214, v215
    v_mfma_f32_16x16x32_bf16 v[112:115], v[228:231], v[144:147], v[112:115]
    v_mfma_f32_16x16x32_bf16 v[120:123], v[228:231], v[148:151], v[120:123]
    s_waitcnt lgkmcnt(12)
    v_or_b32 v170, v216, v217
    v_mfma_f32_16x16x32_bf16 v[128:131], v[228:231], v[152:155], v[128:131]
    s_waitcnt lgkmcnt(8)
    v_or_b32 v171, v218, v219
    v_mfma_f32_16x16x32_bf16 v[136:139], v[228:231], v[156:159], v[136:139]
    ds_read_b64_tr_b16 v[228:229], v255 offset:62536
    ds_read_b64_tr_b16 v[230:231], v255 offset:63304
    s_waitcnt lgkmcnt(8)
    v_or_b32 v174, v220, v221
    v_mfma_f32_16x16x32_bf16 v[116:119], v[232:235], v[144:147], v[116:119]
    s_waitcnt lgkmcnt(6)
    v_or_b32 v175, v222, v223
    v_mfma_f32_16x16x32_bf16 v[124:127], v[232:235], v[148:151], v[124:127]
    v_mfma_f32_16x16x32_bf16 v[132:135], v[232:235], v[152:155], v[132:135]
    v_mfma_f32_16x16x32_bf16 v[140:143], v[232:235], v[156:159], v[140:143]
    ds_read_b64_tr_b16 v[232:233], v255 offset:62592
    ds_read_b64_tr_b16 v[234:235], v255 offset:63360
    v_mfma_f32_16x16x32_bf16 v[48:51], v[236:239], v[160:163], v[48:51]
    v_mfma_f32_16x16x32_bf16 v[56:59], v[236:239], v[164:167], v[56:59]
    v_mfma_f32_16x16x32_bf16 v[64:67], v[236:239], v[168:171], v[64:67]
    v_mfma_f32_16x16x32_bf16 v[72:75], v[236:239], v[172:175], v[72:75]
    ds_read_b64_tr_b16 v[236:237], v255 offset:62600
    ds_read_b64_tr_b16 v[238:239], v255 offset:63368
    s_waitcnt lgkmcnt(8)
    v_mfma_f32_16x16x32_bf16 v[52:55], v[240:243], v[160:163], v[52:55]
    v_mfma_f32_16x16x32_bf16 v[60:63], v[240:243], v[164:167], v[60:63]
    v_mfma_f32_16x16x32_bf16 v[68:71], v[240:243], v[168:171], v[68:71]
    v_mfma_f32_16x16x32_bf16 v[76:79], v[240:243], v[172:175], v[76:79]
    s_waitcnt lgkmcnt(6)
    v_mfma_f32_16x16x32_bf16 v[80:83], v[224:227], v[160:163], v[80:83]
    v_mfma_f32_16x16x32_bf16 v[88:91], v[224:227], v[164:167], v[88:91]
    v_mfma_f32_16x16x32_bf16 v[96:99], v[224:227], v[168:171], v[96:99]
    v_mfma_f32_16x16x32_bf16 v[104:107], v[224:227], v[172:175], v[104:107]
    s_waitcnt lgkmcnt(4)
    v_mfma_f32_16x16x32_bf16 v[84:87], v[228:231], v[160:163], v[84:87]
    v_cvt_pk_bf16_f32 v48, v48, v49
    v_cvt_pk_bf16_f32 v49, v50, v51
    v_cvt_pk_bf16_f32 v50, v52, v53
    v_cvt_pk_bf16_f32 v51, v54, v55
    v_mfma_f32_16x16x32_bf16 v[92:95], v[228:231], v[164:167], v[92:95]
    v_cvt_pk_bf16_f32 v56, v56, v57
    v_cvt_pk_bf16_f32 v57, v58, v59
    v_cvt_pk_bf16_f32 v58, v60, v61
    v_cvt_pk_bf16_f32 v59, v62, v63
    v_mfma_f32_16x16x32_bf16 v[100:103], v[228:231], v[168:171], v[100:103]
    v_cvt_pk_bf16_f32 v64, v64, v65
    v_cvt_pk_bf16_f32 v65, v66, v67
    v_cvt_pk_bf16_f32 v66, v68, v69
    v_cvt_pk_bf16_f32 v67, v70, v71
    v_mfma_f32_16x16x32_bf16 v[108:111], v[228:231], v[172:175], v[108:111]
    v_cvt_pk_bf16_f32 v72, v72, v73
    v_cvt_pk_bf16_f32 v73, v74, v75
    v_cvt_pk_bf16_f32 v74, v76, v77
    v_cvt_pk_bf16_f32 v75, v78, v79
    s_waitcnt lgkmcnt(2)
    v_mfma_f32_16x16x32_bf16 v[112:115], v[232:235], v[160:163], v[112:115]
    v_mfma_f32_16x16x32_bf16 v[120:123], v[232:235], v[164:167], v[120:123]
    v_mfma_f32_16x16x32_bf16 v[128:131], v[232:235], v[168:171], v[128:131]
    v_mfma_f32_16x16x32_bf16 v[136:139], v[232:235], v[172:175], v[136:139]
    s_waitcnt lgkmcnt(0)
    v_mfma_f32_16x16x32_bf16 v[116:119], v[236:239], v[160:163], v[116:119]
    v_cvt_pk_bf16_f32 v80, v80, v81
    v_cvt_pk_bf16_f32 v81, v82, v83
    v_cvt_pk_bf16_f32 v82, v84, v85
    v_cvt_pk_bf16_f32 v83, v86, v87
    v_mfma_f32_16x16x32_bf16 v[124:127], v[236:239], v[164:167], v[124:127]
    v_cvt_pk_bf16_f32 v88, v88, v89
    v_cvt_pk_bf16_f32 v89, v90, v91
    v_cvt_pk_bf16_f32 v90, v92, v93
    v_cvt_pk_bf16_f32 v91, v94, v95
    v_mfma_f32_16x16x32_bf16 v[132:135], v[236:239], v[168:171], v[132:135]
    v_cvt_pk_bf16_f32 v96, v96, v97
    v_cvt_pk_bf16_f32 v97, v98, v99
    v_cvt_pk_bf16_f32 v98, v100, v101
    v_cvt_pk_bf16_f32 v99, v102, v103
    v_mfma_f32_16x16x32_bf16 v[140:143], v[236:239], v[172:175], v[140:143]
    v_cvt_pk_bf16_f32 v104, v104, v105
    v_cvt_pk_bf16_f32 v105, v106, v107
    v_cvt_pk_bf16_f32 v106, v108, v109
    v_cvt_pk_bf16_f32 v107, v110, v111
    v_mov_b32 v52, v48
    v_mov_b32 v53, v49
    v_mov_b32 v54, v50
    v_mov_b32 v55, v51
    v_mov_b32_dpp v48, v80 row_ror:8 row_mask:0xf bank_mask:0xc
    v_mov_b32_dpp v49, v81 row_ror:8 row_mask:0xf bank_mask:0xc
    v_mov_b32_dpp v50, v82 row_ror:8 row_mask:0xf bank_mask:0xc
    v_mov_b32_dpp v51, v83 row_ror:8 row_mask:0xf bank_mask:0xc
    v_mov_b32_dpp v80, v52 row_ror:8 row_mask:0xf bank_mask:0x3
    v_mov_b32_dpp v81, v53 row_ror:8 row_mask:0xf bank_mask:0x3
    v_mov_b32_dpp v82, v54 row_ror:8 row_mask:0xf bank_mask:0x3
    v_mov_b32_dpp v83, v55 row_ror:8 row_mask:0xf bank_mask:0x3
    buffer_store_dwordx4 v[48:51], v244, s[8:11], s24 offen offset:0 sc1
    buffer_store_dwordx4 v[80:83], v245, s[8:11], s24 offen offset:0 sc1
    v_mov_b32 v68, v64
    v_mov_b32 v69, v65
    v_mov_b32 v70, v66
    v_mov_b32 v71, v67
    v_mov_b32_dpp v64, v96 row_ror:8 row_mask:0xf bank_mask:0xc
    v_mov_b32_dpp v65, v97 row_ror:8 row_mask:0xf bank_mask:0xc
    v_mov_b32_dpp v66, v98 row_ror:8 row_mask:0xf bank_mask:0xc
    v_mov_b32_dpp v67, v99 row_ror:8 row_mask:0xf bank_mask:0xc
    v_mov_b32_dpp v96, v68 row_ror:8 row_mask:0xf bank_mask:0x3
    v_mov_b32_dpp v97, v69 row_ror:8 row_mask:0xf bank_mask:0x3
    v_mov_b32_dpp v98, v70 row_ror:8 row_mask:0xf bank_mask:0x3
    v_mov_b32_dpp v99, v71 row_ror:8 row_mask:0xf bank_mask:0x3
    buffer_store_dwordx4 v[64:67], v244, s[8:11], s25 offen offset:0 sc1
    buffer_store_dwordx4 v[96:99], v245, s[8:11], s25 offen offset:0 sc1
    v_cvt_pk_bf16_f32 v112, v112, v113
    v_cvt_pk_bf16_f32 v113, v114, v115
    v_cvt_pk_bf16_f32 v114, v116, v117
    v_cvt_pk_bf16_f32 v115, v118, v119
    v_cvt_pk_bf16_f32 v120, v120, v121
    v_cvt_pk_bf16_f32 v121, v122, v123
    v_cvt_pk_bf16_f32 v122, v124, v125
    v_cvt_pk_bf16_f32 v123, v126, v127
    v_mov_b32 v116, v112
    v_mov_b32 v117, v113
    v_mov_b32 v118, v114
    v_mov_b32 v119, v115
    v_mov_b32_dpp v112, v56 row_ror:8 row_mask:0xf bank_mask:0xc
    v_mov_b32_dpp v113, v57 row_ror:8 row_mask:0xf bank_mask:0xc
    v_mov_b32_dpp v114, v58 row_ror:8 row_mask:0xf bank_mask:0xc
    v_mov_b32_dpp v115, v59 row_ror:8 row_mask:0xf bank_mask:0xc
    v_mov_b32_dpp v56, v116 row_ror:8 row_mask:0xf bank_mask:0x3
    v_mov_b32_dpp v57, v117 row_ror:8 row_mask:0xf bank_mask:0x3
    v_mov_b32_dpp v58, v118 row_ror:8 row_mask:0xf bank_mask:0x3
    v_mov_b32_dpp v59, v119 row_ror:8 row_mask:0xf bank_mask:0x3
    buffer_store_dwordx4 v[112:115], v244, s[8:11], s24 offen offset:128 sc1
    buffer_store_dwordx4 v[56:59], v245, s[8:11], s24 offen offset:128 sc1
    v_mov_b32 v92, v88
    v_mov_b32 v93, v89
    v_mov_b32 v94, v90
    v_mov_b32 v95, v91
    v_mov_b32_dpp v88, v120 row_ror:8 row_mask:0xf bank_mask:0xc
    v_mov_b32_dpp v89, v121 row_ror:8 row_mask:0xf bank_mask:0xc
    v_mov_b32_dpp v90, v122 row_ror:8 row_mask:0xf bank_mask:0xc
    v_mov_b32_dpp v91, v123 row_ror:8 row_mask:0xf bank_mask:0xc
    v_mov_b32_dpp v120, v92 row_ror:8 row_mask:0xf bank_mask:0x3
    v_mov_b32_dpp v121, v93 row_ror:8 row_mask:0xf bank_mask:0x3
    v_mov_b32_dpp v122, v94 row_ror:8 row_mask:0xf bank_mask:0x3
    v_mov_b32_dpp v123, v95 row_ror:8 row_mask:0xf bank_mask:0x3
    buffer_store_dwordx4 v[88:91], v244, s[8:11], s24 offen offset:256 sc1
    buffer_store_dwordx4 v[120:123], v245, s[8:11], s24 offen offset:256 sc1
    v_cvt_pk_bf16_f32 v128, v128, v129
    v_cvt_pk_bf16_f32 v129, v130, v131
    v_cvt_pk_bf16_f32 v130, v132, v133
    v_cvt_pk_bf16_f32 v131, v134, v135
    v_cvt_pk_bf16_f32 v136, v136, v137
    v_cvt_pk_bf16_f32 v137, v138, v139
    v_cvt_pk_bf16_f32 v138, v140, v141
    v_cvt_pk_bf16_f32 v139, v142, v143
    v_mov_b32 v132, v128
    v_mov_b32 v133, v129
    v_mov_b32 v134, v130
    v_mov_b32 v135, v131
    v_mov_b32_dpp v128, v72 row_ror:8 row_mask:0xf bank_mask:0xc
    v_mov_b32_dpp v129, v73 row_ror:8 row_mask:0xf bank_mask:0xc
    v_mov_b32_dpp v130, v74 row_ror:8 row_mask:0xf bank_mask:0xc
    v_mov_b32_dpp v131, v75 row_ror:8 row_mask:0xf bank_mask:0xc
    v_mov_b32_dpp v72, v132 row_ror:8 row_mask:0xf bank_mask:0x3
    v_mov_b32_dpp v73, v133 row_ror:8 row_mask:0xf bank_mask:0x3
    v_mov_b32_dpp v74, v134 row_ror:8 row_mask:0xf bank_mask:0x3
    v_mov_b32_dpp v75, v135 row_ror:8 row_mask:0xf bank_mask:0x3
    buffer_store_dwordx4 v[128:131], v244, s[8:11], s25 offen offset:128 sc1
    buffer_store_dwordx4 v[72:75], v245, s[8:11], s25 offen offset:128 sc1
    v_mov_b32 v108, v104
    v_mov_b32 v109, v105
    v_mov_b32 v110, v106
    v_mov_b32 v111, v107
    v_mov_b32_dpp v104, v136 row_ror:8 row_mask:0xf bank_mask:0xc
    v_mov_b32_dpp v105, v137 row_ror:8 row_mask:0xf bank_mask:0xc
    v_mov_b32_dpp v106, v138 row_ror:8 row_mask:0xf bank_mask:0xc
    v_mov_b32_dpp v107, v139 row_ror:8 row_mask:0xf bank_mask:0xc
    v_mov_b32_dpp v136, v108 row_ror:8 row_mask:0xf bank_mask:0x3
    v_mov_b32_dpp v137, v109 row_ror:8 row_mask:0xf bank_mask:0x3
    v_mov_b32_dpp v138, v110 row_ror:8 row_mask:0xf bank_mask:0x3
    v_mov_b32_dpp v139, v111 row_ror:8 row_mask:0xf bank_mask:0x3
    buffer_store_dwordx4 v[104:107], v244, s[8:11], s25 offen offset:256 sc1
    buffer_store_dwordx4 v[136:139], v245, s[8:11], s25 offen offset:256 sc1
L_fin2:

    s_cmp_lg_u32 s17, 0
    s_cbranch_scc1 L_end
    s_mov_b32 s17, 1
    s_mov_b32 s24, s36
    s_mov_b32 s25, s37
    s_mov_b32 s36, 1073741824
    s_mov_b32 s37, 1073741824
    s_setprio 1
    s_branch L_mtile
L_end:
    s_endpgm

.section .rodata,"a"

.p2align 6
.amdhsa_kernel standalone__modern_conv_block_replknet__vision_kernel
.amdhsa_next_free_vgpr 256
.amdhsa_next_free_sgpr 100
.amdhsa_accum_offset 256
.amdhsa_group_segment_fixed_size 0
.amdhsa_kernarg_size 64
.amdhsa_user_sgpr_count 2
.amdhsa_user_sgpr_kernarg_segment_ptr 1
.amdhsa_system_sgpr_workgroup_id_x 1
.amdhsa_float_denorm_mode_32 3
.end_amdhsa_kernel
```

```asm
; @launch grid=(256,1,1) block=(512,1,1) lds=162320
.amdgcn_target "amdgcn-amd-amdhsa--gfx950"
.text

.globl standalone__modern_conv_block_replknet__vision_kernel
.p2align 8
.type standalone__modern_conv_block_replknet__vision_kernel,@function
standalone__modern_conv_block_replknet__vision_kernel:
    s_cmp_ge_u32 s2, 256
    s_cbranch_scc1 L_end
    s_load_dwordx8 s[64:71], s[0:1], 0
    s_load_dwordx4 s[72:75], s[0:1], 32

    s_getpc_b64 s[96:97]
L_pc0:
    v_add_u32 v16, 448, v0
    v_and_b32 v16, 511, v16
    v_lshlrev_b32 v16, 7, v16
    v_min_u32 v16, L_end-L_pc0, v16
    v_mov_b32 v17, s97
    v_add_co_u32 v16, vcc, s96, v16
    s_nop 1
    v_addc_co_u32 v17, vcc, 0, v17, vcc
    global_load_dword v18, v[16:17], off sc1
    s_setprio 3
    v_mov_b32 v14, v0
    v_lshrrev_b32 v1, 6, v0
    v_and_b32 v0, 63, v0
    v_mov_b32 v10, 1073741824
    v_readfirstlane_b32 s16, v1
    v_lshlrev_b32 v2, 2, v0
    v_add_u32 v2, 161808, v2
    v_add_u32 v3, -10, v0
    v_cmp_gt_u32 vcc, 10, v3
    v_cmp_eq_u32 s[56:57], 36, v0
    s_or_b64 vcc, vcc, s[56:57]
    v_cndmask_b32 v3, 0, 1, vcc
    v_lshlrev_b32 v253, 4, v0
    v_min_u32 v240, 1, v0
    ds_write_b32 v2, v3
    v_lshlrev_b32 v240, 2, v240
    s_and_b32 s26, s2, 3
    s_lshl_b32 s26, s26, 2
    s_bfe_u32 s27, s2, 0x20003
    s_add_u32 s26, s26, s27
    s_lshl_b32 s22, s26, 5
    s_bfe_u32 s26, s2, 0x10002
    s_lshl_b32 s26, s26, 3
    s_lshr_b32 s27, s2, 5
    s_add_u32 s26, s26, s27
    s_lshl_b32 s23, s26, 5
    v_mul_u32_u24 v12, 43, v0
    v_lshrrev_b32 v12, 9, v12
    v_mul_u32_u24 v13, 12, v12
    v_sub_u32 v13, v0, v13
    v_mul_u32_u24 v5, 98304, v12
    v_lshl_add_u32 v5, v13, 4, v5
    v_cmp_gt_u32 vcc, 48, v0
    v_cmp_gt_u32 s[58:59], 24, v0
    s_cmp_eq_u32 s22, 0
    s_cselect_b32 s80, 1073741824, 0
    v_cndmask_b32 v247, v10, v5, vcc
    s_mov_b32 s82, 3840
    s_cmp_eq_u32 s22, 480
    s_cselect_b32 s81, 1073741824, s82
    s_mov_b32 s18, s16
    v_add_u32 v15, -256, v14

    s_waitcnt lgkmcnt(0)
    s_barrier
    s_mov_b32 s4, s64
    s_and_b32 s5, s65, 0xffff
    s_mov_b32 s6, 50331648
    s_mov_b32 s7, 0x20000
    s_mov_b32 s48, s66
    s_and_b32 s49, s67, 0xffff
    s_mov_b32 s50, 1728
    s_mov_b32 s51, 0x20000
    s_mov_b32 s52, s68
    s_and_b32 s53, s69, 0xffff
    s_mov_b32 s54, 4800
    s_mov_b32 s55, 0x20000
    s_mov_b32 s40, s70
    s_and_b32 s41, s71, 0xffff
    s_mov_b32 s42, 73728
    s_mov_b32 s43, 0x20000
    s_mov_b32 s44, s72
    s_and_b32 s45, s73, 0xffff
    s_mov_b32 s46, 73728
    s_mov_b32 s47, 0x20000
    s_mov_b32 s8, s74
    s_and_b32 s9, s75, 0xffff
    s_mov_b32 s10, 50331648
    s_mov_b32 s11, 0x20000

    s_cmp_lg_u32 s16, 0
    s_cbranch_scc1 L_pb
    s_mov_b32 m0, 21504
    s_mov_b32 s26, 4096

    buffer_load_dwordx4 v253, s[52:55], 0 offen offset:0 lds
    buffer_load_dwordx4 v253, s[52:55], 0 offen offset:1024 lds
    buffer_load_dwordx4 v253, s[52:55], 0 offen offset:2048 lds
    buffer_load_dwordx4 v253, s[52:55], 0 offen offset:3072 lds
    s_mov_b32 m0, 25600
    s_nop 0
    buffer_load_dwordx4 v253, s[52:55], s26 offen lds
    s_mov_b32 m0, 26624
    s_nop 0
    buffer_load_dwordx4 v253, s[48:51], 0 offen offset:0 lds
    buffer_load_dwordx4 v253, s[48:51], 0 offen offset:1024 lds

    s_lshl_b32 s26, s18, 2
    s_add_u32 s26, s26, s23
    s_lshl_b32 s27, s26, 9
    s_add_u32 s27, s27, s22
    s_mul_i32 s27, s27, 192
    s_cmp_lt_u32 s26, 2
    s_cselect_b64 vcc, s[58:59], 0
    v_mov_b32 v248, 1073741824
    s_sub_u32 s28, s27, 196608
    v_add_u32 v255, s28, v247
    v_cndmask_b32 v248, v255, v248, vcc
    v_add_u32 v255, -384, v248

    buffer_load_dwordx4 v[48:51], v255, s[4:7], s80 offen offset:0 sc1
    buffer_load_dwordx4 v[52:55], v255, s[4:7], s80 offen offset:192 sc1
    buffer_load_dwordx4 v[56:59], v248, s[4:7], 0 offen offset:0 sc1
    buffer_load_dwordx4 v[60:63], v248, s[4:7], 0 offen offset:192 sc1
    buffer_load_dwordx4 v[64:67], v248, s[4:7], 0 offen offset:384 sc1
    buffer_load_dwordx4 v[68:71], v248, s[4:7], 0 offen offset:576 sc1
    buffer_load_dwordx4 v[72:75], v248, s[4:7], 0 offen offset:768 sc1
    buffer_load_dwordx4 v[76:79], v248, s[4:7], 0 offen offset:960 sc1
    buffer_load_dwordx4 v[80:83], v248, s[4:7], 0 offen offset:1152 sc1
    buffer_load_dwordx4 v[84:87], v248, s[4:7], 0 offen offset:1344 sc1
    buffer_load_dwordx4 v[88:91], v248, s[4:7], 0 offen offset:1536 sc1
    buffer_load_dwordx4 v[92:95], v248, s[4:7], 0 offen offset:1728 sc1
    buffer_load_dwordx4 v[96:99], v248, s[4:7], 0 offen offset:1920 sc1
    buffer_load_dwordx4 v[100:103], v248, s[4:7], 0 offen offset:2112 sc1
    buffer_load_dwordx4 v[104:107], v248, s[4:7], 0 offen offset:2304 sc1
    buffer_load_dwordx4 v[108:111], v248, s[4:7], 0 offen offset:2496 sc1
    buffer_load_dwordx4 v[112:115], v248, s[4:7], 0 offen offset:2688 sc1
    buffer_load_dwordx4 v[116:119], v248, s[4:7], 0 offen offset:2880 sc1
    buffer_load_dwordx4 v[120:123], v248, s[4:7], 0 offen offset:3072 sc1
    buffer_load_dwordx4 v[124:127], v248, s[4:7], 0 offen offset:3264 sc1
    buffer_load_dwordx4 v[128:131], v248, s[4:7], 0 offen offset:3456 sc1
    buffer_load_dwordx4 v[132:135], v248, s[4:7], 0 offen offset:3648 sc1
    buffer_load_dwordx4 v[136:139], v248, s[4:7], s82 offen offset:0 sc1
    buffer_load_dwordx4 v[140:143], v248, s[4:7], s82 offen offset:192 sc1
    buffer_load_dwordx4 v[144:147], v248, s[4:7], s82 offen offset:384 sc1
    buffer_load_dwordx4 v[148:151], v248, s[4:7], s82 offen offset:576 sc1
    buffer_load_dwordx4 v[152:155], v248, s[4:7], s82 offen offset:768 sc1
    buffer_load_dwordx4 v[156:159], v248, s[4:7], s82 offen offset:960 sc1
    buffer_load_dwordx4 v[160:163], v248, s[4:7], s82 offen offset:1152 sc1
    buffer_load_dwordx4 v[164:167], v248, s[4:7], s82 offen offset:1344 sc1
    buffer_load_dwordx4 v[168:171], v248, s[4:7], s82 offen offset:1536 sc1
    buffer_load_dwordx4 v[172:175], v248, s[4:7], s82 offen offset:1728 sc1
    buffer_load_dwordx4 v[176:179], v248, s[4:7], s82 offen offset:1920 sc1
    buffer_load_dwordx4 v[180:183], v248, s[4:7], s82 offen offset:2112 sc1
    buffer_load_dwordx4 v[184:187], v248, s[4:7], s81 offen offset:2304 sc1
    buffer_load_dwordx4 v[188:191], v248, s[4:7], s81 offen offset:2496 sc1

    v_mov_b32 v254, 161972
    v_mov_b32 v255, 1
    ds_write_b32 v254, v255
    s_waitcnt vmcnt(36)
    ds_write_b32 v254, v255 offset:12

L_pb:
    s_mov_b32 s20, 0x05040100
    s_mov_b32 s21, 0x07060302
    s_lshr_b32 s26, s2, 3
    s_mul_i32 s27, s26, 43
    s_lshr_b32 s27, s27, 9
    s_mul_i32 s27, s27, 12
    s_sub_u32 s39, s26, s27
    v_bfe_u32 v1, v0, 3, 1
    v_lshrrev_b32 v2, 5, v0
    v_bfe_u32 v3, v0, 4, 1
    v_bfe_u32 v4, v0, 2, 1
    v_sub_u32 v3, v3, v4
    v_and_b32 v4, 3, v0
    v_mul_u32_u24 v5, 65440, v1
    v_lshl_add_u32 v5, v4, 4, v5
    v_add_u32 v5, 50176, v5
    v_cmp_eq_u32 s[56:57], v1, v2
    v_add_u32 v6, 0, v3
    v_cmp_gt_u32 vcc, 5, v6
    v_lshl_add_u32 v7, v6, 6, v5
    s_and_b64 vcc, vcc, s[56:57]
    v_cndmask_b32 v241, v10, v7, vcc
    v_add_u32 v6, 2, v3
    v_lshl_add_u32 v7, v6, 6, v5
    v_cndmask_b32 v242, v10, v7, s[56:57]
    v_add_u32 v6, 4, v3
    v_cmp_gt_u32 vcc, 5, v6
    v_lshl_add_u32 v7, v6, 6, v5
    s_and_b64 vcc, vcc, s[56:57]
    v_cndmask_b32 v243, v10, v7, vcc
    v_mul_u32_u24 v2, 1168, v2
    v_and_b32 v3, 7, v0
    v_lshl_add_u32 v250, v3, 3, v2
    v_mul_u32_u24 v3, 768, v3
    v_mul_u32_u24 v4, 196608, v1
    v_add_u32 v3, v3, v4
    v_lshrrev_b32 v4, 4, v0
    v_lshl_add_u32 v252, v4, 4, v3

    v_bfe_u32 v3, v0, 4, 1
    v_mul_u32_u24 v3, 7104, v3
    v_add_u32 v250, v250, v3
    v_cmp_eq_u32 s[56:57], 1, v1
    v_and_b32 v5, 1, v12
    v_mul_u32_u24 v5, 7104, v5
    v_mul_u32_u24 v6, 584, v13
    v_add_u32 v249, v5, v6
    s_lshl_b32 s26, s16, 2
    s_add_u32 s26, s26, s23
    s_lshl_b32 s26, s26, 9
    s_add_u32 s26, s26, s22
    s_mul_i32 s36, s26, 192
    s_add_u32 s37, s36, 98304
    s_add_u32 s24, s36, 384
    s_add_u32 s25, s24, 98304
    s_cmp_lt_u32 s16, 1
    s_cbranch_scc1 L_perm
    s_cmp_lt_u32 s16, 4
    s_cbranch_scc1 L_xload

    v_mov_b32 v254, 161984

    s_mov_b32 s29, 200000
L_wraw:
    ds_read_b32 v255, v254
    s_waitcnt lgkmcnt(0)
    v_cmp_eq_u32 vcc, 1, v255
    s_cmp_eq_u64 vcc, exec
    s_cbranch_scc1 L_wraw_ok
    s_sleep 2
    s_sub_u32 s29, s29, 1
    s_cmp_lg_u32 s29, 0
    s_cbranch_scc1 L_wraw
L_wraw_ok:

    v_add_u32 v1, 0, v15
    v_mul_u32_u24 v128, 683, v1
    v_lshrrev_b32 v128, 16, v128
    v_mul_u32_u24 v129, 96, v128
    v_sub_u32 v129, v1, v129
    v_mul_u32_u24 v2, 960, v128
    v_lshl_add_u32 v2, v129, 1, v2
    v_add_u32 v1, -1, v128
    v_mul_u32_u24 v3, 576, v1
    v_lshl_add_u32 v3, v129, 1, v3
    v_cmp_gt_u32 vcc, 3, v1
    s_nop 1
    v_cndmask_b32 v3, v10, v3, vcc

    ds_read_u16 v132, v2 offset:21504
    ds_read_u16 v133, v2 offset:21696
    ds_read_u16 v134, v2 offset:21888
    ds_read_u16 v135, v2 offset:22080
    ds_read_u16 v136, v2 offset:22272
    ds_read_u16 v137, v3 offset:26624
    ds_read_u16 v138, v3 offset:26816
    ds_read_u16 v139, v3 offset:27008

    v_add_u32 v1, 256, v15
    v_mul_u32_u24 v144, 683, v1
    v_lshrrev_b32 v144, 16, v144
    v_mul_u32_u24 v145, 96, v144
    v_sub_u32 v145, v1, v145
    v_mul_u32_u24 v2, 960, v144
    v_lshl_add_u32 v2, v145, 1, v2
    v_add_u32 v1, -1, v144
    v_mul_u32_u24 v3, 576, v1
    v_lshl_add_u32 v3, v145, 1, v3
    v_cmp_gt_u32 vcc, 3, v1
    s_nop 1
    v_cndmask_b32 v3, v10, v3, vcc

    ds_read_u16 v148, v2 offset:21504
    ds_read_u16 v149, v2 offset:21696
    ds_read_u16 v150, v2 offset:21888
    ds_read_u16 v151, v2 offset:22080
    ds_read_u16 v152, v2 offset:22272
    ds_read_u16 v153, v3 offset:26624
    ds_read_u16 v154, v3 offset:26816
    ds_read_u16 v155, v3 offset:27008
    s_waitcnt lgkmcnt(0)
    v_lshlrev_b32 v132, 16, v132
    v_lshlrev_b32 v133, 16, v133
    v_lshlrev_b32 v134, 16, v134
    v_lshlrev_b32 v135, 16, v135
    v_lshlrev_b32 v136, 16, v136
    v_lshlrev_b32 v137, 16, v137
    v_lshlrev_b32 v138, 16, v138
    v_lshlrev_b32 v139, 16, v139

    v_add_f32 v133, v133, v137
    v_add_f32 v134, v134, v138
    v_add_f32 v135, v135, v139
    v_mov_b32 v1, 0
    v_cvt_pk_bf16_f32 v160, v132, v133
    v_cvt_pk_bf16_f32 v161, v134, v135
    v_cvt_pk_bf16_f32 v162, v136, v1
    v_mov_b32 v163, 0
    v_cvt_pk_bf16_f32 v164, v1, v132
    v_cvt_pk_bf16_f32 v165, v133, v134
    v_cvt_pk_bf16_f32 v166, v135, v136
    v_mov_b32 v167, 0
    v_mov_b32 v168, 0
    v_mov_b32 v169, v160
    v_mov_b32 v170, v161
    v_mov_b32 v171, v162
    v_mov_b32 v172, 0
    v_mov_b32 v173, v164
    v_mov_b32 v174, v165
    v_mov_b32 v175, v166
    v_lshrrev_b32 v2, 5, v129
    v_and_b32 v3, 15, v129
    v_lshl_add_u32 v2, v2, 4, v3
    v_mul_u32_u24 v2, 320, v2
    v_bfe_u32 v3, v129, 4, 1
    v_mul_u32_u24 v3, 65440, v3
    v_add_u32 v2, v2, v3
    v_lshl_add_u32 v2, v128, 6, v2
    v_add_u32 v2, 50176, v2
    v_cmp_gt_u32 vcc, 5, v128
    s_nop 1
    v_cndmask_b32 v2, v10, v2, vcc
    ds_write_b128 v2, v[160:163]
    ds_write_b128 v2, v[164:167] offset:16
    ds_write_b128 v2, v[168:171] offset:32
    ds_write_b128 v2, v[172:175] offset:48

    v_lshlrev_b32 v148, 16, v148
    v_lshlrev_b32 v149, 16, v149
    v_lshlrev_b32 v150, 16, v150
    v_lshlrev_b32 v151, 16, v151
    v_lshlrev_b32 v152, 16, v152
    v_lshlrev_b32 v153, 16, v153
    v_lshlrev_b32 v154, 16, v154
    v_lshlrev_b32 v155, 16, v155

    v_add_f32 v149, v149, v153
    v_add_f32 v150, v150, v154
    v_add_f32 v151, v151, v155
    v_mov_b32 v1, 0
    v_cvt_pk_bf16_f32 v176, v148, v149
    v_cvt_pk_bf16_f32 v177, v150, v151
    v_cvt_pk_bf16_f32 v178, v152, v1
    v_mov_b32 v179, 0
    v_cvt_pk_bf16_f32 v180, v1, v148
    v_cvt_pk_bf16_f32 v181, v149, v150
    v_cvt_pk_bf16_f32 v182, v151, v152
    v_mov_b32 v183, 0
    v_mov_b32 v184, 0
    v_mov_b32 v185, v176
    v_mov_b32 v186, v177
    v_mov_b32 v187, v178
    v_mov_b32 v188, 0
    v_mov_b32 v189, v180
    v_mov_b32 v190, v181
    v_mov_b32 v191, v182
    v_lshrrev_b32 v2, 5, v145
    v_and_b32 v3, 15, v145
    v_lshl_add_u32 v2, v2, 4, v3
    v_mul_u32_u24 v2, 320, v2
    v_bfe_u32 v3, v145, 4, 1
    v_mul_u32_u24 v3, 65440, v3
    v_add_u32 v2, v2, v3
    v_lshl_add_u32 v2, v144, 6, v2
    v_add_u32 v2, 50176, v2
    v_cmp_gt_u32 vcc, 5, v144
    s_nop 1
    v_cndmask_b32 v2, v10, v2, vcc
    ds_write_b128 v2, v[176:179]
    ds_write_b128 v2, v[180:183] offset:16
    ds_write_b128 v2, v[184:187] offset:32
    ds_write_b128 v2, v[188:191] offset:48

    v_mov_b32 v254, 161968
    v_mov_b32 v255, 1
    s_waitcnt lgkmcnt(0)
    s_mov_b64 exec, 1
    ds_add_u32 v254, v255
    s_mov_b64 exec, -1

    s_cmp_lt_u32 s16, 6
    s_cbranch_scc1 L_xload
L_tab:
    v_add_u32 v1, -384, v14
    v_lshlrev_b32 v2, 2, v1
    v_add_u32 v3, 65536, v2
    v_lshlrev_b32 v4, 17, v1
    v_or_b32 v4, 0x8000, v4
    v_cmp_gt_u32 vcc, 64, v1
    v_mov_b32 v5, 931135488
    v_mov_b32 v6, 939524096
    v_cndmask_b32 v5, v5, v6, vcc
    v_cndmask_b32 v6, 0, v6, vcc
    v_add_u32 v4, v4, v5
    s_mov_b32 s26, 0x3dd2d3e8
    v_mov_b32 v7, 0x40135761
    s_mov_b32 s27, 14
L_tabl:
    v_add_u32 v9, 0x10000, v4
    v_sub_f32 v8, v4, v6
    v_sub_f32 v9, v9, v6
    v_mul_f32 v10, v8, v8
    v_mul_f32 v11, v9, v9
    v_fma_f32 v10, v10, s26, v7
    v_fma_f32 v11, v11, s26, v7
    v_mul_f32 v10, v10, v8
    v_mul_f32 v11, v11, v9
    v_exp_f32 v10, -v10
    v_exp_f32 v11, -v11
    s_nop 0
    v_add_f32 v12, 1.0, v10
    v_add_f32 v13, 1.0, v11
    v_rcp_f32 v12, v12
    v_rcp_f32 v13, v13
    s_nop 0
    v_mul_f32 v8, v8, v12
    v_mul_f32 v9, v9, v13
    v_mul_f32 v10, -v8, v10
    v_mul_f32 v11, -v9, v11
    v_cvt_pk_bf16_f32 v12, v8, v9
    v_cvt_pk_bf16_f32 v13, v10, v11
    ds_write_b32 v2, v12
    ds_write_b32 v3, v13
    v_sub_u32 v4, v4, v5
    v_mov_b32 v5, 931135488
    v_mov_b32 v6, 0
    v_add_u32 v4, v4, v5
    v_add_u32 v4, 0x1000000, v4
    v_add_u32 v2, 512, v2
    v_add_u32 v3, 512, v3
    s_sub_u32 s27, s27, 1
    s_cmp_lg_u32 s27, 0
    s_cbranch_scc1 L_tabl

    v_mov_b32 v254, 161980
    v_mov_b32 v255, 1
    s_waitcnt lgkmcnt(0)
    s_mov_b64 exec, 1
    ds_add_u32 v254, v255
    s_mov_b64 exec, -1

L_xload:
    v_mov_b32 v254, 161972

    s_mov_b32 s29, 200000
L_wiss:
    ds_read_b32 v255, v254
    s_waitcnt lgkmcnt(0)
    v_cmp_eq_u32 vcc, s18, v255
    s_cmp_eq_u64 vcc, exec
    s_cbranch_scc1 L_wiss_ok
    s_sleep 2
    s_sub_u32 s29, s29, 1
    s_cmp_lg_u32 s29, 0
    s_cbranch_scc1 L_wiss
L_wiss_ok:

    s_cmp_lg_u32 s18, 5
    s_cbranch_scc1 L_nocpb

    s_getpc_b64 s[96:97]
L_pcb:
    s_add_u32 s96, s96, L_loader-L_pcb
    s_addc_u32 s97, s97, 0
    v_lshlrev_b32 v20, 3, v253
    v_mov_b32 v23, s97

    v_add_u32 v21, 0, v20
    v_min_u32 v21, L_end-L_loader, v21
    v_add_co_u32 v24, vcc, s96, v21
    s_nop 1
    v_addc_co_u32 v25, vcc, 0, v23, vcc
    global_load_dword v22, v[24:25], off sc1

    v_add_u32 v21, 8192, v20
    v_min_u32 v21, L_end-L_loader, v21
    v_add_co_u32 v26, vcc, s96, v21
    s_nop 1
    v_addc_co_u32 v27, vcc, 0, v23, vcc
    global_load_dword v22, v[26:27], off sc1

L_nocpb:

    s_lshl_b32 s26, s18, 2
    s_add_u32 s26, s26, s23
    s_lshl_b32 s27, s26, 9
    s_add_u32 s27, s27, s22
    s_mul_i32 s27, s27, 192
    s_cmp_lt_u32 s26, 2
    s_cselect_b64 vcc, s[58:59], 0
    v_mov_b32 v248, 1073741824
    s_sub_u32 s28, s27, 196608
    v_add_u32 v255, s28, v247
    v_cndmask_b32 v248, v255, v248, vcc
    v_add_u32 v255, -384, v248

    buffer_load_dwordx4 v[48:51], v255, s[4:7], s80 offen offset:0 sc1
    buffer_load_dwordx4 v[52:55], v255, s[4:7], s80 offen offset:192 sc1
    buffer_load_dwordx4 v[56:59], v248, s[4:7], 0 offen offset:0 sc1
    buffer_load_dwordx4 v[60:63], v248, s[4:7], 0 offen offset:192 sc1
    buffer_load_dwordx4 v[64:67], v248, s[4:7], 0 offen offset:384 sc1
    buffer_load_dwordx4 v[68:71], v248, s[4:7], 0 offen offset:576 sc1
    buffer_load_dwordx4 v[72:75], v248, s[4:7], 0 offen offset:768 sc1
    buffer_load_dwordx4 v[76:79], v248, s[4:7], 0 offen offset:960 sc1
    buffer_load_dwordx4 v[80:83], v248, s[4:7], 0 offen offset:1152 sc1
    buffer_load_dwordx4 v[84:87], v248, s[4:7], 0 offen offset:1344 sc1
    buffer_load_dwordx4 v[88:91], v248, s[4:7], 0 offen offset:1536 sc1
    buffer_load_dwordx4 v[92:95], v248, s[4:7], 0 offen offset:1728 sc1
    buffer_load_dwordx4 v[96:99], v248, s[4:7], 0 offen offset:1920 sc1
    buffer_load_dwordx4 v[100:103], v248, s[4:7], 0 offen offset:2112 sc1
    buffer_load_dwordx4 v[104:107], v248, s[4:7], 0 offen offset:2304 sc1
    buffer_load_dwordx4 v[108:111], v248, s[4:7], 0 offen offset:2496 sc1
    buffer_load_dwordx4 v[112:115], v248, s[4:7], 0 offen offset:2688 sc1
    buffer_load_dwordx4 v[116:119], v248, s[4:7], 0 offen offset:2880 sc1
    buffer_load_dwordx4 v[120:123], v248, s[4:7], 0 offen offset:3072 sc1
    buffer_load_dwordx4 v[124:127], v248, s[4:7], 0 offen offset:3264 sc1
    buffer_load_dwordx4 v[128:131], v248, s[4:7], 0 offen offset:3456 sc1
    buffer_load_dwordx4 v[132:135], v248, s[4:7], 0 offen offset:3648 sc1
    buffer_load_dwordx4 v[136:139], v248, s[4:7], s82 offen offset:0 sc1
    buffer_load_dwordx4 v[140:143], v248, s[4:7], s82 offen offset:192 sc1
    buffer_load_dwordx4 v[144:147], v248, s[4:7], s82 offen offset:384 sc1
    buffer_load_dwordx4 v[148:151], v248, s[4:7], s82 offen offset:576 sc1
    buffer_load_dwordx4 v[152:155], v248, s[4:7], s82 offen offset:768 sc1
    buffer_load_dwordx4 v[156:159], v248, s[4:7], s82 offen offset:960 sc1
    buffer_load_dwordx4 v[160:163], v248, s[4:7], s82 offen offset:1152 sc1
    buffer_load_dwordx4 v[164:167], v248, s[4:7], s82 offen offset:1344 sc1
    buffer_load_dwordx4 v[168:171], v248, s[4:7], s82 offen offset:1536 sc1
    buffer_load_dwordx4 v[172:175], v248, s[4:7], s82 offen offset:1728 sc1
    buffer_load_dwordx4 v[176:179], v248, s[4:7], s82 offen offset:1920 sc1
    buffer_load_dwordx4 v[180:183], v248, s[4:7], s82 offen offset:2112 sc1
    buffer_load_dwordx4 v[184:187], v248, s[4:7], s81 offen offset:2304 sc1
    buffer_load_dwordx4 v[188:191], v248, s[4:7], s81 offen offset:2496 sc1

    s_add_u32 s26, s18, 1
    v_mov_b32 v255, s26
    ds_write_b32 v254, v255

L_perm:
    s_mov_b32 exec_hi, 0x0000ffff
    s_waitcnt vmcnt(32)
    v_perm_b32 v192, v52, v48, s20
    v_perm_b32 v193, v60, v56, s20
    v_perm_b32 v194, v52, v48, s21
    v_perm_b32 v195, v60, v56, s21
    v_perm_b32 v196, v53, v49, s20
    v_perm_b32 v197, v61, v57, s20
    v_perm_b32 v198, v53, v49, s21
    v_perm_b32 v199, v61, v57, s21
    v_perm_b32 v200, v54, v50, s20
    v_perm_b32 v201, v62, v58, s20
    v_perm_b32 v202, v54, v50, s21
    v_perm_b32 v203, v62, v58, s21
    v_perm_b32 v204, v55, v51, s20
    v_perm_b32 v205, v63, v59, s20
    v_perm_b32 v206, v55, v51, s21
    v_perm_b32 v207, v63, v59, s21
    s_waitcnt vmcnt(28)
    v_perm_b32 v48, v68, v64, s20
    v_perm_b32 v49, v76, v72, s20
    v_perm_b32 v50, v68, v64, s21
    v_perm_b32 v51, v76, v72, s21
    v_perm_b32 v52, v69, v65, s20
    v_perm_b32 v53, v77, v73, s20
    v_perm_b32 v54, v69, v65, s21
    v_perm_b32 v55, v77, v73, s21
    v_perm_b32 v56, v70, v66, s20
    v_perm_b32 v57, v78, v74, s20
    v_perm_b32 v58, v70, v66, s21
    v_perm_b32 v59, v78, v74, s21
    v_perm_b32 v60, v71, v67, s20
    v_perm_b32 v61, v79, v75, s20
    v_perm_b32 v62, v71, v67, s21
    v_perm_b32 v63, v79, v75, s21
    s_waitcnt vmcnt(24)
    v_perm_b32 v64, v84, v80, s20
    v_perm_b32 v65, v92, v88, s20
    v_perm_b32 v66, v84, v80, s21
    v_perm_b32 v67, v92, v88, s21
    v_perm_b32 v68, v85, v81, s20
    v_perm_b32 v69, v93, v89, s20
    v_perm_b32 v70, v85, v81, s21
    v_perm_b32 v71, v93, v89, s21
    v_perm_b32 v72, v86, v82, s20
    v_perm_b32 v73, v94, v90, s20
    v_perm_b32 v74, v86, v82, s21
    v_perm_b32 v75, v94, v90, s21
    v_perm_b32 v76, v87, v83, s20
    v_perm_b32 v77, v95, v91, s20
    v_perm_b32 v78, v87, v83, s21
    v_perm_b32 v79, v95, v91, s21
    s_waitcnt vmcnt(20)
    v_perm_b32 v80, v100, v96, s20
    v_perm_b32 v81, v108, v104, s20
    v_perm_b32 v82, v100, v96, s21
    v_perm_b32 v83, v108, v104, s21
    v_perm_b32 v84, v101, v97, s20
    v_perm_b32 v85, v109, v105, s20
    v_perm_b32 v86, v101, v97, s21
    v_perm_b32 v87, v109, v105, s21
    v_perm_b32 v88, v102, v98, s20
    v_perm_b32 v89, v110, v106, s20
    v_perm_b32 v90, v102, v98, s21
    v_perm_b32 v91, v110, v106, s21
    v_perm_b32 v92, v103, v99, s20
    v_perm_b32 v93, v111, v107, s20
    v_perm_b32 v94, v103, v99, s21
    v_perm_b32 v95, v111, v107, s21
    s_waitcnt vmcnt(16)
    v_perm_b32 v96, v116, v112, s20
    v_perm_b32 v97, v124, v120, s20
    v_perm_b32 v98, v116, v112, s21
    v_perm_b32 v99, v124, v120, s21
    v_perm_b32 v100, v117, v113, s20
    v_perm_b32 v101, v125, v121, s20
    v_perm_b32 v102, v117, v113, s21
    v_perm_b32 v103, v125, v121, s21
    v_perm_b32 v104, v118, v114, s20
    v_perm_b32 v105, v126, v122, s20
    v_perm_b32 v106, v118, v114, s21
    v_perm_b32 v107, v126, v122, s21
    v_perm_b32 v108, v119, v115, s20
    v_perm_b32 v109, v127, v123, s20
    v_perm_b32 v110, v119, v115, s21
    v_perm_b32 v111, v127, v123, s21
    s_waitcnt vmcnt(12)
    v_perm_b32 v112, v132, v128, s20
    v_perm_b32 v113, v140, v136, s20
    v_perm_b32 v114, v132, v128, s21
    v_perm_b32 v115, v140, v136, s21
    v_perm_b32 v116, v133, v129, s20
    v_perm_b32 v117, v141, v137, s20
    v_perm_b32 v118, v133, v129, s21
    v_perm_b32 v119, v141, v137, s21
    v_perm_b32 v120, v134, v130, s20
    v_perm_b32 v121, v142, v138, s20
    v_perm_b32 v122, v134, v130, s21
    v_perm_b32 v123, v142, v138, s21
    v_perm_b32 v124, v135, v131, s20
    v_perm_b32 v125, v143, v139, s20
    v_perm_b32 v126, v135, v131, s21
    v_perm_b32 v127, v143, v139, s21
    s_waitcnt vmcnt(8)
    v_perm_b32 v128, v148, v144, s20
    v_perm_b32 v129, v156, v152, s20
    v_perm_b32 v130, v148, v144, s21
    v_perm_b32 v131, v156, v152, s21
    v_perm_b32 v132, v149, v145, s20
    v_perm_b32 v133, v157, v153, s20
    v_perm_b32 v134, v149, v145, s21
    v_perm_b32 v135, v157, v153, s21
    v_perm_b32 v136, v150, v146, s20
    v_perm_b32 v137, v158, v154, s20
    v_perm_b32 v138, v150, v146, s21
    v_perm_b32 v139, v158, v154, s21
    v_perm_b32 v140, v151, v147, s20
    v_perm_b32 v141, v159, v155, s20
    v_perm_b32 v142, v151, v147, s21
    v_perm_b32 v143, v159, v155, s21
    s_waitcnt vmcnt(4)
    v_perm_b32 v144, v164, v160, s20
    v_perm_b32 v145, v172, v168, s20
    v_perm_b32 v146, v164, v160, s21
    v_perm_b32 v147, v172, v168, s21
    v_perm_b32 v148, v165, v161, s20
    v_perm_b32 v149, v173, v169, s20
    v_perm_b32 v150, v165, v161, s21
    v_perm_b32 v151, v173, v169, s21
    v_perm_b32 v152, v166, v162, s20
    v_perm_b32 v153, v174, v170, s20
    v_perm_b32 v154, v166, v162, s21
    v_perm_b32 v155, v174, v170, s21
    v_perm_b32 v156, v167, v163, s20
    v_perm_b32 v157, v175, v171, s20
    v_perm_b32 v158, v167, v163, s21
    v_perm_b32 v159, v175, v171, s21
    s_waitcnt vmcnt(0)
    v_perm_b32 v160, v180, v176, s20
    v_perm_b32 v161, v188, v184, s20
    v_perm_b32 v162, v180, v176, s21
    v_perm_b32 v163, v188, v184, s21
    v_perm_b32 v164, v181, v177, s20
    v_perm_b32 v165, v189, v185, s20
    v_perm_b32 v166, v181, v177, s21
    v_perm_b32 v167, v189, v185, s21
    v_perm_b32 v168, v182, v178, s20
    v_perm_b32 v169, v190, v186, s20
    v_perm_b32 v170, v182, v178, s21
    v_perm_b32 v171, v190, v186, s21
    v_perm_b32 v172, v183, v179, s20
    v_perm_b32 v173, v191, v187, s20
    v_perm_b32 v174, v183, v179, s21
    v_perm_b32 v175, v191, v187, s21
    s_mov_b32 exec_hi, -1
    s_cmp_lg_u32 s18, 3
    s_cbranch_scc1 L_wt3_ok
    v_mov_b32 v254, 161968

    s_mov_b32 s29, 200000
L_wt3:
    ds_read_b32 v255, v254
    s_waitcnt lgkmcnt(0)
    v_cmp_eq_u32 vcc, 4, v255
    s_cmp_eq_u64 vcc, exec
    s_cbranch_scc1 L_wt3_ok
    s_sleep 2
    s_sub_u32 s29, s29, 1
    s_cmp_lg_u32 s29, 0
    s_cbranch_scc1 L_wt3
L_wt3_ok:

    s_lshl_b32 s26, s18, 3
    s_add_u32 s26, s26, 161852

    v_add_u32 v254, s26, v240

    s_mov_b32 s29, 200000
L_wslot:
    ds_read_b32 v255, v254
    s_waitcnt lgkmcnt(0)
    v_cmp_ne_u32 vcc, 0, v255
    s_cmp_eq_u64 vcc, exec
    s_cbranch_scc1 L_wslot_ok
    s_sleep 2
    s_sub_u32 s29, s29, 1
    s_cmp_lg_u32 s29, 0
    s_cbranch_scc1 L_wslot
L_wslot_ok:

    s_add_u32 s30, s18, 2
    s_and_b32 s30, s30, 3
    s_cmp_eq_u32 s30, 3
    s_mul_i32 s30, s30, 14336
    s_cselect_b32 s31, 72704, s30
    s_cselect_b32 s30, 124160, s30
    s_add_u32 s30, s30, 7168
    s_add_u32 s31, s31, 72832

    v_add_u32 v254, s30, v249
    v_add_u32 v255, s31, v249
    v_cndmask_b32 v254, v255, v254, s[58:59]
    s_mov_b32 exec_hi, 0x0000ffff

    ds_write_b64 v254, v[192:193] offset:0
    ds_write_b64 v254, v[194:195] offset:72
    ds_write_b64 v254, v[196:197] offset:144
    ds_write_b64 v254, v[198:199] offset:216
    ds_write_b64 v254, v[200:201] offset:288
    ds_write_b64 v254, v[202:203] offset:360
    ds_write_b64 v254, v[204:205] offset:432
    ds_write_b64 v254, v[206:207] offset:504
    ds_write_b64 v254, v[48:49] offset:8
    ds_write_b64 v254, v[50:51] offset:80
    ds_write_b64 v254, v[52:53] offset:152
    ds_write_b64 v254, v[54:55] offset:224
    ds_write_b64 v254, v[56:57] offset:296
    ds_write_b64 v254, v[58:59] offset:368
    ds_write_b64 v254, v[60:61] offset:440
    ds_write_b64 v254, v[62:63] offset:512
    ds_write_b64 v254, v[64:65] offset:16
    ds_write_b64 v254, v[66:67] offset:88
    ds_write_b64 v254, v[68:69] offset:160
    ds_write_b64 v254, v[70:71] offset:232
    ds_write_b64 v254, v[72:73] offset:304
    ds_write_b64 v254, v[74:75] offset:376
    ds_write_b64 v254, v[76:77] offset:448
    ds_write_b64 v254, v[78:79] offset:520
    ds_write_b64 v254, v[80:81] offset:24
    ds_write_b64 v254, v[82:83] offset:96
    ds_write_b64 v254, v[84:85] offset:168
    ds_write_b64 v254, v[86:87] offset:240
    ds_write_b64 v254, v[88:89] offset:312
    ds_write_b64 v254, v[90:91] offset:384
    ds_write_b64 v254, v[92:93] offset:456
    ds_write_b64 v254, v[94:95] offset:528
    ds_write_b64 v254, v[96:97] offset:32
    ds_write_b64 v254, v[98:99] offset:104
    ds_write_b64 v254, v[100:101] offset:176
    ds_write_b64 v254, v[102:103] offset:248
    ds_write_b64 v254, v[104:105] offset:320
    ds_write_b64 v254, v[106:107] offset:392
    ds_write_b64 v254, v[108:109] offset:464
    ds_write_b64 v254, v[110:111] offset:536
    ds_write_b64 v254, v[112:113] offset:40
    ds_write_b64 v254, v[114:115] offset:112
    ds_write_b64 v254, v[116:117] offset:184
    ds_write_b64 v254, v[118:119] offset:256
    ds_write_b64 v254, v[120:121] offset:328
    ds_write_b64 v254, v[122:123] offset:400
    ds_write_b64 v254, v[124:125] offset:472
    ds_write_b64 v254, v[126:127] offset:544
    ds_write_b64 v254, v[128:129] offset:48
    ds_write_b64 v254, v[130:131] offset:120
    ds_write_b64 v254, v[132:133] offset:192
    ds_write_b64 v254, v[134:135] offset:264
    ds_write_b64 v254, v[136:137] offset:336
    ds_write_b64 v254, v[138:139] offset:408
    ds_write_b64 v254, v[140:141] offset:480
    ds_write_b64 v254, v[142:143] offset:552
    ds_write_b64 v254, v[144:145] offset:56
    ds_write_b64 v254, v[146:147] offset:128
    ds_write_b64 v254, v[148:149] offset:200
    ds_write_b64 v254, v[150:151] offset:272
    ds_write_b64 v254, v[152:153] offset:344
    ds_write_b64 v254, v[154:155] offset:416
    ds_write_b64 v254, v[156:157] offset:488
    ds_write_b64 v254, v[158:159] offset:560
    ds_write_b64 v254, v[160:161] offset:64
    ds_write_b64 v254, v[162:163] offset:136
    ds_write_b64 v254, v[164:165] offset:208
    ds_write_b64 v254, v[166:167] offset:280
    ds_write_b64 v254, v[168:169] offset:352
    ds_write_b64 v254, v[170:171] offset:424
    ds_write_b64 v254, v[172:173] offset:496
    ds_write_b64 v254, v[174:175] offset:568

    s_mov_b32 exec_hi, -1
    s_lshl_b32 s26, s18, 2
    s_add_u32 s26, s26, 161808
    v_mov_b32 v254, s26
    v_mov_b32 v255, 1
    s_waitcnt lgkmcnt(0)
    ds_write_b32 v254, v255
    s_cmp_eq_u32 s18, 8
    s_cbranch_scc1 L_loader

    s_setprio 2
    s_add_u32 s27, s18, 1

    s_add_u32 s32, s27, 2
    s_and_b32 s32, s32, 3
    s_cmp_eq_u32 s32, 3
    s_mul_i32 s32, s32, 14336
    s_cselect_b32 s33, 72704, s32
    s_cselect_b32 s32, 124160, s32
    s_add_u32 s32, s32, 7168
    s_add_u32 s33, s33, 72832

    v_add_u32 v232, s30, v250
    v_add_u32 v233, s31, v250
    v_add_u32 v234, s32, v250
    v_add_u32 v235, s33, v250
    v_cndmask_b32 v244, v232, v233, s[56:57]
    v_cndmask_b32 v245, v233, v234, s[56:57]
    v_cndmask_b32 v246, v234, v235, s[56:57]
    v_mov_b32 v254, 161968

    s_mov_b32 s29, 200000
L_wt:
    ds_read_b32 v255, v254
    s_waitcnt lgkmcnt(0)
    v_cmp_eq_u32 vcc, 4, v255
    s_cmp_eq_u64 vcc, exec
    s_cbranch_scc1 L_wt_ok
    s_sleep 2
    s_sub_u32 s29, s29, 1
    s_cmp_lg_u32 s29, 0
    s_cbranch_scc1 L_wt
L_wt_ok:

    ds_read_b128 v[192:195], v241 offset:0
    ds_read_b64 v[212:213], v244 offset:0
    ds_read_b64 v[214:215], v244 offset:8
    ds_read_b128 v[196:199], v241 offset:320
    ds_read_b64 v[216:217], v244 offset:72
    ds_read_b64 v[218:219], v244 offset:80
    ds_read_b128 v[200:203], v241 offset:640
    ds_read_b64 v[220:221], v244 offset:144
    ds_read_b64 v[222:223], v244 offset:152
    ds_read_b128 v[204:207], v241 offset:960
    ds_read_b64 v[224:225], v244 offset:216
    ds_read_b64 v[226:227], v244 offset:224
    ds_read_b128 v[208:211], v241 offset:1280
    ds_read_b64 v[228:229], v244 offset:288
    ds_read_b64 v[230:231], v244 offset:296
    s_waitcnt lgkmcnt(9)
    v_mfma_f32_16x16x32_bf16 v[0:3], v[192:195], v[212:215], 0
    ds_read_b128 v[192:195], v241 offset:1600
    ds_read_b64 v[212:213], v244 offset:360
    ds_read_b64 v[214:215], v244 offset:368
    v_mfma_f32_16x16x32_bf16 v[4:7], v[196:199], v[216:219], 0
    ds_read_b128 v[196:199], v241 offset:1920
    ds_read_b64 v[216:217], v244 offset:432
    ds_read_b64 v[218:219], v244 offset:440
    s_waitcnt lgkmcnt(9)
    v_mfma_f32_16x16x32_bf16 v[8:11], v[200:203], v[220:223], 0
    ds_read_b128 v[200:203], v241 offset:2240
    ds_read_b64 v[220:221], v244 offset:504
    ds_read_b64 v[222:223], v244 offset:512
    v_mfma_f32_16x16x32_bf16 v[12:15], v[204:207], v[224:227], 0
    ds_read_b128 v[204:207], v241 offset:2560
    ds_read_b64 v[224:225], v244 offset:584
    ds_read_b64 v[226:227], v244 offset:592
    s_waitcnt lgkmcnt(9)
    v_mfma_f32_16x16x32_bf16 v[16:19], v[208:211], v[228:231], 0
    ds_read_b128 v[208:211], v241 offset:2880
    ds_read_b64 v[228:229], v244 offset:656
    ds_read_b64 v[230:231], v244 offset:664
    v_mfma_f32_16x16x32_bf16 v[20:23], v[192:195], v[212:215], 0
    ds_read_b128 v[192:195], v241 offset:3200
    ds_read_b64 v[212:213], v244 offset:728
    ds_read_b64 v[214:215], v244 offset:736
    s_waitcnt lgkmcnt(9)
    v_mfma_f32_16x16x32_bf16 v[24:27], v[196:199], v[216:219], 0
    ds_read_b128 v[196:199], v241 offset:3520
    ds_read_b64 v[216:217], v244 offset:800
    ds_read_b64 v[218:219], v244 offset:808
    v_mfma_f32_16x16x32_bf16 v[28:31], v[200:203], v[220:223], 0
    ds_read_b128 v[200:203], v241 offset:3840
    ds_read_b64 v[220:221], v244 offset:872
    ds_read_b64 v[222:223], v244 offset:880
    s_waitcnt lgkmcnt(9)
    v_mfma_f32_16x16x32_bf16 v[32:35], v[204:207], v[224:227], 0
    ds_read_b128 v[204:207], v241 offset:4160
    ds_read_b64 v[224:225], v244 offset:944
    ds_read_b64 v[226:227], v244 offset:952
    v_mfma_f32_16x16x32_bf16 v[36:39], v[208:211], v[228:231], 0
    ds_read_b128 v[208:211], v241 offset:4480
    ds_read_b64 v[228:229], v244 offset:1016
    ds_read_b64 v[230:231], v244 offset:1024
    s_waitcnt lgkmcnt(9)
    v_mfma_f32_16x16x32_bf16 v[40:43], v[192:195], v[212:215], 0
    ds_read_b128 v[192:195], v241 offset:4800
    ds_read_b64 v[212:213], v244 offset:1088
    ds_read_b64 v[214:215], v244 offset:1096
    v_mfma_f32_16x16x32_bf16 v[44:47], v[196:199], v[216:219], 0
    ds_read_b128 v[196:199], v241 offset:5120
    ds_read_b64 v[216:217], v244 offset:2336
    ds_read_b64 v[218:219], v244 offset:2344
    s_waitcnt lgkmcnt(9)
    v_mfma_f32_16x16x32_bf16 v[48:51], v[200:203], v[220:223], 0
    ds_read_b128 v[200:203], v241 offset:5440
    ds_read_b64 v[220:221], v244 offset:2408
    ds_read_b64 v[222:223], v244 offset:2416
    v_mfma_f32_16x16x32_bf16 v[52:55], v[204:207], v[224:227], 0
    ds_read_b128 v[204:207], v241 offset:5760
    ds_read_b64 v[224:225], v244 offset:2480
    ds_read_b64 v[226:227], v244 offset:2488
    s_waitcnt lgkmcnt(9)
    v_mfma_f32_16x16x32_bf16 v[56:59], v[208:211], v[228:231], 0
    ds_read_b128 v[208:211], v241 offset:6080
    ds_read_b64 v[228:229], v244 offset:2552
    ds_read_b64 v[230:231], v244 offset:2560
    v_mfma_f32_16x16x32_bf16 v[60:63], v[192:195], v[212:215], 0
    ds_read_b128 v[192:195], v241 offset:6400
    ds_read_b64 v[212:213], v244 offset:2624
    ds_read_b64 v[214:215], v244 offset:2632
    s_waitcnt lgkmcnt(9)
    v_mfma_f32_16x16x32_bf16 v[64:67], v[196:199], v[216:219], 0
    ds_read_b128 v[196:199], v241 offset:6720
    ds_read_b64 v[216:217], v244 offset:2696
    ds_read_b64 v[218:219], v244 offset:2704
    v_mfma_f32_16x16x32_bf16 v[68:71], v[200:203], v[220:223], 0
    ds_read_b128 v[200:203], v241 offset:7040
    ds_read_b64 v[220:221], v244 offset:2768
    ds_read_b64 v[222:223], v244 offset:2776
    s_waitcnt lgkmcnt(9)
    v_mfma_f32_16x16x32_bf16 v[72:75], v[204:207], v[224:227], 0
    ds_read_b128 v[204:207], v241 offset:7360
    ds_read_b64 v[224:225], v244 offset:2840
    ds_read_b64 v[226:227], v244 offset:2848
    v_mfma_f32_16x16x32_bf16 v[76:79], v[208:211], v[228:231], 0
    ds_read_b128 v[208:211], v241 offset:7680
    ds_read_b64 v[228:229], v244 offset:2920
    ds_read_b64 v[230:231], v244 offset:2928
    s_waitcnt lgkmcnt(9)
    v_mfma_f32_16x16x32_bf16 v[80:83], v[192:195], v[212:215], 0
    ds_read_b128 v[192:195], v241 offset:8000
    ds_read_b64 v[212:213], v244 offset:2992
    ds_read_b64 v[214:215], v244 offset:3000
    v_mfma_f32_16x16x32_bf16 v[84:87], v[196:199], v[216:219], 0
    ds_read_b128 v[196:199], v241 offset:8320
    ds_read_b64 v[216:217], v244 offset:3064
    ds_read_b64 v[218:219], v244 offset:3072
    s_waitcnt lgkmcnt(9)
    v_mfma_f32_16x16x32_bf16 v[88:91], v[200:203], v[220:223], 0
    ds_read_b128 v[200:203], v241 offset:8640
    ds_read_b64 v[220:221], v244 offset:3136
    ds_read_b64 v[222:223], v244 offset:3144
    v_mfma_f32_16x16x32_bf16 v[92:95], v[204:207], v[224:227], 0
    ds_read_b128 v[204:207], v241 offset:8960
    ds_read_b64 v[224:225], v244 offset:3208
    ds_read_b64 v[226:227], v244 offset:3216
    s_waitcnt lgkmcnt(9)
    v_mfma_f32_16x16x32_bf16 v[96:99], v[208:211], v[228:231], 0
    ds_read_b128 v[208:211], v241 offset:9280
    ds_read_b64 v[228:229], v244 offset:3280
    ds_read_b64 v[230:231], v244 offset:3288
    v_mfma_f32_16x16x32_bf16 v[100:103], v[192:195], v[212:215], 0
    ds_read_b128 v[192:195], v241 offset:9600
    ds_read_b64 v[212:213], v244 offset:3352
    ds_read_b64 v[214:215], v244 offset:3360
    s_waitcnt lgkmcnt(9)
    v_mfma_f32_16x16x32_bf16 v[104:107], v[196:199], v[216:219], 0
    ds_read_b128 v[196:199], v241 offset:9920
    ds_read_b64 v[216:217], v244 offset:3424
    ds_read_b64 v[218:219], v244 offset:3432
    v_mfma_f32_16x16x32_bf16 v[108:111], v[200:203], v[220:223], 0
    ds_read_b128 v[200:203], v241 offset:10240
    ds_read_b64 v[220:221], v244 offset:4672
    ds_read_b64 v[222:223], v244 offset:4680
    s_waitcnt lgkmcnt(9)
    v_mfma_f32_16x16x32_bf16 v[112:115], v[204:207], v[224:227], 0
    ds_read_b128 v[204:207], v241 offset:10560
    ds_read_b64 v[224:225], v244 offset:4744
    ds_read_b64 v[226:227], v244 offset:4752
    v_mfma_f32_16x16x32_bf16 v[116:119], v[208:211], v[228:231], 0
    ds_read_b128 v[208:211], v241 offset:10880
    ds_read_b64 v[228:229], v244 offset:4816
    ds_read_b64 v[230:231], v244 offset:4824
    s_waitcnt lgkmcnt(9)
    v_mfma_f32_16x16x32_bf16 v[120:123], v[192:195], v[212:215], 0
    ds_read_b128 v[192:195], v241 offset:11200
    ds_read_b64 v[212:213], v244 offset:4888
    ds_read_b64 v[214:215], v244 offset:4896
    v_mfma_f32_16x16x32_bf16 v[124:127], v[196:199], v[216:219], 0
    ds_read_b128 v[196:199], v241 offset:11520
    ds_read_b64 v[216:217], v244 offset:4960
    ds_read_b64 v[218:219], v244 offset:4968
    s_waitcnt lgkmcnt(9)
    v_mfma_f32_16x16x32_bf16 v[128:131], v[200:203], v[220:223], 0
    ds_read_b128 v[200:203], v241 offset:11840
    ds_read_b64 v[220:221], v244 offset:5032
    ds_read_b64 v[222:223], v244 offset:5040
    v_mfma_f32_16x16x32_bf16 v[132:135], v[204:207], v[224:227], 0
    ds_read_b128 v[204:207], v241 offset:12160
    ds_read_b64 v[224:225], v244 offset:5104
    ds_read_b64 v[226:227], v244 offset:5112
    s_waitcnt lgkmcnt(9)
    v_mfma_f32_16x16x32_bf16 v[136:139], v[208:211], v[228:231], 0
    ds_read_b128 v[208:211], v241 offset:12480
    ds_read_b64 v[228:229], v244 offset:5176
    ds_read_b64 v[230:231], v244 offset:5184
    v_mfma_f32_16x16x32_bf16 v[140:143], v[192:195], v[212:215], 0
    ds_read_b128 v[192:195], v241 offset:12800
    ds_read_b64 v[212:213], v244 offset:5256
    ds_read_b64 v[214:215], v244 offset:5264
    s_waitcnt lgkmcnt(9)
    v_mfma_f32_16x16x32_bf16 v[144:147], v[196:199], v[216:219], 0
    ds_read_b128 v[196:199], v241 offset:13120
    ds_read_b64 v[216:217], v244 offset:5328
    ds_read_b64 v[218:219], v244 offset:5336
    v_mfma_f32_16x16x32_bf16 v[148:151], v[200:203], v[220:223], 0
    ds_read_b128 v[200:203], v241 offset:13440
    ds_read_b64 v[220:221], v244 offset:5400
    ds_read_b64 v[222:223], v244 offset:5408
    s_waitcnt lgkmcnt(9)
    v_mfma_f32_16x16x32_bf16 v[152:155], v[204:207], v[224:227], 0
    ds_read_b128 v[204:207], v241 offset:13760
    ds_read_b64 v[224:225], v244 offset:5472
    ds_read_b64 v[226:227], v244 offset:5480
    v_mfma_f32_16x16x32_bf16 v[156:159], v[208:211], v[228:231], 0
    ds_read_b128 v[208:211], v241 offset:14080
    ds_read_b64 v[228:229], v244 offset:5544
    ds_read_b64 v[230:231], v244 offset:5552
    s_waitcnt lgkmcnt(9)
    v_mfma_f32_16x16x32_bf16 v[160:163], v[192:195], v[212:215], 0
    ds_read_b128 v[192:195], v241 offset:14400
    ds_read_b64 v[212:213], v244 offset:5616
    ds_read_b64 v[214:215], v244 offset:5624
    v_mfma_f32_16x16x32_bf16 v[164:167], v[196:199], v[216:219], 0
    ds_read_b128 v[196:199], v241 offset:14720
    ds_read_b64 v[216:217], v244 offset:5688
    ds_read_b64 v[218:219], v244 offset:5696
    s_waitcnt lgkmcnt(9)
    v_mfma_f32_16x16x32_bf16 v[168:171], v[200:203], v[220:223], 0
    ds_read_b128 v[200:203], v241 offset:15040
    ds_read_b64 v[220:221], v244 offset:5760
    ds_read_b64 v[222:223], v244 offset:5768
    v_mfma_f32_16x16x32_bf16 v[172:175], v[204:207], v[224:227], 0
    v_add_u32 v254, s26, v240

    s_mov_b32 s29, 200000
L_wrdy:
    ds_read_b32 v255, v254
    s_waitcnt lgkmcnt(0)
    v_cmp_ne_u32 vcc, 0, v255
    s_cmp_eq_u64 vcc, exec
    s_cbranch_scc1 L_wrdy_ok
    s_sleep 2
    s_sub_u32 s29, s29, 1
    s_cmp_lg_u32 s29, 0
    s_cbranch_scc1 L_wrdy
L_wrdy_ok:

    s_lshl_b32 s26, s16, 3
    s_add_u32 s26, s26, 161888
    v_mov_b32 v254, s26
    v_mov_b32 v255, 1

    ds_read_b128 v[204:207], v242 offset:0
    ds_read_b64 v[224:225], v245 offset:0
    ds_read_b64 v[226:227], v245 offset:8
    s_waitcnt lgkmcnt(9)
    v_mfma_f32_16x16x32_bf16 v[176:179], v[208:211], v[228:231], 0
    ds_read_b128 v[208:211], v242 offset:320
    ds_read_b64 v[228:229], v245 offset:72
    ds_read_b64 v[230:231], v245 offset:80
    v_mfma_f32_16x16x32_bf16 v[180:183], v[192:195], v[212:215], 0
    ds_read_b128 v[192:195], v242 offset:640
    ds_read_b64 v[212:213], v245 offset:144
    ds_read_b64 v[214:215], v245 offset:152
    s_waitcnt lgkmcnt(9)
    v_mfma_f32_16x16x32_bf16 v[184:187], v[196:199], v[216:219], 0
    ds_read_b128 v[196:199], v242 offset:960
    ds_read_b64 v[216:217], v245 offset:216
    ds_read_b64 v[218:219], v245 offset:224
    v_mfma_f32_16x16x32_bf16 v[188:191], v[200:203], v[220:223], 0
    ds_read_b128 v[200:203], v242 offset:1280
    ds_read_b64 v[220:221], v245 offset:288
    ds_read_b64 v[222:223], v245 offset:296
    s_waitcnt lgkmcnt(9)
    v_mfma_f32_16x16x32_bf16 v[0:3], v[204:207], v[224:227], v[0:3]
    ds_read_b128 v[204:207], v242 offset:1600
    ds_read_b64 v[224:225], v245 offset:360
    ds_read_b64 v[226:227], v245 offset:368
    v_mfma_f32_16x16x32_bf16 v[4:7], v[208:211], v[228:231], v[4:7]
    ds_read_b128 v[208:211], v242 offset:1920
    ds_read_b64 v[228:229], v245 offset:432
    ds_read_b64 v[230:231], v245 offset:440
    s_waitcnt lgkmcnt(9)
    v_mfma_f32_16x16x32_bf16 v[8:11], v[192:195], v[212:215], v[8:11]
    ds_read_b128 v[192:195], v242 offset:2240
    ds_read_b64 v[212:213], v245 offset:504
    ds_read_b64 v[214:215], v245 offset:512
    v_mfma_f32_16x16x32_bf16 v[12:15], v[196:199], v[216:219], v[12:15]
    ds_read_b128 v[196:199], v242 offset:2560
    ds_read_b64 v[216:217], v245 offset:584
    ds_read_b64 v[218:219], v245 offset:592
    s_waitcnt lgkmcnt(9)
    v_mfma_f32_16x16x32_bf16 v[16:19], v[200:203], v[220:223], v[16:19]
    ds_read_b128 v[200:203], v242 offset:2880
    ds_read_b64 v[220:221], v245 offset:656
    ds_read_b64 v[222:223], v245 offset:664
    v_mfma_f32_16x16x32_bf16 v[20:23], v[204:207], v[224:227], v[20:23]
    ds_read_b128 v[204:207], v242 offset:3200
    ds_read_b64 v[224:225], v245 offset:728
    ds_read_b64 v[226:227], v245 offset:736
    s_waitcnt lgkmcnt(9)
    v_mfma_f32_16x16x32_bf16 v[24:27], v[208:211], v[228:231], v[24:27]
    ds_read_b128 v[208:211], v242 offset:3520
    ds_read_b64 v[228:229], v245 offset:800
    ds_read_b64 v[230:231], v245 offset:808
    v_mfma_f32_16x16x32_bf16 v[28:31], v[192:195], v[212:215], v[28:31]
    ds_read_b128 v[192:195], v242 offset:3840
    ds_read_b64 v[212:213], v245 offset:872
    ds_read_b64 v[214:215], v245 offset:880
    s_waitcnt lgkmcnt(9)
    v_mfma_f32_16x16x32_bf16 v[32:35], v[196:199], v[216:219], v[32:35]
    ds_read_b128 v[196:199], v242 offset:4160
    ds_read_b64 v[216:217], v245 offset:944
    ds_read_b64 v[218:219], v245 offset:952
    v_mfma_f32_16x16x32_bf16 v[36:39], v[200:203], v[220:223], v[36:39]
    ds_read_b128 v[200:203], v242 offset:4480
    ds_read_b64 v[220:221], v245 offset:1016
    ds_read_b64 v[222:223], v245 offset:1024
    s_waitcnt lgkmcnt(9)
    v_mfma_f32_16x16x32_bf16 v[40:43], v[204:207], v[224:227], v[40:43]
    ds_read_b128 v[204:207], v242 offset:4800
    ds_read_b64 v[224:225], v245 offset:1088
    ds_read_b64 v[226:227], v245 offset:1096
    v_mfma_f32_16x16x32_bf16 v[44:47], v[208:211], v[228:231], v[44:47]
    ds_read_b128 v[208:211], v242 offset:5120
    ds_read_b64 v[228:229], v245 offset:2336
    ds_read_b64 v[230:231], v245 offset:2344
    s_waitcnt lgkmcnt(9)
    v_mfma_f32_16x16x32_bf16 v[48:51], v[192:195], v[212:215], v[48:51]
    ds_read_b128 v[192:195], v242 offset:5440
    ds_read_b64 v[212:213], v245 offset:2408
    ds_read_b64 v[214:215], v245 offset:2416
    v_mfma_f32_16x16x32_bf16 v[52:55], v[196:199], v[216:219], v[52:55]
    ds_read_b128 v[196:199], v242 offset:5760
    ds_read_b64 v[216:217], v245 offset:2480
    ds_read_b64 v[218:219], v245 offset:2488
    s_waitcnt lgkmcnt(9)
    v_mfma_f32_16x16x32_bf16 v[56:59], v[200:203], v[220:223], v[56:59]
    ds_read_b128 v[200:203], v242 offset:6080
    ds_read_b64 v[220:221], v245 offset:2552
    ds_read_b64 v[222:223], v245 offset:2560
    v_mfma_f32_16x16x32_bf16 v[60:63], v[204:207], v[224:227], v[60:63]
    ds_read_b128 v[204:207], v242 offset:6400
    ds_read_b64 v[224:225], v245 offset:2624
    ds_read_b64 v[226:227], v245 offset:2632
    s_waitcnt lgkmcnt(9)
    v_mfma_f32_16x16x32_bf16 v[64:67], v[208:211], v[228:231], v[64:67]
    ds_read_b128 v[208:211], v242 offset:6720
    ds_read_b64 v[228:229], v245 offset:2696
    ds_read_b64 v[230:231], v245 offset:2704
    v_mfma_f32_16x16x32_bf16 v[68:71], v[192:195], v[212:215], v[68:71]
    ds_read_b128 v[192:195], v242 offset:7040
    ds_read_b64 v[212:213], v245 offset:2768
    ds_read_b64 v[214:215], v245 offset:2776
    s_waitcnt lgkmcnt(9)
    v_mfma_f32_16x16x32_bf16 v[72:75], v[196:199], v[216:219], v[72:75]
    ds_read_b128 v[196:199], v242 offset:7360
    ds_read_b64 v[216:217], v245 offset:2840
    ds_read_b64 v[218:219], v245 offset:2848
    v_mfma_f32_16x16x32_bf16 v[76:79], v[200:203], v[220:223], v[76:79]
    ds_read_b128 v[200:203], v242 offset:7680
    ds_read_b64 v[220:221], v245 offset:2920
    ds_read_b64 v[222:223], v245 offset:2928
    s_waitcnt lgkmcnt(9)
    v_mfma_f32_16x16x32_bf16 v[80:83], v[204:207], v[224:227], v[80:83]
    ds_read_b128 v[204:207], v242 offset:8000
    ds_read_b64 v[224:225], v245 offset:2992
    ds_read_b64 v[226:227], v245 offset:3000
    v_mfma_f32_16x16x32_bf16 v[84:87], v[208:211], v[228:231], v[84:87]
    ds_read_b128 v[208:211], v242 offset:8320
    ds_read_b64 v[228:229], v245 offset:3064
    ds_read_b64 v[230:231], v245 offset:3072
    s_waitcnt lgkmcnt(9)
    v_mfma_f32_16x16x32_bf16 v[88:91], v[192:195], v[212:215], v[88:91]
    ds_read_b128 v[192:195], v242 offset:8640
    ds_read_b64 v[212:213], v245 offset:3136
    ds_read_b64 v[214:215], v245 offset:3144
    v_mfma_f32_16x16x32_bf16 v[92:95], v[196:199], v[216:219], v[92:95]
    ds_read_b128 v[196:199], v242 offset:8960
    ds_read_b64 v[216:217], v245 offset:3208
    ds_read_b64 v[218:219], v245 offset:3216
    s_waitcnt lgkmcnt(9)
    v_mfma_f32_16x16x32_bf16 v[96:99], v[200:203], v[220:223], v[96:99]
    ds_read_b128 v[200:203], v242 offset:9280
    ds_read_b64 v[220:221], v245 offset:3280
    ds_read_b64 v[222:223], v245 offset:3288
    v_mfma_f32_16x16x32_bf16 v[100:103], v[204:207], v[224:227], v[100:103]
    ds_read_b128 v[204:207], v242 offset:9600
    ds_read_b64 v[224:225], v245 offset:3352
    ds_read_b64 v[226:227], v245 offset:3360
    s_waitcnt lgkmcnt(9)
    v_mfma_f32_16x16x32_bf16 v[104:107], v[208:211], v[228:231], v[104:107]
    ds_read_b128 v[208:211], v242 offset:9920
    ds_read_b64 v[228:229], v245 offset:3424
    ds_read_b64 v[230:231], v245 offset:3432
    v_mfma_f32_16x16x32_bf16 v[108:111], v[192:195], v[212:215], v[108:111]
    ds_read_b128 v[192:195], v242 offset:10240
    ds_read_b64 v[212:213], v245 offset:4672
    ds_read_b64 v[214:215], v245 offset:4680
    s_waitcnt lgkmcnt(9)
    v_mfma_f32_16x16x32_bf16 v[112:115], v[196:199], v[216:219], v[112:115]
    ds_read_b128 v[196:199], v242 offset:10560
    ds_read_b64 v[216:217], v245 offset:4744
    ds_read_b64 v[218:219], v245 offset:4752
    v_mfma_f32_16x16x32_bf16 v[116:119], v[200:203], v[220:223], v[116:119]
    ds_read_b128 v[200:203], v242 offset:10880
    ds_read_b64 v[220:221], v245 offset:4816
    ds_read_b64 v[222:223], v245 offset:4824
    s_waitcnt lgkmcnt(9)
    v_mfma_f32_16x16x32_bf16 v[120:123], v[204:207], v[224:227], v[120:123]
    ds_read_b128 v[204:207], v242 offset:11200
    ds_read_b64 v[224:225], v245 offset:4888
    ds_read_b64 v[226:227], v245 offset:4896
    v_mfma_f32_16x16x32_bf16 v[124:127], v[208:211], v[228:231], v[124:127]
    ds_read_b128 v[208:211], v242 offset:11520
    ds_read_b64 v[228:229], v245 offset:4960
    ds_read_b64 v[230:231], v245 offset:4968
    s_waitcnt lgkmcnt(9)
    v_mfma_f32_16x16x32_bf16 v[128:131], v[192:195], v[212:215], v[128:131]
    ds_read_b128 v[192:195], v242 offset:11840
    ds_read_b64 v[212:213], v245 offset:5032
    ds_read_b64 v[214:215], v245 offset:5040
    v_mfma_f32_16x16x32_bf16 v[132:135], v[196:199], v[216:219], v[132:135]
    ds_read_b128 v[196:199], v242 offset:12160
    ds_read_b64 v[216:217], v245 offset:5104
    ds_read_b64 v[218:219], v245 offset:5112
    s_waitcnt lgkmcnt(9)
    v_mfma_f32_16x16x32_bf16 v[136:139], v[200:203], v[220:223], v[136:139]
    ds_read_b128 v[200:203], v242 offset:12480
    ds_read_b64 v[220:221], v245 offset:5176
    ds_read_b64 v[222:223], v245 offset:5184
    v_mfma_f32_16x16x32_bf16 v[140:143], v[204:207], v[224:227], v[140:143]
    ds_read_b128 v[204:207], v242 offset:12800
    ds_read_b64 v[224:225], v245 offset:5256
    ds_read_b64 v[226:227], v245 offset:5264
    s_waitcnt lgkmcnt(9)
    v_mfma_f32_16x16x32_bf16 v[144:147], v[208:211], v[228:231], v[144:147]
    ds_read_b128 v[208:211], v242 offset:13120
    ds_read_b64 v[228:229], v245 offset:5328
    ds_read_b64 v[230:231], v245 offset:5336
    v_mfma_f32_16x16x32_bf16 v[148:151], v[192:195], v[212:215], v[148:151]
    ds_read_b128 v[192:195], v242 offset:13440
    ds_read_b64 v[212:213], v245 offset:5400
    ds_read_b64 v[214:215], v245 offset:5408
    s_waitcnt lgkmcnt(9)
    v_mfma_f32_16x16x32_bf16 v[152:155], v[196:199], v[216:219], v[152:155]
    ds_read_b128 v[196:199], v242 offset:13760
    ds_read_b64 v[216:217], v245 offset:5472
    ds_read_b64 v[218:219], v245 offset:5480
    v_mfma_f32_16x16x32_bf16 v[156:159], v[200:203], v[220:223], v[156:159]
    ds_read_b128 v[200:203], v242 offset:14080
    ds_read_b64 v[220:221], v245 offset:5544
    ds_read_b64 v[222:223], v245 offset:5552
    s_waitcnt lgkmcnt(9)
    v_mfma_f32_16x16x32_bf16 v[160:163], v[204:207], v[224:227], v[160:163]
    ds_read_b128 v[204:207], v242 offset:14400
    ds_read_b64 v[224:225], v245 offset:5616
    ds_read_b64 v[226:227], v245 offset:5624
    v_mfma_f32_16x16x32_bf16 v[164:167], v[208:211], v[228:231], v[164:167]
    ds_read_b128 v[208:211], v242 offset:14720
    ds_read_b64 v[228:229], v245 offset:5688
    ds_read_b64 v[230:231], v245 offset:5696
    s_waitcnt lgkmcnt(9)
    v_mfma_f32_16x16x32_bf16 v[168:171], v[192:195], v[212:215], v[168:171]
    ds_read_b128 v[192:195], v242 offset:15040
    ds_read_b64 v[212:213], v245 offset:5760
    ds_read_b64 v[214:215], v245 offset:5768
    v_mfma_f32_16x16x32_bf16 v[172:175], v[196:199], v[216:219], v[172:175]
    ds_read_b128 v[196:199], v243 offset:0
    ds_read_b64 v[216:217], v246 offset:0
    ds_read_b64 v[218:219], v246 offset:8
    s_waitcnt lgkmcnt(9)
    v_mfma_f32_16x16x32_bf16 v[176:179], v[200:203], v[220:223], v[176:179]
    ds_read_b128 v[200:203], v243 offset:320
    ds_read_b64 v[220:221], v246 offset:72
    ds_read_b64 v[222:223], v246 offset:80
    v_mfma_f32_16x16x32_bf16 v[180:183], v[204:207], v[224:227], v[180:183]
    ds_read_b128 v[204:207], v243 offset:640
    ds_read_b64 v[224:225], v246 offset:144
    ds_read_b64 v[226:227], v246 offset:152
    s_waitcnt lgkmcnt(9)
    v_mfma_f32_16x16x32_bf16 v[184:187], v[208:211], v[228:231], v[184:187]
    ds_read_b128 v[208:211], v243 offset:960
    ds_read_b64 v[228:229], v246 offset:216
    ds_read_b64 v[230:231], v246 offset:224
    v_mfma_f32_16x16x32_bf16 v[188:191], v[192:195], v[212:215], v[188:191]
    ds_read_b128 v[192:195], v243 offset:1280
    ds_read_b64 v[212:213], v246 offset:288
    ds_read_b64 v[214:215], v246 offset:296
    s_waitcnt lgkmcnt(9)
    ds_write_b32 v254, v255
    v_mfma_f32_16x16x32_bf16 v[0:3], v[196:199], v[216:219], v[0:3]
    ds_read_b128 v[196:199], v243 offset:1600
    ds_read_b64 v[216:217], v246 offset:360
    ds_read_b64 v[218:219], v246 offset:368
    v_mfma_f32_16x16x32_bf16 v[4:7], v[200:203], v[220:223], v[4:7]
    s_waitcnt lgkmcnt(12)
    ds_read_b128 v[200:203], v243 offset:1920
    ds_read_b64 v[220:221], v246 offset:432
    ds_read_b64 v[222:223], v246 offset:440
    s_waitcnt lgkmcnt(9)
    v_mfma_f32_16x16x32_bf16 v[8:11], v[204:207], v[224:227], v[8:11]
    ds_read_b128 v[204:207], v243 offset:2240
    ds_read_b64 v[224:225], v246 offset:504
    ds_read_b64 v[226:227], v246 offset:512
    v_mfma_f32_16x16x32_bf16 v[12:15], v[208:211], v[228:231], v[12:15]
    ds_read_b128 v[208:211], v243 offset:2560
    ds_read_b64 v[228:229], v246 offset:584
    ds_read_b64 v[230:231], v246 offset:592
    s_waitcnt lgkmcnt(9)
    v_mfma_f32_16x16x32_bf16 v[16:19], v[192:195], v[212:215], v[16:19]
    ds_read_b128 v[192:195], v243 offset:2880
    ds_read_b64 v[212:213], v246 offset:656
    ds_read_b64 v[214:215], v246 offset:664
    v_mfma_f32_16x16x32_bf16 v[20:23], v[196:199], v[216:219], v[20:23]
    ds_read_b128 v[196:199], v243 offset:3200
    ds_read_b64 v[216:217], v246 offset:728
    ds_read_b64 v[218:219], v246 offset:736
    s_waitcnt lgkmcnt(9)
    v_mfma_f32_16x16x32_bf16 v[24:27], v[200:203], v[220:223], v[24:27]
    ds_read_b128 v[200:203], v243 offset:3520
    ds_read_b64 v[220:221], v246 offset:800
    ds_read_b64 v[222:223], v246 offset:808
    v_mfma_f32_16x16x32_bf16 v[28:31], v[204:207], v[224:227], v[28:31]
    ds_read_b128 v[204:207], v243 offset:3840
    ds_read_b64 v[224:225], v246 offset:872
    ds_read_b64 v[226:227], v246 offset:880
    s_waitcnt lgkmcnt(9)
    v_mfma_f32_16x16x32_bf16 v[32:35], v[208:211], v[228:231], v[32:35]
    ds_read_b128 v[208:211], v243 offset:4160
    ds_read_b64 v[228:229], v246 offset:944
    ds_read_b64 v[230:231], v246 offset:952
    v_mfma_f32_16x16x32_bf16 v[36:39], v[192:195], v[212:215], v[36:39]
    ds_read_b128 v[192:195], v243 offset:4480
    ds_read_b64 v[212:213], v246 offset:1016
    ds_read_b64 v[214:215], v246 offset:1024
    s_waitcnt lgkmcnt(9)
    v_mfma_f32_16x16x32_bf16 v[40:43], v[196:199], v[216:219], v[40:43]
    ds_read_b128 v[196:199], v243 offset:4800
    ds_read_b64 v[216:217], v246 offset:1088
    ds_read_b64 v[218:219], v246 offset:1096
    v_mfma_f32_16x16x32_bf16 v[44:47], v[200:203], v[220:223], v[44:47]
    ds_read_b128 v[200:203], v243 offset:5120
    ds_read_b64 v[220:221], v246 offset:2336
    ds_read_b64 v[222:223], v246 offset:2344
    s_waitcnt lgkmcnt(9)
    v_mfma_f32_16x16x32_bf16 v[48:51], v[204:207], v[224:227], v[48:51]
    ds_read_b128 v[204:207], v243 offset:5440
    ds_read_b64 v[224:225], v246 offset:2408
    ds_read_b64 v[226:227], v246 offset:2416
    v_mfma_f32_16x16x32_bf16 v[52:55], v[208:211], v[228:231], v[52:55]
    ds_read_b128 v[208:211], v243 offset:5760
    ds_read_b64 v[228:229], v246 offset:2480
    ds_read_b64 v[230:231], v246 offset:2488
    s_waitcnt lgkmcnt(9)
    v_mfma_f32_16x16x32_bf16 v[56:59], v[192:195], v[212:215], v[56:59]
    ds_read_b128 v[192:195], v243 offset:6080
    ds_read_b64 v[212:213], v246 offset:2552
    ds_read_b64 v[214:215], v246 offset:2560
    v_mfma_f32_16x16x32_bf16 v[60:63], v[196:199], v[216:219], v[60:63]
    ds_read_b128 v[196:199], v243 offset:6400
    ds_read_b64 v[216:217], v246 offset:2624
    ds_read_b64 v[218:219], v246 offset:2632
    s_waitcnt lgkmcnt(9)
    v_mfma_f32_16x16x32_bf16 v[64:67], v[200:203], v[220:223], v[64:67]
    ds_read_b128 v[200:203], v243 offset:6720
    ds_read_b64 v[220:221], v246 offset:2696
    ds_read_b64 v[222:223], v246 offset:2704
    v_mfma_f32_16x16x32_bf16 v[68:71], v[204:207], v[224:227], v[68:71]
    ds_read_b128 v[204:207], v243 offset:7040
    ds_read_b64 v[224:225], v246 offset:2768
    ds_read_b64 v[226:227], v246 offset:2776
    s_waitcnt lgkmcnt(9)
    v_mfma_f32_16x16x32_bf16 v[72:75], v[208:211], v[228:231], v[72:75]
    ds_read_b128 v[208:211], v243 offset:7360
    ds_read_b64 v[228:229], v246 offset:2840
    ds_read_b64 v[230:231], v246 offset:2848
    v_mfma_f32_16x16x32_bf16 v[76:79], v[192:195], v[212:215], v[76:79]
    ds_read_b128 v[192:195], v243 offset:7680
    ds_read_b64 v[212:213], v246 offset:2920
    ds_read_b64 v[214:215], v246 offset:2928
    s_waitcnt lgkmcnt(9)
    v_mfma_f32_16x16x32_bf16 v[80:83], v[196:199], v[216:219], v[80:83]
    ds_read_b128 v[196:199], v243 offset:8000
    ds_read_b64 v[216:217], v246 offset:2992
    ds_read_b64 v[218:219], v246 offset:3000
    v_mfma_f32_16x16x32_bf16 v[84:87], v[200:203], v[220:223], v[84:87]
    ds_read_b128 v[200:203], v243 offset:8320
    ds_read_b64 v[220:221], v246 offset:3064
    ds_read_b64 v[222:223], v246 offset:3072
    s_waitcnt lgkmcnt(9)
    v_mfma_f32_16x16x32_bf16 v[88:91], v[204:207], v[224:227], v[88:91]
    ds_read_b128 v[204:207], v243 offset:8640
    ds_read_b64 v[224:225], v246 offset:3136
    ds_read_b64 v[226:227], v246 offset:3144
    v_mfma_f32_16x16x32_bf16 v[92:95], v[208:211], v[228:231], v[92:95]
    ds_read_b128 v[208:211], v243 offset:8960
    ds_read_b64 v[228:229], v246 offset:3208
    ds_read_b64 v[230:231], v246 offset:3216
    s_waitcnt lgkmcnt(9)
    v_mfma_f32_16x16x32_bf16 v[96:99], v[192:195], v[212:215], v[96:99]
    ds_read_b128 v[192:195], v243 offset:9280
    ds_read_b64 v[212:213], v246 offset:3280
    ds_read_b64 v[214:215], v246 offset:3288
    v_mfma_f32_16x16x32_bf16 v[100:103], v[196:199], v[216:219], v[100:103]
    ds_read_b128 v[196:199], v243 offset:9600
    ds_read_b64 v[216:217], v246 offset:3352
    ds_read_b64 v[218:219], v246 offset:3360
    s_waitcnt lgkmcnt(9)
    v_mfma_f32_16x16x32_bf16 v[104:107], v[200:203], v[220:223], v[104:107]
    ds_read_b128 v[200:203], v243 offset:9920
    ds_read_b64 v[220:221], v246 offset:3424
    ds_read_b64 v[222:223], v246 offset:3432
    v_mfma_f32_16x16x32_bf16 v[108:111], v[204:207], v[224:227], v[108:111]
    ds_read_b128 v[204:207], v243 offset:10240
    ds_read_b64 v[224:225], v246 offset:4672
    ds_read_b64 v[226:227], v246 offset:4680
    s_waitcnt lgkmcnt(9)
    v_mfma_f32_16x16x32_bf16 v[112:115], v[208:211], v[228:231], v[112:115]
    ds_read_b128 v[208:211], v243 offset:10560
    ds_read_b64 v[228:229], v246 offset:4744
    ds_read_b64 v[230:231], v246 offset:4752
    v_mfma_f32_16x16x32_bf16 v[116:119], v[192:195], v[212:215], v[116:119]
    ds_read_b128 v[192:195], v243 offset:10880
    ds_read_b64 v[212:213], v246 offset:4816
    ds_read_b64 v[214:215], v246 offset:4824
    s_waitcnt lgkmcnt(9)
    v_mfma_f32_16x16x32_bf16 v[120:123], v[196:199], v[216:219], v[120:123]
    ds_read_b128 v[196:199], v243 offset:11200
    ds_read_b64 v[216:217], v246 offset:4888
    ds_read_b64 v[218:219], v246 offset:4896
    v_mfma_f32_16x16x32_bf16 v[124:127], v[200:203], v[220:223], v[124:127]
    ds_read_b128 v[200:203], v243 offset:11520
    ds_read_b64 v[220:221], v246 offset:4960
    ds_read_b64 v[222:223], v246 offset:4968
    s_waitcnt lgkmcnt(9)
    v_mfma_f32_16x16x32_bf16 v[128:131], v[204:207], v[224:227], v[128:131]
    ds_read_b128 v[204:207], v243 offset:11840
    ds_read_b64 v[224:225], v246 offset:5032
    ds_read_b64 v[226:227], v246 offset:5040
    v_mfma_f32_16x16x32_bf16 v[132:135], v[208:211], v[228:231], v[132:135]
    ds_read_b128 v[208:211], v243 offset:12160
    ds_read_b64 v[228:229], v246 offset:5104
    ds_read_b64 v[230:231], v246 offset:5112
    s_waitcnt lgkmcnt(9)
    v_mfma_f32_16x16x32_bf16 v[136:139], v[192:195], v[212:215], v[136:139]
    ds_read_b128 v[192:195], v243 offset:12480
    ds_read_b64 v[212:213], v246 offset:5176
    ds_read_b64 v[214:215], v246 offset:5184
    v_mfma_f32_16x16x32_bf16 v[140:143], v[196:199], v[216:219], v[140:143]
    ds_read_b128 v[196:199], v243 offset:12800
    ds_read_b64 v[216:217], v246 offset:5256
    ds_read_b64 v[218:219], v246 offset:5264
    s_waitcnt lgkmcnt(9)
    v_mfma_f32_16x16x32_bf16 v[144:147], v[200:203], v[220:223], v[144:147]
    ds_read_b128 v[200:203], v243 offset:13120
    ds_read_b64 v[220:221], v246 offset:5328
    ds_read_b64 v[222:223], v246 offset:5336
    v_mfma_f32_16x16x32_bf16 v[148:151], v[204:207], v[224:227], v[148:151]
    ds_read_b128 v[204:207], v243 offset:13440
    ds_read_b64 v[224:225], v246 offset:5400
    ds_read_b64 v[226:227], v246 offset:5408
    s_waitcnt lgkmcnt(9)
    v_mfma_f32_16x16x32_bf16 v[152:155], v[208:211], v[228:231], v[152:155]
    ds_read_b128 v[208:211], v243 offset:13760
    ds_read_b64 v[228:229], v246 offset:5472
    ds_read_b64 v[230:231], v246 offset:5480
    v_mfma_f32_16x16x32_bf16 v[156:159], v[192:195], v[212:215], v[156:159]
    ds_read_b128 v[192:195], v243 offset:14080
    ds_read_b64 v[212:213], v246 offset:5544
    ds_read_b64 v[214:215], v246 offset:5552
    s_waitcnt lgkmcnt(9)
    v_mfma_f32_16x16x32_bf16 v[160:163], v[196:199], v[216:219], v[160:163]
    ds_read_b128 v[196:199], v243 offset:14400
    ds_read_b64 v[216:217], v246 offset:5616
    ds_read_b64 v[218:219], v246 offset:5624
    v_mfma_f32_16x16x32_bf16 v[164:167], v[200:203], v[220:223], v[164:167]
    ds_read_b128 v[200:203], v243 offset:14720
    ds_read_b64 v[220:221], v246 offset:5688
    ds_read_b64 v[222:223], v246 offset:5696
    s_waitcnt lgkmcnt(9)
    v_mfma_f32_16x16x32_bf16 v[168:171], v[204:207], v[224:227], v[168:171]
    ds_read_b128 v[204:207], v243 offset:15040
    ds_read_b64 v[224:225], v246 offset:5760
    ds_read_b64 v[226:227], v246 offset:5768
    v_mfma_f32_16x16x32_bf16 v[172:175], v[208:211], v[228:231], v[172:175]
    s_waitcnt lgkmcnt(6)
    v_mfma_f32_16x16x32_bf16 v[176:179], v[192:195], v[212:215], v[176:179]
    v_mfma_f32_16x16x32_bf16 v[180:183], v[196:199], v[216:219], v[180:183]
    s_waitcnt lgkmcnt(0)
    v_mfma_f32_16x16x32_bf16 v[184:187], v[200:203], v[220:223], v[184:187]
    ds_write_b32 v254, v255 offset:4
    v_mfma_f32_16x16x32_bf16 v[188:191], v[204:207], v[224:227], v[188:191]
    s_setprio 2
    v_pk_add_f32 v[232:233], v[0:1], v[4:5]
    v_pk_mul_f32 v[236:237], v[0:1], v[0:1]
    v_pk_add_f32 v[234:235], v[2:3], v[6:7]
    v_pk_mul_f32 v[238:239], v[2:3], v[2:3]
    v_pk_fma_f32 v[236:237], v[4:5], v[4:5], v[236:237]
    v_pk_fma_f32 v[238:239], v[6:7], v[6:7], v[238:239]
    v_pk_add_f32 v[232:233], v[232:233], v[8:9]
    v_pk_fma_f32 v[236:237], v[8:9], v[8:9], v[236:237]
    v_pk_add_f32 v[234:235], v[234:235], v[10:11]
    v_pk_fma_f32 v[238:239], v[10:11], v[10:11], v[238:239]
    v_pk_add_f32 v[232:233], v[232:233], v[12:13]
    v_pk_fma_f32 v[236:237], v[12:13], v[12:13], v[236:237]
    v_pk_add_f32 v[234:235], v[234:235], v[14:15]
    v_pk_fma_f32 v[238:239], v[14:15], v[14:15], v[238:239]
    v_pk_add_f32 v[232:233], v[232:233], v[16:17]
    v_pk_fma_f32 v[236:237], v[16:17], v[16:17], v[236:237]
    v_pk_add_f32 v[234:235], v[234:235], v[18:19]
    v_pk_fma_f32 v[238:239], v[18:19], v[18:19], v[238:239]
    v_pk_add_f32 v[232:233], v[232:233], v[20:21]
    v_pk_fma_f32 v[236:237], v[20:21], v[20:21], v[236:237]
    v_pk_add_f32 v[234:235], v[234:235], v[22:23]
    v_pk_fma_f32 v[238:239], v[22:23], v[22:23], v[238:239]
    v_pk_add_f32 v[232:233], v[232:233], v[24:25]
    v_pk_fma_f32 v[236:237], v[24:25], v[24:25], v[236:237]
    v_pk_add_f32 v[234:235], v[234:235], v[26:27]
    v_pk_fma_f32 v[238:239], v[26:27], v[26:27], v[238:239]
    v_pk_add_f32 v[232:233], v[232:233], v[28:29]
    v_pk_fma_f32 v[236:237], v[28:29], v[28:29], v[236:237]
    v_pk_add_f32 v[234:235], v[234:235], v[30:31]
    v_pk_fma_f32 v[238:239], v[30:31], v[30:31], v[238:239]
    v_pk_add_f32 v[232:233], v[232:233], v[32:33]
    v_pk_fma_f32 v[236:237], v[32:33], v[32:33], v[236:237]
    v_pk_add_f32 v[234:235], v[234:235], v[34:35]
    v_pk_fma_f32 v[238:239], v[34:35], v[34:35], v[238:239]
    v_pk_add_f32 v[232:233], v[232:233], v[36:37]
    v_pk_fma_f32 v[236:237], v[36:37], v[36:37], v[236:237]
    v_pk_add_f32 v[234:235], v[234:235], v[38:39]
    v_pk_fma_f32 v[238:239], v[38:39], v[38:39], v[238:239]
    v_pk_add_f32 v[232:233], v[232:233], v[40:41]
    v_pk_fma_f32 v[236:237], v[40:41], v[40:41], v[236:237]
    v_pk_add_f32 v[234:235], v[234:235], v[42:43]
    v_pk_fma_f32 v[238:239], v[42:43], v[42:43], v[238:239]
    v_pk_add_f32 v[232:233], v[232:233], v[44:45]
    v_pk_fma_f32 v[236:237], v[44:45], v[44:45], v[236:237]
    v_pk_add_f32 v[234:235], v[234:235], v[46:47]
    v_pk_fma_f32 v[238:239], v[46:47], v[46:47], v[238:239]
    v_pk_add_f32 v[232:233], v[232:233], v[48:49]
    v_pk_fma_f32 v[236:237], v[48:49], v[48:49], v[236:237]
    v_pk_add_f32 v[234:235], v[234:235], v[50:51]
    v_pk_fma_f32 v[238:239], v[50:51], v[50:51], v[238:239]
    v_pk_add_f32 v[232:233], v[232:233], v[52:53]
    v_pk_fma_f32 v[236:237], v[52:53], v[52:53], v[236:237]
    v_pk_add_f32 v[234:235], v[234:235], v[54:55]
    v_pk_fma_f32 v[238:239], v[54:55], v[54:55], v[238:239]
    v_pk_add_f32 v[232:233], v[232:233], v[56:57]
    v_pk_fma_f32 v[236:237], v[56:57], v[56:57], v[236:237]
    v_pk_add_f32 v[234:235], v[234:235], v[58:59]
    v_pk_fma_f32 v[238:239], v[58:59], v[58:59], v[238:239]
    v_pk_add_f32 v[232:233], v[232:233], v[60:61]
    v_pk_fma_f32 v[236:237], v[60:61], v[60:61], v[236:237]
    v_pk_add_f32 v[234:235], v[234:235], v[62:63]
    v_pk_fma_f32 v[238:239], v[62:63], v[62:63], v[238:239]
    v_pk_add_f32 v[232:233], v[232:233], v[64:65]
    v_pk_fma_f32 v[236:237], v[64:65], v[64:65], v[236:237]
    v_pk_add_f32 v[234:235], v[234:235], v[66:67]
    v_pk_fma_f32 v[238:239], v[66:67], v[66:67], v[238:239]
    v_pk_add_f32 v[232:233], v[232:233], v[68:69]
    v_pk_fma_f32 v[236:237], v[68:69], v[68:69], v[236:237]
    v_pk_add_f32 v[234:235], v[234:235], v[70:71]
    v_pk_fma_f32 v[238:239], v[70:71], v[70:71], v[238:239]
    v_pk_add_f32 v[232:233], v[232:233], v[72:73]
    v_pk_fma_f32 v[236:237], v[72:73], v[72:73], v[236:237]
    v_pk_add_f32 v[234:235], v[234:235], v[74:75]
    v_pk_fma_f32 v[238:239], v[74:75], v[74:75], v[238:239]
    v_pk_add_f32 v[232:233], v[232:233], v[76:77]
    v_pk_fma_f32 v[236:237], v[76:77], v[76:77], v[236:237]
    v_pk_add_f32 v[234:235], v[234:235], v[78:79]
    v_pk_fma_f32 v[238:239], v[78:79], v[78:79], v[238:239]
    v_pk_add_f32 v[232:233], v[232:233], v[80:81]
    v_pk_fma_f32 v[236:237], v[80:81], v[80:81], v[236:237]
    v_pk_add_f32 v[234:235], v[234:235], v[82:83]
    v_pk_fma_f32 v[238:239], v[82:83], v[82:83], v[238:239]
    v_pk_add_f32 v[232:233], v[232:233], v[84:85]
    v_pk_fma_f32 v[236:237], v[84:85], v[84:85], v[236:237]
    v_pk_add_f32 v[234:235], v[234:235], v[86:87]
    v_pk_fma_f32 v[238:239], v[86:87], v[86:87], v[238:239]
    v_pk_add_f32 v[232:233], v[232:233], v[88:89]
    v_pk_fma_f32 v[236:237], v[88:89], v[88:89], v[236:237]
    v_pk_add_f32 v[234:235], v[234:235], v[90:91]
    v_pk_fma_f32 v[238:239], v[90:91], v[90:91], v[238:239]
    v_pk_add_f32 v[232:233], v[232:233], v[92:93]
    v_pk_fma_f32 v[236:237], v[92:93], v[92:93], v[236:237]
    v_pk_add_f32 v[234:235], v[234:235], v[94:95]
    v_pk_fma_f32 v[238:239], v[94:95], v[94:95], v[238:239]
    v_pk_add_f32 v[232:233], v[232:233], v[96:97]
    v_pk_fma_f32 v[236:237], v[96:97], v[96:97], v[236:237]
    v_pk_add_f32 v[234:235], v[234:235], v[98:99]
    v_pk_fma_f32 v[238:239], v[98:99], v[98:99], v[238:239]
    v_pk_add_f32 v[232:233], v[232:233], v[100:101]
    v_pk_fma_f32 v[236:237], v[100:101], v[100:101], v[236:237]
    v_pk_add_f32 v[234:235], v[234:235], v[102:103]
    v_pk_fma_f32 v[238:239], v[102:103], v[102:103], v[238:239]
    v_pk_add_f32 v[232:233], v[232:233], v[104:105]
    v_pk_fma_f32 v[236:237], v[104:105], v[104:105], v[236:237]
    v_pk_add_f32 v[234:235], v[234:235], v[106:107]
    v_pk_fma_f32 v[238:239], v[106:107], v[106:107], v[238:239]
    v_pk_add_f32 v[232:233], v[232:233], v[108:109]
    v_pk_fma_f32 v[236:237], v[108:109], v[108:109], v[236:237]
    v_pk_add_f32 v[234:235], v[234:235], v[110:111]
    v_pk_fma_f32 v[238:239], v[110:111], v[110:111], v[238:239]
    v_pk_add_f32 v[232:233], v[232:233], v[112:113]
    v_pk_fma_f32 v[236:237], v[112:113], v[112:113], v[236:237]
    v_pk_add_f32 v[234:235], v[234:235], v[114:115]
    v_pk_fma_f32 v[238:239], v[114:115], v[114:115], v[238:239]
    v_pk_add_f32 v[232:233], v[232:233], v[116:117]
    v_pk_fma_f32 v[236:237], v[116:117], v[116:117], v[236:237]
    v_pk_add_f32 v[234:235], v[234:235], v[118:119]
    v_pk_fma_f32 v[238:239], v[118:119], v[118:119], v[238:239]
    v_pk_add_f32 v[232:233], v[232:233], v[120:121]
    v_pk_fma_f32 v[236:237], v[120:121], v[120:121], v[236:237]
    v_pk_add_f32 v[234:235], v[234:235], v[122:123]
    v_pk_fma_f32 v[238:239], v[122:123], v[122:123], v[238:239]
    v_pk_add_f32 v[232:233], v[232:233], v[124:125]
    v_pk_fma_f32 v[236:237], v[124:125], v[124:125], v[236:237]
    v_pk_add_f32 v[234:235], v[234:235], v[126:127]
    v_pk_fma_f32 v[238:239], v[126:127], v[126:127], v[238:239]
    v_pk_add_f32 v[232:233], v[232:233], v[128:129]
    v_pk_fma_f32 v[236:237], v[128:129], v[128:129], v[236:237]
    v_pk_add_f32 v[234:235], v[234:235], v[130:131]
    v_pk_fma_f32 v[238:239], v[130:131], v[130:131], v[238:239]
    v_pk_add_f32 v[232:233], v[232:233], v[132:133]
    v_pk_fma_f32 v[236:237], v[132:133], v[132:133], v[236:237]
    v_pk_add_f32 v[234:235], v[234:235], v[134:135]
    v_pk_fma_f32 v[238:239], v[134:135], v[134:135], v[238:239]
    v_pk_add_f32 v[232:233], v[232:233], v[136:137]
    v_pk_fma_f32 v[236:237], v[136:137], v[136:137], v[236:237]
    v_pk_add_f32 v[234:235], v[234:235], v[138:139]
    v_pk_fma_f32 v[238:239], v[138:139], v[138:139], v[238:239]
    v_pk_add_f32 v[232:233], v[232:233], v[140:141]
    v_pk_fma_f32 v[236:237], v[140:141], v[140:141], v[236:237]
    v_pk_add_f32 v[234:235], v[234:235], v[142:143]
    v_pk_fma_f32 v[238:239], v[142:143], v[142:143], v[238:239]
    v_pk_add_f32 v[232:233], v[232:233], v[144:145]
    v_pk_fma_f32 v[236:237], v[144:145], v[144:145], v[236:237]
    v_pk_add_f32 v[234:235], v[234:235], v[146:147]
    v_pk_fma_f32 v[238:239], v[146:147], v[146:147], v[238:239]
    v_pk_add_f32 v[232:233], v[232:233], v[148:149]
    v_pk_fma_f32 v[236:237], v[148:149], v[148:149], v[236:237]
    v_pk_add_f32 v[234:235], v[234:235], v[150:151]
    v_pk_fma_f32 v[238:239], v[150:151], v[150:151], v[238:239]
    v_pk_add_f32 v[232:233], v[232:233], v[152:153]
    v_pk_fma_f32 v[236:237], v[152:153], v[152:153], v[236:237]
    v_pk_add_f32 v[234:235], v[234:235], v[154:155]
    v_pk_fma_f32 v[238:239], v[154:155], v[154:155], v[238:239]
    v_pk_add_f32 v[232:233], v[232:233], v[156:157]
    v_pk_fma_f32 v[236:237], v[156:157], v[156:157], v[236:237]
    v_pk_add_f32 v[234:235], v[234:235], v[158:159]
    v_pk_fma_f32 v[238:239], v[158:159], v[158:159], v[238:239]
    v_pk_add_f32 v[232:233], v[232:233], v[160:161]
    v_pk_fma_f32 v[236:237], v[160:161], v[160:161], v[236:237]
    v_pk_add_f32 v[234:235], v[234:235], v[162:163]
    v_pk_fma_f32 v[238:239], v[162:163], v[162:163], v[238:239]
    v_pk_add_f32 v[232:233], v[232:233], v[164:165]
    v_pk_fma_f32 v[236:237], v[164:165], v[164:165], v[236:237]
    v_pk_add_f32 v[234:235], v[234:235], v[166:167]
    v_pk_fma_f32 v[238:239], v[166:167], v[166:167], v[238:239]
    v_pk_add_f32 v[232:233], v[232:233], v[168:169]
    v_pk_fma_f32 v[236:237], v[168:169], v[168:169], v[236:237]
    v_pk_add_f32 v[234:235], v[234:235], v[170:171]
    v_pk_fma_f32 v[238:239], v[170:171], v[170:171], v[238:239]
    v_pk_add_f32 v[232:233], v[232:233], v[172:173]
    v_pk_fma_f32 v[236:237], v[172:173], v[172:173], v[236:237]
    v_pk_add_f32 v[234:235], v[234:235], v[174:175]
    v_pk_fma_f32 v[238:239], v[174:175], v[174:175], v[238:239]
    v_pk_add_f32 v[232:233], v[232:233], v[176:177]
    v_pk_fma_f32 v[236:237], v[176:177], v[176:177], v[236:237]
    v_pk_add_f32 v[234:235], v[234:235], v[178:179]
    v_pk_fma_f32 v[238:239], v[178:179], v[178:179], v[238:239]
    v_pk_add_f32 v[232:233], v[232:233], v[180:181]
    v_pk_fma_f32 v[236:237], v[180:181], v[180:181], v[236:237]
    v_pk_add_f32 v[234:235], v[234:235], v[182:183]
    v_pk_fma_f32 v[238:239], v[182:183], v[182:183], v[238:239]
    v_pk_add_f32 v[232:233], v[232:233], v[184:185]
    v_pk_fma_f32 v[236:237], v[184:185], v[184:185], v[236:237]
    v_pk_add_f32 v[234:235], v[234:235], v[186:187]
    v_pk_fma_f32 v[238:239], v[186:187], v[186:187], v[238:239]
    v_pk_add_f32 v[232:233], v[232:233], v[188:189]
    v_pk_fma_f32 v[236:237], v[188:189], v[188:189], v[236:237]
    v_pk_add_f32 v[234:235], v[234:235], v[190:191]
    v_pk_fma_f32 v[238:239], v[190:191], v[190:191], v[238:239]

    s_nop 1
    v_permlane32_swap_b32 v232, v233
    v_permlane32_swap_b32 v234, v235
    v_permlane32_swap_b32 v236, v237
    v_permlane32_swap_b32 v238, v239

    v_add_f32 v232, v232, v233
    v_add_f32 v236, v236, v237
    v_mul_f32 v232, 0x3c2aaaab, v232
    v_mul_f32 v236, 0x3c2aaaab, v236
    v_fma_f32 v236, -v232, v232, v236
    v_max_f32 v236, 0, v236
    v_add_f32 v236, 0x3727c5ac, v236
    v_rsq_f32 v236, v236
    s_nop 0
    v_mul_f32 v232, v232, v236
    v_mul_f32 v236, 0x08000000, v236
    v_mul_f32 v232, 0x88000000, v232
    v_mov_b32 v237, v236
    v_mov_b32 v233, v232

    v_add_f32 v234, v234, v235
    v_add_f32 v238, v238, v239
    v_mul_f32 v234, 0x3c2aaaab, v234
    v_mul_f32 v238, 0x3c2aaaab, v238
    v_fma_f32 v238, -v234, v234, v238
    v_max_f32 v238, 0, v238
    v_add_f32 v238, 0x3727c5ac, v238
    v_rsq_f32 v238, v238
    s_nop 0
    v_mul_f32 v234, v234, v238
    v_mul_f32 v238, 0x08000000, v238
    v_mul_f32 v234, 0x88000000, v234
    v_mov_b32 v239, v238
    v_mov_b32 v235, v234

    s_nop 1
    v_permlane32_swap_b32 v232, v233
    v_permlane32_swap_b32 v234, v235
    v_permlane32_swap_b32 v236, v237
    v_permlane32_swap_b32 v238, v239

    v_pk_fma_f32 v[0:1], v[0:1], v[236:237], v[232:233]
    v_pk_fma_f32 v[2:3], v[2:3], v[238:239], v[234:235]
    v_pk_fma_f32 v[4:5], v[4:5], v[236:237], v[232:233]
    v_pk_fma_f32 v[6:7], v[6:7], v[238:239], v[234:235]
    v_pk_fma_f32 v[8:9], v[8:9], v[236:237], v[232:233]
    v_pk_fma_f32 v[10:11], v[10:11], v[238:239], v[234:235]
    v_pk_fma_f32 v[12:13], v[12:13], v[236:237], v[232:233]
    v_pk_fma_f32 v[14:15], v[14:15], v[238:239], v[234:235]
    v_pk_fma_f32 v[16:17], v[16:17], v[236:237], v[232:233]
    v_pk_fma_f32 v[18:19], v[18:19], v[238:239], v[234:235]
    v_pk_fma_f32 v[20:21], v[20:21], v[236:237], v[232:233]
    v_pk_fma_f32 v[22:23], v[22:23], v[238:239], v[234:235]
    v_pk_fma_f32 v[24:25], v[24:25], v[236:237], v[232:233]
    v_pk_fma_f32 v[26:27], v[26:27], v[238:239], v[234:235]
    v_pk_fma_f32 v[28:29], v[28:29], v[236:237], v[232:233]
    v_pk_fma_f32 v[30:31], v[30:31], v[238:239], v[234:235]
    v_pk_fma_f32 v[32:33], v[32:33], v[236:237], v[232:233]
    v_pk_fma_f32 v[34:35], v[34:35], v[238:239], v[234:235]
    v_pk_fma_f32 v[36:37], v[36:37], v[236:237], v[232:233]
    v_pk_fma_f32 v[38:39], v[38:39], v[238:239], v[234:235]
    v_pk_fma_f32 v[40:41], v[40:41], v[236:237], v[232:233]
    v_pk_fma_f32 v[42:43], v[42:43], v[238:239], v[234:235]
    v_pk_fma_f32 v[44:45], v[44:45], v[236:237], v[232:233]
    v_pk_fma_f32 v[46:47], v[46:47], v[238:239], v[234:235]
    v_pk_fma_f32 v[48:49], v[48:49], v[236:237], v[232:233]
    v_pk_fma_f32 v[50:51], v[50:51], v[238:239], v[234:235]
    v_pk_fma_f32 v[52:53], v[52:53], v[236:237], v[232:233]
    v_pk_fma_f32 v[54:55], v[54:55], v[238:239], v[234:235]
    v_pk_fma_f32 v[56:57], v[56:57], v[236:237], v[232:233]
    v_pk_fma_f32 v[58:59], v[58:59], v[238:239], v[234:235]
    v_pk_fma_f32 v[60:61], v[60:61], v[236:237], v[232:233]
    v_pk_fma_f32 v[62:63], v[62:63], v[238:239], v[234:235]
    v_cvt_pk_bf16_f32 v192, v0, v4
    v_cvt_pk_bf16_f32 v193, v8, v12
    v_cvt_pk_bf16_f32 v194, v16, v20
    v_cvt_pk_bf16_f32 v195, v24, v28
    v_cvt_pk_bf16_f32 v200, v32, v36
    v_cvt_pk_bf16_f32 v201, v40, v44
    v_cvt_pk_bf16_f32 v202, v48, v52
    v_cvt_pk_bf16_f32 v203, v56, v60
    v_cvt_pk_bf16_f32 v196, v1, v5
    v_cvt_pk_bf16_f32 v197, v9, v13
    v_cvt_pk_bf16_f32 v198, v17, v21
    v_cvt_pk_bf16_f32 v199, v25, v29
    v_cvt_pk_bf16_f32 v204, v33, v37
    v_cvt_pk_bf16_f32 v205, v41, v45
    v_cvt_pk_bf16_f32 v206, v49, v53
    v_cvt_pk_bf16_f32 v207, v57, v61
    v_cvt_pk_bf16_f32 v208, v2, v6
    v_cvt_pk_bf16_f32 v209, v10, v14
    v_cvt_pk_bf16_f32 v210, v18, v22
    v_cvt_pk_bf16_f32 v211, v26, v30
    v_cvt_pk_bf16_f32 v216, v34, v38
    v_cvt_pk_bf16_f32 v217, v42, v46
    v_cvt_pk_bf16_f32 v218, v50, v54
    v_cvt_pk_bf16_f32 v219, v58, v62
    v_cvt_pk_bf16_f32 v212, v3, v7
    v_cvt_pk_bf16_f32 v213, v11, v15
    v_cvt_pk_bf16_f32 v214, v19, v23
    v_cvt_pk_bf16_f32 v215, v27, v31
    v_cvt_pk_bf16_f32 v220, v35, v39
    v_cvt_pk_bf16_f32 v221, v43, v47
    v_cvt_pk_bf16_f32 v222, v51, v55
    v_cvt_pk_bf16_f32 v223, v59, v63
    s_nop 0
    v_permlane16_swap_b32 v192, v200
    v_permlane16_swap_b32 v193, v201
    v_permlane16_swap_b32 v194, v202
    v_permlane16_swap_b32 v195, v203
    v_permlane16_swap_b32 v196, v204
    v_permlane16_swap_b32 v197, v205
    v_permlane16_swap_b32 v198, v206
    v_permlane16_swap_b32 v199, v207
    v_permlane16_swap_b32 v208, v216
    v_permlane16_swap_b32 v209, v217
    v_permlane16_swap_b32 v210, v218
    v_permlane16_swap_b32 v211, v219
    v_permlane16_swap_b32 v212, v220
    v_permlane16_swap_b32 v213, v221
    v_permlane16_swap_b32 v214, v222
    v_permlane16_swap_b32 v215, v223
    v_mov_b32 v0, v208
    v_mov_b32 v1, v209
    v_mov_b32 v2, v210
    v_mov_b32 v3, v211
    v_mov_b32 v4, v212
    v_mov_b32 v5, v213
    v_mov_b32 v6, v214
    v_mov_b32 v7, v215
    v_mov_b32 v8, v216
    v_mov_b32 v9, v217
    v_mov_b32 v10, v218
    v_mov_b32 v11, v219
    v_mov_b32 v12, v220
    v_mov_b32 v13, v221
    v_mov_b32 v14, v222
    v_mov_b32 v15, v223
    v_pk_fma_f32 v[64:65], v[64:65], v[236:237], v[232:233]
    v_pk_fma_f32 v[66:67], v[66:67], v[238:239], v[234:235]
    v_pk_fma_f32 v[68:69], v[68:69], v[236:237], v[232:233]
    v_pk_fma_f32 v[70:71], v[70:71], v[238:239], v[234:235]
    v_pk_fma_f32 v[72:73], v[72:73], v[236:237], v[232:233]
    v_pk_fma_f32 v[74:75], v[74:75], v[238:239], v[234:235]
    v_pk_fma_f32 v[76:77], v[76:77], v[236:237], v[232:233]
    v_pk_fma_f32 v[78:79], v[78:79], v[238:239], v[234:235]
    v_pk_fma_f32 v[80:81], v[80:81], v[236:237], v[232:233]
    v_pk_fma_f32 v[82:83], v[82:83], v[238:239], v[234:235]
    v_pk_fma_f32 v[84:85], v[84:85], v[236:237], v[232:233]
    v_pk_fma_f32 v[86:87], v[86:87], v[238:239], v[234:235]
    v_pk_fma_f32 v[88:89], v[88:89], v[236:237], v[232:233]
    v_pk_fma_f32 v[90:91], v[90:91], v[238:239], v[234:235]
    v_pk_fma_f32 v[92:93], v[92:93], v[236:237], v[232:233]
    v_pk_fma_f32 v[94:95], v[94:95], v[238:239], v[234:235]
    v_pk_fma_f32 v[96:97], v[96:97], v[236:237], v[232:233]
    v_pk_fma_f32 v[98:99], v[98:99], v[238:239], v[234:235]
    v_pk_fma_f32 v[100:101], v[100:101], v[236:237], v[232:233]
    v_pk_fma_f32 v[102:103], v[102:103], v[238:239], v[234:235]
    v_pk_fma_f32 v[104:105], v[104:105], v[236:237], v[232:233]
    v_pk_fma_f32 v[106:107], v[106:107], v[238:239], v[234:235]
    v_pk_fma_f32 v[108:109], v[108:109], v[236:237], v[232:233]
    v_pk_fma_f32 v[110:111], v[110:111], v[238:239], v[234:235]
    v_pk_fma_f32 v[112:113], v[112:113], v[236:237], v[232:233]
    v_pk_fma_f32 v[114:115], v[114:115], v[238:239], v[234:235]
    v_pk_fma_f32 v[116:117], v[116:117], v[236:237], v[232:233]
    v_pk_fma_f32 v[118:119], v[118:119], v[238:239], v[234:235]
    v_pk_fma_f32 v[120:121], v[120:121], v[236:237], v[232:233]
    v_pk_fma_f32 v[122:123], v[122:123], v[238:239], v[234:235]
    v_pk_fma_f32 v[124:125], v[124:125], v[236:237], v[232:233]
    v_pk_fma_f32 v[126:127], v[126:127], v[238:239], v[234:235]
    v_cvt_pk_bf16_f32 v48, v64, v68
    v_cvt_pk_bf16_f32 v49, v72, v76
    v_cvt_pk_bf16_f32 v50, v80, v84
    v_cvt_pk_bf16_f32 v51, v88, v92
    v_cvt_pk_bf16_f32 v56, v96, v100
    v_cvt_pk_bf16_f32 v57, v104, v108
    v_cvt_pk_bf16_f32 v58, v112, v116
    v_cvt_pk_bf16_f32 v59, v120, v124
    v_cvt_pk_bf16_f32 v52, v65, v69
    v_cvt_pk_bf16_f32 v53, v73, v77
    v_cvt_pk_bf16_f32 v54, v81, v85
    v_cvt_pk_bf16_f32 v55, v89, v93
    v_cvt_pk_bf16_f32 v60, v97, v101
    v_cvt_pk_bf16_f32 v61, v105, v109
    v_cvt_pk_bf16_f32 v62, v113, v117
    v_cvt_pk_bf16_f32 v63, v121, v125
    v_cvt_pk_bf16_f32 v16, v66, v70
    v_cvt_pk_bf16_f32 v17, v74, v78
    v_cvt_pk_bf16_f32 v18, v82, v86
    v_cvt_pk_bf16_f32 v19, v90, v94
    v_cvt_pk_bf16_f32 v24, v98, v102
    v_cvt_pk_bf16_f32 v25, v106, v110
    v_cvt_pk_bf16_f32 v26, v114, v118
    v_cvt_pk_bf16_f32 v27, v122, v126
    v_cvt_pk_bf16_f32 v20, v67, v71
    v_cvt_pk_bf16_f32 v21, v75, v79
    v_cvt_pk_bf16_f32 v22, v83, v87
    v_cvt_pk_bf16_f32 v23, v91, v95
    v_cvt_pk_bf16_f32 v28, v99, v103
    v_cvt_pk_bf16_f32 v29, v107, v111
    v_cvt_pk_bf16_f32 v30, v115, v119
    v_cvt_pk_bf16_f32 v31, v123, v127
    s_nop 0
    v_permlane16_swap_b32 v48, v56
    v_permlane16_swap_b32 v49, v57
    v_permlane16_swap_b32 v50, v58
    v_permlane16_swap_b32 v51, v59
    v_permlane16_swap_b32 v52, v60
    v_permlane16_swap_b32 v53, v61
    v_permlane16_swap_b32 v54, v62
    v_permlane16_swap_b32 v55, v63
    v_permlane16_swap_b32 v16, v24
    v_permlane16_swap_b32 v17, v25
    v_permlane16_swap_b32 v18, v26
    v_permlane16_swap_b32 v19, v27
    v_permlane16_swap_b32 v20, v28
    v_permlane16_swap_b32 v21, v29
    v_permlane16_swap_b32 v22, v30
    v_permlane16_swap_b32 v23, v31
    v_mov_b32 v80, v192
    v_mov_b32 v81, v193
    v_mov_b32 v82, v194
    v_mov_b32 v83, v195
    v_mov_b32 v84, v196
    v_mov_b32 v85, v197
    v_mov_b32 v86, v198
    v_mov_b32 v87, v199
    v_mov_b32 v88, v200
    v_mov_b32 v89, v201
    v_mov_b32 v90, v202
    v_mov_b32 v91, v203
    v_mov_b32 v92, v204
    v_mov_b32 v93, v205
    v_mov_b32 v94, v206
    v_mov_b32 v95, v207
    v_pk_fma_f32 v[128:129], v[128:129], v[236:237], v[232:233]
    v_pk_fma_f32 v[130:131], v[130:131], v[238:239], v[234:235]
    v_pk_fma_f32 v[132:133], v[132:133], v[236:237], v[232:233]
    v_pk_fma_f32 v[134:135], v[134:135], v[238:239], v[234:235]
    v_pk_fma_f32 v[136:137], v[136:137], v[236:237], v[232:233]
    v_pk_fma_f32 v[138:139], v[138:139], v[238:239], v[234:235]
    v_pk_fma_f32 v[140:141], v[140:141], v[236:237], v[232:233]
    v_pk_fma_f32 v[142:143], v[142:143], v[238:239], v[234:235]
    v_pk_fma_f32 v[144:145], v[144:145], v[236:237], v[232:233]
    v_pk_fma_f32 v[146:147], v[146:147], v[238:239], v[234:235]
    v_pk_fma_f32 v[148:149], v[148:149], v[236:237], v[232:233]
    v_pk_fma_f32 v[150:151], v[150:151], v[238:239], v[234:235]
    v_pk_fma_f32 v[152:153], v[152:153], v[236:237], v[232:233]
    v_pk_fma_f32 v[154:155], v[154:155], v[238:239], v[234:235]
    v_pk_fma_f32 v[156:157], v[156:157], v[236:237], v[232:233]
    v_pk_fma_f32 v[158:159], v[158:159], v[238:239], v[234:235]
    v_pk_fma_f32 v[160:161], v[160:161], v[236:237], v[232:233]
    v_pk_fma_f32 v[162:163], v[162:163], v[238:239], v[234:235]
    v_pk_fma_f32 v[164:165], v[164:165], v[236:237], v[232:233]
    v_pk_fma_f32 v[166:167], v[166:167], v[238:239], v[234:235]
    v_pk_fma_f32 v[168:169], v[168:169], v[236:237], v[232:233]
    v_pk_fma_f32 v[170:171], v[170:171], v[238:239], v[234:235]
    v_pk_fma_f32 v[172:173], v[172:173], v[236:237], v[232:233]
    v_pk_fma_f32 v[174:175], v[174:175], v[238:239], v[234:235]
    v_pk_fma_f32 v[176:177], v[176:177], v[236:237], v[232:233]
    v_pk_fma_f32 v[178:179], v[178:179], v[238:239], v[234:235]
    v_pk_fma_f32 v[180:181], v[180:181], v[236:237], v[232:233]
    v_pk_fma_f32 v[182:183], v[182:183], v[238:239], v[234:235]
    v_pk_fma_f32 v[184:185], v[184:185], v[236:237], v[232:233]
    v_pk_fma_f32 v[186:187], v[186:187], v[238:239], v[234:235]
    v_pk_fma_f32 v[188:189], v[188:189], v[236:237], v[232:233]
    v_pk_fma_f32 v[190:191], v[190:191], v[238:239], v[234:235]
    v_cvt_pk_bf16_f32 v64, v128, v132
    v_cvt_pk_bf16_f32 v65, v136, v140
    v_cvt_pk_bf16_f32 v66, v144, v148
    v_cvt_pk_bf16_f32 v67, v152, v156
    v_cvt_pk_bf16_f32 v72, v160, v164
    v_cvt_pk_bf16_f32 v73, v168, v172
    v_cvt_pk_bf16_f32 v74, v176, v180
    v_cvt_pk_bf16_f32 v75, v184, v188
    v_cvt_pk_bf16_f32 v68, v129, v133
    v_cvt_pk_bf16_f32 v69, v137, v141
    v_cvt_pk_bf16_f32 v70, v145, v149
    v_cvt_pk_bf16_f32 v71, v153, v157
    v_cvt_pk_bf16_f32 v76, v161, v165
    v_cvt_pk_bf16_f32 v77, v169, v173
    v_cvt_pk_bf16_f32 v78, v177, v181
    v_cvt_pk_bf16_f32 v79, v185, v189
    v_cvt_pk_bf16_f32 v32, v130, v134
    v_cvt_pk_bf16_f32 v33, v138, v142
    v_cvt_pk_bf16_f32 v34, v146, v150
    v_cvt_pk_bf16_f32 v35, v154, v158
    v_cvt_pk_bf16_f32 v40, v162, v166
    v_cvt_pk_bf16_f32 v41, v170, v174
    v_cvt_pk_bf16_f32 v42, v178, v182
    v_cvt_pk_bf16_f32 v43, v186, v190
    v_cvt_pk_bf16_f32 v36, v131, v135
    v_cvt_pk_bf16_f32 v37, v139, v143
    v_cvt_pk_bf16_f32 v38, v147, v151
    v_cvt_pk_bf16_f32 v39, v155, v159
    v_cvt_pk_bf16_f32 v44, v163, v167
    v_cvt_pk_bf16_f32 v45, v171, v175
    v_cvt_pk_bf16_f32 v46, v179, v183
    v_cvt_pk_bf16_f32 v47, v187, v191
    s_nop 0
    v_permlane16_swap_b32 v64, v72
    v_permlane16_swap_b32 v65, v73
    v_permlane16_swap_b32 v66, v74
    v_permlane16_swap_b32 v67, v75
    v_permlane16_swap_b32 v68, v76
    v_permlane16_swap_b32 v69, v77
    v_permlane16_swap_b32 v70, v78
    v_permlane16_swap_b32 v71, v79
    v_permlane16_swap_b32 v32, v40
    v_permlane16_swap_b32 v33, v41
    v_permlane16_swap_b32 v34, v42
    v_permlane16_swap_b32 v35, v43
    v_permlane16_swap_b32 v36, v44
    v_permlane16_swap_b32 v37, v45
    v_permlane16_swap_b32 v38, v46
    v_permlane16_swap_b32 v39, v47

    s_mov_b32 s18, 8
    s_mov_b32 s38, 1
    s_sub_u32 s26, s16, 1
    s_cmp_lt_u32 s26, 0
    s_cbranch_scc1 L_p2
    s_mov_b32 s38, 0

    v_lshrrev_b32 v232, 7, v253
    v_mul_u32_u24 v232, 640, v232
    v_add_u32 v232, v232, v253
    v_add_u32 v233, 196608, v232
    buffer_store_dwordx4 v[48:51], v232, s[8:11], s36 offen offset:0 sc1
    buffer_store_dwordx4 v[52:55], v232, s[8:11], s36 offen offset:128 sc1
    buffer_store_dwordx4 v[56:59], v232, s[8:11], s36 offen offset:256 sc1
    buffer_store_dwordx4 v[60:63], v232, s[8:11], s37 offen offset:0 sc1
    buffer_store_dwordx4 v[64:67], v232, s[8:11], s37 offen offset:128 sc1
    buffer_store_dwordx4 v[68:71], v232, s[8:11], s37 offen offset:256 sc1
    buffer_store_dwordx4 v[72:75], v233, s[8:11], s36 offen offset:0 sc1
    buffer_store_dwordx4 v[76:79], v233, s[8:11], s36 offen offset:128 sc1
    buffer_store_dwordx4 v[80:83], v233, s[8:11], s36 offen offset:256 sc1
    buffer_store_dwordx4 v[84:87], v233, s[8:11], s37 offen offset:0 sc1
    buffer_store_dwordx4 v[88:91], v233, s[8:11], s37 offen offset:128 sc1
    buffer_store_dwordx4 v[92:95], v233, s[8:11], s37 offen offset:256 sc1

    s_cmp_lg_u32 s16, 0
    s_cbranch_scc1 L_p2
    s_setprio 3
    s_branch L_xload
L_loader:

    v_lshrrev_b32 v60, 9, v253
    v_mul_u32_u24 v61, 1536, v60
    v_add_u32 v61, v61, v253
    v_bfe_u32 v254, v253, 6, 3
    v_lshl_add_u32 v60, v60, 4, v254
    v_mul_u32_u24 v60, 768, v60
    v_and_b32 v254, 48, v253
    v_add_u32 v60, v60, v254

    v_add_u32 v254, 161932, v240

    s_mov_b32 s29, 200000
L_wg1:
    ds_read_b32 v255, v254
    s_waitcnt lgkmcnt(0)
    v_cmp_ne_u32 vcc, 0, v255
    s_cmp_eq_u64 vcc, exec
    s_cbranch_scc1 L_wg1_ok
    s_sleep 2
    s_sub_u32 s29, s29, 1
    s_cmp_lg_u32 s29, 0
    s_cbranch_scc1 L_wg1
L_wg1_ok:

    s_add_u32 s26, s39, 1
    s_cmp_ge_u32 s26, 12
    s_cselect_b32 s27, 12, 0
    s_sub_u32 s26, s26, s27
    s_mul_i32 s26, s26, 6144

    s_mov_b32 m0, 7168
    s_add_u32 s30, s26, 0
    s_add_u32 s31, s26, 1536
    buffer_load_dwordx4 v253, s[44:47], s30 offen lds
    buffer_load_dwordx4 v61, s[44:47], s30 offen offset:1024 lds
    buffer_load_dwordx4 v253, s[44:47], s31 offen offset:2048 lds
    s_mov_b32 m0, 72712
    s_add_u32 s30, s26, 1536
    s_add_u32 s31, s26, 3072
    buffer_load_dwordx4 v253, s[44:47], s30 offen lds
    buffer_load_dwordx4 v61, s[44:47], s30 offen offset:1024 lds
    buffer_load_dwordx4 v253, s[44:47], s31 offen offset:2048 lds

    s_add_u32 s26, s39, 4
    s_cmp_ge_u32 s26, 12
    s_cselect_b32 s27, 12, 0
    s_sub_u32 s26, s26, s27
    s_mul_i32 s26, s26, 64

    s_mov_b32 m0, 10240
    s_add_u32 s30, s26, 0
    s_add_u32 s31, s26, 23552
    s_add_u32 s32, s26, 47104
    buffer_load_dwordx4 v60, s[40:43], s30 offen offset:0 lds
    buffer_load_dwordx4 v60, s[40:43], s31 offen offset:1024 lds
    buffer_load_dwordx4 v60, s[40:43], s32 offen offset:2048 lds
    s_mov_b32 m0, 75784
    s_add_u32 s30, s26, 6144
    s_add_u32 s31, s26, 29696
    s_add_u32 s32, s26, 53248
    buffer_load_dwordx4 v60, s[40:43], s30 offen offset:0 lds
    buffer_load_dwordx4 v60, s[40:43], s31 offen offset:1024 lds
    buffer_load_dwordx4 v60, s[40:43], s32 offen offset:2048 lds

    s_add_u32 s26, s39, 2
    s_cmp_ge_u32 s26, 12
    s_cselect_b32 s27, 12, 0
    s_sub_u32 s26, s26, s27
    s_mul_i32 s26, s26, 6144

    s_mov_b32 m0, 13312
    s_add_u32 s30, s26, 0
    s_add_u32 s31, s26, 1536
    buffer_load_dwordx4 v253, s[44:47], s30 offen lds
    buffer_load_dwordx4 v61, s[44:47], s30 offen offset:1024 lds
    buffer_load_dwordx4 v253, s[44:47], s31 offen offset:2048 lds
    s_mov_b32 m0, 78856
    s_add_u32 s30, s26, 1536
    s_add_u32 s31, s26, 3072
    buffer_load_dwordx4 v253, s[44:47], s30 offen lds
    buffer_load_dwordx4 v61, s[44:47], s30 offen offset:1024 lds
    buffer_load_dwordx4 v253, s[44:47], s31 offen offset:2048 lds

    s_add_u32 s26, s39, 5
    s_cmp_ge_u32 s26, 12
    s_cselect_b32 s27, 12, 0
    s_sub_u32 s26, s26, s27
    s_mul_i32 s26, s26, 64

    s_mov_b32 m0, 16384
    s_add_u32 s30, s26, 0
    s_add_u32 s31, s26, 23552
    s_add_u32 s32, s26, 47104
    buffer_load_dwordx4 v60, s[40:43], s30 offen offset:0 lds
    buffer_load_dwordx4 v60, s[40:43], s31 offen offset:1024 lds
    buffer_load_dwordx4 v60, s[40:43], s32 offen offset:2048 lds
    s_mov_b32 m0, 81928
    s_add_u32 s30, s26, 6144
    s_add_u32 s31, s26, 29696
    s_add_u32 s32, s26, 53248
    buffer_load_dwordx4 v60, s[40:43], s30 offen offset:0 lds
    buffer_load_dwordx4 v60, s[40:43], s31 offen offset:1024 lds
    buffer_load_dwordx4 v60, s[40:43], s32 offen offset:2048 lds
    v_mov_b32 v254, 161976

    s_mov_b32 s29, 200000
L_wo1:
    ds_read_b32 v255, v254
    s_waitcnt lgkmcnt(0)
    v_cmp_eq_u32 vcc, 5, v255
    s_cmp_eq_u64 vcc, exec
    s_cbranch_scc1 L_wo1_ok
    s_sleep 2
    s_sub_u32 s29, s29, 1
    s_cmp_lg_u32 s29, 0
    s_cbranch_scc1 L_wo1
L_wo1_ok:

    v_mov_b32 v254, 161976
    v_mov_b32 v64, 6
    s_waitcnt vmcnt(18)
    ds_write_b32 v254, v64
    v_mov_b32 v65, 7
    s_waitcnt vmcnt(12)
    ds_write_b32 v254, v65
    v_mov_b32 v66, 8
    s_waitcnt vmcnt(6)
    ds_write_b32 v254, v66
    v_mov_b32 v67, 9
    s_waitcnt vmcnt(0)
    ds_write_b32 v254, v67
    v_add_u32 v254, 161940, v240

    s_mov_b32 s29, 200000
L_wg2:
    ds_read_b32 v255, v254
    s_waitcnt lgkmcnt(0)
    v_cmp_ne_u32 vcc, 0, v255
    s_cmp_eq_u64 vcc, exec
    s_cbranch_scc1 L_wg2_ok
    s_sleep 2
    s_sub_u32 s29, s29, 1
    s_cmp_lg_u32 s29, 0
    s_cbranch_scc1 L_wg2
L_wg2_ok:

    s_add_u32 s26, s39, 3
    s_cmp_ge_u32 s26, 12
    s_cselect_b32 s27, 12, 0
    s_sub_u32 s26, s26, s27
    s_mul_i32 s26, s26, 6144

    s_mov_b32 m0, 19456
    s_add_u32 s30, s26, 0
    s_add_u32 s31, s26, 1536
    buffer_load_dwordx4 v253, s[44:47], s30 offen lds
    buffer_load_dwordx4 v61, s[44:47], s30 offen offset:1024 lds
    buffer_load_dwordx4 v253, s[44:47], s31 offen offset:2048 lds
    s_mov_b32 m0, 85000
    s_add_u32 s30, s26, 1536
    s_add_u32 s31, s26, 3072
    buffer_load_dwordx4 v253, s[44:47], s30 offen lds
    buffer_load_dwordx4 v61, s[44:47], s30 offen offset:1024 lds
    buffer_load_dwordx4 v253, s[44:47], s31 offen offset:2048 lds

    s_add_u32 s26, s39, 6
    s_cmp_ge_u32 s26, 12
    s_cselect_b32 s27, 12, 0
    s_sub_u32 s26, s26, s27
    s_mul_i32 s26, s26, 64

    s_mov_b32 m0, 22528
    s_add_u32 s30, s26, 0
    s_add_u32 s31, s26, 23552
    s_add_u32 s32, s26, 47104
    buffer_load_dwordx4 v60, s[40:43], s30 offen offset:0 lds
    buffer_load_dwordx4 v60, s[40:43], s31 offen offset:1024 lds
    buffer_load_dwordx4 v60, s[40:43], s32 offen offset:2048 lds
    s_mov_b32 m0, 88072
    s_add_u32 s30, s26, 6144
    s_add_u32 s31, s26, 29696
    s_add_u32 s32, s26, 53248
    buffer_load_dwordx4 v60, s[40:43], s30 offen offset:0 lds
    buffer_load_dwordx4 v60, s[40:43], s31 offen offset:1024 lds
    buffer_load_dwordx4 v60, s[40:43], s32 offen offset:2048 lds

    s_add_u32 s26, s39, 4
    s_cmp_ge_u32 s26, 12
    s_cselect_b32 s27, 12, 0
    s_sub_u32 s26, s26, s27
    s_mul_i32 s26, s26, 6144

    s_mov_b32 m0, 25600
    s_add_u32 s30, s26, 0
    s_add_u32 s31, s26, 1536
    buffer_load_dwordx4 v253, s[44:47], s30 offen lds
    buffer_load_dwordx4 v61, s[44:47], s30 offen offset:1024 lds
    buffer_load_dwordx4 v253, s[44:47], s31 offen offset:2048 lds
    s_mov_b32 m0, 91144
    s_add_u32 s30, s26, 1536
    s_add_u32 s31, s26, 3072
    buffer_load_dwordx4 v253, s[44:47], s30 offen lds
    buffer_load_dwordx4 v61, s[44:47], s30 offen offset:1024 lds
    buffer_load_dwordx4 v253, s[44:47], s31 offen offset:2048 lds

    s_add_u32 s26, s39, 7
    s_cmp_ge_u32 s26, 12
    s_cselect_b32 s27, 12, 0
    s_sub_u32 s26, s26, s27
    s_mul_i32 s26, s26, 64

    s_mov_b32 m0, 28672
    s_add_u32 s30, s26, 0
    s_add_u32 s31, s26, 23552
    s_add_u32 s32, s26, 47104
    buffer_load_dwordx4 v60, s[40:43], s30 offen offset:0 lds
    buffer_load_dwordx4 v60, s[40:43], s31 offen offset:1024 lds
    buffer_load_dwordx4 v60, s[40:43], s32 offen offset:2048 lds
    s_mov_b32 m0, 94216
    s_add_u32 s30, s26, 6144
    s_add_u32 s31, s26, 29696
    s_add_u32 s32, s26, 53248
    buffer_load_dwordx4 v60, s[40:43], s30 offen offset:0 lds
    buffer_load_dwordx4 v60, s[40:43], s31 offen offset:1024 lds
    buffer_load_dwordx4 v60, s[40:43], s32 offen offset:2048 lds

    s_add_u32 s26, s39, 5
    s_cmp_ge_u32 s26, 12
    s_cselect_b32 s27, 12, 0
    s_sub_u32 s26, s26, s27
    s_mul_i32 s26, s26, 6144

    s_mov_b32 m0, 31744
    s_add_u32 s30, s26, 0
    s_add_u32 s31, s26, 1536
    buffer_load_dwordx4 v253, s[44:47], s30 offen lds
    buffer_load_dwordx4 v61, s[44:47], s30 offen offset:1024 lds
    buffer_load_dwordx4 v253, s[44:47], s31 offen offset:2048 lds
    s_mov_b32 m0, 97288
    s_add_u32 s30, s26, 1536
    s_add_u32 s31, s26, 3072
    buffer_load_dwordx4 v253, s[44:47], s30 offen lds
    buffer_load_dwordx4 v61, s[44:47], s30 offen offset:1024 lds
    buffer_load_dwordx4 v253, s[44:47], s31 offen offset:2048 lds
    v_mov_b32 v254, 161976
    v_mov_b32 v64, 10
    s_waitcnt vmcnt(24)
    ds_write_b32 v254, v64
    v_mov_b32 v65, 11
    s_waitcnt vmcnt(18)
    ds_write_b32 v254, v65
    v_mov_b32 v66, 12
    s_waitcnt vmcnt(12)
    ds_write_b32 v254, v66
    v_mov_b32 v67, 13
    s_waitcnt vmcnt(6)
    ds_write_b32 v254, v67
    v_mov_b32 v68, 14
    s_waitcnt vmcnt(0)
    ds_write_b32 v254, v68
    v_add_u32 v254, 161948, v240

    s_mov_b32 s29, 200000
L_wg3:
    ds_read_b32 v255, v254
    s_waitcnt lgkmcnt(0)
    v_cmp_ne_u32 vcc, 0, v255
    s_cmp_eq_u64 vcc, exec
    s_cbranch_scc1 L_wg3_ok
    s_sleep 2
    s_sub_u32 s29, s29, 1
    s_cmp_lg_u32 s29, 0
    s_cbranch_scc1 L_wg3
L_wg3_ok:

    s_add_u32 s26, s39, 8
    s_cmp_ge_u32 s26, 12
    s_cselect_b32 s27, 12, 0
    s_sub_u32 s26, s26, s27
    s_mul_i32 s26, s26, 64

    s_mov_b32 m0, 34816
    s_add_u32 s30, s26, 0
    s_add_u32 s31, s26, 23552
    s_add_u32 s32, s26, 47104
    buffer_load_dwordx4 v60, s[40:43], s30 offen offset:0 lds
    buffer_load_dwordx4 v60, s[40:43], s31 offen offset:1024 lds
    buffer_load_dwordx4 v60, s[40:43], s32 offen offset:2048 lds
    s_mov_b32 m0, 100360
    s_add_u32 s30, s26, 6144
    s_add_u32 s31, s26, 29696
    s_add_u32 s32, s26, 53248
    buffer_load_dwordx4 v60, s[40:43], s30 offen offset:0 lds
    buffer_load_dwordx4 v60, s[40:43], s31 offen offset:1024 lds
    buffer_load_dwordx4 v60, s[40:43], s32 offen offset:2048 lds

    s_add_u32 s26, s39, 6
    s_cmp_ge_u32 s26, 12
    s_cselect_b32 s27, 12, 0
    s_sub_u32 s26, s26, s27
    s_mul_i32 s26, s26, 6144

    s_mov_b32 m0, 37888
    s_add_u32 s30, s26, 0
    s_add_u32 s31, s26, 1536
    buffer_load_dwordx4 v253, s[44:47], s30 offen lds
    buffer_load_dwordx4 v61, s[44:47], s30 offen offset:1024 lds
    buffer_load_dwordx4 v253, s[44:47], s31 offen offset:2048 lds
    s_mov_b32 m0, 103432
    s_add_u32 s30, s26, 1536
    s_add_u32 s31, s26, 3072
    buffer_load_dwordx4 v253, s[44:47], s30 offen lds
    buffer_load_dwordx4 v61, s[44:47], s30 offen offset:1024 lds
    buffer_load_dwordx4 v253, s[44:47], s31 offen offset:2048 lds

    s_add_u32 s26, s39, 9
    s_cmp_ge_u32 s26, 12
    s_cselect_b32 s27, 12, 0
    s_sub_u32 s26, s26, s27
    s_mul_i32 s26, s26, 64

    s_mov_b32 m0, 40960
    s_add_u32 s30, s26, 0
    s_add_u32 s31, s26, 23552
    s_add_u32 s32, s26, 47104
    buffer_load_dwordx4 v60, s[40:43], s30 offen offset:0 lds
    buffer_load_dwordx4 v60, s[40:43], s31 offen offset:1024 lds
    buffer_load_dwordx4 v60, s[40:43], s32 offen offset:2048 lds
    s_mov_b32 m0, 106504
    s_add_u32 s30, s26, 6144
    s_add_u32 s31, s26, 29696
    s_add_u32 s32, s26, 53248
    buffer_load_dwordx4 v60, s[40:43], s30 offen offset:0 lds
    buffer_load_dwordx4 v60, s[40:43], s31 offen offset:1024 lds
    buffer_load_dwordx4 v60, s[40:43], s32 offen offset:2048 lds

    s_add_u32 s26, s39, 7
    s_cmp_ge_u32 s26, 12
    s_cselect_b32 s27, 12, 0
    s_sub_u32 s26, s26, s27
    s_mul_i32 s26, s26, 6144

    s_mov_b32 m0, 44032
    s_add_u32 s30, s26, 0
    s_add_u32 s31, s26, 1536
    buffer_load_dwordx4 v253, s[44:47], s30 offen lds
    buffer_load_dwordx4 v61, s[44:47], s30 offen offset:1024 lds
    buffer_load_dwordx4 v253, s[44:47], s31 offen offset:2048 lds
    s_mov_b32 m0, 109576
    s_add_u32 s30, s26, 1536
    s_add_u32 s31, s26, 3072
    buffer_load_dwordx4 v253, s[44:47], s30 offen lds
    buffer_load_dwordx4 v61, s[44:47], s30 offen offset:1024 lds
    buffer_load_dwordx4 v253, s[44:47], s31 offen offset:2048 lds

    s_add_u32 s26, s39, 10
    s_cmp_ge_u32 s26, 12
    s_cselect_b32 s27, 12, 0
    s_sub_u32 s26, s26, s27
    s_mul_i32 s26, s26, 64

    s_mov_b32 m0, 47104
    s_add_u32 s30, s26, 0
    s_add_u32 s31, s26, 23552
    s_add_u32 s32, s26, 47104
    buffer_load_dwordx4 v60, s[40:43], s30 offen offset:0 lds
    buffer_load_dwordx4 v60, s[40:43], s31 offen offset:1024 lds
    buffer_load_dwordx4 v60, s[40:43], s32 offen offset:2048 lds
    s_mov_b32 m0, 112648
    s_add_u32 s30, s26, 6144
    s_add_u32 s31, s26, 29696
    s_add_u32 s32, s26, 53248
    buffer_load_dwordx4 v60, s[40:43], s30 offen offset:0 lds
    buffer_load_dwordx4 v60, s[40:43], s31 offen offset:1024 lds
    buffer_load_dwordx4 v60, s[40:43], s32 offen offset:2048 lds

    s_add_u32 s26, s39, 8
    s_cmp_ge_u32 s26, 12
    s_cselect_b32 s27, 12, 0
    s_sub_u32 s26, s26, s27
    s_mul_i32 s26, s26, 6144

    s_mov_b32 m0, 50176
    s_add_u32 s30, s26, 0
    s_add_u32 s31, s26, 1536
    buffer_load_dwordx4 v253, s[44:47], s30 offen lds
    buffer_load_dwordx4 v61, s[44:47], s30 offen offset:1024 lds
    buffer_load_dwordx4 v253, s[44:47], s31 offen offset:2048 lds
    s_mov_b32 m0, 115720
    s_add_u32 s30, s26, 1536
    s_add_u32 s31, s26, 3072
    buffer_load_dwordx4 v253, s[44:47], s30 offen lds
    buffer_load_dwordx4 v61, s[44:47], s30 offen offset:1024 lds
    buffer_load_dwordx4 v253, s[44:47], s31 offen offset:2048 lds

    s_add_u32 s26, s39, 11
    s_cmp_ge_u32 s26, 12
    s_cselect_b32 s27, 12, 0
    s_sub_u32 s26, s26, s27
    s_mul_i32 s26, s26, 64

    s_mov_b32 m0, 53248
    s_add_u32 s30, s26, 0
    s_add_u32 s31, s26, 23552
    s_add_u32 s32, s26, 47104
    buffer_load_dwordx4 v60, s[40:43], s30 offen offset:0 lds
    buffer_load_dwordx4 v60, s[40:43], s31 offen offset:1024 lds
    buffer_load_dwordx4 v60, s[40:43], s32 offen offset:2048 lds
    s_mov_b32 m0, 118792
    s_add_u32 s30, s26, 6144
    s_add_u32 s31, s26, 29696
    s_add_u32 s32, s26, 53248
    buffer_load_dwordx4 v60, s[40:43], s30 offen offset:0 lds
    buffer_load_dwordx4 v60, s[40:43], s31 offen offset:1024 lds
    buffer_load_dwordx4 v60, s[40:43], s32 offen offset:2048 lds

    s_add_u32 s26, s39, 9
    s_cmp_ge_u32 s26, 12
    s_cselect_b32 s27, 12, 0
    s_sub_u32 s26, s26, s27
    s_mul_i32 s26, s26, 6144

    s_mov_b32 m0, 56320
    s_add_u32 s30, s26, 0
    s_add_u32 s31, s26, 1536
    buffer_load_dwordx4 v253, s[44:47], s30 offen lds
    buffer_load_dwordx4 v61, s[44:47], s30 offen offset:1024 lds
    buffer_load_dwordx4 v253, s[44:47], s31 offen offset:2048 lds
    s_mov_b32 m0, 121864
    s_add_u32 s30, s26, 1536
    s_add_u32 s31, s26, 3072
    buffer_load_dwordx4 v253, s[44:47], s30 offen lds
    buffer_load_dwordx4 v61, s[44:47], s30 offen offset:1024 lds
    buffer_load_dwordx4 v253, s[44:47], s31 offen offset:2048 lds

    s_add_u32 s26, s39, 10
    s_cmp_ge_u32 s26, 12
    s_cselect_b32 s27, 12, 0
    s_sub_u32 s26, s26, s27
    s_mul_i32 s26, s26, 6144

    s_mov_b32 m0, 59392
    s_add_u32 s30, s26, 0
    s_add_u32 s31, s26, 1536
    buffer_load_dwordx4 v253, s[44:47], s30 offen lds
    buffer_load_dwordx4 v61, s[44:47], s30 offen offset:1024 lds
    buffer_load_dwordx4 v253, s[44:47], s31 offen offset:2048 lds
    s_mov_b32 m0, 124936
    s_add_u32 s30, s26, 1536
    s_add_u32 s31, s26, 3072
    buffer_load_dwordx4 v253, s[44:47], s30 offen lds
    buffer_load_dwordx4 v61, s[44:47], s30 offen offset:1024 lds
    buffer_load_dwordx4 v253, s[44:47], s31 offen offset:2048 lds

    s_add_u32 s26, s39, 11
    s_cmp_ge_u32 s26, 12
    s_cselect_b32 s27, 12, 0
    s_sub_u32 s26, s26, s27
    s_mul_i32 s26, s26, 6144

    s_mov_b32 m0, 62464
    s_add_u32 s30, s26, 0
    s_add_u32 s31, s26, 1536
    buffer_load_dwordx4 v253, s[44:47], s30 offen lds
    buffer_load_dwordx4 v61, s[44:47], s30 offen offset:1024 lds
    buffer_load_dwordx4 v253, s[44:47], s31 offen offset:2048 lds
    s_mov_b32 m0, 128008
    s_add_u32 s30, s26, 1536
    s_add_u32 s31, s26, 3072
    buffer_load_dwordx4 v253, s[44:47], s30 offen lds
    buffer_load_dwordx4 v61, s[44:47], s30 offen offset:1024 lds
    buffer_load_dwordx4 v253, s[44:47], s31 offen offset:2048 lds
    v_mov_b32 v254, 161976
    v_mov_b32 v64, 15
    s_waitcnt vmcnt(54)
    ds_write_b32 v254, v64
    v_mov_b32 v65, 16
    s_waitcnt vmcnt(48)
    ds_write_b32 v254, v65
    v_mov_b32 v66, 17
    s_waitcnt vmcnt(42)
    ds_write_b32 v254, v66
    v_mov_b32 v67, 18
    s_waitcnt vmcnt(36)
    ds_write_b32 v254, v67
    v_mov_b32 v68, 19
    s_waitcnt vmcnt(30)
    ds_write_b32 v254, v68
    v_mov_b32 v69, 20
    s_waitcnt vmcnt(24)
    ds_write_b32 v254, v69
    v_mov_b32 v70, 21
    s_waitcnt vmcnt(18)
    ds_write_b32 v254, v70
    v_mov_b32 v71, 22
    s_waitcnt vmcnt(12)
    ds_write_b32 v254, v71
    v_mov_b32 v72, 23
    s_waitcnt vmcnt(6)
    ds_write_b32 v254, v72
    v_mov_b32 v73, 24
    s_waitcnt vmcnt(0)
    ds_write_b32 v254, v73
L_p2:
    s_cmp_lg_u32 s16, 1
    s_cbranch_scc1 L_nodma0
    s_setprio 3

    v_lshrrev_b32 v176, 9, v253
    v_mul_u32_u24 v177, 1536, v176
    v_add_u32 v177, v177, v253
    v_bfe_u32 v254, v253, 6, 3
    v_lshl_add_u32 v176, v176, 4, v254
    v_mul_u32_u24 v176, 768, v176
    v_and_b32 v254, 48, v253
    v_add_u32 v176, v176, v254

    v_add_u32 v254, 161924, v240

    s_mov_b32 s29, 200000
L_wg0:
    ds_read_b32 v255, v254
    s_waitcnt lgkmcnt(0)
    v_cmp_ne_u32 vcc, 0, v255
    s_cmp_eq_u64 vcc, exec
    s_cbranch_scc1 L_wg0_ok
    s_sleep 2
    s_sub_u32 s29, s29, 1
    s_cmp_lg_u32 s29, 0
    s_cbranch_scc1 L_wg0
L_wg0_ok:

    s_add_u32 s26, s39, 0
    s_cmp_ge_u32 s26, 12
    s_cselect_b32 s27, 12, 0
    s_sub_u32 s26, s26, s27
    s_mul_i32 s26, s26, 64

    s_mov_b32 m0, 131080
    s_add_u32 s30, s26, 0
    s_add_u32 s31, s26, 23552
    s_add_u32 s32, s26, 47104
    buffer_load_dwordx4 v176, s[40:43], s30 offen offset:0 lds
    buffer_load_dwordx4 v176, s[40:43], s31 offen offset:1024 lds
    buffer_load_dwordx4 v176, s[40:43], s32 offen offset:2048 lds
    s_mov_b32 m0, 146448
    s_add_u32 s30, s26, 6144
    s_add_u32 s31, s26, 29696
    s_add_u32 s32, s26, 53248
    buffer_load_dwordx4 v176, s[40:43], s30 offen offset:0 lds
    buffer_load_dwordx4 v176, s[40:43], s31 offen offset:1024 lds
    buffer_load_dwordx4 v176, s[40:43], s32 offen offset:2048 lds

    s_add_u32 s26, s39, 1
    s_cmp_ge_u32 s26, 12
    s_cselect_b32 s27, 12, 0
    s_sub_u32 s26, s26, s27
    s_mul_i32 s26, s26, 64

    s_mov_b32 m0, 134152
    s_add_u32 s30, s26, 0
    s_add_u32 s31, s26, 23552
    s_add_u32 s32, s26, 47104
    buffer_load_dwordx4 v176, s[40:43], s30 offen offset:0 lds
    buffer_load_dwordx4 v176, s[40:43], s31 offen offset:1024 lds
    buffer_load_dwordx4 v176, s[40:43], s32 offen offset:2048 lds
    s_mov_b32 m0, 149520
    s_add_u32 s30, s26, 6144
    s_add_u32 s31, s26, 29696
    s_add_u32 s32, s26, 53248
    buffer_load_dwordx4 v176, s[40:43], s30 offen offset:0 lds
    buffer_load_dwordx4 v176, s[40:43], s31 offen offset:1024 lds
    buffer_load_dwordx4 v176, s[40:43], s32 offen offset:2048 lds

    s_add_u32 s26, s39, 2
    s_cmp_ge_u32 s26, 12
    s_cselect_b32 s27, 12, 0
    s_sub_u32 s26, s26, s27
    s_mul_i32 s26, s26, 64

    s_mov_b32 m0, 137224
    s_add_u32 s30, s26, 0
    s_add_u32 s31, s26, 23552
    s_add_u32 s32, s26, 47104
    buffer_load_dwordx4 v176, s[40:43], s30 offen offset:0 lds
    buffer_load_dwordx4 v176, s[40:43], s31 offen offset:1024 lds
    buffer_load_dwordx4 v176, s[40:43], s32 offen offset:2048 lds
    s_mov_b32 m0, 152592
    s_add_u32 s30, s26, 6144
    s_add_u32 s31, s26, 29696
    s_add_u32 s32, s26, 53248
    buffer_load_dwordx4 v176, s[40:43], s30 offen offset:0 lds
    buffer_load_dwordx4 v176, s[40:43], s31 offen offset:1024 lds
    buffer_load_dwordx4 v176, s[40:43], s32 offen offset:2048 lds

    s_add_u32 s26, s39, 0
    s_cmp_ge_u32 s26, 12
    s_cselect_b32 s27, 12, 0
    s_sub_u32 s26, s26, s27
    s_mul_i32 s26, s26, 6144

    s_mov_b32 m0, 140296
    s_add_u32 s30, s26, 0
    s_add_u32 s31, s26, 1536
    buffer_load_dwordx4 v253, s[44:47], s30 offen lds
    buffer_load_dwordx4 v177, s[44:47], s30 offen offset:1024 lds
    buffer_load_dwordx4 v253, s[44:47], s31 offen offset:2048 lds
    s_mov_b32 m0, 155664
    s_add_u32 s30, s26, 1536
    s_add_u32 s31, s26, 3072
    buffer_load_dwordx4 v253, s[44:47], s30 offen lds
    buffer_load_dwordx4 v177, s[44:47], s30 offen offset:1024 lds
    buffer_load_dwordx4 v253, s[44:47], s31 offen offset:2048 lds

    s_add_u32 s26, s39, 3
    s_cmp_ge_u32 s26, 12
    s_cselect_b32 s27, 12, 0
    s_sub_u32 s26, s26, s27
    s_mul_i32 s26, s26, 64

    s_mov_b32 m0, 143368
    s_add_u32 s30, s26, 0
    s_add_u32 s31, s26, 23552
    s_add_u32 s32, s26, 47104
    buffer_load_dwordx4 v176, s[40:43], s30 offen offset:0 lds
    buffer_load_dwordx4 v176, s[40:43], s31 offen offset:1024 lds
    buffer_load_dwordx4 v176, s[40:43], s32 offen offset:2048 lds
    s_mov_b32 m0, 158736
    s_add_u32 s30, s26, 6144
    s_add_u32 s31, s26, 29696
    s_add_u32 s32, s26, 53248
    buffer_load_dwordx4 v176, s[40:43], s30 offen offset:0 lds
    buffer_load_dwordx4 v176, s[40:43], s31 offen offset:1024 lds
    buffer_load_dwordx4 v176, s[40:43], s32 offen offset:2048 lds
    v_mov_b32 v254, 161976
    v_mov_b32 v180, 1
    s_waitcnt vmcnt(24)
    ds_write_b32 v254, v180
    v_mov_b32 v181, 2
    s_waitcnt vmcnt(18)
    ds_write_b32 v254, v181
    v_mov_b32 v182, 3
    s_waitcnt vmcnt(12)
    ds_write_b32 v254, v182
    v_mov_b32 v183, 4
    s_waitcnt vmcnt(6)
    ds_write_b32 v254, v183
    v_mov_b32 v184, 5
    s_waitcnt vmcnt(0)
    ds_write_b32 v254, v184
L_nodma0:
    v_mov_b32 v254, 161980

    s_mov_b32 s29, 200000
L_wi:
    ds_read_b32 v255, v254
    s_waitcnt lgkmcnt(0)
    v_cmp_eq_u32 vcc, 2, v255
    s_cmp_eq_u64 vcc, exec
    s_cbranch_scc1 L_wi_ok
    s_sleep 2
    s_sub_u32 s29, s29, 1
    s_cmp_lg_u32 s29, 0
    s_cbranch_scc1 L_wi
L_wi_ok:

    v_bfe_u32 v176, v253, 6, 2
    v_and_b32 v177, 48, v253
    v_lshrrev_b32 v178, 9, v253
    v_lshl_add_u32 v176, v178, 3, v176
    v_lshl_add_u32 v254, v176, 6, v177
    v_mul_u32_u24 v176, 192, v176
    v_add_u32 v255, v176, v177
    v_bfe_u32 v176, v253, 8, 1
    v_mul_u32_u24 v177, 65544, v176
    v_add_u32 v254, v254, v177
    v_add_u32 v255, v255, v177
    s_mov_b32 s84, 0xc4eac4ea
    s_mov_b32 s85, 0x377f377f
    s_mov_b32 s83, 0x766fde6e
    s_mov_b32 s86, 0x00003f80
    s_mov_b32 s87, 0x3f800000
    s_mov_b32 s17, 0
    s_mov_b32 s19, 0
    s_setprio 1
L_mtile:

    v_bfe_u32 v224, v253, 8, 1
    v_mul_u32_u24 v224, 50176, v224
    v_subrev_u32 v224, 131080, v224
    v_sub_u32 v254, v254, v224

    s_cmp_ge_u32 s19, 1
    s_cbranch_scc1 L_rd1_go
    v_mov_b32 v224, 161976

    s_mov_b32 s29, 200000
L_rd1:
    ds_read_b32 v225, v224
    s_waitcnt lgkmcnt(0)
    v_cmp_le_u32 vcc, 1, v225
    s_cmp_eq_u64 vcc, exec
    s_cbranch_scc1 L_rd1_ok
    s_sleep 2
    s_sub_u32 s29, s29, 1
    s_cmp_lg_u32 s29, 0
    s_cbranch_scc1 L_rd1
L_rd1_ok:

    v_readfirstlane_b32 s19, v225
L_rd1_go:

    ds_read_b64_tr_b16 v[224:225], v254 offset:0
    ds_read_b64_tr_b16 v[226:227], v254 offset:256
    ds_read_b64_tr_b16 v[228:229], v254 offset:1024
    ds_read_b64_tr_b16 v[230:231], v254 offset:1280
    ds_read_b64_tr_b16 v[232:233], v254 offset:2048
    ds_read_b64_tr_b16 v[234:235], v254 offset:2304
    ds_read_b64_tr_b16 v[236:237], v254 offset:8
    ds_read_b64_tr_b16 v[238:239], v254 offset:264
    ds_read_b64_tr_b16 v[240:241], v254 offset:1032
    ds_read_b64_tr_b16 v[242:243], v254 offset:1288
    s_waitcnt vmcnt(12)
    s_waitcnt lgkmcnt(8)
    v_mfma_f32_16x16x32_bf16 v[176:179], v[224:227], v[0:3], 0
    v_mfma_f32_16x16x32_bf16 v[180:183], v[224:227], v[4:7], 0
    v_mfma_f32_16x16x32_bf16 v[184:187], v[224:227], v[8:11], 0
    v_mfma_f32_16x16x32_bf16 v[188:191], v[224:227], v[12:15], 0
    ds_read_b64_tr_b16 v[224:225], v254 offset:2056
    ds_read_b64_tr_b16 v[226:227], v254 offset:2312
    s_waitcnt lgkmcnt(8)
    v_mfma_f32_16x16x32_bf16 v[176:179], v[228:231], v[16:19], v[176:179]
    v_mfma_f32_16x16x32_bf16 v[180:183], v[228:231], v[20:23], v[180:183]
    v_mfma_f32_16x16x32_bf16 v[184:187], v[228:231], v[24:27], v[184:187]
    v_mfma_f32_16x16x32_bf16 v[188:191], v[228:231], v[28:31], v[188:191]

    s_cmp_ge_u32 s19, 2
    s_cbranch_scc1 L_rd2_go
    v_mov_b32 v228, 161976

    s_mov_b32 s29, 200000
L_rd2:
    ds_read_b32 v229, v228
    s_waitcnt lgkmcnt(0)
    v_cmp_le_u32 vcc, 2, v229
    s_cmp_eq_u64 vcc, exec
    s_cbranch_scc1 L_rd2_ok
    s_sleep 2
    s_sub_u32 s29, s29, 1
    s_cmp_lg_u32 s29, 0
    s_cbranch_scc1 L_rd2
L_rd2_ok:

    v_readfirstlane_b32 s19, v229
L_rd2_go:

    ds_read_b64_tr_b16 v[228:229], v254 offset:3072
    ds_read_b64_tr_b16 v[230:231], v254 offset:3328
    s_waitcnt lgkmcnt(8)
    v_mfma_f32_16x16x32_bf16 v[176:179], v[232:235], v[32:35], v[176:179]
    v_mfma_f32_16x16x32_bf16 v[180:183], v[232:235], v[36:39], v[180:183]
    v_mfma_f32_16x16x32_bf16 v[184:187], v[232:235], v[40:43], v[184:187]
    v_mfma_f32_16x16x32_bf16 v[188:191], v[232:235], v[44:47], v[188:191]
    ds_read_b64_tr_b16 v[232:233], v254 offset:4096
    ds_read_b64_tr_b16 v[234:235], v254 offset:4352
    s_waitcnt lgkmcnt(8)
    v_mfma_f32_16x16x32_bf16 v[192:195], v[236:239], v[0:3], 0
    v_mfma_f32_16x16x32_bf16 v[196:199], v[236:239], v[4:7], 0
    v_mfma_f32_16x16x32_bf16 v[200:203], v[236:239], v[8:11], 0
    v_mfma_f32_16x16x32_bf16 v[204:207], v[236:239], v[12:15], 0
    ds_read_b64_tr_b16 v[236:237], v254 offset:5120
    ds_read_b64_tr_b16 v[238:239], v254 offset:5376
    s_waitcnt lgkmcnt(8)
    v_mfma_f32_16x16x32_bf16 v[192:195], v[240:243], v[16:19], v[192:195]
    v_lshlrev_b32_sdwa v176, 1, v176 dst_sel:DWORD dst_unused:UNUSED_PAD src0_sel:DWORD src1_sel:WORD_1
    v_lshlrev_b32_sdwa v177, 1, v177 dst_sel:DWORD dst_unused:UNUSED_PAD src0_sel:DWORD src1_sel:WORD_1
    ds_read_u16_d16 v176, v176
    ds_read_u16_d16_hi v177, v177
    v_lshlrev_b32_sdwa v178, 1, v178 dst_sel:DWORD dst_unused:UNUSED_PAD src0_sel:DWORD src1_sel:WORD_1
    v_mfma_f32_16x16x32_bf16 v[196:199], v[240:243], v[20:23], v[196:199]
    v_lshlrev_b32_sdwa v179, 1, v179 dst_sel:DWORD dst_unused:UNUSED_PAD src0_sel:DWORD src1_sel:WORD_1
    ds_read_u16_d16 v178, v178
    ds_read_u16_d16_hi v179, v179
    v_lshlrev_b32_sdwa v180, 1, v180 dst_sel:DWORD dst_unused:UNUSED_PAD src0_sel:DWORD src1_sel:WORD_1
    v_lshlrev_b32_sdwa v181, 1, v181 dst_sel:DWORD dst_unused:UNUSED_PAD src0_sel:DWORD src1_sel:WORD_1
    ds_read_u16_d16 v180, v180
    ds_read_u16_d16_hi v181, v181
    v_mfma_f32_16x16x32_bf16 v[200:203], v[240:243], v[24:27], v[200:203]
    v_lshlrev_b32_sdwa v182, 1, v182 dst_sel:DWORD dst_unused:UNUSED_PAD src0_sel:DWORD src1_sel:WORD_1
    v_lshlrev_b32_sdwa v183, 1, v183 dst_sel:DWORD dst_unused:UNUSED_PAD src0_sel:DWORD src1_sel:WORD_1
    ds_read_u16_d16 v182, v182
    ds_read_u16_d16_hi v183, v183
    v_mfma_f32_16x16x32_bf16 v[204:207], v[240:243], v[28:31], v[204:207]
    ds_read_b64_tr_b16 v[240:241], v254 offset:3080
    ds_read_b64_tr_b16 v[242:243], v254 offset:3336
    v_lshlrev_b32_sdwa v184, 1, v184 dst_sel:DWORD dst_unused:UNUSED_PAD src0_sel:DWORD src1_sel:WORD_1
    v_lshlrev_b32_sdwa v185, 1, v185 dst_sel:DWORD dst_unused:UNUSED_PAD src0_sel:DWORD src1_sel:WORD_1
    ds_read_u16_d16 v184, v184
    ds_read_u16_d16_hi v185, v185
    v_lshlrev_b32_sdwa v186, 1, v186 dst_sel:DWORD dst_unused:UNUSED_PAD src0_sel:DWORD src1_sel:WORD_1
    s_waitcnt lgkmcnt(14)
    v_mfma_f32_16x16x32_bf16 v[192:195], v[224:227], v[32:35], v[192:195]
    v_lshlrev_b32_sdwa v187, 1, v187 dst_sel:DWORD dst_unused:UNUSED_PAD src0_sel:DWORD src1_sel:WORD_1
    ds_read_u16_d16 v186, v186
    ds_read_u16_d16_hi v187, v187
    v_lshlrev_b32_sdwa v188, 1, v188 dst_sel:DWORD dst_unused:UNUSED_PAD src0_sel:DWORD src1_sel:WORD_1
    v_lshlrev_b32_sdwa v189, 1, v189 dst_sel:DWORD dst_unused:UNUSED_PAD src0_sel:DWORD src1_sel:WORD_1
    ds_read_u16_d16 v188, v188
    ds_read_u16_d16_hi v189, v189
    v_mfma_f32_16x16x32_bf16 v[196:199], v[224:227], v[36:39], v[196:199]
    v_lshlrev_b32_sdwa v190, 1, v190 dst_sel:DWORD dst_unused:UNUSED_PAD src0_sel:DWORD src1_sel:WORD_1
    v_lshlrev_b32_sdwa v191, 1, v191 dst_sel:DWORD dst_unused:UNUSED_PAD src0_sel:DWORD src1_sel:WORD_1
    ds_read_u16_d16 v190, v190
    ds_read_u16_d16_hi v191, v191
    v_mfma_f32_16x16x32_bf16 v[200:203], v[224:227], v[40:43], v[200:203]
    v_mfma_f32_16x16x32_bf16 v[204:207], v[224:227], v[44:47], v[204:207]
    ds_read_b64_tr_b16 v[224:225], v254 offset:4104
    ds_read_b64_tr_b16 v[226:227], v254 offset:4360
    v_mfma_f32_16x16x32_bf16 v[208:211], v[228:231], v[0:3], 0
    v_mfma_f32_16x16x32_bf16 v[212:215], v[228:231], v[4:7], 0
    v_mfma_f32_16x16x32_bf16 v[216:219], v[228:231], v[8:11], 0
    v_mfma_f32_16x16x32_bf16 v[220:223], v[228:231], v[12:15], 0
    ds_read_b64_tr_b16 v[228:229], v254 offset:5128
    ds_read_b64_tr_b16 v[230:231], v254 offset:5384
    v_mfma_f32_16x16x32_bf16 v[208:211], v[232:235], v[16:19], v[208:211]
    s_waitcnt lgkmcnt(14)
    v_or_b32 v144, v176, v177
    v_lshlrev_b32_sdwa v192, 1, v192 dst_sel:DWORD dst_unused:UNUSED_PAD src0_sel:DWORD src1_sel:WORD_1
    v_lshlrev_b32_sdwa v193, 1, v193 dst_sel:DWORD dst_unused:UNUSED_PAD src0_sel:DWORD src1_sel:WORD_1
    ds_read_u16_d16 v192, v192
    ds_read_u16_d16_hi v193, v193
    v_or_b32 v145, v178, v179
    v_mfma_f32_16x16x32_bf16 v[212:215], v[232:235], v[20:23], v[212:215]
    v_lshlrev_b32_sdwa v194, 1, v194 dst_sel:DWORD dst_unused:UNUSED_PAD src0_sel:DWORD src1_sel:WORD_1
    v_lshlrev_b32_sdwa v195, 1, v195 dst_sel:DWORD dst_unused:UNUSED_PAD src0_sel:DWORD src1_sel:WORD_1
    ds_read_u16_d16 v194, v194
    ds_read_u16_d16_hi v195, v195
    v_or_b32 v148, v180, v181
    v_lshlrev_b32_sdwa v196, 1, v196 dst_sel:DWORD dst_unused:UNUSED_PAD src0_sel:DWORD src1_sel:WORD_1
    v_mfma_f32_16x16x32_bf16 v[216:219], v[232:235], v[24:27], v[216:219]
    v_lshlrev_b32_sdwa v197, 1, v197 dst_sel:DWORD dst_unused:UNUSED_PAD src0_sel:DWORD src1_sel:WORD_1
    ds_read_u16_d16 v196, v196
    ds_read_u16_d16_hi v197, v197
    v_or_b32 v149, v182, v183
    v_lshlrev_b32_sdwa v198, 1, v198 dst_sel:DWORD dst_unused:UNUSED_PAD src0_sel:DWORD src1_sel:WORD_1
    v_lshlrev_b32_sdwa v199, 1, v199 dst_sel:DWORD dst_unused:UNUSED_PAD src0_sel:DWORD src1_sel:WORD_1
    ds_read_u16_d16 v198, v198
    ds_read_u16_d16_hi v199, v199
    v_mfma_f32_16x16x32_bf16 v[220:223], v[232:235], v[28:31], v[220:223]

    s_cmp_ge_u32 s19, 3
    s_cbranch_scc1 L_rd3_go
    v_mov_b32 v232, 161976

    s_mov_b32 s29, 200000
L_rd3:
    ds_read_b32 v233, v232
    s_waitcnt lgkmcnt(0)
    v_cmp_le_u32 vcc, 3, v233
    s_cmp_eq_u64 vcc, exec
    s_cbranch_scc1 L_rd3_ok
    s_sleep 2
    s_sub_u32 s29, s29, 1
    s_cmp_lg_u32 s29, 0
    s_cbranch_scc1 L_rd3
L_rd3_ok:

    v_readfirstlane_b32 s19, v233
L_rd3_go:

    ds_read_b64_tr_b16 v[232:233], v254 offset:6144
    ds_read_b64_tr_b16 v[234:235], v254 offset:6400
    s_waitcnt lgkmcnt(14)
    v_or_b32 v152, v184, v185
    v_lshlrev_b32_sdwa v200, 1, v200 dst_sel:DWORD dst_unused:UNUSED_PAD src0_sel:DWORD src1_sel:WORD_1
    v_lshlrev_b32_sdwa v201, 1, v201 dst_sel:DWORD dst_unused:UNUSED_PAD src0_sel:DWORD src1_sel:WORD_1
    ds_read_u16_d16 v200, v200
    ds_read_u16_d16_hi v201, v201
    v_or_b32 v153, v186, v187
    v_mfma_f32_16x16x32_bf16 v[208:211], v[236:239], v[32:35], v[208:211]
    v_lshlrev_b32_sdwa v202, 1, v202 dst_sel:DWORD dst_unused:UNUSED_PAD src0_sel:DWORD src1_sel:WORD_1
    v_lshlrev_b32_sdwa v203, 1, v203 dst_sel:DWORD dst_unused:UNUSED_PAD src0_sel:DWORD src1_sel:WORD_1
    ds_read_u16_d16 v202, v202
    ds_read_u16_d16_hi v203, v203
    v_or_b32 v156, v188, v189
    v_lshlrev_b32_sdwa v204, 1, v204 dst_sel:DWORD dst_unused:UNUSED_PAD src0_sel:DWORD src1_sel:WORD_1
    v_mfma_f32_16x16x32_bf16 v[212:215], v[236:239], v[36:39], v[212:215]
    v_lshlrev_b32_sdwa v205, 1, v205 dst_sel:DWORD dst_unused:UNUSED_PAD src0_sel:DWORD src1_sel:WORD_1
    ds_read_u16_d16 v204, v204
    ds_read_u16_d16_hi v205, v205
    v_or_b32 v157, v190, v191
    v_lshlrev_b32_sdwa v206, 1, v206 dst_sel:DWORD dst_unused:UNUSED_PAD src0_sel:DWORD src1_sel:WORD_1
    v_lshlrev_b32_sdwa v207, 1, v207 dst_sel:DWORD dst_unused:UNUSED_PAD src0_sel:DWORD src1_sel:WORD_1
    ds_read_u16_d16 v206, v206
    ds_read_u16_d16_hi v207, v207
    v_mfma_f32_16x16x32_bf16 v[216:219], v[236:239], v[40:43], v[216:219]
    v_mfma_f32_16x16x32_bf16 v[220:223], v[236:239], v[44:47], v[220:223]
    v_bfe_u32 v236, v253, 8, 1
    v_mul_u32_u24 v236, 50176, v236
    v_subrev_u32 v236, 131080, v236
    v_sub_u32 v255, v255, v236

    s_cmp_ge_u32 s19, 4
    s_cbranch_scc1 L_rd4_go
    v_mov_b32 v236, 161976

    s_mov_b32 s29, 200000
L_rd4:
    ds_read_b32 v237, v236
    s_waitcnt lgkmcnt(0)
    v_cmp_le_u32 vcc, 4, v237
    s_cmp_eq_u64 vcc, exec
    s_cbranch_scc1 L_rd4_ok
    s_sleep 2
    s_sub_u32 s29, s29, 1
    s_cmp_lg_u32 s29, 0
    s_cbranch_scc1 L_rd4
L_rd4_ok:

    v_readfirstlane_b32 s19, v237
L_rd4_go:

    ds_read_b64_tr_b16 v[236:237], v255 offset:9216
    ds_read_b64_tr_b16 v[238:239], v255 offset:9984
    v_mfma_f32_16x16x32_bf16 v[176:179], v[240:243], v[0:3], 0
    v_mfma_f32_16x16x32_bf16 v[180:183], v[240:243], v[4:7], 0
    v_mfma_f32_16x16x32_bf16 v[184:187], v[240:243], v[8:11], 0
    v_mfma_f32_16x16x32_bf16 v[188:191], v[240:243], v[12:15], 0
    ds_read_b64_tr_b16 v[240:241], v254 offset:7168
    ds_read_b64_tr_b16 v[242:243], v254 offset:7424
    s_waitcnt lgkmcnt(14)
    v_mfma_f32_16x16x32_bf16 v[176:179], v[224:227], v[16:19], v[176:179]
    v_or_b32 v146, v192, v193
    v_lshlrev_b32_sdwa v208, 1, v208 dst_sel:DWORD dst_unused:UNUSED_PAD src0_sel:DWORD src1_sel:WORD_1
    v_lshlrev_b32_sdwa v209, 1, v209 dst_sel:DWORD dst_unused:UNUSED_PAD src0_sel:DWORD src1_sel:WORD_1
    ds_read_u16_d16 v208, v208
    ds_read_u16_d16_hi v209, v209
    v_or_b32 v147, v194, v195
    v_mfma_f32_16x16x32_bf16 v[180:183], v[224:227], v[20:23], v[180:183]
    v_lshlrev_b32_sdwa v210, 1, v210 dst_sel:DWORD dst_unused:UNUSED_PAD src0_sel:DWORD src1_sel:WORD_1
    v_lshlrev_b32_sdwa v211, 1, v211 dst_sel:DWORD dst_unused:UNUSED_PAD src0_sel:DWORD src1_sel:WORD_1
    ds_read_u16_d16 v210, v210
    ds_read_u16_d16_hi v211, v211
    v_or_b32 v150, v196, v197
    v_lshlrev_b32_sdwa v212, 1, v212 dst_sel:DWORD dst_unused:UNUSED_PAD src0_sel:DWORD src1_sel:WORD_1
    v_mfma_f32_16x16x32_bf16 v[184:187], v[224:227], v[24:27], v[184:187]
    v_lshlrev_b32_sdwa v213, 1, v213 dst_sel:DWORD dst_unused:UNUSED_PAD src0_sel:DWORD src1_sel:WORD_1
    ds_read_u16_d16 v212, v212
    ds_read_u16_d16_hi v213, v213
    v_or_b32 v151, v198, v199
    v_lshlrev_b32_sdwa v214, 1, v214 dst_sel:DWORD dst_unused:UNUSED_PAD src0_sel:DWORD src1_sel:WORD_1
    v_lshlrev_b32_sdwa v215, 1, v215 dst_sel:DWORD dst_unused:UNUSED_PAD src0_sel:DWORD src1_sel:WORD_1
    ds_read_u16_d16 v214, v214
    ds_read_u16_d16_hi v215, v215
    v_mfma_f32_16x16x32_bf16 v[188:191], v[224:227], v[28:31], v[188:191]
    ds_read_b64_tr_b16 v[224:225], v255 offset:9224
    ds_read_b64_tr_b16 v[226:227], v255 offset:9992
    s_waitcnt lgkmcnt(14)
    v_or_b32 v154, v200, v201
    v_lshlrev_b32_sdwa v216, 1, v216 dst_sel:DWORD dst_unused:UNUSED_PAD src0_sel:DWORD src1_sel:WORD_1
    v_lshlrev_b32_sdwa v217, 1, v217 dst_sel:DWORD dst_unused:UNUSED_PAD src0_sel:DWORD src1_sel:WORD_1
    ds_read_u16_d16 v216, v216
    ds_read_u16_d16_hi v217, v217
    v_or_b32 v155, v202, v203
    v_mfma_f32_16x16x32_bf16 v[176:179], v[228:231], v[32:35], v[176:179]
    v_lshlrev_b32_sdwa v218, 1, v218 dst_sel:DWORD dst_unused:UNUSED_PAD src0_sel:DWORD src1_sel:WORD_1
    v_lshlrev_b32_sdwa v219, 1, v219 dst_sel:DWORD dst_unused:UNUSED_PAD src0_sel:DWORD src1_sel:WORD_1
    ds_read_u16_d16 v218, v218
    ds_read_u16_d16_hi v219, v219
    v_or_b32 v158, v204, v205
    v_lshlrev_b32_sdwa v220, 1, v220 dst_sel:DWORD dst_unused:UNUSED_PAD src0_sel:DWORD src1_sel:WORD_1
    v_mfma_f32_16x16x32_bf16 v[180:183], v[228:231], v[36:39], v[180:183]
    v_lshlrev_b32_sdwa v221, 1, v221 dst_sel:DWORD dst_unused:UNUSED_PAD src0_sel:DWORD src1_sel:WORD_1
    ds_read_u16_d16 v220, v220
    ds_read_u16_d16_hi v221, v221
    v_or_b32 v159, v206, v207
    v_lshlrev_b32_sdwa v222, 1, v222 dst_sel:DWORD dst_unused:UNUSED_PAD src0_sel:DWORD src1_sel:WORD_1
    v_lshlrev_b32_sdwa v223, 1, v223 dst_sel:DWORD dst_unused:UNUSED_PAD src0_sel:DWORD src1_sel:WORD_1
    ds_read_u16_d16 v222, v222
    ds_read_u16_d16_hi v223, v223

    s_cmp_eq_u32 s38, 0
    s_cbranch_scc1 L_rdh_go
    v_mov_b32 v244, 161972

    s_mov_b32 s29, 200000
L_wi9:
    ds_read_b32 v245, v244
    s_waitcnt lgkmcnt(0)
    v_cmp_eq_u32 vcc, 9, v245
    s_cmp_eq_u64 vcc, exec
    s_cbranch_scc1 L_wi9_ok
    s_sleep 2
    s_sub_u32 s29, s29, 1
    s_cmp_lg_u32 s29, 0
    s_cbranch_scc1 L_wi9
L_wi9_ok:

    v_lshrrev_b32 v244, 7, v253
    v_mul_u32_u24 v244, 640, v244
    v_add_u32 v244, v244, v253
    v_add_u32 v245, 196608, v244
    buffer_store_dwordx4 v[48:51], v244, s[8:11], s36 offen offset:0 sc1
    buffer_store_dwordx4 v[52:55], v244, s[8:11], s36 offen offset:128 sc1
    buffer_store_dwordx4 v[56:59], v244, s[8:11], s36 offen offset:256 sc1
    buffer_store_dwordx4 v[60:63], v244, s[8:11], s37 offen offset:0 sc1
    buffer_store_dwordx4 v[64:67], v244, s[8:11], s37 offen offset:128 sc1
    buffer_store_dwordx4 v[68:71], v244, s[8:11], s37 offen offset:256 sc1
    buffer_store_dwordx4 v[72:75], v245, s[8:11], s36 offen offset:0 sc1
    buffer_store_dwordx4 v[76:79], v245, s[8:11], s36 offen offset:128 sc1
    buffer_store_dwordx4 v[80:83], v245, s[8:11], s36 offen offset:256 sc1
    buffer_store_dwordx4 v[84:87], v245, s[8:11], s37 offen offset:0 sc1
    buffer_store_dwordx4 v[88:91], v245, s[8:11], s37 offen offset:128 sc1
    buffer_store_dwordx4 v[92:95], v245, s[8:11], s37 offen offset:256 sc1
    s_mov_b32 s38, 0
L_rdh_go:
    v_mfma_f32_16x16x32_bf16 v[184:187], v[228:231], v[40:43], v[184:187]
    v_mfma_f32_16x16x32_bf16 v[188:191], v[228:231], v[44:47], v[188:191]
    ds_read_b64_tr_b16 v[228:229], v254 offset:8192
    ds_read_b64_tr_b16 v[230:231], v254 offset:8448
    v_mfma_f32_16x16x32_bf16 v[192:195], v[232:235], v[0:3], 0
    v_mfma_f32_16x16x32_bf16 v[196:199], v[232:235], v[4:7], 0
    v_mfma_f32_16x16x32_bf16 v[200:203], v[232:235], v[8:11], 0
    v_mfma_f32_16x16x32_bf16 v[204:207], v[232:235], v[12:15], 0
    ds_read_b64_tr_b16 v[232:233], v255 offset:9280
    ds_read_b64_tr_b16 v[234:235], v255 offset:10048
    s_waitcnt lgkmcnt(14)
    v_mfma_f32_16x16x32_bf16 v[48:51], v[236:239], v[144:147], 0
    v_or_b32 v160, v208, v209
    v_lshlrev_b32_sdwa v176, 1, v176 dst_sel:DWORD dst_unused:UNUSED_PAD src0_sel:DWORD src1_sel:WORD_1
    v_mfma_f32_16x16x32_bf16 v[56:59], v[236:239], v[148:151], 0
    v_lshlrev_b32_sdwa v177, 1, v177 dst_sel:DWORD dst_unused:UNUSED_PAD src0_sel:DWORD src1_sel:WORD_1
    ds_read_u16_d16 v176, v176
    ds_read_u16_d16_hi v177, v177
    v_mfma_f32_16x16x32_bf16 v[64:67], v[236:239], v[152:155], 0
    v_or_b32 v161, v210, v211
    v_mfma_f32_16x16x32_bf16 v[72:75], v[236:239], v[156:159], 0
    ds_read_b64_tr_b16 v[236:237], v254 offset:6152
    ds_read_b64_tr_b16 v[238:239], v254 offset:6408
    v_lshlrev_b32_sdwa v178, 1, v178 dst_sel:DWORD dst_unused:UNUSED_PAD src0_sel:DWORD src1_sel:WORD_1
    v_lshlrev_b32_sdwa v179, 1, v179 dst_sel:DWORD dst_unused:UNUSED_PAD src0_sel:DWORD src1_sel:WORD_1
    ds_read_u16_d16 v178, v178
    ds_read_u16_d16_hi v179, v179
    v_mfma_f32_16x16x32_bf16 v[192:195], v[240:243], v[16:19], v[192:195]
    v_or_b32 v164, v212, v213
    v_mfma_f32_16x16x32_bf16 v[196:199], v[240:243], v[20:23], v[196:199]
    v_lshlrev_b32_sdwa v180, 1, v180 dst_sel:DWORD dst_unused:UNUSED_PAD src0_sel:DWORD src1_sel:WORD_1
    v_mfma_f32_16x16x32_bf16 v[200:203], v[240:243], v[24:27], v[200:203]
    v_lshlrev_b32_sdwa v181, 1, v181 dst_sel:DWORD dst_unused:UNUSED_PAD src0_sel:DWORD src1_sel:WORD_1
    ds_read_u16_d16 v180, v180
    ds_read_u16_d16_hi v181, v181
    v_or_b32 v165, v214, v215
    v_mfma_f32_16x16x32_bf16 v[204:207], v[240:243], v[28:31], v[204:207]
    ds_read_b64_tr_b16 v[240:241], v255 offset:9288
    ds_read_b64_tr_b16 v[242:243], v255 offset:10056
    v_lshlrev_b32_sdwa v182, 1, v182 dst_sel:DWORD dst_unused:UNUSED_PAD src0_sel:DWORD src1_sel:WORD_1
    s_waitcnt lgkmcnt(14)
    v_mfma_f32_16x16x32_bf16 v[52:55], v[224:227], v[144:147], 0
    v_lshlrev_b32_sdwa v183, 1, v183 dst_sel:DWORD dst_unused:UNUSED_PAD src0_sel:DWORD src1_sel:WORD_1
    ds_read_u16_d16 v182, v182
    ds_read_u16_d16_hi v183, v183
    v_mfma_f32_16x16x32_bf16 v[60:63], v[224:227], v[148:151], 0
    v_or_b32 v168, v216, v217
    v_lshlrev_b32_sdwa v184, 1, v184 dst_sel:DWORD dst_unused:UNUSED_PAD src0_sel:DWORD src1_sel:WORD_1
    v_mfma_f32_16x16x32_bf16 v[68:71], v[224:227], v[152:155], 0
    v_lshlrev_b32_sdwa v185, 1, v185 dst_sel:DWORD dst_unused:UNUSED_PAD src0_sel:DWORD src1_sel:WORD_1
    ds_read_u16_d16 v184, v184
    ds_read_u16_d16_hi v185, v185
    v_mfma_f32_16x16x32_bf16 v[76:79], v[224:227], v[156:159], 0
    ds_read_b64_tr_b16 v[224:225], v254 offset:7176
    ds_read_b64_tr_b16 v[226:227], v254 offset:7432
    v_or_b32 v169, v218, v219
    s_waitcnt lgkmcnt(14)
    v_mfma_f32_16x16x32_bf16 v[192:195], v[228:231], v[32:35], v[192:195]
    v_lshlrev_b32_sdwa v186, 1, v186 dst_sel:DWORD dst_unused:UNUSED_PAD src0_sel:DWORD src1_sel:WORD_1
    v_lshlrev_b32_sdwa v187, 1, v187 dst_sel:DWORD dst_unused:UNUSED_PAD src0_sel:DWORD src1_sel:WORD_1
    ds_read_u16_d16 v186, v186
    ds_read_u16_d16_hi v187, v187
    v_mfma_f32_16x16x32_bf16 v[196:199], v[228:231], v[36:39], v[196:199]
    v_or_b32 v172, v220, v221
    v_mfma_f32_16x16x32_bf16 v[200:203], v[228:231], v[40:43], v[200:203]
    v_lshlrev_b32_sdwa v188, 1, v188 dst_sel:DWORD dst_unused:UNUSED_PAD src0_sel:DWORD src1_sel:WORD_1
    v_mfma_f32_16x16x32_bf16 v[204:207], v[228:231], v[44:47], v[204:207]
    ds_read_b64_tr_b16 v[228:229], v255 offset:9344
    ds_read_b64_tr_b16 v[230:231], v255 offset:10112
    v_lshlrev_b32_sdwa v189, 1, v189 dst_sel:DWORD dst_unused:UNUSED_PAD src0_sel:DWORD src1_sel:WORD_1
    ds_read_u16_d16 v188, v188
    ds_read_u16_d16_hi v189, v189
    v_or_b32 v173, v222, v223
    v_mfma_f32_16x16x32_bf16 v[80:83], v[232:235], v[144:147], 0
    v_lshlrev_b32_sdwa v190, 1, v190 dst_sel:DWORD dst_unused:UNUSED_PAD src0_sel:DWORD src1_sel:WORD_1
    v_mfma_f32_16x16x32_bf16 v[88:91], v[232:235], v[148:151], 0
    v_lshlrev_b32_sdwa v191, 1, v191 dst_sel:DWORD dst_unused:UNUSED_PAD src0_sel:DWORD src1_sel:WORD_1
    ds_read_u16_d16 v190, v190
    ds_read_u16_d16_hi v191, v191
    v_mfma_f32_16x16x32_bf16 v[96:99], v[232:235], v[152:155], 0
    v_mfma_f32_16x16x32_bf16 v[104:107], v[232:235], v[156:159], 0
    ds_read_b64_tr_b16 v[232:233], v254 offset:8200
    ds_read_b64_tr_b16 v[234:235], v254 offset:8456
    s_waitcnt lgkmcnt(14)
    v_mfma_f32_16x16x32_bf16 v[208:211], v[236:239], v[0:3], 0
    v_or_b32 v162, v176, v177
    v_lshlrev_b32_sdwa v192, 1, v192 dst_sel:DWORD dst_unused:UNUSED_PAD src0_sel:DWORD src1_sel:WORD_1
    v_mfma_f32_16x16x32_bf16 v[212:215], v[236:239], v[4:7], 0
    v_lshlrev_b32_sdwa v193, 1, v193 dst_sel:DWORD dst_unused:UNUSED_PAD src0_sel:DWORD src1_sel:WORD_1
    ds_read_u16_d16 v192, v192
    ds_read_u16_d16_hi v193, v193
    v_mfma_f32_16x16x32_bf16 v[216:219], v[236:239], v[8:11], 0
    v_or_b32 v163, v178, v179
    v_mfma_f32_16x16x32_bf16 v[220:223], v[236:239], v[12:15], 0
    ds_read_b64_tr_b16 v[236:237], v255 offset:9352
    ds_read_b64_tr_b16 v[238:239], v255 offset:10120
    v_lshlrev_b32_sdwa v194, 1, v194 dst_sel:DWORD dst_unused:UNUSED_PAD src0_sel:DWORD src1_sel:WORD_1
    v_mfma_f32_16x16x32_bf16 v[84:87], v[240:243], v[144:147], 0
    v_lshlrev_b32_sdwa v195, 1, v195 dst_sel:DWORD dst_unused:UNUSED_PAD src0_sel:DWORD src1_sel:WORD_1
    ds_read_u16_d16 v194, v194
    ds_read_u16_d16_hi v195, v195
    v_mfma_f32_16x16x32_bf16 v[92:95], v[240:243], v[148:151], 0
    v_or_b32 v166, v180, v181
    v_mfma_f32_16x16x32_bf16 v[100:103], v[240:243], v[152:155], 0
    v_lshlrev_b32_sdwa v196, 1, v196 dst_sel:DWORD dst_unused:UNUSED_PAD src0_sel:DWORD src1_sel:WORD_1
    v_mfma_f32_16x16x32_bf16 v[108:111], v[240:243], v[156:159], 0

    s_cmp_ge_u32 s19, 5
    s_cbranch_scc1 L_rd5_go
    v_mov_b32 v240, 161976

    s_mov_b32 s29, 200000
L_rd5:
    ds_read_b32 v241, v240
    s_waitcnt lgkmcnt(0)
    v_cmp_le_u32 vcc, 5, v241
    s_cmp_eq_u64 vcc, exec
    s_cbranch_scc1 L_rd5_ok
    s_sleep 2
    s_sub_u32 s29, s29, 1
    s_cmp_lg_u32 s29, 0
    s_cbranch_scc1 L_rd5
L_rd5_ok:

    v_readfirstlane_b32 s19, v241
L_rd5_go:

    ds_read_b64_tr_b16 v[240:241], v254 offset:12288
    ds_read_b64_tr_b16 v[242:243], v254 offset:12544
    v_lshlrev_b32_sdwa v197, 1, v197 dst_sel:DWORD dst_unused:UNUSED_PAD src0_sel:DWORD src1_sel:WORD_1
    ds_read_u16_d16 v196, v196
    ds_read_u16_d16_hi v197, v197
    s_waitcnt lgkmcnt(14)
    v_mfma_f32_16x16x32_bf16 v[208:211], v[224:227], v[16:19], v[208:211]
    v_or_b32 v167, v182, v183
    v_mfma_f32_16x16x32_bf16 v[212:215], v[224:227], v[20:23], v[212:215]
    v_lshlrev_b32_sdwa v198, 1, v198 dst_sel:DWORD dst_unused:UNUSED_PAD src0_sel:DWORD src1_sel:WORD_1
    v_mfma_f32_16x16x32_bf16 v[216:219], v[224:227], v[24:27], v[216:219]
    v_lshlrev_b32_sdwa v199, 1, v199 dst_sel:DWORD dst_unused:UNUSED_PAD src0_sel:DWORD src1_sel:WORD_1
    ds_read_u16_d16 v198, v198
    ds_read_u16_d16_hi v199, v199
    v_mfma_f32_16x16x32_bf16 v[220:223], v[224:227], v[28:31], v[220:223]
    v_bfe_u32 v224, v253, 8, 1
    v_mul_u32_u24 v224, 50176, v224
    v_subrev_u32 v224, 131080, v224
    v_add_u32 v255, v255, v224

    s_cmp_ge_u32 s19, 6
    s_cbranch_scc1 L_rd6_go
    v_mov_b32 v224, 161976

    s_mov_b32 s29, 200000
L_rd6:
    ds_read_b32 v225, v224
    s_waitcnt lgkmcnt(0)
    v_cmp_le_u32 vcc, 6, v225
    s_cmp_eq_u64 vcc, exec
    s_cbranch_scc1 L_rd6_ok
    s_sleep 2
    s_sub_u32 s29, s29, 1
    s_cmp_lg_u32 s29, 0
    s_cbranch_scc1 L_rd6
L_rd6_ok:

    v_readfirstlane_b32 s19, v225
L_rd6_go:

    ds_read_b64_tr_b16 v[224:225], v255 offset:7168
    ds_read_b64_tr_b16 v[226:227], v255 offset:7936
    v_or_b32 v170, v184, v185
    v_lshlrev_b32_sdwa v200, 1, v200 dst_sel:DWORD dst_unused:UNUSED_PAD src0_sel:DWORD src1_sel:WORD_1
    v_mfma_f32_16x16x32_bf16 v[112:115], v[228:231], v[144:147], 0
    v_lshlrev_b32_sdwa v201, 1, v201 dst_sel:DWORD dst_unused:UNUSED_PAD src0_sel:DWORD src1_sel:WORD_1
    ds_read_u16_d16 v200, v200
    ds_read_u16_d16_hi v201, v201
    v_mfma_f32_16x16x32_bf16 v[120:123], v[228:231], v[148:151], 0
    v_or_b32 v171, v186, v187
    v_mfma_f32_16x16x32_bf16 v[128:131], v[228:231], v[152:155], 0
    v_lshlrev_b32_sdwa v202, 1, v202 dst_sel:DWORD dst_unused:UNUSED_PAD src0_sel:DWORD src1_sel:WORD_1
    v_mfma_f32_16x16x32_bf16 v[136:139], v[228:231], v[156:159], 0
    ds_read_b64_tr_b16 v[228:229], v254 offset:13312
    ds_read_b64_tr_b16 v[230:231], v254 offset:13568
    v_lshlrev_b32_sdwa v203, 1, v203 dst_sel:DWORD dst_unused:UNUSED_PAD src0_sel:DWORD src1_sel:WORD_1
    ds_read_u16_d16 v202, v202
    ds_read_u16_d16_hi v203, v203
    s_waitcnt lgkmcnt(14)
    v_mfma_f32_16x16x32_bf16 v[208:211], v[232:235], v[32:35], v[208:211]
    v_or_b32 v174, v188, v189
    v_mfma_f32_16x16x32_bf16 v[212:215], v[232:235], v[36:39], v[212:215]
    v_lshlrev_b32_sdwa v204, 1, v204 dst_sel:DWORD dst_unused:UNUSED_PAD src0_sel:DWORD src1_sel:WORD_1
    v_mfma_f32_16x16x32_bf16 v[216:219], v[232:235], v[40:43], v[216:219]
    v_lshlrev_b32_sdwa v205, 1, v205 dst_sel:DWORD dst_unused:UNUSED_PAD src0_sel:DWORD src1_sel:WORD_1
    ds_read_u16_d16 v204, v204
    ds_read_u16_d16_hi v205, v205
    v_mfma_f32_16x16x32_bf16 v[220:223], v[232:235], v[44:47], v[220:223]
    ds_read_b64_tr_b16 v[232:233], v255 offset:7176
    ds_read_b64_tr_b16 v[234:235], v255 offset:7944
    v_or_b32 v175, v190, v191
    v_mfma_f32_16x16x32_bf16 v[116:119], v[236:239], v[144:147], 0
    v_lshlrev_b32_sdwa v206, 1, v206 dst_sel:DWORD dst_unused:UNUSED_PAD src0_sel:DWORD src1_sel:WORD_1
    v_mfma_f32_16x16x32_bf16 v[124:127], v[236:239], v[148:151], 0
    v_lshlrev_b32_sdwa v207, 1, v207 dst_sel:DWORD dst_unused:UNUSED_PAD src0_sel:DWORD src1_sel:WORD_1
    ds_read_u16_d16 v206, v206
    ds_read_u16_d16_hi v207, v207
    v_mfma_f32_16x16x32_bf16 v[132:135], v[236:239], v[152:155], 0
    buffer_load_dwordx4 v[244:247], v252, s[4:7], s24 offen offset:0 sc1
    buffer_load_dwordx4 v[248:251], v252, s[4:7], s24 offen offset:64 sc1
    v_mfma_f32_16x16x32_bf16 v[140:143], v[236:239], v[156:159], 0
    ds_read_b64_tr_b16 v[236:237], v254 offset:14336
    ds_read_b64_tr_b16 v[238:239], v254 offset:14592
    s_waitcnt lgkmcnt(14)
    v_mfma_f32_16x16x32_bf16 v[176:179], v[240:243], v[0:3], 0
    v_or_b32 v144, v192, v193
    v_lshlrev_b32_sdwa v208, 1, v208 dst_sel:DWORD dst_unused:UNUSED_PAD src0_sel:DWORD src1_sel:WORD_1
    v_mfma_f32_16x16x32_bf16 v[180:183], v[240:243], v[4:7], 0
    v_lshlrev_b32_sdwa v209, 1, v209 dst_sel:DWORD dst_unused:UNUSED_PAD src0_sel:DWORD src1_sel:WORD_1
    ds_read_u16_d16 v208, v208
    ds_read_u16_d16_hi v209, v209
    v_mfma_f32_16x16x32_bf16 v[184:187], v[240:243], v[8:11], 0
    v_or_b32 v145, v194, v195
    v_mfma_f32_16x16x32_bf16 v[188:191], v[240:243], v[12:15], 0
    ds_read_b64_tr_b16 v[240:241], v255 offset:7232
    ds_read_b64_tr_b16 v[242:243], v255 offset:8000
    v_lshlrev_b32_sdwa v210, 1, v210 dst_sel:DWORD dst_unused:UNUSED_PAD src0_sel:DWORD src1_sel:WORD_1
    v_mfma_f32_16x16x32_bf16 v[48:51], v[224:227], v[160:163], v[48:51]
    v_lshlrev_b32_sdwa v211, 1, v211 dst_sel:DWORD dst_unused:UNUSED_PAD src0_sel:DWORD src1_sel:WORD_1
    ds_read_u16_d16 v210, v210
    ds_read_u16_d16_hi v211, v211
    v_mfma_f32_16x16x32_bf16 v[56:59], v[224:227], v[164:167], v[56:59]
    v_or_b32 v148, v196, v197
    v_mfma_f32_16x16x32_bf16 v[64:67], v[224:227], v[168:171], v[64:67]
    v_lshlrev_b32_sdwa v212, 1, v212 dst_sel:DWORD dst_unused:UNUSED_PAD src0_sel:DWORD src1_sel:WORD_1
    v_mfma_f32_16x16x32_bf16 v[72:75], v[224:227], v[172:175], v[72:75]
    ds_read_b64_tr_b16 v[224:225], v254 offset:12296
    ds_read_b64_tr_b16 v[226:227], v254 offset:12552
    v_lshlrev_b32_sdwa v213, 1, v213 dst_sel:DWORD dst_unused:UNUSED_PAD src0_sel:DWORD src1_sel:WORD_1
    ds_read_u16_d16 v212, v212
    ds_read_u16_d16_hi v213, v213
    s_waitcnt lgkmcnt(14)
    v_mfma_f32_16x16x32_bf16 v[176:179], v[228:231], v[16:19], v[176:179]
    v_or_b32 v149, v198, v199
    v_mfma_f32_16x16x32_bf16 v[180:183], v[228:231], v[20:23], v[180:183]
    v_lshlrev_b32_sdwa v214, 1, v214 dst_sel:DWORD dst_unused:UNUSED_PAD src0_sel:DWORD src1_sel:WORD_1
    v_mfma_f32_16x16x32_bf16 v[184:187], v[228:231], v[24:27], v[184:187]
    v_lshlrev_b32_sdwa v215, 1, v215 dst_sel:DWORD dst_unused:UNUSED_PAD src0_sel:DWORD src1_sel:WORD_1
    ds_read_u16_d16 v214, v214
    ds_read_u16_d16_hi v215, v215
    v_mfma_f32_16x16x32_bf16 v[188:191], v[228:231], v[28:31], v[188:191]
    ds_read_b64_tr_b16 v[228:229], v255 offset:7240
    ds_read_b64_tr_b16 v[230:231], v255 offset:8008
    v_or_b32 v152, v200, v201
    v_lshlrev_b32_sdwa v216, 1, v216 dst_sel:DWORD dst_unused:UNUSED_PAD src0_sel:DWORD src1_sel:WORD_1
    v_mfma_f32_16x16x32_bf16 v[52:55], v[232:235], v[160:163], v[52:55]
    v_lshlrev_b32_sdwa v217, 1, v217 dst_sel:DWORD dst_unused:UNUSED_PAD src0_sel:DWORD src1_sel:WORD_1
    ds_read_u16_d16 v216, v216
    ds_read_u16_d16_hi v217, v217
    v_mfma_f32_16x16x32_bf16 v[60:63], v[232:235], v[164:167], v[60:63]
    v_or_b32 v153, v202, v203
    v_mfma_f32_16x16x32_bf16 v[68:71], v[232:235], v[168:171], v[68:71]
    v_lshlrev_b32_sdwa v218, 1, v218 dst_sel:DWORD dst_unused:UNUSED_PAD src0_sel:DWORD src1_sel:WORD_1
    v_mfma_f32_16x16x32_bf16 v[76:79], v[232:235], v[172:175], v[76:79]
    ds_read_b64_tr_b16 v[232:233], v254 offset:13320
    ds_read_b64_tr_b16 v[234:235], v254 offset:13576
    v_lshlrev_b32_sdwa v219, 1, v219 dst_sel:DWORD dst_unused:UNUSED_PAD src0_sel:DWORD src1_sel:WORD_1
    ds_read_u16_d16 v218, v218
    ds_read_u16_d16_hi v219, v219
    s_waitcnt lgkmcnt(14)
    v_mfma_f32_16x16x32_bf16 v[176:179], v[236:239], v[32:35], v[176:179]
    v_or_b32 v156, v204, v205
    v_mfma_f32_16x16x32_bf16 v[180:183], v[236:239], v[36:39], v[180:183]
    v_lshlrev_b32_sdwa v220, 1, v220 dst_sel:DWORD dst_unused:UNUSED_PAD src0_sel:DWORD src1_sel:WORD_1
    v_mfma_f32_16x16x32_bf16 v[184:187], v[236:239], v[40:43], v[184:187]
    v_lshlrev_b32_sdwa v221, 1, v221 dst_sel:DWORD dst_unused:UNUSED_PAD src0_sel:DWORD src1_sel:WORD_1
    ds_read_u16_d16 v220, v220
    ds_read_u16_d16_hi v221, v221
    v_mfma_f32_16x16x32_bf16 v[188:191], v[236:239], v[44:47], v[188:191]
    ds_read_b64_tr_b16 v[236:237], v255 offset:7296
    ds_read_b64_tr_b16 v[238:239], v255 offset:8064
    v_or_b32 v157, v206, v207
    v_mfma_f32_16x16x32_bf16 v[80:83], v[240:243], v[160:163], v[80:83]
    v_lshlrev_b32_sdwa v222, 1, v222 dst_sel:DWORD dst_unused:UNUSED_PAD src0_sel:DWORD src1_sel:WORD_1
    v_mfma_f32_16x16x32_bf16 v[88:91], v[240:243], v[164:167], v[88:91]
    v_lshlrev_b32_sdwa v223, 1, v223 dst_sel:DWORD dst_unused:UNUSED_PAD src0_sel:DWORD src1_sel:WORD_1
    ds_read_u16_d16 v222, v222
    ds_read_u16_d16_hi v223, v223
    v_mfma_f32_16x16x32_bf16 v[96:99], v[240:243], v[168:171], v[96:99]
    v_mfma_f32_16x16x32_bf16 v[104:107], v[240:243], v[172:175], v[104:107]
    ds_read_b64_tr_b16 v[240:241], v254 offset:14344
    ds_read_b64_tr_b16 v[242:243], v254 offset:14600
    s_waitcnt lgkmcnt(14)
    v_mfma_f32_16x16x32_bf16 v[192:195], v[224:227], v[0:3], 0
    v_or_b32 v146, v208, v209
    v_lshlrev_b32_sdwa v176, 1, v176 dst_sel:DWORD dst_unused:UNUSED_PAD src0_sel:DWORD src1_sel:WORD_1
    v_mfma_f32_16x16x32_bf16 v[196:199], v[224:227], v[4:7], 0
    v_lshlrev_b32_sdwa v177, 1, v177 dst_sel:DWORD dst_unused:UNUSED_PAD src0_sel:DWORD src1_sel:WORD_1
    ds_read_u16_d16 v176, v176
    ds_read_u16_d16_hi v177, v177
    v_mfma_f32_16x16x32_bf16 v[200:203], v[224:227], v[8:11], 0
    v_or_b32 v147, v210, v211
    v_mfma_f32_16x16x32_bf16 v[204:207], v[224:227], v[12:15], 0
    ds_read_b64_tr_b16 v[224:225], v255 offset:7304
    ds_read_b64_tr_b16 v[226:227], v255 offset:8072
    v_lshlrev_b32_sdwa v178, 1, v178 dst_sel:DWORD dst_unused:UNUSED_PAD src0_sel:DWORD src1_sel:WORD_1
    v_mfma_f32_16x16x32_bf16 v[84:87], v[228:231], v[160:163], v[84:87]
    v_lshlrev_b32_sdwa v179, 1, v179 dst_sel:DWORD dst_unused:UNUSED_PAD src0_sel:DWORD src1_sel:WORD_1
    ds_read_u16_d16 v178, v178
    ds_read_u16_d16_hi v179, v179
    v_mfma_f32_16x16x32_bf16 v[92:95], v[228:231], v[164:167], v[92:95]
    v_or_b32 v150, v212, v213
    v_mfma_f32_16x16x32_bf16 v[100:103], v[228:231], v[168:171], v[100:103]
    v_lshlrev_b32_sdwa v180, 1, v180 dst_sel:DWORD dst_unused:UNUSED_PAD src0_sel:DWORD src1_sel:WORD_1
    v_mfma_f32_16x16x32_bf16 v[108:111], v[228:231], v[172:175], v[108:111]
    v_bfe_u32 v228, v253, 8, 1
    v_mul_u32_u24 v228, 50176, v228
    v_subrev_u32 v228, 131080, v228
    v_add_u32 v254, v254, v228

    s_cmp_ge_u32 s19, 7
    s_cbranch_scc1 L_rd7_go
    v_mov_b32 v228, 161976

    s_mov_b32 s29, 200000
L_rd7:
    ds_read_b32 v229, v228
    s_waitcnt lgkmcnt(0)
    v_cmp_le_u32 vcc, 7, v229
    s_cmp_eq_u64 vcc, exec
    s_cbranch_scc1 L_rd7_ok
    s_sleep 2
    s_sub_u32 s29, s29, 1
    s_cmp_lg_u32 s29, 0
    s_cbranch_scc1 L_rd7
L_rd7_ok:

    v_readfirstlane_b32 s19, v229
L_rd7_go:

    ds_read_b64_tr_b16 v[228:229], v254 offset:10240
    ds_read_b64_tr_b16 v[230:231], v254 offset:10496
    v_lshlrev_b32_sdwa v181, 1, v181 dst_sel:DWORD dst_unused:UNUSED_PAD src0_sel:DWORD src1_sel:WORD_1
    ds_read_u16_d16 v180, v180
    ds_read_u16_d16_hi v181, v181
    s_waitcnt lgkmcnt(14)
    v_mfma_f32_16x16x32_bf16 v[192:195], v[232:235], v[16:19], v[192:195]
    v_or_b32 v151, v214, v215
    v_mfma_f32_16x16x32_bf16 v[196:199], v[232:235], v[20:23], v[196:199]
    v_lshlrev_b32_sdwa v182, 1, v182 dst_sel:DWORD dst_unused:UNUSED_PAD src0_sel:DWORD src1_sel:WORD_1
    v_mfma_f32_16x16x32_bf16 v[200:203], v[232:235], v[24:27], v[200:203]
    v_lshlrev_b32_sdwa v183, 1, v183 dst_sel:DWORD dst_unused:UNUSED_PAD src0_sel:DWORD src1_sel:WORD_1
    ds_read_u16_d16 v182, v182
    ds_read_u16_d16_hi v183, v183
    v_mfma_f32_16x16x32_bf16 v[204:207], v[232:235], v[28:31], v[204:207]

    s_cmp_ge_u32 s19, 8
    s_cbranch_scc1 L_rd8_go
    v_mov_b32 v232, 161976

    s_mov_b32 s29, 200000
L_rd8:
    ds_read_b32 v233, v232
    s_waitcnt lgkmcnt(0)
    v_cmp_le_u32 vcc, 8, v233
    s_cmp_eq_u64 vcc, exec
    s_cbranch_scc1 L_rd8_ok
    s_sleep 2
    s_sub_u32 s29, s29, 1
    s_cmp_lg_u32 s29, 0
    s_cbranch_scc1 L_rd8
L_rd8_ok:

    v_readfirstlane_b32 s19, v233
L_rd8_go:

    ds_read_b64_tr_b16 v[232:233], v255 offset:13312
    ds_read_b64_tr_b16 v[234:235], v255 offset:14080
    v_or_b32 v154, v216, v217
    v_lshlrev_b32_sdwa v184, 1, v184 dst_sel:DWORD dst_unused:UNUSED_PAD src0_sel:DWORD src1_sel:WORD_1
    v_mfma_f32_16x16x32_bf16 v[112:115], v[236:239], v[160:163], v[112:115]
    v_lshlrev_b32_sdwa v185, 1, v185 dst_sel:DWORD dst_unused:UNUSED_PAD src0_sel:DWORD src1_sel:WORD_1
    ds_read_u16_d16 v184, v184
    ds_read_u16_d16_hi v185, v185
    v_mfma_f32_16x16x32_bf16 v[120:123], v[236:239], v[164:167], v[120:123]
    v_or_b32 v155, v218, v219
    v_mfma_f32_16x16x32_bf16 v[128:131], v[236:239], v[168:171], v[128:131]
    v_lshlrev_b32_sdwa v186, 1, v186 dst_sel:DWORD dst_unused:UNUSED_PAD src0_sel:DWORD src1_sel:WORD_1
    v_mfma_f32_16x16x32_bf16 v[136:139], v[236:239], v[172:175], v[136:139]
    ds_read_b64_tr_b16 v[236:237], v254 offset:11264
    ds_read_b64_tr_b16 v[238:239], v254 offset:11520
    v_lshlrev_b32_sdwa v187, 1, v187 dst_sel:DWORD dst_unused:UNUSED_PAD src0_sel:DWORD src1_sel:WORD_1
    ds_read_u16_d16 v186, v186
    ds_read_u16_d16_hi v187, v187
    s_waitcnt lgkmcnt(14)
    v_mfma_f32_16x16x32_bf16 v[192:195], v[240:243], v[32:35], v[192:195]
    v_or_b32 v158, v220, v221
    v_mfma_f32_16x16x32_bf16 v[196:199], v[240:243], v[36:39], v[196:199]
    v_lshlrev_b32_sdwa v188, 1, v188 dst_sel:DWORD dst_unused:UNUSED_PAD src0_sel:DWORD src1_sel:WORD_1
    v_mfma_f32_16x16x32_bf16 v[200:203], v[240:243], v[40:43], v[200:203]
    v_lshlrev_b32_sdwa v189, 1, v189 dst_sel:DWORD dst_unused:UNUSED_PAD src0_sel:DWORD src1_sel:WORD_1
    ds_read_u16_d16 v188, v188
    ds_read_u16_d16_hi v189, v189
    v_mfma_f32_16x16x32_bf16 v[204:207], v[240:243], v[44:47], v[204:207]
    ds_read_b64_tr_b16 v[240:241], v255 offset:13320
    ds_read_b64_tr_b16 v[242:243], v255 offset:14088
    v_or_b32 v159, v222, v223
    v_mfma_f32_16x16x32_bf16 v[116:119], v[224:227], v[160:163], v[116:119]
    v_lshlrev_b32_sdwa v190, 1, v190 dst_sel:DWORD dst_unused:UNUSED_PAD src0_sel:DWORD src1_sel:WORD_1
    v_mfma_f32_16x16x32_bf16 v[124:127], v[224:227], v[164:167], v[124:127]
    v_lshlrev_b32_sdwa v191, 1, v191 dst_sel:DWORD dst_unused:UNUSED_PAD src0_sel:DWORD src1_sel:WORD_1
    ds_read_u16_d16 v190, v190
    ds_read_u16_d16_hi v191, v191
    v_mfma_f32_16x16x32_bf16 v[132:135], v[224:227], v[168:171], v[132:135]
    v_mfma_f32_16x16x32_bf16 v[140:143], v[224:227], v[172:175], v[140:143]
    ds_read_b64_tr_b16 v[224:225], v254 offset:12288
    ds_read_b64_tr_b16 v[226:227], v254 offset:12544
    s_waitcnt lgkmcnt(14)
    v_mfma_f32_16x16x32_bf16 v[208:211], v[228:231], v[0:3], 0
    v_or_b32 v160, v176, v177
    v_lshlrev_b32_sdwa v192, 1, v192 dst_sel:DWORD dst_unused:UNUSED_PAD src0_sel:DWORD src1_sel:WORD_1
    v_mfma_f32_16x16x32_bf16 v[212:215], v[228:231], v[4:7], 0
    v_lshlrev_b32_sdwa v193, 1, v193 dst_sel:DWORD dst_unused:UNUSED_PAD src0_sel:DWORD src1_sel:WORD_1
    ds_read_u16_d16 v192, v192
    ds_read_u16_d16_hi v193, v193
    v_mfma_f32_16x16x32_bf16 v[216:219], v[228:231], v[8:11], 0
    v_or_b32 v161, v178, v179
    v_mfma_f32_16x16x32_bf16 v[220:223], v[228:231], v[12:15], 0
    ds_read_b64_tr_b16 v[228:229], v255 offset:13376
    ds_read_b64_tr_b16 v[230:231], v255 offset:14144
    v_lshlrev_b32_sdwa v194, 1, v194 dst_sel:DWORD dst_unused:UNUSED_PAD src0_sel:DWORD src1_sel:WORD_1
    v_mfma_f32_16x16x32_bf16 v[48:51], v[232:235], v[144:147], v[48:51]
    v_lshlrev_b32_sdwa v195, 1, v195 dst_sel:DWORD dst_unused:UNUSED_PAD src0_sel:DWORD src1_sel:WORD_1
    ds_read_u16_d16 v194, v194
    ds_read_u16_d16_hi v195, v195
    v_mfma_f32_16x16x32_bf16 v[56:59], v[232:235], v[148:151], v[56:59]
    v_or_b32 v164, v180, v181
    s_waitcnt vmcnt(0)
    v_dot2_f32_bf16 v52, v246, s86, v52
    v_dot2_f32_bf16 v53, v246, s87, v53
    v_mfma_f32_16x16x32_bf16 v[64:67], v[232:235], v[152:155], v[64:67]
    v_lshlrev_b32_sdwa v196, 1, v196 dst_sel:DWORD dst_unused:UNUSED_PAD src0_sel:DWORD src1_sel:WORD_1
    v_dot2_f32_bf16 v54, v247, s86, v54
    v_dot2_f32_bf16 v55, v247, s87, v55
    v_mfma_f32_16x16x32_bf16 v[72:75], v[232:235], v[156:159], v[72:75]
    ds_read_b64_tr_b16 v[232:233], v254 offset:10248
    ds_read_b64_tr_b16 v[234:235], v254 offset:10504
    v_lshlrev_b32_sdwa v197, 1, v197 dst_sel:DWORD dst_unused:UNUSED_PAD src0_sel:DWORD src1_sel:WORD_1
    ds_read_u16_d16 v196, v196
    ds_read_u16_d16_hi v197, v197
    v_dot2_f32_bf16 v80, v248, s86, v80
    v_dot2_f32_bf16 v81, v248, s87, v81
    s_waitcnt lgkmcnt(14)
    v_mfma_f32_16x16x32_bf16 v[208:211], v[236:239], v[16:19], v[208:211]
    v_or_b32 v165, v182, v183
    v_dot2_f32_bf16 v82, v249, s86, v82
    v_dot2_f32_bf16 v83, v249, s87, v83
    v_mfma_f32_16x16x32_bf16 v[212:215], v[236:239], v[20:23], v[212:215]
    v_lshlrev_b32_sdwa v198, 1, v198 dst_sel:DWORD dst_unused:UNUSED_PAD src0_sel:DWORD src1_sel:WORD_1
    v_dot2_f32_bf16 v48, v244, s86, v48
    v_dot2_f32_bf16 v49, v244, s87, v49
    v_mfma_f32_16x16x32_bf16 v[216:219], v[236:239], v[24:27], v[216:219]
    v_lshlrev_b32_sdwa v199, 1, v199 dst_sel:DWORD dst_unused:UNUSED_PAD src0_sel:DWORD src1_sel:WORD_1
    ds_read_u16_d16 v198, v198
    ds_read_u16_d16_hi v199, v199
    v_dot2_f32_bf16 v50, v245, s86, v50
    v_dot2_f32_bf16 v51, v245, s87, v51
    v_mfma_f32_16x16x32_bf16 v[220:223], v[236:239], v[28:31], v[220:223]
    ds_read_b64_tr_b16 v[236:237], v255 offset:13384
    ds_read_b64_tr_b16 v[238:239], v255 offset:14152
    v_or_b32 v168, v184, v185
    v_lshlrev_b32_sdwa v200, 1, v200 dst_sel:DWORD dst_unused:UNUSED_PAD src0_sel:DWORD src1_sel:WORD_1
    v_dot2_f32_bf16 v84, v250, s86, v84
    v_dot2_f32_bf16 v85, v250, s87, v85
    v_mfma_f32_16x16x32_bf16 v[52:55], v[240:243], v[144:147], v[52:55]
    v_lshlrev_b32_sdwa v201, 1, v201 dst_sel:DWORD dst_unused:UNUSED_PAD src0_sel:DWORD src1_sel:WORD_1
    ds_read_u16_d16 v200, v200
    ds_read_u16_d16_hi v201, v201
    v_dot2_f32_bf16 v86, v251, s86, v86
    v_dot2_f32_bf16 v87, v251, s87, v87
    buffer_load_dwordx4 v[244:247], v252, s[4:7], s24 offen offset:128 sc1
    buffer_load_dwordx4 v[248:251], v252, s[4:7], s24 offen offset:192 sc1
    v_mfma_f32_16x16x32_bf16 v[60:63], v[240:243], v[148:151], v[60:63]
    v_or_b32 v169, v186, v187
    v_mfma_f32_16x16x32_bf16 v[68:71], v[240:243], v[152:155], v[68:71]
    v_lshlrev_b32_sdwa v202, 1, v202 dst_sel:DWORD dst_unused:UNUSED_PAD src0_sel:DWORD src1_sel:WORD_1
    v_mfma_f32_16x16x32_bf16 v[76:79], v[240:243], v[156:159], v[76:79]
    ds_read_b64_tr_b16 v[240:241], v254 offset:11272
    ds_read_b64_tr_b16 v[242:243], v254 offset:11528
    v_lshlrev_b32_sdwa v203, 1, v203 dst_sel:DWORD dst_unused:UNUSED_PAD src0_sel:DWORD src1_sel:WORD_1
    ds_read_u16_d16 v202, v202
    ds_read_u16_d16_hi v203, v203
    s_waitcnt lgkmcnt(14)
    v_mfma_f32_16x16x32_bf16 v[208:211], v[224:227], v[32:35], v[208:211]
    v_or_b32 v172, v188, v189
    v_mfma_f32_16x16x32_bf16 v[212:215], v[224:227], v[36:39], v[212:215]
    v_lshlrev_b32_sdwa v204, 1, v204 dst_sel:DWORD dst_unused:UNUSED_PAD src0_sel:DWORD src1_sel:WORD_1
    v_mfma_f32_16x16x32_bf16 v[216:219], v[224:227], v[40:43], v[216:219]
    v_lshlrev_b32_sdwa v205, 1, v205 dst_sel:DWORD dst_unused:UNUSED_PAD src0_sel:DWORD src1_sel:WORD_1
    ds_read_u16_d16 v204, v204
    ds_read_u16_d16_hi v205, v205
    v_mfma_f32_16x16x32_bf16 v[220:223], v[224:227], v[44:47], v[220:223]
    ds_read_b64_tr_b16 v[224:225], v255 offset:13440
    ds_read_b64_tr_b16 v[226:227], v255 offset:14208
    v_or_b32 v173, v190, v191
    v_mfma_f32_16x16x32_bf16 v[80:83], v[228:231], v[144:147], v[80:83]
    v_lshlrev_b32_sdwa v206, 1, v206 dst_sel:DWORD dst_unused:UNUSED_PAD src0_sel:DWORD src1_sel:WORD_1
    v_mfma_f32_16x16x32_bf16 v[88:91], v[228:231], v[148:151], v[88:91]
    v_lshlrev_b32_sdwa v207, 1, v207 dst_sel:DWORD dst_unused:UNUSED_PAD src0_sel:DWORD src1_sel:WORD_1
    ds_read_u16_d16 v206, v206
    ds_read_u16_d16_hi v207, v207
    v_mfma_f32_16x16x32_bf16 v[96:99], v[228:231], v[152:155], v[96:99]
    v_mfma_f32_16x16x32_bf16 v[104:107], v[228:231], v[156:159], v[104:107]
    ds_read_b64_tr_b16 v[228:229], v254 offset:12296
    ds_read_b64_tr_b16 v[230:231], v254 offset:12552
    s_waitcnt lgkmcnt(14)
    v_mfma_f32_16x16x32_bf16 v[176:179], v[232:235], v[0:3], 0
    v_or_b32 v162, v192, v193
    v_lshlrev_b32_sdwa v208, 1, v208 dst_sel:DWORD dst_unused:UNUSED_PAD src0_sel:DWORD src1_sel:WORD_1
    v_mfma_f32_16x16x32_bf16 v[180:183], v[232:235], v[4:7], 0
    v_lshlrev_b32_sdwa v209, 1, v209 dst_sel:DWORD dst_unused:UNUSED_PAD src0_sel:DWORD src1_sel:WORD_1
    ds_read_u16_d16 v208, v208
    ds_read_u16_d16_hi v209, v209
    v_mfma_f32_16x16x32_bf16 v[184:187], v[232:235], v[8:11], 0
    v_or_b32 v163, v194, v195
    v_mfma_f32_16x16x32_bf16 v[188:191], v[232:235], v[12:15], 0
    ds_read_b64_tr_b16 v[232:233], v255 offset:13448
    ds_read_b64_tr_b16 v[234:235], v255 offset:14216
    v_lshlrev_b32_sdwa v210, 1, v210 dst_sel:DWORD dst_unused:UNUSED_PAD src0_sel:DWORD src1_sel:WORD_1
    v_mfma_f32_16x16x32_bf16 v[84:87], v[236:239], v[144:147], v[84:87]
    v_lshlrev_b32_sdwa v211, 1, v211 dst_sel:DWORD dst_unused:UNUSED_PAD src0_sel:DWORD src1_sel:WORD_1
    ds_read_u16_d16 v210, v210
    ds_read_u16_d16_hi v211, v211
    v_mfma_f32_16x16x32_bf16 v[92:95], v[236:239], v[148:151], v[92:95]
    v_or_b32 v166, v196, v197
    v_mfma_f32_16x16x32_bf16 v[100:103], v[236:239], v[152:155], v[100:103]
    v_lshlrev_b32_sdwa v212, 1, v212 dst_sel:DWORD dst_unused:UNUSED_PAD src0_sel:DWORD src1_sel:WORD_1
    v_mfma_f32_16x16x32_bf16 v[108:111], v[236:239], v[156:159], v[108:111]

    s_cmp_ge_u32 s19, 9
    s_cbranch_scc1 L_rd9_go
    v_mov_b32 v236, 161976

    s_mov_b32 s29, 200000
L_rd9:
    ds_read_b32 v237, v236
    s_waitcnt lgkmcnt(0)
    v_cmp_le_u32 vcc, 9, v237
    s_cmp_eq_u64 vcc, exec
    s_cbranch_scc1 L_rd9_ok
    s_sleep 2
    s_sub_u32 s29, s29, 1
    s_cmp_lg_u32 s29, 0
    s_cbranch_scc1 L_rd9
L_rd9_ok:

    v_readfirstlane_b32 s19, v237
L_rd9_go:

    ds_read_b64_tr_b16 v[236:237], v254 offset:16384
    ds_read_b64_tr_b16 v[238:239], v254 offset:16640
    v_lshlrev_b32_sdwa v213, 1, v213 dst_sel:DWORD dst_unused:UNUSED_PAD src0_sel:DWORD src1_sel:WORD_1
    ds_read_u16_d16 v212, v212
    ds_read_u16_d16_hi v213, v213
    s_waitcnt lgkmcnt(14)
    v_mfma_f32_16x16x32_bf16 v[176:179], v[240:243], v[16:19], v[176:179]
    v_or_b32 v167, v198, v199
    v_mfma_f32_16x16x32_bf16 v[180:183], v[240:243], v[20:23], v[180:183]
    v_lshlrev_b32_sdwa v214, 1, v214 dst_sel:DWORD dst_unused:UNUSED_PAD src0_sel:DWORD src1_sel:WORD_1
    v_mfma_f32_16x16x32_bf16 v[184:187], v[240:243], v[24:27], v[184:187]
    v_lshlrev_b32_sdwa v215, 1, v215 dst_sel:DWORD dst_unused:UNUSED_PAD src0_sel:DWORD src1_sel:WORD_1
    ds_read_u16_d16 v214, v214
    ds_read_u16_d16_hi v215, v215
    v_mfma_f32_16x16x32_bf16 v[188:191], v[240:243], v[28:31], v[188:191]

    s_cmp_ge_u32 s19, 10
    s_cbranch_scc1 L_rd10_go
    v_mov_b32 v240, 161976

    s_mov_b32 s29, 200000
L_rd10:
    ds_read_b32 v241, v240
    s_waitcnt lgkmcnt(0)
    v_cmp_le_u32 vcc, 10, v241
    s_cmp_eq_u64 vcc, exec
    s_cbranch_scc1 L_rd10_ok
    s_sleep 2
    s_sub_u32 s29, s29, 1
    s_cmp_lg_u32 s29, 0
    s_cbranch_scc1 L_rd10
L_rd10_ok:

    v_readfirstlane_b32 s19, v241
L_rd10_go:

    ds_read_b64_tr_b16 v[240:241], v255 offset:19456
    ds_read_b64_tr_b16 v[242:243], v255 offset:20224
    v_or_b32 v170, v200, v201
    v_lshlrev_b32_sdwa v216, 1, v216 dst_sel:DWORD dst_unused:UNUSED_PAD src0_sel:DWORD src1_sel:WORD_1
    v_mfma_f32_16x16x32_bf16 v[112:115], v[224:227], v[144:147], v[112:115]
    v_lshlrev_b32_sdwa v217, 1, v217 dst_sel:DWORD dst_unused:UNUSED_PAD src0_sel:DWORD src1_sel:WORD_1
    ds_read_u16_d16 v216, v216
    ds_read_u16_d16_hi v217, v217
    v_mfma_f32_16x16x32_bf16 v[120:123], v[224:227], v[148:151], v[120:123]
    v_or_b32 v171, v202, v203
    v_mfma_f32_16x16x32_bf16 v[128:131], v[224:227], v[152:155], v[128:131]
    v_lshlrev_b32_sdwa v218, 1, v218 dst_sel:DWORD dst_unused:UNUSED_PAD src0_sel:DWORD src1_sel:WORD_1
    v_mfma_f32_16x16x32_bf16 v[136:139], v[224:227], v[156:159], v[136:139]
    ds_read_b64_tr_b16 v[224:225], v254 offset:17408
    ds_read_b64_tr_b16 v[226:227], v254 offset:17664
    v_lshlrev_b32_sdwa v219, 1, v219 dst_sel:DWORD dst_unused:UNUSED_PAD src0_sel:DWORD src1_sel:WORD_1
    ds_read_u16_d16 v218, v218
    ds_read_u16_d16_hi v219, v219
    s_waitcnt lgkmcnt(14)
    v_mfma_f32_16x16x32_bf16 v[176:179], v[228:231], v[32:35], v[176:179]
    v_or_b32 v174, v204, v205
    v_mfma_f32_16x16x32_bf16 v[180:183], v[228:231], v[36:39], v[180:183]
    v_lshlrev_b32_sdwa v220, 1, v220 dst_sel:DWORD dst_unused:UNUSED_PAD src0_sel:DWORD src1_sel:WORD_1
    v_mfma_f32_16x16x32_bf16 v[184:187], v[228:231], v[40:43], v[184:187]
    v_lshlrev_b32_sdwa v221, 1, v221 dst_sel:DWORD dst_unused:UNUSED_PAD src0_sel:DWORD src1_sel:WORD_1
    ds_read_u16_d16 v220, v220
    ds_read_u16_d16_hi v221, v221
    v_mfma_f32_16x16x32_bf16 v[188:191], v[228:231], v[44:47], v[188:191]
    ds_read_b64_tr_b16 v[228:229], v255 offset:19464
    ds_read_b64_tr_b16 v[230:231], v255 offset:20232
    v_or_b32 v175, v206, v207
    v_mfma_f32_16x16x32_bf16 v[116:119], v[232:235], v[144:147], v[116:119]
    v_lshlrev_b32_sdwa v222, 1, v222 dst_sel:DWORD dst_unused:UNUSED_PAD src0_sel:DWORD src1_sel:WORD_1
    v_mfma_f32_16x16x32_bf16 v[124:127], v[232:235], v[148:151], v[124:127]
    v_lshlrev_b32_sdwa v223, 1, v223 dst_sel:DWORD dst_unused:UNUSED_PAD src0_sel:DWORD src1_sel:WORD_1
    ds_read_u16_d16 v222, v222
    ds_read_u16_d16_hi v223, v223
    v_mfma_f32_16x16x32_bf16 v[132:135], v[232:235], v[152:155], v[132:135]
    v_mfma_f32_16x16x32_bf16 v[140:143], v[232:235], v[156:159], v[140:143]
    ds_read_b64_tr_b16 v[232:233], v254 offset:18432
    ds_read_b64_tr_b16 v[234:235], v254 offset:18688
    s_waitcnt lgkmcnt(14)
    v_mfma_f32_16x16x32_bf16 v[192:195], v[236:239], v[0:3], 0
    v_or_b32 v144, v208, v209
    v_lshlrev_b32_sdwa v176, 1, v176 dst_sel:DWORD dst_unused:UNUSED_PAD src0_sel:DWORD src1_sel:WORD_1
    v_mfma_f32_16x16x32_bf16 v[196:199], v[236:239], v[4:7], 0
    v_lshlrev_b32_sdwa v177, 1, v177 dst_sel:DWORD dst_unused:UNUSED_PAD src0_sel:DWORD src1_sel:WORD_1
    ds_read_u16_d16 v176, v176
    ds_read_u16_d16_hi v177, v177
    v_mfma_f32_16x16x32_bf16 v[200:203], v[236:239], v[8:11], 0
    v_or_b32 v145, v210, v211
    v_mfma_f32_16x16x32_bf16 v[204:207], v[236:239], v[12:15], 0
    ds_read_b64_tr_b16 v[236:237], v255 offset:19520
    ds_read_b64_tr_b16 v[238:239], v255 offset:20288
    v_lshlrev_b32_sdwa v178, 1, v178 dst_sel:DWORD dst_unused:UNUSED_PAD src0_sel:DWORD src1_sel:WORD_1
    v_mfma_f32_16x16x32_bf16 v[48:51], v[240:243], v[160:163], v[48:51]
    v_lshlrev_b32_sdwa v179, 1, v179 dst_sel:DWORD dst_unused:UNUSED_PAD src0_sel:DWORD src1_sel:WORD_1
    ds_read_u16_d16 v178, v178
    ds_read_u16_d16_hi v179, v179
    v_mfma_f32_16x16x32_bf16 v[56:59], v[240:243], v[164:167], v[56:59]
    v_or_b32 v148, v212, v213
    v_mfma_f32_16x16x32_bf16 v[64:67], v[240:243], v[168:171], v[64:67]
    v_lshlrev_b32_sdwa v180, 1, v180 dst_sel:DWORD dst_unused:UNUSED_PAD src0_sel:DWORD src1_sel:WORD_1
    v_mfma_f32_16x16x32_bf16 v[72:75], v[240:243], v[172:175], v[72:75]
    ds_read_b64_tr_b16 v[240:241], v254 offset:16392
    ds_read_b64_tr_b16 v[242:243], v254 offset:16648
    v_lshlrev_b32_sdwa v181, 1, v181 dst_sel:DWORD dst_unused:UNUSED_PAD src0_sel:DWORD src1_sel:WORD_1
    ds_read_u16_d16 v180, v180
    ds_read_u16_d16_hi v181, v181
    s_waitcnt lgkmcnt(14)
    v_mfma_f32_16x16x32_bf16 v[192:195], v[224:227], v[16:19], v[192:195]
    v_or_b32 v149, v214, v215
    v_mfma_f32_16x16x32_bf16 v[196:199], v[224:227], v[20:23], v[196:199]
    v_lshlrev_b32_sdwa v182, 1, v182 dst_sel:DWORD dst_unused:UNUSED_PAD src0_sel:DWORD src1_sel:WORD_1
    v_mfma_f32_16x16x32_bf16 v[200:203], v[224:227], v[24:27], v[200:203]
    v_lshlrev_b32_sdwa v183, 1, v183 dst_sel:DWORD dst_unused:UNUSED_PAD src0_sel:DWORD src1_sel:WORD_1
    ds_read_u16_d16 v182, v182
    ds_read_u16_d16_hi v183, v183
    v_mfma_f32_16x16x32_bf16 v[204:207], v[224:227], v[28:31], v[204:207]
    ds_read_b64_tr_b16 v[224:225], v255 offset:19528
    ds_read_b64_tr_b16 v[226:227], v255 offset:20296
    v_or_b32 v152, v216, v217
    v_lshlrev_b32_sdwa v184, 1, v184 dst_sel:DWORD dst_unused:UNUSED_PAD src0_sel:DWORD src1_sel:WORD_1
    v_mfma_f32_16x16x32_bf16 v[52:55], v[228:231], v[160:163], v[52:55]
    v_lshlrev_b32_sdwa v185, 1, v185 dst_sel:DWORD dst_unused:UNUSED_PAD src0_sel:DWORD src1_sel:WORD_1
    ds_read_u16_d16 v184, v184
    ds_read_u16_d16_hi v185, v185
    v_mfma_f32_16x16x32_bf16 v[60:63], v[228:231], v[164:167], v[60:63]
    v_or_b32 v153, v218, v219
    v_mfma_f32_16x16x32_bf16 v[68:71], v[228:231], v[168:171], v[68:71]
    v_lshlrev_b32_sdwa v186, 1, v186 dst_sel:DWORD dst_unused:UNUSED_PAD src0_sel:DWORD src1_sel:WORD_1
    v_mfma_f32_16x16x32_bf16 v[76:79], v[228:231], v[172:175], v[76:79]
    ds_read_b64_tr_b16 v[228:229], v254 offset:17416
    ds_read_b64_tr_b16 v[230:231], v254 offset:17672
    v_lshlrev_b32_sdwa v187, 1, v187 dst_sel:DWORD dst_unused:UNUSED_PAD src0_sel:DWORD src1_sel:WORD_1
    ds_read_u16_d16 v186, v186
    ds_read_u16_d16_hi v187, v187
    s_waitcnt lgkmcnt(14)
    v_mfma_f32_16x16x32_bf16 v[192:195], v[232:235], v[32:35], v[192:195]
    v_or_b32 v156, v220, v221
    v_mfma_f32_16x16x32_bf16 v[196:199], v[232:235], v[36:39], v[196:199]
    v_lshlrev_b32_sdwa v188, 1, v188 dst_sel:DWORD dst_unused:UNUSED_PAD src0_sel:DWORD src1_sel:WORD_1
    v_mfma_f32_16x16x32_bf16 v[200:203], v[232:235], v[40:43], v[200:203]
    v_lshlrev_b32_sdwa v189, 1, v189 dst_sel:DWORD dst_unused:UNUSED_PAD src0_sel:DWORD src1_sel:WORD_1
    ds_read_u16_d16 v188, v188
    ds_read_u16_d16_hi v189, v189
    v_mfma_f32_16x16x32_bf16 v[204:207], v[232:235], v[44:47], v[204:207]
    ds_read_b64_tr_b16 v[232:233], v255 offset:19584
    ds_read_b64_tr_b16 v[234:235], v255 offset:20352
    v_or_b32 v157, v222, v223
    v_mfma_f32_16x16x32_bf16 v[80:83], v[236:239], v[160:163], v[80:83]
    v_lshlrev_b32_sdwa v190, 1, v190 dst_sel:DWORD dst_unused:UNUSED_PAD src0_sel:DWORD src1_sel:WORD_1
    v_mfma_f32_16x16x32_bf16 v[88:91], v[236:239], v[164:167], v[88:91]
    v_lshlrev_b32_sdwa v191, 1, v191 dst_sel:DWORD dst_unused:UNUSED_PAD src0_sel:DWORD src1_sel:WORD_1
    ds_read_u16_d16 v190, v190
    ds_read_u16_d16_hi v191, v191
    v_mfma_f32_16x16x32_bf16 v[96:99], v[236:239], v[168:171], v[96:99]
    v_mfma_f32_16x16x32_bf16 v[104:107], v[236:239], v[172:175], v[104:107]
    ds_read_b64_tr_b16 v[236:237], v254 offset:18440
    ds_read_b64_tr_b16 v[238:239], v254 offset:18696
    s_waitcnt lgkmcnt(14)
    v_mfma_f32_16x16x32_bf16 v[208:211], v[240:243], v[0:3], 0
    v_or_b32 v146, v176, v177
    v_lshlrev_b32_sdwa v192, 1, v192 dst_sel:DWORD dst_unused:UNUSED_PAD src0_sel:DWORD src1_sel:WORD_1
    v_mfma_f32_16x16x32_bf16 v[212:215], v[240:243], v[4:7], 0
    v_lshlrev_b32_sdwa v193, 1, v193 dst_sel:DWORD dst_unused:UNUSED_PAD src0_sel:DWORD src1_sel:WORD_1
    ds_read_u16_d16 v192, v192
    ds_read_u16_d16_hi v193, v193
    v_mfma_f32_16x16x32_bf16 v[216:219], v[240:243], v[8:11], 0
    v_or_b32 v147, v178, v179
    v_mfma_f32_16x16x32_bf16 v[220:223], v[240:243], v[12:15], 0
    ds_read_b64_tr_b16 v[240:241], v255 offset:19592
    ds_read_b64_tr_b16 v[242:243], v255 offset:20360
    v_lshlrev_b32_sdwa v194, 1, v194 dst_sel:DWORD dst_unused:UNUSED_PAD src0_sel:DWORD src1_sel:WORD_1
    v_mfma_f32_16x16x32_bf16 v[84:87], v[224:227], v[160:163], v[84:87]
    v_lshlrev_b32_sdwa v195, 1, v195 dst_sel:DWORD dst_unused:UNUSED_PAD src0_sel:DWORD src1_sel:WORD_1
    ds_read_u16_d16 v194, v194
    ds_read_u16_d16_hi v195, v195
    v_mfma_f32_16x16x32_bf16 v[92:95], v[224:227], v[164:167], v[92:95]
    v_or_b32 v150, v180, v181
    s_waitcnt vmcnt(0)
    v_dot2_f32_bf16 v112, v244, s86, v112
    v_dot2_f32_bf16 v113, v244, s87, v113
    v_mfma_f32_16x16x32_bf16 v[100:103], v[224:227], v[168:171], v[100:103]
    v_lshlrev_b32_sdwa v196, 1, v196 dst_sel:DWORD dst_unused:UNUSED_PAD src0_sel:DWORD src1_sel:WORD_1
    v_dot2_f32_bf16 v114, v245, s86, v114
    v_dot2_f32_bf16 v115, v245, s87, v115
    v_mfma_f32_16x16x32_bf16 v[108:111], v[224:227], v[172:175], v[108:111]

    s_cmp_ge_u32 s19, 11
    s_cbranch_scc1 L_rd11_go
    v_mov_b32 v224, 161976

    s_mov_b32 s29, 200000
L_rd11:
    ds_read_b32 v225, v224
    s_waitcnt lgkmcnt(0)
    v_cmp_le_u32 vcc, 11, v225
    s_cmp_eq_u64 vcc, exec
    s_cbranch_scc1 L_rd11_ok
    s_sleep 2
    s_sub_u32 s29, s29, 1
    s_cmp_lg_u32 s29, 0
    s_cbranch_scc1 L_rd11
L_rd11_ok:

    v_readfirstlane_b32 s19, v225
L_rd11_go:

    ds_read_b64_tr_b16 v[224:225], v254 offset:22528
    ds_read_b64_tr_b16 v[226:227], v254 offset:22784
    v_lshlrev_b32_sdwa v197, 1, v197 dst_sel:DWORD dst_unused:UNUSED_PAD src0_sel:DWORD src1_sel:WORD_1
    ds_read_u16_d16 v196, v196
    ds_read_u16_d16_hi v197, v197
    v_dot2_f32_bf16 v116, v246, s86, v116
    v_dot2_f32_bf16 v117, v246, s87, v117
    s_waitcnt lgkmcnt(14)
    v_mfma_f32_16x16x32_bf16 v[208:211], v[228:231], v[16:19], v[208:211]
    v_or_b32 v151, v182, v183
    v_dot2_f32_bf16 v118, v247, s86, v118
    v_dot2_f32_bf16 v119, v247, s87, v119
    v_mfma_f32_16x16x32_bf16 v[212:215], v[228:231], v[20:23], v[212:215]
    v_lshlrev_b32_sdwa v198, 1, v198 dst_sel:DWORD dst_unused:UNUSED_PAD src0_sel:DWORD src1_sel:WORD_1
    v_dot2_f32_bf16 v56, v248, s86, v56
    v_dot2_f32_bf16 v57, v248, s87, v57
    v_mfma_f32_16x16x32_bf16 v[216:219], v[228:231], v[24:27], v[216:219]
    v_lshlrev_b32_sdwa v199, 1, v199 dst_sel:DWORD dst_unused:UNUSED_PAD src0_sel:DWORD src1_sel:WORD_1
    ds_read_u16_d16 v198, v198
    ds_read_u16_d16_hi v199, v199
    v_dot2_f32_bf16 v58, v249, s86, v58
    v_dot2_f32_bf16 v59, v249, s87, v59
    v_mfma_f32_16x16x32_bf16 v[220:223], v[228:231], v[28:31], v[220:223]

    s_cmp_ge_u32 s19, 12
    s_cbranch_scc1 L_rd12_go
    v_mov_b32 v228, 161976

    s_mov_b32 s29, 200000
L_rd12:
    ds_read_b32 v229, v228
    s_waitcnt lgkmcnt(0)
    v_cmp_le_u32 vcc, 12, v229
    s_cmp_eq_u64 vcc, exec
    s_cbranch_scc1 L_rd12_ok
    s_sleep 2
    s_sub_u32 s29, s29, 1
    s_cmp_lg_u32 s29, 0
    s_cbranch_scc1 L_rd12
L_rd12_ok:

    v_readfirstlane_b32 s19, v229
L_rd12_go:

    ds_read_b64_tr_b16 v[228:229], v255 offset:25600
    ds_read_b64_tr_b16 v[230:231], v255 offset:26368
    v_or_b32 v154, v184, v185
    v_lshlrev_b32_sdwa v200, 1, v200 dst_sel:DWORD dst_unused:UNUSED_PAD src0_sel:DWORD src1_sel:WORD_1
    v_dot2_f32_bf16 v60, v250, s86, v60
    v_dot2_f32_bf16 v61, v250, s87, v61
    v_mfma_f32_16x16x32_bf16 v[112:115], v[232:235], v[160:163], v[112:115]
    v_lshlrev_b32_sdwa v201, 1, v201 dst_sel:DWORD dst_unused:UNUSED_PAD src0_sel:DWORD src1_sel:WORD_1
    ds_read_u16_d16 v200, v200
    ds_read_u16_d16_hi v201, v201
    v_dot2_f32_bf16 v62, v251, s86, v62
    v_dot2_f32_bf16 v63, v251, s87, v63
    buffer_load_dwordx4 v[244:247], v252, s[4:7], s24 offen offset:256 sc1
    buffer_load_dwordx4 v[248:251], v252, s[4:7], s24 offen offset:320 sc1
    v_mfma_f32_16x16x32_bf16 v[120:123], v[232:235], v[164:167], v[120:123]
    v_or_b32 v155, v186, v187
    v_mfma_f32_16x16x32_bf16 v[128:131], v[232:235], v[168:171], v[128:131]
    v_lshlrev_b32_sdwa v202, 1, v202 dst_sel:DWORD dst_unused:UNUSED_PAD src0_sel:DWORD src1_sel:WORD_1
    v_mfma_f32_16x16x32_bf16 v[136:139], v[232:235], v[172:175], v[136:139]
    ds_read_b64_tr_b16 v[232:233], v254 offset:23552
    ds_read_b64_tr_b16 v[234:235], v254 offset:23808
    v_lshlrev_b32_sdwa v203, 1, v203 dst_sel:DWORD dst_unused:UNUSED_PAD src0_sel:DWORD src1_sel:WORD_1
    ds_read_u16_d16 v202, v202
    ds_read_u16_d16_hi v203, v203
    s_waitcnt lgkmcnt(14)
    v_mfma_f32_16x16x32_bf16 v[208:211], v[236:239], v[32:35], v[208:211]
    v_or_b32 v158, v188, v189
    v_mfma_f32_16x16x32_bf16 v[212:215], v[236:239], v[36:39], v[212:215]
    v_lshlrev_b32_sdwa v204, 1, v204 dst_sel:DWORD dst_unused:UNUSED_PAD src0_sel:DWORD src1_sel:WORD_1
    v_mfma_f32_16x16x32_bf16 v[216:219], v[236:239], v[40:43], v[216:219]
    v_lshlrev_b32_sdwa v205, 1, v205 dst_sel:DWORD dst_unused:UNUSED_PAD src0_sel:DWORD src1_sel:WORD_1
    ds_read_u16_d16 v204, v204
    ds_read_u16_d16_hi v205, v205
    v_mfma_f32_16x16x32_bf16 v[220:223], v[236:239], v[44:47], v[220:223]
    ds_read_b64_tr_b16 v[236:237], v255 offset:25608
    ds_read_b64_tr_b16 v[238:239], v255 offset:26376
    v_or_b32 v159, v190, v191
    v_mfma_f32_16x16x32_bf16 v[116:119], v[240:243], v[160:163], v[116:119]
    v_lshlrev_b32_sdwa v206, 1, v206 dst_sel:DWORD dst_unused:UNUSED_PAD src0_sel:DWORD src1_sel:WORD_1
    v_mfma_f32_16x16x32_bf16 v[124:127], v[240:243], v[164:167], v[124:127]
    v_lshlrev_b32_sdwa v207, 1, v207 dst_sel:DWORD dst_unused:UNUSED_PAD src0_sel:DWORD src1_sel:WORD_1
    ds_read_u16_d16 v206, v206
    ds_read_u16_d16_hi v207, v207
    v_mfma_f32_16x16x32_bf16 v[132:135], v[240:243], v[168:171], v[132:135]
    v_mfma_f32_16x16x32_bf16 v[140:143], v[240:243], v[172:175], v[140:143]
    ds_read_b64_tr_b16 v[240:241], v254 offset:24576
    ds_read_b64_tr_b16 v[242:243], v254 offset:24832
    s_waitcnt lgkmcnt(14)
    v_mfma_f32_16x16x32_bf16 v[176:179], v[224:227], v[0:3], 0
    v_or_b32 v160, v192, v193
    v_lshlrev_b32_sdwa v208, 1, v208 dst_sel:DWORD dst_unused:UNUSED_PAD src0_sel:DWORD src1_sel:WORD_1
    v_mfma_f32_16x16x32_bf16 v[180:183], v[224:227], v[4:7], 0
    v_lshlrev_b32_sdwa v209, 1, v209 dst_sel:DWORD dst_unused:UNUSED_PAD src0_sel:DWORD src1_sel:WORD_1
    ds_read_u16_d16 v208, v208
    ds_read_u16_d16_hi v209, v209
    v_mfma_f32_16x16x32_bf16 v[184:187], v[224:227], v[8:11], 0
    v_or_b32 v161, v194, v195
    v_mfma_f32_16x16x32_bf16 v[188:191], v[224:227], v[12:15], 0
    ds_read_b64_tr_b16 v[224:225], v255 offset:25664
    ds_read_b64_tr_b16 v[226:227], v255 offset:26432
    v_lshlrev_b32_sdwa v210, 1, v210 dst_sel:DWORD dst_unused:UNUSED_PAD src0_sel:DWORD src1_sel:WORD_1
    v_mfma_f32_16x16x32_bf16 v[48:51], v[228:231], v[144:147], v[48:51]
    v_lshlrev_b32_sdwa v211, 1, v211 dst_sel:DWORD dst_unused:UNUSED_PAD src0_sel:DWORD src1_sel:WORD_1
    ds_read_u16_d16 v210, v210
    ds_read_u16_d16_hi v211, v211
    v_mfma_f32_16x16x32_bf16 v[56:59], v[228:231], v[148:151], v[56:59]
    v_or_b32 v164, v196, v197
    v_mfma_f32_16x16x32_bf16 v[64:67], v[228:231], v[152:155], v[64:67]
    v_lshlrev_b32_sdwa v212, 1, v212 dst_sel:DWORD dst_unused:UNUSED_PAD src0_sel:DWORD src1_sel:WORD_1
    v_mfma_f32_16x16x32_bf16 v[72:75], v[228:231], v[156:159], v[72:75]
    ds_read_b64_tr_b16 v[228:229], v254 offset:22536
    ds_read_b64_tr_b16 v[230:231], v254 offset:22792
    v_lshlrev_b32_sdwa v213, 1, v213 dst_sel:DWORD dst_unused:UNUSED_PAD src0_sel:DWORD src1_sel:WORD_1
    ds_read_u16_d16 v212, v212
    ds_read_u16_d16_hi v213, v213
    s_waitcnt lgkmcnt(14)
    v_mfma_f32_16x16x32_bf16 v[176:179], v[232:235], v[16:19], v[176:179]
    v_or_b32 v165, v198, v199
    v_mfma_f32_16x16x32_bf16 v[180:183], v[232:235], v[20:23], v[180:183]
    v_lshlrev_b32_sdwa v214, 1, v214 dst_sel:DWORD dst_unused:UNUSED_PAD src0_sel:DWORD src1_sel:WORD_1
    v_mfma_f32_16x16x32_bf16 v[184:187], v[232:235], v[24:27], v[184:187]
    v_lshlrev_b32_sdwa v215, 1, v215 dst_sel:DWORD dst_unused:UNUSED_PAD src0_sel:DWORD src1_sel:WORD_1
    ds_read_u16_d16 v214, v214
    ds_read_u16_d16_hi v215, v215
    v_mfma_f32_16x16x32_bf16 v[188:191], v[232:235], v[28:31], v[188:191]
    ds_read_b64_tr_b16 v[232:233], v255 offset:25672
    ds_read_b64_tr_b16 v[234:235], v255 offset:26440
    v_or_b32 v168, v200, v201
    v_lshlrev_b32_sdwa v216, 1, v216 dst_sel:DWORD dst_unused:UNUSED_PAD src0_sel:DWORD src1_sel:WORD_1
    v_mfma_f32_16x16x32_bf16 v[52:55], v[236:239], v[144:147], v[52:55]
    v_lshlrev_b32_sdwa v217, 1, v217 dst_sel:DWORD dst_unused:UNUSED_PAD src0_sel:DWORD src1_sel:WORD_1
    ds_read_u16_d16 v216, v216
    ds_read_u16_d16_hi v217, v217
    v_mfma_f32_16x16x32_bf16 v[60:63], v[236:239], v[148:151], v[60:63]
    v_or_b32 v169, v202, v203
    v_mfma_f32_16x16x32_bf16 v[68:71], v[236:239], v[152:155], v[68:71]
    v_lshlrev_b32_sdwa v218, 1, v218 dst_sel:DWORD dst_unused:UNUSED_PAD src0_sel:DWORD src1_sel:WORD_1
    v_mfma_f32_16x16x32_bf16 v[76:79], v[236:239], v[156:159], v[76:79]
    ds_read_b64_tr_b16 v[236:237], v254 offset:23560
    ds_read_b64_tr_b16 v[238:239], v254 offset:23816
    v_lshlrev_b32_sdwa v219, 1, v219 dst_sel:DWORD dst_unused:UNUSED_PAD src0_sel:DWORD src1_sel:WORD_1
    ds_read_u16_d16 v218, v218
    ds_read_u16_d16_hi v219, v219
    s_waitcnt lgkmcnt(14)
    v_mfma_f32_16x16x32_bf16 v[176:179], v[240:243], v[32:35], v[176:179]
    v_or_b32 v172, v204, v205
    v_mfma_f32_16x16x32_bf16 v[180:183], v[240:243], v[36:39], v[180:183]
    v_lshlrev_b32_sdwa v220, 1, v220 dst_sel:DWORD dst_unused:UNUSED_PAD src0_sel:DWORD src1_sel:WORD_1
    v_mfma_f32_16x16x32_bf16 v[184:187], v[240:243], v[40:43], v[184:187]
    v_lshlrev_b32_sdwa v221, 1, v221 dst_sel:DWORD dst_unused:UNUSED_PAD src0_sel:DWORD src1_sel:WORD_1
    ds_read_u16_d16 v220, v220
    ds_read_u16_d16_hi v221, v221
    v_mfma_f32_16x16x32_bf16 v[188:191], v[240:243], v[44:47], v[188:191]
    ds_read_b64_tr_b16 v[240:241], v255 offset:25728
    ds_read_b64_tr_b16 v[242:243], v255 offset:26496
    v_or_b32 v173, v206, v207
    v_mfma_f32_16x16x32_bf16 v[80:83], v[224:227], v[144:147], v[80:83]
    v_lshlrev_b32_sdwa v222, 1, v222 dst_sel:DWORD dst_unused:UNUSED_PAD src0_sel:DWORD src1_sel:WORD_1
    v_mfma_f32_16x16x32_bf16 v[88:91], v[224:227], v[148:151], v[88:91]
    v_lshlrev_b32_sdwa v223, 1, v223 dst_sel:DWORD dst_unused:UNUSED_PAD src0_sel:DWORD src1_sel:WORD_1
    ds_read_u16_d16 v222, v222
    ds_read_u16_d16_hi v223, v223
    v_mfma_f32_16x16x32_bf16 v[96:99], v[224:227], v[152:155], v[96:99]
    v_mfma_f32_16x16x32_bf16 v[104:107], v[224:227], v[156:159], v[104:107]
    ds_read_b64_tr_b16 v[224:225], v254 offset:24584
    ds_read_b64_tr_b16 v[226:227], v254 offset:24840
    s_cmp_eq_u32 s17, 0
    s_cbranch_scc1 L_pu
    s_setprio 0
L_pu:
    s_waitcnt lgkmcnt(14)
    v_mfma_f32_16x16x32_bf16 v[192:195], v[228:231], v[0:3], 0
    v_or_b32 v162, v208, v209
    v_lshlrev_b32_sdwa v176, 1, v176 dst_sel:DWORD dst_unused:UNUSED_PAD src0_sel:DWORD src1_sel:WORD_1
    v_mfma_f32_16x16x32_bf16 v[196:199], v[228:231], v[4:7], 0
    v_lshlrev_b32_sdwa v177, 1, v177 dst_sel:DWORD dst_unused:UNUSED_PAD src0_sel:DWORD src1_sel:WORD_1
    ds_read_u16_d16 v176, v176
    ds_read_u16_d16_hi v177, v177
    v_mfma_f32_16x16x32_bf16 v[200:203], v[228:231], v[8:11], 0
    v_or_b32 v163, v210, v211
    v_mfma_f32_16x16x32_bf16 v[204:207], v[228:231], v[12:15], 0
    ds_read_b64_tr_b16 v[228:229], v255 offset:25736
    ds_read_b64_tr_b16 v[230:231], v255 offset:26504
    v_lshlrev_b32_sdwa v178, 1, v178 dst_sel:DWORD dst_unused:UNUSED_PAD src0_sel:DWORD src1_sel:WORD_1
    v_mfma_f32_16x16x32_bf16 v[84:87], v[232:235], v[144:147], v[84:87]
    v_lshlrev_b32_sdwa v179, 1, v179 dst_sel:DWORD dst_unused:UNUSED_PAD src0_sel:DWORD src1_sel:WORD_1
    ds_read_u16_d16 v178, v178
    ds_read_u16_d16_hi v179, v179
    v_mfma_f32_16x16x32_bf16 v[92:95], v[232:235], v[148:151], v[92:95]
    v_or_b32 v166, v212, v213
    v_mfma_f32_16x16x32_bf16 v[100:103], v[232:235], v[152:155], v[100:103]
    v_lshlrev_b32_sdwa v180, 1, v180 dst_sel:DWORD dst_unused:UNUSED_PAD src0_sel:DWORD src1_sel:WORD_1
    v_mfma_f32_16x16x32_bf16 v[108:111], v[232:235], v[156:159], v[108:111]

    s_cmp_ge_u32 s19, 13
    s_cbranch_scc1 L_rd13_go
    v_mov_b32 v232, 161976

    s_mov_b32 s29, 200000
L_rd13:
    ds_read_b32 v233, v232
    s_waitcnt lgkmcnt(0)
    v_cmp_le_u32 vcc, 13, v233
    s_cmp_eq_u64 vcc, exec
    s_cbranch_scc1 L_rd13_ok
    s_sleep 2
    s_sub_u32 s29, s29, 1
    s_cmp_lg_u32 s29, 0
    s_cbranch_scc1 L_rd13
L_rd13_ok:

    v_readfirstlane_b32 s19, v233
L_rd13_go:

    ds_read_b64_tr_b16 v[232:233], v254 offset:28672
    ds_read_b64_tr_b16 v[234:235], v254 offset:28928
    v_lshlrev_b32_sdwa v181, 1, v181 dst_sel:DWORD dst_unused:UNUSED_PAD src0_sel:DWORD src1_sel:WORD_1
    ds_read_u16_d16 v180, v180
    ds_read_u16_d16_hi v181, v181
    s_waitcnt lgkmcnt(14)
    v_mfma_f32_16x16x32_bf16 v[192:195], v[236:239], v[16:19], v[192:195]
    v_or_b32 v167, v214, v215
    v_mfma_f32_16x16x32_bf16 v[196:199], v[236:239], v[20:23], v[196:199]
    v_lshlrev_b32_sdwa v182, 1, v182 dst_sel:DWORD dst_unused:UNUSED_PAD src0_sel:DWORD src1_sel:WORD_1
    v_mfma_f32_16x16x32_bf16 v[200:203], v[236:239], v[24:27], v[200:203]
    v_lshlrev_b32_sdwa v183, 1, v183 dst_sel:DWORD dst_unused:UNUSED_PAD src0_sel:DWORD src1_sel:WORD_1
    ds_read_u16_d16 v182, v182
    ds_read_u16_d16_hi v183, v183
    v_mfma_f32_16x16x32_bf16 v[204:207], v[236:239], v[28:31], v[204:207]

    s_cmp_ge_u32 s19, 14
    s_cbranch_scc1 L_rd14_go
    v_mov_b32 v236, 161976

    s_mov_b32 s29, 200000
L_rd14:
    ds_read_b32 v237, v236
    s_waitcnt lgkmcnt(0)
    v_cmp_le_u32 vcc, 14, v237
    s_cmp_eq_u64 vcc, exec
    s_cbranch_scc1 L_rd14_ok
    s_sleep 2
    s_sub_u32 s29, s29, 1
    s_cmp_lg_u32 s29, 0
    s_cbranch_scc1 L_rd14
L_rd14_ok:

    v_readfirstlane_b32 s19, v237
L_rd14_go:

    ds_read_b64_tr_b16 v[236:237], v255 offset:31744
    ds_read_b64_tr_b16 v[238:239], v255 offset:32512
    v_or_b32 v170, v216, v217
    v_lshlrev_b32_sdwa v184, 1, v184 dst_sel:DWORD dst_unused:UNUSED_PAD src0_sel:DWORD src1_sel:WORD_1
    v_mfma_f32_16x16x32_bf16 v[112:115], v[240:243], v[144:147], v[112:115]
    v_lshlrev_b32_sdwa v185, 1, v185 dst_sel:DWORD dst_unused:UNUSED_PAD src0_sel:DWORD src1_sel:WORD_1
    ds_read_u16_d16 v184, v184
    ds_read_u16_d16_hi v185, v185
    v_mfma_f32_16x16x32_bf16 v[120:123], v[240:243], v[148:151], v[120:123]
    v_or_b32 v171, v218, v219
    v_mfma_f32_16x16x32_bf16 v[128:131], v[240:243], v[152:155], v[128:131]
    v_lshlrev_b32_sdwa v186, 1, v186 dst_sel:DWORD dst_unused:UNUSED_PAD src0_sel:DWORD src1_sel:WORD_1
    v_mfma_f32_16x16x32_bf16 v[136:139], v[240:243], v[156:159], v[136:139]
    ds_read_b64_tr_b16 v[240:241], v254 offset:29696
    ds_read_b64_tr_b16 v[242:243], v254 offset:29952
    v_lshlrev_b32_sdwa v187, 1, v187 dst_sel:DWORD dst_unused:UNUSED_PAD src0_sel:DWORD src1_sel:WORD_1
    ds_read_u16_d16 v186, v186
    ds_read_u16_d16_hi v187, v187
    s_waitcnt lgkmcnt(14)
    v_mfma_f32_16x16x32_bf16 v[192:195], v[224:227], v[32:35], v[192:195]
    v_or_b32 v174, v220, v221
    v_mfma_f32_16x16x32_bf16 v[196:199], v[224:227], v[36:39], v[196:199]
    v_lshlrev_b32_sdwa v188, 1, v188 dst_sel:DWORD dst_unused:UNUSED_PAD src0_sel:DWORD src1_sel:WORD_1
    v_mfma_f32_16x16x32_bf16 v[200:203], v[224:227], v[40:43], v[200:203]
    v_lshlrev_b32_sdwa v189, 1, v189 dst_sel:DWORD dst_unused:UNUSED_PAD src0_sel:DWORD src1_sel:WORD_1
    ds_read_u16_d16 v188, v188
    ds_read_u16_d16_hi v189, v189
    v_mfma_f32_16x16x32_bf16 v[204:207], v[224:227], v[44:47], v[204:207]
    ds_read_b64_tr_b16 v[224:225], v255 offset:31752
    ds_read_b64_tr_b16 v[226:227], v255 offset:32520
    v_or_b32 v175, v222, v223
    v_mfma_f32_16x16x32_bf16 v[116:119], v[228:231], v[144:147], v[116:119]
    v_lshlrev_b32_sdwa v190, 1, v190 dst_sel:DWORD dst_unused:UNUSED_PAD src0_sel:DWORD src1_sel:WORD_1
    v_mfma_f32_16x16x32_bf16 v[124:127], v[228:231], v[148:151], v[124:127]
    v_lshlrev_b32_sdwa v191, 1, v191 dst_sel:DWORD dst_unused:UNUSED_PAD src0_sel:DWORD src1_sel:WORD_1
    ds_read_u16_d16 v190, v190
    ds_read_u16_d16_hi v191, v191
    v_mfma_f32_16x16x32_bf16 v[132:135], v[228:231], v[152:155], v[132:135]
    v_mfma_f32_16x16x32_bf16 v[140:143], v[228:231], v[156:159], v[140:143]
    ds_read_b64_tr_b16 v[228:229], v254 offset:30720
    ds_read_b64_tr_b16 v[230:231], v254 offset:30976
    s_waitcnt lgkmcnt(14)
    v_mfma_f32_16x16x32_bf16 v[208:211], v[232:235], v[0:3], 0
    v_or_b32 v144, v176, v177
    v_lshlrev_b32_sdwa v192, 1, v192 dst_sel:DWORD dst_unused:UNUSED_PAD src0_sel:DWORD src1_sel:WORD_1
    v_mfma_f32_16x16x32_bf16 v[212:215], v[232:235], v[4:7], 0
    v_lshlrev_b32_sdwa v193, 1, v193 dst_sel:DWORD dst_unused:UNUSED_PAD src0_sel:DWORD src1_sel:WORD_1
    ds_read_u16_d16 v192, v192
    ds_read_u16_d16_hi v193, v193
    v_mfma_f32_16x16x32_bf16 v[216:219], v[232:235], v[8:11], 0
    v_or_b32 v145, v178, v179
    v_mfma_f32_16x16x32_bf16 v[220:223], v[232:235], v[12:15], 0
    ds_read_b64_tr_b16 v[232:233], v255 offset:31808
    ds_read_b64_tr_b16 v[234:235], v255 offset:32576
    v_lshlrev_b32_sdwa v194, 1, v194 dst_sel:DWORD dst_unused:UNUSED_PAD src0_sel:DWORD src1_sel:WORD_1
    v_mfma_f32_16x16x32_bf16 v[48:51], v[236:239], v[160:163], v[48:51]
    v_lshlrev_b32_sdwa v195, 1, v195 dst_sel:DWORD dst_unused:UNUSED_PAD src0_sel:DWORD src1_sel:WORD_1
    ds_read_u16_d16 v194, v194
    ds_read_u16_d16_hi v195, v195
    v_mfma_f32_16x16x32_bf16 v[56:59], v[236:239], v[164:167], v[56:59]
    v_or_b32 v148, v180, v181
    s_waitcnt vmcnt(0)
    v_dot2_f32_bf16 v88, v244, s86, v88
    v_dot2_f32_bf16 v89, v244, s87, v89
    v_mfma_f32_16x16x32_bf16 v[64:67], v[236:239], v[168:171], v[64:67]
    v_lshlrev_b32_sdwa v196, 1, v196 dst_sel:DWORD dst_unused:UNUSED_PAD src0_sel:DWORD src1_sel:WORD_1
    v_dot2_f32_bf16 v90, v245, s86, v90
    v_dot2_f32_bf16 v91, v245, s87, v91
    v_mfma_f32_16x16x32_bf16 v[72:75], v[236:239], v[172:175], v[72:75]
    ds_read_b64_tr_b16 v[236:237], v254 offset:28680
    ds_read_b64_tr_b16 v[238:239], v254 offset:28936
    v_lshlrev_b32_sdwa v197, 1, v197 dst_sel:DWORD dst_unused:UNUSED_PAD src0_sel:DWORD src1_sel:WORD_1
    ds_read_u16_d16 v196, v196
    ds_read_u16_d16_hi v197, v197
    v_dot2_f32_bf16 v92, v246, s86, v92
    v_dot2_f32_bf16 v93, v246, s87, v93
    s_waitcnt lgkmcnt(14)
    v_mfma_f32_16x16x32_bf16 v[208:211], v[240:243], v[16:19], v[208:211]
    v_or_b32 v149, v182, v183
    v_dot2_f32_bf16 v94, v247, s86, v94
    v_dot2_f32_bf16 v95, v247, s87, v95
    v_mfma_f32_16x16x32_bf16 v[212:215], v[240:243], v[20:23], v[212:215]
    v_lshlrev_b32_sdwa v198, 1, v198 dst_sel:DWORD dst_unused:UNUSED_PAD src0_sel:DWORD src1_sel:WORD_1
    v_dot2_f32_bf16 v120, v248, s86, v120
    v_dot2_f32_bf16 v121, v248, s87, v121
    v_mfma_f32_16x16x32_bf16 v[216:219], v[240:243], v[24:27], v[216:219]
    v_lshlrev_b32_sdwa v199, 1, v199 dst_sel:DWORD dst_unused:UNUSED_PAD src0_sel:DWORD src1_sel:WORD_1
    ds_read_u16_d16 v198, v198
    ds_read_u16_d16_hi v199, v199
    v_dot2_f32_bf16 v122, v249, s86, v122
    v_dot2_f32_bf16 v123, v249, s87, v123
    v_mfma_f32_16x16x32_bf16 v[220:223], v[240:243], v[28:31], v[220:223]
    ds_read_b64_tr_b16 v[240:241], v255 offset:31816
    ds_read_b64_tr_b16 v[242:243], v255 offset:32584
    v_or_b32 v152, v184, v185
    v_lshlrev_b32_sdwa v200, 1, v200 dst_sel:DWORD dst_unused:UNUSED_PAD src0_sel:DWORD src1_sel:WORD_1
    v_dot2_f32_bf16 v124, v250, s86, v124
    v_dot2_f32_bf16 v125, v250, s87, v125
    v_mfma_f32_16x16x32_bf16 v[52:55], v[224:227], v[160:163], v[52:55]
    v_lshlrev_b32_sdwa v201, 1, v201 dst_sel:DWORD dst_unused:UNUSED_PAD src0_sel:DWORD src1_sel:WORD_1
    ds_read_u16_d16 v200, v200
    ds_read_u16_d16_hi v201, v201
    v_dot2_f32_bf16 v126, v251, s86, v126
    v_dot2_f32_bf16 v127, v251, s87, v127
    buffer_load_dwordx4 v[244:247], v252, s[4:7], s25 offen offset:0 sc1
    buffer_load_dwordx4 v[248:251], v252, s[4:7], s25 offen offset:64 sc1
    v_mfma_f32_16x16x32_bf16 v[60:63], v[224:227], v[164:167], v[60:63]
    v_or_b32 v153, v186, v187
    v_mfma_f32_16x16x32_bf16 v[68:71], v[224:227], v[168:171], v[68:71]
    v_lshlrev_b32_sdwa v202, 1, v202 dst_sel:DWORD dst_unused:UNUSED_PAD src0_sel:DWORD src1_sel:WORD_1
    v_mfma_f32_16x16x32_bf16 v[76:79], v[224:227], v[172:175], v[76:79]
    ds_read_b64_tr_b16 v[224:225], v254 offset:29704
    ds_read_b64_tr_b16 v[226:227], v254 offset:29960
    v_lshlrev_b32_sdwa v203, 1, v203 dst_sel:DWORD dst_unused:UNUSED_PAD src0_sel:DWORD src1_sel:WORD_1
    ds_read_u16_d16 v202, v202
    ds_read_u16_d16_hi v203, v203
    s_waitcnt lgkmcnt(14)
    v_mfma_f32_16x16x32_bf16 v[208:211], v[228:231], v[32:35], v[208:211]
    v_or_b32 v156, v188, v189
    v_mfma_f32_16x16x32_bf16 v[212:215], v[228:231], v[36:39], v[212:215]
    v_lshlrev_b32_sdwa v204, 1, v204 dst_sel:DWORD dst_unused:UNUSED_PAD src0_sel:DWORD src1_sel:WORD_1
    v_mfma_f32_16x16x32_bf16 v[216:219], v[228:231], v[40:43], v[216:219]
    v_lshlrev_b32_sdwa v205, 1, v205 dst_sel:DWORD dst_unused:UNUSED_PAD src0_sel:DWORD src1_sel:WORD_1
    ds_read_u16_d16 v204, v204
    ds_read_u16_d16_hi v205, v205
    v_mfma_f32_16x16x32_bf16 v[220:223], v[228:231], v[44:47], v[220:223]
    ds_read_b64_tr_b16 v[228:229], v255 offset:31872
    ds_read_b64_tr_b16 v[230:231], v255 offset:32640
    v_or_b32 v157, v190, v191
    v_mfma_f32_16x16x32_bf16 v[80:83], v[232:235], v[160:163], v[80:83]
    v_lshlrev_b32_sdwa v206, 1, v206 dst_sel:DWORD dst_unused:UNUSED_PAD src0_sel:DWORD src1_sel:WORD_1
    v_mfma_f32_16x16x32_bf16 v[88:91], v[232:235], v[164:167], v[88:91]
    v_lshlrev_b32_sdwa v207, 1, v207 dst_sel:DWORD dst_unused:UNUSED_PAD src0_sel:DWORD src1_sel:WORD_1
    ds_read_u16_d16 v206, v206
    ds_read_u16_d16_hi v207, v207
    v_mfma_f32_16x16x32_bf16 v[96:99], v[232:235], v[168:171], v[96:99]
    v_mfma_f32_16x16x32_bf16 v[104:107], v[232:235], v[172:175], v[104:107]
    ds_read_b64_tr_b16 v[232:233], v254 offset:30728
    ds_read_b64_tr_b16 v[234:235], v254 offset:30984
    s_waitcnt lgkmcnt(14)
    v_mfma_f32_16x16x32_bf16 v[176:179], v[236:239], v[0:3], 0
    v_or_b32 v146, v192, v193
    v_lshlrev_b32_sdwa v208, 1, v208 dst_sel:DWORD dst_unused:UNUSED_PAD src0_sel:DWORD src1_sel:WORD_1
    v_mfma_f32_16x16x32_bf16 v[180:183], v[236:239], v[4:7], 0
    v_lshlrev_b32_sdwa v209, 1, v209 dst_sel:DWORD dst_unused:UNUSED_PAD src0_sel:DWORD src1_sel:WORD_1
    ds_read_u16_d16 v208, v208
    ds_read_u16_d16_hi v209, v209
    v_mfma_f32_16x16x32_bf16 v[184:187], v[236:239], v[8:11], 0
    v_or_b32 v147, v194, v195
    v_mfma_f32_16x16x32_bf16 v[188:191], v[236:239], v[12:15], 0
    ds_read_b64_tr_b16 v[236:237], v255 offset:31880
    ds_read_b64_tr_b16 v[238:239], v255 offset:32648
    v_lshlrev_b32_sdwa v210, 1, v210 dst_sel:DWORD dst_unused:UNUSED_PAD src0_sel:DWORD src1_sel:WORD_1
    v_mfma_f32_16x16x32_bf16 v[84:87], v[240:243], v[160:163], v[84:87]
    v_lshlrev_b32_sdwa v211, 1, v211 dst_sel:DWORD dst_unused:UNUSED_PAD src0_sel:DWORD src1_sel:WORD_1
    ds_read_u16_d16 v210, v210
    ds_read_u16_d16_hi v211, v211
    v_mfma_f32_16x16x32_bf16 v[92:95], v[240:243], v[164:167], v[92:95]
    v_or_b32 v150, v196, v197
    v_mfma_f32_16x16x32_bf16 v[100:103], v[240:243], v[168:171], v[100:103]
    v_lshlrev_b32_sdwa v212, 1, v212 dst_sel:DWORD dst_unused:UNUSED_PAD src0_sel:DWORD src1_sel:WORD_1
    v_mfma_f32_16x16x32_bf16 v[108:111], v[240:243], v[172:175], v[108:111]

    s_cmp_ge_u32 s19, 15
    s_cbranch_scc1 L_rd15_go
    v_mov_b32 v240, 161976

    s_mov_b32 s29, 200000
L_rd15:
    ds_read_b32 v241, v240
    s_waitcnt lgkmcnt(0)
    v_cmp_le_u32 vcc, 15, v241
    s_cmp_eq_u64 vcc, exec
    s_cbranch_scc1 L_rd15_ok
    s_sleep 2
    s_sub_u32 s29, s29, 1
    s_cmp_lg_u32 s29, 0
    s_cbranch_scc1 L_rd15
L_rd15_ok:

    v_readfirstlane_b32 s19, v241
L_rd15_go:

    ds_read_b64_tr_b16 v[240:241], v254 offset:34816
    ds_read_b64_tr_b16 v[242:243], v254 offset:35072
    v_lshlrev_b32_sdwa v213, 1, v213 dst_sel:DWORD dst_unused:UNUSED_PAD src0_sel:DWORD src1_sel:WORD_1
    ds_read_u16_d16 v212, v212
    ds_read_u16_d16_hi v213, v213
    s_waitcnt lgkmcnt(14)
    v_mfma_f32_16x16x32_bf16 v[176:179], v[224:227], v[16:19], v[176:179]
    v_or_b32 v151, v198, v199
    v_mfma_f32_16x16x32_bf16 v[180:183], v[224:227], v[20:23], v[180:183]
    v_lshlrev_b32_sdwa v214, 1, v214 dst_sel:DWORD dst_unused:UNUSED_PAD src0_sel:DWORD src1_sel:WORD_1
    v_mfma_f32_16x16x32_bf16 v[184:187], v[224:227], v[24:27], v[184:187]
    v_lshlrev_b32_sdwa v215, 1, v215 dst_sel:DWORD dst_unused:UNUSED_PAD src0_sel:DWORD src1_sel:WORD_1
    ds_read_u16_d16 v214, v214
    ds_read_u16_d16_hi v215, v215
    v_mfma_f32_16x16x32_bf16 v[188:191], v[224:227], v[28:31], v[188:191]

    s_cmp_ge_u32 s19, 16
    s_cbranch_scc1 L_rd16_go
    v_mov_b32 v224, 161976

    s_mov_b32 s29, 200000
L_rd16:
    ds_read_b32 v225, v224
    s_waitcnt lgkmcnt(0)
    v_cmp_le_u32 vcc, 16, v225
    s_cmp_eq_u64 vcc, exec
    s_cbranch_scc1 L_rd16_ok
    s_sleep 2
    s_sub_u32 s29, s29, 1
    s_cmp_lg_u32 s29, 0
    s_cbranch_scc1 L_rd16
L_rd16_ok:

    v_readfirstlane_b32 s19, v225
L_rd16_go:

    ds_read_b64_tr_b16 v[224:225], v255 offset:37888
    ds_read_b64_tr_b16 v[226:227], v255 offset:38656
    v_or_b32 v154, v200, v201
    v_lshlrev_b32_sdwa v216, 1, v216 dst_sel:DWORD dst_unused:UNUSED_PAD src0_sel:DWORD src1_sel:WORD_1
    v_mfma_f32_16x16x32_bf16 v[112:115], v[228:231], v[160:163], v[112:115]
    v_lshlrev_b32_sdwa v217, 1, v217 dst_sel:DWORD dst_unused:UNUSED_PAD src0_sel:DWORD src1_sel:WORD_1
    ds_read_u16_d16 v216, v216
    ds_read_u16_d16_hi v217, v217
    v_mfma_f32_16x16x32_bf16 v[120:123], v[228:231], v[164:167], v[120:123]
    v_or_b32 v155, v202, v203
    v_mfma_f32_16x16x32_bf16 v[128:131], v[228:231], v[168:171], v[128:131]
    v_lshlrev_b32_sdwa v218, 1, v218 dst_sel:DWORD dst_unused:UNUSED_PAD src0_sel:DWORD src1_sel:WORD_1
    v_mfma_f32_16x16x32_bf16 v[136:139], v[228:231], v[172:175], v[136:139]
    ds_read_b64_tr_b16 v[228:229], v254 offset:35840
    ds_read_b64_tr_b16 v[230:231], v254 offset:36096
    v_lshlrev_b32_sdwa v219, 1, v219 dst_sel:DWORD dst_unused:UNUSED_PAD src0_sel:DWORD src1_sel:WORD_1
    ds_read_u16_d16 v218, v218
    ds_read_u16_d16_hi v219, v219
    s_waitcnt lgkmcnt(14)
    v_mfma_f32_16x16x32_bf16 v[176:179], v[232:235], v[32:35], v[176:179]
    v_or_b32 v158, v204, v205
    v_mfma_f32_16x16x32_bf16 v[180:183], v[232:235], v[36:39], v[180:183]
    v_lshlrev_b32_sdwa v220, 1, v220 dst_sel:DWORD dst_unused:UNUSED_PAD src0_sel:DWORD src1_sel:WORD_1
    v_mfma_f32_16x16x32_bf16 v[184:187], v[232:235], v[40:43], v[184:187]
    v_lshlrev_b32_sdwa v221, 1, v221 dst_sel:DWORD dst_unused:UNUSED_PAD src0_sel:DWORD src1_sel:WORD_1
    ds_read_u16_d16 v220, v220
    ds_read_u16_d16_hi v221, v221
    v_mfma_f32_16x16x32_bf16 v[188:191], v[232:235], v[44:47], v[188:191]
    ds_read_b64_tr_b16 v[232:233], v255 offset:37896
    ds_read_b64_tr_b16 v[234:235], v255 offset:38664
    v_or_b32 v159, v206, v207
    v_mfma_f32_16x16x32_bf16 v[116:119], v[236:239], v[160:163], v[116:119]
    v_lshlrev_b32_sdwa v222, 1, v222 dst_sel:DWORD dst_unused:UNUSED_PAD src0_sel:DWORD src1_sel:WORD_1
    v_mfma_f32_16x16x32_bf16 v[124:127], v[236:239], v[164:167], v[124:127]
    v_lshlrev_b32_sdwa v223, 1, v223 dst_sel:DWORD dst_unused:UNUSED_PAD src0_sel:DWORD src1_sel:WORD_1
    ds_read_u16_d16 v222, v222
    ds_read_u16_d16_hi v223, v223
    v_mfma_f32_16x16x32_bf16 v[132:135], v[236:239], v[168:171], v[132:135]
    v_mfma_f32_16x16x32_bf16 v[140:143], v[236:239], v[172:175], v[140:143]
    ds_read_b64_tr_b16 v[236:237], v254 offset:36864
    ds_read_b64_tr_b16 v[238:239], v254 offset:37120
    s_waitcnt lgkmcnt(14)
    v_mfma_f32_16x16x32_bf16 v[192:195], v[240:243], v[0:3], 0
    v_or_b32 v160, v208, v209
    v_lshlrev_b32_sdwa v176, 1, v176 dst_sel:DWORD dst_unused:UNUSED_PAD src0_sel:DWORD src1_sel:WORD_1
    v_mfma_f32_16x16x32_bf16 v[196:199], v[240:243], v[4:7], 0
    v_lshlrev_b32_sdwa v177, 1, v177 dst_sel:DWORD dst_unused:UNUSED_PAD src0_sel:DWORD src1_sel:WORD_1
    ds_read_u16_d16 v176, v176
    ds_read_u16_d16_hi v177, v177
    v_mfma_f32_16x16x32_bf16 v[200:203], v[240:243], v[8:11], 0
    v_or_b32 v161, v210, v211
    v_mfma_f32_16x16x32_bf16 v[204:207], v[240:243], v[12:15], 0
    ds_read_b64_tr_b16 v[240:241], v255 offset:37952
    ds_read_b64_tr_b16 v[242:243], v255 offset:38720
    v_lshlrev_b32_sdwa v178, 1, v178 dst_sel:DWORD dst_unused:UNUSED_PAD src0_sel:DWORD src1_sel:WORD_1
    v_mfma_f32_16x16x32_bf16 v[48:51], v[224:227], v[144:147], v[48:51]
    v_lshlrev_b32_sdwa v179, 1, v179 dst_sel:DWORD dst_unused:UNUSED_PAD src0_sel:DWORD src1_sel:WORD_1
    ds_read_u16_d16 v178, v178
    ds_read_u16_d16_hi v179, v179
    v_mfma_f32_16x16x32_bf16 v[56:59], v[224:227], v[148:151], v[56:59]
    v_or_b32 v164, v212, v213
    v_mfma_f32_16x16x32_bf16 v[64:67], v[224:227], v[152:155], v[64:67]
    v_lshlrev_b32_sdwa v180, 1, v180 dst_sel:DWORD dst_unused:UNUSED_PAD src0_sel:DWORD src1_sel:WORD_1
    v_mfma_f32_16x16x32_bf16 v[72:75], v[224:227], v[156:159], v[72:75]
    ds_read_b64_tr_b16 v[224:225], v254 offset:34824
    ds_read_b64_tr_b16 v[226:227], v254 offset:35080
    v_lshlrev_b32_sdwa v181, 1, v181 dst_sel:DWORD dst_unused:UNUSED_PAD src0_sel:DWORD src1_sel:WORD_1
    ds_read_u16_d16 v180, v180
    ds_read_u16_d16_hi v181, v181
    s_waitcnt lgkmcnt(14)
    v_mfma_f32_16x16x32_bf16 v[192:195], v[228:231], v[16:19], v[192:195]
    v_or_b32 v165, v214, v215
    v_mfma_f32_16x16x32_bf16 v[196:199], v[228:231], v[20:23], v[196:199]
    v_lshlrev_b32_sdwa v182, 1, v182 dst_sel:DWORD dst_unused:UNUSED_PAD src0_sel:DWORD src1_sel:WORD_1
    v_mfma_f32_16x16x32_bf16 v[200:203], v[228:231], v[24:27], v[200:203]
    v_lshlrev_b32_sdwa v183, 1, v183 dst_sel:DWORD dst_unused:UNUSED_PAD src0_sel:DWORD src1_sel:WORD_1
    ds_read_u16_d16 v182, v182
    ds_read_u16_d16_hi v183, v183
    v_mfma_f32_16x16x32_bf16 v[204:207], v[228:231], v[28:31], v[204:207]
    ds_read_b64_tr_b16 v[228:229], v255 offset:37960
    ds_read_b64_tr_b16 v[230:231], v255 offset:38728
    v_or_b32 v168, v216, v217
    v_lshlrev_b32_sdwa v184, 1, v184 dst_sel:DWORD dst_unused:UNUSED_PAD src0_sel:DWORD src1_sel:WORD_1
    v_mfma_f32_16x16x32_bf16 v[52:55], v[232:235], v[144:147], v[52:55]
    v_lshlrev_b32_sdwa v185, 1, v185 dst_sel:DWORD dst_unused:UNUSED_PAD src0_sel:DWORD src1_sel:WORD_1
    ds_read_u16_d16 v184, v184
    ds_read_u16_d16_hi v185, v185
    v_mfma_f32_16x16x32_bf16 v[60:63], v[232:235], v[148:151], v[60:63]
    v_or_b32 v169, v218, v219
    v_mfma_f32_16x16x32_bf16 v[68:71], v[232:235], v[152:155], v[68:71]
    v_lshlrev_b32_sdwa v186, 1, v186 dst_sel:DWORD dst_unused:UNUSED_PAD src0_sel:DWORD src1_sel:WORD_1
    v_mfma_f32_16x16x32_bf16 v[76:79], v[232:235], v[156:159], v[76:79]
    ds_read_b64_tr_b16 v[232:233], v254 offset:35848
    ds_read_b64_tr_b16 v[234:235], v254 offset:36104
    v_lshlrev_b32_sdwa v187, 1, v187 dst_sel:DWORD dst_unused:UNUSED_PAD src0_sel:DWORD src1_sel:WORD_1
    ds_read_u16_d16 v186, v186
    ds_read_u16_d16_hi v187, v187
    s_waitcnt lgkmcnt(14)
    v_mfma_f32_16x16x32_bf16 v[192:195], v[236:239], v[32:35], v[192:195]
    v_or_b32 v172, v220, v221
    v_mfma_f32_16x16x32_bf16 v[196:199], v[236:239], v[36:39], v[196:199]
    v_lshlrev_b32_sdwa v188, 1, v188 dst_sel:DWORD dst_unused:UNUSED_PAD src0_sel:DWORD src1_sel:WORD_1
    v_mfma_f32_16x16x32_bf16 v[200:203], v[236:239], v[40:43], v[200:203]
    v_lshlrev_b32_sdwa v189, 1, v189 dst_sel:DWORD dst_unused:UNUSED_PAD src0_sel:DWORD src1_sel:WORD_1
    ds_read_u16_d16 v188, v188
    ds_read_u16_d16_hi v189, v189
    v_mfma_f32_16x16x32_bf16 v[204:207], v[236:239], v[44:47], v[204:207]
    ds_read_b64_tr_b16 v[236:237], v255 offset:38016
    ds_read_b64_tr_b16 v[238:239], v255 offset:38784
    v_or_b32 v173, v222, v223
    v_mfma_f32_16x16x32_bf16 v[80:83], v[240:243], v[144:147], v[80:83]
    v_lshlrev_b32_sdwa v190, 1, v190 dst_sel:DWORD dst_unused:UNUSED_PAD src0_sel:DWORD src1_sel:WORD_1
    v_mfma_f32_16x16x32_bf16 v[88:91], v[240:243], v[148:151], v[88:91]
    v_lshlrev_b32_sdwa v191, 1, v191 dst_sel:DWORD dst_unused:UNUSED_PAD src0_sel:DWORD src1_sel:WORD_1
    ds_read_u16_d16 v190, v190
    ds_read_u16_d16_hi v191, v191
    v_mfma_f32_16x16x32_bf16 v[96:99], v[240:243], v[152:155], v[96:99]
    v_mfma_f32_16x16x32_bf16 v[104:107], v[240:243], v[156:159], v[104:107]
    ds_read_b64_tr_b16 v[240:241], v254 offset:36872
    ds_read_b64_tr_b16 v[242:243], v254 offset:37128
    s_waitcnt lgkmcnt(14)
    v_mfma_f32_16x16x32_bf16 v[208:211], v[224:227], v[0:3], 0
    v_or_b32 v162, v176, v177
    v_lshlrev_b32_sdwa v192, 1, v192 dst_sel:DWORD dst_unused:UNUSED_PAD src0_sel:DWORD src1_sel:WORD_1
    v_mfma_f32_16x16x32_bf16 v[212:215], v[224:227], v[4:7], 0
    v_lshlrev_b32_sdwa v193, 1, v193 dst_sel:DWORD dst_unused:UNUSED_PAD src0_sel:DWORD src1_sel:WORD_1
    ds_read_u16_d16 v192, v192
    ds_read_u16_d16_hi v193, v193
    v_mfma_f32_16x16x32_bf16 v[216:219], v[224:227], v[8:11], 0
    v_or_b32 v163, v178, v179
    v_mfma_f32_16x16x32_bf16 v[220:223], v[224:227], v[12:15], 0
    ds_read_b64_tr_b16 v[224:225], v255 offset:38024
    ds_read_b64_tr_b16 v[226:227], v255 offset:38792
    v_lshlrev_b32_sdwa v194, 1, v194 dst_sel:DWORD dst_unused:UNUSED_PAD src0_sel:DWORD src1_sel:WORD_1
    v_mfma_f32_16x16x32_bf16 v[84:87], v[228:231], v[144:147], v[84:87]
    v_lshlrev_b32_sdwa v195, 1, v195 dst_sel:DWORD dst_unused:UNUSED_PAD src0_sel:DWORD src1_sel:WORD_1
    ds_read_u16_d16 v194, v194
    ds_read_u16_d16_hi v195, v195
    v_mfma_f32_16x16x32_bf16 v[92:95], v[228:231], v[148:151], v[92:95]
    v_or_b32 v166, v180, v181
    s_waitcnt vmcnt(0)
    v_dot2_f32_bf16 v64, v244, s86, v64
    v_dot2_f32_bf16 v65, v244, s87, v65
    v_mfma_f32_16x16x32_bf16 v[100:103], v[228:231], v[152:155], v[100:103]
    v_lshlrev_b32_sdwa v196, 1, v196 dst_sel:DWORD dst_unused:UNUSED_PAD src0_sel:DWORD src1_sel:WORD_1
    v_dot2_f32_bf16 v66, v245, s86, v66
    v_dot2_f32_bf16 v67, v245, s87, v67
    v_mfma_f32_16x16x32_bf16 v[108:111], v[228:231], v[156:159], v[108:111]

    s_cmp_ge_u32 s19, 17
    s_cbranch_scc1 L_rd17_go
    v_mov_b32 v228, 161976

    s_mov_b32 s29, 200000
L_rd17:
    ds_read_b32 v229, v228
    s_waitcnt lgkmcnt(0)
    v_cmp_le_u32 vcc, 17, v229
    s_cmp_eq_u64 vcc, exec
    s_cbranch_scc1 L_rd17_ok
    s_sleep 2
    s_sub_u32 s29, s29, 1
    s_cmp_lg_u32 s29, 0
    s_cbranch_scc1 L_rd17
L_rd17_ok:

    v_readfirstlane_b32 s19, v229
L_rd17_go:

    ds_read_b64_tr_b16 v[228:229], v254 offset:40960
    ds_read_b64_tr_b16 v[230:231], v254 offset:41216
    v_lshlrev_b32_sdwa v197, 1, v197 dst_sel:DWORD dst_unused:UNUSED_PAD src0_sel:DWORD src1_sel:WORD_1
    ds_read_u16_d16 v196, v196
    ds_read_u16_d16_hi v197, v197
    v_dot2_f32_bf16 v68, v246, s86, v68
    v_dot2_f32_bf16 v69, v246, s87, v69
    s_waitcnt lgkmcnt(14)
    v_mfma_f32_16x16x32_bf16 v[208:211], v[232:235], v[16:19], v[208:211]
    v_or_b32 v167, v182, v183
    v_dot2_f32_bf16 v70, v247, s86, v70
    v_dot2_f32_bf16 v71, v247, s87, v71
    v_mfma_f32_16x16x32_bf16 v[212:215], v[232:235], v[20:23], v[212:215]
    v_lshlrev_b32_sdwa v198, 1, v198 dst_sel:DWORD dst_unused:UNUSED_PAD src0_sel:DWORD src1_sel:WORD_1
    v_dot2_f32_bf16 v96, v248, s86, v96
    v_dot2_f32_bf16 v97, v248, s87, v97
    v_mfma_f32_16x16x32_bf16 v[216:219], v[232:235], v[24:27], v[216:219]
    v_lshlrev_b32_sdwa v199, 1, v199 dst_sel:DWORD dst_unused:UNUSED_PAD src0_sel:DWORD src1_sel:WORD_1
    ds_read_u16_d16 v198, v198
    ds_read_u16_d16_hi v199, v199
    v_dot2_f32_bf16 v98, v249, s86, v98
    v_dot2_f32_bf16 v99, v249, s87, v99
    v_mfma_f32_16x16x32_bf16 v[220:223], v[232:235], v[28:31], v[220:223]

    s_cmp_ge_u32 s19, 18
    s_cbranch_scc1 L_rd18_go
    v_mov_b32 v232, 161976

    s_mov_b32 s29, 200000
L_rd18:
    ds_read_b32 v233, v232
    s_waitcnt lgkmcnt(0)
    v_cmp_le_u32 vcc, 18, v233
    s_cmp_eq_u64 vcc, exec
    s_cbranch_scc1 L_rd18_ok
    s_sleep 2
    s_sub_u32 s29, s29, 1
    s_cmp_lg_u32 s29, 0
    s_cbranch_scc1 L_rd18
L_rd18_ok:

    v_readfirstlane_b32 s19, v233
L_rd18_go:

    ds_read_b64_tr_b16 v[232:233], v255 offset:44032
    ds_read_b64_tr_b16 v[234:235], v255 offset:44800
    v_or_b32 v170, v184, v185
    v_lshlrev_b32_sdwa v200, 1, v200 dst_sel:DWORD dst_unused:UNUSED_PAD src0_sel:DWORD src1_sel:WORD_1
    v_dot2_f32_bf16 v100, v250, s86, v100
    v_dot2_f32_bf16 v101, v250, s87, v101
    v_mfma_f32_16x16x32_bf16 v[112:115], v[236:239], v[144:147], v[112:115]
    v_lshlrev_b32_sdwa v201, 1, v201 dst_sel:DWORD dst_unused:UNUSED_PAD src0_sel:DWORD src1_sel:WORD_1
    ds_read_u16_d16 v200, v200
    ds_read_u16_d16_hi v201, v201
    v_dot2_f32_bf16 v102, v251, s86, v102
    v_dot2_f32_bf16 v103, v251, s87, v103
    buffer_load_dwordx4 v[244:247], v252, s[4:7], s25 offen offset:128 sc1
    buffer_load_dwordx4 v[248:251], v252, s[4:7], s25 offen offset:192 sc1
    v_mfma_f32_16x16x32_bf16 v[120:123], v[236:239], v[148:151], v[120:123]
    v_or_b32 v171, v186, v187
    v_mfma_f32_16x16x32_bf16 v[128:131], v[236:239], v[152:155], v[128:131]
    v_lshlrev_b32_sdwa v202, 1, v202 dst_sel:DWORD dst_unused:UNUSED_PAD src0_sel:DWORD src1_sel:WORD_1
    v_mfma_f32_16x16x32_bf16 v[136:139], v[236:239], v[156:159], v[136:139]
    ds_read_b64_tr_b16 v[236:237], v254 offset:41984
    ds_read_b64_tr_b16 v[238:239], v254 offset:42240
    v_lshlrev_b32_sdwa v203, 1, v203 dst_sel:DWORD dst_unused:UNUSED_PAD src0_sel:DWORD src1_sel:WORD_1
    ds_read_u16_d16 v202, v202
    ds_read_u16_d16_hi v203, v203
    s_waitcnt lgkmcnt(14)
    v_mfma_f32_16x16x32_bf16 v[208:211], v[240:243], v[32:35], v[208:211]
    v_or_b32 v174, v188, v189
    v_mfma_f32_16x16x32_bf16 v[212:215], v[240:243], v[36:39], v[212:215]
    v_lshlrev_b32_sdwa v204, 1, v204 dst_sel:DWORD dst_unused:UNUSED_PAD src0_sel:DWORD src1_sel:WORD_1
    v_mfma_f32_16x16x32_bf16 v[216:219], v[240:243], v[40:43], v[216:219]
    v_lshlrev_b32_sdwa v205, 1, v205 dst_sel:DWORD dst_unused:UNUSED_PAD src0_sel:DWORD src1_sel:WORD_1
    ds_read_u16_d16 v204, v204
    ds_read_u16_d16_hi v205, v205
    v_mfma_f32_16x16x32_bf16 v[220:223], v[240:243], v[44:47], v[220:223]
    ds_read_b64_tr_b16 v[240:241], v255 offset:44040
    ds_read_b64_tr_b16 v[242:243], v255 offset:44808
    v_or_b32 v175, v190, v191
    v_mfma_f32_16x16x32_bf16 v[116:119], v[224:227], v[144:147], v[116:119]
    v_lshlrev_b32_sdwa v206, 1, v206 dst_sel:DWORD dst_unused:UNUSED_PAD src0_sel:DWORD src1_sel:WORD_1
    v_mfma_f32_16x16x32_bf16 v[124:127], v[224:227], v[148:151], v[124:127]
    v_lshlrev_b32_sdwa v207, 1, v207 dst_sel:DWORD dst_unused:UNUSED_PAD src0_sel:DWORD src1_sel:WORD_1
    ds_read_u16_d16 v206, v206
    ds_read_u16_d16_hi v207, v207
    v_mfma_f32_16x16x32_bf16 v[132:135], v[224:227], v[152:155], v[132:135]
    v_mfma_f32_16x16x32_bf16 v[140:143], v[224:227], v[156:159], v[140:143]
    ds_read_b64_tr_b16 v[224:225], v254 offset:43008
    ds_read_b64_tr_b16 v[226:227], v254 offset:43264
    s_waitcnt lgkmcnt(14)
    v_mfma_f32_16x16x32_bf16 v[176:179], v[228:231], v[0:3], 0
    v_or_b32 v144, v192, v193
    v_lshlrev_b32_sdwa v208, 1, v208 dst_sel:DWORD dst_unused:UNUSED_PAD src0_sel:DWORD src1_sel:WORD_1
    v_mfma_f32_16x16x32_bf16 v[180:183], v[228:231], v[4:7], 0
    v_lshlrev_b32_sdwa v209, 1, v209 dst_sel:DWORD dst_unused:UNUSED_PAD src0_sel:DWORD src1_sel:WORD_1
    ds_read_u16_d16 v208, v208
    ds_read_u16_d16_hi v209, v209
    v_mfma_f32_16x16x32_bf16 v[184:187], v[228:231], v[8:11], 0
    v_or_b32 v145, v194, v195
    v_mfma_f32_16x16x32_bf16 v[188:191], v[228:231], v[12:15], 0
    ds_read_b64_tr_b16 v[228:229], v255 offset:44096
    ds_read_b64_tr_b16 v[230:231], v255 offset:44864
    v_lshlrev_b32_sdwa v210, 1, v210 dst_sel:DWORD dst_unused:UNUSED_PAD src0_sel:DWORD src1_sel:WORD_1
    v_mfma_f32_16x16x32_bf16 v[48:51], v[232:235], v[160:163], v[48:51]
    v_lshlrev_b32_sdwa v211, 1, v211 dst_sel:DWORD dst_unused:UNUSED_PAD src0_sel:DWORD src1_sel:WORD_1
    ds_read_u16_d16 v210, v210
    ds_read_u16_d16_hi v211, v211
    v_mfma_f32_16x16x32_bf16 v[56:59], v[232:235], v[164:167], v[56:59]
    v_or_b32 v148, v196, v197
    v_mfma_f32_16x16x32_bf16 v[64:67], v[232:235], v[168:171], v[64:67]
    v_lshlrev_b32_sdwa v212, 1, v212 dst_sel:DWORD dst_unused:UNUSED_PAD src0_sel:DWORD src1_sel:WORD_1
    v_mfma_f32_16x16x32_bf16 v[72:75], v[232:235], v[172:175], v[72:75]
    ds_read_b64_tr_b16 v[232:233], v254 offset:40968
    ds_read_b64_tr_b16 v[234:235], v254 offset:41224
    v_lshlrev_b32_sdwa v213, 1, v213 dst_sel:DWORD dst_unused:UNUSED_PAD src0_sel:DWORD src1_sel:WORD_1
    ds_read_u16_d16 v212, v212
    ds_read_u16_d16_hi v213, v213
    s_waitcnt lgkmcnt(14)
    v_mfma_f32_16x16x32_bf16 v[176:179], v[236:239], v[16:19], v[176:179]
    v_or_b32 v149, v198, v199
    v_mfma_f32_16x16x32_bf16 v[180:183], v[236:239], v[20:23], v[180:183]
    v_lshlrev_b32_sdwa v214, 1, v214 dst_sel:DWORD dst_unused:UNUSED_PAD src0_sel:DWORD src1_sel:WORD_1
    v_mfma_f32_16x16x32_bf16 v[184:187], v[236:239], v[24:27], v[184:187]
    v_lshlrev_b32_sdwa v215, 1, v215 dst_sel:DWORD dst_unused:UNUSED_PAD src0_sel:DWORD src1_sel:WORD_1
    ds_read_u16_d16 v214, v214
    ds_read_u16_d16_hi v215, v215
    v_mfma_f32_16x16x32_bf16 v[188:191], v[236:239], v[28:31], v[188:191]
    ds_read_b64_tr_b16 v[236:237], v255 offset:44104
    ds_read_b64_tr_b16 v[238:239], v255 offset:44872
    v_or_b32 v152, v200, v201
    v_lshlrev_b32_sdwa v216, 1, v216 dst_sel:DWORD dst_unused:UNUSED_PAD src0_sel:DWORD src1_sel:WORD_1
    v_mfma_f32_16x16x32_bf16 v[52:55], v[240:243], v[160:163], v[52:55]
    v_lshlrev_b32_sdwa v217, 1, v217 dst_sel:DWORD dst_unused:UNUSED_PAD src0_sel:DWORD src1_sel:WORD_1
    ds_read_u16_d16 v216, v216
    ds_read_u16_d16_hi v217, v217
    v_mfma_f32_16x16x32_bf16 v[60:63], v[240:243], v[164:167], v[60:63]
    v_or_b32 v153, v202, v203
    v_mfma_f32_16x16x32_bf16 v[68:71], v[240:243], v[168:171], v[68:71]
    v_lshlrev_b32_sdwa v218, 1, v218 dst_sel:DWORD dst_unused:UNUSED_PAD src0_sel:DWORD src1_sel:WORD_1
    v_mfma_f32_16x16x32_bf16 v[76:79], v[240:243], v[172:175], v[76:79]
    ds_read_b64_tr_b16 v[240:241], v254 offset:41992
    ds_read_b64_tr_b16 v[242:243], v254 offset:42248
    v_lshlrev_b32_sdwa v219, 1, v219 dst_sel:DWORD dst_unused:UNUSED_PAD src0_sel:DWORD src1_sel:WORD_1
    ds_read_u16_d16 v218, v218
    ds_read_u16_d16_hi v219, v219
    s_waitcnt lgkmcnt(14)
    v_mfma_f32_16x16x32_bf16 v[176:179], v[224:227], v[32:35], v[176:179]
    v_or_b32 v156, v204, v205
    v_mfma_f32_16x16x32_bf16 v[180:183], v[224:227], v[36:39], v[180:183]
    v_lshlrev_b32_sdwa v220, 1, v220 dst_sel:DWORD dst_unused:UNUSED_PAD src0_sel:DWORD src1_sel:WORD_1
    v_mfma_f32_16x16x32_bf16 v[184:187], v[224:227], v[40:43], v[184:187]
    v_lshlrev_b32_sdwa v221, 1, v221 dst_sel:DWORD dst_unused:UNUSED_PAD src0_sel:DWORD src1_sel:WORD_1
    ds_read_u16_d16 v220, v220
    ds_read_u16_d16_hi v221, v221
    v_mfma_f32_16x16x32_bf16 v[188:191], v[224:227], v[44:47], v[188:191]
    ds_read_b64_tr_b16 v[224:225], v255 offset:44160
    ds_read_b64_tr_b16 v[226:227], v255 offset:44928
    v_or_b32 v157, v206, v207
    v_mfma_f32_16x16x32_bf16 v[80:83], v[228:231], v[160:163], v[80:83]
    v_lshlrev_b32_sdwa v222, 1, v222 dst_sel:DWORD dst_unused:UNUSED_PAD src0_sel:DWORD src1_sel:WORD_1
    v_mfma_f32_16x16x32_bf16 v[88:91], v[228:231], v[164:167], v[88:91]
    v_lshlrev_b32_sdwa v223, 1, v223 dst_sel:DWORD dst_unused:UNUSED_PAD src0_sel:DWORD src1_sel:WORD_1
    ds_read_u16_d16 v222, v222
    ds_read_u16_d16_hi v223, v223
    v_mfma_f32_16x16x32_bf16 v[96:99], v[228:231], v[168:171], v[96:99]
    v_mfma_f32_16x16x32_bf16 v[104:107], v[228:231], v[172:175], v[104:107]
    ds_read_b64_tr_b16 v[228:229], v254 offset:43016
    ds_read_b64_tr_b16 v[230:231], v254 offset:43272
    s_waitcnt lgkmcnt(14)
    v_mfma_f32_16x16x32_bf16 v[192:195], v[232:235], v[0:3], 0
    v_or_b32 v146, v208, v209
    v_lshlrev_b32_sdwa v176, 1, v176 dst_sel:DWORD dst_unused:UNUSED_PAD src0_sel:DWORD src1_sel:WORD_1
    v_mfma_f32_16x16x32_bf16 v[196:199], v[232:235], v[4:7], 0
    v_lshlrev_b32_sdwa v177, 1, v177 dst_sel:DWORD dst_unused:UNUSED_PAD src0_sel:DWORD src1_sel:WORD_1
    ds_read_u16_d16 v176, v176
    ds_read_u16_d16_hi v177, v177
    v_mfma_f32_16x16x32_bf16 v[200:203], v[232:235], v[8:11], 0
    v_or_b32 v147, v210, v211
    v_mfma_f32_16x16x32_bf16 v[204:207], v[232:235], v[12:15], 0
    ds_read_b64_tr_b16 v[232:233], v255 offset:44168
    ds_read_b64_tr_b16 v[234:235], v255 offset:44936
    v_lshlrev_b32_sdwa v178, 1, v178 dst_sel:DWORD dst_unused:UNUSED_PAD src0_sel:DWORD src1_sel:WORD_1
    v_mfma_f32_16x16x32_bf16 v[84:87], v[236:239], v[160:163], v[84:87]
    v_lshlrev_b32_sdwa v179, 1, v179 dst_sel:DWORD dst_unused:UNUSED_PAD src0_sel:DWORD src1_sel:WORD_1
    ds_read_u16_d16 v178, v178
    ds_read_u16_d16_hi v179, v179
    v_mfma_f32_16x16x32_bf16 v[92:95], v[236:239], v[164:167], v[92:95]
    v_or_b32 v150, v212, v213
    v_mfma_f32_16x16x32_bf16 v[100:103], v[236:239], v[168:171], v[100:103]
    v_lshlrev_b32_sdwa v180, 1, v180 dst_sel:DWORD dst_unused:UNUSED_PAD src0_sel:DWORD src1_sel:WORD_1
    v_mfma_f32_16x16x32_bf16 v[108:111], v[236:239], v[172:175], v[108:111]

    s_cmp_ge_u32 s19, 19
    s_cbranch_scc1 L_rd19_go
    v_mov_b32 v236, 161976

    s_mov_b32 s29, 200000
L_rd19:
    ds_read_b32 v237, v236
    s_waitcnt lgkmcnt(0)
    v_cmp_le_u32 vcc, 19, v237
    s_cmp_eq_u64 vcc, exec
    s_cbranch_scc1 L_rd19_ok
    s_sleep 2
    s_sub_u32 s29, s29, 1
    s_cmp_lg_u32 s29, 0
    s_cbranch_scc1 L_rd19
L_rd19_ok:

    v_readfirstlane_b32 s19, v237
L_rd19_go:

    ds_read_b64_tr_b16 v[236:237], v254 offset:47104
    ds_read_b64_tr_b16 v[238:239], v254 offset:47360
    v_lshlrev_b32_sdwa v181, 1, v181 dst_sel:DWORD dst_unused:UNUSED_PAD src0_sel:DWORD src1_sel:WORD_1
    ds_read_u16_d16 v180, v180
    ds_read_u16_d16_hi v181, v181
    s_waitcnt lgkmcnt(14)
    v_mfma_f32_16x16x32_bf16 v[192:195], v[240:243], v[16:19], v[192:195]
    v_or_b32 v151, v214, v215
    v_mfma_f32_16x16x32_bf16 v[196:199], v[240:243], v[20:23], v[196:199]
    v_lshlrev_b32_sdwa v182, 1, v182 dst_sel:DWORD dst_unused:UNUSED_PAD src0_sel:DWORD src1_sel:WORD_1
    v_mfma_f32_16x16x32_bf16 v[200:203], v[240:243], v[24:27], v[200:203]
    v_lshlrev_b32_sdwa v183, 1, v183 dst_sel:DWORD dst_unused:UNUSED_PAD src0_sel:DWORD src1_sel:WORD_1
    ds_read_u16_d16 v182, v182
    ds_read_u16_d16_hi v183, v183
    v_mfma_f32_16x16x32_bf16 v[204:207], v[240:243], v[28:31], v[204:207]

    s_cmp_ge_u32 s19, 20
    s_cbranch_scc1 L_rd20_go
    v_mov_b32 v240, 161976

    s_mov_b32 s29, 200000
L_rd20:
    ds_read_b32 v241, v240
    s_waitcnt lgkmcnt(0)
    v_cmp_le_u32 vcc, 20, v241
    s_cmp_eq_u64 vcc, exec
    s_cbranch_scc1 L_rd20_ok
    s_sleep 2
    s_sub_u32 s29, s29, 1
    s_cmp_lg_u32 s29, 0
    s_cbranch_scc1 L_rd20
L_rd20_ok:

    v_readfirstlane_b32 s19, v241
L_rd20_go:

    ds_read_b64_tr_b16 v[240:241], v255 offset:50176
    ds_read_b64_tr_b16 v[242:243], v255 offset:50944
    v_or_b32 v154, v216, v217
    v_lshlrev_b32_sdwa v184, 1, v184 dst_sel:DWORD dst_unused:UNUSED_PAD src0_sel:DWORD src1_sel:WORD_1
    v_mfma_f32_16x16x32_bf16 v[112:115], v[224:227], v[160:163], v[112:115]
    v_lshlrev_b32_sdwa v185, 1, v185 dst_sel:DWORD dst_unused:UNUSED_PAD src0_sel:DWORD src1_sel:WORD_1
    ds_read_u16_d16 v184, v184
    ds_read_u16_d16_hi v185, v185
    v_mfma_f32_16x16x32_bf16 v[120:123], v[224:227], v[164:167], v[120:123]
    v_or_b32 v155, v218, v219
    v_mfma_f32_16x16x32_bf16 v[128:131], v[224:227], v[168:171], v[128:131]
    v_lshlrev_b32_sdwa v186, 1, v186 dst_sel:DWORD dst_unused:UNUSED_PAD src0_sel:DWORD src1_sel:WORD_1
    v_mfma_f32_16x16x32_bf16 v[136:139], v[224:227], v[172:175], v[136:139]
    ds_read_b64_tr_b16 v[224:225], v254 offset:48128
    ds_read_b64_tr_b16 v[226:227], v254 offset:48384
    v_lshlrev_b32_sdwa v187, 1, v187 dst_sel:DWORD dst_unused:UNUSED_PAD src0_sel:DWORD src1_sel:WORD_1
    ds_read_u16_d16 v186, v186
    ds_read_u16_d16_hi v187, v187
    s_waitcnt lgkmcnt(14)
    v_mfma_f32_16x16x32_bf16 v[192:195], v[228:231], v[32:35], v[192:195]
    v_or_b32 v158, v220, v221
    v_mfma_f32_16x16x32_bf16 v[196:199], v[228:231], v[36:39], v[196:199]
    v_lshlrev_b32_sdwa v188, 1, v188 dst_sel:DWORD dst_unused:UNUSED_PAD src0_sel:DWORD src1_sel:WORD_1
    v_mfma_f32_16x16x32_bf16 v[200:203], v[228:231], v[40:43], v[200:203]
    v_lshlrev_b32_sdwa v189, 1, v189 dst_sel:DWORD dst_unused:UNUSED_PAD src0_sel:DWORD src1_sel:WORD_1
    ds_read_u16_d16 v188, v188
    ds_read_u16_d16_hi v189, v189
    v_mfma_f32_16x16x32_bf16 v[204:207], v[228:231], v[44:47], v[204:207]
    ds_read_b64_tr_b16 v[228:229], v255 offset:50184
    ds_read_b64_tr_b16 v[230:231], v255 offset:50952
    v_or_b32 v159, v222, v223
    v_mfma_f32_16x16x32_bf16 v[116:119], v[232:235], v[160:163], v[116:119]
    v_lshlrev_b32_sdwa v190, 1, v190 dst_sel:DWORD dst_unused:UNUSED_PAD src0_sel:DWORD src1_sel:WORD_1
    v_mfma_f32_16x16x32_bf16 v[124:127], v[232:235], v[164:167], v[124:127]
    v_lshlrev_b32_sdwa v191, 1, v191 dst_sel:DWORD dst_unused:UNUSED_PAD src0_sel:DWORD src1_sel:WORD_1
    ds_read_u16_d16 v190, v190
    ds_read_u16_d16_hi v191, v191
    v_mfma_f32_16x16x32_bf16 v[132:135], v[232:235], v[168:171], v[132:135]
    v_mfma_f32_16x16x32_bf16 v[140:143], v[232:235], v[172:175], v[140:143]
    ds_read_b64_tr_b16 v[232:233], v254 offset:49152
    ds_read_b64_tr_b16 v[234:235], v254 offset:49408
    s_waitcnt lgkmcnt(14)
    v_mfma_f32_16x16x32_bf16 v[208:211], v[236:239], v[0:3], 0
    v_or_b32 v160, v176, v177
    v_lshlrev_b32_sdwa v192, 1, v192 dst_sel:DWORD dst_unused:UNUSED_PAD src0_sel:DWORD src1_sel:WORD_1
    v_mfma_f32_16x16x32_bf16 v[212:215], v[236:239], v[4:7], 0
    v_lshlrev_b32_sdwa v193, 1, v193 dst_sel:DWORD dst_unused:UNUSED_PAD src0_sel:DWORD src1_sel:WORD_1
    ds_read_u16_d16 v192, v192
    ds_read_u16_d16_hi v193, v193
    v_mfma_f32_16x16x32_bf16 v[216:219], v[236:239], v[8:11], 0
    v_or_b32 v161, v178, v179
    v_mfma_f32_16x16x32_bf16 v[220:223], v[236:239], v[12:15], 0
    ds_read_b64_tr_b16 v[236:237], v255 offset:50240
    ds_read_b64_tr_b16 v[238:239], v255 offset:51008
    v_lshlrev_b32_sdwa v194, 1, v194 dst_sel:DWORD dst_unused:UNUSED_PAD src0_sel:DWORD src1_sel:WORD_1
    v_mfma_f32_16x16x32_bf16 v[48:51], v[240:243], v[144:147], v[48:51]
    v_lshlrev_b32_sdwa v195, 1, v195 dst_sel:DWORD dst_unused:UNUSED_PAD src0_sel:DWORD src1_sel:WORD_1
    ds_read_u16_d16 v194, v194
    ds_read_u16_d16_hi v195, v195
    v_mfma_f32_16x16x32_bf16 v[56:59], v[240:243], v[148:151], v[56:59]
    v_or_b32 v164, v180, v181
    s_waitcnt vmcnt(0)
    v_dot2_f32_bf16 v128, v244, s86, v128
    v_dot2_f32_bf16 v129, v244, s87, v129
    v_mfma_f32_16x16x32_bf16 v[64:67], v[240:243], v[152:155], v[64:67]
    v_lshlrev_b32_sdwa v196, 1, v196 dst_sel:DWORD dst_unused:UNUSED_PAD src0_sel:DWORD src1_sel:WORD_1
    v_dot2_f32_bf16 v130, v245, s86, v130
    v_dot2_f32_bf16 v131, v245, s87, v131
    v_mfma_f32_16x16x32_bf16 v[72:75], v[240:243], v[156:159], v[72:75]
    ds_read_b64_tr_b16 v[240:241], v254 offset:47112
    ds_read_b64_tr_b16 v[242:243], v254 offset:47368
    v_lshlrev_b32_sdwa v197, 1, v197 dst_sel:DWORD dst_unused:UNUSED_PAD src0_sel:DWORD src1_sel:WORD_1
    ds_read_u16_d16 v196, v196
    ds_read_u16_d16_hi v197, v197
    v_dot2_f32_bf16 v132, v246, s86, v132
    v_dot2_f32_bf16 v133, v246, s87, v133
    s_waitcnt lgkmcnt(14)
    v_mfma_f32_16x16x32_bf16 v[208:211], v[224:227], v[16:19], v[208:211]
    v_or_b32 v165, v182, v183
    v_dot2_f32_bf16 v134, v247, s86, v134
    v_dot2_f32_bf16 v135, v247, s87, v135
    v_mfma_f32_16x16x32_bf16 v[212:215], v[224:227], v[20:23], v[212:215]
    v_lshlrev_b32_sdwa v198, 1, v198 dst_sel:DWORD dst_unused:UNUSED_PAD src0_sel:DWORD src1_sel:WORD_1
    v_dot2_f32_bf16 v76, v250, s86, v76
    v_dot2_f32_bf16 v77, v250, s87, v77
    v_mfma_f32_16x16x32_bf16 v[216:219], v[224:227], v[24:27], v[216:219]
    v_lshlrev_b32_sdwa v199, 1, v199 dst_sel:DWORD dst_unused:UNUSED_PAD src0_sel:DWORD src1_sel:WORD_1
    ds_read_u16_d16 v198, v198
    ds_read_u16_d16_hi v199, v199
    v_dot2_f32_bf16 v78, v251, s86, v78
    v_dot2_f32_bf16 v79, v251, s87, v79
    v_mfma_f32_16x16x32_bf16 v[220:223], v[224:227], v[28:31], v[220:223]
    ds_read_b64_tr_b16 v[224:225], v255 offset:50248
    ds_read_b64_tr_b16 v[226:227], v255 offset:51016
    v_or_b32 v168, v184, v185
    v_lshlrev_b32_sdwa v200, 1, v200 dst_sel:DWORD dst_unused:UNUSED_PAD src0_sel:DWORD src1_sel:WORD_1
    v_mfma_f32_16x16x32_bf16 v[52:55], v[228:231], v[144:147], v[52:55]
    v_lshlrev_b32_sdwa v201, 1, v201 dst_sel:DWORD dst_unused:UNUSED_PAD src0_sel:DWORD src1_sel:WORD_1
    ds_read_u16_d16 v200, v200
    ds_read_u16_d16_hi v201, v201
    v_dot2_f32_bf16 v72, v248, s86, v72
    v_dot2_f32_bf16 v73, v248, s87, v73
    v_mfma_f32_16x16x32_bf16 v[60:63], v[228:231], v[148:151], v[60:63]
    v_or_b32 v169, v186, v187
    v_dot2_f32_bf16 v74, v249, s86, v74
    v_dot2_f32_bf16 v75, v249, s87, v75
    buffer_load_dwordx4 v[244:247], v252, s[4:7], s25 offen offset:256 sc1
    buffer_load_dwordx4 v[248:251], v252, s[4:7], s25 offen offset:320 sc1
    v_mfma_f32_16x16x32_bf16 v[68:71], v[228:231], v[152:155], v[68:71]
    v_lshlrev_b32_sdwa v202, 1, v202 dst_sel:DWORD dst_unused:UNUSED_PAD src0_sel:DWORD src1_sel:WORD_1
    v_mfma_f32_16x16x32_bf16 v[76:79], v[228:231], v[156:159], v[76:79]
    ds_read_b64_tr_b16 v[228:229], v254 offset:48136
    ds_read_b64_tr_b16 v[230:231], v254 offset:48392
    v_lshlrev_b32_sdwa v203, 1, v203 dst_sel:DWORD dst_unused:UNUSED_PAD src0_sel:DWORD src1_sel:WORD_1
    ds_read_u16_d16 v202, v202
    ds_read_u16_d16_hi v203, v203
    s_waitcnt lgkmcnt(14)
    v_mfma_f32_16x16x32_bf16 v[208:211], v[232:235], v[32:35], v[208:211]
    v_or_b32 v172, v188, v189
    v_mfma_f32_16x16x32_bf16 v[212:215], v[232:235], v[36:39], v[212:215]
    v_lshlrev_b32_sdwa v204, 1, v204 dst_sel:DWORD dst_unused:UNUSED_PAD src0_sel:DWORD src1_sel:WORD_1
    v_mfma_f32_16x16x32_bf16 v[216:219], v[232:235], v[40:43], v[216:219]
    v_lshlrev_b32_sdwa v205, 1, v205 dst_sel:DWORD dst_unused:UNUSED_PAD src0_sel:DWORD src1_sel:WORD_1
    ds_read_u16_d16 v204, v204
    ds_read_u16_d16_hi v205, v205
    v_mfma_f32_16x16x32_bf16 v[220:223], v[232:235], v[44:47], v[220:223]
    ds_read_b64_tr_b16 v[232:233], v255 offset:50304
    ds_read_b64_tr_b16 v[234:235], v255 offset:51072
    v_or_b32 v173, v190, v191
    v_mfma_f32_16x16x32_bf16 v[80:83], v[236:239], v[144:147], v[80:83]
    v_lshlrev_b32_sdwa v206, 1, v206 dst_sel:DWORD dst_unused:UNUSED_PAD src0_sel:DWORD src1_sel:WORD_1
    v_mfma_f32_16x16x32_bf16 v[88:91], v[236:239], v[148:151], v[88:91]
    v_lshlrev_b32_sdwa v207, 1, v207 dst_sel:DWORD dst_unused:UNUSED_PAD src0_sel:DWORD src1_sel:WORD_1
    ds_read_u16_d16 v206, v206
    ds_read_u16_d16_hi v207, v207
    v_mfma_f32_16x16x32_bf16 v[96:99], v[236:239], v[152:155], v[96:99]
    v_mfma_f32_16x16x32_bf16 v[104:107], v[236:239], v[156:159], v[104:107]
    ds_read_b64_tr_b16 v[236:237], v254 offset:49160
    ds_read_b64_tr_b16 v[238:239], v254 offset:49416
    s_waitcnt lgkmcnt(14)
    v_mfma_f32_16x16x32_bf16 v[176:179], v[240:243], v[0:3], 0
    v_or_b32 v162, v192, v193
    v_lshlrev_b32_sdwa v208, 1, v208 dst_sel:DWORD dst_unused:UNUSED_PAD src0_sel:DWORD src1_sel:WORD_1
    v_mfma_f32_16x16x32_bf16 v[180:183], v[240:243], v[4:7], 0
    v_lshlrev_b32_sdwa v209, 1, v209 dst_sel:DWORD dst_unused:UNUSED_PAD src0_sel:DWORD src1_sel:WORD_1
    ds_read_u16_d16 v208, v208
    ds_read_u16_d16_hi v209, v209
    v_mfma_f32_16x16x32_bf16 v[184:187], v[240:243], v[8:11], 0
    v_or_b32 v163, v194, v195
    v_mfma_f32_16x16x32_bf16 v[188:191], v[240:243], v[12:15], 0
    ds_read_b64_tr_b16 v[240:241], v255 offset:50312
    ds_read_b64_tr_b16 v[242:243], v255 offset:51080
    v_lshlrev_b32_sdwa v210, 1, v210 dst_sel:DWORD dst_unused:UNUSED_PAD src0_sel:DWORD src1_sel:WORD_1
    v_mfma_f32_16x16x32_bf16 v[84:87], v[224:227], v[144:147], v[84:87]
    v_lshlrev_b32_sdwa v211, 1, v211 dst_sel:DWORD dst_unused:UNUSED_PAD src0_sel:DWORD src1_sel:WORD_1
    ds_read_u16_d16 v210, v210
    ds_read_u16_d16_hi v211, v211
    v_mfma_f32_16x16x32_bf16 v[92:95], v[224:227], v[148:151], v[92:95]
    v_or_b32 v166, v196, v197
    v_mfma_f32_16x16x32_bf16 v[100:103], v[224:227], v[152:155], v[100:103]
    v_lshlrev_b32_sdwa v212, 1, v212 dst_sel:DWORD dst_unused:UNUSED_PAD src0_sel:DWORD src1_sel:WORD_1
    v_mfma_f32_16x16x32_bf16 v[108:111], v[224:227], v[156:159], v[108:111]

    s_cmp_ge_u32 s19, 21
    s_cbranch_scc1 L_rd21_go
    v_mov_b32 v224, 161976

    s_mov_b32 s29, 200000
L_rd21:
    ds_read_b32 v225, v224
    s_waitcnt lgkmcnt(0)
    v_cmp_le_u32 vcc, 21, v225
    s_cmp_eq_u64 vcc, exec
    s_cbranch_scc1 L_rd21_ok
    s_sleep 2
    s_sub_u32 s29, s29, 1
    s_cmp_lg_u32 s29, 0
    s_cbranch_scc1 L_rd21
L_rd21_ok:

    v_readfirstlane_b32 s19, v225
L_rd21_go:

    ds_read_b64_tr_b16 v[224:225], v254 offset:53248
    ds_read_b64_tr_b16 v[226:227], v254 offset:53504
    v_lshlrev_b32_sdwa v213, 1, v213 dst_sel:DWORD dst_unused:UNUSED_PAD src0_sel:DWORD src1_sel:WORD_1
    ds_read_u16_d16 v212, v212
    ds_read_u16_d16_hi v213, v213
    s_waitcnt lgkmcnt(14)
    v_mfma_f32_16x16x32_bf16 v[176:179], v[228:231], v[16:19], v[176:179]
    v_or_b32 v167, v198, v199
    v_mfma_f32_16x16x32_bf16 v[180:183], v[228:231], v[20:23], v[180:183]
    v_lshlrev_b32_sdwa v214, 1, v214 dst_sel:DWORD dst_unused:UNUSED_PAD src0_sel:DWORD src1_sel:WORD_1
    v_mfma_f32_16x16x32_bf16 v[184:187], v[228:231], v[24:27], v[184:187]
    v_lshlrev_b32_sdwa v215, 1, v215 dst_sel:DWORD dst_unused:UNUSED_PAD src0_sel:DWORD src1_sel:WORD_1
    ds_read_u16_d16 v214, v214
    ds_read_u16_d16_hi v215, v215
    v_mfma_f32_16x16x32_bf16 v[188:191], v[228:231], v[28:31], v[188:191]

    s_cmp_ge_u32 s19, 22
    s_cbranch_scc1 L_rd22_go
    v_mov_b32 v228, 161976

    s_mov_b32 s29, 200000
L_rd22:
    ds_read_b32 v229, v228
    s_waitcnt lgkmcnt(0)
    v_cmp_le_u32 vcc, 22, v229
    s_cmp_eq_u64 vcc, exec
    s_cbranch_scc1 L_rd22_ok
    s_sleep 2
    s_sub_u32 s29, s29, 1
    s_cmp_lg_u32 s29, 0
    s_cbranch_scc1 L_rd22
L_rd22_ok:

    v_readfirstlane_b32 s19, v229
L_rd22_go:

    ds_read_b64_tr_b16 v[228:229], v255 offset:56320
    ds_read_b64_tr_b16 v[230:231], v255 offset:57088
    v_or_b32 v170, v200, v201
    v_lshlrev_b32_sdwa v216, 1, v216 dst_sel:DWORD dst_unused:UNUSED_PAD src0_sel:DWORD src1_sel:WORD_1
    v_mfma_f32_16x16x32_bf16 v[112:115], v[232:235], v[144:147], v[112:115]
    v_lshlrev_b32_sdwa v217, 1, v217 dst_sel:DWORD dst_unused:UNUSED_PAD src0_sel:DWORD src1_sel:WORD_1
    ds_read_u16_d16 v216, v216
    ds_read_u16_d16_hi v217, v217
    v_mfma_f32_16x16x32_bf16 v[120:123], v[232:235], v[148:151], v[120:123]
    v_or_b32 v171, v202, v203
    v_mfma_f32_16x16x32_bf16 v[128:131], v[232:235], v[152:155], v[128:131]
    v_lshlrev_b32_sdwa v218, 1, v218 dst_sel:DWORD dst_unused:UNUSED_PAD src0_sel:DWORD src1_sel:WORD_1
    v_mfma_f32_16x16x32_bf16 v[136:139], v[232:235], v[156:159], v[136:139]
    ds_read_b64_tr_b16 v[232:233], v254 offset:54272
    ds_read_b64_tr_b16 v[234:235], v254 offset:54528
    v_lshlrev_b32_sdwa v219, 1, v219 dst_sel:DWORD dst_unused:UNUSED_PAD src0_sel:DWORD src1_sel:WORD_1
    ds_read_u16_d16 v218, v218
    ds_read_u16_d16_hi v219, v219
    s_waitcnt lgkmcnt(14)
    v_mfma_f32_16x16x32_bf16 v[176:179], v[236:239], v[32:35], v[176:179]
    v_or_b32 v174, v204, v205
    v_mfma_f32_16x16x32_bf16 v[180:183], v[236:239], v[36:39], v[180:183]
    v_lshlrev_b32_sdwa v220, 1, v220 dst_sel:DWORD dst_unused:UNUSED_PAD src0_sel:DWORD src1_sel:WORD_1
    v_mfma_f32_16x16x32_bf16 v[184:187], v[236:239], v[40:43], v[184:187]
    v_lshlrev_b32_sdwa v221, 1, v221 dst_sel:DWORD dst_unused:UNUSED_PAD src0_sel:DWORD src1_sel:WORD_1
    ds_read_u16_d16 v220, v220
    ds_read_u16_d16_hi v221, v221
    v_mfma_f32_16x16x32_bf16 v[188:191], v[236:239], v[44:47], v[188:191]
    ds_read_b64_tr_b16 v[236:237], v255 offset:56328
    ds_read_b64_tr_b16 v[238:239], v255 offset:57096
    v_or_b32 v175, v206, v207
    v_mfma_f32_16x16x32_bf16 v[116:119], v[240:243], v[144:147], v[116:119]
    v_lshlrev_b32_sdwa v222, 1, v222 dst_sel:DWORD dst_unused:UNUSED_PAD src0_sel:DWORD src1_sel:WORD_1
    v_mfma_f32_16x16x32_bf16 v[124:127], v[240:243], v[148:151], v[124:127]
    v_lshlrev_b32_sdwa v223, 1, v223 dst_sel:DWORD dst_unused:UNUSED_PAD src0_sel:DWORD src1_sel:WORD_1
    ds_read_u16_d16 v222, v222
    ds_read_u16_d16_hi v223, v223
    v_mfma_f32_16x16x32_bf16 v[132:135], v[240:243], v[152:155], v[132:135]
    v_mfma_f32_16x16x32_bf16 v[140:143], v[240:243], v[156:159], v[140:143]
    ds_read_b64_tr_b16 v[240:241], v254 offset:55296
    ds_read_b64_tr_b16 v[242:243], v254 offset:55552
    s_waitcnt lgkmcnt(14)
    v_mfma_f32_16x16x32_bf16 v[192:195], v[224:227], v[0:3], 0
    v_or_b32 v144, v208, v209
    v_lshlrev_b32_sdwa v176, 1, v176 dst_sel:DWORD dst_unused:UNUSED_PAD src0_sel:DWORD src1_sel:WORD_1
    v_mfma_f32_16x16x32_bf16 v[196:199], v[224:227], v[4:7], 0
    v_lshlrev_b32_sdwa v177, 1, v177 dst_sel:DWORD dst_unused:UNUSED_PAD src0_sel:DWORD src1_sel:WORD_1
    ds_read_u16_d16 v176, v176
    ds_read_u16_d16_hi v177, v177
    v_mfma_f32_16x16x32_bf16 v[200:203], v[224:227], v[8:11], 0
    v_or_b32 v145, v210, v211
    v_mfma_f32_16x16x32_bf16 v[204:207], v[224:227], v[12:15], 0
    ds_read_b64_tr_b16 v[224:225], v255 offset:56384
    ds_read_b64_tr_b16 v[226:227], v255 offset:57152
    v_lshlrev_b32_sdwa v178, 1, v178 dst_sel:DWORD dst_unused:UNUSED_PAD src0_sel:DWORD src1_sel:WORD_1
    v_mfma_f32_16x16x32_bf16 v[48:51], v[228:231], v[160:163], v[48:51]
    v_lshlrev_b32_sdwa v179, 1, v179 dst_sel:DWORD dst_unused:UNUSED_PAD src0_sel:DWORD src1_sel:WORD_1
    ds_read_u16_d16 v178, v178
    ds_read_u16_d16_hi v179, v179
    v_mfma_f32_16x16x32_bf16 v[56:59], v[228:231], v[164:167], v[56:59]
    v_or_b32 v148, v212, v213
    v_mfma_f32_16x16x32_bf16 v[64:67], v[228:231], v[168:171], v[64:67]
    v_lshlrev_b32_sdwa v180, 1, v180 dst_sel:DWORD dst_unused:UNUSED_PAD src0_sel:DWORD src1_sel:WORD_1
    v_mfma_f32_16x16x32_bf16 v[72:75], v[228:231], v[172:175], v[72:75]
    ds_read_b64_tr_b16 v[228:229], v254 offset:53256
    ds_read_b64_tr_b16 v[230:231], v254 offset:53512
    v_lshlrev_b32_sdwa v181, 1, v181 dst_sel:DWORD dst_unused:UNUSED_PAD src0_sel:DWORD src1_sel:WORD_1
    ds_read_u16_d16 v180, v180
    ds_read_u16_d16_hi v181, v181
    s_waitcnt lgkmcnt(14)
    v_mfma_f32_16x16x32_bf16 v[192:195], v[232:235], v[16:19], v[192:195]
    v_or_b32 v149, v214, v215
    v_mfma_f32_16x16x32_bf16 v[196:199], v[232:235], v[20:23], v[196:199]
    v_lshlrev_b32_sdwa v182, 1, v182 dst_sel:DWORD dst_unused:UNUSED_PAD src0_sel:DWORD src1_sel:WORD_1
    v_mfma_f32_16x16x32_bf16 v[200:203], v[232:235], v[24:27], v[200:203]
    v_lshlrev_b32_sdwa v183, 1, v183 dst_sel:DWORD dst_unused:UNUSED_PAD src0_sel:DWORD src1_sel:WORD_1
    ds_read_u16_d16 v182, v182
    ds_read_u16_d16_hi v183, v183
    v_mfma_f32_16x16x32_bf16 v[204:207], v[232:235], v[28:31], v[204:207]
    ds_read_b64_tr_b16 v[232:233], v255 offset:56392
    ds_read_b64_tr_b16 v[234:235], v255 offset:57160
    v_or_b32 v152, v216, v217
    v_lshlrev_b32_sdwa v184, 1, v184 dst_sel:DWORD dst_unused:UNUSED_PAD src0_sel:DWORD src1_sel:WORD_1
    v_mfma_f32_16x16x32_bf16 v[52:55], v[236:239], v[160:163], v[52:55]
    v_lshlrev_b32_sdwa v185, 1, v185 dst_sel:DWORD dst_unused:UNUSED_PAD src0_sel:DWORD src1_sel:WORD_1
    ds_read_u16_d16 v184, v184
    ds_read_u16_d16_hi v185, v185
    v_mfma_f32_16x16x32_bf16 v[60:63], v[236:239], v[164:167], v[60:63]
    v_or_b32 v153, v218, v219
    v_mfma_f32_16x16x32_bf16 v[68:71], v[236:239], v[168:171], v[68:71]
    v_lshlrev_b32_sdwa v186, 1, v186 dst_sel:DWORD dst_unused:UNUSED_PAD src0_sel:DWORD src1_sel:WORD_1
    v_mfma_f32_16x16x32_bf16 v[76:79], v[236:239], v[172:175], v[76:79]
    ds_read_b64_tr_b16 v[236:237], v254 offset:54280
    ds_read_b64_tr_b16 v[238:239], v254 offset:54536
    v_lshlrev_b32_sdwa v187, 1, v187 dst_sel:DWORD dst_unused:UNUSED_PAD src0_sel:DWORD src1_sel:WORD_1
    ds_read_u16_d16 v186, v186
    ds_read_u16_d16_hi v187, v187
    s_waitcnt lgkmcnt(14)
    v_mfma_f32_16x16x32_bf16 v[192:195], v[240:243], v[32:35], v[192:195]
    v_or_b32 v156, v220, v221
    v_mfma_f32_16x16x32_bf16 v[196:199], v[240:243], v[36:39], v[196:199]
    v_lshlrev_b32_sdwa v188, 1, v188 dst_sel:DWORD dst_unused:UNUSED_PAD src0_sel:DWORD src1_sel:WORD_1
    v_mfma_f32_16x16x32_bf16 v[200:203], v[240:243], v[40:43], v[200:203]
    v_lshlrev_b32_sdwa v189, 1, v189 dst_sel:DWORD dst_unused:UNUSED_PAD src0_sel:DWORD src1_sel:WORD_1
    ds_read_u16_d16 v188, v188
    ds_read_u16_d16_hi v189, v189
    v_mfma_f32_16x16x32_bf16 v[204:207], v[240:243], v[44:47], v[204:207]
    ds_read_b64_tr_b16 v[240:241], v255 offset:56448
    ds_read_b64_tr_b16 v[242:243], v255 offset:57216
    v_or_b32 v157, v222, v223
    v_mfma_f32_16x16x32_bf16 v[80:83], v[224:227], v[160:163], v[80:83]
    v_lshlrev_b32_sdwa v190, 1, v190 dst_sel:DWORD dst_unused:UNUSED_PAD src0_sel:DWORD src1_sel:WORD_1
    v_mfma_f32_16x16x32_bf16 v[88:91], v[224:227], v[164:167], v[88:91]
    v_lshlrev_b32_sdwa v191, 1, v191 dst_sel:DWORD dst_unused:UNUSED_PAD src0_sel:DWORD src1_sel:WORD_1
    ds_read_u16_d16 v190, v190
    ds_read_u16_d16_hi v191, v191
    v_mfma_f32_16x16x32_bf16 v[96:99], v[224:227], v[168:171], v[96:99]
    v_mfma_f32_16x16x32_bf16 v[104:107], v[224:227], v[172:175], v[104:107]
    ds_read_b64_tr_b16 v[224:225], v254 offset:55304
    ds_read_b64_tr_b16 v[226:227], v254 offset:55560
    s_waitcnt lgkmcnt(14)
    v_mfma_f32_16x16x32_bf16 v[208:211], v[228:231], v[0:3], 0
    v_or_b32 v146, v176, v177
    v_lshlrev_b32_sdwa v192, 1, v192 dst_sel:DWORD dst_unused:UNUSED_PAD src0_sel:DWORD src1_sel:WORD_1
    v_mfma_f32_16x16x32_bf16 v[212:215], v[228:231], v[4:7], 0
    v_lshlrev_b32_sdwa v193, 1, v193 dst_sel:DWORD dst_unused:UNUSED_PAD src0_sel:DWORD src1_sel:WORD_1
    ds_read_u16_d16 v192, v192
    ds_read_u16_d16_hi v193, v193
    v_mfma_f32_16x16x32_bf16 v[216:219], v[228:231], v[8:11], 0
    v_or_b32 v147, v178, v179
    v_mfma_f32_16x16x32_bf16 v[220:223], v[228:231], v[12:15], 0
    ds_read_b64_tr_b16 v[228:229], v255 offset:56456
    ds_read_b64_tr_b16 v[230:231], v255 offset:57224
    v_lshlrev_b32_sdwa v194, 1, v194 dst_sel:DWORD dst_unused:UNUSED_PAD src0_sel:DWORD src1_sel:WORD_1
    v_mfma_f32_16x16x32_bf16 v[84:87], v[232:235], v[160:163], v[84:87]
    v_lshlrev_b32_sdwa v195, 1, v195 dst_sel:DWORD dst_unused:UNUSED_PAD src0_sel:DWORD src1_sel:WORD_1
    ds_read_u16_d16 v194, v194
    ds_read_u16_d16_hi v195, v195
    v_mfma_f32_16x16x32_bf16 v[92:95], v[232:235], v[164:167], v[92:95]
    v_or_b32 v150, v180, v181
    s_waitcnt vmcnt(0)
    v_dot2_f32_bf16 v104, v244, s86, v104
    v_dot2_f32_bf16 v105, v244, s87, v105
    v_mfma_f32_16x16x32_bf16 v[100:103], v[232:235], v[168:171], v[100:103]
    v_lshlrev_b32_sdwa v196, 1, v196 dst_sel:DWORD dst_unused:UNUSED_PAD src0_sel:DWORD src1_sel:WORD_1
    v_dot2_f32_bf16 v106, v245, s86, v106
    v_dot2_f32_bf16 v107, v245, s87, v107
    v_mfma_f32_16x16x32_bf16 v[108:111], v[232:235], v[172:175], v[108:111]

    s_cmp_ge_u32 s19, 23
    s_cbranch_scc1 L_rd23_go
    v_mov_b32 v232, 161976

    s_mov_b32 s29, 200000
L_rd23:
    ds_read_b32 v233, v232
    s_waitcnt lgkmcnt(0)
    v_cmp_le_u32 vcc, 23, v233
    s_cmp_eq_u64 vcc, exec
    s_cbranch_scc1 L_rd23_ok
    s_sleep 2
    s_sub_u32 s29, s29, 1
    s_cmp_lg_u32 s29, 0
    s_cbranch_scc1 L_rd23
L_rd23_ok:

    v_readfirstlane_b32 s19, v233
L_rd23_go:

    ds_read_b64_tr_b16 v[232:233], v255 offset:59392
    ds_read_b64_tr_b16 v[234:235], v255 offset:60160
    v_lshlrev_b32_sdwa v197, 1, v197 dst_sel:DWORD dst_unused:UNUSED_PAD src0_sel:DWORD src1_sel:WORD_1
    ds_read_u16_d16 v196, v196
    ds_read_u16_d16_hi v197, v197
    v_dot2_f32_bf16 v136, v248, s86, v136
    v_dot2_f32_bf16 v137, v248, s87, v137
    s_waitcnt lgkmcnt(14)
    v_mfma_f32_16x16x32_bf16 v[208:211], v[236:239], v[16:19], v[208:211]
    v_or_b32 v151, v182, v183
    v_dot2_f32_bf16 v138, v249, s86, v138
    v_dot2_f32_bf16 v139, v249, s87, v139
    v_mfma_f32_16x16x32_bf16 v[212:215], v[236:239], v[20:23], v[212:215]
    v_lshlrev_b32_sdwa v198, 1, v198 dst_sel:DWORD dst_unused:UNUSED_PAD src0_sel:DWORD src1_sel:WORD_1
    v_dot2_f32_bf16 v140, v250, s86, v140
    v_dot2_f32_bf16 v141, v250, s87, v141
    v_mfma_f32_16x16x32_bf16 v[216:219], v[236:239], v[24:27], v[216:219]
    v_lshlrev_b32_sdwa v199, 1, v199 dst_sel:DWORD dst_unused:UNUSED_PAD src0_sel:DWORD src1_sel:WORD_1
    ds_read_u16_d16 v198, v198
    ds_read_u16_d16_hi v199, v199
    v_dot2_f32_bf16 v142, v251, s86, v142
    v_dot2_f32_bf16 v143, v251, s87, v143
    v_mfma_f32_16x16x32_bf16 v[220:223], v[236:239], v[28:31], v[220:223]
    ds_read_b64_tr_b16 v[236:237], v255 offset:59400
    ds_read_b64_tr_b16 v[238:239], v255 offset:60168
    v_or_b32 v154, v184, v185
    v_lshlrev_b32_sdwa v200, 1, v200 dst_sel:DWORD dst_unused:UNUSED_PAD src0_sel:DWORD src1_sel:WORD_1
    v_mfma_f32_16x16x32_bf16 v[112:115], v[240:243], v[160:163], v[112:115]
    v_lshlrev_b32_sdwa v201, 1, v201 dst_sel:DWORD dst_unused:UNUSED_PAD src0_sel:DWORD src1_sel:WORD_1
    ds_read_u16_d16 v200, v200
    ds_read_u16_d16_hi v201, v201
    v_dot2_f32_bf16 v108, v246, s86, v108
    v_dot2_f32_bf16 v109, v246, s87, v109
    v_mfma_f32_16x16x32_bf16 v[120:123], v[240:243], v[164:167], v[120:123]
    v_or_b32 v155, v186, v187
    v_dot2_f32_bf16 v110, v247, s86, v110
    v_dot2_f32_bf16 v111, v247, s87, v111
    v_mfma_f32_16x16x32_bf16 v[128:131], v[240:243], v[168:171], v[128:131]
    v_lshlrev_b32_sdwa v202, 1, v202 dst_sel:DWORD dst_unused:UNUSED_PAD src0_sel:DWORD src1_sel:WORD_1
    v_mfma_f32_16x16x32_bf16 v[136:139], v[240:243], v[172:175], v[136:139]
    ds_read_b64_tr_b16 v[240:241], v255 offset:59456
    ds_read_b64_tr_b16 v[242:243], v255 offset:60224
    v_lshlrev_b32_sdwa v203, 1, v203 dst_sel:DWORD dst_unused:UNUSED_PAD src0_sel:DWORD src1_sel:WORD_1
    ds_read_u16_d16 v202, v202
    ds_read_u16_d16_hi v203, v203
    s_waitcnt lgkmcnt(14)
    v_mfma_f32_16x16x32_bf16 v[208:211], v[224:227], v[32:35], v[208:211]
    v_or_b32 v158, v188, v189
    v_mfma_f32_16x16x32_bf16 v[212:215], v[224:227], v[36:39], v[212:215]
    v_lshlrev_b32_sdwa v204, 1, v204 dst_sel:DWORD dst_unused:UNUSED_PAD src0_sel:DWORD src1_sel:WORD_1
    v_mfma_f32_16x16x32_bf16 v[216:219], v[224:227], v[40:43], v[216:219]
    v_lshlrev_b32_sdwa v205, 1, v205 dst_sel:DWORD dst_unused:UNUSED_PAD src0_sel:DWORD src1_sel:WORD_1
    ds_read_u16_d16 v204, v204
    ds_read_u16_d16_hi v205, v205
    v_mfma_f32_16x16x32_bf16 v[220:223], v[224:227], v[44:47], v[220:223]
    ds_read_b64_tr_b16 v[224:225], v255 offset:59464
    ds_read_b64_tr_b16 v[226:227], v255 offset:60232
    v_or_b32 v159, v190, v191
    v_mfma_f32_16x16x32_bf16 v[116:119], v[228:231], v[160:163], v[116:119]
    v_lshlrev_b32_sdwa v206, 1, v206 dst_sel:DWORD dst_unused:UNUSED_PAD src0_sel:DWORD src1_sel:WORD_1
    v_mfma_f32_16x16x32_bf16 v[124:127], v[228:231], v[164:167], v[124:127]
    v_lshlrev_b32_sdwa v207, 1, v207 dst_sel:DWORD dst_unused:UNUSED_PAD src0_sel:DWORD src1_sel:WORD_1
    ds_read_u16_d16 v206, v206
    ds_read_u16_d16_hi v207, v207
    v_mfma_f32_16x16x32_bf16 v[132:135], v[228:231], v[168:171], v[132:135]
    v_mfma_f32_16x16x32_bf16 v[140:143], v[228:231], v[172:175], v[140:143]
    ds_read_b64_tr_b16 v[228:229], v255 offset:59520
    ds_read_b64_tr_b16 v[230:231], v255 offset:60288
    s_waitcnt lgkmcnt(14)
    v_mfma_f32_16x16x32_bf16 v[48:51], v[232:235], v[144:147], v[48:51]
    v_or_b32 v160, v192, v193
    v_lshlrev_b32_sdwa v208, 1, v208 dst_sel:DWORD dst_unused:UNUSED_PAD src0_sel:DWORD src1_sel:WORD_1
    v_lshlrev_b32_sdwa v209, 1, v209 dst_sel:DWORD dst_unused:UNUSED_PAD src0_sel:DWORD src1_sel:WORD_1
    ds_read_u16_d16 v208, v208
    ds_read_u16_d16_hi v209, v209
    s_waitcnt vmcnt(0)
    v_lshrrev_b32 v244, 7, v253
    v_mul_u32_u24 v244, 640, v244
    v_add_u32 v244, v244, v253
    v_add_u32 v245, 196608, v244
    buffer_load_dwordx4 v[16:19], v244, s[8:11], s36 offen offset:0
    v_mfma_f32_16x16x32_bf16 v[56:59], v[232:235], v[148:151], v[56:59]
    v_or_b32 v161, v194, v195
    v_lshlrev_b32_sdwa v210, 1, v210 dst_sel:DWORD dst_unused:UNUSED_PAD src0_sel:DWORD src1_sel:WORD_1
    buffer_load_dwordx4 v[20:23], v244, s[8:11], s36 offen offset:128
    v_mfma_f32_16x16x32_bf16 v[64:67], v[232:235], v[152:155], v[64:67]
    v_lshlrev_b32_sdwa v211, 1, v211 dst_sel:DWORD dst_unused:UNUSED_PAD src0_sel:DWORD src1_sel:WORD_1
    ds_read_u16_d16 v210, v210
    ds_read_u16_d16_hi v211, v211
    v_or_b32 v164, v196, v197
    v_lshlrev_b32_sdwa v212, 1, v212 dst_sel:DWORD dst_unused:UNUSED_PAD src0_sel:DWORD src1_sel:WORD_1
    buffer_load_dwordx4 v[24:27], v244, s[8:11], s36 offen offset:256
    v_mfma_f32_16x16x32_bf16 v[72:75], v[232:235], v[156:159], v[72:75]
    ds_read_b64_tr_b16 v[232:233], v255 offset:59528
    ds_read_b64_tr_b16 v[234:235], v255 offset:60296
    v_lshlrev_b32_sdwa v213, 1, v213 dst_sel:DWORD dst_unused:UNUSED_PAD src0_sel:DWORD src1_sel:WORD_1
    ds_read_u16_d16 v212, v212
    ds_read_u16_d16_hi v213, v213
    v_or_b32 v165, v198, v199
    buffer_load_dwordx4 v[28:31], v244, s[8:11], s37 offen offset:0
    v_mfma_f32_16x16x32_bf16 v[52:55], v[236:239], v[144:147], v[52:55]
    v_lshlrev_b32_sdwa v214, 1, v214 dst_sel:DWORD dst_unused:UNUSED_PAD src0_sel:DWORD src1_sel:WORD_1
    v_lshlrev_b32_sdwa v215, 1, v215 dst_sel:DWORD dst_unused:UNUSED_PAD src0_sel:DWORD src1_sel:WORD_1
    ds_read_u16_d16 v214, v214
    ds_read_u16_d16_hi v215, v215
    buffer_load_dwordx4 v[32:35], v244, s[8:11], s37 offen offset:128
    v_mfma_f32_16x16x32_bf16 v[60:63], v[236:239], v[148:151], v[60:63]
    s_waitcnt lgkmcnt(14)
    v_or_b32 v168, v200, v201
    v_lshlrev_b32_sdwa v216, 1, v216 dst_sel:DWORD dst_unused:UNUSED_PAD src0_sel:DWORD src1_sel:WORD_1
    v_lshlrev_b32_sdwa v217, 1, v217 dst_sel:DWORD dst_unused:UNUSED_PAD src0_sel:DWORD src1_sel:WORD_1
    ds_read_u16_d16 v216, v216
    ds_read_u16_d16_hi v217, v217
    buffer_load_dwordx4 v[36:39], v244, s[8:11], s37 offen offset:256
    v_mfma_f32_16x16x32_bf16 v[68:71], v[236:239], v[152:155], v[68:71]
    v_or_b32 v169, v202, v203
    v_lshlrev_b32_sdwa v218, 1, v218 dst_sel:DWORD dst_unused:UNUSED_PAD src0_sel:DWORD src1_sel:WORD_1
    buffer_load_dwordx4 v[40:43], v245, s[8:11], s36 offen offset:0
    v_mfma_f32_16x16x32_bf16 v[76:79], v[236:239], v[156:159], v[76:79]

    s_cmp_ge_u32 s19, 24
    s_cbranch_scc1 L_rd24_go
    v_mov_b32 v236, 161976

    s_mov_b32 s29, 200000
L_rd24:
    ds_read_b32 v237, v236
    s_waitcnt lgkmcnt(0)
    v_cmp_le_u32 vcc, 24, v237
    s_cmp_eq_u64 vcc, exec
    s_cbranch_scc1 L_rd24_ok
    s_sleep 2
    s_sub_u32 s29, s29, 1
    s_cmp_lg_u32 s29, 0
    s_cbranch_scc1 L_rd24
L_rd24_ok:

    v_readfirstlane_b32 s19, v237
L_rd24_go:

    ds_read_b64_tr_b16 v[236:237], v255 offset:62464
    ds_read_b64_tr_b16 v[238:239], v255 offset:63232
    v_lshlrev_b32_sdwa v219, 1, v219 dst_sel:DWORD dst_unused:UNUSED_PAD src0_sel:DWORD src1_sel:WORD_1
    ds_read_u16_d16 v218, v218
    ds_read_u16_d16_hi v219, v219
    v_or_b32 v172, v204, v205
    v_lshlrev_b32_sdwa v220, 1, v220 dst_sel:DWORD dst_unused:UNUSED_PAD src0_sel:DWORD src1_sel:WORD_1
    buffer_load_dwordx4 v[44:47], v245, s[8:11], s36 offen offset:128
    v_mfma_f32_16x16x32_bf16 v[80:83], v[240:243], v[144:147], v[80:83]
    v_lshlrev_b32_sdwa v221, 1, v221 dst_sel:DWORD dst_unused:UNUSED_PAD src0_sel:DWORD src1_sel:WORD_1
    ds_read_u16_d16 v220, v220
    ds_read_u16_d16_hi v221, v221
    s_waitcnt lgkmcnt(14)
    v_or_b32 v173, v206, v207
    buffer_load_dwordx4 v[0:3], v245, s[8:11], s36 offen offset:256
    v_mfma_f32_16x16x32_bf16 v[88:91], v[240:243], v[148:151], v[88:91]
    v_lshlrev_b32_sdwa v222, 1, v222 dst_sel:DWORD dst_unused:UNUSED_PAD src0_sel:DWORD src1_sel:WORD_1
    v_lshlrev_b32_sdwa v223, 1, v223 dst_sel:DWORD dst_unused:UNUSED_PAD src0_sel:DWORD src1_sel:WORD_1
    ds_read_u16_d16 v222, v222
    ds_read_u16_d16_hi v223, v223
    buffer_load_dwordx4 v[4:7], v245, s[8:11], s37 offen offset:0
    v_mfma_f32_16x16x32_bf16 v[96:99], v[240:243], v[152:155], v[96:99]
    buffer_load_dwordx4 v[8:11], v245, s[8:11], s37 offen offset:128
    v_mfma_f32_16x16x32_bf16 v[104:107], v[240:243], v[156:159], v[104:107]
    ds_read_b64_tr_b16 v[240:241], v255 offset:62472
    ds_read_b64_tr_b16 v[242:243], v255 offset:63240
    buffer_load_dwordx4 v[12:15], v245, s[8:11], s37 offen offset:256
    v_mfma_f32_16x16x32_bf16 v[84:87], v[224:227], v[144:147], v[84:87]
    v_or_b32 v162, v208, v209
    v_mfma_f32_16x16x32_bf16 v[92:95], v[224:227], v[148:151], v[92:95]
    v_or_b32 v163, v210, v211
    v_mfma_f32_16x16x32_bf16 v[100:103], v[224:227], v[152:155], v[100:103]
    s_waitcnt lgkmcnt(14)
    v_or_b32 v166, v212, v213
    v_bfe_u32 v244, v253, 4, 3
    v_mul_u32_u24 v244, 768, v244
    v_bfe_u32 v245, v253, 7, 1
    v_lshl_add_u32 v244, v245, 6, v244
    v_lshrrev_b32 v245, 8, v253
    v_lshl_add_u32 v244, v245, 4, v244
    v_add_u32 v245, 196608, v244
    v_mfma_f32_16x16x32_bf16 v[108:111], v[224:227], v[156:159], v[108:111]
    ds_read_b64_tr_b16 v[224:225], v255 offset:62528
    ds_read_b64_tr_b16 v[226:227], v255 offset:63296
    s_waitcnt lgkmcnt(14)
    v_or_b32 v167, v214, v215
    v_mfma_f32_16x16x32_bf16 v[112:115], v[228:231], v[144:147], v[112:115]
    v_mfma_f32_16x16x32_bf16 v[120:123], v[228:231], v[148:151], v[120:123]
    s_waitcnt lgkmcnt(12)
    v_or_b32 v170, v216, v217
    v_mfma_f32_16x16x32_bf16 v[128:131], v[228:231], v[152:155], v[128:131]
    s_waitcnt lgkmcnt(8)
    v_or_b32 v171, v218, v219
    v_mfma_f32_16x16x32_bf16 v[136:139], v[228:231], v[156:159], v[136:139]
    ds_read_b64_tr_b16 v[228:229], v255 offset:62536
    ds_read_b64_tr_b16 v[230:231], v255 offset:63304
    s_waitcnt lgkmcnt(8)
    v_or_b32 v174, v220, v221
    v_mfma_f32_16x16x32_bf16 v[116:119], v[232:235], v[144:147], v[116:119]
    s_waitcnt lgkmcnt(6)
    v_or_b32 v175, v222, v223
    v_mfma_f32_16x16x32_bf16 v[124:127], v[232:235], v[148:151], v[124:127]
    v_mfma_f32_16x16x32_bf16 v[132:135], v[232:235], v[152:155], v[132:135]
    v_mfma_f32_16x16x32_bf16 v[140:143], v[232:235], v[156:159], v[140:143]
    ds_read_b64_tr_b16 v[232:233], v255 offset:62592
    ds_read_b64_tr_b16 v[234:235], v255 offset:63360
    v_mfma_f32_16x16x32_bf16 v[48:51], v[236:239], v[160:163], v[48:51]
    v_mfma_f32_16x16x32_bf16 v[56:59], v[236:239], v[164:167], v[56:59]
    v_mfma_f32_16x16x32_bf16 v[64:67], v[236:239], v[168:171], v[64:67]
    v_mfma_f32_16x16x32_bf16 v[72:75], v[236:239], v[172:175], v[72:75]
    ds_read_b64_tr_b16 v[236:237], v255 offset:62600
    ds_read_b64_tr_b16 v[238:239], v255 offset:63368
    s_waitcnt lgkmcnt(8)
    v_mfma_f32_16x16x32_bf16 v[52:55], v[240:243], v[160:163], v[52:55]
    v_mfma_f32_16x16x32_bf16 v[60:63], v[240:243], v[164:167], v[60:63]
    v_mfma_f32_16x16x32_bf16 v[68:71], v[240:243], v[168:171], v[68:71]
    v_mfma_f32_16x16x32_bf16 v[76:79], v[240:243], v[172:175], v[76:79]
    s_waitcnt lgkmcnt(6)
    v_mfma_f32_16x16x32_bf16 v[80:83], v[224:227], v[160:163], v[80:83]
    v_mfma_f32_16x16x32_bf16 v[88:91], v[224:227], v[164:167], v[88:91]
    v_mfma_f32_16x16x32_bf16 v[96:99], v[224:227], v[168:171], v[96:99]
    v_mfma_f32_16x16x32_bf16 v[104:107], v[224:227], v[172:175], v[104:107]
    s_waitcnt lgkmcnt(4)
    v_mfma_f32_16x16x32_bf16 v[84:87], v[228:231], v[160:163], v[84:87]
    v_cvt_pk_bf16_f32 v48, v48, v49
    v_cvt_pk_bf16_f32 v49, v50, v51
    v_cvt_pk_bf16_f32 v50, v52, v53
    v_cvt_pk_bf16_f32 v51, v54, v55
    v_mfma_f32_16x16x32_bf16 v[92:95], v[228:231], v[164:167], v[92:95]
    v_cvt_pk_bf16_f32 v56, v56, v57
    v_cvt_pk_bf16_f32 v57, v58, v59
    v_cvt_pk_bf16_f32 v58, v60, v61
    v_cvt_pk_bf16_f32 v59, v62, v63
    v_mfma_f32_16x16x32_bf16 v[100:103], v[228:231], v[168:171], v[100:103]
    v_cvt_pk_bf16_f32 v64, v64, v65
    v_cvt_pk_bf16_f32 v65, v66, v67
    v_cvt_pk_bf16_f32 v66, v68, v69
    v_cvt_pk_bf16_f32 v67, v70, v71
    v_mfma_f32_16x16x32_bf16 v[108:111], v[228:231], v[172:175], v[108:111]
    v_cvt_pk_bf16_f32 v72, v72, v73
    v_cvt_pk_bf16_f32 v73, v74, v75
    v_cvt_pk_bf16_f32 v74, v76, v77
    v_cvt_pk_bf16_f32 v75, v78, v79
    s_waitcnt lgkmcnt(2)
    v_mfma_f32_16x16x32_bf16 v[112:115], v[232:235], v[160:163], v[112:115]
    v_mfma_f32_16x16x32_bf16 v[120:123], v[232:235], v[164:167], v[120:123]
    v_mfma_f32_16x16x32_bf16 v[128:131], v[232:235], v[168:171], v[128:131]
    v_mfma_f32_16x16x32_bf16 v[136:139], v[232:235], v[172:175], v[136:139]
    s_waitcnt lgkmcnt(0)
    v_mfma_f32_16x16x32_bf16 v[116:119], v[236:239], v[160:163], v[116:119]
    v_cvt_pk_bf16_f32 v80, v80, v81
    v_cvt_pk_bf16_f32 v81, v82, v83
    v_cvt_pk_bf16_f32 v82, v84, v85
    v_cvt_pk_bf16_f32 v83, v86, v87
    v_mfma_f32_16x16x32_bf16 v[124:127], v[236:239], v[164:167], v[124:127]
    v_cvt_pk_bf16_f32 v88, v88, v89
    v_cvt_pk_bf16_f32 v89, v90, v91
    v_cvt_pk_bf16_f32 v90, v92, v93
    v_cvt_pk_bf16_f32 v91, v94, v95
    v_mfma_f32_16x16x32_bf16 v[132:135], v[236:239], v[168:171], v[132:135]
    v_cvt_pk_bf16_f32 v96, v96, v97
    v_cvt_pk_bf16_f32 v97, v98, v99
    v_cvt_pk_bf16_f32 v98, v100, v101
    v_cvt_pk_bf16_f32 v99, v102, v103
    v_mfma_f32_16x16x32_bf16 v[140:143], v[236:239], v[172:175], v[140:143]
    v_cvt_pk_bf16_f32 v104, v104, v105
    v_cvt_pk_bf16_f32 v105, v106, v107
    v_cvt_pk_bf16_f32 v106, v108, v109
    v_cvt_pk_bf16_f32 v107, v110, v111
    v_mov_b32 v52, v48
    v_mov_b32 v53, v49
    v_mov_b32 v54, v50
    v_mov_b32 v55, v51
    v_mov_b32_dpp v48, v80 row_ror:8 row_mask:0xf bank_mask:0xc
    v_mov_b32_dpp v49, v81 row_ror:8 row_mask:0xf bank_mask:0xc
    v_mov_b32_dpp v50, v82 row_ror:8 row_mask:0xf bank_mask:0xc
    v_mov_b32_dpp v51, v83 row_ror:8 row_mask:0xf bank_mask:0xc
    v_mov_b32_dpp v80, v52 row_ror:8 row_mask:0xf bank_mask:0x3
    v_mov_b32_dpp v81, v53 row_ror:8 row_mask:0xf bank_mask:0x3
    v_mov_b32_dpp v82, v54 row_ror:8 row_mask:0xf bank_mask:0x3
    v_mov_b32_dpp v83, v55 row_ror:8 row_mask:0xf bank_mask:0x3
    buffer_store_dwordx4 v[48:51], v244, s[8:11], s24 offen offset:0 sc1
    buffer_store_dwordx4 v[80:83], v245, s[8:11], s24 offen offset:0 sc1
    v_mov_b32 v68, v64
    v_mov_b32 v69, v65
    v_mov_b32 v70, v66
    v_mov_b32 v71, v67
    v_mov_b32_dpp v64, v96 row_ror:8 row_mask:0xf bank_mask:0xc
    v_mov_b32_dpp v65, v97 row_ror:8 row_mask:0xf bank_mask:0xc
    v_mov_b32_dpp v66, v98 row_ror:8 row_mask:0xf bank_mask:0xc
    v_mov_b32_dpp v67, v99 row_ror:8 row_mask:0xf bank_mask:0xc
    v_mov_b32_dpp v96, v68 row_ror:8 row_mask:0xf bank_mask:0x3
    v_mov_b32_dpp v97, v69 row_ror:8 row_mask:0xf bank_mask:0x3
    v_mov_b32_dpp v98, v70 row_ror:8 row_mask:0xf bank_mask:0x3
    v_mov_b32_dpp v99, v71 row_ror:8 row_mask:0xf bank_mask:0x3
    buffer_store_dwordx4 v[64:67], v244, s[8:11], s25 offen offset:0 sc1
    buffer_store_dwordx4 v[96:99], v245, s[8:11], s25 offen offset:0 sc1
    v_cvt_pk_bf16_f32 v112, v112, v113
    v_cvt_pk_bf16_f32 v113, v114, v115
    v_cvt_pk_bf16_f32 v114, v116, v117
    v_cvt_pk_bf16_f32 v115, v118, v119
    v_cvt_pk_bf16_f32 v120, v120, v121
    v_cvt_pk_bf16_f32 v121, v122, v123
    v_cvt_pk_bf16_f32 v122, v124, v125
    v_cvt_pk_bf16_f32 v123, v126, v127
    v_mov_b32 v116, v112
    v_mov_b32 v117, v113
    v_mov_b32 v118, v114
    v_mov_b32 v119, v115
    v_mov_b32_dpp v112, v56 row_ror:8 row_mask:0xf bank_mask:0xc
    v_mov_b32_dpp v113, v57 row_ror:8 row_mask:0xf bank_mask:0xc
    v_mov_b32_dpp v114, v58 row_ror:8 row_mask:0xf bank_mask:0xc
    v_mov_b32_dpp v115, v59 row_ror:8 row_mask:0xf bank_mask:0xc
    v_mov_b32_dpp v56, v116 row_ror:8 row_mask:0xf bank_mask:0x3
    v_mov_b32_dpp v57, v117 row_ror:8 row_mask:0xf bank_mask:0x3
    v_mov_b32_dpp v58, v118 row_ror:8 row_mask:0xf bank_mask:0x3
    v_mov_b32_dpp v59, v119 row_ror:8 row_mask:0xf bank_mask:0x3
    buffer_store_dwordx4 v[112:115], v244, s[8:11], s24 offen offset:128 sc1
    buffer_store_dwordx4 v[56:59], v245, s[8:11], s24 offen offset:128 sc1
    v_mov_b32 v92, v88
    v_mov_b32 v93, v89
    v_mov_b32 v94, v90
    v_mov_b32 v95, v91
    v_mov_b32_dpp v88, v120 row_ror:8 row_mask:0xf bank_mask:0xc
    v_mov_b32_dpp v89, v121 row_ror:8 row_mask:0xf bank_mask:0xc
    v_mov_b32_dpp v90, v122 row_ror:8 row_mask:0xf bank_mask:0xc
    v_mov_b32_dpp v91, v123 row_ror:8 row_mask:0xf bank_mask:0xc
    v_mov_b32_dpp v120, v92 row_ror:8 row_mask:0xf bank_mask:0x3
    v_mov_b32_dpp v121, v93 row_ror:8 row_mask:0xf bank_mask:0x3
    v_mov_b32_dpp v122, v94 row_ror:8 row_mask:0xf bank_mask:0x3
    v_mov_b32_dpp v123, v95 row_ror:8 row_mask:0xf bank_mask:0x3
    buffer_store_dwordx4 v[88:91], v244, s[8:11], s24 offen offset:256 sc1
    buffer_store_dwordx4 v[120:123], v245, s[8:11], s24 offen offset:256 sc1
    v_cvt_pk_bf16_f32 v128, v128, v129
    v_cvt_pk_bf16_f32 v129, v130, v131
    v_cvt_pk_bf16_f32 v130, v132, v133
    v_cvt_pk_bf16_f32 v131, v134, v135
    v_cvt_pk_bf16_f32 v136, v136, v137
    v_cvt_pk_bf16_f32 v137, v138, v139
    v_cvt_pk_bf16_f32 v138, v140, v141
    v_cvt_pk_bf16_f32 v139, v142, v143
    v_mov_b32 v132, v128
    v_mov_b32 v133, v129
    v_mov_b32 v134, v130
    v_mov_b32 v135, v131
    v_mov_b32_dpp v128, v72 row_ror:8 row_mask:0xf bank_mask:0xc
    v_mov_b32_dpp v129, v73 row_ror:8 row_mask:0xf bank_mask:0xc
    v_mov_b32_dpp v130, v74 row_ror:8 row_mask:0xf bank_mask:0xc
    v_mov_b32_dpp v131, v75 row_ror:8 row_mask:0xf bank_mask:0xc
    v_mov_b32_dpp v72, v132 row_ror:8 row_mask:0xf bank_mask:0x3
    v_mov_b32_dpp v73, v133 row_ror:8 row_mask:0xf bank_mask:0x3
    v_mov_b32_dpp v74, v134 row_ror:8 row_mask:0xf bank_mask:0x3
    v_mov_b32_dpp v75, v135 row_ror:8 row_mask:0xf bank_mask:0x3
    buffer_store_dwordx4 v[128:131], v244, s[8:11], s25 offen offset:128 sc1
    buffer_store_dwordx4 v[72:75], v245, s[8:11], s25 offen offset:128 sc1
    v_mov_b32 v108, v104
    v_mov_b32 v109, v105
    v_mov_b32 v110, v106
    v_mov_b32 v111, v107
    v_mov_b32_dpp v104, v136 row_ror:8 row_mask:0xf bank_mask:0xc
    v_mov_b32_dpp v105, v137 row_ror:8 row_mask:0xf bank_mask:0xc
    v_mov_b32_dpp v106, v138 row_ror:8 row_mask:0xf bank_mask:0xc
    v_mov_b32_dpp v107, v139 row_ror:8 row_mask:0xf bank_mask:0xc
    v_mov_b32_dpp v136, v108 row_ror:8 row_mask:0xf bank_mask:0x3
    v_mov_b32_dpp v137, v109 row_ror:8 row_mask:0xf bank_mask:0x3
    v_mov_b32_dpp v138, v110 row_ror:8 row_mask:0xf bank_mask:0x3
    v_mov_b32_dpp v139, v111 row_ror:8 row_mask:0xf bank_mask:0x3
    buffer_store_dwordx4 v[104:107], v244, s[8:11], s25 offen offset:256 sc1
    buffer_store_dwordx4 v[136:139], v245, s[8:11], s25 offen offset:256 sc1
L_fin2:

    s_cmp_lg_u32 s17, 0
    s_cbranch_scc1 L_end
    s_mov_b32 s17, 1
    s_mov_b32 s24, s36
    s_mov_b32 s25, s37
    s_mov_b32 s36, 1073741824
    s_mov_b32 s37, 1073741824
    s_setprio 1
    s_branch L_mtile

L_end:
    s_endpgm

.section .rodata,"a"

.p2align 6
.amdhsa_kernel standalone__modern_conv_block_replknet__vision_kernel
.amdhsa_next_free_vgpr 256
.amdhsa_next_free_sgpr 100
.amdhsa_accum_offset 256
.amdhsa_group_segment_fixed_size 0
.amdhsa_kernarg_size 64
.amdhsa_user_sgpr_count 2
.amdhsa_user_sgpr_kernarg_segment_ptr 1
.amdhsa_system_sgpr_workgroup_id_x 1
.amdhsa_float_denorm_mode_32 3
.end_amdhsa_kernel
```

```asm
; @launch grid=(256,1,1) block=(512,1,1) lds=162320
.amdgcn_target "amdgcn-amd-amdhsa--gfx950"
.text

.globl standalone__modern_conv_block_replknet__vision_kernel
.p2align 8
.type standalone__modern_conv_block_replknet__vision_kernel,@function
standalone__modern_conv_block_replknet__vision_kernel:
    s_cmp_ge_u32 s2, 256
    s_cbranch_scc1 L_end
    s_load_dwordx8 s[64:71], s[0:1], 0
    s_load_dwordx4 s[72:75], s[0:1], 32

    s_getpc_b64 s[96:97]
L_pc0:
    v_add_u32 v16, 448, v0
    v_and_b32 v16, 511, v16
    v_lshlrev_b32 v16, 7, v16
    v_min_u32 v16, L_end-L_pc0, v16
    v_mov_b32 v17, s97
    v_add_co_u32 v16, vcc, s96, v16
    s_nop 1
    v_addc_co_u32 v17, vcc, 0, v17, vcc
    global_load_dword v18, v[16:17], off sc1
    s_setprio 3
    v_mov_b32 v14, v0
    v_lshrrev_b32 v1, 6, v0
    v_and_b32 v0, 63, v0
    v_mov_b32 v10, 1073741824
    v_readfirstlane_b32 s16, v1
    v_lshlrev_b32 v2, 2, v0
    v_add_u32 v2, 161808, v2
    v_add_u32 v3, -10, v0
    v_cmp_gt_u32 vcc, 10, v3
    v_cmp_eq_u32 s[56:57], 36, v0
    s_or_b64 vcc, vcc, s[56:57]
    v_cndmask_b32 v3, 0, 1, vcc
    v_lshlrev_b32 v253, 4, v0
    v_min_u32 v240, 1, v0
    ds_write_b32 v2, v3
    v_lshlrev_b32 v240, 2, v240
    s_and_b32 s26, s2, 3
    s_lshl_b32 s26, s26, 2
    s_bfe_u32 s27, s2, 0x20003
    s_add_u32 s26, s26, s27
    s_lshl_b32 s22, s26, 5
    s_bfe_u32 s26, s2, 0x10002
    s_lshl_b32 s26, s26, 3
    s_lshr_b32 s27, s2, 5
    s_add_u32 s26, s26, s27
    s_lshl_b32 s23, s26, 5
    v_mul_u32_u24 v12, 43, v0
    v_lshrrev_b32 v12, 9, v12
    v_mul_u32_u24 v13, 12, v12
    v_sub_u32 v13, v0, v13
    v_mul_u32_u24 v5, 98304, v12
    v_lshl_add_u32 v5, v13, 4, v5
    v_cmp_gt_u32 vcc, 48, v0
    v_cmp_gt_u32 s[58:59], 24, v0
    s_cmp_eq_u32 s22, 0
    s_cselect_b32 s80, 1073741824, 0
    v_cndmask_b32 v247, v10, v5, vcc
    s_mov_b32 s82, 3840
    s_cmp_eq_u32 s22, 480
    s_cselect_b32 s81, 1073741824, s82
    s_mov_b32 s18, s16
    v_add_u32 v15, -256, v14

    s_waitcnt lgkmcnt(0)
    s_barrier
    s_mov_b32 s4, s64
    s_and_b32 s5, s65, 0xffff
    s_mov_b32 s6, 50331648
    s_mov_b32 s7, 0x20000
    s_mov_b32 s48, s66
    s_and_b32 s49, s67, 0xffff
    s_mov_b32 s50, 1728
    s_mov_b32 s51, 0x20000
    s_mov_b32 s52, s68
    s_and_b32 s53, s69, 0xffff
    s_mov_b32 s54, 4800
    s_mov_b32 s55, 0x20000
    s_mov_b32 s40, s70
    s_and_b32 s41, s71, 0xffff
    s_mov_b32 s42, 73728
    s_mov_b32 s43, 0x20000
    s_mov_b32 s44, s72
    s_and_b32 s45, s73, 0xffff
    s_mov_b32 s46, 73728
    s_mov_b32 s47, 0x20000
    s_mov_b32 s8, s74
    s_and_b32 s9, s75, 0xffff
    s_mov_b32 s10, 50331648
    s_mov_b32 s11, 0x20000

    s_cmp_lg_u32 s16, 0
    s_cbranch_scc1 L_pb
    s_mov_b32 m0, 21504
    s_mov_b32 s26, 4096

    buffer_load_dwordx4 v253, s[52:55], 0 offen offset:0 lds
    buffer_load_dwordx4 v253, s[52:55], 0 offen offset:1024 lds
    buffer_load_dwordx4 v253, s[52:55], 0 offen offset:2048 lds
    buffer_load_dwordx4 v253, s[52:55], 0 offen offset:3072 lds
    s_mov_b32 m0, 25600
    s_nop 0
    buffer_load_dwordx4 v253, s[52:55], s26 offen lds
    s_mov_b32 m0, 26624
    s_nop 0
    buffer_load_dwordx4 v253, s[48:51], 0 offen offset:0 lds
    buffer_load_dwordx4 v253, s[48:51], 0 offen offset:1024 lds

    s_lshl_b32 s26, s18, 2
    s_add_u32 s26, s26, s23
    s_lshl_b32 s27, s26, 9
    s_add_u32 s27, s27, s22
    s_mul_i32 s27, s27, 192
    s_cmp_lt_u32 s26, 2
    s_cselect_b64 vcc, s[58:59], 0
    v_mov_b32 v248, 1073741824
    s_sub_u32 s28, s27, 196608
    v_add_u32 v255, s28, v247
    v_cndmask_b32 v248, v255, v248, vcc
    v_add_u32 v255, -384, v248

    buffer_load_dwordx4 v[48:51], v255, s[4:7], s80 offen offset:0 sc1
    buffer_load_dwordx4 v[52:55], v255, s[4:7], s80 offen offset:192 sc1
    buffer_load_dwordx4 v[56:59], v248, s[4:7], 0 offen offset:0 sc1
    buffer_load_dwordx4 v[60:63], v248, s[4:7], 0 offen offset:192 sc1
    buffer_load_dwordx4 v[64:67], v248, s[4:7], 0 offen offset:384 sc1
    buffer_load_dwordx4 v[68:71], v248, s[4:7], 0 offen offset:576 sc1
    buffer_load_dwordx4 v[72:75], v248, s[4:7], 0 offen offset:768 sc1
    buffer_load_dwordx4 v[76:79], v248, s[4:7], 0 offen offset:960 sc1
    buffer_load_dwordx4 v[80:83], v248, s[4:7], 0 offen offset:1152 sc1
    buffer_load_dwordx4 v[84:87], v248, s[4:7], 0 offen offset:1344 sc1
    buffer_load_dwordx4 v[88:91], v248, s[4:7], 0 offen offset:1536 sc1
    buffer_load_dwordx4 v[92:95], v248, s[4:7], 0 offen offset:1728 sc1
    buffer_load_dwordx4 v[96:99], v248, s[4:7], 0 offen offset:1920 sc1
    buffer_load_dwordx4 v[100:103], v248, s[4:7], 0 offen offset:2112 sc1
    buffer_load_dwordx4 v[104:107], v248, s[4:7], 0 offen offset:2304 sc1
    buffer_load_dwordx4 v[108:111], v248, s[4:7], 0 offen offset:2496 sc1
    buffer_load_dwordx4 v[112:115], v248, s[4:7], 0 offen offset:2688 sc1
    buffer_load_dwordx4 v[116:119], v248, s[4:7], 0 offen offset:2880 sc1
    buffer_load_dwordx4 v[120:123], v248, s[4:7], 0 offen offset:3072 sc1
    buffer_load_dwordx4 v[124:127], v248, s[4:7], 0 offen offset:3264 sc1
    buffer_load_dwordx4 v[128:131], v248, s[4:7], 0 offen offset:3456 sc1
    buffer_load_dwordx4 v[132:135], v248, s[4:7], 0 offen offset:3648 sc1
    buffer_load_dwordx4 v[136:139], v248, s[4:7], s82 offen offset:0 sc1
    buffer_load_dwordx4 v[140:143], v248, s[4:7], s82 offen offset:192 sc1
    buffer_load_dwordx4 v[144:147], v248, s[4:7], s82 offen offset:384 sc1
    buffer_load_dwordx4 v[148:151], v248, s[4:7], s82 offen offset:576 sc1
    buffer_load_dwordx4 v[152:155], v248, s[4:7], s82 offen offset:768 sc1
    buffer_load_dwordx4 v[156:159], v248, s[4:7], s82 offen offset:960 sc1
    buffer_load_dwordx4 v[160:163], v248, s[4:7], s82 offen offset:1152 sc1
    buffer_load_dwordx4 v[164:167], v248, s[4:7], s82 offen offset:1344 sc1
    buffer_load_dwordx4 v[168:171], v248, s[4:7], s82 offen offset:1536 sc1
    buffer_load_dwordx4 v[172:175], v248, s[4:7], s82 offen offset:1728 sc1
    buffer_load_dwordx4 v[176:179], v248, s[4:7], s82 offen offset:1920 sc1
    buffer_load_dwordx4 v[180:183], v248, s[4:7], s82 offen offset:2112 sc1
    buffer_load_dwordx4 v[184:187], v248, s[4:7], s81 offen offset:2304 sc1
    buffer_load_dwordx4 v[188:191], v248, s[4:7], s81 offen offset:2496 sc1

    v_mov_b32 v254, 161972
    v_mov_b32 v255, 1
    ds_write_b32 v254, v255
    s_waitcnt vmcnt(36)
    ds_write_b32 v254, v255 offset:12

L_pb:
    s_mov_b32 s20, 0x05040100
    s_mov_b32 s21, 0x07060302
    s_lshr_b32 s26, s2, 3
    s_mul_i32 s27, s26, 43
    s_lshr_b32 s27, s27, 9
    s_mul_i32 s27, s27, 12
    s_sub_u32 s39, s26, s27
    v_bfe_u32 v1, v0, 3, 1
    v_lshrrev_b32 v2, 5, v0
    v_bfe_u32 v3, v0, 4, 1
    v_bfe_u32 v4, v0, 2, 1
    v_sub_u32 v3, v3, v4
    v_and_b32 v4, 3, v0
    v_mul_u32_u24 v5, 65440, v1
    v_lshl_add_u32 v5, v4, 4, v5
    v_add_u32 v5, 50176, v5
    v_cmp_eq_u32 s[56:57], v1, v2
    v_add_u32 v6, 0, v3
    v_cmp_gt_u32 vcc, 5, v6
    v_lshl_add_u32 v7, v6, 6, v5
    s_and_b64 vcc, vcc, s[56:57]
    v_cndmask_b32 v241, v10, v7, vcc
    v_add_u32 v6, 2, v3
    v_lshl_add_u32 v7, v6, 6, v5
    v_cndmask_b32 v242, v10, v7, s[56:57]
    v_add_u32 v6, 4, v3
    v_cmp_gt_u32 vcc, 5, v6
    v_lshl_add_u32 v7, v6, 6, v5
    s_and_b64 vcc, vcc, s[56:57]
    v_cndmask_b32 v243, v10, v7, vcc
    v_mul_u32_u24 v2, 1168, v2
    v_and_b32 v3, 7, v0
    v_lshl_add_u32 v250, v3, 3, v2
    v_mul_u32_u24 v3, 768, v3
    v_mul_u32_u24 v4, 196608, v1
    v_add_u32 v3, v3, v4
    v_lshrrev_b32 v4, 4, v0
    v_lshl_add_u32 v252, v4, 4, v3

    v_bfe_u32 v3, v0, 4, 1
    v_mul_u32_u24 v3, 7104, v3
    v_add_u32 v250, v250, v3
    v_cmp_eq_u32 s[56:57], 1, v1
    v_and_b32 v5, 1, v12
    v_mul_u32_u24 v5, 7104, v5
    v_mul_u32_u24 v6, 584, v13
    v_add_u32 v249, v5, v6
    s_lshl_b32 s26, s16, 2
    s_add_u32 s26, s26, s23
    s_lshl_b32 s26, s26, 9
    s_add_u32 s26, s26, s22
    s_mul_i32 s36, s26, 192
    s_add_u32 s37, s36, 98304
    s_add_u32 s24, s36, 384
    s_add_u32 s25, s24, 98304
    s_cmp_lt_u32 s16, 1
    s_cbranch_scc1 L_perm
    s_cmp_lt_u32 s16, 4
    s_cbranch_scc1 L_xload

    v_mov_b32 v254, 161984

    s_mov_b32 s29, 200000
L_wraw:
    ds_read_b32 v255, v254
    s_waitcnt lgkmcnt(0)
    v_cmp_eq_u32 vcc, 1, v255
    s_cmp_eq_u64 vcc, exec
    s_cbranch_scc1 L_wraw_ok
    s_sleep 2
    s_sub_u32 s29, s29, 1
    s_cmp_lg_u32 s29, 0
    s_cbranch_scc1 L_wraw
L_wraw_ok:

    v_add_u32 v1, 0, v15
    v_mul_u32_u24 v128, 683, v1
    v_lshrrev_b32 v128, 16, v128
    v_mul_u32_u24 v129, 96, v128
    v_sub_u32 v129, v1, v129
    v_mul_u32_u24 v2, 960, v128
    v_lshl_add_u32 v2, v129, 1, v2
    v_add_u32 v2, 21504, v2
    v_add_u32 v1, -1, v128
    v_mul_u32_u24 v3, 576, v1
    v_lshl_add_u32 v3, v129, 1, v3
    v_add_u32 v3, 26624, v3
    v_cmp_gt_u32 vcc, 3, v1
    s_nop 1
    v_cndmask_b32 v3, v10, v3, vcc

    ds_read_u16 v132, v2 offset:0
    ds_read_u16 v133, v2 offset:192
    ds_read_u16 v134, v2 offset:384
    ds_read_u16 v135, v2 offset:576
    ds_read_u16 v136, v2 offset:768
    ds_read_u16 v137, v3 offset:0
    ds_read_u16 v138, v3 offset:192
    ds_read_u16 v139, v3 offset:384

    v_add_u32 v1, 256, v15
    v_mul_u32_u24 v144, 683, v1
    v_lshrrev_b32 v144, 16, v144
    v_mul_u32_u24 v145, 96, v144
    v_sub_u32 v145, v1, v145
    v_mul_u32_u24 v2, 960, v144
    v_lshl_add_u32 v2, v145, 1, v2
    v_add_u32 v2, 21504, v2
    v_add_u32 v1, -1, v144
    v_mul_u32_u24 v3, 576, v1
    v_lshl_add_u32 v3, v145, 1, v3
    v_add_u32 v3, 26624, v3
    v_cmp_gt_u32 vcc, 3, v1
    s_nop 1
    v_cndmask_b32 v3, v10, v3, vcc

    ds_read_u16 v148, v2 offset:0
    ds_read_u16 v149, v2 offset:192
    ds_read_u16 v150, v2 offset:384
    ds_read_u16 v151, v2 offset:576
    ds_read_u16 v152, v2 offset:768
    ds_read_u16 v153, v3 offset:0
    ds_read_u16 v154, v3 offset:192
    ds_read_u16 v155, v3 offset:384
    s_waitcnt lgkmcnt(0)
    v_lshlrev_b32 v132, 16, v132
    v_lshlrev_b32 v133, 16, v133
    v_lshlrev_b32 v134, 16, v134
    v_lshlrev_b32 v135, 16, v135
    v_lshlrev_b32 v136, 16, v136
    v_lshlrev_b32 v137, 16, v137
    v_lshlrev_b32 v138, 16, v138
    v_lshlrev_b32 v139, 16, v139

    v_add_f32 v133, v133, v137
    v_add_f32 v134, v134, v138
    v_add_f32 v135, v135, v139
    v_mov_b32 v1, 0
    v_cvt_pk_bf16_f32 v160, v132, v133
    v_cvt_pk_bf16_f32 v161, v134, v135
    v_cvt_pk_bf16_f32 v162, v136, v1
    v_mov_b32 v163, 0
    v_cvt_pk_bf16_f32 v164, v1, v132
    v_cvt_pk_bf16_f32 v165, v133, v134
    v_cvt_pk_bf16_f32 v166, v135, v136
    v_mov_b32 v167, 0
    v_mov_b32 v168, 0
    v_mov_b32 v169, v160
    v_mov_b32 v170, v161
    v_mov_b32 v171, v162
    v_mov_b32 v172, 0
    v_mov_b32 v173, v164
    v_mov_b32 v174, v165
    v_mov_b32 v175, v166
    v_lshrrev_b32 v2, 5, v129
    v_and_b32 v3, 15, v129
    v_lshl_add_u32 v2, v2, 4, v3
    v_mul_u32_u24 v2, 320, v2
    v_bfe_u32 v3, v129, 4, 1
    v_mul_u32_u24 v3, 65440, v3
    v_add_u32 v2, v2, v3
    v_lshl_add_u32 v2, v128, 6, v2
    v_add_u32 v2, 50176, v2
    v_cmp_gt_u32 vcc, 5, v128
    s_nop 1
    v_cndmask_b32 v2, v10, v2, vcc
    ds_write_b128 v2, v[160:163]
    ds_write_b128 v2, v[164:167] offset:16
    ds_write_b128 v2, v[168:171] offset:32
    ds_write_b128 v2, v[172:175] offset:48

    v_lshlrev_b32 v148, 16, v148
    v_lshlrev_b32 v149, 16, v149
    v_lshlrev_b32 v150, 16, v150
    v_lshlrev_b32 v151, 16, v151
    v_lshlrev_b32 v152, 16, v152
    v_lshlrev_b32 v153, 16, v153
    v_lshlrev_b32 v154, 16, v154
    v_lshlrev_b32 v155, 16, v155

    v_add_f32 v149, v149, v153
    v_add_f32 v150, v150, v154
    v_add_f32 v151, v151, v155
    v_mov_b32 v1, 0
    v_cvt_pk_bf16_f32 v176, v148, v149
    v_cvt_pk_bf16_f32 v177, v150, v151
    v_cvt_pk_bf16_f32 v178, v152, v1
    v_mov_b32 v179, 0
    v_cvt_pk_bf16_f32 v180, v1, v148
    v_cvt_pk_bf16_f32 v181, v149, v150
    v_cvt_pk_bf16_f32 v182, v151, v152
    v_mov_b32 v183, 0
    v_mov_b32 v184, 0
    v_mov_b32 v185, v176
    v_mov_b32 v186, v177
    v_mov_b32 v187, v178
    v_mov_b32 v188, 0
    v_mov_b32 v189, v180
    v_mov_b32 v190, v181
    v_mov_b32 v191, v182
    v_lshrrev_b32 v2, 5, v145
    v_and_b32 v3, 15, v145
    v_lshl_add_u32 v2, v2, 4, v3
    v_mul_u32_u24 v2, 320, v2
    v_bfe_u32 v3, v145, 4, 1
    v_mul_u32_u24 v3, 65440, v3
    v_add_u32 v2, v2, v3
    v_lshl_add_u32 v2, v144, 6, v2
    v_add_u32 v2, 50176, v2
    v_cmp_gt_u32 vcc, 5, v144
    s_nop 1
    v_cndmask_b32 v2, v10, v2, vcc
    ds_write_b128 v2, v[176:179]
    ds_write_b128 v2, v[180:183] offset:16
    ds_write_b128 v2, v[184:187] offset:32
    ds_write_b128 v2, v[188:191] offset:48

    v_mov_b32 v254, 161968
    v_mov_b32 v255, 1
    s_waitcnt lgkmcnt(0)
    s_mov_b64 exec, 1
    ds_add_u32 v254, v255
    s_mov_b64 exec, -1

    s_cmp_lt_u32 s16, 6
    s_cbranch_scc1 L_xload
L_tab:
    v_add_u32 v1, -384, v14
    v_lshlrev_b32 v2, 2, v1
    v_add_u32 v3, 65536, v2
    v_lshlrev_b32 v4, 17, v1
    v_or_b32 v4, 0x8000, v4
    v_cmp_gt_u32 vcc, 64, v1
    v_mov_b32 v5, 931135488
    v_mov_b32 v6, 939524096
    v_cndmask_b32 v5, v5, v6, vcc
    v_cndmask_b32 v6, 0, v6, vcc
    v_add_u32 v4, v4, v5
    s_mov_b32 s26, 0x3dd2d3e8
    v_mov_b32 v7, 0x40135761
    s_mov_b32 s27, 14
L_tabl:
    v_add_u32 v9, 0x10000, v4
    v_sub_f32 v8, v4, v6
    v_sub_f32 v9, v9, v6
    v_mul_f32 v10, v8, v8
    v_mul_f32 v11, v9, v9
    v_fma_f32 v10, v10, s26, v7
    v_fma_f32 v11, v11, s26, v7
    v_mul_f32 v10, v10, v8
    v_mul_f32 v11, v11, v9
    v_exp_f32 v10, -v10
    v_exp_f32 v11, -v11
    s_nop 0
    v_add_f32 v12, 1.0, v10
    v_add_f32 v13, 1.0, v11
    v_rcp_f32 v12, v12
    v_rcp_f32 v13, v13
    s_nop 0
    v_mul_f32 v8, v8, v12
    v_mul_f32 v9, v9, v13
    v_mul_f32 v10, -v8, v10
    v_mul_f32 v11, -v9, v11
    v_cvt_pk_bf16_f32 v12, v8, v9
    v_cvt_pk_bf16_f32 v13, v10, v11
    ds_write_b32 v2, v12
    ds_write_b32 v3, v13
    v_sub_u32 v4, v4, v5
    v_mov_b32 v5, 931135488
    v_mov_b32 v6, 0
    v_add_u32 v4, v4, v5
    v_add_u32 v4, 0x1000000, v4
    v_add_u32 v2, 512, v2
    v_add_u32 v3, 512, v3
    s_sub_u32 s27, s27, 1
    s_cmp_lg_u32 s27, 0
    s_cbranch_scc1 L_tabl

    v_mov_b32 v254, 161980
    v_mov_b32 v255, 1
    s_waitcnt lgkmcnt(0)
    s_mov_b64 exec, 1
    ds_add_u32 v254, v255
    s_mov_b64 exec, -1

L_xload:
    v_mov_b32 v254, 161972

    s_mov_b32 s29, 200000
L_wiss:
    ds_read_b32 v255, v254
    s_waitcnt lgkmcnt(0)
    v_cmp_eq_u32 vcc, s18, v255
    s_cmp_eq_u64 vcc, exec
    s_cbranch_scc1 L_wiss_ok
    s_sleep 2
    s_sub_u32 s29, s29, 1
    s_cmp_lg_u32 s29, 0
    s_cbranch_scc1 L_wiss
L_wiss_ok:

    s_cmp_lg_u32 s18, 5
    s_cbranch_scc1 L_nocpb

    s_getpc_b64 s[96:97]
L_pcb:
    s_add_u32 s96, s96, L_loader-L_pcb
    s_addc_u32 s97, s97, 0
    v_lshlrev_b32 v20, 3, v253
    v_mov_b32 v23, s97

    v_add_u32 v21, 0, v20
    v_min_u32 v21, L_end-L_loader, v21
    v_add_co_u32 v24, vcc, s96, v21
    s_nop 1
    v_addc_co_u32 v25, vcc, 0, v23, vcc
    global_load_dword v22, v[24:25], off sc1

    v_add_u32 v21, 8192, v20
    v_min_u32 v21, L_end-L_loader, v21
    v_add_co_u32 v26, vcc, s96, v21
    s_nop 1
    v_addc_co_u32 v27, vcc, 0, v23, vcc
    global_load_dword v22, v[26:27], off sc1

L_nocpb:

    s_lshl_b32 s26, s18, 2
    s_add_u32 s26, s26, s23
    s_lshl_b32 s27, s26, 9
    s_add_u32 s27, s27, s22
    s_mul_i32 s27, s27, 192
    s_cmp_lt_u32 s26, 2
    s_cselect_b64 vcc, s[58:59], 0
    v_mov_b32 v248, 1073741824
    s_sub_u32 s28, s27, 196608
    v_add_u32 v255, s28, v247
    v_cndmask_b32 v248, v255, v248, vcc
    v_add_u32 v255, -384, v248

    buffer_load_dwordx4 v[48:51], v255, s[4:7], s80 offen offset:0 sc1
    buffer_load_dwordx4 v[52:55], v255, s[4:7], s80 offen offset:192 sc1
    buffer_load_dwordx4 v[56:59], v248, s[4:7], 0 offen offset:0 sc1
    buffer_load_dwordx4 v[60:63], v248, s[4:7], 0 offen offset:192 sc1
    buffer_load_dwordx4 v[64:67], v248, s[4:7], 0 offen offset:384 sc1
    buffer_load_dwordx4 v[68:71], v248, s[4:7], 0 offen offset:576 sc1
    buffer_load_dwordx4 v[72:75], v248, s[4:7], 0 offen offset:768 sc1
    buffer_load_dwordx4 v[76:79], v248, s[4:7], 0 offen offset:960 sc1
    buffer_load_dwordx4 v[80:83], v248, s[4:7], 0 offen offset:1152 sc1
    buffer_load_dwordx4 v[84:87], v248, s[4:7], 0 offen offset:1344 sc1
    buffer_load_dwordx4 v[88:91], v248, s[4:7], 0 offen offset:1536 sc1
    buffer_load_dwordx4 v[92:95], v248, s[4:7], 0 offen offset:1728 sc1
    buffer_load_dwordx4 v[96:99], v248, s[4:7], 0 offen offset:1920 sc1
    buffer_load_dwordx4 v[100:103], v248, s[4:7], 0 offen offset:2112 sc1
    buffer_load_dwordx4 v[104:107], v248, s[4:7], 0 offen offset:2304 sc1
    buffer_load_dwordx4 v[108:111], v248, s[4:7], 0 offen offset:2496 sc1
    buffer_load_dwordx4 v[112:115], v248, s[4:7], 0 offen offset:2688 sc1
    buffer_load_dwordx4 v[116:119], v248, s[4:7], 0 offen offset:2880 sc1
    buffer_load_dwordx4 v[120:123], v248, s[4:7], 0 offen offset:3072 sc1
    buffer_load_dwordx4 v[124:127], v248, s[4:7], 0 offen offset:3264 sc1
    buffer_load_dwordx4 v[128:131], v248, s[4:7], 0 offen offset:3456 sc1
    buffer_load_dwordx4 v[132:135], v248, s[4:7], 0 offen offset:3648 sc1
    buffer_load_dwordx4 v[136:139], v248, s[4:7], s82 offen offset:0 sc1
    buffer_load_dwordx4 v[140:143], v248, s[4:7], s82 offen offset:192 sc1
    buffer_load_dwordx4 v[144:147], v248, s[4:7], s82 offen offset:384 sc1
    buffer_load_dwordx4 v[148:151], v248, s[4:7], s82 offen offset:576 sc1
    buffer_load_dwordx4 v[152:155], v248, s[4:7], s82 offen offset:768 sc1
    buffer_load_dwordx4 v[156:159], v248, s[4:7], s82 offen offset:960 sc1
    buffer_load_dwordx4 v[160:163], v248, s[4:7], s82 offen offset:1152 sc1
    buffer_load_dwordx4 v[164:167], v248, s[4:7], s82 offen offset:1344 sc1
    buffer_load_dwordx4 v[168:171], v248, s[4:7], s82 offen offset:1536 sc1
    buffer_load_dwordx4 v[172:175], v248, s[4:7], s82 offen offset:1728 sc1
    buffer_load_dwordx4 v[176:179], v248, s[4:7], s82 offen offset:1920 sc1
    buffer_load_dwordx4 v[180:183], v248, s[4:7], s82 offen offset:2112 sc1
    buffer_load_dwordx4 v[184:187], v248, s[4:7], s81 offen offset:2304 sc1
    buffer_load_dwordx4 v[188:191], v248, s[4:7], s81 offen offset:2496 sc1

    s_add_u32 s26, s18, 1
    v_mov_b32 v255, s26
    ds_write_b32 v254, v255

L_perm:
    s_mov_b32 exec_hi, 0x0000ffff
    s_waitcnt vmcnt(32)
    v_perm_b32 v192, v52, v48, s20
    v_perm_b32 v193, v60, v56, s20
    v_perm_b32 v194, v52, v48, s21
    v_perm_b32 v195, v60, v56, s21
    v_perm_b32 v196, v53, v49, s20
    v_perm_b32 v197, v61, v57, s20
    v_perm_b32 v198, v53, v49, s21
    v_perm_b32 v199, v61, v57, s21
    v_perm_b32 v200, v54, v50, s20
    v_perm_b32 v201, v62, v58, s20
    v_perm_b32 v202, v54, v50, s21
    v_perm_b32 v203, v62, v58, s21
    v_perm_b32 v204, v55, v51, s20
    v_perm_b32 v205, v63, v59, s20
    v_perm_b32 v206, v55, v51, s21
    v_perm_b32 v207, v63, v59, s21
    s_waitcnt vmcnt(28)
    v_perm_b32 v48, v68, v64, s20
    v_perm_b32 v49, v76, v72, s20
    v_perm_b32 v50, v68, v64, s21
    v_perm_b32 v51, v76, v72, s21
    v_perm_b32 v52, v69, v65, s20
    v_perm_b32 v53, v77, v73, s20
    v_perm_b32 v54, v69, v65, s21
    v_perm_b32 v55, v77, v73, s21
    v_perm_b32 v56, v70, v66, s20
    v_perm_b32 v57, v78, v74, s20
    v_perm_b32 v58, v70, v66, s21
    v_perm_b32 v59, v78, v74, s21
    v_perm_b32 v60, v71, v67, s20
    v_perm_b32 v61, v79, v75, s20
    v_perm_b32 v62, v71, v67, s21
    v_perm_b32 v63, v79, v75, s21
    s_waitcnt vmcnt(24)
    v_perm_b32 v64, v84, v80, s20
    v_perm_b32 v65, v92, v88, s20
    v_perm_b32 v66, v84, v80, s21
    v_perm_b32 v67, v92, v88, s21
    v_perm_b32 v68, v85, v81, s20
    v_perm_b32 v69, v93, v89, s20
    v_perm_b32 v70, v85, v81, s21
    v_perm_b32 v71, v93, v89, s21
    v_perm_b32 v72, v86, v82, s20
    v_perm_b32 v73, v94, v90, s20
    v_perm_b32 v74, v86, v82, s21
    v_perm_b32 v75, v94, v90, s21
    v_perm_b32 v76, v87, v83, s20
    v_perm_b32 v77, v95, v91, s20
    v_perm_b32 v78, v87, v83, s21
    v_perm_b32 v79, v95, v91, s21
    s_waitcnt vmcnt(20)
    v_perm_b32 v80, v100, v96, s20
    v_perm_b32 v81, v108, v104, s20
    v_perm_b32 v82, v100, v96, s21
    v_perm_b32 v83, v108, v104, s21
    v_perm_b32 v84, v101, v97, s20
    v_perm_b32 v85, v109, v105, s20
    v_perm_b32 v86, v101, v97, s21
    v_perm_b32 v87, v109, v105, s21
    v_perm_b32 v88, v102, v98, s20
    v_perm_b32 v89, v110, v106, s20
    v_perm_b32 v90, v102, v98, s21
    v_perm_b32 v91, v110, v106, s21
    v_perm_b32 v92, v103, v99, s20
    v_perm_b32 v93, v111, v107, s20
    v_perm_b32 v94, v103, v99, s21
    v_perm_b32 v95, v111, v107, s21
    s_waitcnt vmcnt(16)
    v_perm_b32 v96, v116, v112, s20
    v_perm_b32 v97, v124, v120, s20
    v_perm_b32 v98, v116, v112, s21
    v_perm_b32 v99, v124, v120, s21
    v_perm_b32 v100, v117, v113, s20
    v_perm_b32 v101, v125, v121, s20
    v_perm_b32 v102, v117, v113, s21
    v_perm_b32 v103, v125, v121, s21
    v_perm_b32 v104, v118, v114, s20
    v_perm_b32 v105, v126, v122, s20
    v_perm_b32 v106, v118, v114, s21
    v_perm_b32 v107, v126, v122, s21
    v_perm_b32 v108, v119, v115, s20
    v_perm_b32 v109, v127, v123, s20
    v_perm_b32 v110, v119, v115, s21
    v_perm_b32 v111, v127, v123, s21
    s_waitcnt vmcnt(12)
    v_perm_b32 v112, v132, v128, s20
    v_perm_b32 v113, v140, v136, s20
    v_perm_b32 v114, v132, v128, s21
    v_perm_b32 v115, v140, v136, s21
    v_perm_b32 v116, v133, v129, s20
    v_perm_b32 v117, v141, v137, s20
    v_perm_b32 v118, v133, v129, s21
    v_perm_b32 v119, v141, v137, s21
    v_perm_b32 v120, v134, v130, s20
    v_perm_b32 v121, v142, v138, s20
    v_perm_b32 v122, v134, v130, s21
    v_perm_b32 v123, v142, v138, s21
    v_perm_b32 v124, v135, v131, s20
    v_perm_b32 v125, v143, v139, s20
    v_perm_b32 v126, v135, v131, s21
    v_perm_b32 v127, v143, v139, s21
    s_waitcnt vmcnt(8)
    v_perm_b32 v128, v148, v144, s20
    v_perm_b32 v129, v156, v152, s20
    v_perm_b32 v130, v148, v144, s21
    v_perm_b32 v131, v156, v152, s21
    v_perm_b32 v132, v149, v145, s20
    v_perm_b32 v133, v157, v153, s20
    v_perm_b32 v134, v149, v145, s21
    v_perm_b32 v135, v157, v153, s21
    v_perm_b32 v136, v150, v146, s20
    v_perm_b32 v137, v158, v154, s20
    v_perm_b32 v138, v150, v146, s21
    v_perm_b32 v139, v158, v154, s21
    v_perm_b32 v140, v151, v147, s20
    v_perm_b32 v141, v159, v155, s20
    v_perm_b32 v142, v151, v147, s21
    v_perm_b32 v143, v159, v155, s21
    s_waitcnt vmcnt(4)
    v_perm_b32 v144, v164, v160, s20
    v_perm_b32 v145, v172, v168, s20
    v_perm_b32 v146, v164, v160, s21
    v_perm_b32 v147, v172, v168, s21
    v_perm_b32 v148, v165, v161, s20
    v_perm_b32 v149, v173, v169, s20
    v_perm_b32 v150, v165, v161, s21
    v_perm_b32 v151, v173, v169, s21
    v_perm_b32 v152, v166, v162, s20
    v_perm_b32 v153, v174, v170, s20
    v_perm_b32 v154, v166, v162, s21
    v_perm_b32 v155, v174, v170, s21
    v_perm_b32 v156, v167, v163, s20
    v_perm_b32 v157, v175, v171, s20
    v_perm_b32 v158, v167, v163, s21
    v_perm_b32 v159, v175, v171, s21
    s_waitcnt vmcnt(0)
    v_perm_b32 v160, v180, v176, s20
    v_perm_b32 v161, v188, v184, s20
    v_perm_b32 v162, v180, v176, s21
    v_perm_b32 v163, v188, v184, s21
    v_perm_b32 v164, v181, v177, s20
    v_perm_b32 v165, v189, v185, s20
    v_perm_b32 v166, v181, v177, s21
    v_perm_b32 v167, v189, v185, s21
    v_perm_b32 v168, v182, v178, s20
    v_perm_b32 v169, v190, v186, s20
    v_perm_b32 v170, v182, v178, s21
    v_perm_b32 v171, v190, v186, s21
    v_perm_b32 v172, v183, v179, s20
    v_perm_b32 v173, v191, v187, s20
    v_perm_b32 v174, v183, v179, s21
    v_perm_b32 v175, v191, v187, s21
    s_mov_b32 exec_hi, -1
    s_cmp_lg_u32 s18, 3
    s_cbranch_scc1 L_wt3_ok
    v_mov_b32 v254, 161968

    s_mov_b32 s29, 200000
L_wt3:
    ds_read_b32 v255, v254
    s_waitcnt lgkmcnt(0)
    v_cmp_eq_u32 vcc, 4, v255
    s_cmp_eq_u64 vcc, exec
    s_cbranch_scc1 L_wt3_ok
    s_sleep 2
    s_sub_u32 s29, s29, 1
    s_cmp_lg_u32 s29, 0
    s_cbranch_scc1 L_wt3
L_wt3_ok:

    s_lshr_b32 s26, 0, s18
    s_and_b32 s26, s26, 1
    s_add_u32 s26, s26, s18
    s_lshl_b32 s26, s26, 3
    s_add_u32 s26, s26, 161852

    v_add_u32 v254, s26, v240

    s_mov_b32 s29, 200000
L_wslot:
    ds_read_b32 v255, v254
    s_waitcnt lgkmcnt(0)
    v_cmp_ne_u32 vcc, 0, v255
    s_cmp_eq_u64 vcc, exec
    s_cbranch_scc1 L_wslot_ok
    s_sleep 2
    s_sub_u32 s29, s29, 1
    s_cmp_lg_u32 s29, 0
    s_cbranch_scc1 L_wslot
L_wslot_ok:

    s_lshl_b32 s30, s18, 1
    s_lshr_b32 s30, 151118, s30
    s_and_b32 s30, s30, 3
    s_cmp_eq_u32 s30, 3
    s_mul_i32 s30, s30, 14336
    s_cselect_b32 s31, 72704, s30
    s_cselect_b32 s30, 124160, s30
    s_add_u32 s30, s30, 7168
    s_add_u32 s31, s31, 72832

    v_add_u32 v254, s30, v249
    v_add_u32 v255, s31, v249
    v_cndmask_b32 v254, v255, v254, s[58:59]
    s_mov_b32 exec_hi, 0x0000ffff

    ds_write_b64 v254, v[192:193] offset:0
    ds_write_b64 v254, v[194:195] offset:72
    ds_write_b64 v254, v[196:197] offset:144
    ds_write_b64 v254, v[198:199] offset:216
    ds_write_b64 v254, v[200:201] offset:288
    ds_write_b64 v254, v[202:203] offset:360
    ds_write_b64 v254, v[204:205] offset:432
    ds_write_b64 v254, v[206:207] offset:504
    ds_write_b64 v254, v[48:49] offset:8
    ds_write_b64 v254, v[50:51] offset:80
    ds_write_b64 v254, v[52:53] offset:152
    ds_write_b64 v254, v[54:55] offset:224
    ds_write_b64 v254, v[56:57] offset:296
    ds_write_b64 v254, v[58:59] offset:368
    ds_write_b64 v254, v[60:61] offset:440
    ds_write_b64 v254, v[62:63] offset:512
    ds_write_b64 v254, v[64:65] offset:16
    ds_write_b64 v254, v[66:67] offset:88
    ds_write_b64 v254, v[68:69] offset:160
    ds_write_b64 v254, v[70:71] offset:232
    ds_write_b64 v254, v[72:73] offset:304
    ds_write_b64 v254, v[74:75] offset:376
    ds_write_b64 v254, v[76:77] offset:448
    ds_write_b64 v254, v[78:79] offset:520
    ds_write_b64 v254, v[80:81] offset:24
    ds_write_b64 v254, v[82:83] offset:96
    ds_write_b64 v254, v[84:85] offset:168
    ds_write_b64 v254, v[86:87] offset:240
    ds_write_b64 v254, v[88:89] offset:312
    ds_write_b64 v254, v[90:91] offset:384
    ds_write_b64 v254, v[92:93] offset:456
    ds_write_b64 v254, v[94:95] offset:528
    ds_write_b64 v254, v[96:97] offset:32
    ds_write_b64 v254, v[98:99] offset:104
    ds_write_b64 v254, v[100:101] offset:176
    ds_write_b64 v254, v[102:103] offset:248
    ds_write_b64 v254, v[104:105] offset:320
    ds_write_b64 v254, v[106:107] offset:392
    ds_write_b64 v254, v[108:109] offset:464
    ds_write_b64 v254, v[110:111] offset:536
    ds_write_b64 v254, v[112:113] offset:40
    ds_write_b64 v254, v[114:115] offset:112
    ds_write_b64 v254, v[116:117] offset:184
    ds_write_b64 v254, v[118:119] offset:256
    ds_write_b64 v254, v[120:121] offset:328
    ds_write_b64 v254, v[122:123] offset:400
    ds_write_b64 v254, v[124:125] offset:472
    ds_write_b64 v254, v[126:127] offset:544
    ds_write_b64 v254, v[128:129] offset:48
    ds_write_b64 v254, v[130:131] offset:120
    ds_write_b64 v254, v[132:133] offset:192
    ds_write_b64 v254, v[134:135] offset:264
    ds_write_b64 v254, v[136:137] offset:336
    ds_write_b64 v254, v[138:139] offset:408
    ds_write_b64 v254, v[140:141] offset:480
    ds_write_b64 v254, v[142:143] offset:552
    ds_write_b64 v254, v[144:145] offset:56
    ds_write_b64 v254, v[146:147] offset:128
    ds_write_b64 v254, v[148:149] offset:200
    ds_write_b64 v254, v[150:151] offset:272
    ds_write_b64 v254, v[152:153] offset:344
    ds_write_b64 v254, v[154:155] offset:416
    ds_write_b64 v254, v[156:157] offset:488
    ds_write_b64 v254, v[158:159] offset:560
    ds_write_b64 v254, v[160:161] offset:64
    ds_write_b64 v254, v[162:163] offset:136
    ds_write_b64 v254, v[164:165] offset:208
    ds_write_b64 v254, v[166:167] offset:280
    ds_write_b64 v254, v[168:169] offset:352
    ds_write_b64 v254, v[170:171] offset:424
    ds_write_b64 v254, v[172:173] offset:496
    ds_write_b64 v254, v[174:175] offset:568

    s_mov_b32 exec_hi, -1
    s_lshl_b32 s26, s18, 2
    s_add_u32 s26, s26, 161808
    v_mov_b32 v254, s26
    v_mov_b32 v255, 1
    s_waitcnt lgkmcnt(0)
    ds_write_b32 v254, v255
    s_cmp_eq_u32 s18, 8
    s_cbranch_scc1 L_loader

    s_setprio 2
L_hp1:
    s_add_u32 s27, s18, 1

    s_lshl_b32 s32, s27, 1
    s_lshr_b32 s32, 151118, s32
    s_and_b32 s32, s32, 3
    s_cmp_eq_u32 s32, 3
    s_mul_i32 s32, s32, 14336
    s_cselect_b32 s33, 72704, s32
    s_cselect_b32 s32, 124160, s32
    s_add_u32 s32, s32, 7168
    s_add_u32 s33, s33, 72832

    v_add_u32 v232, s30, v250
    v_add_u32 v233, s31, v250
    v_add_u32 v234, s32, v250
    v_add_u32 v235, s33, v250
    v_cndmask_b32 v244, v232, v233, s[56:57]
    v_cndmask_b32 v245, v233, v234, s[56:57]
    v_cndmask_b32 v246, v234, v235, s[56:57]
    v_mov_b32 v254, 161968

    s_mov_b32 s29, 200000
L_wt:
    ds_read_b32 v255, v254
    s_waitcnt lgkmcnt(0)
    v_cmp_eq_u32 vcc, 4, v255
    s_cmp_eq_u64 vcc, exec
    s_cbranch_scc1 L_wt_ok
    s_sleep 2
    s_sub_u32 s29, s29, 1
    s_cmp_lg_u32 s29, 0
    s_cbranch_scc1 L_wt
L_wt_ok:

    ds_read_b128 v[192:195], v241 offset:0
    ds_read_b64 v[212:213], v244 offset:0
    ds_read_b64 v[214:215], v244 offset:8
    ds_read_b128 v[196:199], v241 offset:320
    ds_read_b64 v[216:217], v244 offset:72
    ds_read_b64 v[218:219], v244 offset:80
    ds_read_b128 v[200:203], v241 offset:640
    ds_read_b64 v[220:221], v244 offset:144
    ds_read_b64 v[222:223], v244 offset:152
    ds_read_b128 v[204:207], v241 offset:960
    ds_read_b64 v[224:225], v244 offset:216
    ds_read_b64 v[226:227], v244 offset:224
    ds_read_b128 v[208:211], v241 offset:1280
    ds_read_b64 v[228:229], v244 offset:288
    ds_read_b64 v[230:231], v244 offset:296
    s_waitcnt lgkmcnt(9)
    v_mfma_f32_16x16x32_bf16 v[0:3], v[192:195], v[212:215], 0
    ds_read_b128 v[192:195], v241 offset:1600
    ds_read_b64 v[212:213], v244 offset:360
    ds_read_b64 v[214:215], v244 offset:368
    v_mfma_f32_16x16x32_bf16 v[4:7], v[196:199], v[216:219], 0
    ds_read_b128 v[196:199], v241 offset:1920
    ds_read_b64 v[216:217], v244 offset:432
    ds_read_b64 v[218:219], v244 offset:440
    s_waitcnt lgkmcnt(9)
    v_mfma_f32_16x16x32_bf16 v[8:11], v[200:203], v[220:223], 0
    ds_read_b128 v[200:203], v241 offset:2240
    ds_read_b64 v[220:221], v244 offset:504
    ds_read_b64 v[222:223], v244 offset:512
    v_mfma_f32_16x16x32_bf16 v[12:15], v[204:207], v[224:227], 0
    ds_read_b128 v[204:207], v241 offset:2560
    ds_read_b64 v[224:225], v244 offset:584
    ds_read_b64 v[226:227], v244 offset:592
    s_waitcnt lgkmcnt(9)
    v_mfma_f32_16x16x32_bf16 v[16:19], v[208:211], v[228:231], 0
    ds_read_b128 v[208:211], v241 offset:2880
    ds_read_b64 v[228:229], v244 offset:656
    ds_read_b64 v[230:231], v244 offset:664
    v_mfma_f32_16x16x32_bf16 v[20:23], v[192:195], v[212:215], 0
    ds_read_b128 v[192:195], v241 offset:3200
    ds_read_b64 v[212:213], v244 offset:728
    ds_read_b64 v[214:215], v244 offset:736
    s_waitcnt lgkmcnt(9)
    v_mfma_f32_16x16x32_bf16 v[24:27], v[196:199], v[216:219], 0
    ds_read_b128 v[196:199], v241 offset:3520
    ds_read_b64 v[216:217], v244 offset:800
    ds_read_b64 v[218:219], v244 offset:808
    v_mfma_f32_16x16x32_bf16 v[28:31], v[200:203], v[220:223], 0
    ds_read_b128 v[200:203], v241 offset:3840
    ds_read_b64 v[220:221], v244 offset:872
    ds_read_b64 v[222:223], v244 offset:880
    s_waitcnt lgkmcnt(9)
    v_mfma_f32_16x16x32_bf16 v[32:35], v[204:207], v[224:227], 0
    ds_read_b128 v[204:207], v241 offset:4160
    ds_read_b64 v[224:225], v244 offset:944
    ds_read_b64 v[226:227], v244 offset:952
    v_mfma_f32_16x16x32_bf16 v[36:39], v[208:211], v[228:231], 0
    ds_read_b128 v[208:211], v241 offset:4480
    ds_read_b64 v[228:229], v244 offset:1016
    ds_read_b64 v[230:231], v244 offset:1024
    s_waitcnt lgkmcnt(9)
    v_mfma_f32_16x16x32_bf16 v[40:43], v[192:195], v[212:215], 0
    ds_read_b128 v[192:195], v241 offset:4800
    ds_read_b64 v[212:213], v244 offset:1088
    ds_read_b64 v[214:215], v244 offset:1096
    v_mfma_f32_16x16x32_bf16 v[44:47], v[196:199], v[216:219], 0
    ds_read_b128 v[196:199], v241 offset:5120
    ds_read_b64 v[216:217], v244 offset:2336
    ds_read_b64 v[218:219], v244 offset:2344
    s_waitcnt lgkmcnt(9)
    v_mfma_f32_16x16x32_bf16 v[48:51], v[200:203], v[220:223], 0
    ds_read_b128 v[200:203], v241 offset:5440
    ds_read_b64 v[220:221], v244 offset:2408
    ds_read_b64 v[222:223], v244 offset:2416
    v_mfma_f32_16x16x32_bf16 v[52:55], v[204:207], v[224:227], 0
    ds_read_b128 v[204:207], v241 offset:5760
    ds_read_b64 v[224:225], v244 offset:2480
    ds_read_b64 v[226:227], v244 offset:2488
    s_waitcnt lgkmcnt(9)
    v_mfma_f32_16x16x32_bf16 v[56:59], v[208:211], v[228:231], 0
    ds_read_b128 v[208:211], v241 offset:6080
    ds_read_b64 v[228:229], v244 offset:2552
    ds_read_b64 v[230:231], v244 offset:2560
    v_mfma_f32_16x16x32_bf16 v[60:63], v[192:195], v[212:215], 0
    ds_read_b128 v[192:195], v241 offset:6400
    ds_read_b64 v[212:213], v244 offset:2624
    ds_read_b64 v[214:215], v244 offset:2632
    s_waitcnt lgkmcnt(9)
    v_mfma_f32_16x16x32_bf16 v[64:67], v[196:199], v[216:219], 0
    ds_read_b128 v[196:199], v241 offset:6720
    ds_read_b64 v[216:217], v244 offset:2696
    ds_read_b64 v[218:219], v244 offset:2704
    v_mfma_f32_16x16x32_bf16 v[68:71], v[200:203], v[220:223], 0
    ds_read_b128 v[200:203], v241 offset:7040
    ds_read_b64 v[220:221], v244 offset:2768
    ds_read_b64 v[222:223], v244 offset:2776
    s_waitcnt lgkmcnt(9)
    v_mfma_f32_16x16x32_bf16 v[72:75], v[204:207], v[224:227], 0
    ds_read_b128 v[204:207], v241 offset:7360
    ds_read_b64 v[224:225], v244 offset:2840
    ds_read_b64 v[226:227], v244 offset:2848
    v_mfma_f32_16x16x32_bf16 v[76:79], v[208:211], v[228:231], 0
    ds_read_b128 v[208:211], v241 offset:7680
    ds_read_b64 v[228:229], v244 offset:2920
    ds_read_b64 v[230:231], v244 offset:2928
    s_waitcnt lgkmcnt(9)
    v_mfma_f32_16x16x32_bf16 v[80:83], v[192:195], v[212:215], 0
    ds_read_b128 v[192:195], v241 offset:8000
    ds_read_b64 v[212:213], v244 offset:2992
    ds_read_b64 v[214:215], v244 offset:3000
    v_mfma_f32_16x16x32_bf16 v[84:87], v[196:199], v[216:219], 0
    ds_read_b128 v[196:199], v241 offset:8320
    ds_read_b64 v[216:217], v244 offset:3064
    ds_read_b64 v[218:219], v244 offset:3072
    s_waitcnt lgkmcnt(9)
    v_mfma_f32_16x16x32_bf16 v[88:91], v[200:203], v[220:223], 0
    ds_read_b128 v[200:203], v241 offset:8640
    ds_read_b64 v[220:221], v244 offset:3136
    ds_read_b64 v[222:223], v244 offset:3144
    v_mfma_f32_16x16x32_bf16 v[92:95], v[204:207], v[224:227], 0
    ds_read_b128 v[204:207], v241 offset:8960
    ds_read_b64 v[224:225], v244 offset:3208
    ds_read_b64 v[226:227], v244 offset:3216
    s_waitcnt lgkmcnt(9)
    v_mfma_f32_16x16x32_bf16 v[96:99], v[208:211], v[228:231], 0
    ds_read_b128 v[208:211], v241 offset:9280
    ds_read_b64 v[228:229], v244 offset:3280
    ds_read_b64 v[230:231], v244 offset:3288
    v_mfma_f32_16x16x32_bf16 v[100:103], v[192:195], v[212:215], 0
    ds_read_b128 v[192:195], v241 offset:9600
    ds_read_b64 v[212:213], v244 offset:3352
    ds_read_b64 v[214:215], v244 offset:3360
    s_waitcnt lgkmcnt(9)
    v_mfma_f32_16x16x32_bf16 v[104:107], v[196:199], v[216:219], 0
    ds_read_b128 v[196:199], v241 offset:9920
    ds_read_b64 v[216:217], v244 offset:3424
    ds_read_b64 v[218:219], v244 offset:3432
    v_mfma_f32_16x16x32_bf16 v[108:111], v[200:203], v[220:223], 0
    ds_read_b128 v[200:203], v241 offset:10240
    ds_read_b64 v[220:221], v244 offset:4672
    ds_read_b64 v[222:223], v244 offset:4680
    s_waitcnt lgkmcnt(9)
    v_mfma_f32_16x16x32_bf16 v[112:115], v[204:207], v[224:227], 0
    ds_read_b128 v[204:207], v241 offset:10560
    ds_read_b64 v[224:225], v244 offset:4744
    ds_read_b64 v[226:227], v244 offset:4752
    v_mfma_f32_16x16x32_bf16 v[116:119], v[208:211], v[228:231], 0
    ds_read_b128 v[208:211], v241 offset:10880
    ds_read_b64 v[228:229], v244 offset:4816
    ds_read_b64 v[230:231], v244 offset:4824
    s_waitcnt lgkmcnt(9)
    v_mfma_f32_16x16x32_bf16 v[120:123], v[192:195], v[212:215], 0
    ds_read_b128 v[192:195], v241 offset:11200
    ds_read_b64 v[212:213], v244 offset:4888
    ds_read_b64 v[214:215], v244 offset:4896
    v_mfma_f32_16x16x32_bf16 v[124:127], v[196:199], v[216:219], 0
    ds_read_b128 v[196:199], v241 offset:11520
    ds_read_b64 v[216:217], v244 offset:4960
    ds_read_b64 v[218:219], v244 offset:4968
    s_waitcnt lgkmcnt(9)
    v_mfma_f32_16x16x32_bf16 v[128:131], v[200:203], v[220:223], 0
    ds_read_b128 v[200:203], v241 offset:11840
    ds_read_b64 v[220:221], v244 offset:5032
    ds_read_b64 v[222:223], v244 offset:5040
    v_mfma_f32_16x16x32_bf16 v[132:135], v[204:207], v[224:227], 0
    ds_read_b128 v[204:207], v241 offset:12160
    ds_read_b64 v[224:225], v244 offset:5104
    ds_read_b64 v[226:227], v244 offset:5112
    s_waitcnt lgkmcnt(9)
    v_mfma_f32_16x16x32_bf16 v[136:139], v[208:211], v[228:231], 0
    ds_read_b128 v[208:211], v241 offset:12480
    ds_read_b64 v[228:229], v244 offset:5176
    ds_read_b64 v[230:231], v244 offset:5184
    v_mfma_f32_16x16x32_bf16 v[140:143], v[192:195], v[212:215], 0
    ds_read_b128 v[192:195], v241 offset:12800
    ds_read_b64 v[212:213], v244 offset:5256
    ds_read_b64 v[214:215], v244 offset:5264
    s_waitcnt lgkmcnt(9)
    v_mfma_f32_16x16x32_bf16 v[144:147], v[196:199], v[216:219], 0
    ds_read_b128 v[196:199], v241 offset:13120
    ds_read_b64 v[216:217], v244 offset:5328
    ds_read_b64 v[218:219], v244 offset:5336
    v_mfma_f32_16x16x32_bf16 v[148:151], v[200:203], v[220:223], 0
    ds_read_b128 v[200:203], v241 offset:13440
    ds_read_b64 v[220:221], v244 offset:5400
    ds_read_b64 v[222:223], v244 offset:5408
    s_waitcnt lgkmcnt(9)
    v_mfma_f32_16x16x32_bf16 v[152:155], v[204:207], v[224:227], 0
    ds_read_b128 v[204:207], v241 offset:13760
    ds_read_b64 v[224:225], v244 offset:5472
    ds_read_b64 v[226:227], v244 offset:5480
    v_mfma_f32_16x16x32_bf16 v[156:159], v[208:211], v[228:231], 0
    ds_read_b128 v[208:211], v241 offset:14080
    ds_read_b64 v[228:229], v244 offset:5544
    ds_read_b64 v[230:231], v244 offset:5552
    s_waitcnt lgkmcnt(9)
    v_mfma_f32_16x16x32_bf16 v[160:163], v[192:195], v[212:215], 0
    ds_read_b128 v[192:195], v241 offset:14400
    ds_read_b64 v[212:213], v244 offset:5616
    ds_read_b64 v[214:215], v244 offset:5624
    v_mfma_f32_16x16x32_bf16 v[164:167], v[196:199], v[216:219], 0
    ds_read_b128 v[196:199], v241 offset:14720
    ds_read_b64 v[216:217], v244 offset:5688
    ds_read_b64 v[218:219], v244 offset:5696
    s_waitcnt lgkmcnt(9)
    v_mfma_f32_16x16x32_bf16 v[168:171], v[200:203], v[220:223], 0
    ds_read_b128 v[200:203], v241 offset:15040
    ds_read_b64 v[220:221], v244 offset:5760
    ds_read_b64 v[222:223], v244 offset:5768
    v_mfma_f32_16x16x32_bf16 v[172:175], v[204:207], v[224:227], 0
    v_add_u32 v254, s26, v240

    s_mov_b32 s29, 200000
L_wrdy:
    ds_read_b32 v255, v254
    s_waitcnt lgkmcnt(0)
    v_cmp_ne_u32 vcc, 0, v255
    s_cmp_eq_u64 vcc, exec
    s_cbranch_scc1 L_wrdy_ok
    s_sleep 2
    s_sub_u32 s29, s29, 1
    s_cmp_lg_u32 s29, 0
    s_cbranch_scc1 L_wrdy
L_wrdy_ok:

    s_lshl_b32 s26, s16, 3
    s_add_u32 s26, s26, 161888
    v_mov_b32 v254, s26
    v_mov_b32 v255, 1

    ds_read_b128 v[204:207], v242 offset:0
    ds_read_b64 v[224:225], v245 offset:0
    ds_read_b64 v[226:227], v245 offset:8
    s_waitcnt lgkmcnt(9)
    v_mfma_f32_16x16x32_bf16 v[176:179], v[208:211], v[228:231], 0
    ds_read_b128 v[208:211], v242 offset:320
    ds_read_b64 v[228:229], v245 offset:72
    ds_read_b64 v[230:231], v245 offset:80
    v_mfma_f32_16x16x32_bf16 v[180:183], v[192:195], v[212:215], 0
    ds_read_b128 v[192:195], v242 offset:640
    ds_read_b64 v[212:213], v245 offset:144
    ds_read_b64 v[214:215], v245 offset:152
    s_waitcnt lgkmcnt(9)
    v_mfma_f32_16x16x32_bf16 v[184:187], v[196:199], v[216:219], 0
    ds_read_b128 v[196:199], v242 offset:960
    ds_read_b64 v[216:217], v245 offset:216
    ds_read_b64 v[218:219], v245 offset:224
    v_mfma_f32_16x16x32_bf16 v[188:191], v[200:203], v[220:223], 0
    ds_read_b128 v[200:203], v242 offset:1280
    ds_read_b64 v[220:221], v245 offset:288
    ds_read_b64 v[222:223], v245 offset:296
    s_waitcnt lgkmcnt(9)
    v_mfma_f32_16x16x32_bf16 v[0:3], v[204:207], v[224:227], v[0:3]
    ds_read_b128 v[204:207], v242 offset:1600
    ds_read_b64 v[224:225], v245 offset:360
    ds_read_b64 v[226:227], v245 offset:368
    v_mfma_f32_16x16x32_bf16 v[4:7], v[208:211], v[228:231], v[4:7]
    ds_read_b128 v[208:211], v242 offset:1920
    ds_read_b64 v[228:229], v245 offset:432
    ds_read_b64 v[230:231], v245 offset:440
    s_waitcnt lgkmcnt(9)
    v_mfma_f32_16x16x32_bf16 v[8:11], v[192:195], v[212:215], v[8:11]
    ds_read_b128 v[192:195], v242 offset:2240
    ds_read_b64 v[212:213], v245 offset:504
    ds_read_b64 v[214:215], v245 offset:512
    v_mfma_f32_16x16x32_bf16 v[12:15], v[196:199], v[216:219], v[12:15]
    ds_read_b128 v[196:199], v242 offset:2560
    ds_read_b64 v[216:217], v245 offset:584
    ds_read_b64 v[218:219], v245 offset:592
    s_waitcnt lgkmcnt(9)
    v_mfma_f32_16x16x32_bf16 v[16:19], v[200:203], v[220:223], v[16:19]
    ds_read_b128 v[200:203], v242 offset:2880
    ds_read_b64 v[220:221], v245 offset:656
    ds_read_b64 v[222:223], v245 offset:664
    v_mfma_f32_16x16x32_bf16 v[20:23], v[204:207], v[224:227], v[20:23]
    ds_read_b128 v[204:207], v242 offset:3200
    ds_read_b64 v[224:225], v245 offset:728
    ds_read_b64 v[226:227], v245 offset:736
    s_waitcnt lgkmcnt(9)
    v_mfma_f32_16x16x32_bf16 v[24:27], v[208:211], v[228:231], v[24:27]
    ds_read_b128 v[208:211], v242 offset:3520
    ds_read_b64 v[228:229], v245 offset:800
    ds_read_b64 v[230:231], v245 offset:808
    v_mfma_f32_16x16x32_bf16 v[28:31], v[192:195], v[212:215], v[28:31]
    ds_read_b128 v[192:195], v242 offset:3840
    ds_read_b64 v[212:213], v245 offset:872
    ds_read_b64 v[214:215], v245 offset:880
    s_waitcnt lgkmcnt(9)
    v_mfma_f32_16x16x32_bf16 v[32:35], v[196:199], v[216:219], v[32:35]
    ds_read_b128 v[196:199], v242 offset:4160
    ds_read_b64 v[216:217], v245 offset:944
    ds_read_b64 v[218:219], v245 offset:952
    v_mfma_f32_16x16x32_bf16 v[36:39], v[200:203], v[220:223], v[36:39]
    ds_read_b128 v[200:203], v242 offset:4480
    ds_read_b64 v[220:221], v245 offset:1016
    ds_read_b64 v[222:223], v245 offset:1024
    s_waitcnt lgkmcnt(9)
    v_mfma_f32_16x16x32_bf16 v[40:43], v[204:207], v[224:227], v[40:43]
    ds_read_b128 v[204:207], v242 offset:4800
    ds_read_b64 v[224:225], v245 offset:1088
    ds_read_b64 v[226:227], v245 offset:1096
    v_mfma_f32_16x16x32_bf16 v[44:47], v[208:211], v[228:231], v[44:47]
    ds_read_b128 v[208:211], v242 offset:5120
    ds_read_b64 v[228:229], v245 offset:2336
    ds_read_b64 v[230:231], v245 offset:2344
    s_waitcnt lgkmcnt(9)
    v_mfma_f32_16x16x32_bf16 v[48:51], v[192:195], v[212:215], v[48:51]
    ds_read_b128 v[192:195], v242 offset:5440
    ds_read_b64 v[212:213], v245 offset:2408
    ds_read_b64 v[214:215], v245 offset:2416
    v_mfma_f32_16x16x32_bf16 v[52:55], v[196:199], v[216:219], v[52:55]
    ds_read_b128 v[196:199], v242 offset:5760
    ds_read_b64 v[216:217], v245 offset:2480
    ds_read_b64 v[218:219], v245 offset:2488
    s_waitcnt lgkmcnt(9)
    v_mfma_f32_16x16x32_bf16 v[56:59], v[200:203], v[220:223], v[56:59]
    ds_read_b128 v[200:203], v242 offset:6080
    ds_read_b64 v[220:221], v245 offset:2552
    ds_read_b64 v[222:223], v245 offset:2560
    v_mfma_f32_16x16x32_bf16 v[60:63], v[204:207], v[224:227], v[60:63]
    ds_read_b128 v[204:207], v242 offset:6400
    ds_read_b64 v[224:225], v245 offset:2624
    ds_read_b64 v[226:227], v245 offset:2632
    s_waitcnt lgkmcnt(9)
    v_mfma_f32_16x16x32_bf16 v[64:67], v[208:211], v[228:231], v[64:67]
    ds_read_b128 v[208:211], v242 offset:6720
    ds_read_b64 v[228:229], v245 offset:2696
    ds_read_b64 v[230:231], v245 offset:2704
    v_mfma_f32_16x16x32_bf16 v[68:71], v[192:195], v[212:215], v[68:71]
    ds_read_b128 v[192:195], v242 offset:7040
    ds_read_b64 v[212:213], v245 offset:2768
    ds_read_b64 v[214:215], v245 offset:2776
    s_waitcnt lgkmcnt(9)
    v_mfma_f32_16x16x32_bf16 v[72:75], v[196:199], v[216:219], v[72:75]
    ds_read_b128 v[196:199], v242 offset:7360
    ds_read_b64 v[216:217], v245 offset:2840
    ds_read_b64 v[218:219], v245 offset:2848
    v_mfma_f32_16x16x32_bf16 v[76:79], v[200:203], v[220:223], v[76:79]
    ds_read_b128 v[200:203], v242 offset:7680
    ds_read_b64 v[220:221], v245 offset:2920
    ds_read_b64 v[222:223], v245 offset:2928
    s_waitcnt lgkmcnt(9)
    v_mfma_f32_16x16x32_bf16 v[80:83], v[204:207], v[224:227], v[80:83]
    ds_read_b128 v[204:207], v242 offset:8000
    ds_read_b64 v[224:225], v245 offset:2992
    ds_read_b64 v[226:227], v245 offset:3000
    v_mfma_f32_16x16x32_bf16 v[84:87], v[208:211], v[228:231], v[84:87]
    ds_read_b128 v[208:211], v242 offset:8320
    ds_read_b64 v[228:229], v245 offset:3064
    ds_read_b64 v[230:231], v245 offset:3072
    s_waitcnt lgkmcnt(9)
    v_mfma_f32_16x16x32_bf16 v[88:91], v[192:195], v[212:215], v[88:91]
    ds_read_b128 v[192:195], v242 offset:8640
    ds_read_b64 v[212:213], v245 offset:3136
    ds_read_b64 v[214:215], v245 offset:3144
    v_mfma_f32_16x16x32_bf16 v[92:95], v[196:199], v[216:219], v[92:95]
    ds_read_b128 v[196:199], v242 offset:8960
    ds_read_b64 v[216:217], v245 offset:3208
    ds_read_b64 v[218:219], v245 offset:3216
    s_waitcnt lgkmcnt(9)
    v_mfma_f32_16x16x32_bf16 v[96:99], v[200:203], v[220:223], v[96:99]
    ds_read_b128 v[200:203], v242 offset:9280
    ds_read_b64 v[220:221], v245 offset:3280
    ds_read_b64 v[222:223], v245 offset:3288
    v_mfma_f32_16x16x32_bf16 v[100:103], v[204:207], v[224:227], v[100:103]
    ds_read_b128 v[204:207], v242 offset:9600
    ds_read_b64 v[224:225], v245 offset:3352
    ds_read_b64 v[226:227], v245 offset:3360
    s_waitcnt lgkmcnt(9)
    v_mfma_f32_16x16x32_bf16 v[104:107], v[208:211], v[228:231], v[104:107]
    ds_read_b128 v[208:211], v242 offset:9920
    ds_read_b64 v[228:229], v245 offset:3424
    ds_read_b64 v[230:231], v245 offset:3432
    v_mfma_f32_16x16x32_bf16 v[108:111], v[192:195], v[212:215], v[108:111]
    ds_read_b128 v[192:195], v242 offset:10240
    ds_read_b64 v[212:213], v245 offset:4672
    ds_read_b64 v[214:215], v245 offset:4680
    s_waitcnt lgkmcnt(9)
    v_mfma_f32_16x16x32_bf16 v[112:115], v[196:199], v[216:219], v[112:115]
    ds_read_b128 v[196:199], v242 offset:10560
    ds_read_b64 v[216:217], v245 offset:4744
    ds_read_b64 v[218:219], v245 offset:4752
    v_mfma_f32_16x16x32_bf16 v[116:119], v[200:203], v[220:223], v[116:119]
    ds_read_b128 v[200:203], v242 offset:10880
    ds_read_b64 v[220:221], v245 offset:4816
    ds_read_b64 v[222:223], v245 offset:4824
    s_waitcnt lgkmcnt(9)
    v_mfma_f32_16x16x32_bf16 v[120:123], v[204:207], v[224:227], v[120:123]
    ds_read_b128 v[204:207], v242 offset:11200
    ds_read_b64 v[224:225], v245 offset:4888
    ds_read_b64 v[226:227], v245 offset:4896
    v_mfma_f32_16x16x32_bf16 v[124:127], v[208:211], v[228:231], v[124:127]
    ds_read_b128 v[208:211], v242 offset:11520
    ds_read_b64 v[228:229], v245 offset:4960
    ds_read_b64 v[230:231], v245 offset:4968
    s_waitcnt lgkmcnt(9)
    v_mfma_f32_16x16x32_bf16 v[128:131], v[192:195], v[212:215], v[128:131]
    ds_read_b128 v[192:195], v242 offset:11840
    ds_read_b64 v[212:213], v245 offset:5032
    ds_read_b64 v[214:215], v245 offset:5040
    v_mfma_f32_16x16x32_bf16 v[132:135], v[196:199], v[216:219], v[132:135]
    ds_read_b128 v[196:199], v242 offset:12160
    ds_read_b64 v[216:217], v245 offset:5104
    ds_read_b64 v[218:219], v245 offset:5112
    s_waitcnt lgkmcnt(9)
    v_mfma_f32_16x16x32_bf16 v[136:139], v[200:203], v[220:223], v[136:139]
    ds_read_b128 v[200:203], v242 offset:12480
    ds_read_b64 v[220:221], v245 offset:5176
    ds_read_b64 v[222:223], v245 offset:5184
    v_mfma_f32_16x16x32_bf16 v[140:143], v[204:207], v[224:227], v[140:143]
    ds_read_b128 v[204:207], v242 offset:12800
    ds_read_b64 v[224:225], v245 offset:5256
    ds_read_b64 v[226:227], v245 offset:5264
    s_waitcnt lgkmcnt(9)
    v_mfma_f32_16x16x32_bf16 v[144:147], v[208:211], v[228:231], v[144:147]
    ds_read_b128 v[208:211], v242 offset:13120
    ds_read_b64 v[228:229], v245 offset:5328
    ds_read_b64 v[230:231], v245 offset:5336
    v_mfma_f32_16x16x32_bf16 v[148:151], v[192:195], v[212:215], v[148:151]
    ds_read_b128 v[192:195], v242 offset:13440
    ds_read_b64 v[212:213], v245 offset:5400
    ds_read_b64 v[214:215], v245 offset:5408
    s_waitcnt lgkmcnt(9)
    v_mfma_f32_16x16x32_bf16 v[152:155], v[196:199], v[216:219], v[152:155]
    ds_read_b128 v[196:199], v242 offset:13760
    ds_read_b64 v[216:217], v245 offset:5472
    ds_read_b64 v[218:219], v245 offset:5480
    v_mfma_f32_16x16x32_bf16 v[156:159], v[200:203], v[220:223], v[156:159]
    ds_read_b128 v[200:203], v242 offset:14080
    ds_read_b64 v[220:221], v245 offset:5544
    ds_read_b64 v[222:223], v245 offset:5552
    s_waitcnt lgkmcnt(9)
    v_mfma_f32_16x16x32_bf16 v[160:163], v[204:207], v[224:227], v[160:163]
    ds_read_b128 v[204:207], v242 offset:14400
    ds_read_b64 v[224:225], v245 offset:5616
    ds_read_b64 v[226:227], v245 offset:5624
    v_mfma_f32_16x16x32_bf16 v[164:167], v[208:211], v[228:231], v[164:167]
    ds_read_b128 v[208:211], v242 offset:14720
    ds_read_b64 v[228:229], v245 offset:5688
    ds_read_b64 v[230:231], v245 offset:5696
    s_waitcnt lgkmcnt(9)
    v_mfma_f32_16x16x32_bf16 v[168:171], v[192:195], v[212:215], v[168:171]
    ds_read_b128 v[192:195], v242 offset:15040
    ds_read_b64 v[212:213], v245 offset:5760
    ds_read_b64 v[214:215], v245 offset:5768
    v_mfma_f32_16x16x32_bf16 v[172:175], v[196:199], v[216:219], v[172:175]
    ds_read_b128 v[196:199], v243 offset:0
    ds_read_b64 v[216:217], v246 offset:0
    ds_read_b64 v[218:219], v246 offset:8
    s_waitcnt lgkmcnt(9)
    v_mfma_f32_16x16x32_bf16 v[176:179], v[200:203], v[220:223], v[176:179]
    ds_read_b128 v[200:203], v243 offset:320
    ds_read_b64 v[220:221], v246 offset:72
    ds_read_b64 v[222:223], v246 offset:80
    v_mfma_f32_16x16x32_bf16 v[180:183], v[204:207], v[224:227], v[180:183]
    ds_read_b128 v[204:207], v243 offset:640
    ds_read_b64 v[224:225], v246 offset:144
    ds_read_b64 v[226:227], v246 offset:152
    s_waitcnt lgkmcnt(9)
    v_mfma_f32_16x16x32_bf16 v[184:187], v[208:211], v[228:231], v[184:187]
    ds_read_b128 v[208:211], v243 offset:960
    ds_read_b64 v[228:229], v246 offset:216
    ds_read_b64 v[230:231], v246 offset:224
    v_mfma_f32_16x16x32_bf16 v[188:191], v[192:195], v[212:215], v[188:191]
    ds_read_b128 v[192:195], v243 offset:1280
    ds_read_b64 v[212:213], v246 offset:288
    ds_read_b64 v[214:215], v246 offset:296
    s_waitcnt lgkmcnt(9)
    ds_write_b32 v254, v255
    v_mfma_f32_16x16x32_bf16 v[0:3], v[196:199], v[216:219], v[0:3]
    ds_read_b128 v[196:199], v243 offset:1600
    ds_read_b64 v[216:217], v246 offset:360
    ds_read_b64 v[218:219], v246 offset:368
    v_mfma_f32_16x16x32_bf16 v[4:7], v[200:203], v[220:223], v[4:7]
    s_waitcnt lgkmcnt(12)
    ds_read_b128 v[200:203], v243 offset:1920
    ds_read_b64 v[220:221], v246 offset:432
    ds_read_b64 v[222:223], v246 offset:440
    s_waitcnt lgkmcnt(9)
    v_mfma_f32_16x16x32_bf16 v[8:11], v[204:207], v[224:227], v[8:11]
    ds_read_b128 v[204:207], v243 offset:2240
    ds_read_b64 v[224:225], v246 offset:504
    ds_read_b64 v[226:227], v246 offset:512
    v_mfma_f32_16x16x32_bf16 v[12:15], v[208:211], v[228:231], v[12:15]
    ds_read_b128 v[208:211], v243 offset:2560
    ds_read_b64 v[228:229], v246 offset:584
    ds_read_b64 v[230:231], v246 offset:592
    s_waitcnt lgkmcnt(9)
    v_mfma_f32_16x16x32_bf16 v[16:19], v[192:195], v[212:215], v[16:19]
    ds_read_b128 v[192:195], v243 offset:2880
    ds_read_b64 v[212:213], v246 offset:656
    ds_read_b64 v[214:215], v246 offset:664
    v_mfma_f32_16x16x32_bf16 v[20:23], v[196:199], v[216:219], v[20:23]
    ds_read_b128 v[196:199], v243 offset:3200
    ds_read_b64 v[216:217], v246 offset:728
    ds_read_b64 v[218:219], v246 offset:736
    s_waitcnt lgkmcnt(9)
    v_mfma_f32_16x16x32_bf16 v[24:27], v[200:203], v[220:223], v[24:27]
    ds_read_b128 v[200:203], v243 offset:3520
    ds_read_b64 v[220:221], v246 offset:800
    ds_read_b64 v[222:223], v246 offset:808
    v_mfma_f32_16x16x32_bf16 v[28:31], v[204:207], v[224:227], v[28:31]
    ds_read_b128 v[204:207], v243 offset:3840
    ds_read_b64 v[224:225], v246 offset:872
    ds_read_b64 v[226:227], v246 offset:880
    s_waitcnt lgkmcnt(9)
    v_mfma_f32_16x16x32_bf16 v[32:35], v[208:211], v[228:231], v[32:35]
    ds_read_b128 v[208:211], v243 offset:4160
    ds_read_b64 v[228:229], v246 offset:944
    ds_read_b64 v[230:231], v246 offset:952
    v_mfma_f32_16x16x32_bf16 v[36:39], v[192:195], v[212:215], v[36:39]
    ds_read_b128 v[192:195], v243 offset:4480
    ds_read_b64 v[212:213], v246 offset:1016
    ds_read_b64 v[214:215], v246 offset:1024
    s_waitcnt lgkmcnt(9)
    v_mfma_f32_16x16x32_bf16 v[40:43], v[196:199], v[216:219], v[40:43]
    ds_read_b128 v[196:199], v243 offset:4800
    ds_read_b64 v[216:217], v246 offset:1088
    ds_read_b64 v[218:219], v246 offset:1096
    v_mfma_f32_16x16x32_bf16 v[44:47], v[200:203], v[220:223], v[44:47]
    ds_read_b128 v[200:203], v243 offset:5120
    ds_read_b64 v[220:221], v246 offset:2336
    ds_read_b64 v[222:223], v246 offset:2344
    s_waitcnt lgkmcnt(9)
    v_mfma_f32_16x16x32_bf16 v[48:51], v[204:207], v[224:227], v[48:51]
    ds_read_b128 v[204:207], v243 offset:5440
    ds_read_b64 v[224:225], v246 offset:2408
    ds_read_b64 v[226:227], v246 offset:2416
    v_mfma_f32_16x16x32_bf16 v[52:55], v[208:211], v[228:231], v[52:55]
    ds_read_b128 v[208:211], v243 offset:5760
    ds_read_b64 v[228:229], v246 offset:2480
    ds_read_b64 v[230:231], v246 offset:2488
    s_waitcnt lgkmcnt(9)
    v_mfma_f32_16x16x32_bf16 v[56:59], v[192:195], v[212:215], v[56:59]
    ds_read_b128 v[192:195], v243 offset:6080
    ds_read_b64 v[212:213], v246 offset:2552
    ds_read_b64 v[214:215], v246 offset:2560
    v_mfma_f32_16x16x32_bf16 v[60:63], v[196:199], v[216:219], v[60:63]
    ds_read_b128 v[196:199], v243 offset:6400
    ds_read_b64 v[216:217], v246 offset:2624
    ds_read_b64 v[218:219], v246 offset:2632
    s_waitcnt lgkmcnt(9)
    v_mfma_f32_16x16x32_bf16 v[64:67], v[200:203], v[220:223], v[64:67]
    ds_read_b128 v[200:203], v243 offset:6720
    ds_read_b64 v[220:221], v246 offset:2696
    ds_read_b64 v[222:223], v246 offset:2704
    v_mfma_f32_16x16x32_bf16 v[68:71], v[204:207], v[224:227], v[68:71]
    ds_read_b128 v[204:207], v243 offset:7040
    ds_read_b64 v[224:225], v246 offset:2768
    ds_read_b64 v[226:227], v246 offset:2776
    s_waitcnt lgkmcnt(9)
    v_mfma_f32_16x16x32_bf16 v[72:75], v[208:211], v[228:231], v[72:75]
    ds_read_b128 v[208:211], v243 offset:7360
    ds_read_b64 v[228:229], v246 offset:2840
    ds_read_b64 v[230:231], v246 offset:2848
    v_mfma_f32_16x16x32_bf16 v[76:79], v[192:195], v[212:215], v[76:79]
    ds_read_b128 v[192:195], v243 offset:7680
    ds_read_b64 v[212:213], v246 offset:2920
    ds_read_b64 v[214:215], v246 offset:2928
    s_waitcnt lgkmcnt(9)
    v_mfma_f32_16x16x32_bf16 v[80:83], v[196:199], v[216:219], v[80:83]
    ds_read_b128 v[196:199], v243 offset:8000
    ds_read_b64 v[216:217], v246 offset:2992
    ds_read_b64 v[218:219], v246 offset:3000
    v_mfma_f32_16x16x32_bf16 v[84:87], v[200:203], v[220:223], v[84:87]
    ds_read_b128 v[200:203], v243 offset:8320
    ds_read_b64 v[220:221], v246 offset:3064
    ds_read_b64 v[222:223], v246 offset:3072
    s_waitcnt lgkmcnt(9)
    v_mfma_f32_16x16x32_bf16 v[88:91], v[204:207], v[224:227], v[88:91]
    ds_read_b128 v[204:207], v243 offset:8640
    ds_read_b64 v[224:225], v246 offset:3136
    ds_read_b64 v[226:227], v246 offset:3144
    v_mfma_f32_16x16x32_bf16 v[92:95], v[208:211], v[228:231], v[92:95]
    ds_read_b128 v[208:211], v243 offset:8960
    ds_read_b64 v[228:229], v246 offset:3208
    ds_read_b64 v[230:231], v246 offset:3216
    s_waitcnt lgkmcnt(9)
    v_mfma_f32_16x16x32_bf16 v[96:99], v[192:195], v[212:215], v[96:99]
    ds_read_b128 v[192:195], v243 offset:9280
    ds_read_b64 v[212:213], v246 offset:3280
    ds_read_b64 v[214:215], v246 offset:3288
    v_mfma_f32_16x16x32_bf16 v[100:103], v[196:199], v[216:219], v[100:103]
    ds_read_b128 v[196:199], v243 offset:9600
    ds_read_b64 v[216:217], v246 offset:3352
    ds_read_b64 v[218:219], v246 offset:3360
    s_waitcnt lgkmcnt(9)
    v_mfma_f32_16x16x32_bf16 v[104:107], v[200:203], v[220:223], v[104:107]
    ds_read_b128 v[200:203], v243 offset:9920
    ds_read_b64 v[220:221], v246 offset:3424
    ds_read_b64 v[222:223], v246 offset:3432
    v_mfma_f32_16x16x32_bf16 v[108:111], v[204:207], v[224:227], v[108:111]
    ds_read_b128 v[204:207], v243 offset:10240
    ds_read_b64 v[224:225], v246 offset:4672
    ds_read_b64 v[226:227], v246 offset:4680
    s_waitcnt lgkmcnt(9)
    v_mfma_f32_16x16x32_bf16 v[112:115], v[208:211], v[228:231], v[112:115]
    ds_read_b128 v[208:211], v243 offset:10560
    ds_read_b64 v[228:229], v246 offset:4744
    ds_read_b64 v[230:231], v246 offset:4752
    v_mfma_f32_16x16x32_bf16 v[116:119], v[192:195], v[212:215], v[116:119]
    ds_read_b128 v[192:195], v243 offset:10880
    ds_read_b64 v[212:213], v246 offset:4816
    ds_read_b64 v[214:215], v246 offset:4824
    s_waitcnt lgkmcnt(9)
    v_mfma_f32_16x16x32_bf16 v[120:123], v[196:199], v[216:219], v[120:123]
    ds_read_b128 v[196:199], v243 offset:11200
    ds_read_b64 v[216:217], v246 offset:4888
    ds_read_b64 v[218:219], v246 offset:4896
    v_mfma_f32_16x16x32_bf16 v[124:127], v[200:203], v[220:223], v[124:127]
    ds_read_b128 v[200:203], v243 offset:11520
    ds_read_b64 v[220:221], v246 offset:4960
    ds_read_b64 v[222:223], v246 offset:4968
    s_waitcnt lgkmcnt(9)
    v_mfma_f32_16x16x32_bf16 v[128:131], v[204:207], v[224:227], v[128:131]
    ds_read_b128 v[204:207], v243 offset:11840
    ds_read_b64 v[224:225], v246 offset:5032
    ds_read_b64 v[226:227], v246 offset:5040
    v_mfma_f32_16x16x32_bf16 v[132:135], v[208:211], v[228:231], v[132:135]
    ds_read_b128 v[208:211], v243 offset:12160
    ds_read_b64 v[228:229], v246 offset:5104
    ds_read_b64 v[230:231], v246 offset:5112
    s_waitcnt lgkmcnt(9)
    v_mfma_f32_16x16x32_bf16 v[136:139], v[192:195], v[212:215], v[136:139]
    ds_read_b128 v[192:195], v243 offset:12480
    ds_read_b64 v[212:213], v246 offset:5176
    ds_read_b64 v[214:215], v246 offset:5184
    v_mfma_f32_16x16x32_bf16 v[140:143], v[196:199], v[216:219], v[140:143]
    ds_read_b128 v[196:199], v243 offset:12800
    ds_read_b64 v[216:217], v246 offset:5256
    ds_read_b64 v[218:219], v246 offset:5264
    s_waitcnt lgkmcnt(9)
    v_mfma_f32_16x16x32_bf16 v[144:147], v[200:203], v[220:223], v[144:147]
    ds_read_b128 v[200:203], v243 offset:13120
    ds_read_b64 v[220:221], v246 offset:5328
    ds_read_b64 v[222:223], v246 offset:5336
    v_mfma_f32_16x16x32_bf16 v[148:151], v[204:207], v[224:227], v[148:151]
    ds_read_b128 v[204:207], v243 offset:13440
    ds_read_b64 v[224:225], v246 offset:5400
    ds_read_b64 v[226:227], v246 offset:5408
    s_waitcnt lgkmcnt(9)
    v_mfma_f32_16x16x32_bf16 v[152:155], v[208:211], v[228:231], v[152:155]
    ds_read_b128 v[208:211], v243 offset:13760
    ds_read_b64 v[228:229], v246 offset:5472
    ds_read_b64 v[230:231], v246 offset:5480
    v_mfma_f32_16x16x32_bf16 v[156:159], v[192:195], v[212:215], v[156:159]
    ds_read_b128 v[192:195], v243 offset:14080
    ds_read_b64 v[212:213], v246 offset:5544
    ds_read_b64 v[214:215], v246 offset:5552
    s_waitcnt lgkmcnt(9)
    v_mfma_f32_16x16x32_bf16 v[160:163], v[196:199], v[216:219], v[160:163]
    ds_read_b128 v[196:199], v243 offset:14400
    ds_read_b64 v[216:217], v246 offset:5616
    ds_read_b64 v[218:219], v246 offset:5624
    v_mfma_f32_16x16x32_bf16 v[164:167], v[200:203], v[220:223], v[164:167]
    ds_read_b128 v[200:203], v243 offset:14720
    ds_read_b64 v[220:221], v246 offset:5688
    ds_read_b64 v[222:223], v246 offset:5696
    s_waitcnt lgkmcnt(9)
    v_mfma_f32_16x16x32_bf16 v[168:171], v[204:207], v[224:227], v[168:171]
    ds_read_b128 v[204:207], v243 offset:15040
    ds_read_b64 v[224:225], v246 offset:5760
    ds_read_b64 v[226:227], v246 offset:5768
    v_mfma_f32_16x16x32_bf16 v[172:175], v[208:211], v[228:231], v[172:175]
    s_waitcnt lgkmcnt(6)
    v_mfma_f32_16x16x32_bf16 v[176:179], v[192:195], v[212:215], v[176:179]
    v_mfma_f32_16x16x32_bf16 v[180:183], v[196:199], v[216:219], v[180:183]
    s_waitcnt lgkmcnt(0)
    v_mfma_f32_16x16x32_bf16 v[184:187], v[200:203], v[220:223], v[184:187]
    ds_write_b32 v254, v255 offset:4
    v_mfma_f32_16x16x32_bf16 v[188:191], v[204:207], v[224:227], v[188:191]
    s_setprio 2
L_hp2:

    s_cmp_lg_u32 s16, 1
    s_cbranch_scc1 L_nopf
    s_lshr_b32 s26, s2, 3
    s_mul_i32 s26, s26, 2304
    v_lshlrev_b32 v230, 2, v253
    buffer_load_dword v231, v230, s[40:43], s26 offen
    buffer_load_dword v231, v230, s[44:47], s26 offen
L_nopf:

    v_pk_add_f32 v[232:233], v[0:1], v[4:5]
    v_pk_mul_f32 v[236:237], v[0:1], v[0:1]
    v_pk_add_f32 v[234:235], v[2:3], v[6:7]
    v_pk_mul_f32 v[238:239], v[2:3], v[2:3]
    v_pk_fma_f32 v[236:237], v[4:5], v[4:5], v[236:237]
    v_pk_fma_f32 v[238:239], v[6:7], v[6:7], v[238:239]
    v_pk_add_f32 v[232:233], v[232:233], v[8:9]
    v_pk_fma_f32 v[236:237], v[8:9], v[8:9], v[236:237]
    v_pk_add_f32 v[234:235], v[234:235], v[10:11]
    v_pk_fma_f32 v[238:239], v[10:11], v[10:11], v[238:239]
    v_pk_add_f32 v[232:233], v[232:233], v[12:13]
    v_pk_fma_f32 v[236:237], v[12:13], v[12:13], v[236:237]
    v_pk_add_f32 v[234:235], v[234:235], v[14:15]
    v_pk_fma_f32 v[238:239], v[14:15], v[14:15], v[238:239]
    v_pk_add_f32 v[232:233], v[232:233], v[16:17]
    v_pk_fma_f32 v[236:237], v[16:17], v[16:17], v[236:237]
    v_pk_add_f32 v[234:235], v[234:235], v[18:19]
    v_pk_fma_f32 v[238:239], v[18:19], v[18:19], v[238:239]
    v_pk_add_f32 v[232:233], v[232:233], v[20:21]
    v_pk_fma_f32 v[236:237], v[20:21], v[20:21], v[236:237]
    v_pk_add_f32 v[234:235], v[234:235], v[22:23]
    v_pk_fma_f32 v[238:239], v[22:23], v[22:23], v[238:239]
    v_pk_add_f32 v[232:233], v[232:233], v[24:25]
    v_pk_fma_f32 v[236:237], v[24:25], v[24:25], v[236:237]
    v_pk_add_f32 v[234:235], v[234:235], v[26:27]
    v_pk_fma_f32 v[238:239], v[26:27], v[26:27], v[238:239]
    v_pk_add_f32 v[232:233], v[232:233], v[28:29]
    v_pk_fma_f32 v[236:237], v[28:29], v[28:29], v[236:237]
    v_pk_add_f32 v[234:235], v[234:235], v[30:31]
    v_pk_fma_f32 v[238:239], v[30:31], v[30:31], v[238:239]
    v_pk_add_f32 v[232:233], v[232:233], v[32:33]
    v_pk_fma_f32 v[236:237], v[32:33], v[32:33], v[236:237]
    v_pk_add_f32 v[234:235], v[234:235], v[34:35]
    v_pk_fma_f32 v[238:239], v[34:35], v[34:35], v[238:239]
    v_pk_add_f32 v[232:233], v[232:233], v[36:37]
    v_pk_fma_f32 v[236:237], v[36:37], v[36:37], v[236:237]
    v_pk_add_f32 v[234:235], v[234:235], v[38:39]
    v_pk_fma_f32 v[238:239], v[38:39], v[38:39], v[238:239]
    v_pk_add_f32 v[232:233], v[232:233], v[40:41]
    v_pk_fma_f32 v[236:237], v[40:41], v[40:41], v[236:237]
    v_pk_add_f32 v[234:235], v[234:235], v[42:43]
    v_pk_fma_f32 v[238:239], v[42:43], v[42:43], v[238:239]
    v_pk_add_f32 v[232:233], v[232:233], v[44:45]
    v_pk_fma_f32 v[236:237], v[44:45], v[44:45], v[236:237]
    v_pk_add_f32 v[234:235], v[234:235], v[46:47]
    v_pk_fma_f32 v[238:239], v[46:47], v[46:47], v[238:239]
    v_pk_add_f32 v[232:233], v[232:233], v[48:49]
    v_pk_fma_f32 v[236:237], v[48:49], v[48:49], v[236:237]
    v_pk_add_f32 v[234:235], v[234:235], v[50:51]
    v_pk_fma_f32 v[238:239], v[50:51], v[50:51], v[238:239]
    v_pk_add_f32 v[232:233], v[232:233], v[52:53]
    v_pk_fma_f32 v[236:237], v[52:53], v[52:53], v[236:237]
    v_pk_add_f32 v[234:235], v[234:235], v[54:55]
    v_pk_fma_f32 v[238:239], v[54:55], v[54:55], v[238:239]
    v_pk_add_f32 v[232:233], v[232:233], v[56:57]
    v_pk_fma_f32 v[236:237], v[56:57], v[56:57], v[236:237]
    v_pk_add_f32 v[234:235], v[234:235], v[58:59]
    v_pk_fma_f32 v[238:239], v[58:59], v[58:59], v[238:239]
    v_pk_add_f32 v[232:233], v[232:233], v[60:61]
    v_pk_fma_f32 v[236:237], v[60:61], v[60:61], v[236:237]
    v_pk_add_f32 v[234:235], v[234:235], v[62:63]
    v_pk_fma_f32 v[238:239], v[62:63], v[62:63], v[238:239]
    v_pk_add_f32 v[232:233], v[232:233], v[64:65]
    v_pk_fma_f32 v[236:237], v[64:65], v[64:65], v[236:237]
    v_pk_add_f32 v[234:235], v[234:235], v[66:67]
    v_pk_fma_f32 v[238:239], v[66:67], v[66:67], v[238:239]
    v_pk_add_f32 v[232:233], v[232:233], v[68:69]
    v_pk_fma_f32 v[236:237], v[68:69], v[68:69], v[236:237]
    v_pk_add_f32 v[234:235], v[234:235], v[70:71]
    v_pk_fma_f32 v[238:239], v[70:71], v[70:71], v[238:239]
    v_pk_add_f32 v[232:233], v[232:233], v[72:73]
    v_pk_fma_f32 v[236:237], v[72:73], v[72:73], v[236:237]
    v_pk_add_f32 v[234:235], v[234:235], v[74:75]
    v_pk_fma_f32 v[238:239], v[74:75], v[74:75], v[238:239]
    v_pk_add_f32 v[232:233], v[232:233], v[76:77]
    v_pk_fma_f32 v[236:237], v[76:77], v[76:77], v[236:237]
    v_pk_add_f32 v[234:235], v[234:235], v[78:79]
    v_pk_fma_f32 v[238:239], v[78:79], v[78:79], v[238:239]
    v_pk_add_f32 v[232:233], v[232:233], v[80:81]
    v_pk_fma_f32 v[236:237], v[80:81], v[80:81], v[236:237]
    v_pk_add_f32 v[234:235], v[234:235], v[82:83]
    v_pk_fma_f32 v[238:239], v[82:83], v[82:83], v[238:239]
    v_pk_add_f32 v[232:233], v[232:233], v[84:85]
    v_pk_fma_f32 v[236:237], v[84:85], v[84:85], v[236:237]
    v_pk_add_f32 v[234:235], v[234:235], v[86:87]
    v_pk_fma_f32 v[238:239], v[86:87], v[86:87], v[238:239]
    v_pk_add_f32 v[232:233], v[232:233], v[88:89]
    v_pk_fma_f32 v[236:237], v[88:89], v[88:89], v[236:237]
    v_pk_add_f32 v[234:235], v[234:235], v[90:91]
    v_pk_fma_f32 v[238:239], v[90:91], v[90:91], v[238:239]
    v_pk_add_f32 v[232:233], v[232:233], v[92:93]
    v_pk_fma_f32 v[236:237], v[92:93], v[92:93], v[236:237]
    v_pk_add_f32 v[234:235], v[234:235], v[94:95]
    v_pk_fma_f32 v[238:239], v[94:95], v[94:95], v[238:239]
    v_pk_add_f32 v[232:233], v[232:233], v[96:97]
    v_pk_fma_f32 v[236:237], v[96:97], v[96:97], v[236:237]
    v_pk_add_f32 v[234:235], v[234:235], v[98:99]
    v_pk_fma_f32 v[238:239], v[98:99], v[98:99], v[238:239]
    v_pk_add_f32 v[232:233], v[232:233], v[100:101]
    v_pk_fma_f32 v[236:237], v[100:101], v[100:101], v[236:237]
    v_pk_add_f32 v[234:235], v[234:235], v[102:103]
    v_pk_fma_f32 v[238:239], v[102:103], v[102:103], v[238:239]
    v_pk_add_f32 v[232:233], v[232:233], v[104:105]
    v_pk_fma_f32 v[236:237], v[104:105], v[104:105], v[236:237]
    v_pk_add_f32 v[234:235], v[234:235], v[106:107]
    v_pk_fma_f32 v[238:239], v[106:107], v[106:107], v[238:239]
    v_pk_add_f32 v[232:233], v[232:233], v[108:109]
    v_pk_fma_f32 v[236:237], v[108:109], v[108:109], v[236:237]
    v_pk_add_f32 v[234:235], v[234:235], v[110:111]
    v_pk_fma_f32 v[238:239], v[110:111], v[110:111], v[238:239]
    v_pk_add_f32 v[232:233], v[232:233], v[112:113]
    v_pk_fma_f32 v[236:237], v[112:113], v[112:113], v[236:237]
    v_pk_add_f32 v[234:235], v[234:235], v[114:115]
    v_pk_fma_f32 v[238:239], v[114:115], v[114:115], v[238:239]
    v_pk_add_f32 v[232:233], v[232:233], v[116:117]
    v_pk_fma_f32 v[236:237], v[116:117], v[116:117], v[236:237]
    v_pk_add_f32 v[234:235], v[234:235], v[118:119]
    v_pk_fma_f32 v[238:239], v[118:119], v[118:119], v[238:239]
    v_pk_add_f32 v[232:233], v[232:233], v[120:121]
    v_pk_fma_f32 v[236:237], v[120:121], v[120:121], v[236:237]
    v_pk_add_f32 v[234:235], v[234:235], v[122:123]
    v_pk_fma_f32 v[238:239], v[122:123], v[122:123], v[238:239]
    v_pk_add_f32 v[232:233], v[232:233], v[124:125]
    v_pk_fma_f32 v[236:237], v[124:125], v[124:125], v[236:237]
    v_pk_add_f32 v[234:235], v[234:235], v[126:127]
    v_pk_fma_f32 v[238:239], v[126:127], v[126:127], v[238:239]
    v_pk_add_f32 v[232:233], v[232:233], v[128:129]
    v_pk_fma_f32 v[236:237], v[128:129], v[128:129], v[236:237]
    v_pk_add_f32 v[234:235], v[234:235], v[130:131]
    v_pk_fma_f32 v[238:239], v[130:131], v[130:131], v[238:239]
    v_pk_add_f32 v[232:233], v[232:233], v[132:133]
    v_pk_fma_f32 v[236:237], v[132:133], v[132:133], v[236:237]
    v_pk_add_f32 v[234:235], v[234:235], v[134:135]
    v_pk_fma_f32 v[238:239], v[134:135], v[134:135], v[238:239]
    v_pk_add_f32 v[232:233], v[232:233], v[136:137]
    v_pk_fma_f32 v[236:237], v[136:137], v[136:137], v[236:237]
    v_pk_add_f32 v[234:235], v[234:235], v[138:139]
    v_pk_fma_f32 v[238:239], v[138:139], v[138:139], v[238:239]
    v_pk_add_f32 v[232:233], v[232:233], v[140:141]
    v_pk_fma_f32 v[236:237], v[140:141], v[140:141], v[236:237]
    v_pk_add_f32 v[234:235], v[234:235], v[142:143]
    v_pk_fma_f32 v[238:239], v[142:143], v[142:143], v[238:239]
    v_pk_add_f32 v[232:233], v[232:233], v[144:145]
    v_pk_fma_f32 v[236:237], v[144:145], v[144:145], v[236:237]
    v_pk_add_f32 v[234:235], v[234:235], v[146:147]
    v_pk_fma_f32 v[238:239], v[146:147], v[146:147], v[238:239]
    v_pk_add_f32 v[232:233], v[232:233], v[148:149]
    v_pk_fma_f32 v[236:237], v[148:149], v[148:149], v[236:237]
    v_pk_add_f32 v[234:235], v[234:235], v[150:151]
    v_pk_fma_f32 v[238:239], v[150:151], v[150:151], v[238:239]
    v_pk_add_f32 v[232:233], v[232:233], v[152:153]
    v_pk_fma_f32 v[236:237], v[152:153], v[152:153], v[236:237]
    v_pk_add_f32 v[234:235], v[234:235], v[154:155]
    v_pk_fma_f32 v[238:239], v[154:155], v[154:155], v[238:239]
    v_pk_add_f32 v[232:233], v[232:233], v[156:157]
    v_pk_fma_f32 v[236:237], v[156:157], v[156:157], v[236:237]
    v_pk_add_f32 v[234:235], v[234:235], v[158:159]
    v_pk_fma_f32 v[238:239], v[158:159], v[158:159], v[238:239]
    v_pk_add_f32 v[232:233], v[232:233], v[160:161]
    v_pk_fma_f32 v[236:237], v[160:161], v[160:161], v[236:237]
    v_pk_add_f32 v[234:235], v[234:235], v[162:163]
    v_pk_fma_f32 v[238:239], v[162:163], v[162:163], v[238:239]
    v_pk_add_f32 v[232:233], v[232:233], v[164:165]
    v_pk_fma_f32 v[236:237], v[164:165], v[164:165], v[236:237]
    v_pk_add_f32 v[234:235], v[234:235], v[166:167]
    v_pk_fma_f32 v[238:239], v[166:167], v[166:167], v[238:239]
    v_pk_add_f32 v[232:233], v[232:233], v[168:169]
    v_pk_fma_f32 v[236:237], v[168:169], v[168:169], v[236:237]
    v_pk_add_f32 v[234:235], v[234:235], v[170:171]
    v_pk_fma_f32 v[238:239], v[170:171], v[170:171], v[238:239]
    v_pk_add_f32 v[232:233], v[232:233], v[172:173]
    v_pk_fma_f32 v[236:237], v[172:173], v[172:173], v[236:237]
    v_pk_add_f32 v[234:235], v[234:235], v[174:175]
    v_pk_fma_f32 v[238:239], v[174:175], v[174:175], v[238:239]
    v_pk_add_f32 v[232:233], v[232:233], v[176:177]
    v_pk_fma_f32 v[236:237], v[176:177], v[176:177], v[236:237]
    v_pk_add_f32 v[234:235], v[234:235], v[178:179]
    v_pk_fma_f32 v[238:239], v[178:179], v[178:179], v[238:239]
    v_pk_add_f32 v[232:233], v[232:233], v[180:181]
    v_pk_fma_f32 v[236:237], v[180:181], v[180:181], v[236:237]
    v_pk_add_f32 v[234:235], v[234:235], v[182:183]
    v_pk_fma_f32 v[238:239], v[182:183], v[182:183], v[238:239]
    v_pk_add_f32 v[232:233], v[232:233], v[184:185]
    v_pk_fma_f32 v[236:237], v[184:185], v[184:185], v[236:237]
    v_pk_add_f32 v[234:235], v[234:235], v[186:187]
    v_pk_fma_f32 v[238:239], v[186:187], v[186:187], v[238:239]
    v_pk_add_f32 v[232:233], v[232:233], v[188:189]
    v_pk_fma_f32 v[236:237], v[188:189], v[188:189], v[236:237]
    v_pk_add_f32 v[234:235], v[234:235], v[190:191]
    v_pk_fma_f32 v[238:239], v[190:191], v[190:191], v[238:239]

    s_nop 1
    v_permlane32_swap_b32 v232, v233
    v_permlane32_swap_b32 v234, v235
    v_permlane32_swap_b32 v236, v237
    v_permlane32_swap_b32 v238, v239

    v_add_f32 v232, v232, v233
    v_add_f32 v236, v236, v237
    v_mul_f32 v232, 0x3c2aaaab, v232
    v_mul_f32 v236, 0x3c2aaaab, v236
    v_fma_f32 v236, -v232, v232, v236
    v_max_f32 v236, 0, v236
    v_add_f32 v236, 0x3727c5ac, v236
    v_rsq_f32 v236, v236
    s_nop 0
    v_mul_f32 v232, v232, v236
    v_mul_f32 v236, 0x08000000, v236
    v_mul_f32 v232, 0x88000000, v232
    v_mov_b32 v237, v236
    v_mov_b32 v233, v232

    v_add_f32 v234, v234, v235
    v_add_f32 v238, v238, v239
    v_mul_f32 v234, 0x3c2aaaab, v234
    v_mul_f32 v238, 0x3c2aaaab, v238
    v_fma_f32 v238, -v234, v234, v238
    v_max_f32 v238, 0, v238
    v_add_f32 v238, 0x3727c5ac, v238
    v_rsq_f32 v238, v238
    s_nop 0
    v_mul_f32 v234, v234, v238
    v_mul_f32 v238, 0x08000000, v238
    v_mul_f32 v234, 0x88000000, v234
    v_mov_b32 v239, v238
    v_mov_b32 v235, v234

    s_nop 1
    v_permlane32_swap_b32 v232, v233
    v_permlane32_swap_b32 v234, v235
    v_permlane32_swap_b32 v236, v237
    v_permlane32_swap_b32 v238, v239

    v_pk_fma_f32 v[0:1], v[0:1], v[236:237], v[232:233]
    v_pk_fma_f32 v[2:3], v[2:3], v[238:239], v[234:235]
    v_pk_fma_f32 v[4:5], v[4:5], v[236:237], v[232:233]
    v_pk_fma_f32 v[6:7], v[6:7], v[238:239], v[234:235]
    v_pk_fma_f32 v[8:9], v[8:9], v[236:237], v[232:233]
    v_pk_fma_f32 v[10:11], v[10:11], v[238:239], v[234:235]
    v_pk_fma_f32 v[12:13], v[12:13], v[236:237], v[232:233]
    v_pk_fma_f32 v[14:15], v[14:15], v[238:239], v[234:235]
    v_pk_fma_f32 v[16:17], v[16:17], v[236:237], v[232:233]
    v_pk_fma_f32 v[18:19], v[18:19], v[238:239], v[234:235]
    v_pk_fma_f32 v[20:21], v[20:21], v[236:237], v[232:233]
    v_pk_fma_f32 v[22:23], v[22:23], v[238:239], v[234:235]
    v_pk_fma_f32 v[24:25], v[24:25], v[236:237], v[232:233]
    v_pk_fma_f32 v[26:27], v[26:27], v[238:239], v[234:235]
    v_pk_fma_f32 v[28:29], v[28:29], v[236:237], v[232:233]
    v_pk_fma_f32 v[30:31], v[30:31], v[238:239], v[234:235]
    v_pk_fma_f32 v[32:33], v[32:33], v[236:237], v[232:233]
    v_pk_fma_f32 v[34:35], v[34:35], v[238:239], v[234:235]
    v_pk_fma_f32 v[36:37], v[36:37], v[236:237], v[232:233]
    v_pk_fma_f32 v[38:39], v[38:39], v[238:239], v[234:235]
    v_pk_fma_f32 v[40:41], v[40:41], v[236:237], v[232:233]
    v_pk_fma_f32 v[42:43], v[42:43], v[238:239], v[234:235]
    v_pk_fma_f32 v[44:45], v[44:45], v[236:237], v[232:233]
    v_pk_fma_f32 v[46:47], v[46:47], v[238:239], v[234:235]
    v_pk_fma_f32 v[48:49], v[48:49], v[236:237], v[232:233]
    v_pk_fma_f32 v[50:51], v[50:51], v[238:239], v[234:235]
    v_pk_fma_f32 v[52:53], v[52:53], v[236:237], v[232:233]
    v_pk_fma_f32 v[54:55], v[54:55], v[238:239], v[234:235]
    v_pk_fma_f32 v[56:57], v[56:57], v[236:237], v[232:233]
    v_pk_fma_f32 v[58:59], v[58:59], v[238:239], v[234:235]
    v_pk_fma_f32 v[60:61], v[60:61], v[236:237], v[232:233]
    v_pk_fma_f32 v[62:63], v[62:63], v[238:239], v[234:235]
    v_cvt_pk_bf16_f32 v192, v0, v4
    v_cvt_pk_bf16_f32 v193, v8, v12
    v_cvt_pk_bf16_f32 v194, v16, v20
    v_cvt_pk_bf16_f32 v195, v24, v28
    v_cvt_pk_bf16_f32 v200, v32, v36
    v_cvt_pk_bf16_f32 v201, v40, v44
    v_cvt_pk_bf16_f32 v202, v48, v52
    v_cvt_pk_bf16_f32 v203, v56, v60
    v_cvt_pk_bf16_f32 v196, v1, v5
    v_cvt_pk_bf16_f32 v197, v9, v13
    v_cvt_pk_bf16_f32 v198, v17, v21
    v_cvt_pk_bf16_f32 v199, v25, v29
    v_cvt_pk_bf16_f32 v204, v33, v37
    v_cvt_pk_bf16_f32 v205, v41, v45
    v_cvt_pk_bf16_f32 v206, v49, v53
    v_cvt_pk_bf16_f32 v207, v57, v61
    v_cvt_pk_bf16_f32 v208, v2, v6
    v_cvt_pk_bf16_f32 v209, v10, v14
    v_cvt_pk_bf16_f32 v210, v18, v22
    v_cvt_pk_bf16_f32 v211, v26, v30
    v_cvt_pk_bf16_f32 v216, v34, v38
    v_cvt_pk_bf16_f32 v217, v42, v46
    v_cvt_pk_bf16_f32 v218, v50, v54
    v_cvt_pk_bf16_f32 v219, v58, v62
    v_cvt_pk_bf16_f32 v212, v3, v7
    v_cvt_pk_bf16_f32 v213, v11, v15
    v_cvt_pk_bf16_f32 v214, v19, v23
    v_cvt_pk_bf16_f32 v215, v27, v31
    v_cvt_pk_bf16_f32 v220, v35, v39
    v_cvt_pk_bf16_f32 v221, v43, v47
    v_cvt_pk_bf16_f32 v222, v51, v55
    v_cvt_pk_bf16_f32 v223, v59, v63
    s_nop 0
    v_permlane16_swap_b32 v192, v200
    v_permlane16_swap_b32 v193, v201
    v_permlane16_swap_b32 v194, v202
    v_permlane16_swap_b32 v195, v203
    v_permlane16_swap_b32 v196, v204
    v_permlane16_swap_b32 v197, v205
    v_permlane16_swap_b32 v198, v206
    v_permlane16_swap_b32 v199, v207
    v_permlane16_swap_b32 v208, v216
    v_permlane16_swap_b32 v209, v217
    v_permlane16_swap_b32 v210, v218
    v_permlane16_swap_b32 v211, v219
    v_permlane16_swap_b32 v212, v220
    v_permlane16_swap_b32 v213, v221
    v_permlane16_swap_b32 v214, v222
    v_permlane16_swap_b32 v215, v223
    v_mov_b32 v0, v208
    v_mov_b32 v1, v209
    v_mov_b32 v2, v210
    v_mov_b32 v3, v211
    v_mov_b32 v4, v212
    v_mov_b32 v5, v213
    v_mov_b32 v6, v214
    v_mov_b32 v7, v215
    v_mov_b32 v8, v216
    v_mov_b32 v9, v217
    v_mov_b32 v10, v218
    v_mov_b32 v11, v219
    v_mov_b32 v12, v220
    v_mov_b32 v13, v221
    v_mov_b32 v14, v222
    v_mov_b32 v15, v223
    v_pk_fma_f32 v[64:65], v[64:65], v[236:237], v[232:233]
    v_pk_fma_f32 v[66:67], v[66:67], v[238:239], v[234:235]
    v_pk_fma_f32 v[68:69], v[68:69], v[236:237], v[232:233]
    v_pk_fma_f32 v[70:71], v[70:71], v[238:239], v[234:235]
    v_pk_fma_f32 v[72:73], v[72:73], v[236:237], v[232:233]
    v_pk_fma_f32 v[74:75], v[74:75], v[238:239], v[234:235]
    v_pk_fma_f32 v[76:77], v[76:77], v[236:237], v[232:233]
    v_pk_fma_f32 v[78:79], v[78:79], v[238:239], v[234:235]
    v_pk_fma_f32 v[80:81], v[80:81], v[236:237], v[232:233]
    v_pk_fma_f32 v[82:83], v[82:83], v[238:239], v[234:235]
    v_pk_fma_f32 v[84:85], v[84:85], v[236:237], v[232:233]
    v_pk_fma_f32 v[86:87], v[86:87], v[238:239], v[234:235]
    v_pk_fma_f32 v[88:89], v[88:89], v[236:237], v[232:233]
    v_pk_fma_f32 v[90:91], v[90:91], v[238:239], v[234:235]
    v_pk_fma_f32 v[92:93], v[92:93], v[236:237], v[232:233]
    v_pk_fma_f32 v[94:95], v[94:95], v[238:239], v[234:235]
    v_pk_fma_f32 v[96:97], v[96:97], v[236:237], v[232:233]
    v_pk_fma_f32 v[98:99], v[98:99], v[238:239], v[234:235]
    v_pk_fma_f32 v[100:101], v[100:101], v[236:237], v[232:233]
    v_pk_fma_f32 v[102:103], v[102:103], v[238:239], v[234:235]
    v_pk_fma_f32 v[104:105], v[104:105], v[236:237], v[232:233]
    v_pk_fma_f32 v[106:107], v[106:107], v[238:239], v[234:235]
    v_pk_fma_f32 v[108:109], v[108:109], v[236:237], v[232:233]
    v_pk_fma_f32 v[110:111], v[110:111], v[238:239], v[234:235]
    v_pk_fma_f32 v[112:113], v[112:113], v[236:237], v[232:233]
    v_pk_fma_f32 v[114:115], v[114:115], v[238:239], v[234:235]
    v_pk_fma_f32 v[116:117], v[116:117], v[236:237], v[232:233]
    v_pk_fma_f32 v[118:119], v[118:119], v[238:239], v[234:235]
    v_pk_fma_f32 v[120:121], v[120:121], v[236:237], v[232:233]
    v_pk_fma_f32 v[122:123], v[122:123], v[238:239], v[234:235]
    v_pk_fma_f32 v[124:125], v[124:125], v[236:237], v[232:233]
    v_pk_fma_f32 v[126:127], v[126:127], v[238:239], v[234:235]
    v_cvt_pk_bf16_f32 v48, v64, v68
    v_cvt_pk_bf16_f32 v49, v72, v76
    v_cvt_pk_bf16_f32 v50, v80, v84
    v_cvt_pk_bf16_f32 v51, v88, v92
    v_cvt_pk_bf16_f32 v56, v96, v100
    v_cvt_pk_bf16_f32 v57, v104, v108
    v_cvt_pk_bf16_f32 v58, v112, v116
    v_cvt_pk_bf16_f32 v59, v120, v124
    v_cvt_pk_bf16_f32 v52, v65, v69
    v_cvt_pk_bf16_f32 v53, v73, v77
    v_cvt_pk_bf16_f32 v54, v81, v85
    v_cvt_pk_bf16_f32 v55, v89, v93
    v_cvt_pk_bf16_f32 v60, v97, v101
    v_cvt_pk_bf16_f32 v61, v105, v109
    v_cvt_pk_bf16_f32 v62, v113, v117
    v_cvt_pk_bf16_f32 v63, v121, v125
    v_cvt_pk_bf16_f32 v16, v66, v70
    v_cvt_pk_bf16_f32 v17, v74, v78
    v_cvt_pk_bf16_f32 v18, v82, v86
    v_cvt_pk_bf16_f32 v19, v90, v94
    v_cvt_pk_bf16_f32 v24, v98, v102
    v_cvt_pk_bf16_f32 v25, v106, v110
    v_cvt_pk_bf16_f32 v26, v114, v118
    v_cvt_pk_bf16_f32 v27, v122, v126
    v_cvt_pk_bf16_f32 v20, v67, v71
    v_cvt_pk_bf16_f32 v21, v75, v79
    v_cvt_pk_bf16_f32 v22, v83, v87
    v_cvt_pk_bf16_f32 v23, v91, v95
    v_cvt_pk_bf16_f32 v28, v99, v103
    v_cvt_pk_bf16_f32 v29, v107, v111
    v_cvt_pk_bf16_f32 v30, v115, v119
    v_cvt_pk_bf16_f32 v31, v123, v127
    s_nop 0
    v_permlane16_swap_b32 v48, v56
    v_permlane16_swap_b32 v49, v57
    v_permlane16_swap_b32 v50, v58
    v_permlane16_swap_b32 v51, v59
    v_permlane16_swap_b32 v52, v60
    v_permlane16_swap_b32 v53, v61
    v_permlane16_swap_b32 v54, v62
    v_permlane16_swap_b32 v55, v63
    v_permlane16_swap_b32 v16, v24
    v_permlane16_swap_b32 v17, v25
    v_permlane16_swap_b32 v18, v26
    v_permlane16_swap_b32 v19, v27
    v_permlane16_swap_b32 v20, v28
    v_permlane16_swap_b32 v21, v29
    v_permlane16_swap_b32 v22, v30
    v_permlane16_swap_b32 v23, v31
    v_mov_b32 v80, v192
    v_mov_b32 v81, v193
    v_mov_b32 v82, v194
    v_mov_b32 v83, v195
    v_mov_b32 v84, v196
    v_mov_b32 v85, v197
    v_mov_b32 v86, v198
    v_mov_b32 v87, v199
    v_mov_b32 v88, v200
    v_mov_b32 v89, v201
    v_mov_b32 v90, v202
    v_mov_b32 v91, v203
    v_mov_b32 v92, v204
    v_mov_b32 v93, v205
    v_mov_b32 v94, v206
    v_mov_b32 v95, v207
    v_pk_fma_f32 v[128:129], v[128:129], v[236:237], v[232:233]
    v_pk_fma_f32 v[130:131], v[130:131], v[238:239], v[234:235]
    v_pk_fma_f32 v[132:133], v[132:133], v[236:237], v[232:233]
    v_pk_fma_f32 v[134:135], v[134:135], v[238:239], v[234:235]
    v_pk_fma_f32 v[136:137], v[136:137], v[236:237], v[232:233]
    v_pk_fma_f32 v[138:139], v[138:139], v[238:239], v[234:235]
    v_pk_fma_f32 v[140:141], v[140:141], v[236:237], v[232:233]
    v_pk_fma_f32 v[142:143], v[142:143], v[238:239], v[234:235]
    v_pk_fma_f32 v[144:145], v[144:145], v[236:237], v[232:233]
    v_pk_fma_f32 v[146:147], v[146:147], v[238:239], v[234:235]
    v_pk_fma_f32 v[148:149], v[148:149], v[236:237], v[232:233]
    v_pk_fma_f32 v[150:151], v[150:151], v[238:239], v[234:235]
    v_pk_fma_f32 v[152:153], v[152:153], v[236:237], v[232:233]
    v_pk_fma_f32 v[154:155], v[154:155], v[238:239], v[234:235]
    v_pk_fma_f32 v[156:157], v[156:157], v[236:237], v[232:233]
    v_pk_fma_f32 v[158:159], v[158:159], v[238:239], v[234:235]
    v_pk_fma_f32 v[160:161], v[160:161], v[236:237], v[232:233]
    v_pk_fma_f32 v[162:163], v[162:163], v[238:239], v[234:235]
    v_pk_fma_f32 v[164:165], v[164:165], v[236:237], v[232:233]
    v_pk_fma_f32 v[166:167], v[166:167], v[238:239], v[234:235]
    v_pk_fma_f32 v[168:169], v[168:169], v[236:237], v[232:233]
    v_pk_fma_f32 v[170:171], v[170:171], v[238:239], v[234:235]
    v_pk_fma_f32 v[172:173], v[172:173], v[236:237], v[232:233]
    v_pk_fma_f32 v[174:175], v[174:175], v[238:239], v[234:235]
    v_pk_fma_f32 v[176:177], v[176:177], v[236:237], v[232:233]
    v_pk_fma_f32 v[178:179], v[178:179], v[238:239], v[234:235]
    v_pk_fma_f32 v[180:181], v[180:181], v[236:237], v[232:233]
    v_pk_fma_f32 v[182:183], v[182:183], v[238:239], v[234:235]
    v_pk_fma_f32 v[184:185], v[184:185], v[236:237], v[232:233]
    v_pk_fma_f32 v[186:187], v[186:187], v[238:239], v[234:235]
    v_pk_fma_f32 v[188:189], v[188:189], v[236:237], v[232:233]
    v_pk_fma_f32 v[190:191], v[190:191], v[238:239], v[234:235]
    v_cvt_pk_bf16_f32 v64, v128, v132
    v_cvt_pk_bf16_f32 v65, v136, v140
    v_cvt_pk_bf16_f32 v66, v144, v148
    v_cvt_pk_bf16_f32 v67, v152, v156
    v_cvt_pk_bf16_f32 v72, v160, v164
    v_cvt_pk_bf16_f32 v73, v168, v172
    v_cvt_pk_bf16_f32 v74, v176, v180
    v_cvt_pk_bf16_f32 v75, v184, v188
    v_cvt_pk_bf16_f32 v68, v129, v133
    v_cvt_pk_bf16_f32 v69, v137, v141
    v_cvt_pk_bf16_f32 v70, v145, v149
    v_cvt_pk_bf16_f32 v71, v153, v157
    v_cvt_pk_bf16_f32 v76, v161, v165
    v_cvt_pk_bf16_f32 v77, v169, v173
    v_cvt_pk_bf16_f32 v78, v177, v181
    v_cvt_pk_bf16_f32 v79, v185, v189
    v_cvt_pk_bf16_f32 v32, v130, v134
    v_cvt_pk_bf16_f32 v33, v138, v142
    v_cvt_pk_bf16_f32 v34, v146, v150
    v_cvt_pk_bf16_f32 v35, v154, v158
    v_cvt_pk_bf16_f32 v40, v162, v166
    v_cvt_pk_bf16_f32 v41, v170, v174
    v_cvt_pk_bf16_f32 v42, v178, v182
    v_cvt_pk_bf16_f32 v43, v186, v190
    v_cvt_pk_bf16_f32 v36, v131, v135
    v_cvt_pk_bf16_f32 v37, v139, v143
    v_cvt_pk_bf16_f32 v38, v147, v151
    v_cvt_pk_bf16_f32 v39, v155, v159
    v_cvt_pk_bf16_f32 v44, v163, v167
    v_cvt_pk_bf16_f32 v45, v171, v175
    v_cvt_pk_bf16_f32 v46, v179, v183
    v_cvt_pk_bf16_f32 v47, v187, v191
    s_nop 0
    v_permlane16_swap_b32 v64, v72
    v_permlane16_swap_b32 v65, v73
    v_permlane16_swap_b32 v66, v74
    v_permlane16_swap_b32 v67, v75
    v_permlane16_swap_b32 v68, v76
    v_permlane16_swap_b32 v69, v77
    v_permlane16_swap_b32 v70, v78
    v_permlane16_swap_b32 v71, v79
    v_permlane16_swap_b32 v32, v40
    v_permlane16_swap_b32 v33, v41
    v_permlane16_swap_b32 v34, v42
    v_permlane16_swap_b32 v35, v43
    v_permlane16_swap_b32 v36, v44
    v_permlane16_swap_b32 v37, v45
    v_permlane16_swap_b32 v38, v46
    v_permlane16_swap_b32 v39, v47

    s_mov_b32 s18, 8
    s_mov_b32 s38, 1
    s_sub_u32 s26, s16, 1
    s_cmp_lt_u32 s26, 7
    s_cbranch_scc1 L_p2
    s_mov_b32 s38, 0

    v_lshrrev_b32 v232, 7, v253
    v_mul_u32_u24 v232, 640, v232
    v_add_u32 v232, v232, v253
    v_add_u32 v233, 196608, v232
    buffer_store_dwordx4 v[48:51], v232, s[8:11], s36 offen offset:0 sc1
    buffer_store_dwordx4 v[52:55], v232, s[8:11], s36 offen offset:128 sc1
    buffer_store_dwordx4 v[56:59], v232, s[8:11], s36 offen offset:256 sc1
    buffer_store_dwordx4 v[60:63], v232, s[8:11], s37 offen offset:0 sc1
    buffer_store_dwordx4 v[64:67], v232, s[8:11], s37 offen offset:128 sc1
    buffer_store_dwordx4 v[68:71], v232, s[8:11], s37 offen offset:256 sc1
    buffer_store_dwordx4 v[72:75], v233, s[8:11], s36 offen offset:0 sc1
    buffer_store_dwordx4 v[76:79], v233, s[8:11], s36 offen offset:128 sc1
    buffer_store_dwordx4 v[80:83], v233, s[8:11], s36 offen offset:256 sc1
    buffer_store_dwordx4 v[84:87], v233, s[8:11], s37 offen offset:0 sc1
    buffer_store_dwordx4 v[88:91], v233, s[8:11], s37 offen offset:128 sc1
    buffer_store_dwordx4 v[92:95], v233, s[8:11], s37 offen offset:256 sc1

    s_cmp_lg_u32 s16, 0
    s_cbranch_scc1 L_p2
    s_setprio 3
    s_branch L_xload
L_loader:

    v_lshrrev_b32 v60, 9, v253
    v_mul_u32_u24 v61, 1536, v60
    v_add_u32 v61, v61, v253
    v_bfe_u32 v254, v253, 6, 3
    v_lshl_add_u32 v60, v60, 4, v254
    v_mul_u32_u24 v60, 768, v60
    v_and_b32 v254, 48, v253
    v_add_u32 v60, v60, v254

    v_add_u32 v254, 161932, v240

    s_mov_b32 s29, 200000
L_wg1:
    ds_read_b32 v255, v254
    s_waitcnt lgkmcnt(0)
    v_cmp_ne_u32 vcc, 0, v255
    s_cmp_eq_u64 vcc, exec
    s_cbranch_scc1 L_wg1_ok
    s_sleep 2
    s_sub_u32 s29, s29, 1
    s_cmp_lg_u32 s29, 0
    s_cbranch_scc1 L_wg1
L_wg1_ok:

    s_add_u32 s26, s39, 1
    s_cmp_ge_u32 s26, 12
    s_cselect_b32 s27, 12, 0
    s_sub_u32 s26, s26, s27
    s_mul_i32 s26, s26, 6144

    s_mov_b32 m0, 7168
    s_add_u32 s30, s26, 0
    s_add_u32 s31, s26, 1536
    buffer_load_dwordx4 v253, s[44:47], s30 offen lds
    buffer_load_dwordx4 v61, s[44:47], s30 offen offset:1024 lds
    buffer_load_dwordx4 v253, s[44:47], s31 offen offset:2048 lds
    s_mov_b32 m0, 72712
    s_add_u32 s30, s26, 1536
    s_add_u32 s31, s26, 3072
    buffer_load_dwordx4 v253, s[44:47], s30 offen lds
    buffer_load_dwordx4 v61, s[44:47], s30 offen offset:1024 lds
    buffer_load_dwordx4 v253, s[44:47], s31 offen offset:2048 lds

    s_add_u32 s26, s39, 4
    s_cmp_ge_u32 s26, 12
    s_cselect_b32 s27, 12, 0
    s_sub_u32 s26, s26, s27
    s_mul_i32 s26, s26, 64

    s_mov_b32 m0, 10240
    s_add_u32 s30, s26, 0
    s_add_u32 s31, s26, 23552
    s_add_u32 s32, s26, 47104
    buffer_load_dwordx4 v60, s[40:43], s30 offen offset:0 lds
    buffer_load_dwordx4 v60, s[40:43], s31 offen offset:1024 lds
    buffer_load_dwordx4 v60, s[40:43], s32 offen offset:2048 lds
    s_mov_b32 m0, 75784
    s_add_u32 s30, s26, 6144
    s_add_u32 s31, s26, 29696
    s_add_u32 s32, s26, 53248
    buffer_load_dwordx4 v60, s[40:43], s30 offen offset:0 lds
    buffer_load_dwordx4 v60, s[40:43], s31 offen offset:1024 lds
    buffer_load_dwordx4 v60, s[40:43], s32 offen offset:2048 lds

    s_add_u32 s26, s39, 2
    s_cmp_ge_u32 s26, 12
    s_cselect_b32 s27, 12, 0
    s_sub_u32 s26, s26, s27
    s_mul_i32 s26, s26, 6144

    s_mov_b32 m0, 13312
    s_add_u32 s30, s26, 0
    s_add_u32 s31, s26, 1536
    buffer_load_dwordx4 v253, s[44:47], s30 offen lds
    buffer_load_dwordx4 v61, s[44:47], s30 offen offset:1024 lds
    buffer_load_dwordx4 v253, s[44:47], s31 offen offset:2048 lds
    s_mov_b32 m0, 78856
    s_add_u32 s30, s26, 1536
    s_add_u32 s31, s26, 3072
    buffer_load_dwordx4 v253, s[44:47], s30 offen lds
    buffer_load_dwordx4 v61, s[44:47], s30 offen offset:1024 lds
    buffer_load_dwordx4 v253, s[44:47], s31 offen offset:2048 lds

    s_add_u32 s26, s39, 5
    s_cmp_ge_u32 s26, 12
    s_cselect_b32 s27, 12, 0
    s_sub_u32 s26, s26, s27
    s_mul_i32 s26, s26, 64

    s_mov_b32 m0, 16384
    s_add_u32 s30, s26, 0
    s_add_u32 s31, s26, 23552
    s_add_u32 s32, s26, 47104
    buffer_load_dwordx4 v60, s[40:43], s30 offen offset:0 lds
    buffer_load_dwordx4 v60, s[40:43], s31 offen offset:1024 lds
    buffer_load_dwordx4 v60, s[40:43], s32 offen offset:2048 lds
    s_mov_b32 m0, 81928
    s_add_u32 s30, s26, 6144
    s_add_u32 s31, s26, 29696
    s_add_u32 s32, s26, 53248
    buffer_load_dwordx4 v60, s[40:43], s30 offen offset:0 lds
    buffer_load_dwordx4 v60, s[40:43], s31 offen offset:1024 lds
    buffer_load_dwordx4 v60, s[40:43], s32 offen offset:2048 lds
    v_mov_b32 v254, 161976

    s_mov_b32 s29, 200000
L_wo1:
    ds_read_b32 v255, v254
    s_waitcnt lgkmcnt(0)
    v_cmp_eq_u32 vcc, 5, v255
    s_cmp_eq_u64 vcc, exec
    s_cbranch_scc1 L_wo1_ok
    s_sleep 2
    s_sub_u32 s29, s29, 1
    s_cmp_lg_u32 s29, 0
    s_cbranch_scc1 L_wo1
L_wo1_ok:

    v_mov_b32 v254, 161976
    v_mov_b32 v64, 6
    s_waitcnt vmcnt(18)
    ds_write_b32 v254, v64
    v_mov_b32 v65, 7
    s_waitcnt vmcnt(12)
    ds_write_b32 v254, v65
    v_mov_b32 v66, 8
    s_waitcnt vmcnt(6)
    ds_write_b32 v254, v66
    v_mov_b32 v67, 9
    s_waitcnt vmcnt(0)
    ds_write_b32 v254, v67
    v_add_u32 v254, 161940, v240

    s_mov_b32 s29, 200000
L_wg2:
    ds_read_b32 v255, v254
    s_waitcnt lgkmcnt(0)
    v_cmp_ne_u32 vcc, 0, v255
    s_cmp_eq_u64 vcc, exec
    s_cbranch_scc1 L_wg2_ok
    s_sleep 2
    s_sub_u32 s29, s29, 1
    s_cmp_lg_u32 s29, 0
    s_cbranch_scc1 L_wg2
L_wg2_ok:

    s_add_u32 s26, s39, 3
    s_cmp_ge_u32 s26, 12
    s_cselect_b32 s27, 12, 0
    s_sub_u32 s26, s26, s27
    s_mul_i32 s26, s26, 6144

    s_mov_b32 m0, 19456
    s_add_u32 s30, s26, 0
    s_add_u32 s31, s26, 1536
    buffer_load_dwordx4 v253, s[44:47], s30 offen lds
    buffer_load_dwordx4 v61, s[44:47], s30 offen offset:1024 lds
    buffer_load_dwordx4 v253, s[44:47], s31 offen offset:2048 lds
    s_mov_b32 m0, 85000
    s_add_u32 s30, s26, 1536
    s_add_u32 s31, s26, 3072
    buffer_load_dwordx4 v253, s[44:47], s30 offen lds
    buffer_load_dwordx4 v61, s[44:47], s30 offen offset:1024 lds
    buffer_load_dwordx4 v253, s[44:47], s31 offen offset:2048 lds

    s_add_u32 s26, s39, 6
    s_cmp_ge_u32 s26, 12
    s_cselect_b32 s27, 12, 0
    s_sub_u32 s26, s26, s27
    s_mul_i32 s26, s26, 64

    s_mov_b32 m0, 22528
    s_add_u32 s30, s26, 0
    s_add_u32 s31, s26, 23552
    s_add_u32 s32, s26, 47104
    buffer_load_dwordx4 v60, s[40:43], s30 offen offset:0 lds
    buffer_load_dwordx4 v60, s[40:43], s31 offen offset:1024 lds
    buffer_load_dwordx4 v60, s[40:43], s32 offen offset:2048 lds
    s_mov_b32 m0, 88072
    s_add_u32 s30, s26, 6144
    s_add_u32 s31, s26, 29696
    s_add_u32 s32, s26, 53248
    buffer_load_dwordx4 v60, s[40:43], s30 offen offset:0 lds
    buffer_load_dwordx4 v60, s[40:43], s31 offen offset:1024 lds
    buffer_load_dwordx4 v60, s[40:43], s32 offen offset:2048 lds

    s_add_u32 s26, s39, 4
    s_cmp_ge_u32 s26, 12
    s_cselect_b32 s27, 12, 0
    s_sub_u32 s26, s26, s27
    s_mul_i32 s26, s26, 6144

    s_mov_b32 m0, 25600
    s_add_u32 s30, s26, 0
    s_add_u32 s31, s26, 1536
    buffer_load_dwordx4 v253, s[44:47], s30 offen lds
    buffer_load_dwordx4 v61, s[44:47], s30 offen offset:1024 lds
    buffer_load_dwordx4 v253, s[44:47], s31 offen offset:2048 lds
    s_mov_b32 m0, 91144
    s_add_u32 s30, s26, 1536
    s_add_u32 s31, s26, 3072
    buffer_load_dwordx4 v253, s[44:47], s30 offen lds
    buffer_load_dwordx4 v61, s[44:47], s30 offen offset:1024 lds
    buffer_load_dwordx4 v253, s[44:47], s31 offen offset:2048 lds

    s_add_u32 s26, s39, 7
    s_cmp_ge_u32 s26, 12
    s_cselect_b32 s27, 12, 0
    s_sub_u32 s26, s26, s27
    s_mul_i32 s26, s26, 64

    s_mov_b32 m0, 28672
    s_add_u32 s30, s26, 0
    s_add_u32 s31, s26, 23552
    s_add_u32 s32, s26, 47104
    buffer_load_dwordx4 v60, s[40:43], s30 offen offset:0 lds
    buffer_load_dwordx4 v60, s[40:43], s31 offen offset:1024 lds
    buffer_load_dwordx4 v60, s[40:43], s32 offen offset:2048 lds
    s_mov_b32 m0, 94216
    s_add_u32 s30, s26, 6144
    s_add_u32 s31, s26, 29696
    s_add_u32 s32, s26, 53248
    buffer_load_dwordx4 v60, s[40:43], s30 offen offset:0 lds
    buffer_load_dwordx4 v60, s[40:43], s31 offen offset:1024 lds
    buffer_load_dwordx4 v60, s[40:43], s32 offen offset:2048 lds

    s_add_u32 s26, s39, 5
    s_cmp_ge_u32 s26, 12
    s_cselect_b32 s27, 12, 0
    s_sub_u32 s26, s26, s27
    s_mul_i32 s26, s26, 6144

    s_mov_b32 m0, 31744
    s_add_u32 s30, s26, 0
    s_add_u32 s31, s26, 1536
    buffer_load_dwordx4 v253, s[44:47], s30 offen lds
    buffer_load_dwordx4 v61, s[44:47], s30 offen offset:1024 lds
    buffer_load_dwordx4 v253, s[44:47], s31 offen offset:2048 lds
    s_mov_b32 m0, 97288
    s_add_u32 s30, s26, 1536
    s_add_u32 s31, s26, 3072
    buffer_load_dwordx4 v253, s[44:47], s30 offen lds
    buffer_load_dwordx4 v61, s[44:47], s30 offen offset:1024 lds
    buffer_load_dwordx4 v253, s[44:47], s31 offen offset:2048 lds
    v_mov_b32 v254, 161976
    v_mov_b32 v64, 10
    s_waitcnt vmcnt(24)
    ds_write_b32 v254, v64
    v_mov_b32 v65, 11
    s_waitcnt vmcnt(18)
    ds_write_b32 v254, v65
    v_mov_b32 v66, 12
    s_waitcnt vmcnt(12)
    ds_write_b32 v254, v66
    v_mov_b32 v67, 13
    s_waitcnt vmcnt(6)
    ds_write_b32 v254, v67
    v_mov_b32 v68, 14
    s_waitcnt vmcnt(0)
    ds_write_b32 v254, v68
    v_add_u32 v254, 161948, v240

    s_mov_b32 s29, 200000
L_wg3:
    ds_read_b32 v255, v254
    s_waitcnt lgkmcnt(0)
    v_cmp_ne_u32 vcc, 0, v255
    s_cmp_eq_u64 vcc, exec
    s_cbranch_scc1 L_wg3_ok
    s_sleep 2
    s_sub_u32 s29, s29, 1
    s_cmp_lg_u32 s29, 0
    s_cbranch_scc1 L_wg3
L_wg3_ok:

    s_add_u32 s26, s39, 8
    s_cmp_ge_u32 s26, 12
    s_cselect_b32 s27, 12, 0
    s_sub_u32 s26, s26, s27
    s_mul_i32 s26, s26, 64

    s_mov_b32 m0, 34816
    s_add_u32 s30, s26, 0
    s_add_u32 s31, s26, 23552
    s_add_u32 s32, s26, 47104
    buffer_load_dwordx4 v60, s[40:43], s30 offen offset:0 lds
    buffer_load_dwordx4 v60, s[40:43], s31 offen offset:1024 lds
    buffer_load_dwordx4 v60, s[40:43], s32 offen offset:2048 lds
    s_mov_b32 m0, 100360
    s_add_u32 s30, s26, 6144
    s_add_u32 s31, s26, 29696
    s_add_u32 s32, s26, 53248
    buffer_load_dwordx4 v60, s[40:43], s30 offen offset:0 lds
    buffer_load_dwordx4 v60, s[40:43], s31 offen offset:1024 lds
    buffer_load_dwordx4 v60, s[40:43], s32 offen offset:2048 lds

    s_add_u32 s26, s39, 6
    s_cmp_ge_u32 s26, 12
    s_cselect_b32 s27, 12, 0
    s_sub_u32 s26, s26, s27
    s_mul_i32 s26, s26, 6144

    s_mov_b32 m0, 37888
    s_add_u32 s30, s26, 0
    s_add_u32 s31, s26, 1536
    buffer_load_dwordx4 v253, s[44:47], s30 offen lds
    buffer_load_dwordx4 v61, s[44:47], s30 offen offset:1024 lds
    buffer_load_dwordx4 v253, s[44:47], s31 offen offset:2048 lds
    s_mov_b32 m0, 103432
    s_add_u32 s30, s26, 1536
    s_add_u32 s31, s26, 3072
    buffer_load_dwordx4 v253, s[44:47], s30 offen lds
    buffer_load_dwordx4 v61, s[44:47], s30 offen offset:1024 lds
    buffer_load_dwordx4 v253, s[44:47], s31 offen offset:2048 lds

    s_add_u32 s26, s39, 9
    s_cmp_ge_u32 s26, 12
    s_cselect_b32 s27, 12, 0
    s_sub_u32 s26, s26, s27
    s_mul_i32 s26, s26, 64

    s_mov_b32 m0, 40960
    s_add_u32 s30, s26, 0
    s_add_u32 s31, s26, 23552
    s_add_u32 s32, s26, 47104
    buffer_load_dwordx4 v60, s[40:43], s30 offen offset:0 lds
    buffer_load_dwordx4 v60, s[40:43], s31 offen offset:1024 lds
    buffer_load_dwordx4 v60, s[40:43], s32 offen offset:2048 lds
    s_mov_b32 m0, 106504
    s_add_u32 s30, s26, 6144
    s_add_u32 s31, s26, 29696
    s_add_u32 s32, s26, 53248
    buffer_load_dwordx4 v60, s[40:43], s30 offen offset:0 lds
    buffer_load_dwordx4 v60, s[40:43], s31 offen offset:1024 lds
    buffer_load_dwordx4 v60, s[40:43], s32 offen offset:2048 lds

    s_add_u32 s26, s39, 7
    s_cmp_ge_u32 s26, 12
    s_cselect_b32 s27, 12, 0
    s_sub_u32 s26, s26, s27
    s_mul_i32 s26, s26, 6144

    s_mov_b32 m0, 44032
    s_add_u32 s30, s26, 0
    s_add_u32 s31, s26, 1536
    buffer_load_dwordx4 v253, s[44:47], s30 offen lds
    buffer_load_dwordx4 v61, s[44:47], s30 offen offset:1024 lds
    buffer_load_dwordx4 v253, s[44:47], s31 offen offset:2048 lds
    s_mov_b32 m0, 109576
    s_add_u32 s30, s26, 1536
    s_add_u32 s31, s26, 3072
    buffer_load_dwordx4 v253, s[44:47], s30 offen lds
    buffer_load_dwordx4 v61, s[44:47], s30 offen offset:1024 lds
    buffer_load_dwordx4 v253, s[44:47], s31 offen offset:2048 lds

    s_add_u32 s26, s39, 10
    s_cmp_ge_u32 s26, 12
    s_cselect_b32 s27, 12, 0
    s_sub_u32 s26, s26, s27
    s_mul_i32 s26, s26, 64

    s_mov_b32 m0, 47104
    s_add_u32 s30, s26, 0
    s_add_u32 s31, s26, 23552
    s_add_u32 s32, s26, 47104
    buffer_load_dwordx4 v60, s[40:43], s30 offen offset:0 lds
    buffer_load_dwordx4 v60, s[40:43], s31 offen offset:1024 lds
    buffer_load_dwordx4 v60, s[40:43], s32 offen offset:2048 lds
    s_mov_b32 m0, 112648
    s_add_u32 s30, s26, 6144
    s_add_u32 s31, s26, 29696
    s_add_u32 s32, s26, 53248
    buffer_load_dwordx4 v60, s[40:43], s30 offen offset:0 lds
    buffer_load_dwordx4 v60, s[40:43], s31 offen offset:1024 lds
    buffer_load_dwordx4 v60, s[40:43], s32 offen offset:2048 lds

    s_add_u32 s26, s39, 8
    s_cmp_ge_u32 s26, 12
    s_cselect_b32 s27, 12, 0
    s_sub_u32 s26, s26, s27
    s_mul_i32 s26, s26, 6144

    s_mov_b32 m0, 50176
    s_add_u32 s30, s26, 0
    s_add_u32 s31, s26, 1536
    buffer_load_dwordx4 v253, s[44:47], s30 offen lds
    buffer_load_dwordx4 v61, s[44:47], s30 offen offset:1024 lds
    buffer_load_dwordx4 v253, s[44:47], s31 offen offset:2048 lds
    s_mov_b32 m0, 115720
    s_add_u32 s30, s26, 1536
    s_add_u32 s31, s26, 3072
    buffer_load_dwordx4 v253, s[44:47], s30 offen lds
    buffer_load_dwordx4 v61, s[44:47], s30 offen offset:1024 lds
    buffer_load_dwordx4 v253, s[44:47], s31 offen offset:2048 lds

    s_add_u32 s26, s39, 11
    s_cmp_ge_u32 s26, 12
    s_cselect_b32 s27, 12, 0
    s_sub_u32 s26, s26, s27
    s_mul_i32 s26, s26, 64

    s_mov_b32 m0, 53248
    s_add_u32 s30, s26, 0
    s_add_u32 s31, s26, 23552
    s_add_u32 s32, s26, 47104
    buffer_load_dwordx4 v60, s[40:43], s30 offen offset:0 lds
    buffer_load_dwordx4 v60, s[40:43], s31 offen offset:1024 lds
    buffer_load_dwordx4 v60, s[40:43], s32 offen offset:2048 lds
    s_mov_b32 m0, 118792
    s_add_u32 s30, s26, 6144
    s_add_u32 s31, s26, 29696
    s_add_u32 s32, s26, 53248
    buffer_load_dwordx4 v60, s[40:43], s30 offen offset:0 lds
    buffer_load_dwordx4 v60, s[40:43], s31 offen offset:1024 lds
    buffer_load_dwordx4 v60, s[40:43], s32 offen offset:2048 lds

    s_add_u32 s26, s39, 9
    s_cmp_ge_u32 s26, 12
    s_cselect_b32 s27, 12, 0
    s_sub_u32 s26, s26, s27
    s_mul_i32 s26, s26, 6144

    s_mov_b32 m0, 56320
    s_add_u32 s30, s26, 0
    s_add_u32 s31, s26, 1536
    buffer_load_dwordx4 v253, s[44:47], s30 offen lds
    buffer_load_dwordx4 v61, s[44:47], s30 offen offset:1024 lds
    buffer_load_dwordx4 v253, s[44:47], s31 offen offset:2048 lds
    s_mov_b32 m0, 121864
    s_add_u32 s30, s26, 1536
    s_add_u32 s31, s26, 3072
    buffer_load_dwordx4 v253, s[44:47], s30 offen lds
    buffer_load_dwordx4 v61, s[44:47], s30 offen offset:1024 lds
    buffer_load_dwordx4 v253, s[44:47], s31 offen offset:2048 lds

    s_add_u32 s26, s39, 10
    s_cmp_ge_u32 s26, 12
    s_cselect_b32 s27, 12, 0
    s_sub_u32 s26, s26, s27
    s_mul_i32 s26, s26, 6144

    s_mov_b32 m0, 59392
    s_add_u32 s30, s26, 0
    s_add_u32 s31, s26, 1536
    buffer_load_dwordx4 v253, s[44:47], s30 offen lds
    buffer_load_dwordx4 v61, s[44:47], s30 offen offset:1024 lds
    buffer_load_dwordx4 v253, s[44:47], s31 offen offset:2048 lds
    s_mov_b32 m0, 124936
    s_add_u32 s30, s26, 1536
    s_add_u32 s31, s26, 3072
    buffer_load_dwordx4 v253, s[44:47], s30 offen lds
    buffer_load_dwordx4 v61, s[44:47], s30 offen offset:1024 lds
    buffer_load_dwordx4 v253, s[44:47], s31 offen offset:2048 lds

    s_add_u32 s26, s39, 11
    s_cmp_ge_u32 s26, 12
    s_cselect_b32 s27, 12, 0
    s_sub_u32 s26, s26, s27
    s_mul_i32 s26, s26, 6144

    s_mov_b32 m0, 62464
    s_add_u32 s30, s26, 0
    s_add_u32 s31, s26, 1536
    buffer_load_dwordx4 v253, s[44:47], s30 offen lds
    buffer_load_dwordx4 v61, s[44:47], s30 offen offset:1024 lds
    buffer_load_dwordx4 v253, s[44:47], s31 offen offset:2048 lds
    s_mov_b32 m0, 128008
    s_add_u32 s30, s26, 1536
    s_add_u32 s31, s26, 3072
    buffer_load_dwordx4 v253, s[44:47], s30 offen lds
    buffer_load_dwordx4 v61, s[44:47], s30 offen offset:1024 lds
    buffer_load_dwordx4 v253, s[44:47], s31 offen offset:2048 lds
    v_mov_b32 v254, 161976
    v_mov_b32 v64, 15
    s_waitcnt vmcnt(54)
    ds_write_b32 v254, v64
    v_mov_b32 v65, 16
    s_waitcnt vmcnt(48)
    ds_write_b32 v254, v65
    v_mov_b32 v66, 17
    s_waitcnt vmcnt(42)
    ds_write_b32 v254, v66
    v_mov_b32 v67, 18
    s_waitcnt vmcnt(36)
    ds_write_b32 v254, v67
    v_mov_b32 v68, 19
    s_waitcnt vmcnt(30)
    ds_write_b32 v254, v68
    v_mov_b32 v69, 20
    s_waitcnt vmcnt(24)
    ds_write_b32 v254, v69
    v_mov_b32 v70, 21
    s_waitcnt vmcnt(18)
    ds_write_b32 v254, v70
    v_mov_b32 v71, 22
    s_waitcnt vmcnt(12)
    ds_write_b32 v254, v71
    v_mov_b32 v72, 23
    s_waitcnt vmcnt(6)
    ds_write_b32 v254, v72
    v_mov_b32 v73, 24
    s_waitcnt vmcnt(0)
    ds_write_b32 v254, v73
L_p2:
    s_cmp_lg_u32 s16, 1
    s_cbranch_scc1 L_nodma0
    s_setprio 3

    v_lshrrev_b32 v176, 9, v253
    v_mul_u32_u24 v177, 1536, v176
    v_add_u32 v177, v177, v253
    v_bfe_u32 v254, v253, 6, 3
    v_lshl_add_u32 v176, v176, 4, v254
    v_mul_u32_u24 v176, 768, v176
    v_and_b32 v254, 48, v253
    v_add_u32 v176, v176, v254

    v_add_u32 v254, 161924, v240

    s_mov_b32 s29, 200000
L_wg0:
    ds_read_b32 v255, v254
    s_waitcnt lgkmcnt(0)
    v_cmp_ne_u32 vcc, 0, v255
    s_cmp_eq_u64 vcc, exec
    s_cbranch_scc1 L_wg0_ok
    s_sleep 2
    s_sub_u32 s29, s29, 1
    s_cmp_lg_u32 s29, 0
    s_cbranch_scc1 L_wg0
L_wg0_ok:

    s_add_u32 s26, s39, 0
    s_cmp_ge_u32 s26, 12
    s_cselect_b32 s27, 12, 0
    s_sub_u32 s26, s26, s27
    s_mul_i32 s26, s26, 64

    s_mov_b32 m0, 131080
    s_add_u32 s30, s26, 0
    s_add_u32 s31, s26, 23552
    s_add_u32 s32, s26, 47104
    buffer_load_dwordx4 v176, s[40:43], s30 offen offset:0 lds
    buffer_load_dwordx4 v176, s[40:43], s31 offen offset:1024 lds
    buffer_load_dwordx4 v176, s[40:43], s32 offen offset:2048 lds
    s_mov_b32 m0, 146448
    s_add_u32 s30, s26, 6144
    s_add_u32 s31, s26, 29696
    s_add_u32 s32, s26, 53248
    buffer_load_dwordx4 v176, s[40:43], s30 offen offset:0 lds
    buffer_load_dwordx4 v176, s[40:43], s31 offen offset:1024 lds
    buffer_load_dwordx4 v176, s[40:43], s32 offen offset:2048 lds

    s_add_u32 s26, s39, 1
    s_cmp_ge_u32 s26, 12
    s_cselect_b32 s27, 12, 0
    s_sub_u32 s26, s26, s27
    s_mul_i32 s26, s26, 64

    s_mov_b32 m0, 134152
    s_add_u32 s30, s26, 0
    s_add_u32 s31, s26, 23552
    s_add_u32 s32, s26, 47104
    buffer_load_dwordx4 v176, s[40:43], s30 offen offset:0 lds
    buffer_load_dwordx4 v176, s[40:43], s31 offen offset:1024 lds
    buffer_load_dwordx4 v176, s[40:43], s32 offen offset:2048 lds
    s_mov_b32 m0, 149520
    s_add_u32 s30, s26, 6144
    s_add_u32 s31, s26, 29696
    s_add_u32 s32, s26, 53248
    buffer_load_dwordx4 v176, s[40:43], s30 offen offset:0 lds
    buffer_load_dwordx4 v176, s[40:43], s31 offen offset:1024 lds
    buffer_load_dwordx4 v176, s[40:43], s32 offen offset:2048 lds

    s_add_u32 s26, s39, 2
    s_cmp_ge_u32 s26, 12
    s_cselect_b32 s27, 12, 0
    s_sub_u32 s26, s26, s27
    s_mul_i32 s26, s26, 64

    s_mov_b32 m0, 137224
    s_add_u32 s30, s26, 0
    s_add_u32 s31, s26, 23552
    s_add_u32 s32, s26, 47104
    buffer_load_dwordx4 v176, s[40:43], s30 offen offset:0 lds
    buffer_load_dwordx4 v176, s[40:43], s31 offen offset:1024 lds
    buffer_load_dwordx4 v176, s[40:43], s32 offen offset:2048 lds
    s_mov_b32 m0, 152592
    s_add_u32 s30, s26, 6144
    s_add_u32 s31, s26, 29696
    s_add_u32 s32, s26, 53248
    buffer_load_dwordx4 v176, s[40:43], s30 offen offset:0 lds
    buffer_load_dwordx4 v176, s[40:43], s31 offen offset:1024 lds
    buffer_load_dwordx4 v176, s[40:43], s32 offen offset:2048 lds

    s_add_u32 s26, s39, 0
    s_cmp_ge_u32 s26, 12
    s_cselect_b32 s27, 12, 0
    s_sub_u32 s26, s26, s27
    s_mul_i32 s26, s26, 6144

    s_mov_b32 m0, 140296
    s_add_u32 s30, s26, 0
    s_add_u32 s31, s26, 1536
    buffer_load_dwordx4 v253, s[44:47], s30 offen lds
    buffer_load_dwordx4 v177, s[44:47], s30 offen offset:1024 lds
    buffer_load_dwordx4 v253, s[44:47], s31 offen offset:2048 lds
    s_mov_b32 m0, 155664
    s_add_u32 s30, s26, 1536
    s_add_u32 s31, s26, 3072
    buffer_load_dwordx4 v253, s[44:47], s30 offen lds
    buffer_load_dwordx4 v177, s[44:47], s30 offen offset:1024 lds
    buffer_load_dwordx4 v253, s[44:47], s31 offen offset:2048 lds

    s_add_u32 s26, s39, 3
    s_cmp_ge_u32 s26, 12
    s_cselect_b32 s27, 12, 0
    s_sub_u32 s26, s26, s27
    s_mul_i32 s26, s26, 64

    s_mov_b32 m0, 143368
    s_add_u32 s30, s26, 0
    s_add_u32 s31, s26, 23552
    s_add_u32 s32, s26, 47104
    buffer_load_dwordx4 v176, s[40:43], s30 offen offset:0 lds
    buffer_load_dwordx4 v176, s[40:43], s31 offen offset:1024 lds
    buffer_load_dwordx4 v176, s[40:43], s32 offen offset:2048 lds
    s_mov_b32 m0, 158736
    s_add_u32 s30, s26, 6144
    s_add_u32 s31, s26, 29696
    s_add_u32 s32, s26, 53248
    buffer_load_dwordx4 v176, s[40:43], s30 offen offset:0 lds
    buffer_load_dwordx4 v176, s[40:43], s31 offen offset:1024 lds
    buffer_load_dwordx4 v176, s[40:43], s32 offen offset:2048 lds
    v_mov_b32 v254, 161976
    v_mov_b32 v180, 1
    s_waitcnt vmcnt(24)
    ds_write_b32 v254, v180
    v_mov_b32 v181, 2
    s_waitcnt vmcnt(18)
    ds_write_b32 v254, v181
    v_mov_b32 v182, 3
    s_waitcnt vmcnt(12)
    ds_write_b32 v254, v182
    v_mov_b32 v183, 4
    s_waitcnt vmcnt(6)
    ds_write_b32 v254, v183
    v_mov_b32 v184, 5
    s_waitcnt vmcnt(0)
    ds_write_b32 v254, v184
L_nodma0:
    v_mov_b32 v254, 161980

    s_mov_b32 s29, 200000
L_wi:
    ds_read_b32 v255, v254
    s_waitcnt lgkmcnt(0)
    v_cmp_eq_u32 vcc, 2, v255
    s_cmp_eq_u64 vcc, exec
    s_cbranch_scc1 L_wi_ok
    s_sleep 2
    s_sub_u32 s29, s29, 1
    s_cmp_lg_u32 s29, 0
    s_cbranch_scc1 L_wi
L_wi_ok:

    v_bfe_u32 v176, v253, 6, 2
    v_and_b32 v177, 48, v253
    v_lshrrev_b32 v178, 9, v253
    v_lshl_add_u32 v176, v178, 3, v176
    v_lshl_add_u32 v254, v176, 6, v177
    v_mul_u32_u24 v176, 192, v176
    v_add_u32 v255, v176, v177
    v_bfe_u32 v176, v253, 8, 1
    v_mul_u32_u24 v177, 65544, v176
    v_add_u32 v254, v254, v177
    v_add_u32 v255, v255, v177
    v_lshrrev_b32 v176, 8, v253
    v_bfe_u32 v177, v253, 6, 2
    v_cmp_eq_u32 vcc, v176, v177
    v_and_b32 v176, 16, v253
    v_mov_b32 v177, 0x3f80
    v_lshlrev_b32 v176, v176, v177
    v_cndmask_b32 v176, 0, v176, vcc
    v_and_b32 v177, 32, v253
    v_cmp_eq_u32 vcc, 0, v177
    s_nop 1
    v_cndmask_b32 v242, 0, v176, vcc
    v_sub_u32 v243, v176, v242
    s_mov_b32 s84, 0xc4eac4ea
    s_mov_b32 s85, 0x377f377f
    s_mov_b32 s83, 0x766fde6e
    s_mov_b32 s86, 0x00003f80
    s_mov_b32 s87, 0x3f800000
    s_mov_b32 s17, 0
    s_mov_b32 s19, 0

    s_setprio 1
L_mtile:

    v_bfe_u32 v224, v253, 8, 1
    v_mul_u32_u24 v224, 50176, v224
    v_subrev_u32 v224, 131080, v224
    v_sub_u32 v254, v254, v224
    s_cmp_lt_u32 s19, 1
    s_cbranch_scc1 L_rd1_slow
L_rd1_go:
    ds_read_b64_tr_b16 v[224:225], v254 offset:0
    ds_read_b64_tr_b16 v[226:227], v254 offset:256
    ds_read_b64_tr_b16 v[228:229], v254 offset:1024
    ds_read_b64_tr_b16 v[230:231], v254 offset:1280
    ds_read_b64_tr_b16 v[232:233], v254 offset:2048
    ds_read_b64_tr_b16 v[234:235], v254 offset:2304
    ds_read_b64_tr_b16 v[236:237], v254 offset:8
    ds_read_b64_tr_b16 v[238:239], v254 offset:264
    s_waitcnt vmcnt(12)
    s_waitcnt lgkmcnt(6)
    v_mfma_f32_16x16x32_bf16 v[176:179], v[224:227], v[0:3], 0
    v_mfma_f32_16x16x32_bf16 v[180:183], v[224:227], v[4:7], 0
    v_mfma_f32_16x16x32_bf16 v[184:187], v[224:227], v[8:11], 0
    v_mfma_f32_16x16x32_bf16 v[188:191], v[224:227], v[12:15], 0
    ds_read_b64_tr_b16 v[224:225], v254 offset:1032
    s_waitcnt lgkmcnt(5)
    v_mfma_f32_16x16x32_bf16 v[176:179], v[228:231], v[16:19], v[176:179]
    ds_read_b64_tr_b16 v[226:227], v254 offset:1288
    v_mfma_f32_16x16x32_bf16 v[180:183], v[228:231], v[20:23], v[180:183]
    v_mfma_f32_16x16x32_bf16 v[184:187], v[228:231], v[24:27], v[184:187]
    v_mfma_f32_16x16x32_bf16 v[188:191], v[228:231], v[28:31], v[188:191]
    ds_read_b64_tr_b16 v[228:229], v254 offset:2056
    s_waitcnt lgkmcnt(5)
    v_mfma_f32_16x16x32_bf16 v[176:179], v[232:235], v[32:35], v[176:179]
    ds_read_b64_tr_b16 v[230:231], v254 offset:2312
    v_mfma_f32_16x16x32_bf16 v[180:183], v[232:235], v[36:39], v[180:183]
    v_mfma_f32_16x16x32_bf16 v[184:187], v[232:235], v[40:43], v[184:187]
    v_mfma_f32_16x16x32_bf16 v[188:191], v[232:235], v[44:47], v[188:191]
    s_cmp_lt_u32 s19, 2
    s_cbranch_scc1 L_rd2_slow
L_rd2_go:
    ds_read_b64_tr_b16 v[232:233], v254 offset:3072
    s_waitcnt lgkmcnt(5)
    v_mfma_f32_16x16x32_bf16 v[192:195], v[236:239], v[0:3], 0
    ds_read_b64_tr_b16 v[234:235], v254 offset:3328
    v_mfma_f32_16x16x32_bf16 v[196:199], v[236:239], v[4:7], 0
    v_mfma_f32_16x16x32_bf16 v[200:203], v[236:239], v[8:11], 0
    v_lshlrev_b32_sdwa v176, 1, v176 dst_sel:DWORD dst_unused:UNUSED_PAD src0_sel:DWORD src1_sel:WORD_1
    v_fma_mixlo_f16 v188, v188, s83, 0
    v_fma_mixlo_f16 v190, v190, s83, 0
    v_mfma_f32_16x16x32_bf16 v[204:207], v[236:239], v[12:15], 0
    ds_read_b64_tr_b16 v[236:237], v254 offset:4096
    ds_read_b64_tr_b16 v[238:239], v254 offset:4352
    v_lshlrev_b32_sdwa v177, 1, v177 dst_sel:DWORD dst_unused:UNUSED_PAD src0_sel:DWORD src1_sel:WORD_1
    v_fma_mixhi_f16 v188, v189, s83, 0
    v_lshlrev_b32_sdwa v178, 1, v178 dst_sel:DWORD dst_unused:UNUSED_PAD src0_sel:DWORD src1_sel:WORD_1
    s_waitcnt lgkmcnt(6)
    v_mfma_f32_16x16x32_bf16 v[192:195], v[224:227], v[16:19], v[192:195]
    ds_read_u16_d16 v176, v176
    v_fma_mixhi_f16 v190, v191, s83, 0
    v_pk_fma_f16 v189, v188, v188, s84 neg_lo:[0,1,0] neg_hi:[0,1,0]
    v_lshlrev_b32_sdwa v179, 1, v179 dst_sel:DWORD dst_unused:UNUSED_PAD src0_sel:DWORD src1_sel:WORD_1
    v_mfma_f32_16x16x32_bf16 v[196:199], v[224:227], v[20:23], v[196:199]
    ds_read_u16_d16_hi v177, v177
    ds_read_u16_d16 v178, v178
    v_pk_fma_f16 v191, v190, v190, s84 neg_lo:[0,1,0] neg_hi:[0,1,0]
    v_lshlrev_b32_sdwa v180, 1, v180 dst_sel:DWORD dst_unused:UNUSED_PAD src0_sel:DWORD src1_sel:WORD_1
    v_pk_mul_f16 v189, v189, v188
    v_mfma_f32_16x16x32_bf16 v[200:203], v[224:227], v[24:27], v[200:203]
    ds_read_u16_d16_hi v179, v179
    v_pk_mul_f16 v191, v191, v190
    v_lshlrev_b32_sdwa v181, 1, v181 dst_sel:DWORD dst_unused:UNUSED_PAD src0_sel:DWORD src1_sel:WORD_1
    v_exp_f16_sdwa v189, v189 dst_sel:WORD_0 dst_unused:UNUSED_PRESERVE src0_sel:WORD_0
    v_mfma_f32_16x16x32_bf16 v[204:207], v[224:227], v[28:31], v[204:207]
    ds_read_b64_tr_b16 v[224:225], v254 offset:5120
    ds_read_b64_tr_b16 v[226:227], v254 offset:5376
    v_lshlrev_b32_sdwa v182, 1, v182 dst_sel:DWORD dst_unused:UNUSED_PAD src0_sel:DWORD src1_sel:WORD_1
    v_exp_f16_sdwa v191, v191 dst_sel:WORD_0 dst_unused:UNUSED_PRESERVE src0_sel:WORD_0
    s_waitcnt lgkmcnt(10)
    v_mfma_f32_16x16x32_bf16 v[192:195], v[228:231], v[32:35], v[192:195]
    ds_read_u16_d16 v180, v180
    v_lshlrev_b32_sdwa v183, 1, v183 dst_sel:DWORD dst_unused:UNUSED_PAD src0_sel:DWORD src1_sel:WORD_1
    v_lshlrev_b32_sdwa v184, 1, v184 dst_sel:DWORD dst_unused:UNUSED_PAD src0_sel:DWORD src1_sel:WORD_1
    v_mfma_f32_16x16x32_bf16 v[196:199], v[228:231], v[36:39], v[196:199]
    ds_read_u16_d16_hi v181, v181
    ds_read_u16_d16 v182, v182
    v_exp_f16_sdwa v189, v189 dst_sel:WORD_1 dst_unused:UNUSED_PRESERVE src0_sel:WORD_1
    v_lshlrev_b32_sdwa v185, 1, v185 dst_sel:DWORD dst_unused:UNUSED_PAD src0_sel:DWORD src1_sel:WORD_1
    v_mfma_f32_16x16x32_bf16 v[200:203], v[228:231], v[40:43], v[200:203]
    ds_read_u16_d16_hi v183, v183
    v_exp_f16_sdwa v191, v191 dst_sel:WORD_1 dst_unused:UNUSED_PRESERVE src0_sel:WORD_1
    v_lshlrev_b32_sdwa v186, 1, v186 dst_sel:DWORD dst_unused:UNUSED_PAD src0_sel:DWORD src1_sel:WORD_1
    v_mfma_f32_16x16x32_bf16 v[204:207], v[228:231], v[44:47], v[204:207]
    ds_read_b64_tr_b16 v[228:229], v254 offset:3080
    ds_read_b64_tr_b16 v[230:231], v254 offset:3336
    ds_read_u16_d16 v184, v184
    v_pk_fma_f16 v189, v189, s85, s85
    v_lshlrev_b32_sdwa v187, 1, v187 dst_sel:DWORD dst_unused:UNUSED_PAD src0_sel:DWORD src1_sel:WORD_1
    v_pk_fma_f16 v191, v191, s85, s85
    s_waitcnt lgkmcnt(14)
    v_mfma_f32_16x16x32_bf16 v[208:211], v[232:235], v[0:3], 0
    ds_read_u16_d16_hi v185, v185
    v_mfma_f32_16x16x32_bf16 v[212:215], v[232:235], v[4:7], 0
    ds_read_u16_d16 v186, v186
    ds_read_u16_d16_hi v187, v187
    v_mfma_f32_16x16x32_bf16 v[216:219], v[232:235], v[8:11], 0
    s_waitcnt lgkmcnt(14)
    v_or_b32 v144, v176, v177
    v_rcp_f16_sdwa v189, v189 dst_sel:WORD_0 dst_unused:UNUSED_PRESERVE src0_sel:WORD_0
    v_lshlrev_b32_sdwa v192, 1, v192 dst_sel:DWORD dst_unused:UNUSED_PAD src0_sel:DWORD src1_sel:WORD_1
    v_mfma_f32_16x16x32_bf16 v[220:223], v[232:235], v[12:15], 0
    ds_read_b64_tr_b16 v[232:233], v254 offset:4104
    v_rcp_f16_sdwa v191, v191 dst_sel:WORD_0 dst_unused:UNUSED_PRESERVE src0_sel:WORD_0
    v_lshlrev_b32_sdwa v193, 1, v193 dst_sel:DWORD dst_unused:UNUSED_PAD src0_sel:DWORD src1_sel:WORD_1
    s_waitcnt lgkmcnt(13)
    v_or_b32 v145, v178, v179
    v_fma_mixlo_f16 v206, v206, s83, 0
    v_mfma_f32_16x16x32_bf16 v[208:211], v[236:239], v[16:19], v[208:211]
    ds_read_b64_tr_b16 v[234:235], v254 offset:4360
    ds_read_u16_d16 v192, v192
    v_lshlrev_b32_sdwa v194, 1, v194 dst_sel:DWORD dst_unused:UNUSED_PAD src0_sel:DWORD src1_sel:WORD_1
    v_rcp_f16_sdwa v189, v189 dst_sel:WORD_1 dst_unused:UNUSED_PRESERVE src0_sel:WORD_1
    v_lshlrev_b32_sdwa v195, 1, v195 dst_sel:DWORD dst_unused:UNUSED_PAD src0_sel:DWORD src1_sel:WORD_1
    v_mfma_f32_16x16x32_bf16 v[212:215], v[236:239], v[20:23], v[212:215]
    ds_read_u16_d16_hi v193, v193
    ds_read_u16_d16 v194, v194
    s_waitcnt lgkmcnt(13)
    v_or_b32 v148, v180, v181
    v_rcp_f16_sdwa v191, v191 dst_sel:WORD_1 dst_unused:UNUSED_PRESERVE src0_sel:WORD_1
    v_lshlrev_b32_sdwa v196, 1, v196 dst_sel:DWORD dst_unused:UNUSED_PAD src0_sel:DWORD src1_sel:WORD_1
    v_mfma_f32_16x16x32_bf16 v[216:219], v[236:239], v[24:27], v[216:219]
    ds_read_u16_d16_hi v195, v195
    v_fma_mixhi_f16 v206, v207, s83, 0
    v_lshlrev_b32_sdwa v197, 1, v197 dst_sel:DWORD dst_unused:UNUSED_PAD src0_sel:DWORD src1_sel:WORD_1
    v_fma_mix_f32 v156, v188, v189, 0 op_sel_hi:[1,1,0]
    s_waitcnt lgkmcnt(12)
    v_or_b32 v149, v182, v183
    v_fma_mix_f32 v157, v190, v191, 0 op_sel_hi:[1,1,0]
    v_mfma_f32_16x16x32_bf16 v[220:223], v[236:239], v[28:31], v[220:223]
    ds_read_b64_tr_b16 v[236:237], v254 offset:5128
    ds_read_b64_tr_b16 v[238:239], v254 offset:5384
    v_lshlrev_b32_sdwa v198, 1, v198 dst_sel:DWORD dst_unused:UNUSED_PAD src0_sel:DWORD src1_sel:WORD_1
    v_pk_fma_f16 v207, v206, v206, s84 neg_lo:[0,1,0] neg_hi:[0,1,0]
    v_lshlrev_b32_sdwa v199, 1, v199 dst_sel:DWORD dst_unused:UNUSED_PAD src0_sel:DWORD src1_sel:WORD_1
    v_fma_mix_f32 v189, v188, v189, 0 op_sel:[1,1,0] op_sel_hi:[1,1,0]
    v_mfma_f32_16x16x32_bf16 v[208:211], v[224:227], v[32:35], v[208:211]
    ds_read_u16_d16 v196, v196
    ds_read_u16_d16_hi v197, v197
    s_waitcnt lgkmcnt(12)
    v_or_b32 v152, v184, v185
    v_fma_mix_f32 v191, v190, v191, 0 op_sel:[1,1,0] op_sel_hi:[1,1,0]
    v_lshlrev_b32_sdwa v200, 1, v200 dst_sel:DWORD dst_unused:UNUSED_PAD src0_sel:DWORD src1_sel:WORD_1
    v_pk_mul_f16 v207, v207, v206
    v_mfma_f32_16x16x32_bf16 v[212:215], v[224:227], v[36:39], v[212:215]
    ds_read_u16_d16 v198, v198
    v_cvt_pk_bf16_f32 v156, v156, v189
    v_lshlrev_b32_sdwa v201, 1, v201 dst_sel:DWORD dst_unused:UNUSED_PAD src0_sel:DWORD src1_sel:WORD_1
    v_cvt_pk_bf16_f32 v157, v157, v191
    s_waitcnt lgkmcnt(11)
    v_or_b32 v153, v186, v187
    v_mfma_f32_16x16x32_bf16 v[216:219], v[224:227], v[40:43], v[216:219]
    ds_read_u16_d16_hi v199, v199
    ds_read_u16_d16 v200, v200
    v_exp_f16_sdwa v207, v207 dst_sel:WORD_0 dst_unused:UNUSED_PRESERVE src0_sel:WORD_0
    v_lshlrev_b32_sdwa v202, 1, v202 dst_sel:DWORD dst_unused:UNUSED_PAD src0_sel:DWORD src1_sel:WORD_1
    v_lshlrev_b32_sdwa v203, 1, v203 dst_sel:DWORD dst_unused:UNUSED_PAD src0_sel:DWORD src1_sel:WORD_1
    v_mfma_f32_16x16x32_bf16 v[220:223], v[224:227], v[44:47], v[220:223]
    s_cmp_lt_u32 s19, 3
    s_cbranch_scc1 L_rd3_slow
L_rd3_go:
    ds_read_b64_tr_b16 v[224:225], v254 offset:6144
    ds_read_b64_tr_b16 v[226:227], v254 offset:6400
    ds_read_u16_d16_hi v201, v201
    v_exp_f16_sdwa v207, v207 dst_sel:WORD_1 dst_unused:UNUSED_PRESERVE src0_sel:WORD_1
    v_lshlrev_b32_sdwa v204, 1, v204 dst_sel:DWORD dst_unused:UNUSED_PAD src0_sel:DWORD src1_sel:WORD_1
    v_lshlrev_b32_sdwa v205, 1, v205 dst_sel:DWORD dst_unused:UNUSED_PAD src0_sel:DWORD src1_sel:WORD_1
    v_pk_fma_f16 v207, v207, s85, s85
    v_mfma_f32_16x16x32_bf16 v[176:179], v[228:231], v[0:3], 0
    ds_read_u16_d16 v202, v202
    v_mfma_f32_16x16x32_bf16 v[180:183], v[228:231], v[4:7], 0
    ds_read_u16_d16_hi v203, v203
    ds_read_u16_d16 v204, v204
    v_mfma_f32_16x16x32_bf16 v[184:187], v[228:231], v[8:11], 0
    ds_read_u16_d16_hi v205, v205
    s_waitcnt lgkmcnt(14)
    v_or_b32 v146, v192, v193
    v_rcp_f16_sdwa v207, v207 dst_sel:WORD_0 dst_unused:UNUSED_PRESERVE src0_sel:WORD_0
    v_lshlrev_b32_sdwa v208, 1, v208 dst_sel:DWORD dst_unused:UNUSED_PAD src0_sel:DWORD src1_sel:WORD_1
    v_mfma_f32_16x16x32_bf16 v[188:191], v[228:231], v[12:15], 0
    v_bfe_u32 v228, v253, 8, 1
    v_mul_u32_u24 v228, 50176, v228
    v_subrev_u32 v228, 131080, v228
    v_sub_u32 v255, v255, v228
    s_cmp_lt_u32 s19, 4
    s_cbranch_scc1 L_rd4_slow
L_rd4_go:
    ds_read_b64_tr_b16 v[228:229], v255 offset:9216
    ds_read_b64_tr_b16 v[230:231], v255 offset:9984
    v_fma_mixlo_f16 v220, v220, s83, 0
    v_lshlrev_b32_sdwa v209, 1, v209 dst_sel:DWORD dst_unused:UNUSED_PAD src0_sel:DWORD src1_sel:WORD_1
    v_fma_mixlo_f16 v222, v222, s83, 0
    v_or_b32 v147, v194, v195
    v_mfma_f32_16x16x32_bf16 v[176:179], v[232:235], v[16:19], v[176:179]
    ds_read_u16_d16 v208, v208
    v_rcp_f16_sdwa v207, v207 dst_sel:WORD_1 dst_unused:UNUSED_PRESERVE src0_sel:WORD_1
    v_lshlrev_b32_sdwa v210, 1, v210 dst_sel:DWORD dst_unused:UNUSED_PAD src0_sel:DWORD src1_sel:WORD_1
    v_fma_mixhi_f16 v220, v221, s83, 0
    v_lshlrev_b32_sdwa v211, 1, v211 dst_sel:DWORD dst_unused:UNUSED_PAD src0_sel:DWORD src1_sel:WORD_1
    v_mfma_f32_16x16x32_bf16 v[180:183], v[232:235], v[20:23], v[180:183]
    ds_read_u16_d16_hi v209, v209
    ds_read_u16_d16 v210, v210
    v_fma_mixhi_f16 v222, v223, s83, 0
    s_waitcnt lgkmcnt(14)
    v_or_b32 v150, v196, v197
    v_fma_mix_f32 v159, v206, v207, 0 op_sel_hi:[1,1,0]
    v_pk_fma_f16 v221, v220, v220, s84 neg_lo:[0,1,0] neg_hi:[0,1,0]
    v_lshlrev_b32_sdwa v212, 1, v212 dst_sel:DWORD dst_unused:UNUSED_PAD src0_sel:DWORD src1_sel:WORD_1
    v_mfma_f32_16x16x32_bf16 v[184:187], v[232:235], v[24:27], v[184:187]
    ds_read_u16_d16_hi v211, v211
    v_pk_fma_f16 v223, v222, v222, s84 neg_lo:[0,1,0] neg_hi:[0,1,0]
    v_lshlrev_b32_sdwa v213, 1, v213 dst_sel:DWORD dst_unused:UNUSED_PAD src0_sel:DWORD src1_sel:WORD_1
    v_fma_mix_f32 v207, v206, v207, 0 op_sel:[1,1,0] op_sel_hi:[1,1,0]
    s_waitcnt lgkmcnt(14)
    v_or_b32 v151, v198, v199
    v_mfma_f32_16x16x32_bf16 v[188:191], v[232:235], v[28:31], v[188:191]
    ds_read_b64_tr_b16 v[232:233], v254 offset:7168
    ds_read_b64_tr_b16 v[234:235], v254 offset:7424
    v_pk_mul_f16 v221, v221, v220
    v_pk_mul_f16 v223, v223, v222
    v_lshlrev_b32_sdwa v214, 1, v214 dst_sel:DWORD dst_unused:UNUSED_PAD src0_sel:DWORD src1_sel:WORD_1
    v_cvt_pk_bf16_f32 v159, v159, v207
    v_mfma_f32_16x16x32_bf16 v[176:179], v[236:239], v[32:35], v[176:179]
    ds_read_u16_d16 v212, v212
    v_lshlrev_b32_sdwa v215, 1, v215 dst_sel:DWORD dst_unused:UNUSED_PAD src0_sel:DWORD src1_sel:WORD_1
    v_exp_f16_sdwa v221, v221 dst_sel:WORD_0 dst_unused:UNUSED_PRESERVE src0_sel:WORD_0
    s_waitcnt lgkmcnt(13)
    v_or_b32 v154, v200, v201
    v_mfma_f32_16x16x32_bf16 v[180:183], v[236:239], v[36:39], v[180:183]
    ds_read_u16_d16_hi v213, v213
    ds_read_u16_d16 v214, v214
    v_exp_f16_sdwa v223, v223 dst_sel:WORD_0 dst_unused:UNUSED_PRESERVE src0_sel:WORD_0
    v_lshlrev_b32_sdwa v216, 1, v216 dst_sel:DWORD dst_unused:UNUSED_PAD src0_sel:DWORD src1_sel:WORD_1
    v_lshlrev_b32_sdwa v217, 1, v217 dst_sel:DWORD dst_unused:UNUSED_PAD src0_sel:DWORD src1_sel:WORD_1
    v_exp_f16_sdwa v221, v221 dst_sel:WORD_1 dst_unused:UNUSED_PRESERVE src0_sel:WORD_1
    v_mfma_f32_16x16x32_bf16 v[184:187], v[236:239], v[40:43], v[184:187]
    ds_read_u16_d16_hi v215, v215
    s_waitcnt lgkmcnt(14)
    v_or_b32 v155, v202, v203
    v_exp_f16_sdwa v223, v223 dst_sel:WORD_1 dst_unused:UNUSED_PRESERVE src0_sel:WORD_1
    v_lshlrev_b32_sdwa v218, 1, v218 dst_sel:DWORD dst_unused:UNUSED_PAD src0_sel:DWORD src1_sel:WORD_1
    v_mfma_f32_16x16x32_bf16 v[188:191], v[236:239], v[44:47], v[188:191]
    ds_read_b64_tr_b16 v[236:237], v255 offset:9224
    ds_read_b64_tr_b16 v[238:239], v255 offset:9992
    ds_read_u16_d16 v216, v216
    v_lshlrev_b32_sdwa v219, 1, v219 dst_sel:DWORD dst_unused:UNUSED_PAD src0_sel:DWORD src1_sel:WORD_1
    v_pk_fma_f16 v221, v221, s85, s85
    s_waitcnt lgkmcnt(14)
    v_or_b32 v158, v204, v205
    v_pk_fma_f16 v223, v223, s85, s85
    s_cmp_lg_u32 s38, 0
    s_cbranch_scc1 L_park
L_parked:
    v_mfma_f32_16x16x32_bf16 v[192:195], v[224:227], v[0:3], 0
    ds_read_u16_d16_hi v217, v217
    v_mfma_f32_16x16x32_bf16 v[196:199], v[224:227], v[4:7], 0
    ds_read_u16_d16 v218, v218
    v_mfma_f32_16x16x32_bf16 v[200:203], v[224:227], v[8:11], 0
    ds_read_u16_d16_hi v219, v219
    s_waitcnt lgkmcnt(14)
    v_or_b32 v160, v208, v209
    v_rcp_f16_sdwa v221, v221 dst_sel:WORD_0 dst_unused:UNUSED_PRESERVE src0_sel:WORD_0
    v_mfma_f32_16x16x32_bf16 v[204:207], v[224:227], v[12:15], 0
    ds_read_b64_tr_b16 v[224:225], v254 offset:8192
    v_lshlrev_b32_sdwa v176, 1, v176 dst_sel:DWORD dst_unused:UNUSED_PAD src0_sel:DWORD src1_sel:WORD_1
    v_mfma_f32_16x16x32_bf16 v[48:51], v[228:231], v[144:147], 0
    ds_read_b64_tr_b16 v[226:227], v254 offset:8448
    v_rcp_f16_sdwa v223, v223 dst_sel:WORD_0 dst_unused:UNUSED_PRESERVE src0_sel:WORD_0
    v_mfma_f32_16x16x32_bf16 v[56:59], v[228:231], v[148:151], 0
    ds_read_u16_d16 v176, v176
    v_lshlrev_b32_sdwa v177, 1, v177 dst_sel:DWORD dst_unused:UNUSED_PAD src0_sel:DWORD src1_sel:WORD_1
    s_waitcnt lgkmcnt(14)
    v_or_b32 v161, v210, v211
    v_mfma_f32_16x16x32_bf16 v[64:67], v[228:231], v[152:155], 0
    ds_read_u16_d16_hi v177, v177
    v_fma_mixlo_f16 v190, v190, s83, 0
    v_lshlrev_b32_sdwa v178, 1, v178 dst_sel:DWORD dst_unused:UNUSED_PAD src0_sel:DWORD src1_sel:WORD_1
    v_mfma_f32_16x16x32_bf16 v[72:75], v[228:231], v[156:159], 0
    ds_read_b64_tr_b16 v[228:229], v255 offset:9280
    v_rcp_f16_sdwa v221, v221 dst_sel:WORD_1 dst_unused:UNUSED_PRESERVE src0_sel:WORD_1
    s_waitcnt lgkmcnt(14)
    v_mfma_f32_16x16x32_bf16 v[192:195], v[232:235], v[16:19], v[192:195]
    ds_read_b64_tr_b16 v[230:231], v255 offset:10048
    v_lshlrev_b32_sdwa v179, 1, v179 dst_sel:DWORD dst_unused:UNUSED_PAD src0_sel:DWORD src1_sel:WORD_1
    s_waitcnt lgkmcnt(14)
    v_or_b32 v164, v212, v213
    v_mfma_f32_16x16x32_bf16 v[196:199], v[232:235], v[20:23], v[196:199]
    ds_read_u16_d16 v178, v178
    v_rcp_f16_sdwa v223, v223 dst_sel:WORD_1 dst_unused:UNUSED_PRESERVE src0_sel:WORD_1
    v_mfma_f32_16x16x32_bf16 v[200:203], v[232:235], v[24:27], v[200:203]
    ds_read_u16_d16_hi v179, v179
    v_lshlrev_b32_sdwa v180, 1, v180 dst_sel:DWORD dst_unused:UNUSED_PAD src0_sel:DWORD src1_sel:WORD_1
    v_fma_mixhi_f16 v190, v191, s83, 0
    v_mfma_f32_16x16x32_bf16 v[204:207], v[232:235], v[28:31], v[204:207]
    ds_read_b64_tr_b16 v[232:233], v254 offset:6152
    ds_read_b64_tr_b16 v[234:235], v254 offset:6408
    v_lshlrev_b32_sdwa v181, 1, v181 dst_sel:DWORD dst_unused:UNUSED_PAD src0_sel:DWORD src1_sel:WORD_1
    v_fma_mix_f32 v172, v220, v221, 0 op_sel_hi:[1,1,0]
    s_waitcnt lgkmcnt(14)
    v_mfma_f32_16x16x32_bf16 v[52:55], v[236:239], v[144:147], 0
    ds_read_u16_d16 v180, v180
    v_or_b32 v165, v214, v215
    v_fma_mix_f32 v173, v222, v223, 0 op_sel_hi:[1,1,0]
    v_lshlrev_b32_sdwa v182, 1, v182 dst_sel:DWORD dst_unused:UNUSED_PAD src0_sel:DWORD src1_sel:WORD_1
    v_mfma_f32_16x16x32_bf16 v[60:63], v[236:239], v[148:151], 0
    ds_read_u16_d16_hi v181, v181
    v_pk_fma_f16 v191, v190, v190, s84 neg_lo:[0,1,0] neg_hi:[0,1,0]
    v_lshlrev_b32_sdwa v183, 1, v183 dst_sel:DWORD dst_unused:UNUSED_PAD src0_sel:DWORD src1_sel:WORD_1
    v_mfma_f32_16x16x32_bf16 v[68:71], v[236:239], v[152:155], 0
    ds_read_u16_d16 v182, v182
    v_fma_mix_f32 v221, v220, v221, 0 op_sel:[1,1,0] op_sel_hi:[1,1,0]
    s_waitcnt lgkmcnt(14)
    v_or_b32 v168, v216, v217
    v_mfma_f32_16x16x32_bf16 v[76:79], v[236:239], v[156:159], 0
    ds_read_b64_tr_b16 v[236:237], v255 offset:9288
    v_fma_mix_f32 v223, v222, v223, 0 op_sel:[1,1,0] op_sel_hi:[1,1,0]
    v_lshlrev_b32_sdwa v184, 1, v184 dst_sel:DWORD dst_unused:UNUSED_PAD src0_sel:DWORD src1_sel:WORD_1
    s_waitcnt lgkmcnt(12)
    v_mfma_f32_16x16x32_bf16 v[192:195], v[224:227], v[32:35], v[192:195]
    ds_read_b64_tr_b16 v[238:239], v255 offset:10056
    v_pk_mul_f16 v191, v191, v190
    v_cvt_pk_bf16_f32 v172, v172, v221
    v_mfma_f32_16x16x32_bf16 v[196:199], v[224:227], v[36:39], v[196:199]
    ds_read_u16_d16_hi v183, v183
    v_lshlrev_b32_sdwa v185, 1, v185 dst_sel:DWORD dst_unused:UNUSED_PAD src0_sel:DWORD src1_sel:WORD_1
    v_cvt_pk_bf16_f32 v173, v173, v223
    v_mfma_f32_16x16x32_bf16 v[200:203], v[224:227], v[40:43], v[200:203]
    ds_read_u16_d16 v184, v184
    v_or_b32 v169, v218, v219
    v_mfma_f32_16x16x32_bf16 v[204:207], v[224:227], v[44:47], v[204:207]
    ds_read_b64_tr_b16 v[224:225], v254 offset:7176
    v_exp_f16_sdwa v191, v191 dst_sel:WORD_0 dst_unused:UNUSED_PRESERVE src0_sel:WORD_0
    v_lshlrev_b32_sdwa v186, 1, v186 dst_sel:DWORD dst_unused:UNUSED_PAD src0_sel:DWORD src1_sel:WORD_1
    s_waitcnt lgkmcnt(12)
    v_mfma_f32_16x16x32_bf16 v[80:83], v[228:231], v[144:147], 0
    ds_read_b64_tr_b16 v[226:227], v254 offset:7432
    v_lshlrev_b32_sdwa v187, 1, v187 dst_sel:DWORD dst_unused:UNUSED_PAD src0_sel:DWORD src1_sel:WORD_1
    v_mfma_f32_16x16x32_bf16 v[88:91], v[228:231], v[148:151], 0
    ds_read_u16_d16_hi v185, v185
    v_exp_f16_sdwa v191, v191 dst_sel:WORD_1 dst_unused:UNUSED_PRESERVE src0_sel:WORD_1
    v_lshlrev_b32_sdwa v188, 1, v188 dst_sel:DWORD dst_unused:UNUSED_PAD src0_sel:DWORD src1_sel:WORD_1
    v_mfma_f32_16x16x32_bf16 v[96:99], v[228:231], v[152:155], 0
    ds_read_u16_d16 v186, v186
    buffer_load_dwordx4 v[244:247], v252, s[4:7], s24 offen offset:0 sc1
    buffer_load_dwordx4 v[248:251], v252, s[4:7], s24 offen offset:64 sc1
    v_mfma_f32_16x16x32_bf16 v[104:107], v[228:231], v[156:159], 0
    ds_read_b64_tr_b16 v[228:229], v255 offset:9344
    ds_read_b64_tr_b16 v[230:231], v255 offset:10112
    v_lshlrev_b32_sdwa v189, 1, v189 dst_sel:DWORD dst_unused:UNUSED_PAD src0_sel:DWORD src1_sel:WORD_1
    v_pk_fma_f16 v191, v191, s85, s85
    s_waitcnt lgkmcnt(13)
    v_mfma_f32_16x16x32_bf16 v[208:211], v[232:235], v[0:3], 0
    ds_read_u16_d16_hi v187, v187
    v_or_b32 v162, v176, v177
    v_mfma_f32_16x16x32_bf16 v[212:215], v[232:235], v[4:7], 0
    ds_read_u16_d16 v188, v188
    v_rcp_f16_sdwa v191, v191 dst_sel:WORD_0 dst_unused:UNUSED_PRESERVE src0_sel:WORD_0
    v_lshlrev_b32_sdwa v192, 1, v192 dst_sel:DWORD dst_unused:UNUSED_PAD src0_sel:DWORD src1_sel:WORD_1
    v_mfma_f32_16x16x32_bf16 v[216:219], v[232:235], v[8:11], 0
    ds_read_u16_d16_hi v189, v189
    v_fma_mixlo_f16 v204, v204, s83, 0
    v_lshlrev_b32_sdwa v193, 1, v193 dst_sel:DWORD dst_unused:UNUSED_PAD src0_sel:DWORD src1_sel:WORD_1
    v_mfma_f32_16x16x32_bf16 v[220:223], v[232:235], v[12:15], 0
    ds_read_b64_tr_b16 v[232:233], v254 offset:8200
    v_fma_mixlo_f16 v206, v206, s83, 0
    s_waitcnt lgkmcnt(12)
    v_mfma_f32_16x16x32_bf16 v[84:87], v[236:239], v[144:147], 0
    ds_read_b64_tr_b16 v[234:235], v254 offset:8456
    v_or_b32 v163, v178, v179
    v_rcp_f16_sdwa v191, v191 dst_sel:WORD_1 dst_unused:UNUSED_PRESERVE src0_sel:WORD_1
    v_mfma_f32_16x16x32_bf16 v[92:95], v[236:239], v[148:151], 0
    ds_read_u16_d16 v192, v192
    v_lshlrev_b32_sdwa v194, 1, v194 dst_sel:DWORD dst_unused:UNUSED_PAD src0_sel:DWORD src1_sel:WORD_1
    v_mfma_f32_16x16x32_bf16 v[100:103], v[236:239], v[152:155], 0
    ds_read_u16_d16_hi v193, v193
    v_fma_mixhi_f16 v204, v205, s83, 0
    v_lshlrev_b32_sdwa v195, 1, v195 dst_sel:DWORD dst_unused:UNUSED_PAD src0_sel:DWORD src1_sel:WORD_1
    v_mfma_f32_16x16x32_bf16 v[108:111], v[236:239], v[156:159], 0
    ds_read_b64_tr_b16 v[236:237], v255 offset:9352
    v_fma_mixhi_f16 v206, v207, s83, 0
    v_or_b32 v166, v180, v181
    s_waitcnt lgkmcnt(12)
    v_mfma_f32_16x16x32_bf16 v[208:211], v[224:227], v[16:19], v[208:211]
    ds_read_b64_tr_b16 v[238:239], v255 offset:10120
    v_fma_mix_f32 v175, v190, v191, 0 op_sel_hi:[1,1,0]
    v_pk_fma_f16 v205, v204, v204, s84 neg_lo:[0,1,0] neg_hi:[0,1,0]
    v_mfma_f32_16x16x32_bf16 v[212:215], v[224:227], v[20:23], v[212:215]
    ds_read_u16_d16 v194, v194
    v_lshlrev_b32_sdwa v196, 1, v196 dst_sel:DWORD dst_unused:UNUSED_PAD src0_sel:DWORD src1_sel:WORD_1
    v_mfma_f32_16x16x32_bf16 v[216:219], v[224:227], v[24:27], v[216:219]
    ds_read_u16_d16_hi v195, v195
    v_pk_fma_f16 v207, v206, v206, s84 neg_lo:[0,1,0] neg_hi:[0,1,0]
    v_lshlrev_b32_sdwa v197, 1, v197 dst_sel:DWORD dst_unused:UNUSED_PAD src0_sel:DWORD src1_sel:WORD_1
    v_mfma_f32_16x16x32_bf16 v[220:223], v[224:227], v[28:31], v[220:223]
    s_cmp_lt_u32 s19, 6
    s_cbranch_scc1 L_rd6_slow
L_rd6_go:
    ds_read_b64_tr_b16 v[224:225], v254 offset:12288
    v_fma_mix_f32 v191, v190, v191, 0 op_sel:[1,1,0] op_sel_hi:[1,1,0]
    v_or_b32 v167, v182, v183
    s_waitcnt lgkmcnt(12)
    v_mfma_f32_16x16x32_bf16 v[112:115], v[228:231], v[144:147], 0
    ds_read_b64_tr_b16 v[226:227], v254 offset:12544
    v_pk_mul_f16 v205, v205, v204
    v_pk_mul_f16 v207, v207, v206
    v_mfma_f32_16x16x32_bf16 v[120:123], v[228:231], v[148:151], 0
    ds_read_u16_d16 v196, v196
    v_lshlrev_b32_sdwa v198, 1, v198 dst_sel:DWORD dst_unused:UNUSED_PAD src0_sel:DWORD src1_sel:WORD_1
    v_cvt_pk_bf16_f32 v175, v175, v191
    v_mfma_f32_16x16x32_bf16 v[128:131], v[228:231], v[152:155], 0
    ds_read_u16_d16_hi v197, v197
    v_lshlrev_b32_sdwa v199, 1, v199 dst_sel:DWORD dst_unused:UNUSED_PAD src0_sel:DWORD src1_sel:WORD_1
    v_mfma_f32_16x16x32_bf16 v[136:139], v[228:231], v[156:159], 0
    v_bfe_u32 v228, v253, 8, 1
    v_mul_u32_u24 v228, 50176, v228
    v_subrev_u32 v228, 131080, v228
    v_add_u32 v255, v255, v228
    ds_read_b64_tr_b16 v[228:229], v255 offset:7168
    v_exp_f16_sdwa v205, v205 dst_sel:WORD_0 dst_unused:UNUSED_PRESERVE src0_sel:WORD_0
    s_waitcnt lgkmcnt(11)
    v_mfma_f32_16x16x32_bf16 v[208:211], v[232:235], v[32:35], v[208:211]
    ds_read_b64_tr_b16 v[230:231], v255 offset:7936
    v_or_b32 v170, v184, v185
    v_exp_f16_sdwa v207, v207 dst_sel:WORD_0 dst_unused:UNUSED_PRESERVE src0_sel:WORD_0
    v_mfma_f32_16x16x32_bf16 v[212:215], v[232:235], v[36:39], v[212:215]
    ds_read_u16_d16 v198, v198
    v_lshlrev_b32_sdwa v200, 1, v200 dst_sel:DWORD dst_unused:UNUSED_PAD src0_sel:DWORD src1_sel:WORD_1
    v_mfma_f32_16x16x32_bf16 v[216:219], v[232:235], v[40:43], v[216:219]
    ds_read_u16_d16_hi v199, v199
    v_lshlrev_b32_sdwa v201, 1, v201 dst_sel:DWORD dst_unused:UNUSED_PAD src0_sel:DWORD src1_sel:WORD_1
    v_mfma_f32_16x16x32_bf16 v[220:223], v[232:235], v[44:47], v[220:223]
    ds_read_b64_tr_b16 v[232:233], v254 offset:13312
    v_exp_f16_sdwa v205, v205 dst_sel:WORD_1 dst_unused:UNUSED_PRESERVE src0_sel:WORD_1
    v_or_b32 v171, v186, v187
    s_waitcnt lgkmcnt(11)
    v_mfma_f32_16x16x32_bf16 v[116:119], v[236:239], v[144:147], 0
    ds_read_b64_tr_b16 v[234:235], v254 offset:13568
    v_exp_f16_sdwa v207, v207 dst_sel:WORD_1 dst_unused:UNUSED_PRESERVE src0_sel:WORD_1
    v_mfma_f32_16x16x32_bf16 v[124:127], v[236:239], v[148:151], 0
    ds_read_u16_d16 v200, v200
    v_lshlrev_b32_sdwa v202, 1, v202 dst_sel:DWORD dst_unused:UNUSED_PAD src0_sel:DWORD src1_sel:WORD_1
    v_mfma_f32_16x16x32_bf16 v[132:135], v[236:239], v[152:155], 0
    ds_read_u16_d16_hi v201, v201
    v_lshlrev_b32_sdwa v203, 1, v203 dst_sel:DWORD dst_unused:UNUSED_PAD src0_sel:DWORD src1_sel:WORD_1
    v_pk_fma_f16 v205, v205, s85, s85
    v_mfma_f32_16x16x32_bf16 v[140:143], v[236:239], v[156:159], 0
    ds_read_b64_tr_b16 v[236:237], v255 offset:7176
    v_or_b32 v174, v188, v189
    v_pk_fma_f16 v207, v207, s85, s85
    s_waitcnt lgkmcnt(11)
    v_mfma_f32_16x16x32_bf16 v[176:179], v[224:227], v[0:3], 0
    ds_read_b64_tr_b16 v[238:239], v255 offset:7944
    v_or_b32 v144, v192, v193
    v_mfma_f32_16x16x32_bf16 v[180:183], v[224:227], v[4:7], 0
    ds_read_u16_d16 v202, v202
    v_rcp_f16_sdwa v205, v205 dst_sel:WORD_0 dst_unused:UNUSED_PRESERVE src0_sel:WORD_0
    v_lshlrev_b32_sdwa v208, 1, v208 dst_sel:DWORD dst_unused:UNUSED_PAD src0_sel:DWORD src1_sel:WORD_1
    v_mfma_f32_16x16x32_bf16 v[184:187], v[224:227], v[8:11], 0
    ds_read_u16_d16_hi v203, v203
    v_rcp_f16_sdwa v207, v207 dst_sel:WORD_0 dst_unused:UNUSED_PRESERVE src0_sel:WORD_0
    v_mfma_f32_16x16x32_bf16 v[188:191], v[224:227], v[12:15], 0
    ds_read_b64_tr_b16 v[224:225], v254 offset:14336
    v_lshlrev_b32_sdwa v209, 1, v209 dst_sel:DWORD dst_unused:UNUSED_PAD src0_sel:DWORD src1_sel:WORD_1
    s_waitcnt lgkmcnt(11)
    v_mfma_f32_16x16x32_bf16 v[48:51], v[228:231], v[160:163], v[48:51]
    ds_read_b64_tr_b16 v[226:227], v254 offset:14592
    v_or_b32 v145, v194, v195
    v_fma_mixlo_f16 v222, v222, s83, 0
    v_mfma_f32_16x16x32_bf16 v[56:59], v[228:231], v[164:167], v[56:59]
    ds_read_u16_d16 v208, v208
    v_lshlrev_b32_sdwa v210, 1, v210 dst_sel:DWORD dst_unused:UNUSED_PAD src0_sel:DWORD src1_sel:WORD_1
    v_mfma_f32_16x16x32_bf16 v[64:67], v[228:231], v[168:171], v[64:67]
    ds_read_u16_d16_hi v209, v209
    v_rcp_f16_sdwa v205, v205 dst_sel:WORD_1 dst_unused:UNUSED_PRESERVE src0_sel:WORD_1
    v_lshlrev_b32_sdwa v211, 1, v211 dst_sel:DWORD dst_unused:UNUSED_PAD src0_sel:DWORD src1_sel:WORD_1
    v_mfma_f32_16x16x32_bf16 v[72:75], v[228:231], v[172:175], v[72:75]
    ds_read_b64_tr_b16 v[228:229], v255 offset:7232
    v_or_b32 v148, v196, v197
    s_waitcnt lgkmcnt(11)
    v_mfma_f32_16x16x32_bf16 v[176:179], v[232:235], v[16:19], v[176:179]
    ds_read_b64_tr_b16 v[230:231], v255 offset:8000
    v_rcp_f16_sdwa v207, v207 dst_sel:WORD_1 dst_unused:UNUSED_PRESERVE src0_sel:WORD_1
    v_mfma_f32_16x16x32_bf16 v[180:183], v[232:235], v[20:23], v[180:183]
    ds_read_u16_d16 v210, v210
    v_lshlrev_b32_sdwa v212, 1, v212 dst_sel:DWORD dst_unused:UNUSED_PAD src0_sel:DWORD src1_sel:WORD_1
    v_fma_mixhi_f16 v222, v223, s83, 0
    v_mfma_f32_16x16x32_bf16 v[184:187], v[232:235], v[24:27], v[184:187]
    ds_read_u16_d16_hi v211, v211
    v_lshlrev_b32_sdwa v213, 1, v213 dst_sel:DWORD dst_unused:UNUSED_PAD src0_sel:DWORD src1_sel:WORD_1
    v_fma_mix_f32 v156, v204, v205, 0 op_sel_hi:[1,1,0]
    v_mfma_f32_16x16x32_bf16 v[188:191], v[232:235], v[28:31], v[188:191]
    ds_read_b64_tr_b16 v[232:233], v254 offset:12296
    ds_read_b64_tr_b16 v[234:235], v254 offset:12552
    v_or_b32 v149, v198, v199
    v_fma_mix_f32 v157, v206, v207, 0 op_sel_hi:[1,1,0]
    s_waitcnt lgkmcnt(12)
    v_mfma_f32_16x16x32_bf16 v[52:55], v[236:239], v[160:163], v[52:55]
    ds_read_u16_d16 v212, v212
    v_lshlrev_b32_sdwa v214, 1, v214 dst_sel:DWORD dst_unused:UNUSED_PAD src0_sel:DWORD src1_sel:WORD_1
    v_mfma_f32_16x16x32_bf16 v[60:63], v[236:239], v[164:167], v[60:63]
    ds_read_u16_d16_hi v213, v213
    v_pk_fma_f16 v223, v222, v222, s84 neg_lo:[0,1,0] neg_hi:[0,1,0]
    v_lshlrev_b32_sdwa v215, 1, v215 dst_sel:DWORD dst_unused:UNUSED_PAD src0_sel:DWORD src1_sel:WORD_1
    v_mfma_f32_16x16x32_bf16 v[68:71], v[236:239], v[168:171], v[68:71]
    ds_read_u16_d16 v214, v214
    v_fma_mix_f32 v205, v204, v205, 0 op_sel:[1,1,0] op_sel_hi:[1,1,0]
    v_or_b32 v152, v200, v201
    v_mfma_f32_16x16x32_bf16 v[76:79], v[236:239], v[172:175], v[76:79]
    ds_read_b64_tr_b16 v[236:237], v255 offset:7240
    v_fma_mix_f32 v207, v206, v207, 0 op_sel:[1,1,0] op_sel_hi:[1,1,0]
    v_lshlrev_b32_sdwa v216, 1, v216 dst_sel:DWORD dst_unused:UNUSED_PAD src0_sel:DWORD src1_sel:WORD_1
    s_waitcnt lgkmcnt(12)
    v_mfma_f32_16x16x32_bf16 v[176:179], v[224:227], v[32:35], v[176:179]
    ds_read_b64_tr_b16 v[238:239], v255 offset:8008
    v_pk_mul_f16 v223, v223, v222
    v_mfma_f32_16x16x32_bf16 v[180:183], v[224:227], v[36:39], v[180:183]
    ds_read_u16_d16_hi v215, v215
    v_cvt_pk_bf16_f32 v156, v156, v205
    v_lshlrev_b32_sdwa v217, 1, v217 dst_sel:DWORD dst_unused:UNUSED_PAD src0_sel:DWORD src1_sel:WORD_1
    v_mfma_f32_16x16x32_bf16 v[184:187], v[224:227], v[40:43], v[184:187]
    ds_read_u16_d16 v216, v216
    v_cvt_pk_bf16_f32 v157, v157, v207
    v_or_b32 v153, v202, v203
    v_mfma_f32_16x16x32_bf16 v[188:191], v[224:227], v[44:47], v[188:191]
    ds_read_b64_tr_b16 v[224:225], v254 offset:13320
    v_exp_f16_sdwa v223, v223 dst_sel:WORD_0 dst_unused:UNUSED_PRESERVE src0_sel:WORD_0
    s_waitcnt lgkmcnt(12)
    v_mfma_f32_16x16x32_bf16 v[80:83], v[228:231], v[160:163], v[80:83]
    ds_read_b64_tr_b16 v[226:227], v254 offset:13576
    v_lshlrev_b32_sdwa v218, 1, v218 dst_sel:DWORD dst_unused:UNUSED_PAD src0_sel:DWORD src1_sel:WORD_1
    v_lshlrev_b32_sdwa v219, 1, v219 dst_sel:DWORD dst_unused:UNUSED_PAD src0_sel:DWORD src1_sel:WORD_1
    v_mfma_f32_16x16x32_bf16 v[88:91], v[228:231], v[164:167], v[88:91]
    ds_read_u16_d16_hi v217, v217
    v_exp_f16_sdwa v223, v223 dst_sel:WORD_1 dst_unused:UNUSED_PRESERVE src0_sel:WORD_1
    v_mfma_f32_16x16x32_bf16 v[96:99], v[228:231], v[168:171], v[96:99]
    ds_read_u16_d16 v218, v218
    v_lshlrev_b32_sdwa v220, 1, v220 dst_sel:DWORD dst_unused:UNUSED_PAD src0_sel:DWORD src1_sel:WORD_1
    v_mfma_f32_16x16x32_bf16 v[104:107], v[228:231], v[172:175], v[104:107]
    ds_read_b64_tr_b16 v[228:229], v255 offset:7296
    ds_read_b64_tr_b16 v[230:231], v255 offset:8064
    v_lshlrev_b32_sdwa v221, 1, v221 dst_sel:DWORD dst_unused:UNUSED_PAD src0_sel:DWORD src1_sel:WORD_1
    v_pk_fma_f16 v223, v223, s85, s85
    s_waitcnt lgkmcnt(13)
    v_mfma_f32_16x16x32_bf16 v[192:195], v[232:235], v[0:3], 0
    ds_read_u16_d16_hi v219, v219
    v_or_b32 v146, v208, v209
    v_mfma_f32_16x16x32_bf16 v[196:199], v[232:235], v[4:7], 0
    ds_read_u16_d16 v220, v220
    v_rcp_f16_sdwa v223, v223 dst_sel:WORD_0 dst_unused:UNUSED_PRESERVE src0_sel:WORD_0
    v_lshlrev_b32_sdwa v176, 1, v176 dst_sel:DWORD dst_unused:UNUSED_PAD src0_sel:DWORD src1_sel:WORD_1
    v_mfma_f32_16x16x32_bf16 v[200:203], v[232:235], v[8:11], 0
    ds_read_u16_d16_hi v221, v221
    v_fma_mixlo_f16 v188, v188, s83, 0
    v_lshlrev_b32_sdwa v177, 1, v177 dst_sel:DWORD dst_unused:UNUSED_PAD src0_sel:DWORD src1_sel:WORD_1
    v_mfma_f32_16x16x32_bf16 v[204:207], v[232:235], v[12:15], 0
    ds_read_b64_tr_b16 v[232:233], v254 offset:14344
    v_fma_mixlo_f16 v190, v190, s83, 0
    v_or_b32 v147, v210, v211
    s_waitcnt lgkmcnt(12)
    v_mfma_f32_16x16x32_bf16 v[84:87], v[236:239], v[160:163], v[84:87]
    ds_read_b64_tr_b16 v[234:235], v254 offset:14600
    v_rcp_f16_sdwa v223, v223 dst_sel:WORD_1 dst_unused:UNUSED_PRESERVE src0_sel:WORD_1
    v_mfma_f32_16x16x32_bf16 v[92:95], v[236:239], v[164:167], v[92:95]
    ds_read_u16_d16 v176, v176
    s_waitcnt vmcnt(1)
    v_mfma_f32_16x16x16_bf16 v[48:51], v[242:243], v[244:245], v[48:51]
    v_lshlrev_b32_sdwa v178, 1, v178 dst_sel:DWORD dst_unused:UNUSED_PAD src0_sel:DWORD src1_sel:WORD_1
    v_mfma_f32_16x16x32_bf16 v[100:103], v[236:239], v[168:171], v[100:103]
    ds_read_u16_d16_hi v177, v177
    v_fma_mixhi_f16 v188, v189, s83, 0
    v_mfma_f32_16x16x32_bf16 v[108:111], v[236:239], v[172:175], v[108:111]
    ds_read_b64_tr_b16 v[236:237], v255 offset:7304
    v_mfma_f32_16x16x16_bf16 v[52:55], v[242:243], v[246:247], v[52:55]
    v_lshlrev_b32_sdwa v179, 1, v179 dst_sel:DWORD dst_unused:UNUSED_PAD src0_sel:DWORD src1_sel:WORD_1
    v_fma_mixhi_f16 v190, v191, s83, 0
    s_waitcnt lgkmcnt(12)
    v_mfma_f32_16x16x32_bf16 v[192:195], v[224:227], v[16:19], v[192:195]
    ds_read_b64_tr_b16 v[238:239], v255 offset:8072
    buffer_load_dwordx4 v[244:247], v252, s[4:7], s24 offen offset:128 sc1
    v_or_b32 v150, v212, v213
    v_mfma_f32_16x16x32_bf16 v[196:199], v[224:227], v[20:23], v[196:199]
    ds_read_u16_d16 v178, v178
    v_fma_mix_f32 v159, v222, v223, 0 op_sel_hi:[1,1,0]
    v_pk_fma_f16 v189, v188, v188, s84 neg_lo:[0,1,0] neg_hi:[0,1,0]
    v_mfma_f32_16x16x32_bf16 v[200:203], v[224:227], v[24:27], v[200:203]
    ds_read_u16_d16_hi v179, v179
    v_lshlrev_b32_sdwa v180, 1, v180 dst_sel:DWORD dst_unused:UNUSED_PAD src0_sel:DWORD src1_sel:WORD_1
    v_pk_fma_f16 v191, v190, v190, s84 neg_lo:[0,1,0] neg_hi:[0,1,0]
    v_mfma_f32_16x16x32_bf16 v[204:207], v[224:227], v[28:31], v[204:207]
    v_bfe_u32 v224, v253, 8, 1
    v_mul_u32_u24 v224, 50176, v224
    v_subrev_u32 v224, 131080, v224
    v_add_u32 v254, v254, v224
    s_cmp_lt_u32 s19, 8
    s_cbranch_scc1 L_rd8_slow
L_rd8_go:
    ds_read_b64_tr_b16 v[224:225], v254 offset:10240
    v_lshlrev_b32_sdwa v181, 1, v181 dst_sel:DWORD dst_unused:UNUSED_PAD src0_sel:DWORD src1_sel:WORD_1
    v_fma_mix_f32 v223, v222, v223, 0 op_sel:[1,1,0] op_sel_hi:[1,1,0]
    s_waitcnt lgkmcnt(12)
    v_mfma_f32_16x16x32_bf16 v[112:115], v[228:231], v[160:163], v[112:115]
    ds_read_b64_tr_b16 v[226:227], v254 offset:10496
    v_or_b32 v151, v214, v215
    v_pk_mul_f16 v189, v189, v188
    v_mfma_f32_16x16x32_bf16 v[120:123], v[228:231], v[164:167], v[120:123]
    ds_read_u16_d16 v180, v180
    v_pk_mul_f16 v191, v191, v190
    v_lshlrev_b32_sdwa v182, 1, v182 dst_sel:DWORD dst_unused:UNUSED_PAD src0_sel:DWORD src1_sel:WORD_1
    v_mfma_f32_16x16x32_bf16 v[128:131], v[228:231], v[168:171], v[128:131]
    ds_read_u16_d16_hi v181, v181
    v_cvt_pk_bf16_f32 v159, v159, v223
    v_lshlrev_b32_sdwa v183, 1, v183 dst_sel:DWORD dst_unused:UNUSED_PAD src0_sel:DWORD src1_sel:WORD_1
    v_mfma_f32_16x16x32_bf16 v[136:139], v[228:231], v[172:175], v[136:139]
    ds_read_b64_tr_b16 v[228:229], v255 offset:13312
    v_exp_f16_sdwa v189, v189 dst_sel:WORD_0 dst_unused:UNUSED_PRESERVE src0_sel:WORD_0
    s_waitcnt lgkmcnt(11)
    v_mfma_f32_16x16x32_bf16 v[192:195], v[232:235], v[32:35], v[192:195]
    ds_read_b64_tr_b16 v[230:231], v255 offset:14080
    v_or_b32 v154, v216, v217
    v_mfma_f32_16x16x32_bf16 v[196:199], v[232:235], v[36:39], v[196:199]
    ds_read_u16_d16 v182, v182
    v_exp_f16_sdwa v191, v191 dst_sel:WORD_0 dst_unused:UNUSED_PRESERVE src0_sel:WORD_0
    v_lshlrev_b32_sdwa v184, 1, v184 dst_sel:DWORD dst_unused:UNUSED_PAD src0_sel:DWORD src1_sel:WORD_1
    v_mfma_f32_16x16x32_bf16 v[200:203], v[232:235], v[40:43], v[200:203]
    ds_read_u16_d16_hi v183, v183
    v_lshlrev_b32_sdwa v185, 1, v185 dst_sel:DWORD dst_unused:UNUSED_PAD src0_sel:DWORD src1_sel:WORD_1
    v_mfma_f32_16x16x32_bf16 v[204:207], v[232:235], v[44:47], v[204:207]
    ds_read_b64_tr_b16 v[232:233], v254 offset:11264
    v_exp_f16_sdwa v189, v189 dst_sel:WORD_1 dst_unused:UNUSED_PRESERVE src0_sel:WORD_1
    s_waitcnt lgkmcnt(11)
    v_mfma_f32_16x16x32_bf16 v[116:119], v[236:239], v[160:163], v[116:119]
    ds_read_b64_tr_b16 v[234:235], v254 offset:11520
    v_or_b32 v155, v218, v219
    v_exp_f16_sdwa v191, v191 dst_sel:WORD_1 dst_unused:UNUSED_PRESERVE src0_sel:WORD_1
    v_mfma_f32_16x16x32_bf16 v[124:127], v[236:239], v[164:167], v[124:127]
    ds_read_u16_d16 v184, v184
    v_lshlrev_b32_sdwa v186, 1, v186 dst_sel:DWORD dst_unused:UNUSED_PAD src0_sel:DWORD src1_sel:WORD_1
    v_mfma_f32_16x16x32_bf16 v[132:135], v[236:239], v[168:171], v[132:135]
    ds_read_u16_d16_hi v185, v185
    v_lshlrev_b32_sdwa v187, 1, v187 dst_sel:DWORD dst_unused:UNUSED_PAD src0_sel:DWORD src1_sel:WORD_1
    v_pk_fma_f16 v189, v189, s85, s85
    v_mfma_f32_16x16x32_bf16 v[140:143], v[236:239], v[172:175], v[140:143]
    ds_read_b64_tr_b16 v[236:237], v255 offset:13320
    v_or_b32 v158, v220, v221
    v_pk_fma_f16 v191, v191, s85, s85
    s_waitcnt lgkmcnt(11)
    v_mfma_f32_16x16x32_bf16 v[208:211], v[224:227], v[0:3], 0
    ds_read_b64_tr_b16 v[238:239], v255 offset:14088
    v_or_b32 v160, v176, v177
    v_mfma_f32_16x16x32_bf16 v[212:215], v[224:227], v[4:7], 0
    ds_read_u16_d16 v186, v186
    v_rcp_f16_sdwa v189, v189 dst_sel:WORD_0 dst_unused:UNUSED_PRESERVE src0_sel:WORD_0
    v_lshlrev_b32_sdwa v192, 1, v192 dst_sel:DWORD dst_unused:UNUSED_PAD src0_sel:DWORD src1_sel:WORD_1
    v_mfma_f32_16x16x32_bf16 v[216:219], v[224:227], v[8:11], 0
    ds_read_u16_d16_hi v187, v187
    v_rcp_f16_sdwa v191, v191 dst_sel:WORD_0 dst_unused:UNUSED_PRESERVE src0_sel:WORD_0
    v_mfma_f32_16x16x32_bf16 v[220:223], v[224:227], v[12:15], 0
    ds_read_b64_tr_b16 v[224:225], v254 offset:12288
    v_lshlrev_b32_sdwa v193, 1, v193 dst_sel:DWORD dst_unused:UNUSED_PAD src0_sel:DWORD src1_sel:WORD_1
    v_or_b32 v161, v178, v179
    s_waitcnt lgkmcnt(11)
    v_mfma_f32_16x16x32_bf16 v[48:51], v[228:231], v[144:147], v[48:51]
    ds_read_b64_tr_b16 v[226:227], v254 offset:12544
    v_fma_mixlo_f16 v206, v206, s83, 0
    v_mfma_f32_16x16x32_bf16 v[56:59], v[228:231], v[148:151], v[56:59]
    ds_read_u16_d16 v192, v192
    s_waitcnt vmcnt(1)
    v_mfma_f32_16x16x16_bf16 v[80:83], v[242:243], v[248:249], v[80:83]
    v_lshlrev_b32_sdwa v194, 1, v194 dst_sel:DWORD dst_unused:UNUSED_PAD src0_sel:DWORD src1_sel:WORD_1
    v_mfma_f32_16x16x32_bf16 v[64:67], v[228:231], v[152:155], v[64:67]
    ds_read_u16_d16_hi v193, v193
    v_rcp_f16_sdwa v189, v189 dst_sel:WORD_1 dst_unused:UNUSED_PRESERVE src0_sel:WORD_1
    v_mfma_f32_16x16x32_bf16 v[72:75], v[228:231], v[156:159], v[72:75]
    ds_read_b64_tr_b16 v[228:229], v255 offset:13376
    v_mfma_f32_16x16x16_bf16 v[84:87], v[242:243], v[250:251], v[84:87]
    v_lshlrev_b32_sdwa v195, 1, v195 dst_sel:DWORD dst_unused:UNUSED_PAD src0_sel:DWORD src1_sel:WORD_1
    v_or_b32 v164, v180, v181
    s_waitcnt lgkmcnt(11)
    v_mfma_f32_16x16x32_bf16 v[208:211], v[232:235], v[16:19], v[208:211]
    ds_read_b64_tr_b16 v[230:231], v255 offset:14144
    buffer_load_dwordx4 v[248:251], v252, s[4:7], s24 offen offset:192 sc1
    v_mfma_f32_16x16x32_bf16 v[212:215], v[232:235], v[20:23], v[212:215]
    ds_read_u16_d16 v194, v194
    v_rcp_f16_sdwa v191, v191 dst_sel:WORD_1 dst_unused:UNUSED_PRESERVE src0_sel:WORD_1
    v_lshlrev_b32_sdwa v196, 1, v196 dst_sel:DWORD dst_unused:UNUSED_PAD src0_sel:DWORD src1_sel:WORD_1
    v_mfma_f32_16x16x32_bf16 v[216:219], v[232:235], v[24:27], v[216:219]
    ds_read_u16_d16_hi v195, v195
    v_fma_mixhi_f16 v206, v207, s83, 0
    v_lshlrev_b32_sdwa v197, 1, v197 dst_sel:DWORD dst_unused:UNUSED_PAD src0_sel:DWORD src1_sel:WORD_1
    v_mfma_f32_16x16x32_bf16 v[220:223], v[232:235], v[28:31], v[220:223]
    ds_read_b64_tr_b16 v[232:233], v254 offset:10248
    ds_read_b64_tr_b16 v[234:235], v254 offset:10504
    v_fma_mix_f32 v172, v188, v189, 0 op_sel_hi:[1,1,0]
    v_or_b32 v165, v182, v183
    s_waitcnt lgkmcnt(12)
    v_mfma_f32_16x16x32_bf16 v[52:55], v[236:239], v[144:147], v[52:55]
    ds_read_u16_d16 v196, v196
    v_fma_mix_f32 v173, v190, v191, 0 op_sel_hi:[1,1,0]
    v_mfma_f32_16x16x32_bf16 v[60:63], v[236:239], v[148:151], v[60:63]
    ds_read_u16_d16_hi v197, v197
    v_lshlrev_b32_sdwa v198, 1, v198 dst_sel:DWORD dst_unused:UNUSED_PAD src0_sel:DWORD src1_sel:WORD_1
    v_pk_fma_f16 v207, v206, v206, s84 neg_lo:[0,1,0] neg_hi:[0,1,0]
    v_mfma_f32_16x16x32_bf16 v[68:71], v[236:239], v[152:155], v[68:71]
    ds_read_u16_d16 v198, v198
    v_lshlrev_b32_sdwa v199, 1, v199 dst_sel:DWORD dst_unused:UNUSED_PAD src0_sel:DWORD src1_sel:WORD_1
    v_fma_mix_f32 v189, v188, v189, 0 op_sel:[1,1,0] op_sel_hi:[1,1,0]
    v_mfma_f32_16x16x32_bf16 v[76:79], v[236:239], v[156:159], v[76:79]
    ds_read_b64_tr_b16 v[236:237], v255 offset:13384
    v_or_b32 v168, v184, v185
    v_fma_mix_f32 v191, v190, v191, 0 op_sel:[1,1,0] op_sel_hi:[1,1,0]
    s_waitcnt lgkmcnt(12)
    v_mfma_f32_16x16x32_bf16 v[208:211], v[224:227], v[32:35], v[208:211]
    ds_read_b64_tr_b16 v[238:239], v255 offset:14152
    v_lshlrev_b32_sdwa v200, 1, v200 dst_sel:DWORD dst_unused:UNUSED_PAD src0_sel:DWORD src1_sel:WORD_1
    v_pk_mul_f16 v207, v207, v206
    v_mfma_f32_16x16x32_bf16 v[212:215], v[224:227], v[36:39], v[212:215]
    ds_read_u16_d16_hi v199, v199
    v_cvt_pk_bf16_f32 v172, v172, v189
    v_lshlrev_b32_sdwa v201, 1, v201 dst_sel:DWORD dst_unused:UNUSED_PAD src0_sel:DWORD src1_sel:WORD_1
    v_mfma_f32_16x16x32_bf16 v[216:219], v[224:227], v[40:43], v[216:219]
    ds_read_u16_d16 v200, v200
    v_cvt_pk_bf16_f32 v173, v173, v191
    v_or_b32 v169, v186, v187
    v_mfma_f32_16x16x32_bf16 v[220:223], v[224:227], v[44:47], v[220:223]
    ds_read_b64_tr_b16 v[224:225], v254 offset:11272
    v_exp_f16_sdwa v207, v207 dst_sel:WORD_0 dst_unused:UNUSED_PRESERVE src0_sel:WORD_0
    s_waitcnt lgkmcnt(12)
    v_mfma_f32_16x16x32_bf16 v[80:83], v[228:231], v[144:147], v[80:83]
    ds_read_b64_tr_b16 v[226:227], v254 offset:11528
    v_lshlrev_b32_sdwa v202, 1, v202 dst_sel:DWORD dst_unused:UNUSED_PAD src0_sel:DWORD src1_sel:WORD_1
    v_mfma_f32_16x16x32_bf16 v[88:91], v[228:231], v[148:151], v[88:91]
    ds_read_u16_d16_hi v201, v201
    v_lshlrev_b32_sdwa v203, 1, v203 dst_sel:DWORD dst_unused:UNUSED_PAD src0_sel:DWORD src1_sel:WORD_1
    v_exp_f16_sdwa v207, v207 dst_sel:WORD_1 dst_unused:UNUSED_PRESERVE src0_sel:WORD_1
    v_mfma_f32_16x16x32_bf16 v[96:99], v[228:231], v[152:155], v[96:99]
    ds_read_u16_d16 v202, v202
    v_lshlrev_b32_sdwa v204, 1, v204 dst_sel:DWORD dst_unused:UNUSED_PAD src0_sel:DWORD src1_sel:WORD_1
    v_mfma_f32_16x16x32_bf16 v[104:107], v[228:231], v[156:159], v[104:107]
    ds_read_b64_tr_b16 v[228:229], v255 offset:13440
    ds_read_b64_tr_b16 v[230:231], v255 offset:14208
    v_lshlrev_b32_sdwa v205, 1, v205 dst_sel:DWORD dst_unused:UNUSED_PAD src0_sel:DWORD src1_sel:WORD_1
    v_pk_fma_f16 v207, v207, s85, s85
    s_waitcnt lgkmcnt(13)
    v_mfma_f32_16x16x32_bf16 v[176:179], v[232:235], v[0:3], 0
    ds_read_u16_d16_hi v203, v203
    v_or_b32 v162, v192, v193
    v_mfma_f32_16x16x32_bf16 v[180:183], v[232:235], v[4:7], 0
    ds_read_u16_d16 v204, v204
    v_rcp_f16_sdwa v207, v207 dst_sel:WORD_0 dst_unused:UNUSED_PRESERVE src0_sel:WORD_0
    v_lshlrev_b32_sdwa v208, 1, v208 dst_sel:DWORD dst_unused:UNUSED_PAD src0_sel:DWORD src1_sel:WORD_1
    v_mfma_f32_16x16x32_bf16 v[184:187], v[232:235], v[8:11], 0
    ds_read_u16_d16_hi v205, v205
    v_fma_mixlo_f16 v220, v220, s83, 0
    v_lshlrev_b32_sdwa v209, 1, v209 dst_sel:DWORD dst_unused:UNUSED_PAD src0_sel:DWORD src1_sel:WORD_1
    v_mfma_f32_16x16x32_bf16 v[188:191], v[232:235], v[12:15], 0
    ds_read_b64_tr_b16 v[232:233], v254 offset:12296
    v_fma_mixlo_f16 v222, v222, s83, 0
    s_waitcnt lgkmcnt(12)
    v_mfma_f32_16x16x32_bf16 v[84:87], v[236:239], v[144:147], v[84:87]
    ds_read_b64_tr_b16 v[234:235], v254 offset:12552
    v_or_b32 v163, v194, v195
    v_rcp_f16_sdwa v207, v207 dst_sel:WORD_1 dst_unused:UNUSED_PRESERVE src0_sel:WORD_1
    v_mfma_f32_16x16x32_bf16 v[92:95], v[236:239], v[148:151], v[92:95]
    ds_read_u16_d16 v208, v208
    v_lshlrev_b32_sdwa v210, 1, v210 dst_sel:DWORD dst_unused:UNUSED_PAD src0_sel:DWORD src1_sel:WORD_1
    v_mfma_f32_16x16x32_bf16 v[100:103], v[236:239], v[152:155], v[100:103]
    ds_read_u16_d16_hi v209, v209
    v_fma_mixhi_f16 v220, v221, s83, 0
    v_lshlrev_b32_sdwa v211, 1, v211 dst_sel:DWORD dst_unused:UNUSED_PAD src0_sel:DWORD src1_sel:WORD_1
    v_mfma_f32_16x16x32_bf16 v[108:111], v[236:239], v[156:159], v[108:111]
    ds_read_b64_tr_b16 v[236:237], v255 offset:13448
    v_fma_mixhi_f16 v222, v223, s83, 0
    v_or_b32 v166, v196, v197
    s_waitcnt lgkmcnt(12)
    v_mfma_f32_16x16x32_bf16 v[176:179], v[224:227], v[16:19], v[176:179]
    ds_read_b64_tr_b16 v[238:239], v255 offset:14216
    v_fma_mix_f32 v175, v206, v207, 0 op_sel_hi:[1,1,0]
    v_pk_fma_f16 v221, v220, v220, s84 neg_lo:[0,1,0] neg_hi:[0,1,0]
    v_mfma_f32_16x16x32_bf16 v[180:183], v[224:227], v[20:23], v[180:183]
    ds_read_u16_d16 v210, v210
    v_lshlrev_b32_sdwa v212, 1, v212 dst_sel:DWORD dst_unused:UNUSED_PAD src0_sel:DWORD src1_sel:WORD_1
    v_mfma_f32_16x16x32_bf16 v[184:187], v[224:227], v[24:27], v[184:187]
    ds_read_u16_d16_hi v211, v211
    v_pk_fma_f16 v223, v222, v222, s84 neg_lo:[0,1,0] neg_hi:[0,1,0]
    v_lshlrev_b32_sdwa v213, 1, v213 dst_sel:DWORD dst_unused:UNUSED_PAD src0_sel:DWORD src1_sel:WORD_1
    v_mfma_f32_16x16x32_bf16 v[188:191], v[224:227], v[28:31], v[188:191]
    s_cmp_lt_u32 s19, 10
    s_cbranch_scc1 L_rd10_slow
L_rd10_go:
    ds_read_b64_tr_b16 v[224:225], v254 offset:16384
    v_fma_mix_f32 v207, v206, v207, 0 op_sel:[1,1,0] op_sel_hi:[1,1,0]
    v_or_b32 v167, v198, v199
    s_waitcnt lgkmcnt(12)
    v_mfma_f32_16x16x32_bf16 v[112:115], v[228:231], v[144:147], v[112:115]
    ds_read_b64_tr_b16 v[226:227], v254 offset:16640
    v_pk_mul_f16 v221, v221, v220
    v_pk_mul_f16 v223, v223, v222
    v_mfma_f32_16x16x32_bf16 v[120:123], v[228:231], v[148:151], v[120:123]
    ds_read_u16_d16 v212, v212
    v_lshlrev_b32_sdwa v214, 1, v214 dst_sel:DWORD dst_unused:UNUSED_PAD src0_sel:DWORD src1_sel:WORD_1
    v_cvt_pk_bf16_f32 v175, v175, v207
    v_mfma_f32_16x16x32_bf16 v[128:131], v[228:231], v[152:155], v[128:131]
    ds_read_u16_d16_hi v213, v213
    v_lshlrev_b32_sdwa v215, 1, v215 dst_sel:DWORD dst_unused:UNUSED_PAD src0_sel:DWORD src1_sel:WORD_1
    v_mfma_f32_16x16x32_bf16 v[136:139], v[228:231], v[156:159], v[136:139]
    ds_read_b64_tr_b16 v[228:229], v255 offset:19456
    v_exp_f16_sdwa v221, v221 dst_sel:WORD_0 dst_unused:UNUSED_PRESERVE src0_sel:WORD_0
    s_waitcnt lgkmcnt(11)
    v_mfma_f32_16x16x32_bf16 v[176:179], v[232:235], v[32:35], v[176:179]
    ds_read_b64_tr_b16 v[230:231], v255 offset:20224
    v_or_b32 v170, v200, v201
    v_exp_f16_sdwa v223, v223 dst_sel:WORD_0 dst_unused:UNUSED_PRESERVE src0_sel:WORD_0
    v_mfma_f32_16x16x32_bf16 v[180:183], v[232:235], v[36:39], v[180:183]
    ds_read_u16_d16 v214, v214
    v_lshlrev_b32_sdwa v216, 1, v216 dst_sel:DWORD dst_unused:UNUSED_PAD src0_sel:DWORD src1_sel:WORD_1
    v_mfma_f32_16x16x32_bf16 v[184:187], v[232:235], v[40:43], v[184:187]
    ds_read_u16_d16_hi v215, v215
    v_lshlrev_b32_sdwa v217, 1, v217 dst_sel:DWORD dst_unused:UNUSED_PAD src0_sel:DWORD src1_sel:WORD_1
    v_mfma_f32_16x16x32_bf16 v[188:191], v[232:235], v[44:47], v[188:191]
    ds_read_b64_tr_b16 v[232:233], v254 offset:17408
    v_exp_f16_sdwa v221, v221 dst_sel:WORD_1 dst_unused:UNUSED_PRESERVE src0_sel:WORD_1
    v_or_b32 v171, v202, v203
    s_waitcnt lgkmcnt(11)
    v_mfma_f32_16x16x32_bf16 v[116:119], v[236:239], v[144:147], v[116:119]
    ds_read_b64_tr_b16 v[234:235], v254 offset:17664
    v_exp_f16_sdwa v223, v223 dst_sel:WORD_1 dst_unused:UNUSED_PRESERVE src0_sel:WORD_1
    v_mfma_f32_16x16x32_bf16 v[124:127], v[236:239], v[148:151], v[124:127]
    ds_read_u16_d16 v216, v216
    v_lshlrev_b32_sdwa v218, 1, v218 dst_sel:DWORD dst_unused:UNUSED_PAD src0_sel:DWORD src1_sel:WORD_1
    v_mfma_f32_16x16x32_bf16 v[132:135], v[236:239], v[152:155], v[132:135]
    ds_read_u16_d16_hi v217, v217
    v_lshlrev_b32_sdwa v219, 1, v219 dst_sel:DWORD dst_unused:UNUSED_PAD src0_sel:DWORD src1_sel:WORD_1
    v_pk_fma_f16 v221, v221, s85, s85
    v_mfma_f32_16x16x32_bf16 v[140:143], v[236:239], v[156:159], v[140:143]
    ds_read_b64_tr_b16 v[236:237], v255 offset:19464
    v_or_b32 v174, v204, v205
    v_pk_fma_f16 v223, v223, s85, s85
    s_waitcnt lgkmcnt(11)
    v_mfma_f32_16x16x32_bf16 v[192:195], v[224:227], v[0:3], 0
    ds_read_b64_tr_b16 v[238:239], v255 offset:20232
    v_or_b32 v144, v208, v209
    v_mfma_f32_16x16x32_bf16 v[196:199], v[224:227], v[4:7], 0
    ds_read_u16_d16 v218, v218
    v_rcp_f16_sdwa v221, v221 dst_sel:WORD_0 dst_unused:UNUSED_PRESERVE src0_sel:WORD_0
    v_lshlrev_b32_sdwa v176, 1, v176 dst_sel:DWORD dst_unused:UNUSED_PAD src0_sel:DWORD src1_sel:WORD_1
    v_mfma_f32_16x16x32_bf16 v[200:203], v[224:227], v[8:11], 0
    ds_read_u16_d16_hi v219, v219
    v_rcp_f16_sdwa v223, v223 dst_sel:WORD_0 dst_unused:UNUSED_PRESERVE src0_sel:WORD_0
    v_mfma_f32_16x16x32_bf16 v[204:207], v[224:227], v[12:15], 0
    ds_read_b64_tr_b16 v[224:225], v254 offset:18432
    v_lshlrev_b32_sdwa v177, 1, v177 dst_sel:DWORD dst_unused:UNUSED_PAD src0_sel:DWORD src1_sel:WORD_1
    v_or_b32 v145, v210, v211
    s_waitcnt lgkmcnt(11)
    v_mfma_f32_16x16x32_bf16 v[48:51], v[228:231], v[160:163], v[48:51]
    ds_read_b64_tr_b16 v[226:227], v254 offset:18688
    v_fma_mixlo_f16 v190, v190, s83, 0
    v_mfma_f32_16x16x32_bf16 v[56:59], v[228:231], v[164:167], v[56:59]
    ds_read_u16_d16 v176, v176
    s_waitcnt vmcnt(1)
    v_mfma_f32_16x16x16_bf16 v[112:115], v[242:243], v[244:245], v[112:115]
    v_lshlrev_b32_sdwa v178, 1, v178 dst_sel:DWORD dst_unused:UNUSED_PAD src0_sel:DWORD src1_sel:WORD_1
    v_mfma_f32_16x16x32_bf16 v[64:67], v[228:231], v[168:171], v[64:67]
    ds_read_u16_d16_hi v177, v177
    v_rcp_f16_sdwa v221, v221 dst_sel:WORD_1 dst_unused:UNUSED_PRESERVE src0_sel:WORD_1
    v_mfma_f32_16x16x32_bf16 v[72:75], v[228:231], v[172:175], v[72:75]
    ds_read_b64_tr_b16 v[228:229], v255 offset:19520
    v_mfma_f32_16x16x16_bf16 v[116:119], v[242:243], v[246:247], v[116:119]
    v_lshlrev_b32_sdwa v179, 1, v179 dst_sel:DWORD dst_unused:UNUSED_PAD src0_sel:DWORD src1_sel:WORD_1
    v_or_b32 v148, v212, v213
    s_waitcnt lgkmcnt(11)
    v_mfma_f32_16x16x32_bf16 v[192:195], v[232:235], v[16:19], v[192:195]
    ds_read_b64_tr_b16 v[230:231], v255 offset:20288
    buffer_load_dwordx4 v[244:247], v252, s[4:7], s24 offen offset:256 sc1
    v_mfma_f32_16x16x32_bf16 v[196:199], v[232:235], v[20:23], v[196:199]
    ds_read_u16_d16 v178, v178
    v_rcp_f16_sdwa v223, v223 dst_sel:WORD_1 dst_unused:UNUSED_PRESERVE src0_sel:WORD_1
    v_lshlrev_b32_sdwa v180, 1, v180 dst_sel:DWORD dst_unused:UNUSED_PAD src0_sel:DWORD src1_sel:WORD_1
    v_mfma_f32_16x16x32_bf16 v[200:203], v[232:235], v[24:27], v[200:203]
    ds_read_u16_d16_hi v179, v179
    v_fma_mixhi_f16 v190, v191, s83, 0
    v_lshlrev_b32_sdwa v181, 1, v181 dst_sel:DWORD dst_unused:UNUSED_PAD src0_sel:DWORD src1_sel:WORD_1
    v_mfma_f32_16x16x32_bf16 v[204:207], v[232:235], v[28:31], v[204:207]
    ds_read_b64_tr_b16 v[232:233], v254 offset:16392
    ds_read_b64_tr_b16 v[234:235], v254 offset:16648
    v_fma_mix_f32 v156, v220, v221, 0 op_sel_hi:[1,1,0]
    v_or_b32 v149, v214, v215
    s_waitcnt lgkmcnt(12)
    v_mfma_f32_16x16x32_bf16 v[52:55], v[236:239], v[160:163], v[52:55]
    ds_read_u16_d16 v180, v180
    v_fma_mix_f32 v157, v222, v223, 0 op_sel_hi:[1,1,0]
    v_mfma_f32_16x16x32_bf16 v[60:63], v[236:239], v[164:167], v[60:63]
    ds_read_u16_d16_hi v181, v181
    v_lshlrev_b32_sdwa v182, 1, v182 dst_sel:DWORD dst_unused:UNUSED_PAD src0_sel:DWORD src1_sel:WORD_1
    v_pk_fma_f16 v191, v190, v190, s84 neg_lo:[0,1,0] neg_hi:[0,1,0]
    v_mfma_f32_16x16x32_bf16 v[68:71], v[236:239], v[168:171], v[68:71]
    ds_read_u16_d16 v182, v182
    v_lshlrev_b32_sdwa v183, 1, v183 dst_sel:DWORD dst_unused:UNUSED_PAD src0_sel:DWORD src1_sel:WORD_1
    v_fma_mix_f32 v221, v220, v221, 0 op_sel:[1,1,0] op_sel_hi:[1,1,0]
    v_mfma_f32_16x16x32_bf16 v[76:79], v[236:239], v[172:175], v[76:79]
    ds_read_b64_tr_b16 v[236:237], v255 offset:19528
    v_or_b32 v152, v216, v217
    v_fma_mix_f32 v223, v222, v223, 0 op_sel:[1,1,0] op_sel_hi:[1,1,0]
    s_waitcnt lgkmcnt(12)
    v_mfma_f32_16x16x32_bf16 v[192:195], v[224:227], v[32:35], v[192:195]
    ds_read_b64_tr_b16 v[238:239], v255 offset:20296
    v_lshlrev_b32_sdwa v184, 1, v184 dst_sel:DWORD dst_unused:UNUSED_PAD src0_sel:DWORD src1_sel:WORD_1
    v_pk_mul_f16 v191, v191, v190
    v_mfma_f32_16x16x32_bf16 v[196:199], v[224:227], v[36:39], v[196:199]
    ds_read_u16_d16_hi v183, v183
    v_cvt_pk_bf16_f32 v156, v156, v221
    v_lshlrev_b32_sdwa v185, 1, v185 dst_sel:DWORD dst_unused:UNUSED_PAD src0_sel:DWORD src1_sel:WORD_1
    v_mfma_f32_16x16x32_bf16 v[200:203], v[224:227], v[40:43], v[200:203]
    ds_read_u16_d16 v184, v184
    v_cvt_pk_bf16_f32 v157, v157, v223
    v_or_b32 v153, v218, v219
    v_mfma_f32_16x16x32_bf16 v[204:207], v[224:227], v[44:47], v[204:207]
    ds_read_b64_tr_b16 v[224:225], v254 offset:17416
    v_exp_f16_sdwa v191, v191 dst_sel:WORD_0 dst_unused:UNUSED_PRESERVE src0_sel:WORD_0
    s_waitcnt lgkmcnt(12)
    v_mfma_f32_16x16x32_bf16 v[80:83], v[228:231], v[160:163], v[80:83]
    ds_read_b64_tr_b16 v[226:227], v254 offset:17672
    v_lshlrev_b32_sdwa v186, 1, v186 dst_sel:DWORD dst_unused:UNUSED_PAD src0_sel:DWORD src1_sel:WORD_1
    v_mfma_f32_16x16x32_bf16 v[88:91], v[228:231], v[164:167], v[88:91]
    ds_read_u16_d16_hi v185, v185
    v_lshlrev_b32_sdwa v187, 1, v187 dst_sel:DWORD dst_unused:UNUSED_PAD src0_sel:DWORD src1_sel:WORD_1
    v_exp_f16_sdwa v191, v191 dst_sel:WORD_1 dst_unused:UNUSED_PRESERVE src0_sel:WORD_1
    v_mfma_f32_16x16x32_bf16 v[96:99], v[228:231], v[168:171], v[96:99]
    ds_read_u16_d16 v186, v186
    v_lshlrev_b32_sdwa v188, 1, v188 dst_sel:DWORD dst_unused:UNUSED_PAD src0_sel:DWORD src1_sel:WORD_1
    v_mfma_f32_16x16x32_bf16 v[104:107], v[228:231], v[172:175], v[104:107]
    ds_read_b64_tr_b16 v[228:229], v255 offset:19584
    ds_read_b64_tr_b16 v[230:231], v255 offset:20352
    v_lshlrev_b32_sdwa v189, 1, v189 dst_sel:DWORD dst_unused:UNUSED_PAD src0_sel:DWORD src1_sel:WORD_1
    v_pk_fma_f16 v191, v191, s85, s85
    s_waitcnt lgkmcnt(13)
    v_mfma_f32_16x16x32_bf16 v[208:211], v[232:235], v[0:3], 0
    ds_read_u16_d16_hi v187, v187
    v_or_b32 v146, v176, v177
    v_mfma_f32_16x16x32_bf16 v[212:215], v[232:235], v[4:7], 0
    ds_read_u16_d16 v188, v188
    v_rcp_f16_sdwa v191, v191 dst_sel:WORD_0 dst_unused:UNUSED_PRESERVE src0_sel:WORD_0
    v_lshlrev_b32_sdwa v192, 1, v192 dst_sel:DWORD dst_unused:UNUSED_PAD src0_sel:DWORD src1_sel:WORD_1
    v_mfma_f32_16x16x32_bf16 v[216:219], v[232:235], v[8:11], 0
    ds_read_u16_d16_hi v189, v189
    v_fma_mixlo_f16 v204, v204, s83, 0
    v_lshlrev_b32_sdwa v193, 1, v193 dst_sel:DWORD dst_unused:UNUSED_PAD src0_sel:DWORD src1_sel:WORD_1
    v_mfma_f32_16x16x32_bf16 v[220:223], v[232:235], v[12:15], 0
    ds_read_b64_tr_b16 v[232:233], v254 offset:18440
    v_fma_mixlo_f16 v206, v206, s83, 0
    v_or_b32 v147, v178, v179
    s_waitcnt lgkmcnt(12)
    v_mfma_f32_16x16x32_bf16 v[84:87], v[236:239], v[160:163], v[84:87]
    ds_read_b64_tr_b16 v[234:235], v254 offset:18696
    v_rcp_f16_sdwa v191, v191 dst_sel:WORD_1 dst_unused:UNUSED_PRESERVE src0_sel:WORD_1
    v_mfma_f32_16x16x32_bf16 v[92:95], v[236:239], v[164:167], v[92:95]
    ds_read_u16_d16 v192, v192
    s_waitcnt vmcnt(1)
    v_mfma_f32_16x16x16_bf16 v[56:59], v[242:243], v[248:249], v[56:59]
    v_lshlrev_b32_sdwa v194, 1, v194 dst_sel:DWORD dst_unused:UNUSED_PAD src0_sel:DWORD src1_sel:WORD_1
    v_mfma_f32_16x16x32_bf16 v[100:103], v[236:239], v[168:171], v[100:103]
    ds_read_u16_d16_hi v193, v193
    v_fma_mixhi_f16 v204, v205, s83, 0
    v_mfma_f32_16x16x32_bf16 v[108:111], v[236:239], v[172:175], v[108:111]
    ds_read_b64_tr_b16 v[236:237], v255 offset:19592
    v_mfma_f32_16x16x16_bf16 v[60:63], v[242:243], v[250:251], v[60:63]
    v_lshlrev_b32_sdwa v195, 1, v195 dst_sel:DWORD dst_unused:UNUSED_PAD src0_sel:DWORD src1_sel:WORD_1
    v_fma_mixhi_f16 v206, v207, s83, 0
    s_waitcnt lgkmcnt(12)
    v_mfma_f32_16x16x32_bf16 v[208:211], v[224:227], v[16:19], v[208:211]
    ds_read_b64_tr_b16 v[238:239], v255 offset:20360
    buffer_load_dwordx4 v[248:251], v252, s[4:7], s24 offen offset:320 sc1
    v_or_b32 v150, v180, v181
    v_mfma_f32_16x16x32_bf16 v[212:215], v[224:227], v[20:23], v[212:215]
    ds_read_u16_d16 v194, v194
    v_fma_mix_f32 v159, v190, v191, 0 op_sel_hi:[1,1,0]
    v_pk_fma_f16 v205, v204, v204, s84 neg_lo:[0,1,0] neg_hi:[0,1,0]
    v_mfma_f32_16x16x32_bf16 v[216:219], v[224:227], v[24:27], v[216:219]
    ds_read_u16_d16_hi v195, v195
    v_lshlrev_b32_sdwa v196, 1, v196 dst_sel:DWORD dst_unused:UNUSED_PAD src0_sel:DWORD src1_sel:WORD_1
    v_pk_fma_f16 v207, v206, v206, s84 neg_lo:[0,1,0] neg_hi:[0,1,0]
    v_mfma_f32_16x16x32_bf16 v[220:223], v[224:227], v[28:31], v[220:223]
    s_cmp_lt_u32 s19, 12
    s_cbranch_scc1 L_rd12_slow
L_rd12_go:
    ds_read_b64_tr_b16 v[224:225], v254 offset:22528
    v_lshlrev_b32_sdwa v197, 1, v197 dst_sel:DWORD dst_unused:UNUSED_PAD src0_sel:DWORD src1_sel:WORD_1
    v_fma_mix_f32 v191, v190, v191, 0 op_sel:[1,1,0] op_sel_hi:[1,1,0]
    s_waitcnt lgkmcnt(12)
    v_mfma_f32_16x16x32_bf16 v[112:115], v[228:231], v[160:163], v[112:115]
    ds_read_b64_tr_b16 v[226:227], v254 offset:22784
    v_or_b32 v151, v182, v183
    v_pk_mul_f16 v205, v205, v204
    v_mfma_f32_16x16x32_bf16 v[120:123], v[228:231], v[164:167], v[120:123]
    ds_read_u16_d16 v196, v196
    v_pk_mul_f16 v207, v207, v206
    v_lshlrev_b32_sdwa v198, 1, v198 dst_sel:DWORD dst_unused:UNUSED_PAD src0_sel:DWORD src1_sel:WORD_1
    v_mfma_f32_16x16x32_bf16 v[128:131], v[228:231], v[168:171], v[128:131]
    ds_read_u16_d16_hi v197, v197
    v_cvt_pk_bf16_f32 v159, v159, v191
    v_lshlrev_b32_sdwa v199, 1, v199 dst_sel:DWORD dst_unused:UNUSED_PAD src0_sel:DWORD src1_sel:WORD_1
    v_mfma_f32_16x16x32_bf16 v[136:139], v[228:231], v[172:175], v[136:139]
    ds_read_b64_tr_b16 v[228:229], v255 offset:25600
    v_exp_f16_sdwa v205, v205 dst_sel:WORD_0 dst_unused:UNUSED_PRESERVE src0_sel:WORD_0
    s_waitcnt lgkmcnt(11)
    v_mfma_f32_16x16x32_bf16 v[208:211], v[232:235], v[32:35], v[208:211]
    ds_read_b64_tr_b16 v[230:231], v255 offset:26368
    v_or_b32 v154, v184, v185
    v_mfma_f32_16x16x32_bf16 v[212:215], v[232:235], v[36:39], v[212:215]
    ds_read_u16_d16 v198, v198
    v_exp_f16_sdwa v207, v207 dst_sel:WORD_0 dst_unused:UNUSED_PRESERVE src0_sel:WORD_0
    v_lshlrev_b32_sdwa v200, 1, v200 dst_sel:DWORD dst_unused:UNUSED_PAD src0_sel:DWORD src1_sel:WORD_1
    v_mfma_f32_16x16x32_bf16 v[216:219], v[232:235], v[40:43], v[216:219]
    ds_read_u16_d16_hi v199, v199
    v_lshlrev_b32_sdwa v201, 1, v201 dst_sel:DWORD dst_unused:UNUSED_PAD src0_sel:DWORD src1_sel:WORD_1
    v_mfma_f32_16x16x32_bf16 v[220:223], v[232:235], v[44:47], v[220:223]
    ds_read_b64_tr_b16 v[232:233], v254 offset:23552
    v_exp_f16_sdwa v205, v205 dst_sel:WORD_1 dst_unused:UNUSED_PRESERVE src0_sel:WORD_1
    s_waitcnt lgkmcnt(11)
    v_mfma_f32_16x16x32_bf16 v[116:119], v[236:239], v[160:163], v[116:119]
    ds_read_b64_tr_b16 v[234:235], v254 offset:23808
    v_or_b32 v155, v186, v187
    v_exp_f16_sdwa v207, v207 dst_sel:WORD_1 dst_unused:UNUSED_PRESERVE src0_sel:WORD_1
    v_mfma_f32_16x16x32_bf16 v[124:127], v[236:239], v[164:167], v[124:127]
    ds_read_u16_d16 v200, v200
    v_lshlrev_b32_sdwa v202, 1, v202 dst_sel:DWORD dst_unused:UNUSED_PAD src0_sel:DWORD src1_sel:WORD_1
    v_mfma_f32_16x16x32_bf16 v[132:135], v[236:239], v[168:171], v[132:135]
    ds_read_u16_d16_hi v201, v201
    v_lshlrev_b32_sdwa v203, 1, v203 dst_sel:DWORD dst_unused:UNUSED_PAD src0_sel:DWORD src1_sel:WORD_1
    v_pk_fma_f16 v205, v205, s85, s85
    v_mfma_f32_16x16x32_bf16 v[140:143], v[236:239], v[172:175], v[140:143]
    ds_read_b64_tr_b16 v[236:237], v255 offset:25608
    v_or_b32 v158, v188, v189
    v_pk_fma_f16 v207, v207, s85, s85
    s_waitcnt lgkmcnt(11)
    v_mfma_f32_16x16x32_bf16 v[176:179], v[224:227], v[0:3], 0
    ds_read_b64_tr_b16 v[238:239], v255 offset:26376
    v_or_b32 v160, v192, v193
    v_mfma_f32_16x16x32_bf16 v[180:183], v[224:227], v[4:7], 0
    ds_read_u16_d16 v202, v202
    v_rcp_f16_sdwa v205, v205 dst_sel:WORD_0 dst_unused:UNUSED_PRESERVE src0_sel:WORD_0
    v_lshlrev_b32_sdwa v208, 1, v208 dst_sel:DWORD dst_unused:UNUSED_PAD src0_sel:DWORD src1_sel:WORD_1
    v_mfma_f32_16x16x32_bf16 v[184:187], v[224:227], v[8:11], 0
    ds_read_u16_d16_hi v203, v203
    v_rcp_f16_sdwa v207, v207 dst_sel:WORD_0 dst_unused:UNUSED_PRESERVE src0_sel:WORD_0
    v_mfma_f32_16x16x32_bf16 v[188:191], v[224:227], v[12:15], 0
    ds_read_b64_tr_b16 v[224:225], v254 offset:24576
    v_lshlrev_b32_sdwa v209, 1, v209 dst_sel:DWORD dst_unused:UNUSED_PAD src0_sel:DWORD src1_sel:WORD_1
    s_waitcnt lgkmcnt(11)
    v_mfma_f32_16x16x32_bf16 v[48:51], v[228:231], v[144:147], v[48:51]
    ds_read_b64_tr_b16 v[226:227], v254 offset:24832
    v_or_b32 v161, v194, v195
    v_fma_mixlo_f16 v222, v222, s83, 0
    v_mfma_f32_16x16x32_bf16 v[56:59], v[228:231], v[148:151], v[56:59]
    ds_read_u16_d16 v208, v208
    v_lshlrev_b32_sdwa v210, 1, v210 dst_sel:DWORD dst_unused:UNUSED_PAD src0_sel:DWORD src1_sel:WORD_1
    v_mfma_f32_16x16x32_bf16 v[64:67], v[228:231], v[152:155], v[64:67]
    ds_read_u16_d16_hi v209, v209
    v_rcp_f16_sdwa v205, v205 dst_sel:WORD_1 dst_unused:UNUSED_PRESERVE src0_sel:WORD_1
    v_lshlrev_b32_sdwa v211, 1, v211 dst_sel:DWORD dst_unused:UNUSED_PAD src0_sel:DWORD src1_sel:WORD_1
    v_mfma_f32_16x16x32_bf16 v[72:75], v[228:231], v[156:159], v[72:75]
    ds_read_b64_tr_b16 v[228:229], v255 offset:25664
    v_or_b32 v164, v196, v197
    s_waitcnt lgkmcnt(11)
    v_mfma_f32_16x16x32_bf16 v[176:179], v[232:235], v[16:19], v[176:179]
    ds_read_b64_tr_b16 v[230:231], v255 offset:26432
    v_rcp_f16_sdwa v207, v207 dst_sel:WORD_1 dst_unused:UNUSED_PRESERVE src0_sel:WORD_1
    v_mfma_f32_16x16x32_bf16 v[180:183], v[232:235], v[20:23], v[180:183]
    ds_read_u16_d16 v210, v210
    v_lshlrev_b32_sdwa v212, 1, v212 dst_sel:DWORD dst_unused:UNUSED_PAD src0_sel:DWORD src1_sel:WORD_1
    v_fma_mixhi_f16 v222, v223, s83, 0
    v_mfma_f32_16x16x32_bf16 v[184:187], v[232:235], v[24:27], v[184:187]
    ds_read_u16_d16_hi v211, v211
    v_lshlrev_b32_sdwa v213, 1, v213 dst_sel:DWORD dst_unused:UNUSED_PAD src0_sel:DWORD src1_sel:WORD_1
    v_fma_mix_f32 v172, v204, v205, 0 op_sel_hi:[1,1,0]
    v_mfma_f32_16x16x32_bf16 v[188:191], v[232:235], v[28:31], v[188:191]
    ds_read_b64_tr_b16 v[232:233], v254 offset:22536
    ds_read_b64_tr_b16 v[234:235], v254 offset:22792
    v_or_b32 v165, v198, v199
    v_fma_mix_f32 v173, v206, v207, 0 op_sel_hi:[1,1,0]
    s_waitcnt lgkmcnt(12)
    v_mfma_f32_16x16x32_bf16 v[52:55], v[236:239], v[144:147], v[52:55]
    ds_read_u16_d16 v212, v212
    v_lshlrev_b32_sdwa v214, 1, v214 dst_sel:DWORD dst_unused:UNUSED_PAD src0_sel:DWORD src1_sel:WORD_1
    v_mfma_f32_16x16x32_bf16 v[60:63], v[236:239], v[148:151], v[60:63]
    ds_read_u16_d16_hi v213, v213
    v_pk_fma_f16 v223, v222, v222, s84 neg_lo:[0,1,0] neg_hi:[0,1,0]
    v_lshlrev_b32_sdwa v215, 1, v215 dst_sel:DWORD dst_unused:UNUSED_PAD src0_sel:DWORD src1_sel:WORD_1
    v_mfma_f32_16x16x32_bf16 v[68:71], v[236:239], v[152:155], v[68:71]
    ds_read_u16_d16 v214, v214
    v_fma_mix_f32 v205, v204, v205, 0 op_sel:[1,1,0] op_sel_hi:[1,1,0]
    v_or_b32 v168, v200, v201
    v_mfma_f32_16x16x32_bf16 v[76:79], v[236:239], v[156:159], v[76:79]
    ds_read_b64_tr_b16 v[236:237], v255 offset:25672
    v_fma_mix_f32 v207, v206, v207, 0 op_sel:[1,1,0] op_sel_hi:[1,1,0]
    v_lshlrev_b32_sdwa v216, 1, v216 dst_sel:DWORD dst_unused:UNUSED_PAD src0_sel:DWORD src1_sel:WORD_1
    s_waitcnt lgkmcnt(12)
    v_mfma_f32_16x16x32_bf16 v[176:179], v[224:227], v[32:35], v[176:179]
    ds_read_b64_tr_b16 v[238:239], v255 offset:26440
    v_pk_mul_f16 v223, v223, v222
    v_mfma_f32_16x16x32_bf16 v[180:183], v[224:227], v[36:39], v[180:183]
    ds_read_u16_d16_hi v215, v215
    v_cvt_pk_bf16_f32 v172, v172, v205
    v_lshlrev_b32_sdwa v217, 1, v217 dst_sel:DWORD dst_unused:UNUSED_PAD src0_sel:DWORD src1_sel:WORD_1
    v_mfma_f32_16x16x32_bf16 v[184:187], v[224:227], v[40:43], v[184:187]
    ds_read_u16_d16 v216, v216
    v_cvt_pk_bf16_f32 v173, v173, v207
    v_or_b32 v169, v202, v203
    v_mfma_f32_16x16x32_bf16 v[188:191], v[224:227], v[44:47], v[188:191]
    ds_read_b64_tr_b16 v[224:225], v254 offset:23560
    v_exp_f16_sdwa v223, v223 dst_sel:WORD_0 dst_unused:UNUSED_PRESERVE src0_sel:WORD_0
    s_waitcnt lgkmcnt(12)
    v_mfma_f32_16x16x32_bf16 v[80:83], v[228:231], v[144:147], v[80:83]
    ds_read_b64_tr_b16 v[226:227], v254 offset:23816
    v_lshlrev_b32_sdwa v218, 1, v218 dst_sel:DWORD dst_unused:UNUSED_PAD src0_sel:DWORD src1_sel:WORD_1
    v_lshlrev_b32_sdwa v219, 1, v219 dst_sel:DWORD dst_unused:UNUSED_PAD src0_sel:DWORD src1_sel:WORD_1
    v_mfma_f32_16x16x32_bf16 v[88:91], v[228:231], v[148:151], v[88:91]
    ds_read_u16_d16_hi v217, v217
    v_exp_f16_sdwa v223, v223 dst_sel:WORD_1 dst_unused:UNUSED_PRESERVE src0_sel:WORD_1
    v_mfma_f32_16x16x32_bf16 v[96:99], v[228:231], v[152:155], v[96:99]
    ds_read_u16_d16 v218, v218
    v_lshlrev_b32_sdwa v220, 1, v220 dst_sel:DWORD dst_unused:UNUSED_PAD src0_sel:DWORD src1_sel:WORD_1
    v_mfma_f32_16x16x32_bf16 v[104:107], v[228:231], v[156:159], v[104:107]
    ds_read_b64_tr_b16 v[228:229], v255 offset:25728
    ds_read_b64_tr_b16 v[230:231], v255 offset:26496
    v_lshlrev_b32_sdwa v221, 1, v221 dst_sel:DWORD dst_unused:UNUSED_PAD src0_sel:DWORD src1_sel:WORD_1
    v_pk_fma_f16 v223, v223, s85, s85
    s_cmp_lg_u32 s17, 0
    s_cbranch_scc1 L_pu2
L_pb2:
    s_waitcnt lgkmcnt(13)
    v_mfma_f32_16x16x32_bf16 v[192:195], v[232:235], v[0:3], 0
    ds_read_u16_d16_hi v219, v219
    v_or_b32 v162, v208, v209
    v_mfma_f32_16x16x32_bf16 v[196:199], v[232:235], v[4:7], 0
    ds_read_u16_d16 v220, v220
    v_rcp_f16_sdwa v223, v223 dst_sel:WORD_0 dst_unused:UNUSED_PRESERVE src0_sel:WORD_0
    v_lshlrev_b32_sdwa v176, 1, v176 dst_sel:DWORD dst_unused:UNUSED_PAD src0_sel:DWORD src1_sel:WORD_1
    v_mfma_f32_16x16x32_bf16 v[200:203], v[232:235], v[8:11], 0
    ds_read_u16_d16_hi v221, v221
    v_fma_mixlo_f16 v188, v188, s83, 0
    v_lshlrev_b32_sdwa v177, 1, v177 dst_sel:DWORD dst_unused:UNUSED_PAD src0_sel:DWORD src1_sel:WORD_1
    v_mfma_f32_16x16x32_bf16 v[204:207], v[232:235], v[12:15], 0
    ds_read_b64_tr_b16 v[232:233], v254 offset:24584
    v_fma_mixlo_f16 v190, v190, s83, 0
    v_or_b32 v163, v210, v211
    s_waitcnt lgkmcnt(12)
    v_mfma_f32_16x16x32_bf16 v[84:87], v[236:239], v[144:147], v[84:87]
    ds_read_b64_tr_b16 v[234:235], v254 offset:24840
    v_rcp_f16_sdwa v223, v223 dst_sel:WORD_1 dst_unused:UNUSED_PRESERVE src0_sel:WORD_1
    v_mfma_f32_16x16x32_bf16 v[92:95], v[236:239], v[148:151], v[92:95]
    ds_read_u16_d16 v176, v176
    s_waitcnt vmcnt(1)
    v_mfma_f32_16x16x16_bf16 v[88:91], v[242:243], v[244:245], v[88:91]
    v_lshlrev_b32_sdwa v178, 1, v178 dst_sel:DWORD dst_unused:UNUSED_PAD src0_sel:DWORD src1_sel:WORD_1
    v_mfma_f32_16x16x32_bf16 v[100:103], v[236:239], v[152:155], v[100:103]
    ds_read_u16_d16_hi v177, v177
    v_fma_mixhi_f16 v188, v189, s83, 0
    v_mfma_f32_16x16x32_bf16 v[108:111], v[236:239], v[156:159], v[108:111]
    ds_read_b64_tr_b16 v[236:237], v255 offset:25736
    v_lshlrev_b32_sdwa v179, 1, v179 dst_sel:DWORD dst_unused:UNUSED_PAD src0_sel:DWORD src1_sel:WORD_1
    v_fma_mixhi_f16 v190, v191, s83, 0
    s_waitcnt lgkmcnt(12)
    v_mfma_f32_16x16x32_bf16 v[192:195], v[224:227], v[16:19], v[192:195]
    ds_read_b64_tr_b16 v[238:239], v255 offset:26504
    v_mfma_f32_16x16x16_bf16 v[92:95], v[242:243], v[246:247], v[92:95]
    v_or_b32 v166, v212, v213
    v_fma_mix_f32 v175, v222, v223, 0 op_sel_hi:[1,1,0]
    v_mfma_f32_16x16x32_bf16 v[196:199], v[224:227], v[20:23], v[196:199]
    ds_read_u16_d16 v178, v178
    buffer_load_dwordx4 v[244:247], v252, s[4:7], s25 offen offset:0 sc1
    v_pk_fma_f16 v189, v188, v188, s84 neg_lo:[0,1,0] neg_hi:[0,1,0]
    v_mfma_f32_16x16x32_bf16 v[200:203], v[224:227], v[24:27], v[200:203]
    ds_read_u16_d16_hi v179, v179
    v_lshlrev_b32_sdwa v180, 1, v180 dst_sel:DWORD dst_unused:UNUSED_PAD src0_sel:DWORD src1_sel:WORD_1
    v_pk_fma_f16 v191, v190, v190, s84 neg_lo:[0,1,0] neg_hi:[0,1,0]
    v_mfma_f32_16x16x32_bf16 v[204:207], v[224:227], v[28:31], v[204:207]
    s_cmp_lt_u32 s19, 14
    s_cbranch_scc1 L_rd14_slow
L_rd14_go:
    ds_read_b64_tr_b16 v[224:225], v254 offset:28672
    v_lshlrev_b32_sdwa v181, 1, v181 dst_sel:DWORD dst_unused:UNUSED_PAD src0_sel:DWORD src1_sel:WORD_1
    v_fma_mix_f32 v223, v222, v223, 0 op_sel:[1,1,0] op_sel_hi:[1,1,0]
    s_waitcnt lgkmcnt(12)
    v_mfma_f32_16x16x32_bf16 v[112:115], v[228:231], v[144:147], v[112:115]
    ds_read_b64_tr_b16 v[226:227], v254 offset:28928
    v_or_b32 v167, v214, v215
    v_pk_mul_f16 v189, v189, v188
    v_mfma_f32_16x16x32_bf16 v[120:123], v[228:231], v[148:151], v[120:123]
    ds_read_u16_d16 v180, v180
    v_pk_mul_f16 v191, v191, v190
    v_lshlrev_b32_sdwa v182, 1, v182 dst_sel:DWORD dst_unused:UNUSED_PAD src0_sel:DWORD src1_sel:WORD_1
    v_mfma_f32_16x16x32_bf16 v[128:131], v[228:231], v[152:155], v[128:131]
    ds_read_u16_d16_hi v181, v181
    v_cvt_pk_bf16_f32 v175, v175, v223
    v_lshlrev_b32_sdwa v183, 1, v183 dst_sel:DWORD dst_unused:UNUSED_PAD src0_sel:DWORD src1_sel:WORD_1
    v_mfma_f32_16x16x32_bf16 v[136:139], v[228:231], v[156:159], v[136:139]
    ds_read_b64_tr_b16 v[228:229], v255 offset:31744
    v_exp_f16_sdwa v189, v189 dst_sel:WORD_0 dst_unused:UNUSED_PRESERVE src0_sel:WORD_0
    s_waitcnt lgkmcnt(11)
    v_mfma_f32_16x16x32_bf16 v[192:195], v[232:235], v[32:35], v[192:195]
    ds_read_b64_tr_b16 v[230:231], v255 offset:32512
    v_or_b32 v170, v216, v217
    v_mfma_f32_16x16x32_bf16 v[196:199], v[232:235], v[36:39], v[196:199]
    ds_read_u16_d16 v182, v182
    v_exp_f16_sdwa v191, v191 dst_sel:WORD_0 dst_unused:UNUSED_PRESERVE src0_sel:WORD_0
    v_lshlrev_b32_sdwa v184, 1, v184 dst_sel:DWORD dst_unused:UNUSED_PAD src0_sel:DWORD src1_sel:WORD_1
    v_mfma_f32_16x16x32_bf16 v[200:203], v[232:235], v[40:43], v[200:203]
    ds_read_u16_d16_hi v183, v183
    v_lshlrev_b32_sdwa v185, 1, v185 dst_sel:DWORD dst_unused:UNUSED_PAD src0_sel:DWORD src1_sel:WORD_1
    v_mfma_f32_16x16x32_bf16 v[204:207], v[232:235], v[44:47], v[204:207]
    ds_read_b64_tr_b16 v[232:233], v254 offset:29696
    v_exp_f16_sdwa v189, v189 dst_sel:WORD_1 dst_unused:UNUSED_PRESERVE src0_sel:WORD_1
    s_waitcnt lgkmcnt(11)
    v_mfma_f32_16x16x32_bf16 v[116:119], v[236:239], v[144:147], v[116:119]
    ds_read_b64_tr_b16 v[234:235], v254 offset:29952
    v_or_b32 v171, v218, v219
    v_exp_f16_sdwa v191, v191 dst_sel:WORD_1 dst_unused:UNUSED_PRESERVE src0_sel:WORD_1
    v_mfma_f32_16x16x32_bf16 v[124:127], v[236:239], v[148:151], v[124:127]
    ds_read_u16_d16 v184, v184
    v_lshlrev_b32_sdwa v186, 1, v186 dst_sel:DWORD dst_unused:UNUSED_PAD src0_sel:DWORD src1_sel:WORD_1
    v_mfma_f32_16x16x32_bf16 v[132:135], v[236:239], v[152:155], v[132:135]
    ds_read_u16_d16_hi v185, v185
    v_lshlrev_b32_sdwa v187, 1, v187 dst_sel:DWORD dst_unused:UNUSED_PAD src0_sel:DWORD src1_sel:WORD_1
    v_pk_fma_f16 v189, v189, s85, s85
    v_mfma_f32_16x16x32_bf16 v[140:143], v[236:239], v[156:159], v[140:143]
    ds_read_b64_tr_b16 v[236:237], v255 offset:31752
    v_or_b32 v174, v220, v221
    v_pk_fma_f16 v191, v191, s85, s85
    s_waitcnt lgkmcnt(11)
    v_mfma_f32_16x16x32_bf16 v[208:211], v[224:227], v[0:3], 0
    ds_read_b64_tr_b16 v[238:239], v255 offset:32520
    v_or_b32 v144, v176, v177
    v_mfma_f32_16x16x32_bf16 v[212:215], v[224:227], v[4:7], 0
    ds_read_u16_d16 v186, v186
    v_rcp_f16_sdwa v189, v189 dst_sel:WORD_0 dst_unused:UNUSED_PRESERVE src0_sel:WORD_0
    v_lshlrev_b32_sdwa v192, 1, v192 dst_sel:DWORD dst_unused:UNUSED_PAD src0_sel:DWORD src1_sel:WORD_1
    v_mfma_f32_16x16x32_bf16 v[216:219], v[224:227], v[8:11], 0
    ds_read_u16_d16_hi v187, v187
    v_rcp_f16_sdwa v191, v191 dst_sel:WORD_0 dst_unused:UNUSED_PRESERVE src0_sel:WORD_0
    v_mfma_f32_16x16x32_bf16 v[220:223], v[224:227], v[12:15], 0
    ds_read_b64_tr_b16 v[224:225], v254 offset:30720
    v_lshlrev_b32_sdwa v193, 1, v193 dst_sel:DWORD dst_unused:UNUSED_PAD src0_sel:DWORD src1_sel:WORD_1
    v_or_b32 v145, v178, v179
    s_waitcnt lgkmcnt(11)
    v_mfma_f32_16x16x32_bf16 v[48:51], v[228:231], v[160:163], v[48:51]
    ds_read_b64_tr_b16 v[226:227], v254 offset:30976
    v_fma_mixlo_f16 v206, v206, s83, 0
    v_mfma_f32_16x16x32_bf16 v[56:59], v[228:231], v[164:167], v[56:59]
    ds_read_u16_d16 v192, v192
    s_waitcnt vmcnt(1)
    v_mfma_f32_16x16x16_bf16 v[120:123], v[242:243], v[248:249], v[120:123]
    v_lshlrev_b32_sdwa v194, 1, v194 dst_sel:DWORD dst_unused:UNUSED_PAD src0_sel:DWORD src1_sel:WORD_1
    v_mfma_f32_16x16x32_bf16 v[64:67], v[228:231], v[168:171], v[64:67]
    ds_read_u16_d16_hi v193, v193
    v_rcp_f16_sdwa v189, v189 dst_sel:WORD_1 dst_unused:UNUSED_PRESERVE src0_sel:WORD_1
    v_mfma_f32_16x16x32_bf16 v[72:75], v[228:231], v[172:175], v[72:75]
    ds_read_b64_tr_b16 v[228:229], v255 offset:31808
    v_mfma_f32_16x16x16_bf16 v[124:127], v[242:243], v[250:251], v[124:127]
    v_lshlrev_b32_sdwa v195, 1, v195 dst_sel:DWORD dst_unused:UNUSED_PAD src0_sel:DWORD src1_sel:WORD_1
    v_or_b32 v148, v180, v181
    s_waitcnt lgkmcnt(11)
    v_mfma_f32_16x16x32_bf16 v[208:211], v[232:235], v[16:19], v[208:211]
    ds_read_b64_tr_b16 v[230:231], v255 offset:32576
    buffer_load_dwordx4 v[248:251], v252, s[4:7], s25 offen offset:64 sc1
    v_mfma_f32_16x16x32_bf16 v[212:215], v[232:235], v[20:23], v[212:215]
    ds_read_u16_d16 v194, v194
    v_rcp_f16_sdwa v191, v191 dst_sel:WORD_1 dst_unused:UNUSED_PRESERVE src0_sel:WORD_1
    v_lshlrev_b32_sdwa v196, 1, v196 dst_sel:DWORD dst_unused:UNUSED_PAD src0_sel:DWORD src1_sel:WORD_1
    v_mfma_f32_16x16x32_bf16 v[216:219], v[232:235], v[24:27], v[216:219]
    ds_read_u16_d16_hi v195, v195
    v_fma_mixhi_f16 v206, v207, s83, 0
    v_lshlrev_b32_sdwa v197, 1, v197 dst_sel:DWORD dst_unused:UNUSED_PAD src0_sel:DWORD src1_sel:WORD_1
    v_mfma_f32_16x16x32_bf16 v[220:223], v[232:235], v[28:31], v[220:223]
    ds_read_b64_tr_b16 v[232:233], v254 offset:28680
    ds_read_b64_tr_b16 v[234:235], v254 offset:28936
    v_fma_mix_f32 v156, v188, v189, 0 op_sel_hi:[1,1,0]
    v_or_b32 v149, v182, v183
    s_waitcnt lgkmcnt(12)
    v_mfma_f32_16x16x32_bf16 v[52:55], v[236:239], v[160:163], v[52:55]
    ds_read_u16_d16 v196, v196
    v_fma_mix_f32 v157, v190, v191, 0 op_sel_hi:[1,1,0]
    v_mfma_f32_16x16x32_bf16 v[60:63], v[236:239], v[164:167], v[60:63]
    ds_read_u16_d16_hi v197, v197
    v_lshlrev_b32_sdwa v198, 1, v198 dst_sel:DWORD dst_unused:UNUSED_PAD src0_sel:DWORD src1_sel:WORD_1
    v_pk_fma_f16 v207, v206, v206, s84 neg_lo:[0,1,0] neg_hi:[0,1,0]
    v_mfma_f32_16x16x32_bf16 v[68:71], v[236:239], v[168:171], v[68:71]
    ds_read_u16_d16 v198, v198
    v_lshlrev_b32_sdwa v199, 1, v199 dst_sel:DWORD dst_unused:UNUSED_PAD src0_sel:DWORD src1_sel:WORD_1
    v_fma_mix_f32 v189, v188, v189, 0 op_sel:[1,1,0] op_sel_hi:[1,1,0]
    v_mfma_f32_16x16x32_bf16 v[76:79], v[236:239], v[172:175], v[76:79]
    ds_read_b64_tr_b16 v[236:237], v255 offset:31816
    v_or_b32 v152, v184, v185
    v_fma_mix_f32 v191, v190, v191, 0 op_sel:[1,1,0] op_sel_hi:[1,1,0]
    s_waitcnt lgkmcnt(12)
    v_mfma_f32_16x16x32_bf16 v[208:211], v[224:227], v[32:35], v[208:211]
    ds_read_b64_tr_b16 v[238:239], v255 offset:32584
    v_lshlrev_b32_sdwa v200, 1, v200 dst_sel:DWORD dst_unused:UNUSED_PAD src0_sel:DWORD src1_sel:WORD_1
    v_pk_mul_f16 v207, v207, v206
    v_mfma_f32_16x16x32_bf16 v[212:215], v[224:227], v[36:39], v[212:215]
    ds_read_u16_d16_hi v199, v199
    v_cvt_pk_bf16_f32 v156, v156, v189
    v_lshlrev_b32_sdwa v201, 1, v201 dst_sel:DWORD dst_unused:UNUSED_PAD src0_sel:DWORD src1_sel:WORD_1
    v_mfma_f32_16x16x32_bf16 v[216:219], v[224:227], v[40:43], v[216:219]
    ds_read_u16_d16 v200, v200
    v_cvt_pk_bf16_f32 v157, v157, v191
    v_or_b32 v153, v186, v187
    v_mfma_f32_16x16x32_bf16 v[220:223], v[224:227], v[44:47], v[220:223]
    ds_read_b64_tr_b16 v[224:225], v254 offset:29704
    v_exp_f16_sdwa v207, v207 dst_sel:WORD_0 dst_unused:UNUSED_PRESERVE src0_sel:WORD_0
    s_waitcnt lgkmcnt(12)
    v_mfma_f32_16x16x32_bf16 v[80:83], v[228:231], v[160:163], v[80:83]
    ds_read_b64_tr_b16 v[226:227], v254 offset:29960
    v_lshlrev_b32_sdwa v202, 1, v202 dst_sel:DWORD dst_unused:UNUSED_PAD src0_sel:DWORD src1_sel:WORD_1
    v_mfma_f32_16x16x32_bf16 v[88:91], v[228:231], v[164:167], v[88:91]
    ds_read_u16_d16_hi v201, v201
    v_lshlrev_b32_sdwa v203, 1, v203 dst_sel:DWORD dst_unused:UNUSED_PAD src0_sel:DWORD src1_sel:WORD_1
    v_exp_f16_sdwa v207, v207 dst_sel:WORD_1 dst_unused:UNUSED_PRESERVE src0_sel:WORD_1
    v_mfma_f32_16x16x32_bf16 v[96:99], v[228:231], v[168:171], v[96:99]
    ds_read_u16_d16 v202, v202
    v_lshlrev_b32_sdwa v204, 1, v204 dst_sel:DWORD dst_unused:UNUSED_PAD src0_sel:DWORD src1_sel:WORD_1
    v_mfma_f32_16x16x32_bf16 v[104:107], v[228:231], v[172:175], v[104:107]
    ds_read_b64_tr_b16 v[228:229], v255 offset:31872
    ds_read_b64_tr_b16 v[230:231], v255 offset:32640
    v_lshlrev_b32_sdwa v205, 1, v205 dst_sel:DWORD dst_unused:UNUSED_PAD src0_sel:DWORD src1_sel:WORD_1
    v_pk_fma_f16 v207, v207, s85, s85
    s_waitcnt lgkmcnt(13)
    v_mfma_f32_16x16x32_bf16 v[176:179], v[232:235], v[0:3], 0
    ds_read_u16_d16_hi v203, v203
    v_or_b32 v146, v192, v193
    v_mfma_f32_16x16x32_bf16 v[180:183], v[232:235], v[4:7], 0
    ds_read_u16_d16 v204, v204
    v_rcp_f16_sdwa v207, v207 dst_sel:WORD_0 dst_unused:UNUSED_PRESERVE src0_sel:WORD_0
    v_lshlrev_b32_sdwa v208, 1, v208 dst_sel:DWORD dst_unused:UNUSED_PAD src0_sel:DWORD src1_sel:WORD_1
    v_mfma_f32_16x16x32_bf16 v[184:187], v[232:235], v[8:11], 0
    ds_read_u16_d16_hi v205, v205
    v_fma_mixlo_f16 v220, v220, s83, 0
    v_lshlrev_b32_sdwa v209, 1, v209 dst_sel:DWORD dst_unused:UNUSED_PAD src0_sel:DWORD src1_sel:WORD_1
    v_mfma_f32_16x16x32_bf16 v[188:191], v[232:235], v[12:15], 0
    ds_read_b64_tr_b16 v[232:233], v254 offset:30728
    v_fma_mixlo_f16 v222, v222, s83, 0
    s_waitcnt lgkmcnt(12)
    v_mfma_f32_16x16x32_bf16 v[84:87], v[236:239], v[160:163], v[84:87]
    ds_read_b64_tr_b16 v[234:235], v254 offset:30984
    v_or_b32 v147, v194, v195
    v_rcp_f16_sdwa v207, v207 dst_sel:WORD_1 dst_unused:UNUSED_PRESERVE src0_sel:WORD_1
    v_mfma_f32_16x16x32_bf16 v[92:95], v[236:239], v[164:167], v[92:95]
    ds_read_u16_d16 v208, v208
    v_lshlrev_b32_sdwa v210, 1, v210 dst_sel:DWORD dst_unused:UNUSED_PAD src0_sel:DWORD src1_sel:WORD_1
    v_mfma_f32_16x16x32_bf16 v[100:103], v[236:239], v[168:171], v[100:103]
    ds_read_u16_d16_hi v209, v209
    v_fma_mixhi_f16 v220, v221, s83, 0
    v_lshlrev_b32_sdwa v211, 1, v211 dst_sel:DWORD dst_unused:UNUSED_PAD src0_sel:DWORD src1_sel:WORD_1
    v_mfma_f32_16x16x32_bf16 v[108:111], v[236:239], v[172:175], v[108:111]
    ds_read_b64_tr_b16 v[236:237], v255 offset:31880
    v_fma_mixhi_f16 v222, v223, s83, 0
    v_or_b32 v150, v196, v197
    s_waitcnt lgkmcnt(12)
    v_mfma_f32_16x16x32_bf16 v[176:179], v[224:227], v[16:19], v[176:179]
    ds_read_b64_tr_b16 v[238:239], v255 offset:32648
    v_fma_mix_f32 v159, v206, v207, 0 op_sel_hi:[1,1,0]
    v_pk_fma_f16 v221, v220, v220, s84 neg_lo:[0,1,0] neg_hi:[0,1,0]
    v_mfma_f32_16x16x32_bf16 v[180:183], v[224:227], v[20:23], v[180:183]
    ds_read_u16_d16 v210, v210
    v_lshlrev_b32_sdwa v212, 1, v212 dst_sel:DWORD dst_unused:UNUSED_PAD src0_sel:DWORD src1_sel:WORD_1
    v_mfma_f32_16x16x32_bf16 v[184:187], v[224:227], v[24:27], v[184:187]
    ds_read_u16_d16_hi v211, v211
    v_pk_fma_f16 v223, v222, v222, s84 neg_lo:[0,1,0] neg_hi:[0,1,0]
    v_lshlrev_b32_sdwa v213, 1, v213 dst_sel:DWORD dst_unused:UNUSED_PAD src0_sel:DWORD src1_sel:WORD_1
    v_mfma_f32_16x16x32_bf16 v[188:191], v[224:227], v[28:31], v[188:191]
    s_cmp_lt_u32 s19, 16
    s_cbranch_scc1 L_rd16_slow
L_rd16_go:
    ds_read_b64_tr_b16 v[224:225], v254 offset:34816
    v_fma_mix_f32 v207, v206, v207, 0 op_sel:[1,1,0] op_sel_hi:[1,1,0]
    v_or_b32 v151, v198, v199
    s_waitcnt lgkmcnt(12)
    v_mfma_f32_16x16x32_bf16 v[112:115], v[228:231], v[160:163], v[112:115]
    ds_read_b64_tr_b16 v[226:227], v254 offset:35072
    v_pk_mul_f16 v221, v221, v220
    v_pk_mul_f16 v223, v223, v222
    v_mfma_f32_16x16x32_bf16 v[120:123], v[228:231], v[164:167], v[120:123]
    ds_read_u16_d16 v212, v212
    v_lshlrev_b32_sdwa v214, 1, v214 dst_sel:DWORD dst_unused:UNUSED_PAD src0_sel:DWORD src1_sel:WORD_1
    v_cvt_pk_bf16_f32 v159, v159, v207
    v_mfma_f32_16x16x32_bf16 v[128:131], v[228:231], v[168:171], v[128:131]
    ds_read_u16_d16_hi v213, v213
    v_lshlrev_b32_sdwa v215, 1, v215 dst_sel:DWORD dst_unused:UNUSED_PAD src0_sel:DWORD src1_sel:WORD_1
    v_mfma_f32_16x16x32_bf16 v[136:139], v[228:231], v[172:175], v[136:139]
    ds_read_b64_tr_b16 v[228:229], v255 offset:37888
    v_exp_f16_sdwa v221, v221 dst_sel:WORD_0 dst_unused:UNUSED_PRESERVE src0_sel:WORD_0
    s_waitcnt lgkmcnt(11)
    v_mfma_f32_16x16x32_bf16 v[176:179], v[232:235], v[32:35], v[176:179]
    ds_read_b64_tr_b16 v[230:231], v255 offset:38656
    v_or_b32 v154, v200, v201
    v_exp_f16_sdwa v223, v223 dst_sel:WORD_0 dst_unused:UNUSED_PRESERVE src0_sel:WORD_0
    v_mfma_f32_16x16x32_bf16 v[180:183], v[232:235], v[36:39], v[180:183]
    ds_read_u16_d16 v214, v214
    v_lshlrev_b32_sdwa v216, 1, v216 dst_sel:DWORD dst_unused:UNUSED_PAD src0_sel:DWORD src1_sel:WORD_1
    v_mfma_f32_16x16x32_bf16 v[184:187], v[232:235], v[40:43], v[184:187]
    ds_read_u16_d16_hi v215, v215
    v_lshlrev_b32_sdwa v217, 1, v217 dst_sel:DWORD dst_unused:UNUSED_PAD src0_sel:DWORD src1_sel:WORD_1
    v_mfma_f32_16x16x32_bf16 v[188:191], v[232:235], v[44:47], v[188:191]
    ds_read_b64_tr_b16 v[232:233], v254 offset:35840
    v_exp_f16_sdwa v221, v221 dst_sel:WORD_1 dst_unused:UNUSED_PRESERVE src0_sel:WORD_1
    v_or_b32 v155, v202, v203
    s_waitcnt lgkmcnt(11)
    v_mfma_f32_16x16x32_bf16 v[116:119], v[236:239], v[160:163], v[116:119]
    ds_read_b64_tr_b16 v[234:235], v254 offset:36096
    v_exp_f16_sdwa v223, v223 dst_sel:WORD_1 dst_unused:UNUSED_PRESERVE src0_sel:WORD_1
    v_mfma_f32_16x16x32_bf16 v[124:127], v[236:239], v[164:167], v[124:127]
    ds_read_u16_d16 v216, v216
    v_lshlrev_b32_sdwa v218, 1, v218 dst_sel:DWORD dst_unused:UNUSED_PAD src0_sel:DWORD src1_sel:WORD_1
    v_mfma_f32_16x16x32_bf16 v[132:135], v[236:239], v[168:171], v[132:135]
    ds_read_u16_d16_hi v217, v217
    v_lshlrev_b32_sdwa v219, 1, v219 dst_sel:DWORD dst_unused:UNUSED_PAD src0_sel:DWORD src1_sel:WORD_1
    v_pk_fma_f16 v221, v221, s85, s85
    v_mfma_f32_16x16x32_bf16 v[140:143], v[236:239], v[172:175], v[140:143]
    ds_read_b64_tr_b16 v[236:237], v255 offset:37896
    v_or_b32 v158, v204, v205
    v_pk_fma_f16 v223, v223, s85, s85
    s_waitcnt lgkmcnt(11)
    v_mfma_f32_16x16x32_bf16 v[192:195], v[224:227], v[0:3], 0
    ds_read_b64_tr_b16 v[238:239], v255 offset:38664
    v_or_b32 v160, v208, v209
    v_mfma_f32_16x16x32_bf16 v[196:199], v[224:227], v[4:7], 0
    ds_read_u16_d16 v218, v218
    v_rcp_f16_sdwa v221, v221 dst_sel:WORD_0 dst_unused:UNUSED_PRESERVE src0_sel:WORD_0
    v_lshlrev_b32_sdwa v176, 1, v176 dst_sel:DWORD dst_unused:UNUSED_PAD src0_sel:DWORD src1_sel:WORD_1
    v_mfma_f32_16x16x32_bf16 v[200:203], v[224:227], v[8:11], 0
    ds_read_u16_d16_hi v219, v219
    v_rcp_f16_sdwa v223, v223 dst_sel:WORD_0 dst_unused:UNUSED_PRESERVE src0_sel:WORD_0
    v_mfma_f32_16x16x32_bf16 v[204:207], v[224:227], v[12:15], 0
    ds_read_b64_tr_b16 v[224:225], v254 offset:36864
    v_lshlrev_b32_sdwa v177, 1, v177 dst_sel:DWORD dst_unused:UNUSED_PAD src0_sel:DWORD src1_sel:WORD_1
    v_or_b32 v161, v210, v211
    s_waitcnt lgkmcnt(11)
    v_mfma_f32_16x16x32_bf16 v[48:51], v[228:231], v[144:147], v[48:51]
    ds_read_b64_tr_b16 v[226:227], v254 offset:37120
    v_fma_mixlo_f16 v190, v190, s83, 0
    v_mfma_f32_16x16x32_bf16 v[56:59], v[228:231], v[148:151], v[56:59]
    ds_read_u16_d16 v176, v176
    s_waitcnt vmcnt(1)
    v_mfma_f32_16x16x16_bf16 v[68:71], v[242:243], v[246:247], v[68:71]
    v_lshlrev_b32_sdwa v178, 1, v178 dst_sel:DWORD dst_unused:UNUSED_PAD src0_sel:DWORD src1_sel:WORD_1
    v_mfma_f32_16x16x32_bf16 v[64:67], v[228:231], v[152:155], v[64:67]
    ds_read_u16_d16_hi v177, v177
    v_rcp_f16_sdwa v221, v221 dst_sel:WORD_1 dst_unused:UNUSED_PRESERVE src0_sel:WORD_1
    v_mfma_f32_16x16x32_bf16 v[72:75], v[228:231], v[156:159], v[72:75]
    ds_read_b64_tr_b16 v[228:229], v255 offset:37952
    v_lshlrev_b32_sdwa v179, 1, v179 dst_sel:DWORD dst_unused:UNUSED_PAD src0_sel:DWORD src1_sel:WORD_1
    v_or_b32 v164, v212, v213
    s_waitcnt lgkmcnt(11)
    v_mfma_f32_16x16x32_bf16 v[192:195], v[232:235], v[16:19], v[192:195]
    ds_read_b64_tr_b16 v[230:231], v255 offset:38720
    v_rcp_f16_sdwa v223, v223 dst_sel:WORD_1 dst_unused:UNUSED_PRESERVE src0_sel:WORD_1
    v_mfma_f32_16x16x32_bf16 v[196:199], v[232:235], v[20:23], v[196:199]
    ds_read_u16_d16 v178, v178
    v_mfma_f32_16x16x16_bf16 v[64:67], v[242:243], v[244:245], v[64:67]
    v_lshlrev_b32_sdwa v180, 1, v180 dst_sel:DWORD dst_unused:UNUSED_PAD src0_sel:DWORD src1_sel:WORD_1
    v_fma_mixhi_f16 v190, v191, s83, 0
    v_mfma_f32_16x16x32_bf16 v[200:203], v[232:235], v[24:27], v[200:203]
    ds_read_u16_d16_hi v179, v179
    buffer_load_dwordx4 v[244:247], v252, s[4:7], s25 offen offset:128 sc1
    v_lshlrev_b32_sdwa v181, 1, v181 dst_sel:DWORD dst_unused:UNUSED_PAD src0_sel:DWORD src1_sel:WORD_1
    v_mfma_f32_16x16x32_bf16 v[204:207], v[232:235], v[28:31], v[204:207]
    ds_read_b64_tr_b16 v[232:233], v254 offset:34824
    ds_read_b64_tr_b16 v[234:235], v254 offset:35080
    v_fma_mix_f32 v172, v220, v221, 0 op_sel_hi:[1,1,0]
    v_or_b32 v165, v214, v215
    s_waitcnt lgkmcnt(12)
    v_mfma_f32_16x16x32_bf16 v[52:55], v[236:239], v[144:147], v[52:55]
    ds_read_u16_d16 v180, v180
    v_fma_mix_f32 v173, v222, v223, 0 op_sel_hi:[1,1,0]
    v_mfma_f32_16x16x32_bf16 v[60:63], v[236:239], v[148:151], v[60:63]
    ds_read_u16_d16_hi v181, v181
    v_lshlrev_b32_sdwa v182, 1, v182 dst_sel:DWORD dst_unused:UNUSED_PAD src0_sel:DWORD src1_sel:WORD_1
    v_pk_fma_f16 v191, v190, v190, s84 neg_lo:[0,1,0] neg_hi:[0,1,0]
    v_mfma_f32_16x16x32_bf16 v[68:71], v[236:239], v[152:155], v[68:71]
    ds_read_u16_d16 v182, v182
    v_lshlrev_b32_sdwa v183, 1, v183 dst_sel:DWORD dst_unused:UNUSED_PAD src0_sel:DWORD src1_sel:WORD_1
    v_fma_mix_f32 v221, v220, v221, 0 op_sel:[1,1,0] op_sel_hi:[1,1,0]
    v_mfma_f32_16x16x32_bf16 v[76:79], v[236:239], v[156:159], v[76:79]
    ds_read_b64_tr_b16 v[236:237], v255 offset:37960
    v_or_b32 v168, v216, v217
    v_fma_mix_f32 v223, v222, v223, 0 op_sel:[1,1,0] op_sel_hi:[1,1,0]
    s_waitcnt lgkmcnt(12)
    v_mfma_f32_16x16x32_bf16 v[192:195], v[224:227], v[32:35], v[192:195]
    ds_read_b64_tr_b16 v[238:239], v255 offset:38728
    v_lshlrev_b32_sdwa v184, 1, v184 dst_sel:DWORD dst_unused:UNUSED_PAD src0_sel:DWORD src1_sel:WORD_1
    v_pk_mul_f16 v191, v191, v190
    v_mfma_f32_16x16x32_bf16 v[196:199], v[224:227], v[36:39], v[196:199]
    ds_read_u16_d16_hi v183, v183
    v_cvt_pk_bf16_f32 v172, v172, v221
    v_lshlrev_b32_sdwa v185, 1, v185 dst_sel:DWORD dst_unused:UNUSED_PAD src0_sel:DWORD src1_sel:WORD_1
    v_mfma_f32_16x16x32_bf16 v[200:203], v[224:227], v[40:43], v[200:203]
    ds_read_u16_d16 v184, v184
    v_cvt_pk_bf16_f32 v173, v173, v223
    v_or_b32 v169, v218, v219
    v_mfma_f32_16x16x32_bf16 v[204:207], v[224:227], v[44:47], v[204:207]
    ds_read_b64_tr_b16 v[224:225], v254 offset:35848
    v_exp_f16_sdwa v191, v191 dst_sel:WORD_0 dst_unused:UNUSED_PRESERVE src0_sel:WORD_0
    s_waitcnt lgkmcnt(12)
    v_mfma_f32_16x16x32_bf16 v[80:83], v[228:231], v[144:147], v[80:83]
    ds_read_b64_tr_b16 v[226:227], v254 offset:36104
    v_lshlrev_b32_sdwa v186, 1, v186 dst_sel:DWORD dst_unused:UNUSED_PAD src0_sel:DWORD src1_sel:WORD_1
    v_mfma_f32_16x16x32_bf16 v[88:91], v[228:231], v[148:151], v[88:91]
    ds_read_u16_d16_hi v185, v185
    v_lshlrev_b32_sdwa v187, 1, v187 dst_sel:DWORD dst_unused:UNUSED_PAD src0_sel:DWORD src1_sel:WORD_1
    v_exp_f16_sdwa v191, v191 dst_sel:WORD_1 dst_unused:UNUSED_PRESERVE src0_sel:WORD_1
    v_mfma_f32_16x16x32_bf16 v[96:99], v[228:231], v[152:155], v[96:99]
    ds_read_u16_d16 v186, v186
    v_lshlrev_b32_sdwa v188, 1, v188 dst_sel:DWORD dst_unused:UNUSED_PAD src0_sel:DWORD src1_sel:WORD_1
    v_mfma_f32_16x16x32_bf16 v[104:107], v[228:231], v[156:159], v[104:107]
    ds_read_b64_tr_b16 v[228:229], v255 offset:38016
    ds_read_b64_tr_b16 v[230:231], v255 offset:38784
    v_lshlrev_b32_sdwa v189, 1, v189 dst_sel:DWORD dst_unused:UNUSED_PAD src0_sel:DWORD src1_sel:WORD_1
    v_pk_fma_f16 v191, v191, s85, s85
    s_waitcnt lgkmcnt(13)
    v_mfma_f32_16x16x32_bf16 v[208:211], v[232:235], v[0:3], 0
    ds_read_u16_d16_hi v187, v187
    v_or_b32 v162, v176, v177
    v_mfma_f32_16x16x32_bf16 v[212:215], v[232:235], v[4:7], 0
    ds_read_u16_d16 v188, v188
    v_rcp_f16_sdwa v191, v191 dst_sel:WORD_0 dst_unused:UNUSED_PRESERVE src0_sel:WORD_0
    v_lshlrev_b32_sdwa v192, 1, v192 dst_sel:DWORD dst_unused:UNUSED_PAD src0_sel:DWORD src1_sel:WORD_1
    v_mfma_f32_16x16x32_bf16 v[216:219], v[232:235], v[8:11], 0
    ds_read_u16_d16_hi v189, v189
    v_fma_mixlo_f16 v204, v204, s83, 0
    v_lshlrev_b32_sdwa v193, 1, v193 dst_sel:DWORD dst_unused:UNUSED_PAD src0_sel:DWORD src1_sel:WORD_1
    v_mfma_f32_16x16x32_bf16 v[220:223], v[232:235], v[12:15], 0
    ds_read_b64_tr_b16 v[232:233], v254 offset:36872
    v_fma_mixlo_f16 v206, v206, s83, 0
    v_or_b32 v163, v178, v179
    s_waitcnt lgkmcnt(12)
    v_mfma_f32_16x16x32_bf16 v[84:87], v[236:239], v[144:147], v[84:87]
    ds_read_b64_tr_b16 v[234:235], v254 offset:37128
    v_rcp_f16_sdwa v191, v191 dst_sel:WORD_1 dst_unused:UNUSED_PRESERVE src0_sel:WORD_1
    v_mfma_f32_16x16x32_bf16 v[92:95], v[236:239], v[148:151], v[92:95]
    ds_read_u16_d16 v192, v192
    s_waitcnt vmcnt(1)
    v_mfma_f32_16x16x16_bf16 v[96:99], v[242:243], v[248:249], v[96:99]
    v_lshlrev_b32_sdwa v194, 1, v194 dst_sel:DWORD dst_unused:UNUSED_PAD src0_sel:DWORD src1_sel:WORD_1
    v_mfma_f32_16x16x32_bf16 v[100:103], v[236:239], v[152:155], v[100:103]
    ds_read_u16_d16_hi v193, v193
    v_fma_mixhi_f16 v204, v205, s83, 0
    v_mfma_f32_16x16x32_bf16 v[108:111], v[236:239], v[156:159], v[108:111]
    ds_read_b64_tr_b16 v[236:237], v255 offset:38024
    v_lshlrev_b32_sdwa v195, 1, v195 dst_sel:DWORD dst_unused:UNUSED_PAD src0_sel:DWORD src1_sel:WORD_1
    v_fma_mixhi_f16 v206, v207, s83, 0
    s_waitcnt lgkmcnt(12)
    v_mfma_f32_16x16x32_bf16 v[208:211], v[224:227], v[16:19], v[208:211]
    ds_read_b64_tr_b16 v[238:239], v255 offset:38792
    v_or_b32 v166, v180, v181
    v_fma_mix_f32 v175, v190, v191, 0 op_sel_hi:[1,1,0]
    v_mfma_f32_16x16x32_bf16 v[212:215], v[224:227], v[20:23], v[212:215]
    ds_read_u16_d16 v194, v194
    v_mfma_f32_16x16x16_bf16 v[100:103], v[242:243], v[250:251], v[100:103]
    v_pk_fma_f16 v205, v204, v204, s84 neg_lo:[0,1,0] neg_hi:[0,1,0]
    v_lshlrev_b32_sdwa v196, 1, v196 dst_sel:DWORD dst_unused:UNUSED_PAD src0_sel:DWORD src1_sel:WORD_1
    v_mfma_f32_16x16x32_bf16 v[216:219], v[224:227], v[24:27], v[216:219]
    ds_read_u16_d16_hi v195, v195
    buffer_load_dwordx4 v[248:251], v252, s[4:7], s25 offen offset:192 sc1
    v_pk_fma_f16 v207, v206, v206, s84 neg_lo:[0,1,0] neg_hi:[0,1,0]
    v_mfma_f32_16x16x32_bf16 v[220:223], v[224:227], v[28:31], v[220:223]
    s_cmp_lt_u32 s19, 18
    s_cbranch_scc1 L_rd18_slow
L_rd18_go:
    ds_read_b64_tr_b16 v[224:225], v254 offset:40960
    v_lshlrev_b32_sdwa v197, 1, v197 dst_sel:DWORD dst_unused:UNUSED_PAD src0_sel:DWORD src1_sel:WORD_1
    v_fma_mix_f32 v191, v190, v191, 0 op_sel:[1,1,0] op_sel_hi:[1,1,0]
    s_waitcnt lgkmcnt(12)
    v_mfma_f32_16x16x32_bf16 v[112:115], v[228:231], v[144:147], v[112:115]
    ds_read_b64_tr_b16 v[226:227], v254 offset:41216
    v_or_b32 v167, v182, v183
    v_pk_mul_f16 v205, v205, v204
    v_mfma_f32_16x16x32_bf16 v[120:123], v[228:231], v[148:151], v[120:123]
    ds_read_u16_d16 v196, v196
    v_pk_mul_f16 v207, v207, v206
    v_lshlrev_b32_sdwa v198, 1, v198 dst_sel:DWORD dst_unused:UNUSED_PAD src0_sel:DWORD src1_sel:WORD_1
    v_mfma_f32_16x16x32_bf16 v[128:131], v[228:231], v[152:155], v[128:131]
    ds_read_u16_d16_hi v197, v197
    v_cvt_pk_bf16_f32 v175, v175, v191
    v_lshlrev_b32_sdwa v199, 1, v199 dst_sel:DWORD dst_unused:UNUSED_PAD src0_sel:DWORD src1_sel:WORD_1
    v_mfma_f32_16x16x32_bf16 v[136:139], v[228:231], v[156:159], v[136:139]
    ds_read_b64_tr_b16 v[228:229], v255 offset:44032
    v_exp_f16_sdwa v205, v205 dst_sel:WORD_0 dst_unused:UNUSED_PRESERVE src0_sel:WORD_0
    s_waitcnt lgkmcnt(11)
    v_mfma_f32_16x16x32_bf16 v[208:211], v[232:235], v[32:35], v[208:211]
    ds_read_b64_tr_b16 v[230:231], v255 offset:44800
    v_or_b32 v170, v184, v185
    v_mfma_f32_16x16x32_bf16 v[212:215], v[232:235], v[36:39], v[212:215]
    ds_read_u16_d16 v198, v198
    v_exp_f16_sdwa v207, v207 dst_sel:WORD_0 dst_unused:UNUSED_PRESERVE src0_sel:WORD_0
    v_lshlrev_b32_sdwa v200, 1, v200 dst_sel:DWORD dst_unused:UNUSED_PAD src0_sel:DWORD src1_sel:WORD_1
    v_mfma_f32_16x16x32_bf16 v[216:219], v[232:235], v[40:43], v[216:219]
    ds_read_u16_d16_hi v199, v199
    v_lshlrev_b32_sdwa v201, 1, v201 dst_sel:DWORD dst_unused:UNUSED_PAD src0_sel:DWORD src1_sel:WORD_1
    v_mfma_f32_16x16x32_bf16 v[220:223], v[232:235], v[44:47], v[220:223]
    ds_read_b64_tr_b16 v[232:233], v254 offset:41984
    v_exp_f16_sdwa v205, v205 dst_sel:WORD_1 dst_unused:UNUSED_PRESERVE src0_sel:WORD_1
    s_waitcnt lgkmcnt(11)
    v_mfma_f32_16x16x32_bf16 v[116:119], v[236:239], v[144:147], v[116:119]
    ds_read_b64_tr_b16 v[234:235], v254 offset:42240
    v_or_b32 v171, v186, v187
    v_exp_f16_sdwa v207, v207 dst_sel:WORD_1 dst_unused:UNUSED_PRESERVE src0_sel:WORD_1
    v_mfma_f32_16x16x32_bf16 v[124:127], v[236:239], v[148:151], v[124:127]
    ds_read_u16_d16 v200, v200
    v_lshlrev_b32_sdwa v202, 1, v202 dst_sel:DWORD dst_unused:UNUSED_PAD src0_sel:DWORD src1_sel:WORD_1
    v_mfma_f32_16x16x32_bf16 v[132:135], v[236:239], v[152:155], v[132:135]
    ds_read_u16_d16_hi v201, v201
    v_lshlrev_b32_sdwa v203, 1, v203 dst_sel:DWORD dst_unused:UNUSED_PAD src0_sel:DWORD src1_sel:WORD_1
    v_pk_fma_f16 v205, v205, s85, s85
    v_mfma_f32_16x16x32_bf16 v[140:143], v[236:239], v[156:159], v[140:143]
    ds_read_b64_tr_b16 v[236:237], v255 offset:44040
    v_or_b32 v174, v188, v189
    v_pk_fma_f16 v207, v207, s85, s85
    s_waitcnt lgkmcnt(11)
    v_mfma_f32_16x16x32_bf16 v[176:179], v[224:227], v[0:3], 0
    ds_read_b64_tr_b16 v[238:239], v255 offset:44808
    v_or_b32 v144, v192, v193
    v_mfma_f32_16x16x32_bf16 v[180:183], v[224:227], v[4:7], 0
    ds_read_u16_d16 v202, v202
    v_rcp_f16_sdwa v205, v205 dst_sel:WORD_0 dst_unused:UNUSED_PRESERVE src0_sel:WORD_0
    v_lshlrev_b32_sdwa v208, 1, v208 dst_sel:DWORD dst_unused:UNUSED_PAD src0_sel:DWORD src1_sel:WORD_1
    v_mfma_f32_16x16x32_bf16 v[184:187], v[224:227], v[8:11], 0
    ds_read_u16_d16_hi v203, v203
    v_rcp_f16_sdwa v207, v207 dst_sel:WORD_0 dst_unused:UNUSED_PRESERVE src0_sel:WORD_0
    v_mfma_f32_16x16x32_bf16 v[188:191], v[224:227], v[12:15], 0
    ds_read_b64_tr_b16 v[224:225], v254 offset:43008
    v_lshlrev_b32_sdwa v209, 1, v209 dst_sel:DWORD dst_unused:UNUSED_PAD src0_sel:DWORD src1_sel:WORD_1
    s_waitcnt lgkmcnt(11)
    v_mfma_f32_16x16x32_bf16 v[48:51], v[228:231], v[160:163], v[48:51]
    ds_read_b64_tr_b16 v[226:227], v254 offset:43264
    v_or_b32 v145, v194, v195
    v_fma_mixlo_f16 v222, v222, s83, 0
    v_mfma_f32_16x16x32_bf16 v[56:59], v[228:231], v[164:167], v[56:59]
    ds_read_u16_d16 v208, v208
    v_lshlrev_b32_sdwa v210, 1, v210 dst_sel:DWORD dst_unused:UNUSED_PAD src0_sel:DWORD src1_sel:WORD_1
    v_mfma_f32_16x16x32_bf16 v[64:67], v[228:231], v[168:171], v[64:67]
    ds_read_u16_d16_hi v209, v209
    v_rcp_f16_sdwa v205, v205 dst_sel:WORD_1 dst_unused:UNUSED_PRESERVE src0_sel:WORD_1
    v_lshlrev_b32_sdwa v211, 1, v211 dst_sel:DWORD dst_unused:UNUSED_PAD src0_sel:DWORD src1_sel:WORD_1
    v_mfma_f32_16x16x32_bf16 v[72:75], v[228:231], v[172:175], v[72:75]
    ds_read_b64_tr_b16 v[228:229], v255 offset:44096
    v_or_b32 v148, v196, v197
    s_waitcnt lgkmcnt(11)
    v_mfma_f32_16x16x32_bf16 v[176:179], v[232:235], v[16:19], v[176:179]
    ds_read_b64_tr_b16 v[230:231], v255 offset:44864
    v_rcp_f16_sdwa v207, v207 dst_sel:WORD_1 dst_unused:UNUSED_PRESERVE src0_sel:WORD_1
    v_mfma_f32_16x16x32_bf16 v[180:183], v[232:235], v[20:23], v[180:183]
    ds_read_u16_d16 v210, v210
    v_lshlrev_b32_sdwa v212, 1, v212 dst_sel:DWORD dst_unused:UNUSED_PAD src0_sel:DWORD src1_sel:WORD_1
    v_fma_mixhi_f16 v222, v223, s83, 0
    v_mfma_f32_16x16x32_bf16 v[184:187], v[232:235], v[24:27], v[184:187]
    ds_read_u16_d16_hi v211, v211
    v_lshlrev_b32_sdwa v213, 1, v213 dst_sel:DWORD dst_unused:UNUSED_PAD src0_sel:DWORD src1_sel:WORD_1
    v_fma_mix_f32 v156, v204, v205, 0 op_sel_hi:[1,1,0]
    v_mfma_f32_16x16x32_bf16 v[188:191], v[232:235], v[28:31], v[188:191]
    ds_read_b64_tr_b16 v[232:233], v254 offset:40968
    ds_read_b64_tr_b16 v[234:235], v254 offset:41224
    v_or_b32 v149, v198, v199
    v_fma_mix_f32 v157, v206, v207, 0 op_sel_hi:[1,1,0]
    s_waitcnt lgkmcnt(12)
    v_mfma_f32_16x16x32_bf16 v[52:55], v[236:239], v[160:163], v[52:55]
    ds_read_u16_d16 v212, v212
    v_lshlrev_b32_sdwa v214, 1, v214 dst_sel:DWORD dst_unused:UNUSED_PAD src0_sel:DWORD src1_sel:WORD_1
    v_mfma_f32_16x16x32_bf16 v[60:63], v[236:239], v[164:167], v[60:63]
    ds_read_u16_d16_hi v213, v213
    v_pk_fma_f16 v223, v222, v222, s84 neg_lo:[0,1,0] neg_hi:[0,1,0]
    v_lshlrev_b32_sdwa v215, 1, v215 dst_sel:DWORD dst_unused:UNUSED_PAD src0_sel:DWORD src1_sel:WORD_1
    v_mfma_f32_16x16x32_bf16 v[68:71], v[236:239], v[168:171], v[68:71]
    ds_read_u16_d16 v214, v214
    v_fma_mix_f32 v205, v204, v205, 0 op_sel:[1,1,0] op_sel_hi:[1,1,0]
    v_or_b32 v152, v200, v201
    v_mfma_f32_16x16x32_bf16 v[76:79], v[236:239], v[172:175], v[76:79]
    ds_read_b64_tr_b16 v[236:237], v255 offset:44104
    v_fma_mix_f32 v207, v206, v207, 0 op_sel:[1,1,0] op_sel_hi:[1,1,0]
    v_lshlrev_b32_sdwa v216, 1, v216 dst_sel:DWORD dst_unused:UNUSED_PAD src0_sel:DWORD src1_sel:WORD_1
    s_waitcnt lgkmcnt(12)
    v_mfma_f32_16x16x32_bf16 v[176:179], v[224:227], v[32:35], v[176:179]
    ds_read_b64_tr_b16 v[238:239], v255 offset:44872
    v_pk_mul_f16 v223, v223, v222
    v_mfma_f32_16x16x32_bf16 v[180:183], v[224:227], v[36:39], v[180:183]
    ds_read_u16_d16_hi v215, v215
    v_cvt_pk_bf16_f32 v156, v156, v205
    v_lshlrev_b32_sdwa v217, 1, v217 dst_sel:DWORD dst_unused:UNUSED_PAD src0_sel:DWORD src1_sel:WORD_1
    v_mfma_f32_16x16x32_bf16 v[184:187], v[224:227], v[40:43], v[184:187]
    ds_read_u16_d16 v216, v216
    v_cvt_pk_bf16_f32 v157, v157, v207
    v_or_b32 v153, v202, v203
    v_mfma_f32_16x16x32_bf16 v[188:191], v[224:227], v[44:47], v[188:191]
    ds_read_b64_tr_b16 v[224:225], v254 offset:41992
    v_exp_f16_sdwa v223, v223 dst_sel:WORD_0 dst_unused:UNUSED_PRESERVE src0_sel:WORD_0
    s_waitcnt lgkmcnt(12)
    v_mfma_f32_16x16x32_bf16 v[80:83], v[228:231], v[160:163], v[80:83]
    ds_read_b64_tr_b16 v[226:227], v254 offset:42248
    v_lshlrev_b32_sdwa v218, 1, v218 dst_sel:DWORD dst_unused:UNUSED_PAD src0_sel:DWORD src1_sel:WORD_1
    v_lshlrev_b32_sdwa v219, 1, v219 dst_sel:DWORD dst_unused:UNUSED_PAD src0_sel:DWORD src1_sel:WORD_1
    v_mfma_f32_16x16x32_bf16 v[88:91], v[228:231], v[164:167], v[88:91]
    ds_read_u16_d16_hi v217, v217
    v_exp_f16_sdwa v223, v223 dst_sel:WORD_1 dst_unused:UNUSED_PRESERVE src0_sel:WORD_1
    v_mfma_f32_16x16x32_bf16 v[96:99], v[228:231], v[168:171], v[96:99]
    ds_read_u16_d16 v218, v218
    v_lshlrev_b32_sdwa v220, 1, v220 dst_sel:DWORD dst_unused:UNUSED_PAD src0_sel:DWORD src1_sel:WORD_1
    v_mfma_f32_16x16x32_bf16 v[104:107], v[228:231], v[172:175], v[104:107]
    ds_read_b64_tr_b16 v[228:229], v255 offset:44160
    ds_read_b64_tr_b16 v[230:231], v255 offset:44928
    v_lshlrev_b32_sdwa v221, 1, v221 dst_sel:DWORD dst_unused:UNUSED_PAD src0_sel:DWORD src1_sel:WORD_1
    v_pk_fma_f16 v223, v223, s85, s85
    s_waitcnt lgkmcnt(13)
    v_mfma_f32_16x16x32_bf16 v[192:195], v[232:235], v[0:3], 0
    ds_read_u16_d16_hi v219, v219
    v_or_b32 v146, v208, v209
    v_mfma_f32_16x16x32_bf16 v[196:199], v[232:235], v[4:7], 0
    ds_read_u16_d16 v220, v220
    v_rcp_f16_sdwa v223, v223 dst_sel:WORD_0 dst_unused:UNUSED_PRESERVE src0_sel:WORD_0
    v_lshlrev_b32_sdwa v176, 1, v176 dst_sel:DWORD dst_unused:UNUSED_PAD src0_sel:DWORD src1_sel:WORD_1
    v_mfma_f32_16x16x32_bf16 v[200:203], v[232:235], v[8:11], 0
    ds_read_u16_d16_hi v221, v221
    v_fma_mixlo_f16 v188, v188, s83, 0
    v_lshlrev_b32_sdwa v177, 1, v177 dst_sel:DWORD dst_unused:UNUSED_PAD src0_sel:DWORD src1_sel:WORD_1
    v_mfma_f32_16x16x32_bf16 v[204:207], v[232:235], v[12:15], 0
    ds_read_b64_tr_b16 v[232:233], v254 offset:43016
    v_fma_mixlo_f16 v190, v190, s83, 0
    v_or_b32 v147, v210, v211
    s_waitcnt lgkmcnt(12)
    v_mfma_f32_16x16x32_bf16 v[84:87], v[236:239], v[160:163], v[84:87]
    ds_read_b64_tr_b16 v[234:235], v254 offset:43272
    v_rcp_f16_sdwa v223, v223 dst_sel:WORD_1 dst_unused:UNUSED_PRESERVE src0_sel:WORD_1
    v_mfma_f32_16x16x32_bf16 v[92:95], v[236:239], v[164:167], v[92:95]
    ds_read_u16_d16 v176, v176
    s_waitcnt vmcnt(1)
    v_mfma_f32_16x16x16_bf16 v[128:131], v[242:243], v[244:245], v[128:131]
    v_lshlrev_b32_sdwa v178, 1, v178 dst_sel:DWORD dst_unused:UNUSED_PAD src0_sel:DWORD src1_sel:WORD_1
    v_mfma_f32_16x16x32_bf16 v[100:103], v[236:239], v[168:171], v[100:103]
    ds_read_u16_d16_hi v177, v177
    v_fma_mixhi_f16 v188, v189, s83, 0
    v_mfma_f32_16x16x32_bf16 v[108:111], v[236:239], v[172:175], v[108:111]
    ds_read_b64_tr_b16 v[236:237], v255 offset:44168
    v_mfma_f32_16x16x16_bf16 v[132:135], v[242:243], v[246:247], v[132:135]
    v_lshlrev_b32_sdwa v179, 1, v179 dst_sel:DWORD dst_unused:UNUSED_PAD src0_sel:DWORD src1_sel:WORD_1
    v_fma_mixhi_f16 v190, v191, s83, 0
    s_waitcnt lgkmcnt(12)
    v_mfma_f32_16x16x32_bf16 v[192:195], v[224:227], v[16:19], v[192:195]
    ds_read_b64_tr_b16 v[238:239], v255 offset:44936
    buffer_load_dwordx4 v[244:247], v252, s[4:7], s25 offen offset:256 sc1
    v_or_b32 v150, v212, v213
    v_mfma_f32_16x16x32_bf16 v[196:199], v[224:227], v[20:23], v[196:199]
    ds_read_u16_d16 v178, v178
    v_fma_mix_f32 v159, v222, v223, 0 op_sel_hi:[1,1,0]
    v_pk_fma_f16 v189, v188, v188, s84 neg_lo:[0,1,0] neg_hi:[0,1,0]
    v_mfma_f32_16x16x32_bf16 v[200:203], v[224:227], v[24:27], v[200:203]
    ds_read_u16_d16_hi v179, v179
    v_lshlrev_b32_sdwa v180, 1, v180 dst_sel:DWORD dst_unused:UNUSED_PAD src0_sel:DWORD src1_sel:WORD_1
    v_pk_fma_f16 v191, v190, v190, s84 neg_lo:[0,1,0] neg_hi:[0,1,0]
    v_mfma_f32_16x16x32_bf16 v[204:207], v[224:227], v[28:31], v[204:207]
    s_cmp_lt_u32 s19, 20
    s_cbranch_scc1 L_rd20_slow
L_rd20_go:
    ds_read_b64_tr_b16 v[224:225], v254 offset:47104
    v_lshlrev_b32_sdwa v181, 1, v181 dst_sel:DWORD dst_unused:UNUSED_PAD src0_sel:DWORD src1_sel:WORD_1
    v_fma_mix_f32 v223, v222, v223, 0 op_sel:[1,1,0] op_sel_hi:[1,1,0]
    s_waitcnt lgkmcnt(12)
    v_mfma_f32_16x16x32_bf16 v[112:115], v[228:231], v[160:163], v[112:115]
    ds_read_b64_tr_b16 v[226:227], v254 offset:47360
    v_or_b32 v151, v214, v215
    v_pk_mul_f16 v189, v189, v188
    v_mfma_f32_16x16x32_bf16 v[120:123], v[228:231], v[164:167], v[120:123]
    ds_read_u16_d16 v180, v180
    v_pk_mul_f16 v191, v191, v190
    v_lshlrev_b32_sdwa v182, 1, v182 dst_sel:DWORD dst_unused:UNUSED_PAD src0_sel:DWORD src1_sel:WORD_1
    v_mfma_f32_16x16x32_bf16 v[128:131], v[228:231], v[168:171], v[128:131]
    ds_read_u16_d16_hi v181, v181
    v_cvt_pk_bf16_f32 v159, v159, v223
    v_lshlrev_b32_sdwa v183, 1, v183 dst_sel:DWORD dst_unused:UNUSED_PAD src0_sel:DWORD src1_sel:WORD_1
    v_mfma_f32_16x16x32_bf16 v[136:139], v[228:231], v[172:175], v[136:139]
    ds_read_b64_tr_b16 v[228:229], v255 offset:50176
    v_exp_f16_sdwa v189, v189 dst_sel:WORD_0 dst_unused:UNUSED_PRESERVE src0_sel:WORD_0
    s_waitcnt lgkmcnt(11)
    v_mfma_f32_16x16x32_bf16 v[192:195], v[232:235], v[32:35], v[192:195]
    ds_read_b64_tr_b16 v[230:231], v255 offset:50944
    v_or_b32 v154, v216, v217
    v_mfma_f32_16x16x32_bf16 v[196:199], v[232:235], v[36:39], v[196:199]
    ds_read_u16_d16 v182, v182
    v_exp_f16_sdwa v191, v191 dst_sel:WORD_0 dst_unused:UNUSED_PRESERVE src0_sel:WORD_0
    v_lshlrev_b32_sdwa v184, 1, v184 dst_sel:DWORD dst_unused:UNUSED_PAD src0_sel:DWORD src1_sel:WORD_1
    v_mfma_f32_16x16x32_bf16 v[200:203], v[232:235], v[40:43], v[200:203]
    ds_read_u16_d16_hi v183, v183
    v_lshlrev_b32_sdwa v185, 1, v185 dst_sel:DWORD dst_unused:UNUSED_PAD src0_sel:DWORD src1_sel:WORD_1
    v_mfma_f32_16x16x32_bf16 v[204:207], v[232:235], v[44:47], v[204:207]
    ds_read_b64_tr_b16 v[232:233], v254 offset:48128
    v_exp_f16_sdwa v189, v189 dst_sel:WORD_1 dst_unused:UNUSED_PRESERVE src0_sel:WORD_1
    s_waitcnt lgkmcnt(11)
    v_mfma_f32_16x16x32_bf16 v[116:119], v[236:239], v[160:163], v[116:119]
    ds_read_b64_tr_b16 v[234:235], v254 offset:48384
    v_or_b32 v155, v218, v219
    v_exp_f16_sdwa v191, v191 dst_sel:WORD_1 dst_unused:UNUSED_PRESERVE src0_sel:WORD_1
    v_mfma_f32_16x16x32_bf16 v[124:127], v[236:239], v[164:167], v[124:127]
    ds_read_u16_d16 v184, v184
    v_lshlrev_b32_sdwa v186, 1, v186 dst_sel:DWORD dst_unused:UNUSED_PAD src0_sel:DWORD src1_sel:WORD_1
    v_mfma_f32_16x16x32_bf16 v[132:135], v[236:239], v[168:171], v[132:135]
    ds_read_u16_d16_hi v185, v185
    v_lshlrev_b32_sdwa v187, 1, v187 dst_sel:DWORD dst_unused:UNUSED_PAD src0_sel:DWORD src1_sel:WORD_1
    v_pk_fma_f16 v189, v189, s85, s85
    v_mfma_f32_16x16x32_bf16 v[140:143], v[236:239], v[172:175], v[140:143]
    ds_read_b64_tr_b16 v[236:237], v255 offset:50184
    v_or_b32 v158, v220, v221
    v_pk_fma_f16 v191, v191, s85, s85
    s_waitcnt lgkmcnt(11)
    v_mfma_f32_16x16x32_bf16 v[208:211], v[224:227], v[0:3], 0
    ds_read_b64_tr_b16 v[238:239], v255 offset:50952
    v_or_b32 v160, v176, v177
    v_mfma_f32_16x16x32_bf16 v[212:215], v[224:227], v[4:7], 0
    ds_read_u16_d16 v186, v186
    v_rcp_f16_sdwa v189, v189 dst_sel:WORD_0 dst_unused:UNUSED_PRESERVE src0_sel:WORD_0
    v_lshlrev_b32_sdwa v192, 1, v192 dst_sel:DWORD dst_unused:UNUSED_PAD src0_sel:DWORD src1_sel:WORD_1
    v_mfma_f32_16x16x32_bf16 v[216:219], v[224:227], v[8:11], 0
    ds_read_u16_d16_hi v187, v187
    v_rcp_f16_sdwa v191, v191 dst_sel:WORD_0 dst_unused:UNUSED_PRESERVE src0_sel:WORD_0
    v_mfma_f32_16x16x32_bf16 v[220:223], v[224:227], v[12:15], 0
    ds_read_b64_tr_b16 v[224:225], v254 offset:49152
    v_lshlrev_b32_sdwa v193, 1, v193 dst_sel:DWORD dst_unused:UNUSED_PAD src0_sel:DWORD src1_sel:WORD_1
    v_or_b32 v161, v178, v179
    s_waitcnt lgkmcnt(11)
    v_mfma_f32_16x16x32_bf16 v[48:51], v[228:231], v[144:147], v[48:51]
    ds_read_b64_tr_b16 v[226:227], v254 offset:49408
    v_fma_mixlo_f16 v206, v206, s83, 0
    v_mfma_f32_16x16x32_bf16 v[56:59], v[228:231], v[148:151], v[56:59]
    ds_read_u16_d16 v192, v192
    s_waitcnt vmcnt(1)
    v_mfma_f32_16x16x16_bf16 v[76:79], v[242:243], v[250:251], v[76:79]
    v_lshlrev_b32_sdwa v194, 1, v194 dst_sel:DWORD dst_unused:UNUSED_PAD src0_sel:DWORD src1_sel:WORD_1
    v_mfma_f32_16x16x32_bf16 v[64:67], v[228:231], v[152:155], v[64:67]
    ds_read_u16_d16_hi v193, v193
    v_rcp_f16_sdwa v189, v189 dst_sel:WORD_1 dst_unused:UNUSED_PRESERVE src0_sel:WORD_1
    v_mfma_f32_16x16x32_bf16 v[72:75], v[228:231], v[156:159], v[72:75]
    ds_read_b64_tr_b16 v[228:229], v255 offset:50240
    v_lshlrev_b32_sdwa v195, 1, v195 dst_sel:DWORD dst_unused:UNUSED_PAD src0_sel:DWORD src1_sel:WORD_1
    v_or_b32 v164, v180, v181
    s_waitcnt lgkmcnt(11)
    v_mfma_f32_16x16x32_bf16 v[208:211], v[232:235], v[16:19], v[208:211]
    ds_read_b64_tr_b16 v[230:231], v255 offset:51008
    v_rcp_f16_sdwa v191, v191 dst_sel:WORD_1 dst_unused:UNUSED_PRESERVE src0_sel:WORD_1
    v_mfma_f32_16x16x32_bf16 v[212:215], v[232:235], v[20:23], v[212:215]
    ds_read_u16_d16 v194, v194
    v_lshlrev_b32_sdwa v196, 1, v196 dst_sel:DWORD dst_unused:UNUSED_PAD src0_sel:DWORD src1_sel:WORD_1
    v_fma_mixhi_f16 v206, v207, s83, 0
    v_mfma_f32_16x16x32_bf16 v[216:219], v[232:235], v[24:27], v[216:219]
    ds_read_u16_d16_hi v195, v195
    v_mfma_f32_16x16x16_bf16 v[72:75], v[242:243], v[248:249], v[72:75]
    v_lshlrev_b32_sdwa v197, 1, v197 dst_sel:DWORD dst_unused:UNUSED_PAD src0_sel:DWORD src1_sel:WORD_1
    v_fma_mix_f32 v172, v188, v189, 0 op_sel_hi:[1,1,0]
    v_mfma_f32_16x16x32_bf16 v[220:223], v[232:235], v[28:31], v[220:223]
    ds_read_b64_tr_b16 v[232:233], v254 offset:47112
    ds_read_b64_tr_b16 v[234:235], v254 offset:47368
    buffer_load_dwordx4 v[248:251], v252, s[4:7], s25 offen offset:320 sc1
    v_or_b32 v165, v182, v183
    s_waitcnt lgkmcnt(12)
    v_mfma_f32_16x16x32_bf16 v[52:55], v[236:239], v[144:147], v[52:55]
    ds_read_u16_d16 v196, v196
    v_fma_mix_f32 v173, v190, v191, 0 op_sel_hi:[1,1,0]
    v_mfma_f32_16x16x32_bf16 v[60:63], v[236:239], v[148:151], v[60:63]
    ds_read_u16_d16_hi v197, v197
    v_lshlrev_b32_sdwa v198, 1, v198 dst_sel:DWORD dst_unused:UNUSED_PAD src0_sel:DWORD src1_sel:WORD_1
    v_pk_fma_f16 v207, v206, v206, s84 neg_lo:[0,1,0] neg_hi:[0,1,0]
    v_mfma_f32_16x16x32_bf16 v[68:71], v[236:239], v[152:155], v[68:71]
    ds_read_u16_d16 v198, v198
    v_lshlrev_b32_sdwa v199, 1, v199 dst_sel:DWORD dst_unused:UNUSED_PAD src0_sel:DWORD src1_sel:WORD_1
    v_fma_mix_f32 v189, v188, v189, 0 op_sel:[1,1,0] op_sel_hi:[1,1,0]
    v_mfma_f32_16x16x32_bf16 v[76:79], v[236:239], v[156:159], v[76:79]
    ds_read_b64_tr_b16 v[236:237], v255 offset:50248
    v_or_b32 v168, v184, v185
    v_fma_mix_f32 v191, v190, v191, 0 op_sel:[1,1,0] op_sel_hi:[1,1,0]
    s_waitcnt lgkmcnt(12)
    v_mfma_f32_16x16x32_bf16 v[208:211], v[224:227], v[32:35], v[208:211]
    ds_read_b64_tr_b16 v[238:239], v255 offset:51016
    v_lshlrev_b32_sdwa v200, 1, v200 dst_sel:DWORD dst_unused:UNUSED_PAD src0_sel:DWORD src1_sel:WORD_1
    v_pk_mul_f16 v207, v207, v206
    v_mfma_f32_16x16x32_bf16 v[212:215], v[224:227], v[36:39], v[212:215]
    ds_read_u16_d16_hi v199, v199
    v_cvt_pk_bf16_f32 v172, v172, v189
    v_lshlrev_b32_sdwa v201, 1, v201 dst_sel:DWORD dst_unused:UNUSED_PAD src0_sel:DWORD src1_sel:WORD_1
    v_mfma_f32_16x16x32_bf16 v[216:219], v[224:227], v[40:43], v[216:219]
    ds_read_u16_d16 v200, v200
    v_cvt_pk_bf16_f32 v173, v173, v191
    v_or_b32 v169, v186, v187
    v_mfma_f32_16x16x32_bf16 v[220:223], v[224:227], v[44:47], v[220:223]
    ds_read_b64_tr_b16 v[224:225], v254 offset:48136
    v_exp_f16_sdwa v207, v207 dst_sel:WORD_0 dst_unused:UNUSED_PRESERVE src0_sel:WORD_0
    s_waitcnt lgkmcnt(12)
    v_mfma_f32_16x16x32_bf16 v[80:83], v[228:231], v[144:147], v[80:83]
    ds_read_b64_tr_b16 v[226:227], v254 offset:48392
    v_lshlrev_b32_sdwa v202, 1, v202 dst_sel:DWORD dst_unused:UNUSED_PAD src0_sel:DWORD src1_sel:WORD_1
    v_mfma_f32_16x16x32_bf16 v[88:91], v[228:231], v[148:151], v[88:91]
    ds_read_u16_d16_hi v201, v201
    v_lshlrev_b32_sdwa v203, 1, v203 dst_sel:DWORD dst_unused:UNUSED_PAD src0_sel:DWORD src1_sel:WORD_1
    v_exp_f16_sdwa v207, v207 dst_sel:WORD_1 dst_unused:UNUSED_PRESERVE src0_sel:WORD_1
    v_mfma_f32_16x16x32_bf16 v[96:99], v[228:231], v[152:155], v[96:99]
    ds_read_u16_d16 v202, v202
    v_lshlrev_b32_sdwa v204, 1, v204 dst_sel:DWORD dst_unused:UNUSED_PAD src0_sel:DWORD src1_sel:WORD_1
    v_mfma_f32_16x16x32_bf16 v[104:107], v[228:231], v[156:159], v[104:107]
    ds_read_b64_tr_b16 v[228:229], v255 offset:50304
    ds_read_b64_tr_b16 v[230:231], v255 offset:51072
    v_lshlrev_b32_sdwa v205, 1, v205 dst_sel:DWORD dst_unused:UNUSED_PAD src0_sel:DWORD src1_sel:WORD_1
    v_pk_fma_f16 v207, v207, s85, s85
    s_waitcnt lgkmcnt(13)
    v_mfma_f32_16x16x32_bf16 v[176:179], v[232:235], v[0:3], 0
    ds_read_u16_d16_hi v203, v203
    v_or_b32 v162, v192, v193
    v_mfma_f32_16x16x32_bf16 v[180:183], v[232:235], v[4:7], 0
    ds_read_u16_d16 v204, v204
    v_rcp_f16_sdwa v207, v207 dst_sel:WORD_0 dst_unused:UNUSED_PRESERVE src0_sel:WORD_0
    v_lshlrev_b32_sdwa v208, 1, v208 dst_sel:DWORD dst_unused:UNUSED_PAD src0_sel:DWORD src1_sel:WORD_1
    v_mfma_f32_16x16x32_bf16 v[184:187], v[232:235], v[8:11], 0
    ds_read_u16_d16_hi v205, v205
    v_fma_mixlo_f16 v220, v220, s83, 0
    v_lshlrev_b32_sdwa v209, 1, v209 dst_sel:DWORD dst_unused:UNUSED_PAD src0_sel:DWORD src1_sel:WORD_1
    v_mfma_f32_16x16x32_bf16 v[188:191], v[232:235], v[12:15], 0
    ds_read_b64_tr_b16 v[232:233], v254 offset:49160
    v_fma_mixlo_f16 v222, v222, s83, 0
    s_waitcnt lgkmcnt(12)
    v_mfma_f32_16x16x32_bf16 v[84:87], v[236:239], v[144:147], v[84:87]
    ds_read_b64_tr_b16 v[234:235], v254 offset:49416
    v_or_b32 v163, v194, v195
    v_rcp_f16_sdwa v207, v207 dst_sel:WORD_1 dst_unused:UNUSED_PRESERVE src0_sel:WORD_1
    v_mfma_f32_16x16x32_bf16 v[92:95], v[236:239], v[148:151], v[92:95]
    ds_read_u16_d16 v208, v208
    v_lshlrev_b32_sdwa v210, 1, v210 dst_sel:DWORD dst_unused:UNUSED_PAD src0_sel:DWORD src1_sel:WORD_1
    v_mfma_f32_16x16x32_bf16 v[100:103], v[236:239], v[152:155], v[100:103]
    ds_read_u16_d16_hi v209, v209
    v_fma_mixhi_f16 v220, v221, s83, 0
    v_lshlrev_b32_sdwa v211, 1, v211 dst_sel:DWORD dst_unused:UNUSED_PAD src0_sel:DWORD src1_sel:WORD_1
    v_mfma_f32_16x16x32_bf16 v[108:111], v[236:239], v[156:159], v[108:111]
    ds_read_b64_tr_b16 v[236:237], v255 offset:50312
    v_fma_mixhi_f16 v222, v223, s83, 0
    v_or_b32 v166, v196, v197
    s_waitcnt lgkmcnt(12)
    v_mfma_f32_16x16x32_bf16 v[176:179], v[224:227], v[16:19], v[176:179]
    ds_read_b64_tr_b16 v[238:239], v255 offset:51080
    v_fma_mix_f32 v175, v206, v207, 0 op_sel_hi:[1,1,0]
    v_pk_fma_f16 v221, v220, v220, s84 neg_lo:[0,1,0] neg_hi:[0,1,0]
    v_mfma_f32_16x16x32_bf16 v[180:183], v[224:227], v[20:23], v[180:183]
    ds_read_u16_d16 v210, v210
    v_lshlrev_b32_sdwa v212, 1, v212 dst_sel:DWORD dst_unused:UNUSED_PAD src0_sel:DWORD src1_sel:WORD_1
    v_mfma_f32_16x16x32_bf16 v[184:187], v[224:227], v[24:27], v[184:187]
    ds_read_u16_d16_hi v211, v211
    v_pk_fma_f16 v223, v222, v222, s84 neg_lo:[0,1,0] neg_hi:[0,1,0]
    v_lshlrev_b32_sdwa v213, 1, v213 dst_sel:DWORD dst_unused:UNUSED_PAD src0_sel:DWORD src1_sel:WORD_1
    v_mfma_f32_16x16x32_bf16 v[188:191], v[224:227], v[28:31], v[188:191]
    s_cmp_lt_u32 s19, 22
    s_cbranch_scc1 L_rd22_slow
L_rd22_go:
    ds_read_b64_tr_b16 v[224:225], v254 offset:53248
    v_fma_mix_f32 v207, v206, v207, 0 op_sel:[1,1,0] op_sel_hi:[1,1,0]
    v_or_b32 v167, v198, v199
    s_waitcnt lgkmcnt(12)
    v_mfma_f32_16x16x32_bf16 v[112:115], v[228:231], v[144:147], v[112:115]
    ds_read_b64_tr_b16 v[226:227], v254 offset:53504
    v_pk_mul_f16 v221, v221, v220
    v_pk_mul_f16 v223, v223, v222
    v_mfma_f32_16x16x32_bf16 v[120:123], v[228:231], v[148:151], v[120:123]
    ds_read_u16_d16 v212, v212
    v_lshlrev_b32_sdwa v214, 1, v214 dst_sel:DWORD dst_unused:UNUSED_PAD src0_sel:DWORD src1_sel:WORD_1
    v_cvt_pk_bf16_f32 v175, v175, v207
    v_mfma_f32_16x16x32_bf16 v[128:131], v[228:231], v[152:155], v[128:131]
    ds_read_u16_d16_hi v213, v213
    v_lshlrev_b32_sdwa v215, 1, v215 dst_sel:DWORD dst_unused:UNUSED_PAD src0_sel:DWORD src1_sel:WORD_1
    v_mfma_f32_16x16x32_bf16 v[136:139], v[228:231], v[156:159], v[136:139]
    ds_read_b64_tr_b16 v[228:229], v255 offset:56320
    v_exp_f16_sdwa v221, v221 dst_sel:WORD_0 dst_unused:UNUSED_PRESERVE src0_sel:WORD_0
    s_waitcnt lgkmcnt(11)
    v_mfma_f32_16x16x32_bf16 v[176:179], v[232:235], v[32:35], v[176:179]
    ds_read_b64_tr_b16 v[230:231], v255 offset:57088
    v_or_b32 v170, v200, v201
    v_exp_f16_sdwa v223, v223 dst_sel:WORD_0 dst_unused:UNUSED_PRESERVE src0_sel:WORD_0
    v_mfma_f32_16x16x32_bf16 v[180:183], v[232:235], v[36:39], v[180:183]
    ds_read_u16_d16 v214, v214
    v_lshlrev_b32_sdwa v216, 1, v216 dst_sel:DWORD dst_unused:UNUSED_PAD src0_sel:DWORD src1_sel:WORD_1
    v_mfma_f32_16x16x32_bf16 v[184:187], v[232:235], v[40:43], v[184:187]
    ds_read_u16_d16_hi v215, v215
    v_lshlrev_b32_sdwa v217, 1, v217 dst_sel:DWORD dst_unused:UNUSED_PAD src0_sel:DWORD src1_sel:WORD_1
    v_mfma_f32_16x16x32_bf16 v[188:191], v[232:235], v[44:47], v[188:191]
    ds_read_b64_tr_b16 v[232:233], v254 offset:54272
    v_exp_f16_sdwa v221, v221 dst_sel:WORD_1 dst_unused:UNUSED_PRESERVE src0_sel:WORD_1
    v_or_b32 v171, v202, v203
    s_waitcnt lgkmcnt(11)
    v_mfma_f32_16x16x32_bf16 v[116:119], v[236:239], v[144:147], v[116:119]
    ds_read_b64_tr_b16 v[234:235], v254 offset:54528
    v_exp_f16_sdwa v223, v223 dst_sel:WORD_1 dst_unused:UNUSED_PRESERVE src0_sel:WORD_1
    v_mfma_f32_16x16x32_bf16 v[124:127], v[236:239], v[148:151], v[124:127]
    ds_read_u16_d16 v216, v216
    v_lshlrev_b32_sdwa v218, 1, v218 dst_sel:DWORD dst_unused:UNUSED_PAD src0_sel:DWORD src1_sel:WORD_1
    v_mfma_f32_16x16x32_bf16 v[132:135], v[236:239], v[152:155], v[132:135]
    ds_read_u16_d16_hi v217, v217
    v_lshlrev_b32_sdwa v219, 1, v219 dst_sel:DWORD dst_unused:UNUSED_PAD src0_sel:DWORD src1_sel:WORD_1
    v_pk_fma_f16 v221, v221, s85, s85
    v_mfma_f32_16x16x32_bf16 v[140:143], v[236:239], v[156:159], v[140:143]
    ds_read_b64_tr_b16 v[236:237], v255 offset:56328
    v_or_b32 v174, v204, v205
    v_pk_fma_f16 v223, v223, s85, s85
    s_waitcnt lgkmcnt(11)
    v_mfma_f32_16x16x32_bf16 v[192:195], v[224:227], v[0:3], 0
    ds_read_b64_tr_b16 v[238:239], v255 offset:57096
    v_or_b32 v144, v208, v209
    v_mfma_f32_16x16x32_bf16 v[196:199], v[224:227], v[4:7], 0
    ds_read_u16_d16 v218, v218
    v_rcp_f16_sdwa v221, v221 dst_sel:WORD_0 dst_unused:UNUSED_PRESERVE src0_sel:WORD_0
    v_lshlrev_b32_sdwa v176, 1, v176 dst_sel:DWORD dst_unused:UNUSED_PAD src0_sel:DWORD src1_sel:WORD_1
    v_mfma_f32_16x16x32_bf16 v[200:203], v[224:227], v[8:11], 0
    ds_read_u16_d16_hi v219, v219
    v_rcp_f16_sdwa v223, v223 dst_sel:WORD_0 dst_unused:UNUSED_PRESERVE src0_sel:WORD_0
    v_mfma_f32_16x16x32_bf16 v[204:207], v[224:227], v[12:15], 0
    ds_read_b64_tr_b16 v[224:225], v254 offset:55296
    v_lshlrev_b32_sdwa v177, 1, v177 dst_sel:DWORD dst_unused:UNUSED_PAD src0_sel:DWORD src1_sel:WORD_1
    s_waitcnt lgkmcnt(11)
    v_mfma_f32_16x16x32_bf16 v[48:51], v[228:231], v[160:163], v[48:51]
    ds_read_b64_tr_b16 v[226:227], v254 offset:55552
    v_or_b32 v145, v210, v211
    v_fma_mixlo_f16 v190, v190, s83, 0
    v_mfma_f32_16x16x32_bf16 v[56:59], v[228:231], v[164:167], v[56:59]
    ds_read_u16_d16 v176, v176
    s_waitcnt vmcnt(1)
    v_mfma_f32_16x16x16_bf16 v[104:107], v[242:243], v[244:245], v[104:107]
    v_lshlrev_b32_sdwa v178, 1, v178 dst_sel:DWORD dst_unused:UNUSED_PAD src0_sel:DWORD src1_sel:WORD_1
    v_mfma_f32_16x16x32_bf16 v[64:67], v[228:231], v[168:171], v[64:67]
    ds_read_u16_d16_hi v177, v177
    v_rcp_f16_sdwa v221, v221 dst_sel:WORD_1 dst_unused:UNUSED_PRESERVE src0_sel:WORD_1
    v_mfma_f32_16x16x32_bf16 v[72:75], v[228:231], v[172:175], v[72:75]
    ds_read_b64_tr_b16 v[228:229], v255 offset:56384
    v_mfma_f32_16x16x16_bf16 v[108:111], v[242:243], v[246:247], v[108:111]
    v_lshlrev_b32_sdwa v179, 1, v179 dst_sel:DWORD dst_unused:UNUSED_PAD src0_sel:DWORD src1_sel:WORD_1
    v_or_b32 v148, v212, v213
    s_waitcnt lgkmcnt(11)
    v_mfma_f32_16x16x32_bf16 v[192:195], v[232:235], v[16:19], v[192:195]
    ds_read_b64_tr_b16 v[230:231], v255 offset:57152
    v_rcp_f16_sdwa v223, v223 dst_sel:WORD_1 dst_unused:UNUSED_PRESERVE src0_sel:WORD_1
    v_mfma_f32_16x16x32_bf16 v[196:199], v[232:235], v[20:23], v[196:199]
    ds_read_u16_d16 v178, v178
    v_lshlrev_b32_sdwa v180, 1, v180 dst_sel:DWORD dst_unused:UNUSED_PAD src0_sel:DWORD src1_sel:WORD_1
    v_mfma_f32_16x16x32_bf16 v[200:203], v[232:235], v[24:27], v[200:203]
    ds_read_u16_d16_hi v179, v179
    v_fma_mixhi_f16 v190, v191, s83, 0
    v_lshlrev_b32_sdwa v181, 1, v181 dst_sel:DWORD dst_unused:UNUSED_PAD src0_sel:DWORD src1_sel:WORD_1
    v_mfma_f32_16x16x32_bf16 v[204:207], v[232:235], v[28:31], v[204:207]
    ds_read_b64_tr_b16 v[232:233], v254 offset:53256
    ds_read_b64_tr_b16 v[234:235], v254 offset:53512
    v_fma_mix_f32 v156, v220, v221, 0 op_sel_hi:[1,1,0]
    v_or_b32 v149, v214, v215
    s_waitcnt lgkmcnt(12)
    v_mfma_f32_16x16x32_bf16 v[52:55], v[236:239], v[160:163], v[52:55]
    ds_read_u16_d16 v180, v180
    v_fma_mix_f32 v157, v222, v223, 0 op_sel_hi:[1,1,0]
    v_lshlrev_b32_sdwa v182, 1, v182 dst_sel:DWORD dst_unused:UNUSED_PAD src0_sel:DWORD src1_sel:WORD_1
    v_mfma_f32_16x16x32_bf16 v[60:63], v[236:239], v[164:167], v[60:63]
    ds_read_u16_d16_hi v181, v181
    v_pk_fma_f16 v191, v190, v190, s84 neg_lo:[0,1,0] neg_hi:[0,1,0]
    v_lshlrev_b32_sdwa v183, 1, v183 dst_sel:DWORD dst_unused:UNUSED_PAD src0_sel:DWORD src1_sel:WORD_1
    v_mfma_f32_16x16x32_bf16 v[68:71], v[236:239], v[168:171], v[68:71]
    ds_read_u16_d16 v182, v182
    v_fma_mix_f32 v221, v220, v221, 0 op_sel:[1,1,0] op_sel_hi:[1,1,0]
    v_or_b32 v152, v216, v217
    v_mfma_f32_16x16x32_bf16 v[76:79], v[236:239], v[172:175], v[76:79]
    ds_read_b64_tr_b16 v[236:237], v255 offset:56392
    v_fma_mix_f32 v223, v222, v223, 0 op_sel:[1,1,0] op_sel_hi:[1,1,0]
    s_waitcnt lgkmcnt(12)
    v_mfma_f32_16x16x32_bf16 v[192:195], v[224:227], v[32:35], v[192:195]
    ds_read_b64_tr_b16 v[238:239], v255 offset:57160
    v_lshlrev_b32_sdwa v184, 1, v184 dst_sel:DWORD dst_unused:UNUSED_PAD src0_sel:DWORD src1_sel:WORD_1
    v_pk_mul_f16 v191, v191, v190
    v_mfma_f32_16x16x32_bf16 v[196:199], v[224:227], v[36:39], v[196:199]
    ds_read_u16_d16_hi v183, v183
    v_cvt_pk_bf16_f32 v156, v156, v221
    v_lshlrev_b32_sdwa v185, 1, v185 dst_sel:DWORD dst_unused:UNUSED_PAD src0_sel:DWORD src1_sel:WORD_1
    v_mfma_f32_16x16x32_bf16 v[200:203], v[224:227], v[40:43], v[200:203]
    ds_read_u16_d16 v184, v184
    v_cvt_pk_bf16_f32 v157, v157, v223
    v_or_b32 v153, v218, v219
    v_mfma_f32_16x16x32_bf16 v[204:207], v[224:227], v[44:47], v[204:207]
    ds_read_b64_tr_b16 v[224:225], v254 offset:54280
    v_exp_f16_sdwa v191, v191 dst_sel:WORD_0 dst_unused:UNUSED_PRESERVE src0_sel:WORD_0
    s_waitcnt lgkmcnt(12)
    v_mfma_f32_16x16x32_bf16 v[80:83], v[228:231], v[160:163], v[80:83]
    ds_read_b64_tr_b16 v[226:227], v254 offset:54536
    v_lshlrev_b32_sdwa v186, 1, v186 dst_sel:DWORD dst_unused:UNUSED_PAD src0_sel:DWORD src1_sel:WORD_1
    v_lshlrev_b32_sdwa v187, 1, v187 dst_sel:DWORD dst_unused:UNUSED_PAD src0_sel:DWORD src1_sel:WORD_1
    v_mfma_f32_16x16x32_bf16 v[88:91], v[228:231], v[164:167], v[88:91]
    ds_read_u16_d16_hi v185, v185
    v_exp_f16_sdwa v191, v191 dst_sel:WORD_1 dst_unused:UNUSED_PRESERVE src0_sel:WORD_1
    v_mfma_f32_16x16x32_bf16 v[96:99], v[228:231], v[168:171], v[96:99]
    ds_read_u16_d16 v186, v186
    v_lshlrev_b32_sdwa v188, 1, v188 dst_sel:DWORD dst_unused:UNUSED_PAD src0_sel:DWORD src1_sel:WORD_1
    v_mfma_f32_16x16x32_bf16 v[104:107], v[228:231], v[172:175], v[104:107]
    ds_read_b64_tr_b16 v[228:229], v255 offset:56448
    ds_read_b64_tr_b16 v[230:231], v255 offset:57216
    v_lshlrev_b32_sdwa v189, 1, v189 dst_sel:DWORD dst_unused:UNUSED_PAD src0_sel:DWORD src1_sel:WORD_1
    v_pk_fma_f16 v191, v191, s85, s85
    s_waitcnt lgkmcnt(13)
    v_mfma_f32_16x16x32_bf16 v[208:211], v[232:235], v[0:3], 0
    ds_read_u16_d16_hi v187, v187
    v_or_b32 v146, v176, v177
    v_mfma_f32_16x16x32_bf16 v[212:215], v[232:235], v[4:7], 0
    ds_read_u16_d16 v188, v188
    v_rcp_f16_sdwa v191, v191 dst_sel:WORD_0 dst_unused:UNUSED_PRESERVE src0_sel:WORD_0
    v_lshlrev_b32_sdwa v192, 1, v192 dst_sel:DWORD dst_unused:UNUSED_PAD src0_sel:DWORD src1_sel:WORD_1
    v_mfma_f32_16x16x32_bf16 v[216:219], v[232:235], v[8:11], 0
    ds_read_u16_d16_hi v189, v189
    v_fma_mixlo_f16 v204, v204, s83, 0
    v_lshlrev_b32_sdwa v193, 1, v193 dst_sel:DWORD dst_unused:UNUSED_PAD src0_sel:DWORD src1_sel:WORD_1
    v_mfma_f32_16x16x32_bf16 v[220:223], v[232:235], v[12:15], 0
    ds_read_b64_tr_b16 v[232:233], v254 offset:55304
    v_fma_mixlo_f16 v206, v206, s83, 0
    v_or_b32 v147, v178, v179
    s_waitcnt lgkmcnt(12)
    v_mfma_f32_16x16x32_bf16 v[84:87], v[236:239], v[160:163], v[84:87]
    ds_read_b64_tr_b16 v[234:235], v254 offset:55560
    v_rcp_f16_sdwa v191, v191 dst_sel:WORD_1 dst_unused:UNUSED_PRESERVE src0_sel:WORD_1
    v_mfma_f32_16x16x32_bf16 v[92:95], v[236:239], v[164:167], v[92:95]
    ds_read_u16_d16 v192, v192
    s_waitcnt vmcnt(0)
    v_mfma_f32_16x16x16_bf16 v[136:139], v[242:243], v[248:249], v[136:139]
    v_mfma_f32_16x16x32_bf16 v[100:103], v[236:239], v[168:171], v[100:103]
    ds_read_u16_d16_hi v193, v193
    v_lshlrev_b32_sdwa v194, 1, v194 dst_sel:DWORD dst_unused:UNUSED_PAD src0_sel:DWORD src1_sel:WORD_1
    v_fma_mixhi_f16 v204, v205, s83, 0
    v_mfma_f32_16x16x32_bf16 v[108:111], v[236:239], v[172:175], v[108:111]
    ds_read_b64_tr_b16 v[236:237], v255 offset:56456
    v_mfma_f32_16x16x16_bf16 v[140:143], v[242:243], v[250:251], v[140:143]
    v_lshlrev_b32_sdwa v195, 1, v195 dst_sel:DWORD dst_unused:UNUSED_PAD src0_sel:DWORD src1_sel:WORD_1
    v_fma_mixhi_f16 v206, v207, s83, 0
    s_waitcnt lgkmcnt(12)
    v_mfma_f32_16x16x32_bf16 v[208:211], v[224:227], v[16:19], v[208:211]
    ds_read_b64_tr_b16 v[238:239], v255 offset:57224
    v_or_b32 v150, v180, v181
    v_fma_mix_f32 v159, v190, v191, 0 op_sel_hi:[1,1,0]
    v_mfma_f32_16x16x32_bf16 v[212:215], v[224:227], v[20:23], v[212:215]
    ds_read_u16_d16 v194, v194
    v_pk_fma_f16 v205, v204, v204, s84 neg_lo:[0,1,0] neg_hi:[0,1,0]
    v_lshlrev_b32_sdwa v196, 1, v196 dst_sel:DWORD dst_unused:UNUSED_PAD src0_sel:DWORD src1_sel:WORD_1
    v_mfma_f32_16x16x32_bf16 v[216:219], v[224:227], v[24:27], v[216:219]
    ds_read_u16_d16_hi v195, v195
    v_pk_fma_f16 v207, v206, v206, s84 neg_lo:[0,1,0] neg_hi:[0,1,0]
    v_lshlrev_b32_sdwa v197, 1, v197 dst_sel:DWORD dst_unused:UNUSED_PAD src0_sel:DWORD src1_sel:WORD_1
    v_mfma_f32_16x16x32_bf16 v[220:223], v[224:227], v[28:31], v[220:223]
    s_cmp_lt_u32 s19, 24
    s_cbranch_scc1 L_rd24_slow
L_rd24_go:
    ds_read_b64_tr_b16 v[224:225], v255 offset:59392
    v_fma_mix_f32 v191, v190, v191, 0 op_sel:[1,1,0] op_sel_hi:[1,1,0]
    v_or_b32 v151, v182, v183
    s_waitcnt lgkmcnt(12)
    v_mfma_f32_16x16x32_bf16 v[112:115], v[228:231], v[160:163], v[112:115]
    ds_read_b64_tr_b16 v[226:227], v255 offset:60160
    v_pk_mul_f16 v205, v205, v204
    v_mfma_f32_16x16x32_bf16 v[120:123], v[228:231], v[164:167], v[120:123]
    ds_read_u16_d16 v196, v196
    v_pk_mul_f16 v207, v207, v206
    v_lshlrev_b32_sdwa v198, 1, v198 dst_sel:DWORD dst_unused:UNUSED_PAD src0_sel:DWORD src1_sel:WORD_1
    v_mfma_f32_16x16x32_bf16 v[128:131], v[228:231], v[168:171], v[128:131]
    ds_read_u16_d16_hi v197, v197
    v_cvt_pk_bf16_f32 v159, v159, v191
    v_lshlrev_b32_sdwa v199, 1, v199 dst_sel:DWORD dst_unused:UNUSED_PAD src0_sel:DWORD src1_sel:WORD_1
    v_mfma_f32_16x16x32_bf16 v[136:139], v[228:231], v[172:175], v[136:139]
    ds_read_b64_tr_b16 v[228:229], v255 offset:59400
    v_exp_f16_sdwa v205, v205 dst_sel:WORD_0 dst_unused:UNUSED_PRESERVE src0_sel:WORD_0
    s_waitcnt lgkmcnt(11)
    v_mfma_f32_16x16x32_bf16 v[208:211], v[232:235], v[32:35], v[208:211]
    ds_read_b64_tr_b16 v[230:231], v255 offset:60168
    v_or_b32 v154, v184, v185
    v_mfma_f32_16x16x32_bf16 v[212:215], v[232:235], v[36:39], v[212:215]
    ds_read_u16_d16 v198, v198
    v_exp_f16_sdwa v207, v207 dst_sel:WORD_0 dst_unused:UNUSED_PRESERVE src0_sel:WORD_0
    v_lshlrev_b32_sdwa v200, 1, v200 dst_sel:DWORD dst_unused:UNUSED_PAD src0_sel:DWORD src1_sel:WORD_1
    v_mfma_f32_16x16x32_bf16 v[216:219], v[232:235], v[40:43], v[216:219]
    ds_read_u16_d16_hi v199, v199
    v_lshlrev_b32_sdwa v201, 1, v201 dst_sel:DWORD dst_unused:UNUSED_PAD src0_sel:DWORD src1_sel:WORD_1
    v_mfma_f32_16x16x32_bf16 v[220:223], v[232:235], v[44:47], v[220:223]
    ds_read_b64_tr_b16 v[232:233], v255 offset:59456
    v_exp_f16_sdwa v205, v205 dst_sel:WORD_1 dst_unused:UNUSED_PRESERVE src0_sel:WORD_1
    v_or_b32 v155, v186, v187
    s_waitcnt lgkmcnt(11)
    v_mfma_f32_16x16x32_bf16 v[116:119], v[236:239], v[160:163], v[116:119]
    ds_read_b64_tr_b16 v[234:235], v255 offset:60224
    v_exp_f16_sdwa v207, v207 dst_sel:WORD_1 dst_unused:UNUSED_PRESERVE src0_sel:WORD_1
    v_mfma_f32_16x16x32_bf16 v[124:127], v[236:239], v[164:167], v[124:127]
    ds_read_u16_d16 v200, v200
    v_lshlrev_b32_sdwa v202, 1, v202 dst_sel:DWORD dst_unused:UNUSED_PAD src0_sel:DWORD src1_sel:WORD_1
    v_mfma_f32_16x16x32_bf16 v[132:135], v[236:239], v[168:171], v[132:135]
    ds_read_u16_d16_hi v201, v201
    v_lshlrev_b32_sdwa v203, 1, v203 dst_sel:DWORD dst_unused:UNUSED_PAD src0_sel:DWORD src1_sel:WORD_1
    v_pk_fma_f16 v205, v205, s85, s85
    v_mfma_f32_16x16x32_bf16 v[140:143], v[236:239], v[172:175], v[140:143]
    ds_read_b64_tr_b16 v[236:237], v255 offset:59464
    v_or_b32 v158, v188, v189
    v_pk_fma_f16 v207, v207, s85, s85
    s_waitcnt lgkmcnt(11)
    v_mfma_f32_16x16x32_bf16 v[48:51], v[224:227], v[144:147], v[48:51]
    ds_read_b64_tr_b16 v[238:239], v255 offset:60232
    s_waitcnt vmcnt(0)
    v_lshrrev_b32 v244, 7, v253
    v_mul_u32_u24 v244, 640, v244
    v_add_u32 v244, v244, v253
    v_add_u32 v245, 196608, v244
    buffer_load_dwordx4 v[16:19], v244, s[8:11], s36 offen offset:0
    v_mfma_f32_16x16x32_bf16 v[56:59], v[224:227], v[148:151], v[56:59]
    ds_read_u16_d16 v202, v202
    ds_read_u16_d16_hi v203, v203
    buffer_load_dwordx4 v[20:23], v244, s[8:11], s36 offen offset:128
    v_or_b32 v160, v192, v193
    v_rcp_f16_sdwa v205, v205 dst_sel:WORD_0 dst_unused:UNUSED_PRESERVE src0_sel:WORD_0
    v_mfma_f32_16x16x32_bf16 v[64:67], v[224:227], v[152:155], v[64:67]
    buffer_load_dwordx4 v[24:27], v244, s[8:11], s36 offen offset:256
    v_lshlrev_b32_sdwa v208, 1, v208 dst_sel:DWORD dst_unused:UNUSED_PAD src0_sel:DWORD src1_sel:WORD_1
    v_rcp_f16_sdwa v207, v207 dst_sel:WORD_0 dst_unused:UNUSED_PRESERVE src0_sel:WORD_0
    v_lshlrev_b32_sdwa v209, 1, v209 dst_sel:DWORD dst_unused:UNUSED_PAD src0_sel:DWORD src1_sel:WORD_1
    v_mfma_f32_16x16x32_bf16 v[72:75], v[224:227], v[156:159], v[72:75]
    ds_read_b64_tr_b16 v[224:225], v255 offset:59520
    buffer_load_dwordx4 v[28:31], v244, s[8:11], s37 offen offset:0
    v_or_b32 v161, v194, v195
    v_fma_mixlo_f16 v222, v222, s83, 0
    v_lshlrev_b32_sdwa v210, 1, v210 dst_sel:DWORD dst_unused:UNUSED_PAD src0_sel:DWORD src1_sel:WORD_1
    v_rcp_f16_sdwa v205, v205 dst_sel:WORD_1 dst_unused:UNUSED_PRESERVE src0_sel:WORD_1
    s_waitcnt lgkmcnt(11)
    v_mfma_f32_16x16x32_bf16 v[52:55], v[228:231], v[144:147], v[52:55]
    ds_read_b64_tr_b16 v[226:227], v255 offset:60288
    ds_read_u16_d16 v208, v208
    buffer_load_dwordx4 v[32:35], v244, s[8:11], s37 offen offset:128
    v_lshlrev_b32_sdwa v211, 1, v211 dst_sel:DWORD dst_unused:UNUSED_PAD src0_sel:DWORD src1_sel:WORD_1
    v_or_b32 v164, v196, v197
    v_rcp_f16_sdwa v207, v207 dst_sel:WORD_1 dst_unused:UNUSED_PRESERVE src0_sel:WORD_1
    v_mfma_f32_16x16x32_bf16 v[60:63], v[228:231], v[148:151], v[60:63]
    ds_read_u16_d16_hi v209, v209
    ds_read_u16_d16 v210, v210
    buffer_load_dwordx4 v[36:39], v244, s[8:11], s37 offen offset:256
    v_lshlrev_b32_sdwa v212, 1, v212 dst_sel:DWORD dst_unused:UNUSED_PAD src0_sel:DWORD src1_sel:WORD_1
    v_fma_mixhi_f16 v222, v223, s83, 0
    v_lshlrev_b32_sdwa v213, 1, v213 dst_sel:DWORD dst_unused:UNUSED_PAD src0_sel:DWORD src1_sel:WORD_1
    v_mfma_f32_16x16x32_bf16 v[68:71], v[228:231], v[152:155], v[68:71]
    ds_read_u16_d16_hi v211, v211
    buffer_load_dwordx4 v[40:43], v245, s[8:11], s36 offen offset:0
    v_fma_mix_f32 v172, v204, v205, 0 op_sel_hi:[1,1,0]
    s_waitcnt lgkmcnt(14)
    v_or_b32 v165, v198, v199
    v_fma_mix_f32 v173, v206, v207, 0 op_sel_hi:[1,1,0]
    v_lshlrev_b32_sdwa v214, 1, v214 dst_sel:DWORD dst_unused:UNUSED_PAD src0_sel:DWORD src1_sel:WORD_1
    v_mfma_f32_16x16x32_bf16 v[76:79], v[228:231], v[156:159], v[76:79]
    ds_read_b64_tr_b16 v[228:229], v255 offset:59528
    ds_read_b64_tr_b16 v[230:231], v255 offset:60296
    ds_read_u16_d16 v212, v212
    buffer_load_dwordx4 v[44:47], v245, s[8:11], s36 offen offset:128
    v_pk_fma_f16 v223, v222, v222, s84 neg_lo:[0,1,0] neg_hi:[0,1,0]
    v_lshlrev_b32_sdwa v215, 1, v215 dst_sel:DWORD dst_unused:UNUSED_PAD src0_sel:DWORD src1_sel:WORD_1
    v_fma_mix_f32 v205, v204, v205, 0 op_sel:[1,1,0] op_sel_hi:[1,1,0]
    s_waitcnt lgkmcnt(13)
    v_or_b32 v168, v200, v201
    v_mfma_f32_16x16x32_bf16 v[80:83], v[232:235], v[144:147], v[80:83]
    ds_read_u16_d16_hi v213, v213
    ds_read_u16_d16 v214, v214
    buffer_load_dwordx4 v[0:3], v245, s[8:11], s36 offen offset:256
    v_fma_mix_f32 v207, v206, v207, 0 op_sel:[1,1,0] op_sel_hi:[1,1,0]
    v_lshlrev_b32_sdwa v216, 1, v216 dst_sel:DWORD dst_unused:UNUSED_PAD src0_sel:DWORD src1_sel:WORD_1
    v_pk_mul_f16 v223, v223, v222
    v_cvt_pk_bf16_f32 v172, v172, v205
    v_mfma_f32_16x16x32_bf16 v[88:91], v[232:235], v[148:151], v[88:91]
    ds_read_u16_d16_hi v215, v215
    buffer_load_dwordx4 v[4:7], v245, s[8:11], s37 offen offset:0
    v_lshlrev_b32_sdwa v217, 1, v217 dst_sel:DWORD dst_unused:UNUSED_PAD src0_sel:DWORD src1_sel:WORD_1
    v_cvt_pk_bf16_f32 v173, v173, v207
    s_waitcnt lgkmcnt(12)
    v_or_b32 v169, v202, v203
    v_exp_f16_sdwa v223, v223 dst_sel:WORD_0 dst_unused:UNUSED_PRESERVE src0_sel:WORD_0
    v_mfma_f32_16x16x32_bf16 v[96:99], v[232:235], v[152:155], v[96:99]
    ds_read_u16_d16 v216, v216
    ds_read_u16_d16_hi v217, v217
    buffer_load_dwordx4 v[8:11], v245, s[8:11], s37 offen offset:128
    v_lshlrev_b32_sdwa v218, 1, v218 dst_sel:DWORD dst_unused:UNUSED_PAD src0_sel:DWORD src1_sel:WORD_1
    v_lshlrev_b32_sdwa v219, 1, v219 dst_sel:DWORD dst_unused:UNUSED_PAD src0_sel:DWORD src1_sel:WORD_1
    v_exp_f16_sdwa v223, v223 dst_sel:WORD_1 dst_unused:UNUSED_PRESERVE src0_sel:WORD_1
    v_mfma_f32_16x16x32_bf16 v[104:107], v[232:235], v[156:159], v[104:107]
    ds_read_b64_tr_b16 v[232:233], v255 offset:62464
    ds_read_b64_tr_b16 v[234:235], v255 offset:63232
    buffer_load_dwordx4 v[12:15], v245, s[8:11], s37 offen offset:256
    v_lshlrev_b32_sdwa v220, 1, v220 dst_sel:DWORD dst_unused:UNUSED_PAD src0_sel:DWORD src1_sel:WORD_1
    v_lshlrev_b32_sdwa v221, 1, v221 dst_sel:DWORD dst_unused:UNUSED_PAD src0_sel:DWORD src1_sel:WORD_1
    v_pk_fma_f16 v223, v223, s85, s85
    v_mfma_f32_16x16x32_bf16 v[84:87], v[236:239], v[144:147], v[84:87]
    ds_read_u16_d16 v218, v218
    s_waitcnt lgkmcnt(13)
    v_or_b32 v162, v208, v209
    v_mfma_f32_16x16x32_bf16 v[92:95], v[236:239], v[148:151], v[92:95]
    ds_read_u16_d16_hi v219, v219
    v_rcp_f16_sdwa v223, v223 dst_sel:WORD_0 dst_unused:UNUSED_PRESERVE src0_sel:WORD_0
    s_waitcnt lgkmcnt(12)
    v_or_b32 v163, v210, v211
    v_mfma_f32_16x16x32_bf16 v[100:103], v[236:239], v[152:155], v[100:103]
    ds_read_u16_d16 v220, v220
    v_bfe_u32 v244, v253, 4, 3
    v_mul_u32_u24 v244, 768, v244
    v_bfe_u32 v245, v253, 7, 1
    v_lshl_add_u32 v244, v245, 6, v244
    v_lshrrev_b32 v245, 8, v253
    v_lshl_add_u32 v244, v245, 4, v244
    v_add_u32 v245, 196608, v244
    v_mfma_f32_16x16x32_bf16 v[108:111], v[236:239], v[156:159], v[108:111]
    ds_read_b64_tr_b16 v[236:237], v255 offset:62472
    v_mfma_f32_16x16x32_bf16 v[112:115], v[224:227], v[144:147], v[112:115]
    ds_read_b64_tr_b16 v[238:239], v255 offset:63240
    v_mfma_f32_16x16x32_bf16 v[120:123], v[224:227], v[148:151], v[120:123]
    ds_read_u16_d16_hi v221, v221
    v_mfma_f32_16x16x32_bf16 v[128:131], v[224:227], v[152:155], v[128:131]
    s_waitcnt lgkmcnt(12)
    v_or_b32 v166, v212, v213
    v_mfma_f32_16x16x32_bf16 v[136:139], v[224:227], v[156:159], v[136:139]
    ds_read_b64_tr_b16 v[224:225], v255 offset:62528
    v_rcp_f16_sdwa v223, v223 dst_sel:WORD_1 dst_unused:UNUSED_PRESERVE src0_sel:WORD_1
    v_mfma_f32_16x16x32_bf16 v[116:119], v[228:231], v[144:147], v[116:119]
    ds_read_b64_tr_b16 v[226:227], v255 offset:63296
    s_waitcnt lgkmcnt(12)
    v_or_b32 v167, v214, v215
    s_waitcnt lgkmcnt(10)
    v_or_b32 v170, v216, v217
    v_mfma_f32_16x16x32_bf16 v[124:127], v[228:231], v[148:151], v[124:127]
    v_fma_mix_f32 v175, v222, v223, 0 op_sel_hi:[1,1,0]
    s_waitcnt lgkmcnt(6)
    v_or_b32 v171, v218, v219
    v_mfma_f32_16x16x32_bf16 v[132:135], v[228:231], v[152:155], v[132:135]
    v_fma_mix_f32 v223, v222, v223, 0 op_sel:[1,1,0] op_sel_hi:[1,1,0]
    v_mfma_f32_16x16x32_bf16 v[140:143], v[228:231], v[156:159], v[140:143]
    ds_read_b64_tr_b16 v[228:229], v255 offset:62536
    s_waitcnt lgkmcnt(3)
    v_or_b32 v174, v220, v221
    v_cvt_pk_bf16_f32 v175, v175, v223
    v_mfma_f32_16x16x32_bf16 v[48:51], v[232:235], v[160:163], v[48:51]
    ds_read_b64_tr_b16 v[230:231], v255 offset:63304
    v_mfma_f32_16x16x32_bf16 v[56:59], v[232:235], v[164:167], v[56:59]
    v_mfma_f32_16x16x32_bf16 v[64:67], v[232:235], v[168:171], v[64:67]
    v_mfma_f32_16x16x32_bf16 v[72:75], v[232:235], v[172:175], v[72:75]
    ds_read_b64_tr_b16 v[232:233], v255 offset:62592
    v_mfma_f32_16x16x32_bf16 v[52:55], v[236:239], v[160:163], v[52:55]
    ds_read_b64_tr_b16 v[234:235], v255 offset:63360
    v_mfma_f32_16x16x32_bf16 v[60:63], v[236:239], v[164:167], v[60:63]
    v_mfma_f32_16x16x32_bf16 v[68:71], v[236:239], v[168:171], v[68:71]
    v_mfma_f32_16x16x32_bf16 v[76:79], v[236:239], v[172:175], v[76:79]
    ds_read_b64_tr_b16 v[236:237], v255 offset:62600
    s_waitcnt lgkmcnt(5)
    v_mfma_f32_16x16x32_bf16 v[80:83], v[224:227], v[160:163], v[80:83]
    ds_read_b64_tr_b16 v[238:239], v255 offset:63368
    v_mfma_f32_16x16x32_bf16 v[88:91], v[224:227], v[164:167], v[88:91]
    v_mfma_f32_16x16x32_bf16 v[96:99], v[224:227], v[168:171], v[96:99]
    v_mfma_f32_16x16x32_bf16 v[104:107], v[224:227], v[172:175], v[104:107]
    s_waitcnt lgkmcnt(4)
    v_mfma_f32_16x16x32_bf16 v[84:87], v[228:231], v[160:163], v[84:87]
    v_cvt_pk_bf16_f32 v48, v48, v49
    v_cvt_pk_bf16_f32 v49, v50, v51
    v_cvt_pk_bf16_f32 v50, v52, v53
    v_cvt_pk_bf16_f32 v51, v54, v55
    v_mfma_f32_16x16x32_bf16 v[92:95], v[228:231], v[164:167], v[92:95]
    v_cvt_pk_bf16_f32 v56, v56, v57
    v_cvt_pk_bf16_f32 v57, v58, v59
    v_cvt_pk_bf16_f32 v58, v60, v61
    v_cvt_pk_bf16_f32 v59, v62, v63
    v_mfma_f32_16x16x32_bf16 v[100:103], v[228:231], v[168:171], v[100:103]
    v_cvt_pk_bf16_f32 v64, v64, v65
    v_cvt_pk_bf16_f32 v65, v66, v67
    v_cvt_pk_bf16_f32 v66, v68, v69
    v_cvt_pk_bf16_f32 v67, v70, v71
    v_mfma_f32_16x16x32_bf16 v[108:111], v[228:231], v[172:175], v[108:111]
    v_cvt_pk_bf16_f32 v72, v72, v73
    v_cvt_pk_bf16_f32 v73, v74, v75
    v_cvt_pk_bf16_f32 v74, v76, v77
    v_cvt_pk_bf16_f32 v75, v78, v79
    s_waitcnt lgkmcnt(2)
    v_mfma_f32_16x16x32_bf16 v[112:115], v[232:235], v[160:163], v[112:115]
    v_mfma_f32_16x16x32_bf16 v[120:123], v[232:235], v[164:167], v[120:123]
    v_mfma_f32_16x16x32_bf16 v[128:131], v[232:235], v[168:171], v[128:131]
    v_mfma_f32_16x16x32_bf16 v[136:139], v[232:235], v[172:175], v[136:139]
    s_waitcnt lgkmcnt(0)
    v_mfma_f32_16x16x32_bf16 v[116:119], v[236:239], v[160:163], v[116:119]
    v_cvt_pk_bf16_f32 v80, v80, v81
    v_cvt_pk_bf16_f32 v81, v82, v83
    v_cvt_pk_bf16_f32 v82, v84, v85
    v_cvt_pk_bf16_f32 v83, v86, v87
    v_mfma_f32_16x16x32_bf16 v[124:127], v[236:239], v[164:167], v[124:127]
    v_cvt_pk_bf16_f32 v88, v88, v89
    v_cvt_pk_bf16_f32 v89, v90, v91
    v_cvt_pk_bf16_f32 v90, v92, v93
    v_cvt_pk_bf16_f32 v91, v94, v95
    v_mfma_f32_16x16x32_bf16 v[132:135], v[236:239], v[168:171], v[132:135]
    v_cvt_pk_bf16_f32 v96, v96, v97
    v_cvt_pk_bf16_f32 v97, v98, v99
    v_cvt_pk_bf16_f32 v98, v100, v101
    v_cvt_pk_bf16_f32 v99, v102, v103
    v_mfma_f32_16x16x32_bf16 v[140:143], v[236:239], v[172:175], v[140:143]
    v_cvt_pk_bf16_f32 v104, v104, v105
    v_cvt_pk_bf16_f32 v105, v106, v107
    v_cvt_pk_bf16_f32 v106, v108, v109
    v_cvt_pk_bf16_f32 v107, v110, v111
    v_mov_b32 v52, v48
    v_mov_b32 v53, v49
    v_mov_b32 v54, v50
    v_mov_b32 v55, v51
    v_mov_b32_dpp v48, v80 row_ror:8 row_mask:0xf bank_mask:0xc
    v_mov_b32_dpp v49, v81 row_ror:8 row_mask:0xf bank_mask:0xc
    v_mov_b32_dpp v50, v82 row_ror:8 row_mask:0xf bank_mask:0xc
    v_mov_b32_dpp v51, v83 row_ror:8 row_mask:0xf bank_mask:0xc
    v_mov_b32_dpp v80, v52 row_ror:8 row_mask:0xf bank_mask:0x3
    v_mov_b32_dpp v81, v53 row_ror:8 row_mask:0xf bank_mask:0x3
    v_mov_b32_dpp v82, v54 row_ror:8 row_mask:0xf bank_mask:0x3
    v_mov_b32_dpp v83, v55 row_ror:8 row_mask:0xf bank_mask:0x3
    buffer_store_dwordx4 v[48:51], v244, s[8:11], s24 offen offset:0 sc1
    buffer_store_dwordx4 v[80:83], v245, s[8:11], s24 offen offset:0 sc1
    v_mov_b32 v68, v64
    v_mov_b32 v69, v65
    v_mov_b32 v70, v66
    v_mov_b32 v71, v67
    v_mov_b32_dpp v64, v96 row_ror:8 row_mask:0xf bank_mask:0xc
    v_mov_b32_dpp v65, v97 row_ror:8 row_mask:0xf bank_mask:0xc
    v_mov_b32_dpp v66, v98 row_ror:8 row_mask:0xf bank_mask:0xc
    v_mov_b32_dpp v67, v99 row_ror:8 row_mask:0xf bank_mask:0xc
    v_mov_b32_dpp v96, v68 row_ror:8 row_mask:0xf bank_mask:0x3
    v_mov_b32_dpp v97, v69 row_ror:8 row_mask:0xf bank_mask:0x3
    v_mov_b32_dpp v98, v70 row_ror:8 row_mask:0xf bank_mask:0x3
    v_mov_b32_dpp v99, v71 row_ror:8 row_mask:0xf bank_mask:0x3
    buffer_store_dwordx4 v[64:67], v244, s[8:11], s25 offen offset:0 sc1
    buffer_store_dwordx4 v[96:99], v245, s[8:11], s25 offen offset:0 sc1
    v_cvt_pk_bf16_f32 v112, v112, v113
    v_cvt_pk_bf16_f32 v113, v114, v115
    v_cvt_pk_bf16_f32 v114, v116, v117
    v_cvt_pk_bf16_f32 v115, v118, v119
    v_cvt_pk_bf16_f32 v120, v120, v121
    v_cvt_pk_bf16_f32 v121, v122, v123
    v_cvt_pk_bf16_f32 v122, v124, v125
    v_cvt_pk_bf16_f32 v123, v126, v127
    v_mov_b32 v116, v112
    v_mov_b32 v117, v113
    v_mov_b32 v118, v114
    v_mov_b32 v119, v115
    v_mov_b32_dpp v112, v56 row_ror:8 row_mask:0xf bank_mask:0xc
    v_mov_b32_dpp v113, v57 row_ror:8 row_mask:0xf bank_mask:0xc
    v_mov_b32_dpp v114, v58 row_ror:8 row_mask:0xf bank_mask:0xc
    v_mov_b32_dpp v115, v59 row_ror:8 row_mask:0xf bank_mask:0xc
    v_mov_b32_dpp v56, v116 row_ror:8 row_mask:0xf bank_mask:0x3
    v_mov_b32_dpp v57, v117 row_ror:8 row_mask:0xf bank_mask:0x3
    v_mov_b32_dpp v58, v118 row_ror:8 row_mask:0xf bank_mask:0x3
    v_mov_b32_dpp v59, v119 row_ror:8 row_mask:0xf bank_mask:0x3
    buffer_store_dwordx4 v[112:115], v244, s[8:11], s24 offen offset:128 sc1
    buffer_store_dwordx4 v[56:59], v245, s[8:11], s24 offen offset:128 sc1
    v_mov_b32 v92, v88
    v_mov_b32 v93, v89
    v_mov_b32 v94, v90
    v_mov_b32 v95, v91
    v_mov_b32_dpp v88, v120 row_ror:8 row_mask:0xf bank_mask:0xc
    v_mov_b32_dpp v89, v121 row_ror:8 row_mask:0xf bank_mask:0xc
    v_mov_b32_dpp v90, v122 row_ror:8 row_mask:0xf bank_mask:0xc
    v_mov_b32_dpp v91, v123 row_ror:8 row_mask:0xf bank_mask:0xc
    v_mov_b32_dpp v120, v92 row_ror:8 row_mask:0xf bank_mask:0x3
    v_mov_b32_dpp v121, v93 row_ror:8 row_mask:0xf bank_mask:0x3
    v_mov_b32_dpp v122, v94 row_ror:8 row_mask:0xf bank_mask:0x3
    v_mov_b32_dpp v123, v95 row_ror:8 row_mask:0xf bank_mask:0x3
    buffer_store_dwordx4 v[88:91], v244, s[8:11], s24 offen offset:256 sc1
    buffer_store_dwordx4 v[120:123], v245, s[8:11], s24 offen offset:256 sc1
    v_cvt_pk_bf16_f32 v128, v128, v129
    v_cvt_pk_bf16_f32 v129, v130, v131
    v_cvt_pk_bf16_f32 v130, v132, v133
    v_cvt_pk_bf16_f32 v131, v134, v135
    v_cvt_pk_bf16_f32 v136, v136, v137
    v_cvt_pk_bf16_f32 v137, v138, v139
    v_cvt_pk_bf16_f32 v138, v140, v141
    v_cvt_pk_bf16_f32 v139, v142, v143
    v_mov_b32 v132, v128
    v_mov_b32 v133, v129
    v_mov_b32 v134, v130
    v_mov_b32 v135, v131
    v_mov_b32_dpp v128, v72 row_ror:8 row_mask:0xf bank_mask:0xc
    v_mov_b32_dpp v129, v73 row_ror:8 row_mask:0xf bank_mask:0xc
    v_mov_b32_dpp v130, v74 row_ror:8 row_mask:0xf bank_mask:0xc
    v_mov_b32_dpp v131, v75 row_ror:8 row_mask:0xf bank_mask:0xc
    v_mov_b32_dpp v72, v132 row_ror:8 row_mask:0xf bank_mask:0x3
    v_mov_b32_dpp v73, v133 row_ror:8 row_mask:0xf bank_mask:0x3
    v_mov_b32_dpp v74, v134 row_ror:8 row_mask:0xf bank_mask:0x3
    v_mov_b32_dpp v75, v135 row_ror:8 row_mask:0xf bank_mask:0x3
    buffer_store_dwordx4 v[128:131], v244, s[8:11], s25 offen offset:128 sc1
    buffer_store_dwordx4 v[72:75], v245, s[8:11], s25 offen offset:128 sc1
    v_mov_b32 v108, v104
    v_mov_b32 v109, v105
    v_mov_b32 v110, v106
    v_mov_b32 v111, v107
    v_mov_b32_dpp v104, v136 row_ror:8 row_mask:0xf bank_mask:0xc
    v_mov_b32_dpp v105, v137 row_ror:8 row_mask:0xf bank_mask:0xc
    v_mov_b32_dpp v106, v138 row_ror:8 row_mask:0xf bank_mask:0xc
    v_mov_b32_dpp v107, v139 row_ror:8 row_mask:0xf bank_mask:0xc
    v_mov_b32_dpp v136, v108 row_ror:8 row_mask:0xf bank_mask:0x3
    v_mov_b32_dpp v137, v109 row_ror:8 row_mask:0xf bank_mask:0x3
    v_mov_b32_dpp v138, v110 row_ror:8 row_mask:0xf bank_mask:0x3
    v_mov_b32_dpp v139, v111 row_ror:8 row_mask:0xf bank_mask:0x3
    buffer_store_dwordx4 v[104:107], v244, s[8:11], s25 offen offset:256 sc1
    buffer_store_dwordx4 v[136:139], v245, s[8:11], s25 offen offset:256 sc1

    s_cmp_lg_u32 s17, 0
    s_cbranch_scc1 L_end
    s_mov_b32 s17, 1
    s_mov_b32 s24, s36
    s_mov_b32 s25, s37
    s_mov_b32 s36, 1073741824
    s_mov_b32 s37, 1073741824

    s_branch L_mtile

L_rd1_slow:
    v_mov_b32 v224, 161976

    s_mov_b32 s29, 200000
L_rd1:
    ds_read_b32 v225, v224
    s_waitcnt lgkmcnt(0)
    v_cmp_le_u32 vcc, 1, v225
    s_cmp_eq_u64 vcc, exec
    s_cbranch_scc1 L_rd1_ok
    s_sleep 2
    s_sub_u32 s29, s29, 1
    s_cmp_lg_u32 s29, 0
    s_cbranch_scc1 L_rd1
L_rd1_ok:

    v_readfirstlane_b32 s19, v225
    s_branch L_rd1_go
L_rd2_slow:
    v_mov_b32 v232, 161976

    s_mov_b32 s29, 200000
L_rd2:
    ds_read_b32 v233, v232
    s_waitcnt lgkmcnt(0)
    v_cmp_le_u32 vcc, 2, v233
    s_cmp_eq_u64 vcc, exec
    s_cbranch_scc1 L_rd2_ok
    s_sleep 2
    s_sub_u32 s29, s29, 1
    s_cmp_lg_u32 s29, 0
    s_cbranch_scc1 L_rd2
L_rd2_ok:

    v_readfirstlane_b32 s19, v233
    s_branch L_rd2_go
L_rd3_slow:
    v_mov_b32 v224, 161976

    s_mov_b32 s29, 200000
L_rd3:
    ds_read_b32 v225, v224
    s_waitcnt lgkmcnt(0)
    v_cmp_le_u32 vcc, 3, v225
    s_cmp_eq_u64 vcc, exec
    s_cbranch_scc1 L_rd3_ok
    s_sleep 2
    s_sub_u32 s29, s29, 1
    s_cmp_lg_u32 s29, 0
    s_cbranch_scc1 L_rd3
L_rd3_ok:

    v_readfirstlane_b32 s19, v225
    s_branch L_rd3_go
L_rd4_slow:
    v_mov_b32 v228, 161976

    s_mov_b32 s29, 200000
L_rd4:
    ds_read_b32 v229, v228
    s_waitcnt lgkmcnt(0)
    v_cmp_le_u32 vcc, 4, v229
    s_cmp_eq_u64 vcc, exec
    s_cbranch_scc1 L_rd4_ok
    s_sleep 2
    s_sub_u32 s29, s29, 1
    s_cmp_lg_u32 s29, 0
    s_cbranch_scc1 L_rd4
L_rd4_ok:

    v_readfirstlane_b32 s19, v229
    s_branch L_rd4_go
L_park:
    v_mov_b32 v244, 161972

    s_mov_b32 s29, 200000
L_wi9:
    ds_read_b32 v245, v244
    s_waitcnt lgkmcnt(0)
    v_cmp_eq_u32 vcc, 9, v245
    s_cmp_eq_u64 vcc, exec
    s_cbranch_scc1 L_wi9_ok
    s_sleep 2
    s_sub_u32 s29, s29, 1
    s_cmp_lg_u32 s29, 0
    s_cbranch_scc1 L_wi9
L_wi9_ok:

    v_lshrrev_b32 v244, 7, v253
    v_mul_u32_u24 v244, 640, v244
    v_add_u32 v244, v244, v253
    v_add_u32 v245, 196608, v244
    buffer_store_dwordx4 v[48:51], v244, s[8:11], s36 offen offset:0 sc1
    buffer_store_dwordx4 v[52:55], v244, s[8:11], s36 offen offset:128 sc1
    buffer_store_dwordx4 v[56:59], v244, s[8:11], s36 offen offset:256 sc1
    buffer_store_dwordx4 v[60:63], v244, s[8:11], s37 offen offset:0 sc1
    buffer_store_dwordx4 v[64:67], v244, s[8:11], s37 offen offset:128 sc1
    buffer_store_dwordx4 v[68:71], v244, s[8:11], s37 offen offset:256 sc1
    buffer_store_dwordx4 v[72:75], v245, s[8:11], s36 offen offset:0 sc1
    buffer_store_dwordx4 v[76:79], v245, s[8:11], s36 offen offset:128 sc1
    buffer_store_dwordx4 v[80:83], v245, s[8:11], s36 offen offset:256 sc1
    buffer_store_dwordx4 v[84:87], v245, s[8:11], s37 offen offset:0 sc1
    buffer_store_dwordx4 v[88:91], v245, s[8:11], s37 offen offset:128 sc1
    buffer_store_dwordx4 v[92:95], v245, s[8:11], s37 offen offset:256 sc1
    s_mov_b32 s38, 0
    s_nop 1
    s_branch L_parked
L_rd6_slow:
    v_mov_b32 v224, 161976

    s_mov_b32 s29, 200000
L_rd6:
    ds_read_b32 v225, v224
    s_waitcnt lgkmcnt(0)
    v_cmp_le_u32 vcc, 6, v225
    s_cmp_eq_u64 vcc, exec
    s_cbranch_scc1 L_rd6_ok
    s_sleep 2
    s_sub_u32 s29, s29, 1
    s_cmp_lg_u32 s29, 0
    s_cbranch_scc1 L_rd6
L_rd6_ok:

    v_readfirstlane_b32 s19, v225
    s_branch L_rd6_go
L_rd8_slow:
    v_mov_b32 v224, 161976

    s_mov_b32 s29, 200000
L_rd8:
    ds_read_b32 v225, v224
    s_waitcnt lgkmcnt(0)
    v_cmp_le_u32 vcc, 8, v225
    s_cmp_eq_u64 vcc, exec
    s_cbranch_scc1 L_rd8_ok
    s_sleep 2
    s_sub_u32 s29, s29, 1
    s_cmp_lg_u32 s29, 0
    s_cbranch_scc1 L_rd8
L_rd8_ok:

    v_readfirstlane_b32 s19, v225
    s_branch L_rd8_go
L_rd10_slow:
    v_mov_b32 v224, 161976

    s_mov_b32 s29, 200000
L_rd10:
    ds_read_b32 v225, v224
    s_waitcnt lgkmcnt(0)
    v_cmp_le_u32 vcc, 10, v225
    s_cmp_eq_u64 vcc, exec
    s_cbranch_scc1 L_rd10_ok
    s_sleep 2
    s_sub_u32 s29, s29, 1
    s_cmp_lg_u32 s29, 0
    s_cbranch_scc1 L_rd10
L_rd10_ok:

    v_readfirstlane_b32 s19, v225
    s_branch L_rd10_go
L_rd12_slow:
    v_mov_b32 v224, 161976

    s_mov_b32 s29, 200000
L_rd12:
    ds_read_b32 v225, v224
    s_waitcnt lgkmcnt(0)
    v_cmp_le_u32 vcc, 12, v225
    s_cmp_eq_u64 vcc, exec
    s_cbranch_scc1 L_rd12_ok
    s_sleep 2
    s_sub_u32 s29, s29, 1
    s_cmp_lg_u32 s29, 0
    s_cbranch_scc1 L_rd12
L_rd12_ok:

    v_readfirstlane_b32 s19, v225
    s_branch L_rd12_go
L_pu2:
    s_setprio 0
    s_branch L_pb2
L_rd14_slow:
    v_mov_b32 v224, 161976

    s_mov_b32 s29, 200000
L_rd14:
    ds_read_b32 v225, v224
    s_waitcnt lgkmcnt(0)
    v_cmp_le_u32 vcc, 14, v225
    s_cmp_eq_u64 vcc, exec
    s_cbranch_scc1 L_rd14_ok
    s_sleep 2
    s_sub_u32 s29, s29, 1
    s_cmp_lg_u32 s29, 0
    s_cbranch_scc1 L_rd14
L_rd14_ok:

    v_readfirstlane_b32 s19, v225
    s_branch L_rd14_go
L_rd16_slow:
    v_mov_b32 v224, 161976

    s_mov_b32 s29, 200000
L_rd16:
    ds_read_b32 v225, v224
    s_waitcnt lgkmcnt(0)
    v_cmp_le_u32 vcc, 16, v225
    s_cmp_eq_u64 vcc, exec
    s_cbranch_scc1 L_rd16_ok
    s_sleep 2
    s_sub_u32 s29, s29, 1
    s_cmp_lg_u32 s29, 0
    s_cbranch_scc1 L_rd16
L_rd16_ok:

    v_readfirstlane_b32 s19, v225
    s_branch L_rd16_go
L_rd18_slow:
    v_mov_b32 v224, 161976

    s_mov_b32 s29, 200000
L_rd18:
    ds_read_b32 v225, v224
    s_waitcnt lgkmcnt(0)
    v_cmp_le_u32 vcc, 18, v225
    s_cmp_eq_u64 vcc, exec
    s_cbranch_scc1 L_rd18_ok
    s_sleep 2
    s_sub_u32 s29, s29, 1
    s_cmp_lg_u32 s29, 0
    s_cbranch_scc1 L_rd18
L_rd18_ok:

    v_readfirstlane_b32 s19, v225
    s_branch L_rd18_go
L_rd20_slow:
    v_mov_b32 v224, 161976

    s_mov_b32 s29, 200000
L_rd20:
    ds_read_b32 v225, v224
    s_waitcnt lgkmcnt(0)
    v_cmp_le_u32 vcc, 20, v225
    s_cmp_eq_u64 vcc, exec
    s_cbranch_scc1 L_rd20_ok
    s_sleep 2
    s_sub_u32 s29, s29, 1
    s_cmp_lg_u32 s29, 0
    s_cbranch_scc1 L_rd20
L_rd20_ok:

    v_readfirstlane_b32 s19, v225
    s_branch L_rd20_go
L_rd22_slow:
    v_mov_b32 v224, 161976

    s_mov_b32 s29, 200000
L_rd22:
    ds_read_b32 v225, v224
    s_waitcnt lgkmcnt(0)
    v_cmp_le_u32 vcc, 22, v225
    s_cmp_eq_u64 vcc, exec
    s_cbranch_scc1 L_rd22_ok
    s_sleep 2
    s_sub_u32 s29, s29, 1
    s_cmp_lg_u32 s29, 0
    s_cbranch_scc1 L_rd22
L_rd22_ok:

    v_readfirstlane_b32 s19, v225
    s_branch L_rd22_go
L_rd24_slow:
    v_mov_b32 v224, 161976

    s_mov_b32 s29, 200000
L_rd24:
    ds_read_b32 v225, v224
    s_waitcnt lgkmcnt(0)
    v_cmp_le_u32 vcc, 24, v225
    s_cmp_eq_u64 vcc, exec
    s_cbranch_scc1 L_rd24_ok
    s_sleep 2
    s_sub_u32 s29, s29, 1
    s_cmp_lg_u32 s29, 0
    s_cbranch_scc1 L_rd24
L_rd24_ok:

    v_readfirstlane_b32 s19, v225
    s_branch L_rd24_go

L_end:
    s_endpgm

.section .rodata,"a"

.p2align 6
.amdhsa_kernel standalone__modern_conv_block_replknet__vision_kernel
.amdhsa_next_free_vgpr 256
.amdhsa_next_free_sgpr 100
.amdhsa_accum_offset 256
.amdhsa_group_segment_fixed_size 0
.amdhsa_kernarg_size 64
.amdhsa_user_sgpr_count 2
.amdhsa_user_sgpr_kernarg_segment_ptr 1
.amdhsa_system_sgpr_workgroup_id_x 1
.amdhsa_float_denorm_mode_32 3
.end_amdhsa_kernel
```

```asm
; @launch grid=(256,1,1) block=(512,1,1) lds=162320
.amdgcn_target "amdgcn-amd-amdhsa--gfx950"
.text

.globl standalone__modern_conv_block_replknet__vision_kernel
.p2align 8
.type standalone__modern_conv_block_replknet__vision_kernel,@function
standalone__modern_conv_block_replknet__vision_kernel:
    s_cmp_ge_u32 s2, 256
    s_cbranch_scc1 L_end
    s_load_dwordx8 s[64:71], s[0:1], 0
    s_load_dwordx4 s[72:75], s[0:1], 32

    s_getpc_b64 s[96:97]
L_pc0:
    v_add_u32 v16, 448, v0
    v_and_b32 v16, 511, v16
    v_lshlrev_b32 v16, 7, v16
    v_min_u32 v16, L_end-L_pc0, v16
    v_mov_b32 v17, s97
    v_add_co_u32 v16, vcc, s96, v16
    s_nop 1
    v_addc_co_u32 v17, vcc, 0, v17, vcc
    global_load_dword v18, v[16:17], off sc1
    s_setprio 3
    v_mov_b32 v14, v0
    v_lshrrev_b32 v1, 6, v0
    v_and_b32 v0, 63, v0
    v_mov_b32 v10, 1073741824
    v_readfirstlane_b32 s16, v1
    v_lshlrev_b32 v2, 2, v0
    v_add_u32 v2, 161808, v2
    v_add_u32 v3, -10, v0
    v_cmp_gt_u32 vcc, 10, v3
    v_cmp_eq_u32 s[56:57], 36, v0
    s_or_b64 vcc, vcc, s[56:57]
    v_cmp_eq_u32 s[56:57], 41, v0
    s_or_b64 vcc, vcc, s[56:57]
    v_cndmask_b32 v3, 0, 1, vcc
    v_lshlrev_b32 v253, 4, v0
    v_min_u32 v240, 1, v0
    ds_write_b32 v2, v3
    v_lshlrev_b32 v240, 2, v240
    s_and_b32 s26, s2, 3
    s_lshl_b32 s26, s26, 2
    s_bfe_u32 s27, s2, 0x20003
    s_add_u32 s26, s26, s27
    s_lshl_b32 s22, s26, 5
    s_bfe_u32 s26, s2, 0x10002
    s_lshl_b32 s26, s26, 3
    s_lshr_b32 s27, s2, 5
    s_add_u32 s26, s26, s27
    s_lshl_b32 s23, s26, 5
    s_and_b32 s34, s26, 1
    s_mul_i32 s35, s34, 196608
    s_mul_i32 s34, s34, 3
    v_mul_u32_u24 v12, 43, v0
    v_lshrrev_b32 v12, 9, v12
    v_mul_u32_u24 v13, 12, v12
    v_sub_u32 v13, v0, v13
    v_xor_b32 v5, s34, v12
    v_mul_u32_u24 v5, 98304, v5
    v_lshl_add_u32 v5, v13, 4, v5
    v_cmp_gt_u32 vcc, 48, v0
    v_cmp_gt_u32 s[58:59], 24, v0
    s_cmp_eq_u32 s22, 0
    s_cselect_b32 s80, 1073741824, 0
    v_cndmask_b32 v247, v10, v5, vcc
    s_mov_b32 s82, 3840
    s_cmp_eq_u32 s22, 480
    s_cselect_b32 s81, 1073741824, s82
    s_mov_b32 s18, s16
    v_add_u32 v15, -256, v14

    s_waitcnt lgkmcnt(0)
    s_mov_b32 s4, s64
    s_and_b32 s5, s65, 0xffff
    s_mov_b32 s6, 50331648
    s_mov_b32 s7, 0x20000
    s_mov_b32 s48, s66
    s_and_b32 s49, s67, 0xffff
    s_mov_b32 s50, 1728
    s_mov_b32 s51, 0x20000
    s_mov_b32 s52, s68
    s_and_b32 s53, s69, 0xffff
    s_mov_b32 s54, 4800
    s_mov_b32 s55, 0x20000
    s_mov_b32 s40, s70
    s_and_b32 s41, s71, 0xffff
    s_mov_b32 s42, 73728
    s_mov_b32 s43, 0x20000
    s_mov_b32 s44, s72
    s_and_b32 s45, s73, 0xffff
    s_mov_b32 s46, 73728
    s_mov_b32 s47, 0x20000
    s_mov_b32 s8, s74
    s_and_b32 s9, s75, 0xffff
    s_mov_b32 s10, 50331648
    s_mov_b32 s11, 0x20000

    s_cmp_lg_u32 s16, 0
    s_cbranch_scc1 L_pb0
    s_mov_b32 m0, 131328
    s_mov_b32 s26, 4096

    buffer_load_dwordx4 v253, s[52:55], 0 offen offset:0 lds
    buffer_load_dwordx4 v253, s[52:55], 0 offen offset:1024 lds
    buffer_load_dwordx4 v253, s[52:55], 0 offen offset:2048 lds
    buffer_load_dwordx4 v253, s[52:55], 0 offen offset:3072 lds
    s_mov_b32 m0, 135424
    s_nop 0
    buffer_load_dwordx4 v253, s[52:55], s26 offen lds
    s_mov_b32 m0, 136448
    s_nop 0
    buffer_load_dwordx4 v253, s[48:51], 0 offen offset:0 lds
    buffer_load_dwordx4 v253, s[48:51], 0 offen offset:1024 lds

    s_sub_u32 s26, 8, s18
    s_cmp_eq_u32 s34, 0
    s_cselect_b32 s26, s18, s26
    s_lshl_b32 s26, s26, 2
    s_add_u32 s26, s26, s23
    s_lshl_b32 s27, s26, 9
    s_add_u32 s27, s27, s22
    s_mul_i32 s27, s27, 192
    s_cmp_lt_u32 s26, 2
    s_cselect_b64 vcc, s[58:59], 0
    v_mov_b32 v248, 1073741824
    s_sub_u32 s28, s27, 196608
    v_add_u32 v255, s28, v247
    v_cndmask_b32 v248, v255, v248, vcc
    v_add_u32 v255, -384, v248

    buffer_load_dwordx4 v[48:51], v255, s[4:7], s80 offen offset:0 sc1
    buffer_load_dwordx4 v[52:55], v255, s[4:7], s80 offen offset:192 sc1
    buffer_load_dwordx4 v[56:59], v248, s[4:7], 0 offen offset:0 sc1
    buffer_load_dwordx4 v[60:63], v248, s[4:7], 0 offen offset:192 sc1
    buffer_load_dwordx4 v[64:67], v248, s[4:7], 0 offen offset:384 sc1
    buffer_load_dwordx4 v[68:71], v248, s[4:7], 0 offen offset:576 sc1
    buffer_load_dwordx4 v[72:75], v248, s[4:7], 0 offen offset:768 sc1
    buffer_load_dwordx4 v[76:79], v248, s[4:7], 0 offen offset:960 sc1
    buffer_load_dwordx4 v[80:83], v248, s[4:7], 0 offen offset:1152 sc1
    buffer_load_dwordx4 v[84:87], v248, s[4:7], 0 offen offset:1344 sc1
    buffer_load_dwordx4 v[88:91], v248, s[4:7], 0 offen offset:1536 sc1
    buffer_load_dwordx4 v[92:95], v248, s[4:7], 0 offen offset:1728 sc1
    buffer_load_dwordx4 v[96:99], v248, s[4:7], 0 offen offset:1920 sc1
    buffer_load_dwordx4 v[100:103], v248, s[4:7], 0 offen offset:2112 sc1
    buffer_load_dwordx4 v[104:107], v248, s[4:7], 0 offen offset:2304 sc1
    buffer_load_dwordx4 v[108:111], v248, s[4:7], 0 offen offset:2496 sc1
    buffer_load_dwordx4 v[112:115], v248, s[4:7], 0 offen offset:2688 sc1
    buffer_load_dwordx4 v[116:119], v248, s[4:7], 0 offen offset:2880 sc1
    buffer_load_dwordx4 v[120:123], v248, s[4:7], 0 offen offset:3072 sc1
    buffer_load_dwordx4 v[124:127], v248, s[4:7], 0 offen offset:3264 sc1
    buffer_load_dwordx4 v[128:131], v248, s[4:7], 0 offen offset:3456 sc1
    buffer_load_dwordx4 v[132:135], v248, s[4:7], 0 offen offset:3648 sc1
    buffer_load_dwordx4 v[136:139], v248, s[4:7], s82 offen offset:0 sc1
    buffer_load_dwordx4 v[140:143], v248, s[4:7], s82 offen offset:192 sc1
    buffer_load_dwordx4 v[144:147], v248, s[4:7], s82 offen offset:384 sc1
    buffer_load_dwordx4 v[148:151], v248, s[4:7], s82 offen offset:576 sc1
    buffer_load_dwordx4 v[152:155], v248, s[4:7], s82 offen offset:768 sc1
    buffer_load_dwordx4 v[156:159], v248, s[4:7], s82 offen offset:960 sc1
    buffer_load_dwordx4 v[160:163], v248, s[4:7], s82 offen offset:1152 sc1
    buffer_load_dwordx4 v[164:167], v248, s[4:7], s82 offen offset:1344 sc1
    buffer_load_dwordx4 v[168:171], v248, s[4:7], s82 offen offset:1536 sc1
    buffer_load_dwordx4 v[172:175], v248, s[4:7], s82 offen offset:1728 sc1
    buffer_load_dwordx4 v[176:179], v248, s[4:7], s82 offen offset:1920 sc1
    buffer_load_dwordx4 v[180:183], v248, s[4:7], s82 offen offset:2112 sc1
    buffer_load_dwordx4 v[184:187], v248, s[4:7], s81 offen offset:2304 sc1
    buffer_load_dwordx4 v[188:191], v248, s[4:7], s81 offen offset:2496 sc1

    s_barrier
    v_mov_b32 v254, 161972
    v_mov_b32 v255, 1

    s_waitcnt vmcnt(36)
    ds_write_b32 v254, v255 offset:12

L_pb0:
L_pb:
    s_mov_b32 s98, 931135488
    s_mov_b32 s20, 0x05040100
    s_mov_b32 s21, 0x07060302
    s_lshr_b32 s26, s2, 3
    s_mul_i32 s27, s26, 43
    s_lshr_b32 s27, s27, 9
    s_mul_i32 s27, s27, 12
    s_sub_u32 s39, s26, s27
    v_bfe_u32 v1, v0, 3, 1
    v_lshrrev_b32 v2, 5, v0
    v_bfe_u32 v3, v0, 4, 1
    v_bfe_u32 v4, v0, 2, 1
    v_sub_u32 v3, v3, v4
    v_and_b32 v4, 3, v0
    v_mul_u32_u24 v5, 65440, v1
    v_lshl_add_u32 v5, v4, 4, v5
    v_add_u32 v5, 50176, v5
    v_cmp_eq_u32 s[56:57], v1, v2
    v_add_u32 v6, 0, v3
    v_cmp_gt_u32 vcc, 5, v6
    v_lshl_add_u32 v7, v6, 6, v5
    s_and_b64 vcc, vcc, s[56:57]
    v_cndmask_b32 v241, v10, v7, vcc
    v_add_u32 v6, 2, v3
    v_lshl_add_u32 v7, v6, 6, v5
    v_cndmask_b32 v242, v10, v7, s[56:57]
    v_add_u32 v6, 4, v3
    v_cmp_gt_u32 vcc, 5, v6
    v_lshl_add_u32 v7, v6, 6, v5
    s_and_b64 vcc, vcc, s[56:57]
    v_cndmask_b32 v243, v10, v7, vcc
    v_mul_u32_u24 v2, 1168, v2
    v_and_b32 v3, 7, v0
    v_lshl_add_u32 v250, v3, 3, v2
    v_mul_u32_u24 v3, 768, v3
    v_mul_u32_u24 v4, 196608, v1
    v_xor_b32 v4, s35, v4
    v_add_u32 v3, v3, v4
    v_lshrrev_b32 v4, 4, v0
    v_lshl_add_u32 v252, v4, 4, v3

    v_bfe_u32 v3, v0, 4, 1
    v_mul_u32_u24 v3, 7104, v3
    v_add_u32 v250, v250, v3
    v_cmp_eq_u32 s[56:57], 1, v1
    v_and_b32 v5, 1, v12
    v_mul_u32_u24 v5, 7104, v5
    v_mul_u32_u24 v6, 584, v13
    v_add_u32 v249, v5, v6
    s_sub_u32 s26, 7, s16
    s_cmp_eq_u32 s34, 0
    s_cselect_b32 s26, s16, s26
    s_cselect_b32 s27, 0, 98304
    s_cselect_b32 s28, 98304, 0
    s_lshl_b32 s26, s26, 2
    s_add_u32 s26, s26, s23
    s_lshl_b32 s26, s26, 9
    s_add_u32 s26, s26, s22
    s_mul_i32 s26, s26, 192
    s_add_u32 s36, s26, s27
    s_add_u32 s37, s26, s28
    s_add_u32 s24, s36, 384
    s_add_u32 s25, s37, 384
    s_cmp_lt_u32 s16, 1
    s_cbranch_scc1 L_perm
    s_barrier
    s_cmp_lt_u32 s16, 4
    s_cbranch_scc1 L_xload

    v_mov_b32 v254, 161984

    s_mov_b32 s29, 200000
L_wraw:
    ds_read_b32 v255, v254
    s_waitcnt lgkmcnt(0)
    v_cmp_eq_u32 vcc, 1, v255
    s_cmp_eq_u64 vcc, exec
    s_cbranch_scc1 L_wraw_ok
    s_sleep 2
    s_sub_u32 s29, s29, 1
    s_cmp_lg_u32 s29, 0
    s_cbranch_scc1 L_wraw
L_wraw_ok:

    v_add_u32 v1, 0, v15
    v_mul_u32_u24 v128, 683, v1
    v_lshrrev_b32 v128, 16, v128
    v_mul_u32_u24 v129, 96, v128
    v_sub_u32 v129, v1, v129
    v_mul_u32_u24 v2, 960, v128
    v_lshl_add_u32 v2, v129, 1, v2
    v_add_u32 v2, 131328, v2
    v_add_u32 v1, -1, v128
    v_mul_u32_u24 v3, 576, v1
    v_lshl_add_u32 v3, v129, 1, v3
    v_add_u32 v3, 136448, v3
    v_cmp_gt_u32 vcc, 3, v1
    s_nop 1
    v_cndmask_b32 v3, v10, v3, vcc

    ds_read_u16 v132, v2 offset:0
    ds_read_u16 v133, v2 offset:192
    ds_read_u16 v134, v2 offset:384
    ds_read_u16 v135, v2 offset:576
    ds_read_u16 v136, v2 offset:768
    ds_read_u16 v137, v3 offset:0
    ds_read_u16 v138, v3 offset:192
    ds_read_u16 v139, v3 offset:384

    v_add_u32 v1, 256, v15
    v_mul_u32_u24 v144, 683, v1
    v_lshrrev_b32 v144, 16, v144
    v_mul_u32_u24 v145, 96, v144
    v_sub_u32 v145, v1, v145
    v_mul_u32_u24 v2, 960, v144
    v_lshl_add_u32 v2, v145, 1, v2
    v_add_u32 v2, 131328, v2
    v_add_u32 v1, -1, v144
    v_mul_u32_u24 v3, 576, v1
    v_lshl_add_u32 v3, v145, 1, v3
    v_add_u32 v3, 136448, v3
    v_cmp_gt_u32 vcc, 3, v1
    s_nop 1
    v_cndmask_b32 v3, v10, v3, vcc

    ds_read_u16 v148, v2 offset:0
    ds_read_u16 v149, v2 offset:192
    ds_read_u16 v150, v2 offset:384
    ds_read_u16 v151, v2 offset:576
    ds_read_u16 v152, v2 offset:768
    ds_read_u16 v153, v3 offset:0
    ds_read_u16 v154, v3 offset:192
    ds_read_u16 v155, v3 offset:384
    s_waitcnt lgkmcnt(0)
    v_lshlrev_b32 v132, 16, v132
    v_lshlrev_b32 v133, 16, v133
    v_lshlrev_b32 v134, 16, v134
    v_lshlrev_b32 v135, 16, v135
    v_lshlrev_b32 v136, 16, v136
    v_lshlrev_b32 v137, 16, v137
    v_lshlrev_b32 v138, 16, v138
    v_lshlrev_b32 v139, 16, v139

    v_add_f32 v133, v133, v137
    v_add_f32 v134, v134, v138
    v_add_f32 v135, v135, v139
    v_mul_f32 v132, 0x27800000, v132
    v_mul_f32 v133, 0x27800000, v133
    v_mul_f32 v134, 0x27800000, v134
    v_mul_f32 v135, 0x27800000, v135
    v_mul_f32 v136, 0x27800000, v136
    v_mov_b32 v1, 0
    v_cvt_pk_bf16_f32 v160, v132, v133
    v_cvt_pk_bf16_f32 v161, v134, v135
    v_cvt_pk_bf16_f32 v162, v136, v1
    v_mov_b32 v163, 0
    v_cvt_pk_bf16_f32 v164, v1, v132
    v_cvt_pk_bf16_f32 v165, v133, v134
    v_cvt_pk_bf16_f32 v166, v135, v136
    v_mov_b32 v167, 0
    v_mov_b32 v168, 0
    v_mov_b32 v169, v160
    v_mov_b32 v170, v161
    v_mov_b32 v171, v162
    v_mov_b32 v172, 0
    v_mov_b32 v173, v164
    v_mov_b32 v174, v165
    v_mov_b32 v175, v166
    v_lshrrev_b32 v2, 5, v129
    v_and_b32 v3, 15, v129
    v_lshl_add_u32 v2, v2, 4, v3
    v_mul_u32_u24 v2, 320, v2
    v_bfe_u32 v3, v129, 4, 1
    v_mul_u32_u24 v3, 65440, v3
    v_add_u32 v2, v2, v3
    v_sub_u32 v3, 4, v128
    s_cmp_eq_u32 s34, 0
    s_cselect_b64 vcc, -1, 0
    v_cndmask_b32 v3, v3, v128, vcc
    v_lshl_add_u32 v2, v3, 6, v2
    v_add_u32 v2, 50176, v2
    v_cmp_gt_u32 vcc, 5, v128
    s_nop 1
    v_cndmask_b32 v2, v10, v2, vcc
    ds_write_b128 v2, v[160:163]
    ds_write_b128 v2, v[164:167] offset:16
    ds_write_b128 v2, v[168:171] offset:32
    ds_write_b128 v2, v[172:175] offset:48

    v_lshlrev_b32 v148, 16, v148
    v_lshlrev_b32 v149, 16, v149
    v_lshlrev_b32 v150, 16, v150
    v_lshlrev_b32 v151, 16, v151
    v_lshlrev_b32 v152, 16, v152
    v_lshlrev_b32 v153, 16, v153
    v_lshlrev_b32 v154, 16, v154
    v_lshlrev_b32 v155, 16, v155

    v_add_f32 v149, v149, v153
    v_add_f32 v150, v150, v154
    v_add_f32 v151, v151, v155
    v_mul_f32 v148, 0x27800000, v148
    v_mul_f32 v149, 0x27800000, v149
    v_mul_f32 v150, 0x27800000, v150
    v_mul_f32 v151, 0x27800000, v151
    v_mul_f32 v152, 0x27800000, v152
    v_mov_b32 v1, 0
    v_cvt_pk_bf16_f32 v176, v148, v149
    v_cvt_pk_bf16_f32 v177, v150, v151
    v_cvt_pk_bf16_f32 v178, v152, v1
    v_mov_b32 v179, 0
    v_cvt_pk_bf16_f32 v180, v1, v148
    v_cvt_pk_bf16_f32 v181, v149, v150
    v_cvt_pk_bf16_f32 v182, v151, v152
    v_mov_b32 v183, 0
    v_mov_b32 v184, 0
    v_mov_b32 v185, v176
    v_mov_b32 v186, v177
    v_mov_b32 v187, v178
    v_mov_b32 v188, 0
    v_mov_b32 v189, v180
    v_mov_b32 v190, v181
    v_mov_b32 v191, v182
    v_lshrrev_b32 v2, 5, v145
    v_and_b32 v3, 15, v145
    v_lshl_add_u32 v2, v2, 4, v3
    v_mul_u32_u24 v2, 320, v2
    v_bfe_u32 v3, v145, 4, 1
    v_mul_u32_u24 v3, 65440, v3
    v_add_u32 v2, v2, v3
    v_sub_u32 v3, 4, v144
    s_cmp_eq_u32 s34, 0
    s_cselect_b64 vcc, -1, 0
    v_cndmask_b32 v3, v3, v144, vcc
    v_lshl_add_u32 v2, v3, 6, v2
    v_add_u32 v2, 50176, v2
    v_cmp_gt_u32 vcc, 5, v144
    s_nop 1
    v_cndmask_b32 v2, v10, v2, vcc
    ds_write_b128 v2, v[176:179]
    ds_write_b128 v2, v[180:183] offset:16
    ds_write_b128 v2, v[184:187] offset:32
    ds_write_b128 v2, v[188:191] offset:48

    v_mov_b32 v254, 161968
    v_mov_b32 v255, 1
    s_waitcnt lgkmcnt(0)
    s_mov_b64 exec, 1
    ds_add_u32 v254, v255
    s_mov_b64 exec, -1

    s_cmp_lt_u32 s16, 6
    s_cbranch_scc1 L_xload

    s_add_u32 s28, s98, 8388608
    s_and_b32 s26, s16, 1
    s_lshl_b32 s26, s26, 6
    v_lshrrev_b32 v1, 4, v253
    v_add_u32 v1, s26, v1
    v_lshlrev_b32 v2, 2, v1
    v_add_u32 v3, 65536, v2
    v_lshlrev_b32 v4, 17, v1
    v_or_b32 v4, 0x8000, v4
    v_cmp_gt_u32 vcc, 64, v1
    v_mov_b32 v5, s98
    v_mov_b32 v6, s28
    v_cndmask_b32 v5, v5, v6, vcc
    v_cndmask_b32 v6, 0, v6, vcc
    v_add_u32 v4, v4, v5
    v_mov_b32 v5, 0x1000000
    v_mov_b32 v7, 0x800000
    v_cndmask_b32 v5, v5, v7, vcc
    s_mov_b32 s26, 0x3dd2d3e8
    v_mov_b32 v7, 0x40135761
    s_mov_b32 s27, 14
L_tabla:
    v_add_u32 v9, 0x10000, v4
    v_sub_f32 v8, v4, v6
    v_sub_f32 v9, v9, v6
    v_mul_f32 v10, v8, v8
    v_mul_f32 v11, v9, v9
    v_fma_f32 v10, v10, s26, v7
    v_fma_f32 v11, v11, s26, v7
    v_mul_f32 v10, v10, v8
    v_mul_f32 v11, v11, v9
    v_exp_f32 v10, -v10
    v_exp_f32 v11, -v11
    s_nop 0
    v_add_f32 v12, 1.0, v10
    v_add_f32 v13, 1.0, v11
    v_rcp_f32 v12, v12
    v_rcp_f32 v13, v13
    s_nop 0
    v_mul_f32 v8, v8, v12
    v_mul_f32 v9, v9, v13
    v_mul_f32 v10, -v8, v10
    v_mul_f32 v11, -v9, v11
    v_cvt_pk_bf16_f32 v12, v8, v9
    v_cvt_pk_bf16_f32 v13, v10, v11
    ds_write_b32 v2, v12
    ds_write_b32 v3, v13
    v_add_u32 v4, v4, v5
    v_mov_b32 v5, 0x1000000
    v_mov_b32 v6, 0
    v_add_u32 v2, 512, v2
    v_add_u32 v3, 512, v3
    s_sub_u32 s27, s27, 1
    s_cmp_lg_u32 s27, 0
    s_cbranch_scc1 L_tabla
    v_mov_b32 v3, 65536
    ds_write_b16 v6, v6
    ds_write_b16 v3, v6

    v_mov_b32 v254, 161980
    v_mov_b32 v255, 1
    s_waitcnt lgkmcnt(0)
    s_mov_b64 exec, 1
    ds_add_u32 v254, v255
    s_mov_b64 exec, -1

L_xload:
    v_mov_b32 v254, 161972

    s_mov_b32 s29, 200000
L_wiss:
    ds_read_b32 v255, v254
    s_waitcnt lgkmcnt(0)
    v_cmp_eq_u32 vcc, s18, v255
    s_cmp_eq_u64 vcc, exec
    s_cbranch_scc1 L_wiss_ok
    s_sleep 2
    s_sub_u32 s29, s29, 1
    s_cmp_lg_u32 s29, 0
    s_cbranch_scc1 L_wiss
L_wiss_ok:

    s_cmp_lg_u32 s18, 5
    s_cbranch_scc1 L_nocpb

    s_getpc_b64 s[96:97]
L_pcb:
    s_add_u32 s96, s96, L_loader-L_pcb
    s_addc_u32 s97, s97, 0
    v_lshlrev_b32 v20, 3, v253
    v_mov_b32 v23, s97

    v_add_u32 v21, 0, v20
    v_min_u32 v21, L_end-L_loader, v21
    v_add_co_u32 v24, vcc, s96, v21
    s_nop 1
    v_addc_co_u32 v25, vcc, 0, v23, vcc
    global_load_dword v22, v[24:25], off sc1

    v_add_u32 v21, 8192, v20
    v_min_u32 v21, L_end-L_loader, v21
    v_add_co_u32 v26, vcc, s96, v21
    s_nop 1
    v_addc_co_u32 v27, vcc, 0, v23, vcc
    global_load_dword v22, v[26:27], off sc1

L_nocpb:

    s_sub_u32 s26, 8, s18
    s_cmp_eq_u32 s34, 0
    s_cselect_b32 s26, s18, s26
    s_lshl_b32 s26, s26, 2
    s_add_u32 s26, s26, s23
    s_lshl_b32 s27, s26, 9
    s_add_u32 s27, s27, s22
    s_mul_i32 s27, s27, 192
    s_cmp_lt_u32 s26, 2
    s_cselect_b64 vcc, s[58:59], 0
    v_mov_b32 v248, 1073741824
    s_sub_u32 s28, s27, 196608
    v_add_u32 v255, s28, v247
    v_cndmask_b32 v248, v255, v248, vcc
    v_add_u32 v255, -384, v248

    buffer_load_dwordx4 v[48:51], v255, s[4:7], s80 offen offset:0 sc1
    buffer_load_dwordx4 v[52:55], v255, s[4:7], s80 offen offset:192 sc1
    buffer_load_dwordx4 v[56:59], v248, s[4:7], 0 offen offset:0 sc1
    buffer_load_dwordx4 v[60:63], v248, s[4:7], 0 offen offset:192 sc1
    buffer_load_dwordx4 v[64:67], v248, s[4:7], 0 offen offset:384 sc1
    buffer_load_dwordx4 v[68:71], v248, s[4:7], 0 offen offset:576 sc1
    buffer_load_dwordx4 v[72:75], v248, s[4:7], 0 offen offset:768 sc1
    buffer_load_dwordx4 v[76:79], v248, s[4:7], 0 offen offset:960 sc1
    buffer_load_dwordx4 v[80:83], v248, s[4:7], 0 offen offset:1152 sc1
    buffer_load_dwordx4 v[84:87], v248, s[4:7], 0 offen offset:1344 sc1
    buffer_load_dwordx4 v[88:91], v248, s[4:7], 0 offen offset:1536 sc1
    buffer_load_dwordx4 v[92:95], v248, s[4:7], 0 offen offset:1728 sc1
    buffer_load_dwordx4 v[96:99], v248, s[4:7], 0 offen offset:1920 sc1
    buffer_load_dwordx4 v[100:103], v248, s[4:7], 0 offen offset:2112 sc1
    buffer_load_dwordx4 v[104:107], v248, s[4:7], 0 offen offset:2304 sc1
    buffer_load_dwordx4 v[108:111], v248, s[4:7], 0 offen offset:2496 sc1
    buffer_load_dwordx4 v[112:115], v248, s[4:7], 0 offen offset:2688 sc1
    buffer_load_dwordx4 v[116:119], v248, s[4:7], 0 offen offset:2880 sc1
    buffer_load_dwordx4 v[120:123], v248, s[4:7], 0 offen offset:3072 sc1
    buffer_load_dwordx4 v[124:127], v248, s[4:7], 0 offen offset:3264 sc1
    buffer_load_dwordx4 v[128:131], v248, s[4:7], 0 offen offset:3456 sc1
    buffer_load_dwordx4 v[132:135], v248, s[4:7], 0 offen offset:3648 sc1
    buffer_load_dwordx4 v[136:139], v248, s[4:7], s82 offen offset:0 sc1
    buffer_load_dwordx4 v[140:143], v248, s[4:7], s82 offen offset:192 sc1
    buffer_load_dwordx4 v[144:147], v248, s[4:7], s82 offen offset:384 sc1
    buffer_load_dwordx4 v[148:151], v248, s[4:7], s82 offen offset:576 sc1
    buffer_load_dwordx4 v[152:155], v248, s[4:7], s82 offen offset:768 sc1
    buffer_load_dwordx4 v[156:159], v248, s[4:7], s82 offen offset:960 sc1
    buffer_load_dwordx4 v[160:163], v248, s[4:7], s82 offen offset:1152 sc1
    buffer_load_dwordx4 v[164:167], v248, s[4:7], s82 offen offset:1344 sc1
    buffer_load_dwordx4 v[168:171], v248, s[4:7], s82 offen offset:1536 sc1
    buffer_load_dwordx4 v[172:175], v248, s[4:7], s82 offen offset:1728 sc1
    buffer_load_dwordx4 v[176:179], v248, s[4:7], s82 offen offset:1920 sc1
    buffer_load_dwordx4 v[180:183], v248, s[4:7], s82 offen offset:2112 sc1
    buffer_load_dwordx4 v[184:187], v248, s[4:7], s81 offen offset:2304 sc1
    buffer_load_dwordx4 v[188:191], v248, s[4:7], s81 offen offset:2496 sc1

    s_add_u32 s26, s18, 1
    v_mov_b32 v255, s26
    ds_write_b32 v254, v255

L_perm:
    s_mov_b32 exec_hi, 0x0000ffff
    s_waitcnt vmcnt(32)
    v_perm_b32 v192, v52, v48, s20
    v_perm_b32 v193, v60, v56, s20
    v_perm_b32 v194, v52, v48, s21
    v_perm_b32 v195, v60, v56, s21
    v_perm_b32 v196, v53, v49, s20
    v_perm_b32 v197, v61, v57, s20
    v_perm_b32 v198, v53, v49, s21
    v_perm_b32 v199, v61, v57, s21
    v_perm_b32 v200, v54, v50, s20
    v_perm_b32 v201, v62, v58, s20
    v_perm_b32 v202, v54, v50, s21
    v_perm_b32 v203, v62, v58, s21
    v_perm_b32 v204, v55, v51, s20
    v_perm_b32 v205, v63, v59, s20
    v_perm_b32 v206, v55, v51, s21
    v_perm_b32 v207, v63, v59, s21
    s_waitcnt vmcnt(28)
    v_perm_b32 v48, v68, v64, s20
    v_perm_b32 v49, v76, v72, s20
    v_perm_b32 v50, v68, v64, s21
    v_perm_b32 v51, v76, v72, s21
    v_perm_b32 v52, v69, v65, s20
    v_perm_b32 v53, v77, v73, s20
    v_perm_b32 v54, v69, v65, s21
    v_perm_b32 v55, v77, v73, s21
    v_perm_b32 v56, v70, v66, s20
    v_perm_b32 v57, v78, v74, s20
    v_perm_b32 v58, v70, v66, s21
    v_perm_b32 v59, v78, v74, s21
    v_perm_b32 v60, v71, v67, s20
    v_perm_b32 v61, v79, v75, s20
    v_perm_b32 v62, v71, v67, s21
    v_perm_b32 v63, v79, v75, s21
    s_waitcnt vmcnt(24)
    v_perm_b32 v64, v84, v80, s20
    v_perm_b32 v65, v92, v88, s20
    v_perm_b32 v66, v84, v80, s21
    v_perm_b32 v67, v92, v88, s21
    v_perm_b32 v68, v85, v81, s20
    v_perm_b32 v69, v93, v89, s20
    v_perm_b32 v70, v85, v81, s21
    v_perm_b32 v71, v93, v89, s21
    v_perm_b32 v72, v86, v82, s20
    v_perm_b32 v73, v94, v90, s20
    v_perm_b32 v74, v86, v82, s21
    v_perm_b32 v75, v94, v90, s21
    v_perm_b32 v76, v87, v83, s20
    v_perm_b32 v77, v95, v91, s20
    v_perm_b32 v78, v87, v83, s21
    v_perm_b32 v79, v95, v91, s21
    s_waitcnt vmcnt(20)
    v_perm_b32 v80, v100, v96, s20
    v_perm_b32 v81, v108, v104, s20
    v_perm_b32 v82, v100, v96, s21
    v_perm_b32 v83, v108, v104, s21
    v_perm_b32 v84, v101, v97, s20
    v_perm_b32 v85, v109, v105, s20
    v_perm_b32 v86, v101, v97, s21
    v_perm_b32 v87, v109, v105, s21
    v_perm_b32 v88, v102, v98, s20
    v_perm_b32 v89, v110, v106, s20
    v_perm_b32 v90, v102, v98, s21
    v_perm_b32 v91, v110, v106, s21
    v_perm_b32 v92, v103, v99, s20
    v_perm_b32 v93, v111, v107, s20
    v_perm_b32 v94, v103, v99, s21
    v_perm_b32 v95, v111, v107, s21
    s_waitcnt vmcnt(16)
    v_perm_b32 v96, v116, v112, s20
    v_perm_b32 v97, v124, v120, s20
    v_perm_b32 v98, v116, v112, s21
    v_perm_b32 v99, v124, v120, s21
    v_perm_b32 v100, v117, v113, s20
    v_perm_b32 v101, v125, v121, s20
    v_perm_b32 v102, v117, v113, s21
    v_perm_b32 v103, v125, v121, s21
    v_perm_b32 v104, v118, v114, s20
    v_perm_b32 v105, v126, v122, s20
    v_perm_b32 v106, v118, v114, s21
    v_perm_b32 v107, v126, v122, s21
    v_perm_b32 v108, v119, v115, s20
    v_perm_b32 v109, v127, v123, s20
    v_perm_b32 v110, v119, v115, s21
    v_perm_b32 v111, v127, v123, s21
    s_waitcnt vmcnt(12)
    v_perm_b32 v112, v132, v128, s20
    v_perm_b32 v113, v140, v136, s20
    v_perm_b32 v114, v132, v128, s21
    v_perm_b32 v115, v140, v136, s21
    v_perm_b32 v116, v133, v129, s20
    v_perm_b32 v117, v141, v137, s20
    v_perm_b32 v118, v133, v129, s21
    v_perm_b32 v119, v141, v137, s21
    v_perm_b32 v120, v134, v130, s20
    v_perm_b32 v121, v142, v138, s20
    v_perm_b32 v122, v134, v130, s21
    v_perm_b32 v123, v142, v138, s21
    v_perm_b32 v124, v135, v131, s20
    v_perm_b32 v125, v143, v139, s20
    v_perm_b32 v126, v135, v131, s21
    v_perm_b32 v127, v143, v139, s21
    s_waitcnt vmcnt(8)
    v_perm_b32 v128, v148, v144, s20
    v_perm_b32 v129, v156, v152, s20
    v_perm_b32 v130, v148, v144, s21
    v_perm_b32 v131, v156, v152, s21
    v_perm_b32 v132, v149, v145, s20
    v_perm_b32 v133, v157, v153, s20
    v_perm_b32 v134, v149, v145, s21
    v_perm_b32 v135, v157, v153, s21
    v_perm_b32 v136, v150, v146, s20
    v_perm_b32 v137, v158, v154, s20
    v_perm_b32 v138, v150, v146, s21
    v_perm_b32 v139, v158, v154, s21
    v_perm_b32 v140, v151, v147, s20
    v_perm_b32 v141, v159, v155, s20
    v_perm_b32 v142, v151, v147, s21
    v_perm_b32 v143, v159, v155, s21
    s_waitcnt vmcnt(4)
    v_perm_b32 v144, v164, v160, s20
    v_perm_b32 v145, v172, v168, s20
    v_perm_b32 v146, v164, v160, s21
    v_perm_b32 v147, v172, v168, s21
    v_perm_b32 v148, v165, v161, s20
    v_perm_b32 v149, v173, v169, s20
    v_perm_b32 v150, v165, v161, s21
    v_perm_b32 v151, v173, v169, s21
    v_perm_b32 v152, v166, v162, s20
    v_perm_b32 v153, v174, v170, s20
    v_perm_b32 v154, v166, v162, s21
    v_perm_b32 v155, v174, v170, s21
    v_perm_b32 v156, v167, v163, s20
    v_perm_b32 v157, v175, v171, s20
    v_perm_b32 v158, v167, v163, s21
    v_perm_b32 v159, v175, v171, s21
    s_waitcnt vmcnt(0)
    v_perm_b32 v160, v180, v176, s20
    v_perm_b32 v161, v188, v184, s20
    v_perm_b32 v162, v180, v176, s21
    v_perm_b32 v163, v188, v184, s21
    v_perm_b32 v164, v181, v177, s20
    v_perm_b32 v165, v189, v185, s20
    v_perm_b32 v166, v181, v177, s21
    v_perm_b32 v167, v189, v185, s21
    v_perm_b32 v168, v182, v178, s20
    v_perm_b32 v169, v190, v186, s20
    v_perm_b32 v170, v182, v178, s21
    v_perm_b32 v171, v190, v186, s21
    v_perm_b32 v172, v183, v179, s20
    v_perm_b32 v173, v191, v187, s20
    v_perm_b32 v174, v183, v179, s21
    v_perm_b32 v175, v191, v187, s21
    s_mov_b32 exec_hi, -1
    s_cmp_lg_u32 s18, 3
    s_cbranch_scc1 L_wt3_ok
    v_mov_b32 v254, 161968

    s_mov_b32 s29, 200000
L_wt3:
    ds_read_b32 v255, v254
    s_waitcnt lgkmcnt(0)
    v_cmp_eq_u32 vcc, 4, v255
    s_cmp_eq_u64 vcc, exec
    s_cbranch_scc1 L_wt3_ok
    s_sleep 2
    s_sub_u32 s29, s29, 1
    s_cmp_lg_u32 s29, 0
    s_cbranch_scc1 L_wt3
L_wt3_ok:

    s_lshr_b32 s26, 384, s18
    s_and_b32 s26, s26, 1
    s_add_u32 s26, s26, s18
    s_lshl_b32 s26, s26, 3
    s_add_u32 s26, s26, 161852

    v_add_u32 v254, s26, v240

    s_mov_b32 s29, 200000
L_wslot:
    ds_read_b32 v255, v254
    s_waitcnt lgkmcnt(0)
    v_cmp_ne_u32 vcc, 0, v255
    s_cmp_eq_u64 vcc, exec
    s_cbranch_scc1 L_wslot_ok
    s_sleep 2
    s_sub_u32 s29, s29, 1
    s_cmp_lg_u32 s29, 0
    s_cbranch_scc1 L_wslot
L_wslot_ok:

    s_lshl_b32 s30, s18, 1
    s_lshr_b32 s30, 149961, s30
    s_and_b32 s30, s30, 3
    s_cmp_eq_u32 s30, 3
    s_mul_i32 s30, s30, 14336
    s_cselect_b32 s31, 72704, s30
    s_cselect_b32 s30, 124160, s30
    s_add_u32 s30, s30, 7168
    s_add_u32 s31, s31, 72832

    v_add_u32 v254, s30, v249
    v_add_u32 v255, s31, v249
    v_cndmask_b32 v254, v255, v254, s[58:59]
    s_mov_b32 exec_hi, 0x0000ffff

    ds_write_b64 v254, v[192:193] offset:0
    ds_write_b64 v254, v[194:195] offset:72
    ds_write_b64 v254, v[196:197] offset:144
    ds_write_b64 v254, v[198:199] offset:216
    ds_write_b64 v254, v[200:201] offset:288
    ds_write_b64 v254, v[202:203] offset:360
    ds_write_b64 v254, v[204:205] offset:432
    ds_write_b64 v254, v[206:207] offset:504
    ds_write_b64 v254, v[48:49] offset:8
    ds_write_b64 v254, v[50:51] offset:80
    ds_write_b64 v254, v[52:53] offset:152
    ds_write_b64 v254, v[54:55] offset:224
    ds_write_b64 v254, v[56:57] offset:296
    ds_write_b64 v254, v[58:59] offset:368
    ds_write_b64 v254, v[60:61] offset:440
    ds_write_b64 v254, v[62:63] offset:512
    ds_write_b64 v254, v[64:65] offset:16
    ds_write_b64 v254, v[66:67] offset:88
    ds_write_b64 v254, v[68:69] offset:160
    ds_write_b64 v254, v[70:71] offset:232
    ds_write_b64 v254, v[72:73] offset:304
    ds_write_b64 v254, v[74:75] offset:376
    ds_write_b64 v254, v[76:77] offset:448
    ds_write_b64 v254, v[78:79] offset:520
    ds_write_b64 v254, v[80:81] offset:24
    ds_write_b64 v254, v[82:83] offset:96
    ds_write_b64 v254, v[84:85] offset:168
    ds_write_b64 v254, v[86:87] offset:240
    ds_write_b64 v254, v[88:89] offset:312
    ds_write_b64 v254, v[90:91] offset:384
    ds_write_b64 v254, v[92:93] offset:456
    ds_write_b64 v254, v[94:95] offset:528
    ds_write_b64 v254, v[96:97] offset:32
    ds_write_b64 v254, v[98:99] offset:104
    ds_write_b64 v254, v[100:101] offset:176
    ds_write_b64 v254, v[102:103] offset:248
    ds_write_b64 v254, v[104:105] offset:320
    ds_write_b64 v254, v[106:107] offset:392
    ds_write_b64 v254, v[108:109] offset:464
    ds_write_b64 v254, v[110:111] offset:536
    ds_write_b64 v254, v[112:113] offset:40
    ds_write_b64 v254, v[114:115] offset:112
    ds_write_b64 v254, v[116:117] offset:184
    ds_write_b64 v254, v[118:119] offset:256
    ds_write_b64 v254, v[120:121] offset:328
    ds_write_b64 v254, v[122:123] offset:400
    ds_write_b64 v254, v[124:125] offset:472
    ds_write_b64 v254, v[126:127] offset:544
    ds_write_b64 v254, v[128:129] offset:48
    ds_write_b64 v254, v[130:131] offset:120
    ds_write_b64 v254, v[132:133] offset:192
    ds_write_b64 v254, v[134:135] offset:264
    ds_write_b64 v254, v[136:137] offset:336
    ds_write_b64 v254, v[138:139] offset:408
    ds_write_b64 v254, v[140:141] offset:480
    ds_write_b64 v254, v[142:143] offset:552
    ds_write_b64 v254, v[144:145] offset:56
    ds_write_b64 v254, v[146:147] offset:128
    ds_write_b64 v254, v[148:149] offset:200
    ds_write_b64 v254, v[150:151] offset:272
    ds_write_b64 v254, v[152:153] offset:344
    ds_write_b64 v254, v[154:155] offset:416
    ds_write_b64 v254, v[156:157] offset:488
    ds_write_b64 v254, v[158:159] offset:560
    ds_write_b64 v254, v[160:161] offset:64
    ds_write_b64 v254, v[162:163] offset:136
    ds_write_b64 v254, v[164:165] offset:208
    ds_write_b64 v254, v[166:167] offset:280
    ds_write_b64 v254, v[168:169] offset:352
    ds_write_b64 v254, v[170:171] offset:424
    ds_write_b64 v254, v[172:173] offset:496
    ds_write_b64 v254, v[174:175] offset:568

    s_mov_b32 exec_hi, -1
    s_lshl_b32 s26, s18, 2
    s_add_u32 s26, s26, 161808
    v_mov_b32 v254, s26
    v_mov_b32 v255, 1
    s_waitcnt lgkmcnt(0)
    ds_write_b32 v254, v255
    s_cmp_eq_u32 s18, 8
    s_cbranch_scc1 L_loader

    s_setprio 0
L_hp1:
    s_add_u32 s27, s18, 1

    s_lshl_b32 s32, s27, 1
    s_lshr_b32 s32, 149961, s32
    s_and_b32 s32, s32, 3
    s_cmp_eq_u32 s32, 3
    s_mul_i32 s32, s32, 14336
    s_cselect_b32 s33, 72704, s32
    s_cselect_b32 s32, 124160, s32
    s_add_u32 s32, s32, 7168
    s_add_u32 s33, s33, 72832

    v_add_u32 v232, s30, v250
    v_add_u32 v233, s31, v250
    v_add_u32 v234, s32, v250
    v_add_u32 v235, s33, v250
    v_cndmask_b32 v244, v232, v233, s[56:57]
    v_cndmask_b32 v245, v233, v234, s[56:57]
    v_cndmask_b32 v246, v234, v235, s[56:57]
    v_mov_b32 v254, 161968

    s_mov_b32 s29, 200000
L_wt:
    ds_read_b32 v255, v254
    s_waitcnt lgkmcnt(0)
    v_cmp_eq_u32 vcc, 4, v255
    s_cmp_eq_u64 vcc, exec
    s_cbranch_scc1 L_wt_ok
    s_sleep 2
    s_sub_u32 s29, s29, 1
    s_cmp_lg_u32 s29, 0
    s_cbranch_scc1 L_wt
L_wt_ok:

    ds_read_b128 v[192:195], v241 offset:0
    ds_read_b64 v[212:213], v244 offset:0
    ds_read_b64 v[214:215], v244 offset:8
    ds_read_b128 v[196:199], v241 offset:320
    ds_read_b64 v[216:217], v244 offset:72
    ds_read_b64 v[218:219], v244 offset:80
    ds_read_b128 v[200:203], v241 offset:640
    ds_read_b64 v[220:221], v244 offset:144
    ds_read_b64 v[222:223], v244 offset:152
    ds_read_b128 v[204:207], v241 offset:960
    ds_read_b64 v[224:225], v244 offset:216
    ds_read_b64 v[226:227], v244 offset:224
    ds_read_b128 v[208:211], v241 offset:1280
    ds_read_b64 v[228:229], v244 offset:288
    ds_read_b64 v[230:231], v244 offset:296
    s_waitcnt lgkmcnt(9)
    v_mfma_f32_16x16x32_bf16 v[0:3], v[192:195], v[212:215], 0
    ds_read_b128 v[192:195], v241 offset:1600
    ds_read_b64 v[212:213], v244 offset:360
    ds_read_b64 v[214:215], v244 offset:368
    v_mfma_f32_16x16x32_bf16 v[4:7], v[196:199], v[216:219], 0
    ds_read_b128 v[196:199], v241 offset:1920
    ds_read_b64 v[216:217], v244 offset:432
    ds_read_b64 v[218:219], v244 offset:440
    s_waitcnt lgkmcnt(9)
    v_mfma_f32_16x16x32_bf16 v[8:11], v[200:203], v[220:223], 0
    ds_read_b128 v[200:203], v241 offset:2240
    ds_read_b64 v[220:221], v244 offset:504
    ds_read_b64 v[222:223], v244 offset:512
    v_mfma_f32_16x16x32_bf16 v[12:15], v[204:207], v[224:227], 0
    ds_read_b128 v[204:207], v241 offset:2560
    ds_read_b64 v[224:225], v244 offset:584
    ds_read_b64 v[226:227], v244 offset:592
    s_waitcnt lgkmcnt(9)
    v_mfma_f32_16x16x32_bf16 v[16:19], v[208:211], v[228:231], 0
    ds_read_b128 v[208:211], v241 offset:2880
    ds_read_b64 v[228:229], v244 offset:656
    ds_read_b64 v[230:231], v244 offset:664
    v_mfma_f32_16x16x32_bf16 v[20:23], v[192:195], v[212:215], 0
    ds_read_b128 v[192:195], v241 offset:3200
    ds_read_b64 v[212:213], v244 offset:728
    ds_read_b64 v[214:215], v244 offset:736
    s_waitcnt lgkmcnt(9)
    v_mfma_f32_16x16x32_bf16 v[24:27], v[196:199], v[216:219], 0
    ds_read_b128 v[196:199], v241 offset:3520
    ds_read_b64 v[216:217], v244 offset:800
    ds_read_b64 v[218:219], v244 offset:808
    v_mfma_f32_16x16x32_bf16 v[28:31], v[200:203], v[220:223], 0
    ds_read_b128 v[200:203], v241 offset:3840
    ds_read_b64 v[220:221], v244 offset:872
    ds_read_b64 v[222:223], v244 offset:880
    s_waitcnt lgkmcnt(9)
    v_mfma_f32_16x16x32_bf16 v[32:35], v[204:207], v[224:227], 0
    ds_read_b128 v[204:207], v241 offset:4160
    ds_read_b64 v[224:225], v244 offset:944
    ds_read_b64 v[226:227], v244 offset:952
    v_mfma_f32_16x16x32_bf16 v[36:39], v[208:211], v[228:231], 0
    ds_read_b128 v[208:211], v241 offset:4480
    ds_read_b64 v[228:229], v244 offset:1016
    ds_read_b64 v[230:231], v244 offset:1024
    s_waitcnt lgkmcnt(9)
    v_mfma_f32_16x16x32_bf16 v[40:43], v[192:195], v[212:215], 0
    ds_read_b128 v[192:195], v241 offset:4800
    ds_read_b64 v[212:213], v244 offset:1088
    ds_read_b64 v[214:215], v244 offset:1096
    v_mfma_f32_16x16x32_bf16 v[44:47], v[196:199], v[216:219], 0
    ds_read_b128 v[196:199], v241 offset:5120
    ds_read_b64 v[216:217], v244 offset:2336
    ds_read_b64 v[218:219], v244 offset:2344
    s_waitcnt lgkmcnt(9)
    v_mfma_f32_16x16x32_bf16 v[48:51], v[200:203], v[220:223], 0
    ds_read_b128 v[200:203], v241 offset:5440
    ds_read_b64 v[220:221], v244 offset:2408
    ds_read_b64 v[222:223], v244 offset:2416
    v_mfma_f32_16x16x32_bf16 v[52:55], v[204:207], v[224:227], 0
    ds_read_b128 v[204:207], v241 offset:5760
    ds_read_b64 v[224:225], v244 offset:2480
    ds_read_b64 v[226:227], v244 offset:2488
    s_waitcnt lgkmcnt(9)
    v_mfma_f32_16x16x32_bf16 v[56:59], v[208:211], v[228:231], 0
    ds_read_b128 v[208:211], v241 offset:6080
    ds_read_b64 v[228:229], v244 offset:2552
    ds_read_b64 v[230:231], v244 offset:2560
    v_mfma_f32_16x16x32_bf16 v[60:63], v[192:195], v[212:215], 0
    ds_read_b128 v[192:195], v241 offset:6400
    ds_read_b64 v[212:213], v244 offset:2624
    ds_read_b64 v[214:215], v244 offset:2632
    s_waitcnt lgkmcnt(9)
    v_mfma_f32_16x16x32_bf16 v[64:67], v[196:199], v[216:219], 0
    ds_read_b128 v[196:199], v241 offset:6720
    ds_read_b64 v[216:217], v244 offset:2696
    ds_read_b64 v[218:219], v244 offset:2704
    v_mfma_f32_16x16x32_bf16 v[68:71], v[200:203], v[220:223], 0
    ds_read_b128 v[200:203], v241 offset:7040
    ds_read_b64 v[220:221], v244 offset:2768
    ds_read_b64 v[222:223], v244 offset:2776
    s_waitcnt lgkmcnt(9)
    v_mfma_f32_16x16x32_bf16 v[72:75], v[204:207], v[224:227], 0
    ds_read_b128 v[204:207], v241 offset:7360
    ds_read_b64 v[224:225], v244 offset:2840
    ds_read_b64 v[226:227], v244 offset:2848
    v_mfma_f32_16x16x32_bf16 v[76:79], v[208:211], v[228:231], 0
    ds_read_b128 v[208:211], v241 offset:7680
    ds_read_b64 v[228:229], v244 offset:2920
    ds_read_b64 v[230:231], v244 offset:2928
    s_waitcnt lgkmcnt(9)
    v_mfma_f32_16x16x32_bf16 v[80:83], v[192:195], v[212:215], 0
    ds_read_b128 v[192:195], v241 offset:8000
    ds_read_b64 v[212:213], v244 offset:2992
    ds_read_b64 v[214:215], v244 offset:3000
    v_mfma_f32_16x16x32_bf16 v[84:87], v[196:199], v[216:219], 0
    ds_read_b128 v[196:199], v241 offset:8320
    ds_read_b64 v[216:217], v244 offset:3064
    ds_read_b64 v[218:219], v244 offset:3072
    s_waitcnt lgkmcnt(9)
    v_mfma_f32_16x16x32_bf16 v[88:91], v[200:203], v[220:223], 0
    ds_read_b128 v[200:203], v241 offset:8640
    ds_read_b64 v[220:221], v244 offset:3136
    ds_read_b64 v[222:223], v244 offset:3144
    v_mfma_f32_16x16x32_bf16 v[92:95], v[204:207], v[224:227], 0
    ds_read_b128 v[204:207], v241 offset:8960
    ds_read_b64 v[224:225], v244 offset:3208
    ds_read_b64 v[226:227], v244 offset:3216
    s_waitcnt lgkmcnt(9)
    v_mfma_f32_16x16x32_bf16 v[96:99], v[208:211], v[228:231], 0
    ds_read_b128 v[208:211], v241 offset:9280
    ds_read_b64 v[228:229], v244 offset:3280
    ds_read_b64 v[230:231], v244 offset:3288
    v_mfma_f32_16x16x32_bf16 v[100:103], v[192:195], v[212:215], 0
    ds_read_b128 v[192:195], v241 offset:9600
    ds_read_b64 v[212:213], v244 offset:3352
    ds_read_b64 v[214:215], v244 offset:3360
    s_waitcnt lgkmcnt(9)
    v_mfma_f32_16x16x32_bf16 v[104:107], v[196:199], v[216:219], 0
    ds_read_b128 v[196:199], v241 offset:9920
    ds_read_b64 v[216:217], v244 offset:3424
    ds_read_b64 v[218:219], v244 offset:3432
    v_mfma_f32_16x16x32_bf16 v[108:111], v[200:203], v[220:223], 0
    ds_read_b128 v[200:203], v241 offset:10240
    ds_read_b64 v[220:221], v244 offset:4672
    ds_read_b64 v[222:223], v244 offset:4680
    s_waitcnt lgkmcnt(9)
    v_mfma_f32_16x16x32_bf16 v[112:115], v[204:207], v[224:227], 0
    ds_read_b128 v[204:207], v241 offset:10560
    ds_read_b64 v[224:225], v244 offset:4744
    ds_read_b64 v[226:227], v244 offset:4752
    v_mfma_f32_16x16x32_bf16 v[116:119], v[208:211], v[228:231], 0
    ds_read_b128 v[208:211], v241 offset:10880
    ds_read_b64 v[228:229], v244 offset:4816
    ds_read_b64 v[230:231], v244 offset:4824
    s_waitcnt lgkmcnt(9)
    v_mfma_f32_16x16x32_bf16 v[120:123], v[192:195], v[212:215], 0
    ds_read_b128 v[192:195], v241 offset:11200
    ds_read_b64 v[212:213], v244 offset:4888
    ds_read_b64 v[214:215], v244 offset:4896
    v_mfma_f32_16x16x32_bf16 v[124:127], v[196:199], v[216:219], 0
    ds_read_b128 v[196:199], v241 offset:11520
    ds_read_b64 v[216:217], v244 offset:4960
    ds_read_b64 v[218:219], v244 offset:4968
    s_waitcnt lgkmcnt(9)
    v_mfma_f32_16x16x32_bf16 v[128:131], v[200:203], v[220:223], 0
    ds_read_b128 v[200:203], v241 offset:11840
    ds_read_b64 v[220:221], v244 offset:5032
    ds_read_b64 v[222:223], v244 offset:5040
    v_mfma_f32_16x16x32_bf16 v[132:135], v[204:207], v[224:227], 0
    ds_read_b128 v[204:207], v241 offset:12160
    ds_read_b64 v[224:225], v244 offset:5104
    ds_read_b64 v[226:227], v244 offset:5112
    s_waitcnt lgkmcnt(9)
    v_mfma_f32_16x16x32_bf16 v[136:139], v[208:211], v[228:231], 0
    ds_read_b128 v[208:211], v241 offset:12480
    ds_read_b64 v[228:229], v244 offset:5176
    ds_read_b64 v[230:231], v244 offset:5184
    v_mfma_f32_16x16x32_bf16 v[140:143], v[192:195], v[212:215], 0
    ds_read_b128 v[192:195], v241 offset:12800
    ds_read_b64 v[212:213], v244 offset:5256
    ds_read_b64 v[214:215], v244 offset:5264
    s_waitcnt lgkmcnt(9)
    v_mfma_f32_16x16x32_bf16 v[144:147], v[196:199], v[216:219], 0
    ds_read_b128 v[196:199], v241 offset:13120
    ds_read_b64 v[216:217], v244 offset:5328
    ds_read_b64 v[218:219], v244 offset:5336
    v_mfma_f32_16x16x32_bf16 v[148:151], v[200:203], v[220:223], 0
    ds_read_b128 v[200:203], v241 offset:13440
    ds_read_b64 v[220:221], v244 offset:5400
    ds_read_b64 v[222:223], v244 offset:5408
    s_waitcnt lgkmcnt(9)
    v_mfma_f32_16x16x32_bf16 v[152:155], v[204:207], v[224:227], 0
    ds_read_b128 v[204:207], v241 offset:13760
    ds_read_b64 v[224:225], v244 offset:5472
    ds_read_b64 v[226:227], v244 offset:5480
    v_mfma_f32_16x16x32_bf16 v[156:159], v[208:211], v[228:231], 0
    ds_read_b128 v[208:211], v241 offset:14080
    ds_read_b64 v[228:229], v244 offset:5544
    ds_read_b64 v[230:231], v244 offset:5552
    s_waitcnt lgkmcnt(9)
    v_mfma_f32_16x16x32_bf16 v[160:163], v[192:195], v[212:215], 0
    ds_read_b128 v[192:195], v241 offset:14400
    ds_read_b64 v[212:213], v244 offset:5616
    ds_read_b64 v[214:215], v244 offset:5624
    v_mfma_f32_16x16x32_bf16 v[164:167], v[196:199], v[216:219], 0
    ds_read_b128 v[196:199], v241 offset:14720
    ds_read_b64 v[216:217], v244 offset:5688
    ds_read_b64 v[218:219], v244 offset:5696
    s_waitcnt lgkmcnt(9)
    v_mfma_f32_16x16x32_bf16 v[168:171], v[200:203], v[220:223], 0
    ds_read_b128 v[200:203], v241 offset:15040
    ds_read_b64 v[220:221], v244 offset:5760
    ds_read_b64 v[222:223], v244 offset:5768
    v_mfma_f32_16x16x32_bf16 v[172:175], v[204:207], v[224:227], 0
    v_add_u32 v254, s26, v240

    s_mov_b32 s29, 200000
L_wrdy:
    ds_read_b32 v255, v254
    s_waitcnt lgkmcnt(0)
    v_cmp_ne_u32 vcc, 0, v255
    s_cmp_eq_u64 vcc, exec
    s_cbranch_scc1 L_wrdy_ok
    s_sleep 2
    s_sub_u32 s29, s29, 1
    s_cmp_lg_u32 s29, 0
    s_cbranch_scc1 L_wrdy
L_wrdy_ok:

    s_lshl_b32 s26, s16, 3
    s_add_u32 s26, s26, 161888
    v_mov_b32 v254, s26
    v_mov_b32 v255, 1

    ds_read_b128 v[204:207], v242 offset:0
    ds_read_b64 v[224:225], v245 offset:0
    ds_read_b64 v[226:227], v245 offset:8
    s_waitcnt lgkmcnt(9)
    v_mfma_f32_16x16x32_bf16 v[176:179], v[208:211], v[228:231], 0
    ds_read_b128 v[208:211], v242 offset:320
    ds_read_b64 v[228:229], v245 offset:72
    ds_read_b64 v[230:231], v245 offset:80
    v_mfma_f32_16x16x32_bf16 v[180:183], v[192:195], v[212:215], 0
    ds_read_b128 v[192:195], v242 offset:640
    ds_read_b64 v[212:213], v245 offset:144
    ds_read_b64 v[214:215], v245 offset:152
    s_waitcnt lgkmcnt(9)
    v_mfma_f32_16x16x32_bf16 v[184:187], v[196:199], v[216:219], 0
    ds_read_b128 v[196:199], v242 offset:960
    ds_read_b64 v[216:217], v245 offset:216
    ds_read_b64 v[218:219], v245 offset:224
    v_mfma_f32_16x16x32_bf16 v[188:191], v[200:203], v[220:223], 0
    ds_read_b128 v[200:203], v242 offset:1280
    ds_read_b64 v[220:221], v245 offset:288
    ds_read_b64 v[222:223], v245 offset:296
    s_waitcnt lgkmcnt(9)
    v_mfma_f32_16x16x32_bf16 v[0:3], v[204:207], v[224:227], v[0:3]
    ds_read_b128 v[204:207], v242 offset:1600
    ds_read_b64 v[224:225], v245 offset:360
    ds_read_b64 v[226:227], v245 offset:368
    v_mfma_f32_16x16x32_bf16 v[4:7], v[208:211], v[228:231], v[4:7]
    ds_read_b128 v[208:211], v242 offset:1920
    ds_read_b64 v[228:229], v245 offset:432
    ds_read_b64 v[230:231], v245 offset:440
    s_waitcnt lgkmcnt(9)
    v_mfma_f32_16x16x32_bf16 v[8:11], v[192:195], v[212:215], v[8:11]
    ds_read_b128 v[192:195], v242 offset:2240
    ds_read_b64 v[212:213], v245 offset:504
    ds_read_b64 v[214:215], v245 offset:512
    v_mfma_f32_16x16x32_bf16 v[12:15], v[196:199], v[216:219], v[12:15]
    ds_read_b128 v[196:199], v242 offset:2560
    ds_read_b64 v[216:217], v245 offset:584
    ds_read_b64 v[218:219], v245 offset:592
    s_waitcnt lgkmcnt(9)
    v_mfma_f32_16x16x32_bf16 v[16:19], v[200:203], v[220:223], v[16:19]
    ds_read_b128 v[200:203], v242 offset:2880
    ds_read_b64 v[220:221], v245 offset:656
    ds_read_b64 v[222:223], v245 offset:664
    v_mfma_f32_16x16x32_bf16 v[20:23], v[204:207], v[224:227], v[20:23]
    ds_read_b128 v[204:207], v242 offset:3200
    ds_read_b64 v[224:225], v245 offset:728
    ds_read_b64 v[226:227], v245 offset:736
    s_waitcnt lgkmcnt(9)
    v_mfma_f32_16x16x32_bf16 v[24:27], v[208:211], v[228:231], v[24:27]
    ds_read_b128 v[208:211], v242 offset:3520
    ds_read_b64 v[228:229], v245 offset:800
    ds_read_b64 v[230:231], v245 offset:808
    v_mfma_f32_16x16x32_bf16 v[28:31], v[192:195], v[212:215], v[28:31]
    ds_read_b128 v[192:195], v242 offset:3840
    ds_read_b64 v[212:213], v245 offset:872
    ds_read_b64 v[214:215], v245 offset:880
    s_waitcnt lgkmcnt(9)
    v_mfma_f32_16x16x32_bf16 v[32:35], v[196:199], v[216:219], v[32:35]
    ds_read_b128 v[196:199], v242 offset:4160
    ds_read_b64 v[216:217], v245 offset:944
    ds_read_b64 v[218:219], v245 offset:952
    v_mfma_f32_16x16x32_bf16 v[36:39], v[200:203], v[220:223], v[36:39]
    ds_read_b128 v[200:203], v242 offset:4480
    ds_read_b64 v[220:221], v245 offset:1016
    ds_read_b64 v[222:223], v245 offset:1024
    s_waitcnt lgkmcnt(9)
    v_mfma_f32_16x16x32_bf16 v[40:43], v[204:207], v[224:227], v[40:43]
    ds_read_b128 v[204:207], v242 offset:4800
    ds_read_b64 v[224:225], v245 offset:1088
    ds_read_b64 v[226:227], v245 offset:1096
    v_mfma_f32_16x16x32_bf16 v[44:47], v[208:211], v[228:231], v[44:47]
    ds_read_b128 v[208:211], v242 offset:5120
    ds_read_b64 v[228:229], v245 offset:2336
    ds_read_b64 v[230:231], v245 offset:2344
    s_waitcnt lgkmcnt(9)
    v_mfma_f32_16x16x32_bf16 v[48:51], v[192:195], v[212:215], v[48:51]
    ds_read_b128 v[192:195], v242 offset:5440
    ds_read_b64 v[212:213], v245 offset:2408
    ds_read_b64 v[214:215], v245 offset:2416
    v_mfma_f32_16x16x32_bf16 v[52:55], v[196:199], v[216:219], v[52:55]
    ds_read_b128 v[196:199], v242 offset:5760
    ds_read_b64 v[216:217], v245 offset:2480
    ds_read_b64 v[218:219], v245 offset:2488
    s_waitcnt lgkmcnt(9)
    v_mfma_f32_16x16x32_bf16 v[56:59], v[200:203], v[220:223], v[56:59]
    ds_read_b128 v[200:203], v242 offset:6080
    ds_read_b64 v[220:221], v245 offset:2552
    ds_read_b64 v[222:223], v245 offset:2560
    v_mfma_f32_16x16x32_bf16 v[60:63], v[204:207], v[224:227], v[60:63]
    ds_read_b128 v[204:207], v242 offset:6400
    ds_read_b64 v[224:225], v245 offset:2624
    ds_read_b64 v[226:227], v245 offset:2632
    s_waitcnt lgkmcnt(9)
    v_mfma_f32_16x16x32_bf16 v[64:67], v[208:211], v[228:231], v[64:67]
    ds_read_b128 v[208:211], v242 offset:6720
    ds_read_b64 v[228:229], v245 offset:2696
    ds_read_b64 v[230:231], v245 offset:2704
    v_mfma_f32_16x16x32_bf16 v[68:71], v[192:195], v[212:215], v[68:71]
    ds_read_b128 v[192:195], v242 offset:7040
    ds_read_b64 v[212:213], v245 offset:2768
    ds_read_b64 v[214:215], v245 offset:2776
    s_waitcnt lgkmcnt(9)
    v_mfma_f32_16x16x32_bf16 v[72:75], v[196:199], v[216:219], v[72:75]
    ds_read_b128 v[196:199], v242 offset:7360
    ds_read_b64 v[216:217], v245 offset:2840
    ds_read_b64 v[218:219], v245 offset:2848
    v_mfma_f32_16x16x32_bf16 v[76:79], v[200:203], v[220:223], v[76:79]
    ds_read_b128 v[200:203], v242 offset:7680
    ds_read_b64 v[220:221], v245 offset:2920
    ds_read_b64 v[222:223], v245 offset:2928
    s_waitcnt lgkmcnt(9)
    v_mfma_f32_16x16x32_bf16 v[80:83], v[204:207], v[224:227], v[80:83]
    ds_read_b128 v[204:207], v242 offset:8000
    ds_read_b64 v[224:225], v245 offset:2992
    ds_read_b64 v[226:227], v245 offset:3000
    v_mfma_f32_16x16x32_bf16 v[84:87], v[208:211], v[228:231], v[84:87]
    ds_read_b128 v[208:211], v242 offset:8320
    ds_read_b64 v[228:229], v245 offset:3064
    ds_read_b64 v[230:231], v245 offset:3072
    s_waitcnt lgkmcnt(9)
    v_mfma_f32_16x16x32_bf16 v[88:91], v[192:195], v[212:215], v[88:91]
    ds_read_b128 v[192:195], v242 offset:8640
    ds_read_b64 v[212:213], v245 offset:3136
    ds_read_b64 v[214:215], v245 offset:3144
    v_mfma_f32_16x16x32_bf16 v[92:95], v[196:199], v[216:219], v[92:95]
    ds_read_b128 v[196:199], v242 offset:8960
    ds_read_b64 v[216:217], v245 offset:3208
    ds_read_b64 v[218:219], v245 offset:3216
    s_waitcnt lgkmcnt(9)
    v_mfma_f32_16x16x32_bf16 v[96:99], v[200:203], v[220:223], v[96:99]
    ds_read_b128 v[200:203], v242 offset:9280
    ds_read_b64 v[220:221], v245 offset:3280
    ds_read_b64 v[222:223], v245 offset:3288
    v_mfma_f32_16x16x32_bf16 v[100:103], v[204:207], v[224:227], v[100:103]
    ds_read_b128 v[204:207], v242 offset:9600
    ds_read_b64 v[224:225], v245 offset:3352
    ds_read_b64 v[226:227], v245 offset:3360
    s_waitcnt lgkmcnt(9)
    v_mfma_f32_16x16x32_bf16 v[104:107], v[208:211], v[228:231], v[104:107]
    ds_read_b128 v[208:211], v242 offset:9920
    ds_read_b64 v[228:229], v245 offset:3424
    ds_read_b64 v[230:231], v245 offset:3432
    v_mfma_f32_16x16x32_bf16 v[108:111], v[192:195], v[212:215], v[108:111]
    ds_read_b128 v[192:195], v242 offset:10240
    ds_read_b64 v[212:213], v245 offset:4672
    ds_read_b64 v[214:215], v245 offset:4680
    s_waitcnt lgkmcnt(9)
    v_mfma_f32_16x16x32_bf16 v[112:115], v[196:199], v[216:219], v[112:115]
    ds_read_b128 v[196:199], v242 offset:10560
    ds_read_b64 v[216:217], v245 offset:4744
    ds_read_b64 v[218:219], v245 offset:4752
    v_mfma_f32_16x16x32_bf16 v[116:119], v[200:203], v[220:223], v[116:119]
    ds_read_b128 v[200:203], v242 offset:10880
    ds_read_b64 v[220:221], v245 offset:4816
    ds_read_b64 v[222:223], v245 offset:4824
    s_waitcnt lgkmcnt(9)
    v_mfma_f32_16x16x32_bf16 v[120:123], v[204:207], v[224:227], v[120:123]
    ds_read_b128 v[204:207], v242 offset:11200
    ds_read_b64 v[224:225], v245 offset:4888
    ds_read_b64 v[226:227], v245 offset:4896
    v_mfma_f32_16x16x32_bf16 v[124:127], v[208:211], v[228:231], v[124:127]
    ds_read_b128 v[208:211], v242 offset:11520
    ds_read_b64 v[228:229], v245 offset:4960
    ds_read_b64 v[230:231], v245 offset:4968
    s_waitcnt lgkmcnt(9)
    v_mfma_f32_16x16x32_bf16 v[128:131], v[192:195], v[212:215], v[128:131]
    ds_read_b128 v[192:195], v242 offset:11840
    ds_read_b64 v[212:213], v245 offset:5032
    ds_read_b64 v[214:215], v245 offset:5040
    v_mfma_f32_16x16x32_bf16 v[132:135], v[196:199], v[216:219], v[132:135]
    ds_read_b128 v[196:199], v242 offset:12160
    ds_read_b64 v[216:217], v245 offset:5104
    ds_read_b64 v[218:219], v245 offset:5112
    s_waitcnt lgkmcnt(9)
    v_mfma_f32_16x16x32_bf16 v[136:139], v[200:203], v[220:223], v[136:139]
    ds_read_b128 v[200:203], v242 offset:12480
    ds_read_b64 v[220:221], v245 offset:5176
    ds_read_b64 v[222:223], v245 offset:5184
    v_mfma_f32_16x16x32_bf16 v[140:143], v[204:207], v[224:227], v[140:143]
    ds_read_b128 v[204:207], v242 offset:12800
    ds_read_b64 v[224:225], v245 offset:5256
    ds_read_b64 v[226:227], v245 offset:5264
    s_waitcnt lgkmcnt(9)
    v_mfma_f32_16x16x32_bf16 v[144:147], v[208:211], v[228:231], v[144:147]
    ds_read_b128 v[208:211], v242 offset:13120
    ds_read_b64 v[228:229], v245 offset:5328
    ds_read_b64 v[230:231], v245 offset:5336
    v_mfma_f32_16x16x32_bf16 v[148:151], v[192:195], v[212:215], v[148:151]
    ds_read_b128 v[192:195], v242 offset:13440
    ds_read_b64 v[212:213], v245 offset:5400
    ds_read_b64 v[214:215], v245 offset:5408
    s_waitcnt lgkmcnt(9)
    v_mfma_f32_16x16x32_bf16 v[152:155], v[196:199], v[216:219], v[152:155]
    ds_read_b128 v[196:199], v242 offset:13760
    ds_read_b64 v[216:217], v245 offset:5472
    ds_read_b64 v[218:219], v245 offset:5480
    v_mfma_f32_16x16x32_bf16 v[156:159], v[200:203], v[220:223], v[156:159]
    ds_read_b128 v[200:203], v242 offset:14080
    ds_read_b64 v[220:221], v245 offset:5544
    ds_read_b64 v[222:223], v245 offset:5552
    s_waitcnt lgkmcnt(9)
    v_mfma_f32_16x16x32_bf16 v[160:163], v[204:207], v[224:227], v[160:163]
    ds_read_b128 v[204:207], v242 offset:14400
    ds_read_b64 v[224:225], v245 offset:5616
    ds_read_b64 v[226:227], v245 offset:5624
    v_mfma_f32_16x16x32_bf16 v[164:167], v[208:211], v[228:231], v[164:167]
    ds_read_b128 v[208:211], v242 offset:14720
    ds_read_b64 v[228:229], v245 offset:5688
    ds_read_b64 v[230:231], v245 offset:5696
    s_waitcnt lgkmcnt(9)
    v_mfma_f32_16x16x32_bf16 v[168:171], v[192:195], v[212:215], v[168:171]
    ds_read_b128 v[192:195], v242 offset:15040
    ds_read_b64 v[212:213], v245 offset:5760
    ds_read_b64 v[214:215], v245 offset:5768
    v_mfma_f32_16x16x32_bf16 v[172:175], v[196:199], v[216:219], v[172:175]
    ds_read_b128 v[196:199], v243 offset:0
    ds_read_b64 v[216:217], v246 offset:0
    ds_read_b64 v[218:219], v246 offset:8
    s_waitcnt lgkmcnt(9)
    v_mfma_f32_16x16x32_bf16 v[176:179], v[200:203], v[220:223], v[176:179]
    ds_read_b128 v[200:203], v243 offset:320
    ds_read_b64 v[220:221], v246 offset:72
    ds_read_b64 v[222:223], v246 offset:80
    v_mfma_f32_16x16x32_bf16 v[180:183], v[204:207], v[224:227], v[180:183]
    ds_read_b128 v[204:207], v243 offset:640
    ds_read_b64 v[224:225], v246 offset:144
    ds_read_b64 v[226:227], v246 offset:152
    s_waitcnt lgkmcnt(9)
    v_mfma_f32_16x16x32_bf16 v[184:187], v[208:211], v[228:231], v[184:187]
    ds_read_b128 v[208:211], v243 offset:960
    ds_read_b64 v[228:229], v246 offset:216
    ds_read_b64 v[230:231], v246 offset:224
    v_mfma_f32_16x16x32_bf16 v[188:191], v[192:195], v[212:215], v[188:191]
    ds_read_b128 v[192:195], v243 offset:1280
    ds_read_b64 v[212:213], v246 offset:288
    ds_read_b64 v[214:215], v246 offset:296
    s_waitcnt lgkmcnt(9)
    ds_write_b32 v254, v255
    v_mfma_f32_16x16x32_bf16 v[0:3], v[196:199], v[216:219], v[0:3]
    ds_read_b128 v[196:199], v243 offset:1600
    ds_read_b64 v[216:217], v246 offset:360
    ds_read_b64 v[218:219], v246 offset:368
    v_mfma_f32_16x16x32_bf16 v[4:7], v[200:203], v[220:223], v[4:7]
    s_waitcnt lgkmcnt(12)
    ds_read_b128 v[200:203], v243 offset:1920
    ds_read_b64 v[220:221], v246 offset:432
    ds_read_b64 v[222:223], v246 offset:440
    s_waitcnt lgkmcnt(9)
    v_mfma_f32_16x16x32_bf16 v[8:11], v[204:207], v[224:227], v[8:11]
    ds_read_b128 v[204:207], v243 offset:2240
    ds_read_b64 v[224:225], v246 offset:504
    ds_read_b64 v[226:227], v246 offset:512
    v_mfma_f32_16x16x32_bf16 v[12:15], v[208:211], v[228:231], v[12:15]
    ds_read_b128 v[208:211], v243 offset:2560
    ds_read_b64 v[228:229], v246 offset:584
    ds_read_b64 v[230:231], v246 offset:592
    s_waitcnt lgkmcnt(9)
    v_mfma_f32_16x16x32_bf16 v[16:19], v[192:195], v[212:215], v[16:19]
    ds_read_b128 v[192:195], v243 offset:2880
    ds_read_b64 v[212:213], v246 offset:656
    ds_read_b64 v[214:215], v246 offset:664
    v_mfma_f32_16x16x32_bf16 v[20:23], v[196:199], v[216:219], v[20:23]
    ds_read_b128 v[196:199], v243 offset:3200
    ds_read_b64 v[216:217], v246 offset:728
    ds_read_b64 v[218:219], v246 offset:736
    s_waitcnt lgkmcnt(9)
    v_mfma_f32_16x16x32_bf16 v[24:27], v[200:203], v[220:223], v[24:27]
    ds_read_b128 v[200:203], v243 offset:3520
    ds_read_b64 v[220:221], v246 offset:800
    ds_read_b64 v[222:223], v246 offset:808
    v_mfma_f32_16x16x32_bf16 v[28:31], v[204:207], v[224:227], v[28:31]
    ds_read_b128 v[204:207], v243 offset:3840
    ds_read_b64 v[224:225], v246 offset:872
    ds_read_b64 v[226:227], v246 offset:880
    s_waitcnt lgkmcnt(9)
    v_mfma_f32_16x16x32_bf16 v[32:35], v[208:211], v[228:231], v[32:35]
    ds_read_b128 v[208:211], v243 offset:4160
    ds_read_b64 v[228:229], v246 offset:944
    ds_read_b64 v[230:231], v246 offset:952
    v_mfma_f32_16x16x32_bf16 v[36:39], v[192:195], v[212:215], v[36:39]
    ds_read_b128 v[192:195], v243 offset:4480
    ds_read_b64 v[212:213], v246 offset:1016
    ds_read_b64 v[214:215], v246 offset:1024
    s_waitcnt lgkmcnt(9)
    v_mfma_f32_16x16x32_bf16 v[40:43], v[196:199], v[216:219], v[40:43]
    ds_read_b128 v[196:199], v243 offset:4800
    ds_read_b64 v[216:217], v246 offset:1088
    ds_read_b64 v[218:219], v246 offset:1096
    v_mfma_f32_16x16x32_bf16 v[44:47], v[200:203], v[220:223], v[44:47]
    ds_read_b128 v[200:203], v243 offset:5120
    ds_read_b64 v[220:221], v246 offset:2336
    ds_read_b64 v[222:223], v246 offset:2344
    s_waitcnt lgkmcnt(9)
    v_mfma_f32_16x16x32_bf16 v[48:51], v[204:207], v[224:227], v[48:51]
    ds_read_b128 v[204:207], v243 offset:5440
    ds_read_b64 v[224:225], v246 offset:2408
    ds_read_b64 v[226:227], v246 offset:2416
    v_mfma_f32_16x16x32_bf16 v[52:55], v[208:211], v[228:231], v[52:55]
    ds_read_b128 v[208:211], v243 offset:5760
    ds_read_b64 v[228:229], v246 offset:2480
    ds_read_b64 v[230:231], v246 offset:2488
    s_waitcnt lgkmcnt(9)
    v_mfma_f32_16x16x32_bf16 v[56:59], v[192:195], v[212:215], v[56:59]
    ds_read_b128 v[192:195], v243 offset:6080
    ds_read_b64 v[212:213], v246 offset:2552
    ds_read_b64 v[214:215], v246 offset:2560
    v_mfma_f32_16x16x32_bf16 v[60:63], v[196:199], v[216:219], v[60:63]
    ds_read_b128 v[196:199], v243 offset:6400
    ds_read_b64 v[216:217], v246 offset:2624
    ds_read_b64 v[218:219], v246 offset:2632
    s_waitcnt lgkmcnt(9)
    v_mfma_f32_16x16x32_bf16 v[64:67], v[200:203], v[220:223], v[64:67]
    ds_read_b128 v[200:203], v243 offset:6720
    ds_read_b64 v[220:221], v246 offset:2696
    ds_read_b64 v[222:223], v246 offset:2704
    v_mfma_f32_16x16x32_bf16 v[68:71], v[204:207], v[224:227], v[68:71]
    ds_read_b128 v[204:207], v243 offset:7040
    ds_read_b64 v[224:225], v246 offset:2768
    ds_read_b64 v[226:227], v246 offset:2776
    s_waitcnt lgkmcnt(9)
    v_mfma_f32_16x16x32_bf16 v[72:75], v[208:211], v[228:231], v[72:75]
    ds_read_b128 v[208:211], v243 offset:7360
    ds_read_b64 v[228:229], v246 offset:2840
    ds_read_b64 v[230:231], v246 offset:2848
    v_mfma_f32_16x16x32_bf16 v[76:79], v[192:195], v[212:215], v[76:79]
    ds_read_b128 v[192:195], v243 offset:7680
    ds_read_b64 v[212:213], v246 offset:2920
    ds_read_b64 v[214:215], v246 offset:2928
    s_waitcnt lgkmcnt(9)
    v_mfma_f32_16x16x32_bf16 v[80:83], v[196:199], v[216:219], v[80:83]
    ds_read_b128 v[196:199], v243 offset:8000
    ds_read_b64 v[216:217], v246 offset:2992
    ds_read_b64 v[218:219], v246 offset:3000
    v_mfma_f32_16x16x32_bf16 v[84:87], v[200:203], v[220:223], v[84:87]
    ds_read_b128 v[200:203], v243 offset:8320
    ds_read_b64 v[220:221], v246 offset:3064
    ds_read_b64 v[222:223], v246 offset:3072
    s_waitcnt lgkmcnt(9)
    v_mfma_f32_16x16x32_bf16 v[88:91], v[204:207], v[224:227], v[88:91]
    ds_read_b128 v[204:207], v243 offset:8640
    ds_read_b64 v[224:225], v246 offset:3136
    ds_read_b64 v[226:227], v246 offset:3144
    v_mfma_f32_16x16x32_bf16 v[92:95], v[208:211], v[228:231], v[92:95]
    ds_read_b128 v[208:211], v243 offset:8960
    ds_read_b64 v[228:229], v246 offset:3208
    ds_read_b64 v[230:231], v246 offset:3216
    s_waitcnt lgkmcnt(9)
    v_mfma_f32_16x16x32_bf16 v[96:99], v[192:195], v[212:215], v[96:99]
    ds_read_b128 v[192:195], v243 offset:9280
    ds_read_b64 v[212:213], v246 offset:3280
    ds_read_b64 v[214:215], v246 offset:3288
    v_mfma_f32_16x16x32_bf16 v[100:103], v[196:199], v[216:219], v[100:103]
    ds_read_b128 v[196:199], v243 offset:9600
    ds_read_b64 v[216:217], v246 offset:3352
    ds_read_b64 v[218:219], v246 offset:3360
    s_waitcnt lgkmcnt(9)
    v_mfma_f32_16x16x32_bf16 v[104:107], v[200:203], v[220:223], v[104:107]
    ds_read_b128 v[200:203], v243 offset:9920
    ds_read_b64 v[220:221], v246 offset:3424
    ds_read_b64 v[222:223], v246 offset:3432
    v_mfma_f32_16x16x32_bf16 v[108:111], v[204:207], v[224:227], v[108:111]
    ds_read_b128 v[204:207], v243 offset:10240
    ds_read_b64 v[224:225], v246 offset:4672
    ds_read_b64 v[226:227], v246 offset:4680
    s_waitcnt lgkmcnt(9)
    v_mfma_f32_16x16x32_bf16 v[112:115], v[208:211], v[228:231], v[112:115]
    ds_read_b128 v[208:211], v243 offset:10560
    ds_read_b64 v[228:229], v246 offset:4744
    ds_read_b64 v[230:231], v246 offset:4752
    v_mfma_f32_16x16x32_bf16 v[116:119], v[192:195], v[212:215], v[116:119]
    ds_read_b128 v[192:195], v243 offset:10880
    ds_read_b64 v[212:213], v246 offset:4816
    ds_read_b64 v[214:215], v246 offset:4824
    s_waitcnt lgkmcnt(9)
    v_mfma_f32_16x16x32_bf16 v[120:123], v[196:199], v[216:219], v[120:123]
    ds_read_b128 v[196:199], v243 offset:11200
    ds_read_b64 v[216:217], v246 offset:4888
    ds_read_b64 v[218:219], v246 offset:4896
    v_mfma_f32_16x16x32_bf16 v[124:127], v[200:203], v[220:223], v[124:127]
    ds_read_b128 v[200:203], v243 offset:11520
    ds_read_b64 v[220:221], v246 offset:4960
    ds_read_b64 v[222:223], v246 offset:4968
    s_waitcnt lgkmcnt(9)
    v_mfma_f32_16x16x32_bf16 v[128:131], v[204:207], v[224:227], v[128:131]
    ds_read_b128 v[204:207], v243 offset:11840
    ds_read_b64 v[224:225], v246 offset:5032
    ds_read_b64 v[226:227], v246 offset:5040
    v_mfma_f32_16x16x32_bf16 v[132:135], v[208:211], v[228:231], v[132:135]
    ds_read_b128 v[208:211], v243 offset:12160
    ds_read_b64 v[228:229], v246 offset:5104
    ds_read_b64 v[230:231], v246 offset:5112
    s_waitcnt lgkmcnt(9)
    v_mfma_f32_16x16x32_bf16 v[136:139], v[192:195], v[212:215], v[136:139]
    ds_read_b128 v[192:195], v243 offset:12480
    ds_read_b64 v[212:213], v246 offset:5176
    ds_read_b64 v[214:215], v246 offset:5184
    v_mfma_f32_16x16x32_bf16 v[140:143], v[196:199], v[216:219], v[140:143]
    ds_read_b128 v[196:199], v243 offset:12800
    ds_read_b64 v[216:217], v246 offset:5256
    ds_read_b64 v[218:219], v246 offset:5264
    s_waitcnt lgkmcnt(9)
    v_mfma_f32_16x16x32_bf16 v[144:147], v[200:203], v[220:223], v[144:147]
    ds_read_b128 v[200:203], v243 offset:13120
    ds_read_b64 v[220:221], v246 offset:5328
    ds_read_b64 v[222:223], v246 offset:5336
    v_mfma_f32_16x16x32_bf16 v[148:151], v[204:207], v[224:227], v[148:151]
    ds_read_b128 v[204:207], v243 offset:13440
    ds_read_b64 v[224:225], v246 offset:5400
    ds_read_b64 v[226:227], v246 offset:5408
    s_waitcnt lgkmcnt(9)
    v_mfma_f32_16x16x32_bf16 v[152:155], v[208:211], v[228:231], v[152:155]
    ds_read_b128 v[208:211], v243 offset:13760
    ds_read_b64 v[228:229], v246 offset:5472
    ds_read_b64 v[230:231], v246 offset:5480
    v_mfma_f32_16x16x32_bf16 v[156:159], v[192:195], v[212:215], v[156:159]
    ds_read_b128 v[192:195], v243 offset:14080
    ds_read_b64 v[212:213], v246 offset:5544
    ds_read_b64 v[214:215], v246 offset:5552
    s_waitcnt lgkmcnt(9)
    v_mfma_f32_16x16x32_bf16 v[160:163], v[196:199], v[216:219], v[160:163]
    ds_read_b128 v[196:199], v243 offset:14400
    ds_read_b64 v[216:217], v246 offset:5616
    ds_read_b64 v[218:219], v246 offset:5624
    v_mfma_f32_16x16x32_bf16 v[164:167], v[200:203], v[220:223], v[164:167]
    ds_read_b128 v[200:203], v243 offset:14720
    ds_read_b64 v[220:221], v246 offset:5688
    ds_read_b64 v[222:223], v246 offset:5696
    s_waitcnt lgkmcnt(9)
    v_mfma_f32_16x16x32_bf16 v[168:171], v[204:207], v[224:227], v[168:171]
    ds_read_b128 v[204:207], v243 offset:15040
    ds_read_b64 v[224:225], v246 offset:5760
    ds_read_b64 v[226:227], v246 offset:5768
    v_mfma_f32_16x16x32_bf16 v[172:175], v[208:211], v[228:231], v[172:175]
    s_waitcnt lgkmcnt(6)
    v_mfma_f32_16x16x32_bf16 v[176:179], v[192:195], v[212:215], v[176:179]
    v_mfma_f32_16x16x32_bf16 v[180:183], v[196:199], v[216:219], v[180:183]
    s_waitcnt lgkmcnt(0)
    v_mfma_f32_16x16x32_bf16 v[184:187], v[200:203], v[220:223], v[184:187]
    ds_write_b32 v254, v255 offset:4
    v_mfma_f32_16x16x32_bf16 v[188:191], v[204:207], v[224:227], v[188:191]
    s_setprio 2
L_hp2:

    s_cmp_lg_u32 s16, 1
    s_cbranch_scc1 L_nopf
    s_lshr_b32 s26, s2, 3
    s_mul_i32 s26, s26, 2304
    v_lshlrev_b32 v230, 2, v253
    buffer_load_dword v231, v230, s[40:43], s26 offen
    buffer_load_dword v231, v230, s[44:47], s26 offen
L_nopf:

    v_pk_add_f32 v[232:233], v[0:1], v[4:5]
    v_pk_mul_f32 v[236:237], v[0:1], v[0:1]
    v_pk_add_f32 v[234:235], v[2:3], v[6:7]
    v_pk_mul_f32 v[238:239], v[2:3], v[2:3]
    v_pk_fma_f32 v[236:237], v[4:5], v[4:5], v[236:237]
    v_pk_fma_f32 v[238:239], v[6:7], v[6:7], v[238:239]
    v_pk_add_f32 v[232:233], v[232:233], v[8:9]
    v_pk_fma_f32 v[236:237], v[8:9], v[8:9], v[236:237]
    v_pk_add_f32 v[234:235], v[234:235], v[10:11]
    v_pk_fma_f32 v[238:239], v[10:11], v[10:11], v[238:239]
    v_pk_add_f32 v[232:233], v[232:233], v[12:13]
    v_pk_fma_f32 v[236:237], v[12:13], v[12:13], v[236:237]
    v_pk_add_f32 v[234:235], v[234:235], v[14:15]
    v_pk_fma_f32 v[238:239], v[14:15], v[14:15], v[238:239]
    v_pk_add_f32 v[232:233], v[232:233], v[16:17]
    v_pk_fma_f32 v[236:237], v[16:17], v[16:17], v[236:237]
    v_pk_add_f32 v[234:235], v[234:235], v[18:19]
    v_pk_fma_f32 v[238:239], v[18:19], v[18:19], v[238:239]
    v_pk_add_f32 v[232:233], v[232:233], v[20:21]
    v_pk_fma_f32 v[236:237], v[20:21], v[20:21], v[236:237]
    v_pk_add_f32 v[234:235], v[234:235], v[22:23]
    v_pk_fma_f32 v[238:239], v[22:23], v[22:23], v[238:239]
    v_pk_add_f32 v[232:233], v[232:233], v[24:25]
    v_pk_fma_f32 v[236:237], v[24:25], v[24:25], v[236:237]
    v_pk_add_f32 v[234:235], v[234:235], v[26:27]
    v_pk_fma_f32 v[238:239], v[26:27], v[26:27], v[238:239]
    v_pk_add_f32 v[232:233], v[232:233], v[28:29]
    v_pk_fma_f32 v[236:237], v[28:29], v[28:29], v[236:237]
    v_pk_add_f32 v[234:235], v[234:235], v[30:31]
    v_pk_fma_f32 v[238:239], v[30:31], v[30:31], v[238:239]
    v_pk_add_f32 v[232:233], v[232:233], v[32:33]
    v_pk_fma_f32 v[236:237], v[32:33], v[32:33], v[236:237]
    v_pk_add_f32 v[234:235], v[234:235], v[34:35]
    v_pk_fma_f32 v[238:239], v[34:35], v[34:35], v[238:239]
    v_pk_add_f32 v[232:233], v[232:233], v[36:37]
    v_pk_fma_f32 v[236:237], v[36:37], v[36:37], v[236:237]
    v_pk_add_f32 v[234:235], v[234:235], v[38:39]
    v_pk_fma_f32 v[238:239], v[38:39], v[38:39], v[238:239]
    v_pk_add_f32 v[232:233], v[232:233], v[40:41]
    v_pk_fma_f32 v[236:237], v[40:41], v[40:41], v[236:237]
    v_pk_add_f32 v[234:235], v[234:235], v[42:43]
    v_pk_fma_f32 v[238:239], v[42:43], v[42:43], v[238:239]
    v_pk_add_f32 v[232:233], v[232:233], v[44:45]
    v_pk_fma_f32 v[236:237], v[44:45], v[44:45], v[236:237]
    v_pk_add_f32 v[234:235], v[234:235], v[46:47]
    v_pk_fma_f32 v[238:239], v[46:47], v[46:47], v[238:239]
    v_pk_add_f32 v[232:233], v[232:233], v[48:49]
    v_pk_fma_f32 v[236:237], v[48:49], v[48:49], v[236:237]
    v_pk_add_f32 v[234:235], v[234:235], v[50:51]
    v_pk_fma_f32 v[238:239], v[50:51], v[50:51], v[238:239]
    v_pk_add_f32 v[232:233], v[232:233], v[52:53]
    v_pk_fma_f32 v[236:237], v[52:53], v[52:53], v[236:237]
    v_pk_add_f32 v[234:235], v[234:235], v[54:55]
    v_pk_fma_f32 v[238:239], v[54:55], v[54:55], v[238:239]
    v_pk_add_f32 v[232:233], v[232:233], v[56:57]
    v_pk_fma_f32 v[236:237], v[56:57], v[56:57], v[236:237]
    v_pk_add_f32 v[234:235], v[234:235], v[58:59]
    v_pk_fma_f32 v[238:239], v[58:59], v[58:59], v[238:239]
    v_pk_add_f32 v[232:233], v[232:233], v[60:61]
    v_pk_fma_f32 v[236:237], v[60:61], v[60:61], v[236:237]
    v_pk_add_f32 v[234:235], v[234:235], v[62:63]
    v_pk_fma_f32 v[238:239], v[62:63], v[62:63], v[238:239]
    v_pk_add_f32 v[232:233], v[232:233], v[64:65]
    v_pk_fma_f32 v[236:237], v[64:65], v[64:65], v[236:237]
    v_pk_add_f32 v[234:235], v[234:235], v[66:67]
    v_pk_fma_f32 v[238:239], v[66:67], v[66:67], v[238:239]
    v_pk_add_f32 v[232:233], v[232:233], v[68:69]
    v_pk_fma_f32 v[236:237], v[68:69], v[68:69], v[236:237]
    v_pk_add_f32 v[234:235], v[234:235], v[70:71]
    v_pk_fma_f32 v[238:239], v[70:71], v[70:71], v[238:239]
    v_pk_add_f32 v[232:233], v[232:233], v[72:73]
    v_pk_fma_f32 v[236:237], v[72:73], v[72:73], v[236:237]
    v_pk_add_f32 v[234:235], v[234:235], v[74:75]
    v_pk_fma_f32 v[238:239], v[74:75], v[74:75], v[238:239]
    v_pk_add_f32 v[232:233], v[232:233], v[76:77]
    v_pk_fma_f32 v[236:237], v[76:77], v[76:77], v[236:237]
    v_pk_add_f32 v[234:235], v[234:235], v[78:79]
    v_pk_fma_f32 v[238:239], v[78:79], v[78:79], v[238:239]
    v_pk_add_f32 v[232:233], v[232:233], v[80:81]
    v_pk_fma_f32 v[236:237], v[80:81], v[80:81], v[236:237]
    v_pk_add_f32 v[234:235], v[234:235], v[82:83]
    v_pk_fma_f32 v[238:239], v[82:83], v[82:83], v[238:239]
    v_pk_add_f32 v[232:233], v[232:233], v[84:85]
    v_pk_fma_f32 v[236:237], v[84:85], v[84:85], v[236:237]
    v_pk_add_f32 v[234:235], v[234:235], v[86:87]
    v_pk_fma_f32 v[238:239], v[86:87], v[86:87], v[238:239]
    v_pk_add_f32 v[232:233], v[232:233], v[88:89]
    v_pk_fma_f32 v[236:237], v[88:89], v[88:89], v[236:237]
    v_pk_add_f32 v[234:235], v[234:235], v[90:91]
    v_pk_fma_f32 v[238:239], v[90:91], v[90:91], v[238:239]
    v_pk_add_f32 v[232:233], v[232:233], v[92:93]
    v_pk_fma_f32 v[236:237], v[92:93], v[92:93], v[236:237]
    v_pk_add_f32 v[234:235], v[234:235], v[94:95]
    v_pk_fma_f32 v[238:239], v[94:95], v[94:95], v[238:239]
    v_pk_add_f32 v[232:233], v[232:233], v[96:97]
    v_pk_fma_f32 v[236:237], v[96:97], v[96:97], v[236:237]
    v_pk_add_f32 v[234:235], v[234:235], v[98:99]
    v_pk_fma_f32 v[238:239], v[98:99], v[98:99], v[238:239]
    v_pk_add_f32 v[232:233], v[232:233], v[100:101]
    v_pk_fma_f32 v[236:237], v[100:101], v[100:101], v[236:237]
    v_pk_add_f32 v[234:235], v[234:235], v[102:103]
    v_pk_fma_f32 v[238:239], v[102:103], v[102:103], v[238:239]
    v_pk_add_f32 v[232:233], v[232:233], v[104:105]
    v_pk_fma_f32 v[236:237], v[104:105], v[104:105], v[236:237]
    v_pk_add_f32 v[234:235], v[234:235], v[106:107]
    v_pk_fma_f32 v[238:239], v[106:107], v[106:107], v[238:239]
    v_pk_add_f32 v[232:233], v[232:233], v[108:109]
    v_pk_fma_f32 v[236:237], v[108:109], v[108:109], v[236:237]
    v_pk_add_f32 v[234:235], v[234:235], v[110:111]
    v_pk_fma_f32 v[238:239], v[110:111], v[110:111], v[238:239]
    v_pk_add_f32 v[232:233], v[232:233], v[112:113]
    v_pk_fma_f32 v[236:237], v[112:113], v[112:113], v[236:237]
    v_pk_add_f32 v[234:235], v[234:235], v[114:115]
    v_pk_fma_f32 v[238:239], v[114:115], v[114:115], v[238:239]
    v_pk_add_f32 v[232:233], v[232:233], v[116:117]
    v_pk_fma_f32 v[236:237], v[116:117], v[116:117], v[236:237]
    v_pk_add_f32 v[234:235], v[234:235], v[118:119]
    v_pk_fma_f32 v[238:239], v[118:119], v[118:119], v[238:239]
    v_pk_add_f32 v[232:233], v[232:233], v[120:121]
    v_pk_fma_f32 v[236:237], v[120:121], v[120:121], v[236:237]
    v_pk_add_f32 v[234:235], v[234:235], v[122:123]
    v_pk_fma_f32 v[238:239], v[122:123], v[122:123], v[238:239]
    v_pk_add_f32 v[232:233], v[232:233], v[124:125]
    v_pk_fma_f32 v[236:237], v[124:125], v[124:125], v[236:237]
    v_pk_add_f32 v[234:235], v[234:235], v[126:127]
    v_pk_fma_f32 v[238:239], v[126:127], v[126:127], v[238:239]
    v_pk_add_f32 v[232:233], v[232:233], v[128:129]
    v_pk_fma_f32 v[236:237], v[128:129], v[128:129], v[236:237]
    v_pk_add_f32 v[234:235], v[234:235], v[130:131]
    v_pk_fma_f32 v[238:239], v[130:131], v[130:131], v[238:239]
    v_pk_add_f32 v[232:233], v[232:233], v[132:133]
    v_pk_fma_f32 v[236:237], v[132:133], v[132:133], v[236:237]
    v_pk_add_f32 v[234:235], v[234:235], v[134:135]
    v_pk_fma_f32 v[238:239], v[134:135], v[134:135], v[238:239]
    v_pk_add_f32 v[232:233], v[232:233], v[136:137]
    v_pk_fma_f32 v[236:237], v[136:137], v[136:137], v[236:237]
    v_pk_add_f32 v[234:235], v[234:235], v[138:139]
    v_pk_fma_f32 v[238:239], v[138:139], v[138:139], v[238:239]
    v_pk_add_f32 v[232:233], v[232:233], v[140:141]
    v_pk_fma_f32 v[236:237], v[140:141], v[140:141], v[236:237]
    v_pk_add_f32 v[234:235], v[234:235], v[142:143]
    v_pk_fma_f32 v[238:239], v[142:143], v[142:143], v[238:239]
    v_pk_add_f32 v[232:233], v[232:233], v[144:145]
    v_pk_fma_f32 v[236:237], v[144:145], v[144:145], v[236:237]
    v_pk_add_f32 v[234:235], v[234:235], v[146:147]
    v_pk_fma_f32 v[238:239], v[146:147], v[146:147], v[238:239]
    v_pk_add_f32 v[232:233], v[232:233], v[148:149]
    v_pk_fma_f32 v[236:237], v[148:149], v[148:149], v[236:237]
    v_pk_add_f32 v[234:235], v[234:235], v[150:151]
    v_pk_fma_f32 v[238:239], v[150:151], v[150:151], v[238:239]
    v_pk_add_f32 v[232:233], v[232:233], v[152:153]
    v_pk_fma_f32 v[236:237], v[152:153], v[152:153], v[236:237]
    v_pk_add_f32 v[234:235], v[234:235], v[154:155]
    v_pk_fma_f32 v[238:239], v[154:155], v[154:155], v[238:239]
    v_pk_add_f32 v[232:233], v[232:233], v[156:157]
    v_pk_fma_f32 v[236:237], v[156:157], v[156:157], v[236:237]
    v_pk_add_f32 v[234:235], v[234:235], v[158:159]
    v_pk_fma_f32 v[238:239], v[158:159], v[158:159], v[238:239]
    v_pk_add_f32 v[232:233], v[232:233], v[160:161]
    v_pk_fma_f32 v[236:237], v[160:161], v[160:161], v[236:237]
    v_pk_add_f32 v[234:235], v[234:235], v[162:163]
    v_pk_fma_f32 v[238:239], v[162:163], v[162:163], v[238:239]
    v_pk_add_f32 v[232:233], v[232:233], v[164:165]
    v_pk_fma_f32 v[236:237], v[164:165], v[164:165], v[236:237]
    v_pk_add_f32 v[234:235], v[234:235], v[166:167]
    v_pk_fma_f32 v[238:239], v[166:167], v[166:167], v[238:239]
    v_pk_add_f32 v[232:233], v[232:233], v[168:169]
    v_pk_fma_f32 v[236:237], v[168:169], v[168:169], v[236:237]
    v_pk_add_f32 v[234:235], v[234:235], v[170:171]
    v_pk_fma_f32 v[238:239], v[170:171], v[170:171], v[238:239]
    v_pk_add_f32 v[232:233], v[232:233], v[172:173]
    v_pk_fma_f32 v[236:237], v[172:173], v[172:173], v[236:237]
    v_pk_add_f32 v[234:235], v[234:235], v[174:175]
    v_pk_fma_f32 v[238:239], v[174:175], v[174:175], v[238:239]
    v_pk_add_f32 v[232:233], v[232:233], v[176:177]
    v_pk_fma_f32 v[236:237], v[176:177], v[176:177], v[236:237]
    v_pk_add_f32 v[234:235], v[234:235], v[178:179]
    v_pk_fma_f32 v[238:239], v[178:179], v[178:179], v[238:239]
    v_pk_add_f32 v[232:233], v[232:233], v[180:181]
    v_pk_fma_f32 v[236:237], v[180:181], v[180:181], v[236:237]
    v_pk_add_f32 v[234:235], v[234:235], v[182:183]
    v_pk_fma_f32 v[238:239], v[182:183], v[182:183], v[238:239]
    v_pk_add_f32 v[232:233], v[232:233], v[184:185]
    v_pk_fma_f32 v[236:237], v[184:185], v[184:185], v[236:237]
    v_pk_add_f32 v[234:235], v[234:235], v[186:187]
    v_pk_fma_f32 v[238:239], v[186:187], v[186:187], v[238:239]
    v_pk_add_f32 v[232:233], v[232:233], v[188:189]
    v_pk_fma_f32 v[236:237], v[188:189], v[188:189], v[236:237]
    v_pk_add_f32 v[234:235], v[234:235], v[190:191]
    v_pk_fma_f32 v[238:239], v[190:191], v[190:191], v[238:239]

    s_nop 1
    v_permlane32_swap_b32 v232, v233
    v_permlane32_swap_b32 v234, v235
    v_permlane32_swap_b32 v236, v237
    v_permlane32_swap_b32 v238, v239

    v_add_f32 v232, v232, v233
    v_add_f32 v236, v236, v237
    v_mul_f32 v232, 0x3c2aaaab, v232
    v_mul_f32 v236, 0x3c2aaaab, v236
    v_fma_f32 v236, -v232, v232, v236
    v_max_f32 v236, 0, v236
    v_add_f32 v236, 0x0727c5ac, v236
    v_rsq_f32 v236, v236
    s_nop 0
    v_mul_f32 v232, v232, v236
    v_mul_f32 v236, 0x08000000, v236
    v_mul_f32 v232, 0x88000000, v232
    v_mov_b32 v237, v236
    v_mov_b32 v233, v232

    v_add_f32 v234, v234, v235
    v_add_f32 v238, v238, v239
    v_mul_f32 v234, 0x3c2aaaab, v234
    v_mul_f32 v238, 0x3c2aaaab, v238
    v_fma_f32 v238, -v234, v234, v238
    v_max_f32 v238, 0, v238
    v_add_f32 v238, 0x0727c5ac, v238
    v_rsq_f32 v238, v238
    s_nop 0
    v_mul_f32 v234, v234, v238
    v_mul_f32 v238, 0x08000000, v238
    v_mul_f32 v234, 0x88000000, v234
    v_mov_b32 v239, v238
    v_mov_b32 v235, v234

    s_nop 1
    v_permlane32_swap_b32 v232, v233
    v_permlane32_swap_b32 v234, v235
    v_permlane32_swap_b32 v236, v237
    v_permlane32_swap_b32 v238, v239

    v_pk_fma_f32 v[0:1], v[0:1], v[236:237], v[232:233]
    v_pk_fma_f32 v[2:3], v[2:3], v[238:239], v[234:235]
    v_pk_fma_f32 v[4:5], v[4:5], v[236:237], v[232:233]
    v_pk_fma_f32 v[6:7], v[6:7], v[238:239], v[234:235]
    v_pk_fma_f32 v[8:9], v[8:9], v[236:237], v[232:233]
    v_pk_fma_f32 v[10:11], v[10:11], v[238:239], v[234:235]
    v_pk_fma_f32 v[12:13], v[12:13], v[236:237], v[232:233]
    v_pk_fma_f32 v[14:15], v[14:15], v[238:239], v[234:235]
    v_pk_fma_f32 v[16:17], v[16:17], v[236:237], v[232:233]
    v_pk_fma_f32 v[18:19], v[18:19], v[238:239], v[234:235]
    v_pk_fma_f32 v[20:21], v[20:21], v[236:237], v[232:233]
    v_pk_fma_f32 v[22:23], v[22:23], v[238:239], v[234:235]
    v_pk_fma_f32 v[24:25], v[24:25], v[236:237], v[232:233]
    v_pk_fma_f32 v[26:27], v[26:27], v[238:239], v[234:235]
    v_pk_fma_f32 v[28:29], v[28:29], v[236:237], v[232:233]
    v_pk_fma_f32 v[30:31], v[30:31], v[238:239], v[234:235]
    v_pk_fma_f32 v[32:33], v[32:33], v[236:237], v[232:233]
    v_pk_fma_f32 v[34:35], v[34:35], v[238:239], v[234:235]
    v_pk_fma_f32 v[36:37], v[36:37], v[236:237], v[232:233]
    v_pk_fma_f32 v[38:39], v[38:39], v[238:239], v[234:235]
    v_pk_fma_f32 v[40:41], v[40:41], v[236:237], v[232:233]
    v_pk_fma_f32 v[42:43], v[42:43], v[238:239], v[234:235]
    v_pk_fma_f32 v[44:45], v[44:45], v[236:237], v[232:233]
    v_pk_fma_f32 v[46:47], v[46:47], v[238:239], v[234:235]
    v_pk_fma_f32 v[48:49], v[48:49], v[236:237], v[232:233]
    v_pk_fma_f32 v[50:51], v[50:51], v[238:239], v[234:235]
    v_pk_fma_f32 v[52:53], v[52:53], v[236:237], v[232:233]
    v_pk_fma_f32 v[54:55], v[54:55], v[238:239], v[234:235]
    v_pk_fma_f32 v[56:57], v[56:57], v[236:237], v[232:233]
    v_pk_fma_f32 v[58:59], v[58:59], v[238:239], v[234:235]
    v_pk_fma_f32 v[60:61], v[60:61], v[236:237], v[232:233]
    v_pk_fma_f32 v[62:63], v[62:63], v[238:239], v[234:235]
    v_cvt_pk_bf16_f32 v192, v0, v4
    v_cvt_pk_bf16_f32 v193, v8, v12
    v_cvt_pk_bf16_f32 v194, v16, v20
    v_cvt_pk_bf16_f32 v195, v24, v28
    v_cvt_pk_bf16_f32 v200, v32, v36
    v_cvt_pk_bf16_f32 v201, v40, v44
    v_cvt_pk_bf16_f32 v202, v48, v52
    v_cvt_pk_bf16_f32 v203, v56, v60
    v_cvt_pk_bf16_f32 v196, v1, v5
    v_cvt_pk_bf16_f32 v197, v9, v13
    v_cvt_pk_bf16_f32 v198, v17, v21
    v_cvt_pk_bf16_f32 v199, v25, v29
    v_cvt_pk_bf16_f32 v204, v33, v37
    v_cvt_pk_bf16_f32 v205, v41, v45
    v_cvt_pk_bf16_f32 v206, v49, v53
    v_cvt_pk_bf16_f32 v207, v57, v61
    v_cvt_pk_bf16_f32 v208, v2, v6
    v_cvt_pk_bf16_f32 v209, v10, v14
    v_cvt_pk_bf16_f32 v210, v18, v22
    v_cvt_pk_bf16_f32 v211, v26, v30
    v_cvt_pk_bf16_f32 v216, v34, v38
    v_cvt_pk_bf16_f32 v217, v42, v46
    v_cvt_pk_bf16_f32 v218, v50, v54
    v_cvt_pk_bf16_f32 v219, v58, v62
    v_cvt_pk_bf16_f32 v212, v3, v7
    v_cvt_pk_bf16_f32 v213, v11, v15
    v_cvt_pk_bf16_f32 v214, v19, v23
    v_cvt_pk_bf16_f32 v215, v27, v31
    v_cvt_pk_bf16_f32 v220, v35, v39
    v_cvt_pk_bf16_f32 v221, v43, v47
    v_cvt_pk_bf16_f32 v222, v51, v55
    v_cvt_pk_bf16_f32 v223, v59, v63
    s_nop 0
    v_permlane16_swap_b32 v192, v200
    v_permlane16_swap_b32 v193, v201
    v_permlane16_swap_b32 v194, v202
    v_permlane16_swap_b32 v195, v203
    v_permlane16_swap_b32 v196, v204
    v_permlane16_swap_b32 v197, v205
    v_permlane16_swap_b32 v198, v206
    v_permlane16_swap_b32 v199, v207
    v_permlane16_swap_b32 v208, v216
    v_permlane16_swap_b32 v209, v217
    v_permlane16_swap_b32 v210, v218
    v_permlane16_swap_b32 v211, v219
    v_permlane16_swap_b32 v212, v220
    v_permlane16_swap_b32 v213, v221
    v_permlane16_swap_b32 v214, v222
    v_permlane16_swap_b32 v215, v223
    v_mov_b32 v0, v208
    v_mov_b32 v1, v209
    v_mov_b32 v2, v210
    v_mov_b32 v3, v211
    v_mov_b32 v4, v212
    v_mov_b32 v5, v213
    v_mov_b32 v6, v214
    v_mov_b32 v7, v215
    v_mov_b32 v8, v216
    v_mov_b32 v9, v217
    v_mov_b32 v10, v218
    v_mov_b32 v11, v219
    v_mov_b32 v12, v220
    v_mov_b32 v13, v221
    v_mov_b32 v14, v222
    v_mov_b32 v15, v223
    v_pk_fma_f32 v[64:65], v[64:65], v[236:237], v[232:233]
    v_pk_fma_f32 v[66:67], v[66:67], v[238:239], v[234:235]
    v_pk_fma_f32 v[68:69], v[68:69], v[236:237], v[232:233]
    v_pk_fma_f32 v[70:71], v[70:71], v[238:239], v[234:235]
    v_pk_fma_f32 v[72:73], v[72:73], v[236:237], v[232:233]
    v_pk_fma_f32 v[74:75], v[74:75], v[238:239], v[234:235]
    v_pk_fma_f32 v[76:77], v[76:77], v[236:237], v[232:233]
    v_pk_fma_f32 v[78:79], v[78:79], v[238:239], v[234:235]
    v_pk_fma_f32 v[80:81], v[80:81], v[236:237], v[232:233]
    v_pk_fma_f32 v[82:83], v[82:83], v[238:239], v[234:235]
    v_pk_fma_f32 v[84:85], v[84:85], v[236:237], v[232:233]
    v_pk_fma_f32 v[86:87], v[86:87], v[238:239], v[234:235]
    v_pk_fma_f32 v[88:89], v[88:89], v[236:237], v[232:233]
    v_pk_fma_f32 v[90:91], v[90:91], v[238:239], v[234:235]
    v_pk_fma_f32 v[92:93], v[92:93], v[236:237], v[232:233]
    v_pk_fma_f32 v[94:95], v[94:95], v[238:239], v[234:235]
    v_pk_fma_f32 v[96:97], v[96:97], v[236:237], v[232:233]
    v_pk_fma_f32 v[98:99], v[98:99], v[238:239], v[234:235]
    v_pk_fma_f32 v[100:101], v[100:101], v[236:237], v[232:233]
    v_pk_fma_f32 v[102:103], v[102:103], v[238:239], v[234:235]
    v_pk_fma_f32 v[104:105], v[104:105], v[236:237], v[232:233]
    v_pk_fma_f32 v[106:107], v[106:107], v[238:239], v[234:235]
    v_pk_fma_f32 v[108:109], v[108:109], v[236:237], v[232:233]
    v_pk_fma_f32 v[110:111], v[110:111], v[238:239], v[234:235]
    v_pk_fma_f32 v[112:113], v[112:113], v[236:237], v[232:233]
    v_pk_fma_f32 v[114:115], v[114:115], v[238:239], v[234:235]
    v_pk_fma_f32 v[116:117], v[116:117], v[236:237], v[232:233]
    v_pk_fma_f32 v[118:119], v[118:119], v[238:239], v[234:235]
    v_pk_fma_f32 v[120:121], v[120:121], v[236:237], v[232:233]
    v_pk_fma_f32 v[122:123], v[122:123], v[238:239], v[234:235]
    v_pk_fma_f32 v[124:125], v[124:125], v[236:237], v[232:233]
    v_pk_fma_f32 v[126:127], v[126:127], v[238:239], v[234:235]
    v_cvt_pk_bf16_f32 v48, v64, v68
    v_cvt_pk_bf16_f32 v49, v72, v76
    v_cvt_pk_bf16_f32 v50, v80, v84
    v_cvt_pk_bf16_f32 v51, v88, v92
    v_cvt_pk_bf16_f32 v56, v96, v100
    v_cvt_pk_bf16_f32 v57, v104, v108
    v_cvt_pk_bf16_f32 v58, v112, v116
    v_cvt_pk_bf16_f32 v59, v120, v124
    v_cvt_pk_bf16_f32 v52, v65, v69
    v_cvt_pk_bf16_f32 v53, v73, v77
    v_cvt_pk_bf16_f32 v54, v81, v85
    v_cvt_pk_bf16_f32 v55, v89, v93
    v_cvt_pk_bf16_f32 v60, v97, v101
    v_cvt_pk_bf16_f32 v61, v105, v109
    v_cvt_pk_bf16_f32 v62, v113, v117
    v_cvt_pk_bf16_f32 v63, v121, v125
    v_cvt_pk_bf16_f32 v16, v66, v70
    v_cvt_pk_bf16_f32 v17, v74, v78
    v_cvt_pk_bf16_f32 v18, v82, v86
    v_cvt_pk_bf16_f32 v19, v90, v94
    v_cvt_pk_bf16_f32 v24, v98, v102
    v_cvt_pk_bf16_f32 v25, v106, v110
    v_cvt_pk_bf16_f32 v26, v114, v118
    v_cvt_pk_bf16_f32 v27, v122, v126
    v_cvt_pk_bf16_f32 v20, v67, v71
    v_cvt_pk_bf16_f32 v21, v75, v79
    v_cvt_pk_bf16_f32 v22, v83, v87
    v_cvt_pk_bf16_f32 v23, v91, v95
    v_cvt_pk_bf16_f32 v28, v99, v103
    v_cvt_pk_bf16_f32 v29, v107, v111
    v_cvt_pk_bf16_f32 v30, v115, v119
    v_cvt_pk_bf16_f32 v31, v123, v127
    s_nop 0
    v_permlane16_swap_b32 v48, v56
    v_permlane16_swap_b32 v49, v57
    v_permlane16_swap_b32 v50, v58
    v_permlane16_swap_b32 v51, v59
    v_permlane16_swap_b32 v52, v60
    v_permlane16_swap_b32 v53, v61
    v_permlane16_swap_b32 v54, v62
    v_permlane16_swap_b32 v55, v63
    v_permlane16_swap_b32 v16, v24
    v_permlane16_swap_b32 v17, v25
    v_permlane16_swap_b32 v18, v26
    v_permlane16_swap_b32 v19, v27
    v_permlane16_swap_b32 v20, v28
    v_permlane16_swap_b32 v21, v29
    v_permlane16_swap_b32 v22, v30
    v_permlane16_swap_b32 v23, v31
    v_mov_b32 v80, v192
    v_mov_b32 v81, v193
    v_mov_b32 v82, v194
    v_mov_b32 v83, v195
    v_mov_b32 v84, v196
    v_mov_b32 v85, v197
    v_mov_b32 v86, v198
    v_mov_b32 v87, v199
    v_mov_b32 v88, v200
    v_mov_b32 v89, v201
    v_mov_b32 v90, v202
    v_mov_b32 v91, v203
    v_mov_b32 v92, v204
    v_mov_b32 v93, v205
    v_mov_b32 v94, v206
    v_mov_b32 v95, v207
    v_pk_fma_f32 v[128:129], v[128:129], v[236:237], v[232:233]
    v_pk_fma_f32 v[130:131], v[130:131], v[238:239], v[234:235]
    v_pk_fma_f32 v[132:133], v[132:133], v[236:237], v[232:233]
    v_pk_fma_f32 v[134:135], v[134:135], v[238:239], v[234:235]
    v_pk_fma_f32 v[136:137], v[136:137], v[236:237], v[232:233]
    v_pk_fma_f32 v[138:139], v[138:139], v[238:239], v[234:235]
    v_pk_fma_f32 v[140:141], v[140:141], v[236:237], v[232:233]
    v_pk_fma_f32 v[142:143], v[142:143], v[238:239], v[234:235]
    v_pk_fma_f32 v[144:145], v[144:145], v[236:237], v[232:233]
    v_pk_fma_f32 v[146:147], v[146:147], v[238:239], v[234:235]
    v_pk_fma_f32 v[148:149], v[148:149], v[236:237], v[232:233]
    v_pk_fma_f32 v[150:151], v[150:151], v[238:239], v[234:235]
    v_pk_fma_f32 v[152:153], v[152:153], v[236:237], v[232:233]
    v_pk_fma_f32 v[154:155], v[154:155], v[238:239], v[234:235]
    v_pk_fma_f32 v[156:157], v[156:157], v[236:237], v[232:233]
    v_pk_fma_f32 v[158:159], v[158:159], v[238:239], v[234:235]
    v_pk_fma_f32 v[160:161], v[160:161], v[236:237], v[232:233]
    v_pk_fma_f32 v[162:163], v[162:163], v[238:239], v[234:235]
    v_pk_fma_f32 v[164:165], v[164:165], v[236:237], v[232:233]
    v_pk_fma_f32 v[166:167], v[166:167], v[238:239], v[234:235]
    v_pk_fma_f32 v[168:169], v[168:169], v[236:237], v[232:233]
    v_pk_fma_f32 v[170:171], v[170:171], v[238:239], v[234:235]
    v_pk_fma_f32 v[172:173], v[172:173], v[236:237], v[232:233]
    v_pk_fma_f32 v[174:175], v[174:175], v[238:239], v[234:235]
    v_pk_fma_f32 v[176:177], v[176:177], v[236:237], v[232:233]
    v_pk_fma_f32 v[178:179], v[178:179], v[238:239], v[234:235]
    v_pk_fma_f32 v[180:181], v[180:181], v[236:237], v[232:233]
    v_pk_fma_f32 v[182:183], v[182:183], v[238:239], v[234:235]
    v_pk_fma_f32 v[184:185], v[184:185], v[236:237], v[232:233]
    v_pk_fma_f32 v[186:187], v[186:187], v[238:239], v[234:235]
    v_pk_fma_f32 v[188:189], v[188:189], v[236:237], v[232:233]
    v_pk_fma_f32 v[190:191], v[190:191], v[238:239], v[234:235]
    v_cvt_pk_bf16_f32 v64, v128, v132
    v_cvt_pk_bf16_f32 v65, v136, v140
    v_cvt_pk_bf16_f32 v66, v144, v148
    v_cvt_pk_bf16_f32 v67, v152, v156
    v_cvt_pk_bf16_f32 v72, v160, v164
    v_cvt_pk_bf16_f32 v73, v168, v172
    v_cvt_pk_bf16_f32 v74, v176, v180
    v_cvt_pk_bf16_f32 v75, v184, v188
    v_cvt_pk_bf16_f32 v68, v129, v133
    v_cvt_pk_bf16_f32 v69, v137, v141
    v_cvt_pk_bf16_f32 v70, v145, v149
    v_cvt_pk_bf16_f32 v71, v153, v157
    v_cvt_pk_bf16_f32 v76, v161, v165
    v_cvt_pk_bf16_f32 v77, v169, v173
    v_cvt_pk_bf16_f32 v78, v177, v181
    v_cvt_pk_bf16_f32 v79, v185, v189
    v_cvt_pk_bf16_f32 v32, v130, v134
    v_cvt_pk_bf16_f32 v33, v138, v142
    v_cvt_pk_bf16_f32 v34, v146, v150
    v_cvt_pk_bf16_f32 v35, v154, v158
    v_cvt_pk_bf16_f32 v40, v162, v166
    v_cvt_pk_bf16_f32 v41, v170, v174
    v_cvt_pk_bf16_f32 v42, v178, v182
    v_cvt_pk_bf16_f32 v43, v186, v190
    v_cvt_pk_bf16_f32 v36, v131, v135
    v_cvt_pk_bf16_f32 v37, v139, v143
    v_cvt_pk_bf16_f32 v38, v147, v151
    v_cvt_pk_bf16_f32 v39, v155, v159
    v_cvt_pk_bf16_f32 v44, v163, v167
    v_cvt_pk_bf16_f32 v45, v171, v175
    v_cvt_pk_bf16_f32 v46, v179, v183
    v_cvt_pk_bf16_f32 v47, v187, v191
    s_nop 0
    v_permlane16_swap_b32 v64, v72
    v_permlane16_swap_b32 v65, v73
    v_permlane16_swap_b32 v66, v74
    v_permlane16_swap_b32 v67, v75
    v_permlane16_swap_b32 v68, v76
    v_permlane16_swap_b32 v69, v77
    v_permlane16_swap_b32 v70, v78
    v_permlane16_swap_b32 v71, v79
    v_permlane16_swap_b32 v32, v40
    v_permlane16_swap_b32 v33, v41
    v_permlane16_swap_b32 v34, v42
    v_permlane16_swap_b32 v35, v43
    v_permlane16_swap_b32 v36, v44
    v_permlane16_swap_b32 v37, v45
    v_permlane16_swap_b32 v38, v46
    v_permlane16_swap_b32 v39, v47

    s_mov_b32 s18, 8
    s_mov_b32 s38, 1
    s_sub_u32 s26, s16, 1
    s_cmp_lt_u32 s26, 7
    s_cbranch_scc1 L_p2
    s_mov_b32 s38, 0

    v_lshrrev_b32 v232, 7, v253
    v_mul_u32_u24 v232, 640, v232
    v_add_u32 v232, v232, v253
    v_add_u32 v233, 196608, v232
    buffer_store_dwordx4 v[48:51], v232, s[8:11], s36 offen offset:0 sc1
    buffer_store_dwordx4 v[52:55], v232, s[8:11], s36 offen offset:128 sc1
    buffer_store_dwordx4 v[56:59], v232, s[8:11], s36 offen offset:256 sc1
    buffer_store_dwordx4 v[60:63], v232, s[8:11], s37 offen offset:0 sc1
    buffer_store_dwordx4 v[64:67], v232, s[8:11], s37 offen offset:128 sc1
    buffer_store_dwordx4 v[68:71], v232, s[8:11], s37 offen offset:256 sc1
    buffer_store_dwordx4 v[72:75], v233, s[8:11], s36 offen offset:0 sc1
    buffer_store_dwordx4 v[76:79], v233, s[8:11], s36 offen offset:128 sc1
    buffer_store_dwordx4 v[80:83], v233, s[8:11], s36 offen offset:256 sc1
    buffer_store_dwordx4 v[84:87], v233, s[8:11], s37 offen offset:0 sc1
    buffer_store_dwordx4 v[88:91], v233, s[8:11], s37 offen offset:128 sc1
    buffer_store_dwordx4 v[92:95], v233, s[8:11], s37 offen offset:256 sc1

    s_cmp_lg_u32 s16, 0
    s_cbranch_scc1 L_p2
    s_setprio 3
    s_branch L_xload
L_loader:

    v_lshrrev_b32 v60, 9, v253
    v_mul_u32_u24 v61, 1536, v60
    v_add_u32 v61, v61, v253
    v_bfe_u32 v254, v253, 6, 3
    v_lshl_add_u32 v60, v60, 4, v254
    v_mul_u32_u24 v60, 768, v60
    v_and_b32 v254, 48, v253
    v_add_u32 v60, v60, v254

    v_mov_b32 v76, 0
    v_mov_b32 v77, 0
    v_lshrrev_b32 v78, 1, v253
    v_add_u32 v79, 65544, v78
    v_add_u32 v80, 131080, v78

    v_add_u32 v254, 161932, v240

    s_mov_b32 s29, 200000
L_wg1:
    ds_read_b32 v255, v254
    s_waitcnt lgkmcnt(0)
    v_cmp_ne_u32 vcc, 0, v255
    s_cmp_eq_u64 vcc, exec
    s_cbranch_scc1 L_wg1_ok
    s_sleep 2
    s_sub_u32 s29, s29, 1
    s_cmp_lg_u32 s29, 0
    s_cbranch_scc1 L_wg1
L_wg1_ok:

    s_add_u32 s26, s39, 1
    s_cmp_ge_u32 s26, 12
    s_cselect_b32 s27, 12, 0
    s_sub_u32 s26, s26, s27
    s_mul_i32 s26, s26, 6144

    s_mov_b32 m0, 7168
    s_add_u32 s30, s26, 0
    s_add_u32 s31, s26, 1536
    buffer_load_dwordx4 v253, s[44:47], s30 offen lds
    buffer_load_dwordx4 v61, s[44:47], s30 offen offset:1024 lds
    buffer_load_dwordx4 v253, s[44:47], s31 offen offset:2048 lds
    s_mov_b32 m0, 72712
    s_add_u32 s30, s26, 1536
    s_add_u32 s31, s26, 3072
    buffer_load_dwordx4 v253, s[44:47], s30 offen lds
    buffer_load_dwordx4 v61, s[44:47], s30 offen offset:1024 lds
    buffer_load_dwordx4 v253, s[44:47], s31 offen offset:2048 lds

    s_add_u32 s26, s39, 4
    s_cmp_ge_u32 s26, 12
    s_cselect_b32 s27, 12, 0
    s_sub_u32 s26, s26, s27
    s_mul_i32 s26, s26, 64

    s_mov_b32 m0, 10240
    s_add_u32 s30, s26, 0
    s_add_u32 s31, s26, 23552
    s_add_u32 s32, s26, 47104
    buffer_load_dwordx4 v60, s[40:43], s30 offen offset:0 lds
    buffer_load_dwordx4 v60, s[40:43], s31 offen offset:1024 lds
    buffer_load_dwordx4 v60, s[40:43], s32 offen offset:2048 lds
    s_mov_b32 m0, 75784
    s_add_u32 s30, s26, 6144
    s_add_u32 s31, s26, 29696
    s_add_u32 s32, s26, 53248
    buffer_load_dwordx4 v60, s[40:43], s30 offen offset:0 lds
    buffer_load_dwordx4 v60, s[40:43], s31 offen offset:1024 lds
    buffer_load_dwordx4 v60, s[40:43], s32 offen offset:2048 lds

    s_add_u32 s26, s39, 2
    s_cmp_ge_u32 s26, 12
    s_cselect_b32 s27, 12, 0
    s_sub_u32 s26, s26, s27
    s_mul_i32 s26, s26, 6144

    s_mov_b32 m0, 13312
    s_add_u32 s30, s26, 0
    s_add_u32 s31, s26, 1536
    buffer_load_dwordx4 v253, s[44:47], s30 offen lds
    buffer_load_dwordx4 v61, s[44:47], s30 offen offset:1024 lds
    buffer_load_dwordx4 v253, s[44:47], s31 offen offset:2048 lds
    s_mov_b32 m0, 78856
    s_add_u32 s30, s26, 1536
    s_add_u32 s31, s26, 3072
    buffer_load_dwordx4 v253, s[44:47], s30 offen lds
    buffer_load_dwordx4 v61, s[44:47], s30 offen offset:1024 lds
    buffer_load_dwordx4 v253, s[44:47], s31 offen offset:2048 lds

    s_add_u32 s26, s39, 5
    s_cmp_ge_u32 s26, 12
    s_cselect_b32 s27, 12, 0
    s_sub_u32 s26, s26, s27
    s_mul_i32 s26, s26, 64

    s_mov_b32 m0, 16384
    s_add_u32 s30, s26, 0
    s_add_u32 s31, s26, 23552
    s_add_u32 s32, s26, 47104
    buffer_load_dwordx4 v60, s[40:43], s30 offen offset:0 lds
    buffer_load_dwordx4 v60, s[40:43], s31 offen offset:1024 lds
    buffer_load_dwordx4 v60, s[40:43], s32 offen offset:2048 lds
    s_mov_b32 m0, 81928
    s_add_u32 s30, s26, 6144
    s_add_u32 s31, s26, 29696
    s_add_u32 s32, s26, 53248
    buffer_load_dwordx4 v60, s[40:43], s30 offen offset:0 lds
    buffer_load_dwordx4 v60, s[40:43], s31 offen offset:1024 lds
    buffer_load_dwordx4 v60, s[40:43], s32 offen offset:2048 lds
    v_mov_b32 v254, 161976

    s_mov_b32 s29, 200000
L_wo1:
    ds_read_b32 v255, v254
    s_waitcnt lgkmcnt(0)
    v_cmp_eq_u32 vcc, 5, v255
    s_cmp_eq_u64 vcc, exec
    s_cbranch_scc1 L_wo1_ok
    s_sleep 2
    s_sub_u32 s29, s29, 1
    s_cmp_lg_u32 s29, 0
    s_cbranch_scc1 L_wo1
L_wo1_ok:

    ds_read_b64 v[96:97], v80 offset:0
    ds_read_b64 v[98:99], v80 offset:512
    ds_read_b64 v[100:101], v80 offset:1024
    ds_read_b64 v[102:103], v80 offset:1536
    ds_read_b64 v[104:105], v80 offset:2048
    ds_read_b64 v[106:107], v80 offset:2560
    ds_read_b64 v[108:109], v80 offset:15368
    ds_read_b64 v[110:111], v80 offset:15880
    ds_read_b64 v[112:113], v80 offset:16392
    ds_read_b64 v[114:115], v80 offset:16904
    ds_read_b64 v[116:117], v80 offset:17416
    s_waitcnt lgkmcnt(10)
    v_pk_maximum3_f16 v76, v76, v96, v96 neg_lo:[0,0,1] neg_hi:[0,0,1]
    v_pk_maximum3_f16 v77, v77, v97, v97 neg_lo:[0,0,1] neg_hi:[0,0,1]
    ds_read_b64 v[118:119], v80 offset:17928
    s_waitcnt lgkmcnt(10)
    v_pk_maximum3_f16 v76, v76, v98, v98 neg_lo:[0,0,1] neg_hi:[0,0,1]
    v_pk_maximum3_f16 v77, v77, v99, v99 neg_lo:[0,0,1] neg_hi:[0,0,1]
    ds_read_b64 v[120:121], v80 offset:3072
    s_waitcnt lgkmcnt(10)
    v_pk_maximum3_f16 v76, v76, v100, v100 neg_lo:[0,0,1] neg_hi:[0,0,1]
    v_pk_maximum3_f16 v77, v77, v101, v101 neg_lo:[0,0,1] neg_hi:[0,0,1]
    ds_read_b64 v[122:123], v80 offset:3584
    s_waitcnt lgkmcnt(10)
    v_pk_maximum3_f16 v76, v76, v102, v102 neg_lo:[0,0,1] neg_hi:[0,0,1]
    v_pk_maximum3_f16 v77, v77, v103, v103 neg_lo:[0,0,1] neg_hi:[0,0,1]
    ds_read_b64 v[124:125], v80 offset:4096
    s_waitcnt lgkmcnt(10)
    v_pk_maximum3_f16 v76, v76, v104, v104 neg_lo:[0,0,1] neg_hi:[0,0,1]
    v_pk_maximum3_f16 v77, v77, v105, v105 neg_lo:[0,0,1] neg_hi:[0,0,1]
    ds_read_b64 v[126:127], v80 offset:4608
    s_waitcnt lgkmcnt(10)
    v_pk_maximum3_f16 v76, v76, v106, v106 neg_lo:[0,0,1] neg_hi:[0,0,1]
    v_pk_maximum3_f16 v77, v77, v107, v107 neg_lo:[0,0,1] neg_hi:[0,0,1]
    ds_read_b64 v[128:129], v80 offset:5120
    s_waitcnt lgkmcnt(10)
    v_pk_maximum3_f16 v76, v76, v108, v108 neg_lo:[0,0,1] neg_hi:[0,0,1]
    v_pk_maximum3_f16 v77, v77, v109, v109 neg_lo:[0,0,1] neg_hi:[0,0,1]
    ds_read_b64 v[130:131], v80 offset:5632
    s_waitcnt lgkmcnt(10)
    v_pk_maximum3_f16 v76, v76, v110, v110 neg_lo:[0,0,1] neg_hi:[0,0,1]
    v_pk_maximum3_f16 v77, v77, v111, v111 neg_lo:[0,0,1] neg_hi:[0,0,1]
    ds_read_b64 v[132:133], v80 offset:18440
    s_waitcnt lgkmcnt(10)
    v_pk_maximum3_f16 v76, v76, v112, v112 neg_lo:[0,0,1] neg_hi:[0,0,1]
    v_pk_maximum3_f16 v77, v77, v113, v113 neg_lo:[0,0,1] neg_hi:[0,0,1]
    ds_read_b64 v[134:135], v80 offset:18952
    s_waitcnt lgkmcnt(10)
    v_pk_maximum3_f16 v76, v76, v114, v114 neg_lo:[0,0,1] neg_hi:[0,0,1]
    v_pk_maximum3_f16 v77, v77, v115, v115 neg_lo:[0,0,1] neg_hi:[0,0,1]
    ds_read_b64 v[136:137], v80 offset:19464
    s_waitcnt lgkmcnt(10)
    v_pk_maximum3_f16 v76, v76, v116, v116 neg_lo:[0,0,1] neg_hi:[0,0,1]
    v_pk_maximum3_f16 v77, v77, v117, v117 neg_lo:[0,0,1] neg_hi:[0,0,1]
    ds_read_b64 v[138:139], v80 offset:19976
    s_waitcnt lgkmcnt(10)
    v_pk_maximum3_f16 v76, v76, v118, v118 neg_lo:[0,0,1] neg_hi:[0,0,1]
    v_pk_maximum3_f16 v77, v77, v119, v119 neg_lo:[0,0,1] neg_hi:[0,0,1]
    ds_read_b64 v[140:141], v80 offset:20488
    s_waitcnt lgkmcnt(10)
    v_pk_maximum3_f16 v76, v76, v120, v120 neg_lo:[0,0,1] neg_hi:[0,0,1]
    v_pk_maximum3_f16 v77, v77, v121, v121 neg_lo:[0,0,1] neg_hi:[0,0,1]
    ds_read_b64 v[142:143], v80 offset:21000
    s_waitcnt lgkmcnt(10)
    v_pk_maximum3_f16 v76, v76, v122, v122 neg_lo:[0,0,1] neg_hi:[0,0,1]
    v_pk_maximum3_f16 v77, v77, v123, v123 neg_lo:[0,0,1] neg_hi:[0,0,1]
    ds_read_b64 v[144:145], v80 offset:6144
    s_waitcnt lgkmcnt(10)
    v_pk_maximum3_f16 v76, v76, v124, v124 neg_lo:[0,0,1] neg_hi:[0,0,1]
    v_pk_maximum3_f16 v77, v77, v125, v125 neg_lo:[0,0,1] neg_hi:[0,0,1]
    ds_read_b64 v[146:147], v80 offset:6656
    s_waitcnt lgkmcnt(10)
    v_pk_maximum3_f16 v76, v76, v126, v126 neg_lo:[0,0,1] neg_hi:[0,0,1]
    v_pk_maximum3_f16 v77, v77, v127, v127 neg_lo:[0,0,1] neg_hi:[0,0,1]
    ds_read_b64 v[148:149], v80 offset:7168
    s_waitcnt lgkmcnt(10)
    v_pk_maximum3_f16 v76, v76, v128, v128 neg_lo:[0,0,1] neg_hi:[0,0,1]
    v_pk_maximum3_f16 v77, v77, v129, v129 neg_lo:[0,0,1] neg_hi:[0,0,1]
    ds_read_b64 v[150:151], v80 offset:7680
    s_waitcnt lgkmcnt(10)
    v_pk_maximum3_f16 v76, v76, v130, v130 neg_lo:[0,0,1] neg_hi:[0,0,1]
    v_pk_maximum3_f16 v77, v77, v131, v131 neg_lo:[0,0,1] neg_hi:[0,0,1]
    ds_read_b64 v[152:153], v80 offset:8192
    s_waitcnt lgkmcnt(10)
    v_pk_maximum3_f16 v76, v76, v132, v132 neg_lo:[0,0,1] neg_hi:[0,0,1]
    v_pk_maximum3_f16 v77, v77, v133, v133 neg_lo:[0,0,1] neg_hi:[0,0,1]
    ds_read_b64 v[154:155], v80 offset:8704
    s_waitcnt lgkmcnt(10)
    v_pk_maximum3_f16 v76, v76, v134, v134 neg_lo:[0,0,1] neg_hi:[0,0,1]
    v_pk_maximum3_f16 v77, v77, v135, v135 neg_lo:[0,0,1] neg_hi:[0,0,1]
    ds_read_b64 v[156:157], v80 offset:21512
    s_waitcnt lgkmcnt(10)
    v_pk_maximum3_f16 v76, v76, v136, v136 neg_lo:[0,0,1] neg_hi:[0,0,1]
    v_pk_maximum3_f16 v77, v77, v137, v137 neg_lo:[0,0,1] neg_hi:[0,0,1]
    ds_read_b64 v[158:159], v80 offset:22024
    s_waitcnt lgkmcnt(10)
    v_pk_maximum3_f16 v76, v76, v138, v138 neg_lo:[0,0,1] neg_hi:[0,0,1]
    v_pk_maximum3_f16 v77, v77, v139, v139 neg_lo:[0,0,1] neg_hi:[0,0,1]
    ds_read_b64 v[160:161], v80 offset:22536
    s_waitcnt lgkmcnt(10)
    v_pk_maximum3_f16 v76, v76, v140, v140 neg_lo:[0,0,1] neg_hi:[0,0,1]
    v_pk_maximum3_f16 v77, v77, v141, v141 neg_lo:[0,0,1] neg_hi:[0,0,1]
    ds_read_b64 v[162:163], v80 offset:23048
    s_waitcnt lgkmcnt(10)
    v_pk_maximum3_f16 v76, v76, v142, v142 neg_lo:[0,0,1] neg_hi:[0,0,1]
    v_pk_maximum3_f16 v77, v77, v143, v143 neg_lo:[0,0,1] neg_hi:[0,0,1]
    ds_read_b64 v[164:165], v80 offset:23560
    s_waitcnt lgkmcnt(10)
    v_pk_maximum3_f16 v76, v76, v144, v144 neg_lo:[0,0,1] neg_hi:[0,0,1]
    v_pk_maximum3_f16 v77, v77, v145, v145 neg_lo:[0,0,1] neg_hi:[0,0,1]
    ds_read_b64 v[166:167], v80 offset:24072
    s_waitcnt lgkmcnt(10)
    v_pk_maximum3_f16 v76, v76, v146, v146 neg_lo:[0,0,1] neg_hi:[0,0,1]
    v_pk_maximum3_f16 v77, v77, v147, v147 neg_lo:[0,0,1] neg_hi:[0,0,1]
    ds_read_b64 v[168:169], v80 offset:12288
    s_waitcnt lgkmcnt(10)
    v_pk_maximum3_f16 v76, v76, v148, v148 neg_lo:[0,0,1] neg_hi:[0,0,1]
    v_pk_maximum3_f16 v77, v77, v149, v149 neg_lo:[0,0,1] neg_hi:[0,0,1]
    ds_read_b64 v[170:171], v80 offset:12800
    s_waitcnt lgkmcnt(10)
    v_pk_maximum3_f16 v76, v76, v150, v150 neg_lo:[0,0,1] neg_hi:[0,0,1]
    v_pk_maximum3_f16 v77, v77, v151, v151 neg_lo:[0,0,1] neg_hi:[0,0,1]
    ds_read_b64 v[172:173], v80 offset:13312
    s_waitcnt lgkmcnt(10)
    v_pk_maximum3_f16 v76, v76, v152, v152 neg_lo:[0,0,1] neg_hi:[0,0,1]
    v_pk_maximum3_f16 v77, v77, v153, v153 neg_lo:[0,0,1] neg_hi:[0,0,1]
    ds_read_b64 v[174:175], v80 offset:13824
    s_waitcnt lgkmcnt(10)
    v_pk_maximum3_f16 v76, v76, v154, v154 neg_lo:[0,0,1] neg_hi:[0,0,1]
    v_pk_maximum3_f16 v77, v77, v155, v155 neg_lo:[0,0,1] neg_hi:[0,0,1]
    ds_read_b64 v[176:177], v80 offset:14336
    s_waitcnt lgkmcnt(10)
    v_pk_maximum3_f16 v76, v76, v156, v156 neg_lo:[0,0,1] neg_hi:[0,0,1]
    v_pk_maximum3_f16 v77, v77, v157, v157 neg_lo:[0,0,1] neg_hi:[0,0,1]
    ds_read_b64 v[178:179], v80 offset:14848
    s_waitcnt lgkmcnt(10)
    v_pk_maximum3_f16 v76, v76, v158, v158 neg_lo:[0,0,1] neg_hi:[0,0,1]
    v_pk_maximum3_f16 v77, v77, v159, v159 neg_lo:[0,0,1] neg_hi:[0,0,1]
    ds_read_b64 v[180:181], v80 offset:27656
    s_waitcnt lgkmcnt(10)
    v_pk_maximum3_f16 v76, v76, v160, v160 neg_lo:[0,0,1] neg_hi:[0,0,1]
    v_pk_maximum3_f16 v77, v77, v161, v161 neg_lo:[0,0,1] neg_hi:[0,0,1]
    ds_read_b64 v[182:183], v80 offset:28168
    s_waitcnt lgkmcnt(10)
    v_pk_maximum3_f16 v76, v76, v162, v162 neg_lo:[0,0,1] neg_hi:[0,0,1]
    v_pk_maximum3_f16 v77, v77, v163, v163 neg_lo:[0,0,1] neg_hi:[0,0,1]
    ds_read_b64 v[184:185], v80 offset:28680
    s_waitcnt lgkmcnt(10)
    v_pk_maximum3_f16 v76, v76, v164, v164 neg_lo:[0,0,1] neg_hi:[0,0,1]
    v_pk_maximum3_f16 v77, v77, v165, v165 neg_lo:[0,0,1] neg_hi:[0,0,1]
    ds_read_b64 v[186:187], v80 offset:29192
    s_waitcnt lgkmcnt(10)
    v_pk_maximum3_f16 v76, v76, v166, v166 neg_lo:[0,0,1] neg_hi:[0,0,1]
    v_pk_maximum3_f16 v77, v77, v167, v167 neg_lo:[0,0,1] neg_hi:[0,0,1]
    ds_read_b64 v[188:189], v80 offset:29704
    s_waitcnt lgkmcnt(10)
    v_pk_maximum3_f16 v76, v76, v168, v168 neg_lo:[0,0,1] neg_hi:[0,0,1]
    v_pk_maximum3_f16 v77, v77, v169, v169 neg_lo:[0,0,1] neg_hi:[0,0,1]
    ds_read_b64 v[190:191], v80 offset:30216
    s_waitcnt lgkmcnt(10)
    v_pk_maximum3_f16 v76, v76, v170, v170 neg_lo:[0,0,1] neg_hi:[0,0,1]
    v_pk_maximum3_f16 v77, v77, v171, v171 neg_lo:[0,0,1] neg_hi:[0,0,1]
    s_waitcnt lgkmcnt(9)
    v_pk_maximum3_f16 v76, v76, v172, v172 neg_lo:[0,0,1] neg_hi:[0,0,1]
    v_pk_maximum3_f16 v77, v77, v173, v173 neg_lo:[0,0,1] neg_hi:[0,0,1]
    s_waitcnt lgkmcnt(8)
    v_pk_maximum3_f16 v76, v76, v174, v174 neg_lo:[0,0,1] neg_hi:[0,0,1]
    v_pk_maximum3_f16 v77, v77, v175, v175 neg_lo:[0,0,1] neg_hi:[0,0,1]
    s_waitcnt lgkmcnt(7)
    v_pk_maximum3_f16 v76, v76, v176, v176 neg_lo:[0,0,1] neg_hi:[0,0,1]
    v_pk_maximum3_f16 v77, v77, v177, v177 neg_lo:[0,0,1] neg_hi:[0,0,1]
    s_waitcnt lgkmcnt(6)
    v_pk_maximum3_f16 v76, v76, v178, v178 neg_lo:[0,0,1] neg_hi:[0,0,1]
    v_pk_maximum3_f16 v77, v77, v179, v179 neg_lo:[0,0,1] neg_hi:[0,0,1]
    s_waitcnt lgkmcnt(5)
    v_pk_maximum3_f16 v76, v76, v180, v180 neg_lo:[0,0,1] neg_hi:[0,0,1]
    v_pk_maximum3_f16 v77, v77, v181, v181 neg_lo:[0,0,1] neg_hi:[0,0,1]
    s_waitcnt lgkmcnt(4)
    v_pk_maximum3_f16 v76, v76, v182, v182 neg_lo:[0,0,1] neg_hi:[0,0,1]
    v_pk_maximum3_f16 v77, v77, v183, v183 neg_lo:[0,0,1] neg_hi:[0,0,1]
    s_waitcnt lgkmcnt(3)
    v_pk_maximum3_f16 v76, v76, v184, v184 neg_lo:[0,0,1] neg_hi:[0,0,1]
    v_pk_maximum3_f16 v77, v77, v185, v185 neg_lo:[0,0,1] neg_hi:[0,0,1]
    s_waitcnt lgkmcnt(2)
    v_pk_maximum3_f16 v76, v76, v186, v186 neg_lo:[0,0,1] neg_hi:[0,0,1]
    v_pk_maximum3_f16 v77, v77, v187, v187 neg_lo:[0,0,1] neg_hi:[0,0,1]
    s_waitcnt lgkmcnt(1)
    v_pk_maximum3_f16 v76, v76, v188, v188 neg_lo:[0,0,1] neg_hi:[0,0,1]
    v_pk_maximum3_f16 v77, v77, v189, v189 neg_lo:[0,0,1] neg_hi:[0,0,1]
    s_waitcnt lgkmcnt(0)
    v_pk_maximum3_f16 v76, v76, v190, v190 neg_lo:[0,0,1] neg_hi:[0,0,1]
    v_pk_maximum3_f16 v77, v77, v191, v191 neg_lo:[0,0,1] neg_hi:[0,0,1]
    v_mov_b32 v254, 161976
    v_mov_b32 v64, 6
    s_waitcnt vmcnt(18)
    ds_write_b32 v254, v64
    v_mov_b32 v65, 7
    s_waitcnt vmcnt(12)
    ds_write_b32 v254, v65
    v_mov_b32 v66, 8
    s_waitcnt vmcnt(6)
    ds_write_b32 v254, v66
    v_mov_b32 v67, 9
    s_waitcnt vmcnt(0)
    ds_write_b32 v254, v67
    v_add_u32 v254, 161940, v240

    s_mov_b32 s29, 200000
L_wg2:
    ds_read_b32 v255, v254
    s_waitcnt lgkmcnt(0)
    v_cmp_ne_u32 vcc, 0, v255
    s_cmp_eq_u64 vcc, exec
    s_cbranch_scc1 L_wg2_ok
    s_sleep 2
    s_sub_u32 s29, s29, 1
    s_cmp_lg_u32 s29, 0
    s_cbranch_scc1 L_wg2
L_wg2_ok:

    s_add_u32 s26, s39, 3
    s_cmp_ge_u32 s26, 12
    s_cselect_b32 s27, 12, 0
    s_sub_u32 s26, s26, s27
    s_mul_i32 s26, s26, 6144

    s_mov_b32 m0, 19456
    s_add_u32 s30, s26, 0
    s_add_u32 s31, s26, 1536
    buffer_load_dwordx4 v253, s[44:47], s30 offen lds
    buffer_load_dwordx4 v61, s[44:47], s30 offen offset:1024 lds
    buffer_load_dwordx4 v253, s[44:47], s31 offen offset:2048 lds
    s_mov_b32 m0, 85000
    s_add_u32 s30, s26, 1536
    s_add_u32 s31, s26, 3072
    buffer_load_dwordx4 v253, s[44:47], s30 offen lds
    buffer_load_dwordx4 v61, s[44:47], s30 offen offset:1024 lds
    buffer_load_dwordx4 v253, s[44:47], s31 offen offset:2048 lds

    s_add_u32 s26, s39, 6
    s_cmp_ge_u32 s26, 12
    s_cselect_b32 s27, 12, 0
    s_sub_u32 s26, s26, s27
    s_mul_i32 s26, s26, 64

    s_mov_b32 m0, 22528
    s_add_u32 s30, s26, 0
    s_add_u32 s31, s26, 23552
    s_add_u32 s32, s26, 47104
    buffer_load_dwordx4 v60, s[40:43], s30 offen offset:0 lds
    buffer_load_dwordx4 v60, s[40:43], s31 offen offset:1024 lds
    buffer_load_dwordx4 v60, s[40:43], s32 offen offset:2048 lds
    s_mov_b32 m0, 88072
    s_add_u32 s30, s26, 6144
    s_add_u32 s31, s26, 29696
    s_add_u32 s32, s26, 53248
    buffer_load_dwordx4 v60, s[40:43], s30 offen offset:0 lds
    buffer_load_dwordx4 v60, s[40:43], s31 offen offset:1024 lds
    buffer_load_dwordx4 v60, s[40:43], s32 offen offset:2048 lds

    s_add_u32 s26, s39, 4
    s_cmp_ge_u32 s26, 12
    s_cselect_b32 s27, 12, 0
    s_sub_u32 s26, s26, s27
    s_mul_i32 s26, s26, 6144

    s_mov_b32 m0, 25600
    s_add_u32 s30, s26, 0
    s_add_u32 s31, s26, 1536
    buffer_load_dwordx4 v253, s[44:47], s30 offen lds
    buffer_load_dwordx4 v61, s[44:47], s30 offen offset:1024 lds
    buffer_load_dwordx4 v253, s[44:47], s31 offen offset:2048 lds
    s_mov_b32 m0, 91144
    s_add_u32 s30, s26, 1536
    s_add_u32 s31, s26, 3072
    buffer_load_dwordx4 v253, s[44:47], s30 offen lds
    buffer_load_dwordx4 v61, s[44:47], s30 offen offset:1024 lds
    buffer_load_dwordx4 v253, s[44:47], s31 offen offset:2048 lds

    s_add_u32 s26, s39, 7
    s_cmp_ge_u32 s26, 12
    s_cselect_b32 s27, 12, 0
    s_sub_u32 s26, s26, s27
    s_mul_i32 s26, s26, 64

    s_mov_b32 m0, 28672
    s_add_u32 s30, s26, 0
    s_add_u32 s31, s26, 23552
    s_add_u32 s32, s26, 47104
    buffer_load_dwordx4 v60, s[40:43], s30 offen offset:0 lds
    buffer_load_dwordx4 v60, s[40:43], s31 offen offset:1024 lds
    buffer_load_dwordx4 v60, s[40:43], s32 offen offset:2048 lds
    s_mov_b32 m0, 94216
    s_add_u32 s30, s26, 6144
    s_add_u32 s31, s26, 29696
    s_add_u32 s32, s26, 53248
    buffer_load_dwordx4 v60, s[40:43], s30 offen offset:0 lds
    buffer_load_dwordx4 v60, s[40:43], s31 offen offset:1024 lds
    buffer_load_dwordx4 v60, s[40:43], s32 offen offset:2048 lds

    s_add_u32 s26, s39, 5
    s_cmp_ge_u32 s26, 12
    s_cselect_b32 s27, 12, 0
    s_sub_u32 s26, s26, s27
    s_mul_i32 s26, s26, 6144

    s_mov_b32 m0, 31744
    s_add_u32 s30, s26, 0
    s_add_u32 s31, s26, 1536
    buffer_load_dwordx4 v253, s[44:47], s30 offen lds
    buffer_load_dwordx4 v61, s[44:47], s30 offen offset:1024 lds
    buffer_load_dwordx4 v253, s[44:47], s31 offen offset:2048 lds
    s_mov_b32 m0, 97288
    s_add_u32 s30, s26, 1536
    s_add_u32 s31, s26, 3072
    buffer_load_dwordx4 v253, s[44:47], s30 offen lds
    buffer_load_dwordx4 v61, s[44:47], s30 offen offset:1024 lds
    buffer_load_dwordx4 v253, s[44:47], s31 offen offset:2048 lds
    ds_read_b64 v[96:97], v78 offset:10240
    ds_read_b64 v[98:99], v78 offset:10752
    ds_read_b64 v[100:101], v78 offset:11264
    ds_read_b64 v[102:103], v78 offset:11776
    ds_read_b64 v[104:105], v78 offset:12288
    ds_read_b64 v[106:107], v78 offset:12800
    ds_read_b64 v[108:109], v79 offset:10240
    ds_read_b64 v[110:111], v79 offset:10752
    ds_read_b64 v[112:113], v79 offset:11264
    ds_read_b64 v[114:115], v79 offset:11776
    ds_read_b64 v[116:117], v79 offset:12288
    s_waitcnt lgkmcnt(10)
    v_pk_maximum3_f16 v76, v76, v96, v96 neg_lo:[0,0,1] neg_hi:[0,0,1]
    v_pk_maximum3_f16 v77, v77, v97, v97 neg_lo:[0,0,1] neg_hi:[0,0,1]
    ds_read_b64 v[118:119], v79 offset:12800
    s_waitcnt lgkmcnt(10)
    v_pk_maximum3_f16 v76, v76, v98, v98 neg_lo:[0,0,1] neg_hi:[0,0,1]
    v_pk_maximum3_f16 v77, v77, v99, v99 neg_lo:[0,0,1] neg_hi:[0,0,1]
    ds_read_b64 v[120:121], v78 offset:16384
    s_waitcnt lgkmcnt(10)
    v_pk_maximum3_f16 v76, v76, v100, v100 neg_lo:[0,0,1] neg_hi:[0,0,1]
    v_pk_maximum3_f16 v77, v77, v101, v101 neg_lo:[0,0,1] neg_hi:[0,0,1]
    ds_read_b64 v[122:123], v78 offset:16896
    s_waitcnt lgkmcnt(10)
    v_pk_maximum3_f16 v76, v76, v102, v102 neg_lo:[0,0,1] neg_hi:[0,0,1]
    v_pk_maximum3_f16 v77, v77, v103, v103 neg_lo:[0,0,1] neg_hi:[0,0,1]
    ds_read_b64 v[124:125], v78 offset:17408
    s_waitcnt lgkmcnt(10)
    v_pk_maximum3_f16 v76, v76, v104, v104 neg_lo:[0,0,1] neg_hi:[0,0,1]
    v_pk_maximum3_f16 v77, v77, v105, v105 neg_lo:[0,0,1] neg_hi:[0,0,1]
    ds_read_b64 v[126:127], v78 offset:17920
    s_waitcnt lgkmcnt(10)
    v_pk_maximum3_f16 v76, v76, v106, v106 neg_lo:[0,0,1] neg_hi:[0,0,1]
    v_pk_maximum3_f16 v77, v77, v107, v107 neg_lo:[0,0,1] neg_hi:[0,0,1]
    ds_read_b64 v[128:129], v78 offset:18432
    s_waitcnt lgkmcnt(10)
    v_pk_maximum3_f16 v76, v76, v108, v108 neg_lo:[0,0,1] neg_hi:[0,0,1]
    v_pk_maximum3_f16 v77, v77, v109, v109 neg_lo:[0,0,1] neg_hi:[0,0,1]
    ds_read_b64 v[130:131], v78 offset:18944
    s_waitcnt lgkmcnt(10)
    v_pk_maximum3_f16 v76, v76, v110, v110 neg_lo:[0,0,1] neg_hi:[0,0,1]
    v_pk_maximum3_f16 v77, v77, v111, v111 neg_lo:[0,0,1] neg_hi:[0,0,1]
    ds_read_b64 v[132:133], v79 offset:16384
    s_waitcnt lgkmcnt(10)
    v_pk_maximum3_f16 v76, v76, v112, v112 neg_lo:[0,0,1] neg_hi:[0,0,1]
    v_pk_maximum3_f16 v77, v77, v113, v113 neg_lo:[0,0,1] neg_hi:[0,0,1]
    ds_read_b64 v[134:135], v79 offset:16896
    s_waitcnt lgkmcnt(10)
    v_pk_maximum3_f16 v76, v76, v114, v114 neg_lo:[0,0,1] neg_hi:[0,0,1]
    v_pk_maximum3_f16 v77, v77, v115, v115 neg_lo:[0,0,1] neg_hi:[0,0,1]
    ds_read_b64 v[136:137], v79 offset:17408
    s_waitcnt lgkmcnt(10)
    v_pk_maximum3_f16 v76, v76, v116, v116 neg_lo:[0,0,1] neg_hi:[0,0,1]
    v_pk_maximum3_f16 v77, v77, v117, v117 neg_lo:[0,0,1] neg_hi:[0,0,1]
    ds_read_b64 v[138:139], v79 offset:17920
    s_waitcnt lgkmcnt(10)
    v_pk_maximum3_f16 v76, v76, v118, v118 neg_lo:[0,0,1] neg_hi:[0,0,1]
    v_pk_maximum3_f16 v77, v77, v119, v119 neg_lo:[0,0,1] neg_hi:[0,0,1]
    ds_read_b64 v[140:141], v79 offset:18432
    s_waitcnt lgkmcnt(10)
    v_pk_maximum3_f16 v76, v76, v120, v120 neg_lo:[0,0,1] neg_hi:[0,0,1]
    v_pk_maximum3_f16 v77, v77, v121, v121 neg_lo:[0,0,1] neg_hi:[0,0,1]
    ds_read_b64 v[142:143], v79 offset:18944
    s_waitcnt lgkmcnt(10)
    v_pk_maximum3_f16 v76, v76, v122, v122 neg_lo:[0,0,1] neg_hi:[0,0,1]
    v_pk_maximum3_f16 v77, v77, v123, v123 neg_lo:[0,0,1] neg_hi:[0,0,1]
    s_waitcnt lgkmcnt(9)
    v_pk_maximum3_f16 v76, v76, v124, v124 neg_lo:[0,0,1] neg_hi:[0,0,1]
    v_pk_maximum3_f16 v77, v77, v125, v125 neg_lo:[0,0,1] neg_hi:[0,0,1]
    s_waitcnt lgkmcnt(8)
    v_pk_maximum3_f16 v76, v76, v126, v126 neg_lo:[0,0,1] neg_hi:[0,0,1]
    v_pk_maximum3_f16 v77, v77, v127, v127 neg_lo:[0,0,1] neg_hi:[0,0,1]
    s_waitcnt lgkmcnt(7)
    v_pk_maximum3_f16 v76, v76, v128, v128 neg_lo:[0,0,1] neg_hi:[0,0,1]
    v_pk_maximum3_f16 v77, v77, v129, v129 neg_lo:[0,0,1] neg_hi:[0,0,1]
    s_waitcnt lgkmcnt(6)
    v_pk_maximum3_f16 v76, v76, v130, v130 neg_lo:[0,0,1] neg_hi:[0,0,1]
    v_pk_maximum3_f16 v77, v77, v131, v131 neg_lo:[0,0,1] neg_hi:[0,0,1]
    s_waitcnt lgkmcnt(5)
    v_pk_maximum3_f16 v76, v76, v132, v132 neg_lo:[0,0,1] neg_hi:[0,0,1]
    v_pk_maximum3_f16 v77, v77, v133, v133 neg_lo:[0,0,1] neg_hi:[0,0,1]
    s_waitcnt lgkmcnt(4)
    v_pk_maximum3_f16 v76, v76, v134, v134 neg_lo:[0,0,1] neg_hi:[0,0,1]
    v_pk_maximum3_f16 v77, v77, v135, v135 neg_lo:[0,0,1] neg_hi:[0,0,1]
    s_waitcnt lgkmcnt(3)
    v_pk_maximum3_f16 v76, v76, v136, v136 neg_lo:[0,0,1] neg_hi:[0,0,1]
    v_pk_maximum3_f16 v77, v77, v137, v137 neg_lo:[0,0,1] neg_hi:[0,0,1]
    s_waitcnt lgkmcnt(2)
    v_pk_maximum3_f16 v76, v76, v138, v138 neg_lo:[0,0,1] neg_hi:[0,0,1]
    v_pk_maximum3_f16 v77, v77, v139, v139 neg_lo:[0,0,1] neg_hi:[0,0,1]
    s_waitcnt lgkmcnt(1)
    v_pk_maximum3_f16 v76, v76, v140, v140 neg_lo:[0,0,1] neg_hi:[0,0,1]
    v_pk_maximum3_f16 v77, v77, v141, v141 neg_lo:[0,0,1] neg_hi:[0,0,1]
    s_waitcnt lgkmcnt(0)
    v_pk_maximum3_f16 v76, v76, v142, v142 neg_lo:[0,0,1] neg_hi:[0,0,1]
    v_pk_maximum3_f16 v77, v77, v143, v143 neg_lo:[0,0,1] neg_hi:[0,0,1]
    v_mov_b32 v254, 161976
    v_mov_b32 v64, 10
    s_waitcnt vmcnt(24)
    ds_write_b32 v254, v64
    v_mov_b32 v65, 11
    s_waitcnt vmcnt(18)
    ds_write_b32 v254, v65
    v_mov_b32 v66, 12
    s_waitcnt vmcnt(12)
    ds_write_b32 v254, v66
    v_mov_b32 v67, 13
    s_waitcnt vmcnt(6)
    ds_write_b32 v254, v67
    v_mov_b32 v68, 14
    s_waitcnt vmcnt(0)
    ds_write_b32 v254, v68
    v_add_u32 v254, 161948, v240

    s_mov_b32 s29, 200000
L_wg3:
    ds_read_b32 v255, v254
    s_waitcnt lgkmcnt(0)
    v_cmp_ne_u32 vcc, 0, v255
    s_cmp_eq_u64 vcc, exec
    s_cbranch_scc1 L_wg3_ok
    s_sleep 2
    s_sub_u32 s29, s29, 1
    s_cmp_lg_u32 s29, 0
    s_cbranch_scc1 L_wg3
L_wg3_ok:

    s_add_u32 s26, s39, 8
    s_cmp_ge_u32 s26, 12
    s_cselect_b32 s27, 12, 0
    s_sub_u32 s26, s26, s27
    s_mul_i32 s26, s26, 64

    s_mov_b32 m0, 34816
    s_add_u32 s30, s26, 0
    s_add_u32 s31, s26, 23552
    s_add_u32 s32, s26, 47104
    buffer_load_dwordx4 v60, s[40:43], s30 offen offset:0 lds
    buffer_load_dwordx4 v60, s[40:43], s31 offen offset:1024 lds
    buffer_load_dwordx4 v60, s[40:43], s32 offen offset:2048 lds
    s_mov_b32 m0, 100360
    s_add_u32 s30, s26, 6144
    s_add_u32 s31, s26, 29696
    s_add_u32 s32, s26, 53248
    buffer_load_dwordx4 v60, s[40:43], s30 offen offset:0 lds
    buffer_load_dwordx4 v60, s[40:43], s31 offen offset:1024 lds
    buffer_load_dwordx4 v60, s[40:43], s32 offen offset:2048 lds

    s_add_u32 s26, s39, 6
    s_cmp_ge_u32 s26, 12
    s_cselect_b32 s27, 12, 0
    s_sub_u32 s26, s26, s27
    s_mul_i32 s26, s26, 6144

    s_mov_b32 m0, 37888
    s_add_u32 s30, s26, 0
    s_add_u32 s31, s26, 1536
    buffer_load_dwordx4 v253, s[44:47], s30 offen lds
    buffer_load_dwordx4 v61, s[44:47], s30 offen offset:1024 lds
    buffer_load_dwordx4 v253, s[44:47], s31 offen offset:2048 lds
    s_mov_b32 m0, 103432
    s_add_u32 s30, s26, 1536
    s_add_u32 s31, s26, 3072
    buffer_load_dwordx4 v253, s[44:47], s30 offen lds
    buffer_load_dwordx4 v61, s[44:47], s30 offen offset:1024 lds
    buffer_load_dwordx4 v253, s[44:47], s31 offen offset:2048 lds

    s_add_u32 s26, s39, 9
    s_cmp_ge_u32 s26, 12
    s_cselect_b32 s27, 12, 0
    s_sub_u32 s26, s26, s27
    s_mul_i32 s26, s26, 64

    s_mov_b32 m0, 40960
    s_add_u32 s30, s26, 0
    s_add_u32 s31, s26, 23552
    s_add_u32 s32, s26, 47104
    buffer_load_dwordx4 v60, s[40:43], s30 offen offset:0 lds
    buffer_load_dwordx4 v60, s[40:43], s31 offen offset:1024 lds
    buffer_load_dwordx4 v60, s[40:43], s32 offen offset:2048 lds
    s_mov_b32 m0, 106504
    s_add_u32 s30, s26, 6144
    s_add_u32 s31, s26, 29696
    s_add_u32 s32, s26, 53248
    buffer_load_dwordx4 v60, s[40:43], s30 offen offset:0 lds
    buffer_load_dwordx4 v60, s[40:43], s31 offen offset:1024 lds
    buffer_load_dwordx4 v60, s[40:43], s32 offen offset:2048 lds

    s_add_u32 s26, s39, 7
    s_cmp_ge_u32 s26, 12
    s_cselect_b32 s27, 12, 0
    s_sub_u32 s26, s26, s27
    s_mul_i32 s26, s26, 6144

    s_mov_b32 m0, 44032
    s_add_u32 s30, s26, 0
    s_add_u32 s31, s26, 1536
    buffer_load_dwordx4 v253, s[44:47], s30 offen lds
    buffer_load_dwordx4 v61, s[44:47], s30 offen offset:1024 lds
    buffer_load_dwordx4 v253, s[44:47], s31 offen offset:2048 lds
    s_mov_b32 m0, 109576
    s_add_u32 s30, s26, 1536
    s_add_u32 s31, s26, 3072
    buffer_load_dwordx4 v253, s[44:47], s30 offen lds
    buffer_load_dwordx4 v61, s[44:47], s30 offen offset:1024 lds
    buffer_load_dwordx4 v253, s[44:47], s31 offen offset:2048 lds

    s_add_u32 s26, s39, 10
    s_cmp_ge_u32 s26, 12
    s_cselect_b32 s27, 12, 0
    s_sub_u32 s26, s26, s27
    s_mul_i32 s26, s26, 64

    s_mov_b32 m0, 47104
    s_add_u32 s30, s26, 0
    s_add_u32 s31, s26, 23552
    s_add_u32 s32, s26, 47104
    buffer_load_dwordx4 v60, s[40:43], s30 offen offset:0 lds
    buffer_load_dwordx4 v60, s[40:43], s31 offen offset:1024 lds
    buffer_load_dwordx4 v60, s[40:43], s32 offen offset:2048 lds
    s_mov_b32 m0, 112648
    s_add_u32 s30, s26, 6144
    s_add_u32 s31, s26, 29696
    s_add_u32 s32, s26, 53248
    buffer_load_dwordx4 v60, s[40:43], s30 offen offset:0 lds
    buffer_load_dwordx4 v60, s[40:43], s31 offen offset:1024 lds
    buffer_load_dwordx4 v60, s[40:43], s32 offen offset:2048 lds

    s_add_u32 s26, s39, 8
    s_cmp_ge_u32 s26, 12
    s_cselect_b32 s27, 12, 0
    s_sub_u32 s26, s26, s27
    s_mul_i32 s26, s26, 6144

    s_mov_b32 m0, 50176
    s_add_u32 s30, s26, 0
    s_add_u32 s31, s26, 1536
    buffer_load_dwordx4 v253, s[44:47], s30 offen lds
    buffer_load_dwordx4 v61, s[44:47], s30 offen offset:1024 lds
    buffer_load_dwordx4 v253, s[44:47], s31 offen offset:2048 lds
    s_mov_b32 m0, 115720
    s_add_u32 s30, s26, 1536
    s_add_u32 s31, s26, 3072
    buffer_load_dwordx4 v253, s[44:47], s30 offen lds
    buffer_load_dwordx4 v61, s[44:47], s30 offen offset:1024 lds
    buffer_load_dwordx4 v253, s[44:47], s31 offen offset:2048 lds

    s_add_u32 s26, s39, 11
    s_cmp_ge_u32 s26, 12
    s_cselect_b32 s27, 12, 0
    s_sub_u32 s26, s26, s27
    s_mul_i32 s26, s26, 64

    s_mov_b32 m0, 53248
    s_add_u32 s30, s26, 0
    s_add_u32 s31, s26, 23552
    s_add_u32 s32, s26, 47104
    buffer_load_dwordx4 v60, s[40:43], s30 offen offset:0 lds
    buffer_load_dwordx4 v60, s[40:43], s31 offen offset:1024 lds
    buffer_load_dwordx4 v60, s[40:43], s32 offen offset:2048 lds
    s_mov_b32 m0, 118792
    s_add_u32 s30, s26, 6144
    s_add_u32 s31, s26, 29696
    s_add_u32 s32, s26, 53248
    buffer_load_dwordx4 v60, s[40:43], s30 offen offset:0 lds
    buffer_load_dwordx4 v60, s[40:43], s31 offen offset:1024 lds
    buffer_load_dwordx4 v60, s[40:43], s32 offen offset:2048 lds

    s_add_u32 s26, s39, 9
    s_cmp_ge_u32 s26, 12
    s_cselect_b32 s27, 12, 0
    s_sub_u32 s26, s26, s27
    s_mul_i32 s26, s26, 6144

    s_mov_b32 m0, 56320
    s_add_u32 s30, s26, 0
    s_add_u32 s31, s26, 1536
    buffer_load_dwordx4 v253, s[44:47], s30 offen lds
    buffer_load_dwordx4 v61, s[44:47], s30 offen offset:1024 lds
    buffer_load_dwordx4 v253, s[44:47], s31 offen offset:2048 lds
    s_mov_b32 m0, 121864
    s_add_u32 s30, s26, 1536
    s_add_u32 s31, s26, 3072
    buffer_load_dwordx4 v253, s[44:47], s30 offen lds
    buffer_load_dwordx4 v61, s[44:47], s30 offen offset:1024 lds
    buffer_load_dwordx4 v253, s[44:47], s31 offen offset:2048 lds

    s_add_u32 s26, s39, 10
    s_cmp_ge_u32 s26, 12
    s_cselect_b32 s27, 12, 0
    s_sub_u32 s26, s26, s27
    s_mul_i32 s26, s26, 6144

    s_mov_b32 m0, 59392
    s_add_u32 s30, s26, 0
    s_add_u32 s31, s26, 1536
    buffer_load_dwordx4 v253, s[44:47], s30 offen lds
    buffer_load_dwordx4 v61, s[44:47], s30 offen offset:1024 lds
    buffer_load_dwordx4 v253, s[44:47], s31 offen offset:2048 lds
    s_mov_b32 m0, 124936
    s_add_u32 s30, s26, 1536
    s_add_u32 s31, s26, 3072
    buffer_load_dwordx4 v253, s[44:47], s30 offen lds
    buffer_load_dwordx4 v61, s[44:47], s30 offen offset:1024 lds
    buffer_load_dwordx4 v253, s[44:47], s31 offen offset:2048 lds

    s_add_u32 s26, s39, 11
    s_cmp_ge_u32 s26, 12
    s_cselect_b32 s27, 12, 0
    s_sub_u32 s26, s26, s27
    s_mul_i32 s26, s26, 6144

    s_mov_b32 m0, 62464
    s_add_u32 s30, s26, 0
    s_add_u32 s31, s26, 1536
    buffer_load_dwordx4 v253, s[44:47], s30 offen lds
    buffer_load_dwordx4 v61, s[44:47], s30 offen offset:1024 lds
    buffer_load_dwordx4 v253, s[44:47], s31 offen offset:2048 lds
    s_mov_b32 m0, 128008
    s_add_u32 s30, s26, 1536
    s_add_u32 s31, s26, 3072
    buffer_load_dwordx4 v253, s[44:47], s30 offen lds
    buffer_load_dwordx4 v61, s[44:47], s30 offen offset:1024 lds
    buffer_load_dwordx4 v253, s[44:47], s31 offen offset:2048 lds
    ds_read_b64 v[96:97], v78 offset:22528
    ds_read_b64 v[98:99], v78 offset:23040
    ds_read_b64 v[100:101], v78 offset:23552
    ds_read_b64 v[102:103], v78 offset:24064
    ds_read_b64 v[104:105], v78 offset:24576
    ds_read_b64 v[106:107], v78 offset:25088
    ds_read_b64 v[108:109], v79 offset:22528
    ds_read_b64 v[110:111], v79 offset:23040
    ds_read_b64 v[112:113], v79 offset:23552
    ds_read_b64 v[114:115], v79 offset:24064
    ds_read_b64 v[116:117], v79 offset:24576
    s_waitcnt lgkmcnt(10)
    v_pk_maximum3_f16 v76, v76, v96, v96 neg_lo:[0,0,1] neg_hi:[0,0,1]
    v_pk_maximum3_f16 v77, v77, v97, v97 neg_lo:[0,0,1] neg_hi:[0,0,1]
    ds_read_b64 v[118:119], v79 offset:25088
    s_waitcnt lgkmcnt(10)
    v_pk_maximum3_f16 v76, v76, v98, v98 neg_lo:[0,0,1] neg_hi:[0,0,1]
    v_pk_maximum3_f16 v77, v77, v99, v99 neg_lo:[0,0,1] neg_hi:[0,0,1]
    ds_read_b64 v[120:121], v78 offset:28672
    s_waitcnt lgkmcnt(10)
    v_pk_maximum3_f16 v76, v76, v100, v100 neg_lo:[0,0,1] neg_hi:[0,0,1]
    v_pk_maximum3_f16 v77, v77, v101, v101 neg_lo:[0,0,1] neg_hi:[0,0,1]
    ds_read_b64 v[122:123], v78 offset:29184
    s_waitcnt lgkmcnt(10)
    v_pk_maximum3_f16 v76, v76, v102, v102 neg_lo:[0,0,1] neg_hi:[0,0,1]
    v_pk_maximum3_f16 v77, v77, v103, v103 neg_lo:[0,0,1] neg_hi:[0,0,1]
    ds_read_b64 v[124:125], v78 offset:29696
    s_waitcnt lgkmcnt(10)
    v_pk_maximum3_f16 v76, v76, v104, v104 neg_lo:[0,0,1] neg_hi:[0,0,1]
    v_pk_maximum3_f16 v77, v77, v105, v105 neg_lo:[0,0,1] neg_hi:[0,0,1]
    ds_read_b64 v[126:127], v78 offset:30208
    s_waitcnt lgkmcnt(10)
    v_pk_maximum3_f16 v76, v76, v106, v106 neg_lo:[0,0,1] neg_hi:[0,0,1]
    v_pk_maximum3_f16 v77, v77, v107, v107 neg_lo:[0,0,1] neg_hi:[0,0,1]
    ds_read_b64 v[128:129], v78 offset:30720
    s_waitcnt lgkmcnt(10)
    v_pk_maximum3_f16 v76, v76, v108, v108 neg_lo:[0,0,1] neg_hi:[0,0,1]
    v_pk_maximum3_f16 v77, v77, v109, v109 neg_lo:[0,0,1] neg_hi:[0,0,1]
    ds_read_b64 v[130:131], v78 offset:31232
    s_waitcnt lgkmcnt(10)
    v_pk_maximum3_f16 v76, v76, v110, v110 neg_lo:[0,0,1] neg_hi:[0,0,1]
    v_pk_maximum3_f16 v77, v77, v111, v111 neg_lo:[0,0,1] neg_hi:[0,0,1]
    ds_read_b64 v[132:133], v79 offset:28672
    s_waitcnt lgkmcnt(10)
    v_pk_maximum3_f16 v76, v76, v112, v112 neg_lo:[0,0,1] neg_hi:[0,0,1]
    v_pk_maximum3_f16 v77, v77, v113, v113 neg_lo:[0,0,1] neg_hi:[0,0,1]
    ds_read_b64 v[134:135], v79 offset:29184
    s_waitcnt lgkmcnt(10)
    v_pk_maximum3_f16 v76, v76, v114, v114 neg_lo:[0,0,1] neg_hi:[0,0,1]
    v_pk_maximum3_f16 v77, v77, v115, v115 neg_lo:[0,0,1] neg_hi:[0,0,1]
    ds_read_b64 v[136:137], v79 offset:29696
    s_waitcnt lgkmcnt(10)
    v_pk_maximum3_f16 v76, v76, v116, v116 neg_lo:[0,0,1] neg_hi:[0,0,1]
    v_pk_maximum3_f16 v77, v77, v117, v117 neg_lo:[0,0,1] neg_hi:[0,0,1]
    ds_read_b64 v[138:139], v79 offset:30208
    s_waitcnt lgkmcnt(10)
    v_pk_maximum3_f16 v76, v76, v118, v118 neg_lo:[0,0,1] neg_hi:[0,0,1]
    v_pk_maximum3_f16 v77, v77, v119, v119 neg_lo:[0,0,1] neg_hi:[0,0,1]
    ds_read_b64 v[140:141], v79 offset:30720
    s_waitcnt lgkmcnt(10)
    v_pk_maximum3_f16 v76, v76, v120, v120 neg_lo:[0,0,1] neg_hi:[0,0,1]
    v_pk_maximum3_f16 v77, v77, v121, v121 neg_lo:[0,0,1] neg_hi:[0,0,1]
    ds_read_b64 v[142:143], v79 offset:31232
    s_waitcnt lgkmcnt(10)
    v_pk_maximum3_f16 v76, v76, v122, v122 neg_lo:[0,0,1] neg_hi:[0,0,1]
    v_pk_maximum3_f16 v77, v77, v123, v123 neg_lo:[0,0,1] neg_hi:[0,0,1]
    s_waitcnt lgkmcnt(9)
    v_pk_maximum3_f16 v76, v76, v124, v124 neg_lo:[0,0,1] neg_hi:[0,0,1]
    v_pk_maximum3_f16 v77, v77, v125, v125 neg_lo:[0,0,1] neg_hi:[0,0,1]
    s_waitcnt lgkmcnt(8)
    v_pk_maximum3_f16 v76, v76, v126, v126 neg_lo:[0,0,1] neg_hi:[0,0,1]
    v_pk_maximum3_f16 v77, v77, v127, v127 neg_lo:[0,0,1] neg_hi:[0,0,1]
    s_waitcnt lgkmcnt(7)
    v_pk_maximum3_f16 v76, v76, v128, v128 neg_lo:[0,0,1] neg_hi:[0,0,1]
    v_pk_maximum3_f16 v77, v77, v129, v129 neg_lo:[0,0,1] neg_hi:[0,0,1]
    s_waitcnt lgkmcnt(6)
    v_pk_maximum3_f16 v76, v76, v130, v130 neg_lo:[0,0,1] neg_hi:[0,0,1]
    v_pk_maximum3_f16 v77, v77, v131, v131 neg_lo:[0,0,1] neg_hi:[0,0,1]
    s_waitcnt lgkmcnt(5)
    v_pk_maximum3_f16 v76, v76, v132, v132 neg_lo:[0,0,1] neg_hi:[0,0,1]
    v_pk_maximum3_f16 v77, v77, v133, v133 neg_lo:[0,0,1] neg_hi:[0,0,1]
    s_waitcnt lgkmcnt(4)
    v_pk_maximum3_f16 v76, v76, v134, v134 neg_lo:[0,0,1] neg_hi:[0,0,1]
    v_pk_maximum3_f16 v77, v77, v135, v135 neg_lo:[0,0,1] neg_hi:[0,0,1]
    s_waitcnt lgkmcnt(3)
    v_pk_maximum3_f16 v76, v76, v136, v136 neg_lo:[0,0,1] neg_hi:[0,0,1]
    v_pk_maximum3_f16 v77, v77, v137, v137 neg_lo:[0,0,1] neg_hi:[0,0,1]
    s_waitcnt lgkmcnt(2)
    v_pk_maximum3_f16 v76, v76, v138, v138 neg_lo:[0,0,1] neg_hi:[0,0,1]
    v_pk_maximum3_f16 v77, v77, v139, v139 neg_lo:[0,0,1] neg_hi:[0,0,1]
    s_waitcnt lgkmcnt(1)
    v_pk_maximum3_f16 v76, v76, v140, v140 neg_lo:[0,0,1] neg_hi:[0,0,1]
    v_pk_maximum3_f16 v77, v77, v141, v141 neg_lo:[0,0,1] neg_hi:[0,0,1]
    s_waitcnt lgkmcnt(0)
    v_pk_maximum3_f16 v76, v76, v142, v142 neg_lo:[0,0,1] neg_hi:[0,0,1]
    v_pk_maximum3_f16 v77, v77, v143, v143 neg_lo:[0,0,1] neg_hi:[0,0,1]
    v_mov_b32 v254, 161976
    v_mov_b32 v64, 15
    s_waitcnt vmcnt(54)
    ds_write_b32 v254, v64
    v_mov_b32 v65, 16
    s_waitcnt vmcnt(48)
    ds_write_b32 v254, v65
    v_mov_b32 v66, 17
    s_waitcnt vmcnt(42)
    ds_write_b32 v254, v66
    v_mov_b32 v67, 18
    s_waitcnt vmcnt(36)
    ds_write_b32 v254, v67
    v_mov_b32 v68, 19
    s_waitcnt vmcnt(30)
    ds_write_b32 v254, v68
    v_mov_b32 v69, 20
    s_waitcnt vmcnt(24)
    ds_write_b32 v254, v69
    v_mov_b32 v70, 21
    s_waitcnt vmcnt(18)
    ds_write_b32 v254, v70
    v_mov_b32 v71, 22
    s_waitcnt vmcnt(12)
    ds_write_b32 v254, v71
    v_mov_b32 v72, 23
    s_waitcnt vmcnt(6)
    ds_write_b32 v254, v72
    v_mov_b32 v73, 24
    s_waitcnt vmcnt(0)
    ds_write_b32 v254, v73
    s_waitcnt lgkmcnt(0)
    ds_read_b64 v[96:97], v78 offset:34816
    ds_read_b64 v[98:99], v78 offset:35328
    ds_read_b64 v[100:101], v78 offset:35840
    ds_read_b64 v[102:103], v78 offset:36352
    ds_read_b64 v[104:105], v78 offset:36864
    ds_read_b64 v[106:107], v78 offset:37376
    ds_read_b64 v[108:109], v79 offset:34816
    ds_read_b64 v[110:111], v79 offset:35328
    ds_read_b64 v[112:113], v79 offset:35840
    ds_read_b64 v[114:115], v79 offset:36352
    ds_read_b64 v[116:117], v79 offset:36864
    s_waitcnt lgkmcnt(10)
    v_pk_maximum3_f16 v76, v76, v96, v96 neg_lo:[0,0,1] neg_hi:[0,0,1]
    v_pk_maximum3_f16 v77, v77, v97, v97 neg_lo:[0,0,1] neg_hi:[0,0,1]
    ds_read_b64 v[118:119], v79 offset:37376
    s_waitcnt lgkmcnt(10)
    v_pk_maximum3_f16 v76, v76, v98, v98 neg_lo:[0,0,1] neg_hi:[0,0,1]
    v_pk_maximum3_f16 v77, v77, v99, v99 neg_lo:[0,0,1] neg_hi:[0,0,1]
    ds_read_b64 v[120:121], v78 offset:40960
    s_waitcnt lgkmcnt(10)
    v_pk_maximum3_f16 v76, v76, v100, v100 neg_lo:[0,0,1] neg_hi:[0,0,1]
    v_pk_maximum3_f16 v77, v77, v101, v101 neg_lo:[0,0,1] neg_hi:[0,0,1]
    ds_read_b64 v[122:123], v78 offset:41472
    s_waitcnt lgkmcnt(10)
    v_pk_maximum3_f16 v76, v76, v102, v102 neg_lo:[0,0,1] neg_hi:[0,0,1]
    v_pk_maximum3_f16 v77, v77, v103, v103 neg_lo:[0,0,1] neg_hi:[0,0,1]
    ds_read_b64 v[124:125], v78 offset:41984
    s_waitcnt lgkmcnt(10)
    v_pk_maximum3_f16 v76, v76, v104, v104 neg_lo:[0,0,1] neg_hi:[0,0,1]
    v_pk_maximum3_f16 v77, v77, v105, v105 neg_lo:[0,0,1] neg_hi:[0,0,1]
    ds_read_b64 v[126:127], v78 offset:42496
    s_waitcnt lgkmcnt(10)
    v_pk_maximum3_f16 v76, v76, v106, v106 neg_lo:[0,0,1] neg_hi:[0,0,1]
    v_pk_maximum3_f16 v77, v77, v107, v107 neg_lo:[0,0,1] neg_hi:[0,0,1]
    ds_read_b64 v[128:129], v78 offset:43008
    s_waitcnt lgkmcnt(10)
    v_pk_maximum3_f16 v76, v76, v108, v108 neg_lo:[0,0,1] neg_hi:[0,0,1]
    v_pk_maximum3_f16 v77, v77, v109, v109 neg_lo:[0,0,1] neg_hi:[0,0,1]
    ds_read_b64 v[130:131], v78 offset:43520
    s_waitcnt lgkmcnt(10)
    v_pk_maximum3_f16 v76, v76, v110, v110 neg_lo:[0,0,1] neg_hi:[0,0,1]
    v_pk_maximum3_f16 v77, v77, v111, v111 neg_lo:[0,0,1] neg_hi:[0,0,1]
    ds_read_b64 v[132:133], v79 offset:40960
    s_waitcnt lgkmcnt(10)
    v_pk_maximum3_f16 v76, v76, v112, v112 neg_lo:[0,0,1] neg_hi:[0,0,1]
    v_pk_maximum3_f16 v77, v77, v113, v113 neg_lo:[0,0,1] neg_hi:[0,0,1]
    ds_read_b64 v[134:135], v79 offset:41472
    s_waitcnt lgkmcnt(10)
    v_pk_maximum3_f16 v76, v76, v114, v114 neg_lo:[0,0,1] neg_hi:[0,0,1]
    v_pk_maximum3_f16 v77, v77, v115, v115 neg_lo:[0,0,1] neg_hi:[0,0,1]
    ds_read_b64 v[136:137], v79 offset:41984
    s_waitcnt lgkmcnt(10)
    v_pk_maximum3_f16 v76, v76, v116, v116 neg_lo:[0,0,1] neg_hi:[0,0,1]
    v_pk_maximum3_f16 v77, v77, v117, v117 neg_lo:[0,0,1] neg_hi:[0,0,1]
    ds_read_b64 v[138:139], v79 offset:42496
    s_waitcnt lgkmcnt(10)
    v_pk_maximum3_f16 v76, v76, v118, v118 neg_lo:[0,0,1] neg_hi:[0,0,1]
    v_pk_maximum3_f16 v77, v77, v119, v119 neg_lo:[0,0,1] neg_hi:[0,0,1]
    ds_read_b64 v[140:141], v79 offset:43008
    s_waitcnt lgkmcnt(10)
    v_pk_maximum3_f16 v76, v76, v120, v120 neg_lo:[0,0,1] neg_hi:[0,0,1]
    v_pk_maximum3_f16 v77, v77, v121, v121 neg_lo:[0,0,1] neg_hi:[0,0,1]
    ds_read_b64 v[142:143], v79 offset:43520
    s_waitcnt lgkmcnt(10)
    v_pk_maximum3_f16 v76, v76, v122, v122 neg_lo:[0,0,1] neg_hi:[0,0,1]
    v_pk_maximum3_f16 v77, v77, v123, v123 neg_lo:[0,0,1] neg_hi:[0,0,1]
    ds_read_b64 v[144:145], v78 offset:47104
    s_waitcnt lgkmcnt(10)
    v_pk_maximum3_f16 v76, v76, v124, v124 neg_lo:[0,0,1] neg_hi:[0,0,1]
    v_pk_maximum3_f16 v77, v77, v125, v125 neg_lo:[0,0,1] neg_hi:[0,0,1]
    ds_read_b64 v[146:147], v78 offset:47616
    s_waitcnt lgkmcnt(10)
    v_pk_maximum3_f16 v76, v76, v126, v126 neg_lo:[0,0,1] neg_hi:[0,0,1]
    v_pk_maximum3_f16 v77, v77, v127, v127 neg_lo:[0,0,1] neg_hi:[0,0,1]
    ds_read_b64 v[148:149], v78 offset:48128
    s_waitcnt lgkmcnt(10)
    v_pk_maximum3_f16 v76, v76, v128, v128 neg_lo:[0,0,1] neg_hi:[0,0,1]
    v_pk_maximum3_f16 v77, v77, v129, v129 neg_lo:[0,0,1] neg_hi:[0,0,1]
    ds_read_b64 v[150:151], v78 offset:48640
    s_waitcnt lgkmcnt(10)
    v_pk_maximum3_f16 v76, v76, v130, v130 neg_lo:[0,0,1] neg_hi:[0,0,1]
    v_pk_maximum3_f16 v77, v77, v131, v131 neg_lo:[0,0,1] neg_hi:[0,0,1]
    ds_read_b64 v[152:153], v78 offset:49152
    s_waitcnt lgkmcnt(10)
    v_pk_maximum3_f16 v76, v76, v132, v132 neg_lo:[0,0,1] neg_hi:[0,0,1]
    v_pk_maximum3_f16 v77, v77, v133, v133 neg_lo:[0,0,1] neg_hi:[0,0,1]
    ds_read_b64 v[154:155], v78 offset:49664
    s_waitcnt lgkmcnt(10)
    v_pk_maximum3_f16 v76, v76, v134, v134 neg_lo:[0,0,1] neg_hi:[0,0,1]
    v_pk_maximum3_f16 v77, v77, v135, v135 neg_lo:[0,0,1] neg_hi:[0,0,1]
    ds_read_b64 v[156:157], v79 offset:47104
    s_waitcnt lgkmcnt(10)
    v_pk_maximum3_f16 v76, v76, v136, v136 neg_lo:[0,0,1] neg_hi:[0,0,1]
    v_pk_maximum3_f16 v77, v77, v137, v137 neg_lo:[0,0,1] neg_hi:[0,0,1]
    ds_read_b64 v[158:159], v79 offset:47616
    s_waitcnt lgkmcnt(10)
    v_pk_maximum3_f16 v76, v76, v138, v138 neg_lo:[0,0,1] neg_hi:[0,0,1]
    v_pk_maximum3_f16 v77, v77, v139, v139 neg_lo:[0,0,1] neg_hi:[0,0,1]
    ds_read_b64 v[160:161], v79 offset:48128
    s_waitcnt lgkmcnt(10)
    v_pk_maximum3_f16 v76, v76, v140, v140 neg_lo:[0,0,1] neg_hi:[0,0,1]
    v_pk_maximum3_f16 v77, v77, v141, v141 neg_lo:[0,0,1] neg_hi:[0,0,1]
    ds_read_b64 v[162:163], v79 offset:48640
    s_waitcnt lgkmcnt(10)
    v_pk_maximum3_f16 v76, v76, v142, v142 neg_lo:[0,0,1] neg_hi:[0,0,1]
    v_pk_maximum3_f16 v77, v77, v143, v143 neg_lo:[0,0,1] neg_hi:[0,0,1]
    ds_read_b64 v[164:165], v79 offset:49152
    s_waitcnt lgkmcnt(10)
    v_pk_maximum3_f16 v76, v76, v144, v144 neg_lo:[0,0,1] neg_hi:[0,0,1]
    v_pk_maximum3_f16 v77, v77, v145, v145 neg_lo:[0,0,1] neg_hi:[0,0,1]
    ds_read_b64 v[166:167], v79 offset:49664
    s_waitcnt lgkmcnt(10)
    v_pk_maximum3_f16 v76, v76, v146, v146 neg_lo:[0,0,1] neg_hi:[0,0,1]
    v_pk_maximum3_f16 v77, v77, v147, v147 neg_lo:[0,0,1] neg_hi:[0,0,1]
    ds_read_b64 v[168:169], v78 offset:53248
    s_waitcnt lgkmcnt(10)
    v_pk_maximum3_f16 v76, v76, v148, v148 neg_lo:[0,0,1] neg_hi:[0,0,1]
    v_pk_maximum3_f16 v77, v77, v149, v149 neg_lo:[0,0,1] neg_hi:[0,0,1]
    ds_read_b64 v[170:171], v78 offset:53760
    s_waitcnt lgkmcnt(10)
    v_pk_maximum3_f16 v76, v76, v150, v150 neg_lo:[0,0,1] neg_hi:[0,0,1]
    v_pk_maximum3_f16 v77, v77, v151, v151 neg_lo:[0,0,1] neg_hi:[0,0,1]
    ds_read_b64 v[172:173], v78 offset:54272
    s_waitcnt lgkmcnt(10)
    v_pk_maximum3_f16 v76, v76, v152, v152 neg_lo:[0,0,1] neg_hi:[0,0,1]
    v_pk_maximum3_f16 v77, v77, v153, v153 neg_lo:[0,0,1] neg_hi:[0,0,1]
    ds_read_b64 v[174:175], v78 offset:54784
    s_waitcnt lgkmcnt(10)
    v_pk_maximum3_f16 v76, v76, v154, v154 neg_lo:[0,0,1] neg_hi:[0,0,1]
    v_pk_maximum3_f16 v77, v77, v155, v155 neg_lo:[0,0,1] neg_hi:[0,0,1]
    ds_read_b64 v[176:177], v78 offset:55296
    s_waitcnt lgkmcnt(10)
    v_pk_maximum3_f16 v76, v76, v156, v156 neg_lo:[0,0,1] neg_hi:[0,0,1]
    v_pk_maximum3_f16 v77, v77, v157, v157 neg_lo:[0,0,1] neg_hi:[0,0,1]
    ds_read_b64 v[178:179], v78 offset:55808
    s_waitcnt lgkmcnt(10)
    v_pk_maximum3_f16 v76, v76, v158, v158 neg_lo:[0,0,1] neg_hi:[0,0,1]
    v_pk_maximum3_f16 v77, v77, v159, v159 neg_lo:[0,0,1] neg_hi:[0,0,1]
    ds_read_b64 v[180:181], v79 offset:53248
    s_waitcnt lgkmcnt(10)
    v_pk_maximum3_f16 v76, v76, v160, v160 neg_lo:[0,0,1] neg_hi:[0,0,1]
    v_pk_maximum3_f16 v77, v77, v161, v161 neg_lo:[0,0,1] neg_hi:[0,0,1]
    ds_read_b64 v[182:183], v79 offset:53760
    s_waitcnt lgkmcnt(10)
    v_pk_maximum3_f16 v76, v76, v162, v162 neg_lo:[0,0,1] neg_hi:[0,0,1]
    v_pk_maximum3_f16 v77, v77, v163, v163 neg_lo:[0,0,1] neg_hi:[0,0,1]
    ds_read_b64 v[184:185], v79 offset:54272
    s_waitcnt lgkmcnt(10)
    v_pk_maximum3_f16 v76, v76, v164, v164 neg_lo:[0,0,1] neg_hi:[0,0,1]
    v_pk_maximum3_f16 v77, v77, v165, v165 neg_lo:[0,0,1] neg_hi:[0,0,1]
    ds_read_b64 v[186:187], v79 offset:54784
    s_waitcnt lgkmcnt(10)
    v_pk_maximum3_f16 v76, v76, v166, v166 neg_lo:[0,0,1] neg_hi:[0,0,1]
    v_pk_maximum3_f16 v77, v77, v167, v167 neg_lo:[0,0,1] neg_hi:[0,0,1]
    ds_read_b64 v[188:189], v79 offset:55296
    s_waitcnt lgkmcnt(10)
    v_pk_maximum3_f16 v76, v76, v168, v168 neg_lo:[0,0,1] neg_hi:[0,0,1]
    v_pk_maximum3_f16 v77, v77, v169, v169 neg_lo:[0,0,1] neg_hi:[0,0,1]
    ds_read_b64 v[190:191], v79 offset:55808
    s_waitcnt lgkmcnt(10)
    v_pk_maximum3_f16 v76, v76, v170, v170 neg_lo:[0,0,1] neg_hi:[0,0,1]
    v_pk_maximum3_f16 v77, v77, v171, v171 neg_lo:[0,0,1] neg_hi:[0,0,1]
    s_waitcnt lgkmcnt(9)
    v_pk_maximum3_f16 v76, v76, v172, v172 neg_lo:[0,0,1] neg_hi:[0,0,1]
    v_pk_maximum3_f16 v77, v77, v173, v173 neg_lo:[0,0,1] neg_hi:[0,0,1]
    s_waitcnt lgkmcnt(8)
    v_pk_maximum3_f16 v76, v76, v174, v174 neg_lo:[0,0,1] neg_hi:[0,0,1]
    v_pk_maximum3_f16 v77, v77, v175, v175 neg_lo:[0,0,1] neg_hi:[0,0,1]
    s_waitcnt lgkmcnt(7)
    v_pk_maximum3_f16 v76, v76, v176, v176 neg_lo:[0,0,1] neg_hi:[0,0,1]
    v_pk_maximum3_f16 v77, v77, v177, v177 neg_lo:[0,0,1] neg_hi:[0,0,1]
    s_waitcnt lgkmcnt(6)
    v_pk_maximum3_f16 v76, v76, v178, v178 neg_lo:[0,0,1] neg_hi:[0,0,1]
    v_pk_maximum3_f16 v77, v77, v179, v179 neg_lo:[0,0,1] neg_hi:[0,0,1]
    s_waitcnt lgkmcnt(5)
    v_pk_maximum3_f16 v76, v76, v180, v180 neg_lo:[0,0,1] neg_hi:[0,0,1]
    v_pk_maximum3_f16 v77, v77, v181, v181 neg_lo:[0,0,1] neg_hi:[0,0,1]
    s_waitcnt lgkmcnt(4)
    v_pk_maximum3_f16 v76, v76, v182, v182 neg_lo:[0,0,1] neg_hi:[0,0,1]
    v_pk_maximum3_f16 v77, v77, v183, v183 neg_lo:[0,0,1] neg_hi:[0,0,1]
    s_waitcnt lgkmcnt(3)
    v_pk_maximum3_f16 v76, v76, v184, v184 neg_lo:[0,0,1] neg_hi:[0,0,1]
    v_pk_maximum3_f16 v77, v77, v185, v185 neg_lo:[0,0,1] neg_hi:[0,0,1]
    s_waitcnt lgkmcnt(2)
    v_pk_maximum3_f16 v76, v76, v186, v186 neg_lo:[0,0,1] neg_hi:[0,0,1]
    v_pk_maximum3_f16 v77, v77, v187, v187 neg_lo:[0,0,1] neg_hi:[0,0,1]
    s_waitcnt lgkmcnt(1)
    v_pk_maximum3_f16 v76, v76, v188, v188 neg_lo:[0,0,1] neg_hi:[0,0,1]
    v_pk_maximum3_f16 v77, v77, v189, v189 neg_lo:[0,0,1] neg_hi:[0,0,1]
    s_waitcnt lgkmcnt(0)
    v_pk_maximum3_f16 v76, v76, v190, v190 neg_lo:[0,0,1] neg_hi:[0,0,1]
    v_pk_maximum3_f16 v77, v77, v191, v191 neg_lo:[0,0,1] neg_hi:[0,0,1]

    v_and_b32 v76, 0x7fff7fff, v76
    v_and_b32 v77, 0x7fff7fff, v77
    v_pk_max_u16 v76, v76, v77
    s_nop 0
    v_lshrrev_b32 v77, 16, v76
    v_and_b32 v76, 0xffff, v76
    v_max_u32 v76, v76, v77
    ds_max_u32 v254, v76 offset:16
    ds_read_b32 v255, v254 offset:16
    s_waitcnt lgkmcnt(0)
    v_readfirstlane_b32 s26, v255
    s_lshr_b32 s26, s26, 7
    s_max_u32 s26, s26, 21
    s_min_u32 s26, s26, 140
    s_sub_u32 s26, s26, 20
    s_sub_u32 s27, 111, s26
    s_cmp_le_u32 s27, 12
    s_cselect_b32 s26, 111, s26
    s_lshl_b32 s26, s26, 8
    v_mov_b32 v255, s26
    ds_write_b32 v254, v255

L_p2:
    s_cmp_lg_u32 s16, 1
    s_cbranch_scc1 L_nodma0
    s_setprio 3

    v_lshrrev_b32 v176, 9, v253
    v_mul_u32_u24 v177, 1536, v176
    v_add_u32 v177, v177, v253
    v_bfe_u32 v254, v253, 6, 3
    v_lshl_add_u32 v176, v176, 4, v254
    v_mul_u32_u24 v176, 768, v176
    v_and_b32 v254, 48, v253
    v_add_u32 v176, v176, v254

    v_add_u32 v254, 161908, v240

    s_mov_b32 s29, 200000
L_wg0:
    ds_read_b32 v255, v254
    s_waitcnt lgkmcnt(0)
    v_cmp_ne_u32 vcc, 0, v255
    s_cmp_eq_u64 vcc, exec
    s_cbranch_scc1 L_wg0_ok
    s_sleep 2
    s_sub_u32 s29, s29, 1
    s_cmp_lg_u32 s29, 0
    s_cbranch_scc1 L_wg0
L_wg0_ok:

    s_add_u32 s26, s39, 0
    s_cmp_ge_u32 s26, 12
    s_cselect_b32 s27, 12, 0
    s_sub_u32 s26, s26, s27
    s_mul_i32 s26, s26, 64

    s_mov_b32 m0, 131080
    s_add_u32 s30, s26, 0
    s_add_u32 s31, s26, 23552
    s_add_u32 s32, s26, 47104
    buffer_load_dwordx4 v176, s[40:43], s30 offen offset:0 lds
    buffer_load_dwordx4 v176, s[40:43], s31 offen offset:1024 lds
    buffer_load_dwordx4 v176, s[40:43], s32 offen offset:2048 lds
    s_mov_b32 m0, 146448
    s_add_u32 s30, s26, 6144
    s_add_u32 s31, s26, 29696
    s_add_u32 s32, s26, 53248
    buffer_load_dwordx4 v176, s[40:43], s30 offen offset:0 lds
    buffer_load_dwordx4 v176, s[40:43], s31 offen offset:1024 lds
    buffer_load_dwordx4 v176, s[40:43], s32 offen offset:2048 lds

    s_add_u32 s26, s39, 1
    s_cmp_ge_u32 s26, 12
    s_cselect_b32 s27, 12, 0
    s_sub_u32 s26, s26, s27
    s_mul_i32 s26, s26, 64

    s_mov_b32 m0, 134152
    s_add_u32 s30, s26, 0
    s_add_u32 s31, s26, 23552
    s_add_u32 s32, s26, 47104
    buffer_load_dwordx4 v176, s[40:43], s30 offen offset:0 lds
    buffer_load_dwordx4 v176, s[40:43], s31 offen offset:1024 lds
    buffer_load_dwordx4 v176, s[40:43], s32 offen offset:2048 lds
    s_mov_b32 m0, 149520
    s_add_u32 s30, s26, 6144
    s_add_u32 s31, s26, 29696
    s_add_u32 s32, s26, 53248
    buffer_load_dwordx4 v176, s[40:43], s30 offen offset:0 lds
    buffer_load_dwordx4 v176, s[40:43], s31 offen offset:1024 lds
    buffer_load_dwordx4 v176, s[40:43], s32 offen offset:2048 lds

    s_add_u32 s26, s39, 2
    s_cmp_ge_u32 s26, 12
    s_cselect_b32 s27, 12, 0
    s_sub_u32 s26, s26, s27
    s_mul_i32 s26, s26, 64

    s_mov_b32 m0, 137224
    s_add_u32 s30, s26, 0
    s_add_u32 s31, s26, 23552
    s_add_u32 s32, s26, 47104
    buffer_load_dwordx4 v176, s[40:43], s30 offen offset:0 lds
    buffer_load_dwordx4 v176, s[40:43], s31 offen offset:1024 lds
    buffer_load_dwordx4 v176, s[40:43], s32 offen offset:2048 lds
    s_mov_b32 m0, 152592
    s_add_u32 s30, s26, 6144
    s_add_u32 s31, s26, 29696
    s_add_u32 s32, s26, 53248
    buffer_load_dwordx4 v176, s[40:43], s30 offen offset:0 lds
    buffer_load_dwordx4 v176, s[40:43], s31 offen offset:1024 lds
    buffer_load_dwordx4 v176, s[40:43], s32 offen offset:2048 lds

    s_add_u32 s26, s39, 0
    s_cmp_ge_u32 s26, 12
    s_cselect_b32 s27, 12, 0
    s_sub_u32 s26, s26, s27
    s_mul_i32 s26, s26, 6144

    s_mov_b32 m0, 140296
    s_add_u32 s30, s26, 0
    s_add_u32 s31, s26, 1536
    buffer_load_dwordx4 v253, s[44:47], s30 offen lds
    buffer_load_dwordx4 v177, s[44:47], s30 offen offset:1024 lds
    buffer_load_dwordx4 v253, s[44:47], s31 offen offset:2048 lds
    s_mov_b32 m0, 155664
    s_add_u32 s30, s26, 1536
    s_add_u32 s31, s26, 3072
    buffer_load_dwordx4 v253, s[44:47], s30 offen lds
    buffer_load_dwordx4 v177, s[44:47], s30 offen offset:1024 lds
    buffer_load_dwordx4 v253, s[44:47], s31 offen offset:2048 lds

    s_add_u32 s26, s39, 3
    s_cmp_ge_u32 s26, 12
    s_cselect_b32 s27, 12, 0
    s_sub_u32 s26, s26, s27
    s_mul_i32 s26, s26, 64

    s_mov_b32 m0, 143368
    s_add_u32 s30, s26, 0
    s_add_u32 s31, s26, 23552
    s_add_u32 s32, s26, 47104
    buffer_load_dwordx4 v176, s[40:43], s30 offen offset:0 lds
    buffer_load_dwordx4 v176, s[40:43], s31 offen offset:1024 lds
    buffer_load_dwordx4 v176, s[40:43], s32 offen offset:2048 lds
    s_mov_b32 m0, 158736
    s_add_u32 s30, s26, 6144
    s_add_u32 s31, s26, 29696
    s_add_u32 s32, s26, 53248
    buffer_load_dwordx4 v176, s[40:43], s30 offen offset:0 lds
    buffer_load_dwordx4 v176, s[40:43], s31 offen offset:1024 lds
    buffer_load_dwordx4 v176, s[40:43], s32 offen offset:2048 lds
    v_mov_b32 v254, 161976
    v_mov_b32 v180, 1
    s_waitcnt vmcnt(24)
    ds_write_b32 v254, v180
    v_mov_b32 v181, 2
    s_waitcnt vmcnt(18)
    ds_write_b32 v254, v181
    v_mov_b32 v182, 3
    s_waitcnt vmcnt(12)
    ds_write_b32 v254, v182
    v_mov_b32 v183, 4
    s_waitcnt vmcnt(6)
    ds_write_b32 v254, v183
    v_mov_b32 v184, 5
    s_waitcnt vmcnt(0)
    ds_write_b32 v254, v184
L_nodma0:
    v_mov_b32 v254, 161980

    s_mov_b32 s29, 200000
L_wi:
    ds_read_b32 v255, v254
    s_waitcnt lgkmcnt(0)
    v_cmp_eq_u32 vcc, 2, v255
    s_cmp_eq_u64 vcc, exec
    s_cbranch_scc1 L_wi_ok
    s_sleep 2
    s_sub_u32 s29, s29, 1
    s_cmp_lg_u32 s29, 0
    s_cbranch_scc1 L_wi
L_wi_ok:

    v_bfe_u32 v176, v253, 6, 2
    v_and_b32 v177, 48, v253
    v_lshrrev_b32 v178, 9, v253
    v_lshl_add_u32 v176, v178, 3, v176
    v_lshl_add_u32 v254, v176, 6, v177
    v_mul_u32_u24 v176, 192, v176
    v_add_u32 v255, v176, v177
    v_bfe_u32 v176, v253, 8, 1
    v_mul_u32_u24 v177, 65544, v176
    v_add_u32 v254, v254, v177
    v_add_u32 v255, v255, v177
    v_lshrrev_b32 v176, 8, v253
    v_bfe_u32 v177, v253, 6, 2
    v_cmp_eq_u32 vcc, v176, v177
    v_and_b32 v176, 16, v253
    v_mov_b32 v177, 0x3f80
    v_lshlrev_b32 v176, v176, v177
    v_cndmask_b32 v176, 0, v176, vcc
    v_and_b32 v177, 32, v253
    v_cmp_eq_u32 vcc, 0, v177
    s_nop 1
    v_cndmask_b32 v242, 0, v176, vcc
    v_sub_u32 v243, v176, v242
    s_mov_b32 s84, 0xc4eac4ea
    s_mov_b32 s85, 0x377f377f
    s_add_u32 s83, s98, 0x3eefde6e
    s_mov_b32 s86, 0x00003f80
    s_mov_b32 s87, 0x3f800000
    s_mov_b32 s17, 0
    s_mov_b32 s19, 0
    s_mov_b32 s99, 0

    s_setprio 1
L_mtile:

    v_bfe_u32 v224, v253, 8, 1
    v_mul_u32_u24 v224, 50176, v224
    v_subrev_u32 v224, 131080, v224
    v_sub_u32 v254, v254, v224
    s_cmp_lt_u32 s19, 1
    s_cbranch_scc1 L_rd1_slow
L_rd1_go:
    ds_read_b64_tr_b16 v[224:225], v254 offset:0
    ds_read_b64_tr_b16 v[226:227], v254 offset:256
    ds_read_b64_tr_b16 v[228:229], v254 offset:1024
    ds_read_b64_tr_b16 v[230:231], v254 offset:1280
    ds_read_b64_tr_b16 v[232:233], v254 offset:2048
    ds_read_b64_tr_b16 v[234:235], v254 offset:2304
    ds_read_b64_tr_b16 v[236:237], v254 offset:8
    ds_read_b64_tr_b16 v[238:239], v254 offset:264
    s_waitcnt vmcnt(12)
    s_cmp_lg_u32 s99, 0
    s_cbranch_scc1 L_fix
L_fixed:
    s_waitcnt lgkmcnt(6)
    v_mfma_f32_16x16x32_bf16 v[176:179], v[224:227], v[0:3], 0
    v_mfma_f32_16x16x32_bf16 v[180:183], v[224:227], v[4:7], 0
    v_mfma_f32_16x16x32_bf16 v[184:187], v[224:227], v[8:11], 0
    v_mfma_f32_16x16x32_bf16 v[188:191], v[224:227], v[12:15], 0
    ds_read_b64_tr_b16 v[224:225], v254 offset:1032
    s_waitcnt lgkmcnt(5)
    v_mfma_f32_16x16x32_bf16 v[176:179], v[228:231], v[16:19], v[176:179]
    ds_read_b64_tr_b16 v[226:227], v254 offset:1288
    v_mfma_f32_16x16x32_bf16 v[180:183], v[228:231], v[20:23], v[180:183]
    v_mfma_f32_16x16x32_bf16 v[184:187], v[228:231], v[24:27], v[184:187]
    v_mfma_f32_16x16x32_bf16 v[188:191], v[228:231], v[28:31], v[188:191]
    ds_read_b64_tr_b16 v[228:229], v254 offset:2056
    s_waitcnt lgkmcnt(5)
    v_mfma_f32_16x16x32_bf16 v[176:179], v[232:235], v[32:35], v[176:179]
    ds_read_b64_tr_b16 v[230:231], v254 offset:2312
    v_mfma_f32_16x16x32_bf16 v[180:183], v[232:235], v[36:39], v[180:183]
    v_mfma_f32_16x16x32_bf16 v[184:187], v[232:235], v[40:43], v[184:187]
    v_mfma_f32_16x16x32_bf16 v[188:191], v[232:235], v[44:47], v[188:191]
    s_cmp_lt_u32 s19, 2
    s_cbranch_scc1 L_rd2_slow
L_rd2_go:
    ds_read_b64_tr_b16 v[232:233], v254 offset:3072
    s_waitcnt lgkmcnt(5)
    v_mfma_f32_16x16x32_bf16 v[192:195], v[236:239], v[0:3], 0
    ds_read_b64_tr_b16 v[234:235], v254 offset:3328
    v_mfma_f32_16x16x32_bf16 v[196:199], v[236:239], v[4:7], 0
    v_mfma_f32_16x16x32_bf16 v[200:203], v[236:239], v[8:11], 0
    v_lshlrev_b32_sdwa v176, 1, v176 dst_sel:DWORD dst_unused:UNUSED_PAD src0_sel:DWORD src1_sel:WORD_1
    v_fma_mixlo_f16 v188, v188, s83, 0
    v_fma_mixlo_f16 v190, v190, s83, 0
    v_mfma_f32_16x16x32_bf16 v[204:207], v[236:239], v[12:15], 0
    ds_read_b64_tr_b16 v[236:237], v254 offset:4096
    ds_read_b64_tr_b16 v[238:239], v254 offset:4352
    v_lshlrev_b32_sdwa v177, 1, v177 dst_sel:DWORD dst_unused:UNUSED_PAD src0_sel:DWORD src1_sel:WORD_1
    v_fma_mixhi_f16 v188, v189, s83, 0
    v_lshlrev_b32_sdwa v178, 1, v178 dst_sel:DWORD dst_unused:UNUSED_PAD src0_sel:DWORD src1_sel:WORD_1
    s_waitcnt lgkmcnt(6)
    v_mfma_f32_16x16x32_bf16 v[192:195], v[224:227], v[16:19], v[192:195]
    ds_read_u16_d16 v176, v176
    v_fma_mixhi_f16 v190, v191, s83, 0
    v_pk_fma_f16 v189, v188, v188, s84 neg_lo:[0,1,0] neg_hi:[0,1,0]
    v_lshlrev_b32_sdwa v179, 1, v179 dst_sel:DWORD dst_unused:UNUSED_PAD src0_sel:DWORD src1_sel:WORD_1
    v_mfma_f32_16x16x32_bf16 v[196:199], v[224:227], v[20:23], v[196:199]
    ds_read_u16_d16_hi v177, v177
    ds_read_u16_d16 v178, v178
    v_pk_fma_f16 v191, v190, v190, s84 neg_lo:[0,1,0] neg_hi:[0,1,0]
    v_lshlrev_b32_sdwa v180, 1, v180 dst_sel:DWORD dst_unused:UNUSED_PAD src0_sel:DWORD src1_sel:WORD_1
    v_pk_mul_f16 v189, v189, v188
    v_mfma_f32_16x16x32_bf16 v[200:203], v[224:227], v[24:27], v[200:203]
    ds_read_u16_d16_hi v179, v179
    v_pk_mul_f16 v191, v191, v190
    v_lshlrev_b32_sdwa v181, 1, v181 dst_sel:DWORD dst_unused:UNUSED_PAD src0_sel:DWORD src1_sel:WORD_1
    v_exp_f16_sdwa v189, v189 dst_sel:WORD_0 dst_unused:UNUSED_PRESERVE src0_sel:WORD_0
    v_mfma_f32_16x16x32_bf16 v[204:207], v[224:227], v[28:31], v[204:207]
    ds_read_b64_tr_b16 v[224:225], v254 offset:5120
    ds_read_b64_tr_b16 v[226:227], v254 offset:5376
    v_lshlrev_b32_sdwa v182, 1, v182 dst_sel:DWORD dst_unused:UNUSED_PAD src0_sel:DWORD src1_sel:WORD_1
    v_exp_f16_sdwa v191, v191 dst_sel:WORD_0 dst_unused:UNUSED_PRESERVE src0_sel:WORD_0
    s_waitcnt lgkmcnt(10)
    v_mfma_f32_16x16x32_bf16 v[192:195], v[228:231], v[32:35], v[192:195]
    ds_read_u16_d16 v180, v180
    v_lshlrev_b32_sdwa v183, 1, v183 dst_sel:DWORD dst_unused:UNUSED_PAD src0_sel:DWORD src1_sel:WORD_1
    v_lshlrev_b32_sdwa v184, 1, v184 dst_sel:DWORD dst_unused:UNUSED_PAD src0_sel:DWORD src1_sel:WORD_1
    v_mfma_f32_16x16x32_bf16 v[196:199], v[228:231], v[36:39], v[196:199]
    ds_read_u16_d16_hi v181, v181
    ds_read_u16_d16 v182, v182
    v_exp_f16_sdwa v189, v189 dst_sel:WORD_1 dst_unused:UNUSED_PRESERVE src0_sel:WORD_1
    v_lshlrev_b32_sdwa v185, 1, v185 dst_sel:DWORD dst_unused:UNUSED_PAD src0_sel:DWORD src1_sel:WORD_1
    v_mfma_f32_16x16x32_bf16 v[200:203], v[228:231], v[40:43], v[200:203]
    ds_read_u16_d16_hi v183, v183
    v_exp_f16_sdwa v191, v191 dst_sel:WORD_1 dst_unused:UNUSED_PRESERVE src0_sel:WORD_1
    v_lshlrev_b32_sdwa v186, 1, v186 dst_sel:DWORD dst_unused:UNUSED_PAD src0_sel:DWORD src1_sel:WORD_1
    v_mfma_f32_16x16x32_bf16 v[204:207], v[228:231], v[44:47], v[204:207]
    ds_read_b64_tr_b16 v[228:229], v254 offset:3080
    ds_read_b64_tr_b16 v[230:231], v254 offset:3336
    ds_read_u16_d16 v184, v184
    v_pk_fma_f16 v189, v189, s85, s85
    v_lshlrev_b32_sdwa v187, 1, v187 dst_sel:DWORD dst_unused:UNUSED_PAD src0_sel:DWORD src1_sel:WORD_1
    v_pk_fma_f16 v191, v191, s85, s85
    s_waitcnt lgkmcnt(14)
    v_mfma_f32_16x16x32_bf16 v[208:211], v[232:235], v[0:3], 0
    ds_read_u16_d16_hi v185, v185
    v_mfma_f32_16x16x32_bf16 v[212:215], v[232:235], v[4:7], 0
    ds_read_u16_d16 v186, v186
    ds_read_u16_d16_hi v187, v187
    v_mfma_f32_16x16x32_bf16 v[216:219], v[232:235], v[8:11], 0
    s_waitcnt lgkmcnt(14)
    v_or_b32 v144, v176, v177
    v_rcp_f16_sdwa v189, v189 dst_sel:WORD_0 dst_unused:UNUSED_PRESERVE src0_sel:WORD_0
    v_lshlrev_b32_sdwa v192, 1, v192 dst_sel:DWORD dst_unused:UNUSED_PAD src0_sel:DWORD src1_sel:WORD_1
    v_mfma_f32_16x16x32_bf16 v[220:223], v[232:235], v[12:15], 0
    ds_read_b64_tr_b16 v[232:233], v254 offset:4104
    v_rcp_f16_sdwa v191, v191 dst_sel:WORD_0 dst_unused:UNUSED_PRESERVE src0_sel:WORD_0
    v_lshlrev_b32_sdwa v193, 1, v193 dst_sel:DWORD dst_unused:UNUSED_PAD src0_sel:DWORD src1_sel:WORD_1
    s_waitcnt lgkmcnt(13)
    v_or_b32 v145, v178, v179
    v_fma_mixlo_f16 v206, v206, s83, 0
    v_mfma_f32_16x16x32_bf16 v[208:211], v[236:239], v[16:19], v[208:211]
    ds_read_b64_tr_b16 v[234:235], v254 offset:4360
    ds_read_u16_d16 v192, v192
    v_lshlrev_b32_sdwa v194, 1, v194 dst_sel:DWORD dst_unused:UNUSED_PAD src0_sel:DWORD src1_sel:WORD_1
    v_rcp_f16_sdwa v189, v189 dst_sel:WORD_1 dst_unused:UNUSED_PRESERVE src0_sel:WORD_1
    v_lshlrev_b32_sdwa v195, 1, v195 dst_sel:DWORD dst_unused:UNUSED_PAD src0_sel:DWORD src1_sel:WORD_1
    v_mfma_f32_16x16x32_bf16 v[212:215], v[236:239], v[20:23], v[212:215]
    ds_read_u16_d16_hi v193, v193
    ds_read_u16_d16 v194, v194
    s_waitcnt lgkmcnt(13)
    v_or_b32 v148, v180, v181
    v_rcp_f16_sdwa v191, v191 dst_sel:WORD_1 dst_unused:UNUSED_PRESERVE src0_sel:WORD_1
    v_lshlrev_b32_sdwa v196, 1, v196 dst_sel:DWORD dst_unused:UNUSED_PAD src0_sel:DWORD src1_sel:WORD_1
    v_mfma_f32_16x16x32_bf16 v[216:219], v[236:239], v[24:27], v[216:219]
    ds_read_u16_d16_hi v195, v195
    v_fma_mixhi_f16 v206, v207, s83, 0
    v_lshlrev_b32_sdwa v197, 1, v197 dst_sel:DWORD dst_unused:UNUSED_PAD src0_sel:DWORD src1_sel:WORD_1
    v_fma_mix_f32 v156, v188, v189, 0 op_sel_hi:[1,1,0]
    s_waitcnt lgkmcnt(12)
    v_or_b32 v149, v182, v183
    v_fma_mix_f32 v157, v190, v191, 0 op_sel_hi:[1,1,0]
    v_mfma_f32_16x16x32_bf16 v[220:223], v[236:239], v[28:31], v[220:223]
    ds_read_b64_tr_b16 v[236:237], v254 offset:5128
    ds_read_b64_tr_b16 v[238:239], v254 offset:5384
    v_lshlrev_b32_sdwa v198, 1, v198 dst_sel:DWORD dst_unused:UNUSED_PAD src0_sel:DWORD src1_sel:WORD_1
    v_pk_fma_f16 v207, v206, v206, s84 neg_lo:[0,1,0] neg_hi:[0,1,0]
    v_lshlrev_b32_sdwa v199, 1, v199 dst_sel:DWORD dst_unused:UNUSED_PAD src0_sel:DWORD src1_sel:WORD_1
    v_fma_mix_f32 v189, v188, v189, 0 op_sel:[1,1,0] op_sel_hi:[1,1,0]
    v_mfma_f32_16x16x32_bf16 v[208:211], v[224:227], v[32:35], v[208:211]
    ds_read_u16_d16 v196, v196
    ds_read_u16_d16_hi v197, v197
    s_waitcnt lgkmcnt(12)
    v_or_b32 v152, v184, v185
    v_fma_mix_f32 v191, v190, v191, 0 op_sel:[1,1,0] op_sel_hi:[1,1,0]
    v_lshlrev_b32_sdwa v200, 1, v200 dst_sel:DWORD dst_unused:UNUSED_PAD src0_sel:DWORD src1_sel:WORD_1
    v_pk_mul_f16 v207, v207, v206
    v_mfma_f32_16x16x32_bf16 v[212:215], v[224:227], v[36:39], v[212:215]
    ds_read_u16_d16 v198, v198
    v_cvt_pk_bf16_f32 v156, v156, v189
    v_lshlrev_b32_sdwa v201, 1, v201 dst_sel:DWORD dst_unused:UNUSED_PAD src0_sel:DWORD src1_sel:WORD_1
    v_cvt_pk_bf16_f32 v157, v157, v191
    s_waitcnt lgkmcnt(11)
    v_or_b32 v153, v186, v187
    v_mfma_f32_16x16x32_bf16 v[216:219], v[224:227], v[40:43], v[216:219]
    ds_read_u16_d16_hi v199, v199
    ds_read_u16_d16 v200, v200
    v_exp_f16_sdwa v207, v207 dst_sel:WORD_0 dst_unused:UNUSED_PRESERVE src0_sel:WORD_0
    v_lshlrev_b32_sdwa v202, 1, v202 dst_sel:DWORD dst_unused:UNUSED_PAD src0_sel:DWORD src1_sel:WORD_1
    v_lshlrev_b32_sdwa v203, 1, v203 dst_sel:DWORD dst_unused:UNUSED_PAD src0_sel:DWORD src1_sel:WORD_1
    v_mfma_f32_16x16x32_bf16 v[220:223], v[224:227], v[44:47], v[220:223]
    s_cmp_lt_u32 s19, 3
    s_cbranch_scc1 L_rd3_slow
L_rd3_go:
    ds_read_b64_tr_b16 v[224:225], v254 offset:6144
    ds_read_b64_tr_b16 v[226:227], v254 offset:6400
    ds_read_u16_d16_hi v201, v201
    v_exp_f16_sdwa v207, v207 dst_sel:WORD_1 dst_unused:UNUSED_PRESERVE src0_sel:WORD_1
    v_lshlrev_b32_sdwa v204, 1, v204 dst_sel:DWORD dst_unused:UNUSED_PAD src0_sel:DWORD src1_sel:WORD_1
    v_lshlrev_b32_sdwa v205, 1, v205 dst_sel:DWORD dst_unused:UNUSED_PAD src0_sel:DWORD src1_sel:WORD_1
    v_pk_fma_f16 v207, v207, s85, s85
    v_mfma_f32_16x16x32_bf16 v[176:179], v[228:231], v[0:3], 0
    ds_read_u16_d16 v202, v202
    v_mfma_f32_16x16x32_bf16 v[180:183], v[228:231], v[4:7], 0
    ds_read_u16_d16_hi v203, v203
    ds_read_u16_d16 v204, v204
    v_mfma_f32_16x16x32_bf16 v[184:187], v[228:231], v[8:11], 0
    ds_read_u16_d16_hi v205, v205
    s_waitcnt lgkmcnt(14)
    v_or_b32 v146, v192, v193
    v_rcp_f16_sdwa v207, v207 dst_sel:WORD_0 dst_unused:UNUSED_PRESERVE src0_sel:WORD_0
    v_lshlrev_b32_sdwa v208, 1, v208 dst_sel:DWORD dst_unused:UNUSED_PAD src0_sel:DWORD src1_sel:WORD_1
    v_mfma_f32_16x16x32_bf16 v[188:191], v[228:231], v[12:15], 0
    v_bfe_u32 v228, v253, 8, 1
    v_mul_u32_u24 v228, 50176, v228
    v_subrev_u32 v228, 131080, v228
    v_sub_u32 v255, v255, v228
    s_cmp_lt_u32 s19, 4
    s_cbranch_scc1 L_rd4_slow
L_rd4_go:
    ds_read_b64_tr_b16 v[228:229], v255 offset:9216
    ds_read_b64_tr_b16 v[230:231], v255 offset:9984
    v_fma_mixlo_f16 v220, v220, s83, 0
    v_lshlrev_b32_sdwa v209, 1, v209 dst_sel:DWORD dst_unused:UNUSED_PAD src0_sel:DWORD src1_sel:WORD_1
    v_fma_mixlo_f16 v222, v222, s83, 0
    v_or_b32 v147, v194, v195
    v_mfma_f32_16x16x32_bf16 v[176:179], v[232:235], v[16:19], v[176:179]
    ds_read_u16_d16 v208, v208
    v_rcp_f16_sdwa v207, v207 dst_sel:WORD_1 dst_unused:UNUSED_PRESERVE src0_sel:WORD_1
    v_lshlrev_b32_sdwa v210, 1, v210 dst_sel:DWORD dst_unused:UNUSED_PAD src0_sel:DWORD src1_sel:WORD_1
    v_fma_mixhi_f16 v220, v221, s83, 0
    v_lshlrev_b32_sdwa v211, 1, v211 dst_sel:DWORD dst_unused:UNUSED_PAD src0_sel:DWORD src1_sel:WORD_1
    v_mfma_f32_16x16x32_bf16 v[180:183], v[232:235], v[20:23], v[180:183]
    ds_read_u16_d16_hi v209, v209
    ds_read_u16_d16 v210, v210
    v_fma_mixhi_f16 v222, v223, s83, 0
    s_waitcnt lgkmcnt(14)
    v_or_b32 v150, v196, v197
    v_fma_mix_f32 v159, v206, v207, 0 op_sel_hi:[1,1,0]
    v_pk_fma_f16 v221, v220, v220, s84 neg_lo:[0,1,0] neg_hi:[0,1,0]
    v_lshlrev_b32_sdwa v212, 1, v212 dst_sel:DWORD dst_unused:UNUSED_PAD src0_sel:DWORD src1_sel:WORD_1
    v_mfma_f32_16x16x32_bf16 v[184:187], v[232:235], v[24:27], v[184:187]
    ds_read_u16_d16_hi v211, v211
    v_pk_fma_f16 v223, v222, v222, s84 neg_lo:[0,1,0] neg_hi:[0,1,0]
    v_lshlrev_b32_sdwa v213, 1, v213 dst_sel:DWORD dst_unused:UNUSED_PAD src0_sel:DWORD src1_sel:WORD_1
    v_fma_mix_f32 v207, v206, v207, 0 op_sel:[1,1,0] op_sel_hi:[1,1,0]
    s_waitcnt lgkmcnt(14)
    v_or_b32 v151, v198, v199
    v_mfma_f32_16x16x32_bf16 v[188:191], v[232:235], v[28:31], v[188:191]
    ds_read_b64_tr_b16 v[232:233], v254 offset:7168
    ds_read_b64_tr_b16 v[234:235], v254 offset:7424
    v_pk_mul_f16 v221, v221, v220
    v_pk_mul_f16 v223, v223, v222
    v_lshlrev_b32_sdwa v214, 1, v214 dst_sel:DWORD dst_unused:UNUSED_PAD src0_sel:DWORD src1_sel:WORD_1
    v_cvt_pk_bf16_f32 v159, v159, v207
    v_mfma_f32_16x16x32_bf16 v[176:179], v[236:239], v[32:35], v[176:179]
    ds_read_u16_d16 v212, v212
    v_lshlrev_b32_sdwa v215, 1, v215 dst_sel:DWORD dst_unused:UNUSED_PAD src0_sel:DWORD src1_sel:WORD_1
    v_exp_f16_sdwa v221, v221 dst_sel:WORD_0 dst_unused:UNUSED_PRESERVE src0_sel:WORD_0
    s_waitcnt lgkmcnt(13)
    v_or_b32 v154, v200, v201
    v_mfma_f32_16x16x32_bf16 v[180:183], v[236:239], v[36:39], v[180:183]
    ds_read_u16_d16_hi v213, v213
    ds_read_u16_d16 v214, v214
    v_exp_f16_sdwa v223, v223 dst_sel:WORD_0 dst_unused:UNUSED_PRESERVE src0_sel:WORD_0
    v_lshlrev_b32_sdwa v216, 1, v216 dst_sel:DWORD dst_unused:UNUSED_PAD src0_sel:DWORD src1_sel:WORD_1
    v_lshlrev_b32_sdwa v217, 1, v217 dst_sel:DWORD dst_unused:UNUSED_PAD src0_sel:DWORD src1_sel:WORD_1
    v_exp_f16_sdwa v221, v221 dst_sel:WORD_1 dst_unused:UNUSED_PRESERVE src0_sel:WORD_1
    v_mfma_f32_16x16x32_bf16 v[184:187], v[236:239], v[40:43], v[184:187]
    ds_read_u16_d16_hi v215, v215
    s_waitcnt lgkmcnt(14)
    v_or_b32 v155, v202, v203
    v_exp_f16_sdwa v223, v223 dst_sel:WORD_1 dst_unused:UNUSED_PRESERVE src0_sel:WORD_1
    v_lshlrev_b32_sdwa v218, 1, v218 dst_sel:DWORD dst_unused:UNUSED_PAD src0_sel:DWORD src1_sel:WORD_1
    v_mfma_f32_16x16x32_bf16 v[188:191], v[236:239], v[44:47], v[188:191]
    ds_read_b64_tr_b16 v[236:237], v255 offset:9224
    ds_read_b64_tr_b16 v[238:239], v255 offset:9992
    ds_read_u16_d16 v216, v216
    v_lshlrev_b32_sdwa v219, 1, v219 dst_sel:DWORD dst_unused:UNUSED_PAD src0_sel:DWORD src1_sel:WORD_1
    v_pk_fma_f16 v221, v221, s85, s85
    s_waitcnt lgkmcnt(14)
    v_or_b32 v158, v204, v205
    v_pk_fma_f16 v223, v223, s85, s85
    s_cmp_lg_u32 s38, 0
    s_cbranch_scc1 L_park
L_parked:
    v_mfma_f32_16x16x32_bf16 v[192:195], v[224:227], v[0:3], 0
    ds_read_u16_d16_hi v217, v217
    v_mfma_f32_16x16x32_bf16 v[196:199], v[224:227], v[4:7], 0
    ds_read_u16_d16 v218, v218
    v_mfma_f32_16x16x32_bf16 v[200:203], v[224:227], v[8:11], 0
    ds_read_u16_d16_hi v219, v219
    s_waitcnt lgkmcnt(14)
    v_or_b32 v160, v208, v209
    v_rcp_f16_sdwa v221, v221 dst_sel:WORD_0 dst_unused:UNUSED_PRESERVE src0_sel:WORD_0
    v_mfma_f32_16x16x32_bf16 v[204:207], v[224:227], v[12:15], 0
    ds_read_b64_tr_b16 v[224:225], v254 offset:8192
    v_lshlrev_b32_sdwa v176, 1, v176 dst_sel:DWORD dst_unused:UNUSED_PAD src0_sel:DWORD src1_sel:WORD_1
    v_mfma_f32_16x16x32_bf16 v[48:51], v[228:231], v[144:147], 0
    ds_read_b64_tr_b16 v[226:227], v254 offset:8448
    v_rcp_f16_sdwa v223, v223 dst_sel:WORD_0 dst_unused:UNUSED_PRESERVE src0_sel:WORD_0
    v_mfma_f32_16x16x32_bf16 v[56:59], v[228:231], v[148:151], 0
    ds_read_u16_d16 v176, v176
    v_lshlrev_b32_sdwa v177, 1, v177 dst_sel:DWORD dst_unused:UNUSED_PAD src0_sel:DWORD src1_sel:WORD_1
    s_waitcnt lgkmcnt(14)
    v_or_b32 v161, v210, v211
    v_mfma_f32_16x16x32_bf16 v[64:67], v[228:231], v[152:155], 0
    ds_read_u16_d16_hi v177, v177
    v_fma_mixlo_f16 v190, v190, s83, 0
    v_lshlrev_b32_sdwa v178, 1, v178 dst_sel:DWORD dst_unused:UNUSED_PAD src0_sel:DWORD src1_sel:WORD_1
    v_mfma_f32_16x16x32_bf16 v[72:75], v[228:231], v[156:159], 0
    ds_read_b64_tr_b16 v[228:229], v255 offset:9280
    v_rcp_f16_sdwa v221, v221 dst_sel:WORD_1 dst_unused:UNUSED_PRESERVE src0_sel:WORD_1
    s_waitcnt lgkmcnt(14)
    v_mfma_f32_16x16x32_bf16 v[192:195], v[232:235], v[16:19], v[192:195]
    ds_read_b64_tr_b16 v[230:231], v255 offset:10048
    v_lshlrev_b32_sdwa v179, 1, v179 dst_sel:DWORD dst_unused:UNUSED_PAD src0_sel:DWORD src1_sel:WORD_1
    s_waitcnt lgkmcnt(14)
    v_or_b32 v164, v212, v213
    v_mfma_f32_16x16x32_bf16 v[196:199], v[232:235], v[20:23], v[196:199]
    ds_read_u16_d16 v178, v178
    v_rcp_f16_sdwa v223, v223 dst_sel:WORD_1 dst_unused:UNUSED_PRESERVE src0_sel:WORD_1
    v_mfma_f32_16x16x32_bf16 v[200:203], v[232:235], v[24:27], v[200:203]
    ds_read_u16_d16_hi v179, v179
    v_lshlrev_b32_sdwa v180, 1, v180 dst_sel:DWORD dst_unused:UNUSED_PAD src0_sel:DWORD src1_sel:WORD_1
    v_fma_mixhi_f16 v190, v191, s83, 0
    v_mfma_f32_16x16x32_bf16 v[204:207], v[232:235], v[28:31], v[204:207]
    ds_read_b64_tr_b16 v[232:233], v254 offset:6152
    ds_read_b64_tr_b16 v[234:235], v254 offset:6408
    v_lshlrev_b32_sdwa v181, 1, v181 dst_sel:DWORD dst_unused:UNUSED_PAD src0_sel:DWORD src1_sel:WORD_1
    v_fma_mix_f32 v172, v220, v221, 0 op_sel_hi:[1,1,0]
    s_waitcnt lgkmcnt(14)
    v_mfma_f32_16x16x32_bf16 v[52:55], v[236:239], v[144:147], 0
    ds_read_u16_d16 v180, v180
    v_or_b32 v165, v214, v215
    v_fma_mix_f32 v173, v222, v223, 0 op_sel_hi:[1,1,0]
    v_lshlrev_b32_sdwa v182, 1, v182 dst_sel:DWORD dst_unused:UNUSED_PAD src0_sel:DWORD src1_sel:WORD_1
    v_mfma_f32_16x16x32_bf16 v[60:63], v[236:239], v[148:151], 0
    ds_read_u16_d16_hi v181, v181
    v_pk_fma_f16 v191, v190, v190, s84 neg_lo:[0,1,0] neg_hi:[0,1,0]
    v_lshlrev_b32_sdwa v183, 1, v183 dst_sel:DWORD dst_unused:UNUSED_PAD src0_sel:DWORD src1_sel:WORD_1
    v_mfma_f32_16x16x32_bf16 v[68:71], v[236:239], v[152:155], 0
    ds_read_u16_d16 v182, v182
    v_fma_mix_f32 v221, v220, v221, 0 op_sel:[1,1,0] op_sel_hi:[1,1,0]
    s_waitcnt lgkmcnt(14)
    v_or_b32 v168, v216, v217
    v_mfma_f32_16x16x32_bf16 v[76:79], v[236:239], v[156:159], 0
    ds_read_b64_tr_b16 v[236:237], v255 offset:9288
    v_fma_mix_f32 v223, v222, v223, 0 op_sel:[1,1,0] op_sel_hi:[1,1,0]
    v_lshlrev_b32_sdwa v184, 1, v184 dst_sel:DWORD dst_unused:UNUSED_PAD src0_sel:DWORD src1_sel:WORD_1
    s_waitcnt lgkmcnt(12)
    v_mfma_f32_16x16x32_bf16 v[192:195], v[224:227], v[32:35], v[192:195]
    ds_read_b64_tr_b16 v[238:239], v255 offset:10056
    v_pk_mul_f16 v191, v191, v190
    v_cvt_pk_bf16_f32 v172, v172, v221
    v_mfma_f32_16x16x32_bf16 v[196:199], v[224:227], v[36:39], v[196:199]
    ds_read_u16_d16_hi v183, v183
    v_lshlrev_b32_sdwa v185, 1, v185 dst_sel:DWORD dst_unused:UNUSED_PAD src0_sel:DWORD src1_sel:WORD_1
    v_cvt_pk_bf16_f32 v173, v173, v223
    v_mfma_f32_16x16x32_bf16 v[200:203], v[224:227], v[40:43], v[200:203]
    ds_read_u16_d16 v184, v184
    v_or_b32 v169, v218, v219
    v_mfma_f32_16x16x32_bf16 v[204:207], v[224:227], v[44:47], v[204:207]
    ds_read_b64_tr_b16 v[224:225], v254 offset:7176
    v_exp_f16_sdwa v191, v191 dst_sel:WORD_0 dst_unused:UNUSED_PRESERVE src0_sel:WORD_0
    v_lshlrev_b32_sdwa v186, 1, v186 dst_sel:DWORD dst_unused:UNUSED_PAD src0_sel:DWORD src1_sel:WORD_1
    s_waitcnt lgkmcnt(12)
    v_mfma_f32_16x16x32_bf16 v[80:83], v[228:231], v[144:147], 0
    ds_read_b64_tr_b16 v[226:227], v254 offset:7432
    v_lshlrev_b32_sdwa v187, 1, v187 dst_sel:DWORD dst_unused:UNUSED_PAD src0_sel:DWORD src1_sel:WORD_1
    v_mfma_f32_16x16x32_bf16 v[88:91], v[228:231], v[148:151], 0
    ds_read_u16_d16_hi v185, v185
    v_exp_f16_sdwa v191, v191 dst_sel:WORD_1 dst_unused:UNUSED_PRESERVE src0_sel:WORD_1
    v_lshlrev_b32_sdwa v188, 1, v188 dst_sel:DWORD dst_unused:UNUSED_PAD src0_sel:DWORD src1_sel:WORD_1
    v_mfma_f32_16x16x32_bf16 v[96:99], v[228:231], v[152:155], 0
    ds_read_u16_d16 v186, v186
    buffer_load_dwordx4 v[244:247], v252, s[4:7], s24 offen offset:0 sc1
    buffer_load_dwordx4 v[248:251], v252, s[4:7], s24 offen offset:64 sc1
    v_mfma_f32_16x16x32_bf16 v[104:107], v[228:231], v[156:159], 0
    ds_read_b64_tr_b16 v[228:229], v255 offset:9344
    ds_read_b64_tr_b16 v[230:231], v255 offset:10112
    v_lshlrev_b32_sdwa v189, 1, v189 dst_sel:DWORD dst_unused:UNUSED_PAD src0_sel:DWORD src1_sel:WORD_1
    v_pk_fma_f16 v191, v191, s85, s85
    s_waitcnt lgkmcnt(13)
    v_mfma_f32_16x16x32_bf16 v[208:211], v[232:235], v[0:3], 0
    ds_read_u16_d16_hi v187, v187
    v_or_b32 v162, v176, v177
    v_mfma_f32_16x16x32_bf16 v[212:215], v[232:235], v[4:7], 0
    ds_read_u16_d16 v188, v188
    v_rcp_f16_sdwa v191, v191 dst_sel:WORD_0 dst_unused:UNUSED_PRESERVE src0_sel:WORD_0
    v_lshlrev_b32_sdwa v192, 1, v192 dst_sel:DWORD dst_unused:UNUSED_PAD src0_sel:DWORD src1_sel:WORD_1
    v_mfma_f32_16x16x32_bf16 v[216:219], v[232:235], v[8:11], 0
    ds_read_u16_d16_hi v189, v189
    v_fma_mixlo_f16 v204, v204, s83, 0
    v_lshlrev_b32_sdwa v193, 1, v193 dst_sel:DWORD dst_unused:UNUSED_PAD src0_sel:DWORD src1_sel:WORD_1
    v_mfma_f32_16x16x32_bf16 v[220:223], v[232:235], v[12:15], 0
    ds_read_b64_tr_b16 v[232:233], v254 offset:8200
    v_fma_mixlo_f16 v206, v206, s83, 0
    s_waitcnt lgkmcnt(12)
    v_mfma_f32_16x16x32_bf16 v[84:87], v[236:239], v[144:147], 0
    ds_read_b64_tr_b16 v[234:235], v254 offset:8456
    v_or_b32 v163, v178, v179
    v_rcp_f16_sdwa v191, v191 dst_sel:WORD_1 dst_unused:UNUSED_PRESERVE src0_sel:WORD_1
    v_mfma_f32_16x16x32_bf16 v[92:95], v[236:239], v[148:151], 0
    ds_read_u16_d16 v192, v192
    v_lshlrev_b32_sdwa v194, 1, v194 dst_sel:DWORD dst_unused:UNUSED_PAD src0_sel:DWORD src1_sel:WORD_1
    v_mfma_f32_16x16x32_bf16 v[100:103], v[236:239], v[152:155], 0
    ds_read_u16_d16_hi v193, v193
    v_fma_mixhi_f16 v204, v205, s83, 0
    v_lshlrev_b32_sdwa v195, 1, v195 dst_sel:DWORD dst_unused:UNUSED_PAD src0_sel:DWORD src1_sel:WORD_1
    v_mfma_f32_16x16x32_bf16 v[108:111], v[236:239], v[156:159], 0
    ds_read_b64_tr_b16 v[236:237], v255 offset:9352
    v_fma_mixhi_f16 v206, v207, s83, 0
    v_or_b32 v166, v180, v181
    s_waitcnt lgkmcnt(12)
    v_mfma_f32_16x16x32_bf16 v[208:211], v[224:227], v[16:19], v[208:211]
    ds_read_b64_tr_b16 v[238:239], v255 offset:10120
    v_fma_mix_f32 v175, v190, v191, 0 op_sel_hi:[1,1,0]
    v_pk_fma_f16 v205, v204, v204, s84 neg_lo:[0,1,0] neg_hi:[0,1,0]
    v_mfma_f32_16x16x32_bf16 v[212:215], v[224:227], v[20:23], v[212:215]
    ds_read_u16_d16 v194, v194
    v_lshlrev_b32_sdwa v196, 1, v196 dst_sel:DWORD dst_unused:UNUSED_PAD src0_sel:DWORD src1_sel:WORD_1
    v_mfma_f32_16x16x32_bf16 v[216:219], v[224:227], v[24:27], v[216:219]
    ds_read_u16_d16_hi v195, v195
    v_pk_fma_f16 v207, v206, v206, s84 neg_lo:[0,1,0] neg_hi:[0,1,0]
    v_lshlrev_b32_sdwa v197, 1, v197 dst_sel:DWORD dst_unused:UNUSED_PAD src0_sel:DWORD src1_sel:WORD_1
    v_mfma_f32_16x16x32_bf16 v[220:223], v[224:227], v[28:31], v[220:223]
    s_cmp_lt_u32 s19, 6
    s_cbranch_scc1 L_rd6_slow
L_rd6_go:
    ds_read_b64_tr_b16 v[224:225], v254 offset:12288
    v_fma_mix_f32 v191, v190, v191, 0 op_sel:[1,1,0] op_sel_hi:[1,1,0]
    v_or_b32 v167, v182, v183
    s_waitcnt lgkmcnt(12)
    v_mfma_f32_16x16x32_bf16 v[112:115], v[228:231], v[144:147], 0
    ds_read_b64_tr_b16 v[226:227], v254 offset:12544
    v_pk_mul_f16 v205, v205, v204
    v_pk_mul_f16 v207, v207, v206
    v_mfma_f32_16x16x32_bf16 v[120:123], v[228:231], v[148:151], 0
    ds_read_u16_d16 v196, v196
    v_lshlrev_b32_sdwa v198, 1, v198 dst_sel:DWORD dst_unused:UNUSED_PAD src0_sel:DWORD src1_sel:WORD_1
    v_cvt_pk_bf16_f32 v175, v175, v191
    v_mfma_f32_16x16x32_bf16 v[128:131], v[228:231], v[152:155], 0
    ds_read_u16_d16_hi v197, v197
    v_lshlrev_b32_sdwa v199, 1, v199 dst_sel:DWORD dst_unused:UNUSED_PAD src0_sel:DWORD src1_sel:WORD_1
    v_mfma_f32_16x16x32_bf16 v[136:139], v[228:231], v[156:159], 0
    v_bfe_u32 v228, v253, 8, 1
    v_mul_u32_u24 v228, 50176, v228
    v_subrev_u32 v228, 131080, v228
    v_add_u32 v255, v255, v228
    ds_read_b64_tr_b16 v[228:229], v255 offset:7168
    v_exp_f16_sdwa v205, v205 dst_sel:WORD_0 dst_unused:UNUSED_PRESERVE src0_sel:WORD_0
    s_waitcnt lgkmcnt(11)
    v_mfma_f32_16x16x32_bf16 v[208:211], v[232:235], v[32:35], v[208:211]
    ds_read_b64_tr_b16 v[230:231], v255 offset:7936
    v_or_b32 v170, v184, v185
    v_exp_f16_sdwa v207, v207 dst_sel:WORD_0 dst_unused:UNUSED_PRESERVE src0_sel:WORD_0
    v_mfma_f32_16x16x32_bf16 v[212:215], v[232:235], v[36:39], v[212:215]
    ds_read_u16_d16 v198, v198
    v_lshlrev_b32_sdwa v200, 1, v200 dst_sel:DWORD dst_unused:UNUSED_PAD src0_sel:DWORD src1_sel:WORD_1
    v_mfma_f32_16x16x32_bf16 v[216:219], v[232:235], v[40:43], v[216:219]
    ds_read_u16_d16_hi v199, v199
    v_lshlrev_b32_sdwa v201, 1, v201 dst_sel:DWORD dst_unused:UNUSED_PAD src0_sel:DWORD src1_sel:WORD_1
    v_mfma_f32_16x16x32_bf16 v[220:223], v[232:235], v[44:47], v[220:223]
    ds_read_b64_tr_b16 v[232:233], v254 offset:13312
    v_exp_f16_sdwa v205, v205 dst_sel:WORD_1 dst_unused:UNUSED_PRESERVE src0_sel:WORD_1
    v_or_b32 v171, v186, v187
    s_waitcnt lgkmcnt(11)
    v_mfma_f32_16x16x32_bf16 v[116:119], v[236:239], v[144:147], 0
    ds_read_b64_tr_b16 v[234:235], v254 offset:13568
    v_exp_f16_sdwa v207, v207 dst_sel:WORD_1 dst_unused:UNUSED_PRESERVE src0_sel:WORD_1
    v_mfma_f32_16x16x32_bf16 v[124:127], v[236:239], v[148:151], 0
    ds_read_u16_d16 v200, v200
    v_lshlrev_b32_sdwa v202, 1, v202 dst_sel:DWORD dst_unused:UNUSED_PAD src0_sel:DWORD src1_sel:WORD_1
    v_mfma_f32_16x16x32_bf16 v[132:135], v[236:239], v[152:155], 0
    ds_read_u16_d16_hi v201, v201
    v_lshlrev_b32_sdwa v203, 1, v203 dst_sel:DWORD dst_unused:UNUSED_PAD src0_sel:DWORD src1_sel:WORD_1
    v_pk_fma_f16 v205, v205, s85, s85
    v_mfma_f32_16x16x32_bf16 v[140:143], v[236:239], v[156:159], 0
    ds_read_b64_tr_b16 v[236:237], v255 offset:7176
    v_or_b32 v174, v188, v189
    v_pk_fma_f16 v207, v207, s85, s85
    s_waitcnt lgkmcnt(11)
    v_mfma_f32_16x16x32_bf16 v[176:179], v[224:227], v[0:3], 0
    ds_read_b64_tr_b16 v[238:239], v255 offset:7944
    v_or_b32 v144, v192, v193
    v_mfma_f32_16x16x32_bf16 v[180:183], v[224:227], v[4:7], 0
    ds_read_u16_d16 v202, v202
    v_rcp_f16_sdwa v205, v205 dst_sel:WORD_0 dst_unused:UNUSED_PRESERVE src0_sel:WORD_0
    v_lshlrev_b32_sdwa v208, 1, v208 dst_sel:DWORD dst_unused:UNUSED_PAD src0_sel:DWORD src1_sel:WORD_1
    v_mfma_f32_16x16x32_bf16 v[184:187], v[224:227], v[8:11], 0
    ds_read_u16_d16_hi v203, v203
    v_rcp_f16_sdwa v207, v207 dst_sel:WORD_0 dst_unused:UNUSED_PRESERVE src0_sel:WORD_0
    v_mfma_f32_16x16x32_bf16 v[188:191], v[224:227], v[12:15], 0
    ds_read_b64_tr_b16 v[224:225], v254 offset:14336
    v_lshlrev_b32_sdwa v209, 1, v209 dst_sel:DWORD dst_unused:UNUSED_PAD src0_sel:DWORD src1_sel:WORD_1
    s_waitcnt lgkmcnt(11)
    v_mfma_f32_16x16x32_bf16 v[48:51], v[228:231], v[160:163], v[48:51]
    ds_read_b64_tr_b16 v[226:227], v254 offset:14592
    v_or_b32 v145, v194, v195
    v_fma_mixlo_f16 v222, v222, s83, 0
    v_mfma_f32_16x16x32_bf16 v[56:59], v[228:231], v[164:167], v[56:59]
    ds_read_u16_d16 v208, v208
    v_lshlrev_b32_sdwa v210, 1, v210 dst_sel:DWORD dst_unused:UNUSED_PAD src0_sel:DWORD src1_sel:WORD_1
    v_mfma_f32_16x16x32_bf16 v[64:67], v[228:231], v[168:171], v[64:67]
    ds_read_u16_d16_hi v209, v209
    v_rcp_f16_sdwa v205, v205 dst_sel:WORD_1 dst_unused:UNUSED_PRESERVE src0_sel:WORD_1
    v_lshlrev_b32_sdwa v211, 1, v211 dst_sel:DWORD dst_unused:UNUSED_PAD src0_sel:DWORD src1_sel:WORD_1
    v_mfma_f32_16x16x32_bf16 v[72:75], v[228:231], v[172:175], v[72:75]
    ds_read_b64_tr_b16 v[228:229], v255 offset:7232
    v_or_b32 v148, v196, v197
    s_waitcnt lgkmcnt(11)
    v_mfma_f32_16x16x32_bf16 v[176:179], v[232:235], v[16:19], v[176:179]
    ds_read_b64_tr_b16 v[230:231], v255 offset:8000
    v_rcp_f16_sdwa v207, v207 dst_sel:WORD_1 dst_unused:UNUSED_PRESERVE src0_sel:WORD_1
    v_mfma_f32_16x16x32_bf16 v[180:183], v[232:235], v[20:23], v[180:183]
    ds_read_u16_d16 v210, v210
    v_lshlrev_b32_sdwa v212, 1, v212 dst_sel:DWORD dst_unused:UNUSED_PAD src0_sel:DWORD src1_sel:WORD_1
    v_fma_mixhi_f16 v222, v223, s83, 0
    v_mfma_f32_16x16x32_bf16 v[184:187], v[232:235], v[24:27], v[184:187]
    ds_read_u16_d16_hi v211, v211
    v_lshlrev_b32_sdwa v213, 1, v213 dst_sel:DWORD dst_unused:UNUSED_PAD src0_sel:DWORD src1_sel:WORD_1
    v_fma_mix_f32 v156, v204, v205, 0 op_sel_hi:[1,1,0]
    v_mfma_f32_16x16x32_bf16 v[188:191], v[232:235], v[28:31], v[188:191]
    ds_read_b64_tr_b16 v[232:233], v254 offset:12296
    ds_read_b64_tr_b16 v[234:235], v254 offset:12552
    v_or_b32 v149, v198, v199
    v_fma_mix_f32 v157, v206, v207, 0 op_sel_hi:[1,1,0]
    s_waitcnt lgkmcnt(12)
    v_mfma_f32_16x16x32_bf16 v[52:55], v[236:239], v[160:163], v[52:55]
    ds_read_u16_d16 v212, v212
    v_lshlrev_b32_sdwa v214, 1, v214 dst_sel:DWORD dst_unused:UNUSED_PAD src0_sel:DWORD src1_sel:WORD_1
    v_mfma_f32_16x16x32_bf16 v[60:63], v[236:239], v[164:167], v[60:63]
    ds_read_u16_d16_hi v213, v213
    v_pk_fma_f16 v223, v222, v222, s84 neg_lo:[0,1,0] neg_hi:[0,1,0]
    v_lshlrev_b32_sdwa v215, 1, v215 dst_sel:DWORD dst_unused:UNUSED_PAD src0_sel:DWORD src1_sel:WORD_1
    v_mfma_f32_16x16x32_bf16 v[68:71], v[236:239], v[168:171], v[68:71]
    ds_read_u16_d16 v214, v214
    v_fma_mix_f32 v205, v204, v205, 0 op_sel:[1,1,0] op_sel_hi:[1,1,0]
    v_or_b32 v152, v200, v201
    v_mfma_f32_16x16x32_bf16 v[76:79], v[236:239], v[172:175], v[76:79]
    ds_read_b64_tr_b16 v[236:237], v255 offset:7240
    v_fma_mix_f32 v207, v206, v207, 0 op_sel:[1,1,0] op_sel_hi:[1,1,0]
    v_lshlrev_b32_sdwa v216, 1, v216 dst_sel:DWORD dst_unused:UNUSED_PAD src0_sel:DWORD src1_sel:WORD_1
    s_waitcnt lgkmcnt(12)
    v_mfma_f32_16x16x32_bf16 v[176:179], v[224:227], v[32:35], v[176:179]
    ds_read_b64_tr_b16 v[238:239], v255 offset:8008
    v_pk_mul_f16 v223, v223, v222
    v_mfma_f32_16x16x32_bf16 v[180:183], v[224:227], v[36:39], v[180:183]
    ds_read_u16_d16_hi v215, v215
    v_cvt_pk_bf16_f32 v156, v156, v205
    v_lshlrev_b32_sdwa v217, 1, v217 dst_sel:DWORD dst_unused:UNUSED_PAD src0_sel:DWORD src1_sel:WORD_1
    v_mfma_f32_16x16x32_bf16 v[184:187], v[224:227], v[40:43], v[184:187]
    ds_read_u16_d16 v216, v216
    v_cvt_pk_bf16_f32 v157, v157, v207
    v_or_b32 v153, v202, v203
    v_mfma_f32_16x16x32_bf16 v[188:191], v[224:227], v[44:47], v[188:191]
    ds_read_b64_tr_b16 v[224:225], v254 offset:13320
    v_exp_f16_sdwa v223, v223 dst_sel:WORD_0 dst_unused:UNUSED_PRESERVE src0_sel:WORD_0
    s_waitcnt lgkmcnt(12)
    v_mfma_f32_16x16x32_bf16 v[80:83], v[228:231], v[160:163], v[80:83]
    ds_read_b64_tr_b16 v[226:227], v254 offset:13576
    v_lshlrev_b32_sdwa v218, 1, v218 dst_sel:DWORD dst_unused:UNUSED_PAD src0_sel:DWORD src1_sel:WORD_1
    v_lshlrev_b32_sdwa v219, 1, v219 dst_sel:DWORD dst_unused:UNUSED_PAD src0_sel:DWORD src1_sel:WORD_1
    v_mfma_f32_16x16x32_bf16 v[88:91], v[228:231], v[164:167], v[88:91]
    ds_read_u16_d16_hi v217, v217
    v_exp_f16_sdwa v223, v223 dst_sel:WORD_1 dst_unused:UNUSED_PRESERVE src0_sel:WORD_1
    v_mfma_f32_16x16x32_bf16 v[96:99], v[228:231], v[168:171], v[96:99]
    ds_read_u16_d16 v218, v218
    v_lshlrev_b32_sdwa v220, 1, v220 dst_sel:DWORD dst_unused:UNUSED_PAD src0_sel:DWORD src1_sel:WORD_1
    v_mfma_f32_16x16x32_bf16 v[104:107], v[228:231], v[172:175], v[104:107]
    ds_read_b64_tr_b16 v[228:229], v255 offset:7296
    ds_read_b64_tr_b16 v[230:231], v255 offset:8064
    v_lshlrev_b32_sdwa v221, 1, v221 dst_sel:DWORD dst_unused:UNUSED_PAD src0_sel:DWORD src1_sel:WORD_1
    v_pk_fma_f16 v223, v223, s85, s85
    s_waitcnt lgkmcnt(13)
    v_mfma_f32_16x16x32_bf16 v[192:195], v[232:235], v[0:3], 0
    ds_read_u16_d16_hi v219, v219
    v_or_b32 v146, v208, v209
    v_mfma_f32_16x16x32_bf16 v[196:199], v[232:235], v[4:7], 0
    ds_read_u16_d16 v220, v220
    v_rcp_f16_sdwa v223, v223 dst_sel:WORD_0 dst_unused:UNUSED_PRESERVE src0_sel:WORD_0
    v_lshlrev_b32_sdwa v176, 1, v176 dst_sel:DWORD dst_unused:UNUSED_PAD src0_sel:DWORD src1_sel:WORD_1
    v_mfma_f32_16x16x32_bf16 v[200:203], v[232:235], v[8:11], 0
    ds_read_u16_d16_hi v221, v221
    v_fma_mixlo_f16 v188, v188, s83, 0
    v_lshlrev_b32_sdwa v177, 1, v177 dst_sel:DWORD dst_unused:UNUSED_PAD src0_sel:DWORD src1_sel:WORD_1
    v_mfma_f32_16x16x32_bf16 v[204:207], v[232:235], v[12:15], 0
    ds_read_b64_tr_b16 v[232:233], v254 offset:14344
    v_fma_mixlo_f16 v190, v190, s83, 0
    v_or_b32 v147, v210, v211
    s_waitcnt lgkmcnt(12)
    v_mfma_f32_16x16x32_bf16 v[84:87], v[236:239], v[160:163], v[84:87]
    ds_read_b64_tr_b16 v[234:235], v254 offset:14600
    v_rcp_f16_sdwa v223, v223 dst_sel:WORD_1 dst_unused:UNUSED_PRESERVE src0_sel:WORD_1
    v_mfma_f32_16x16x32_bf16 v[92:95], v[236:239], v[164:167], v[92:95]
    ds_read_u16_d16 v176, v176
    s_waitcnt vmcnt(1)
    v_mfma_f32_16x16x16_bf16 v[48:51], v[242:243], v[244:245], v[48:51]
    v_lshlrev_b32_sdwa v178, 1, v178 dst_sel:DWORD dst_unused:UNUSED_PAD src0_sel:DWORD src1_sel:WORD_1
    v_mfma_f32_16x16x32_bf16 v[100:103], v[236:239], v[168:171], v[100:103]
    ds_read_u16_d16_hi v177, v177
    v_fma_mixhi_f16 v188, v189, s83, 0
    v_mfma_f32_16x16x32_bf16 v[108:111], v[236:239], v[172:175], v[108:111]
    ds_read_b64_tr_b16 v[236:237], v255 offset:7304
    v_mfma_f32_16x16x16_bf16 v[52:55], v[242:243], v[246:247], v[52:55]
    v_lshlrev_b32_sdwa v179, 1, v179 dst_sel:DWORD dst_unused:UNUSED_PAD src0_sel:DWORD src1_sel:WORD_1
    v_fma_mixhi_f16 v190, v191, s83, 0
    s_waitcnt lgkmcnt(12)
    v_mfma_f32_16x16x32_bf16 v[192:195], v[224:227], v[16:19], v[192:195]
    ds_read_b64_tr_b16 v[238:239], v255 offset:8072
    buffer_load_dwordx4 v[244:247], v252, s[4:7], s24 offen offset:128 sc1
    v_or_b32 v150, v212, v213
    v_mfma_f32_16x16x32_bf16 v[196:199], v[224:227], v[20:23], v[196:199]
    ds_read_u16_d16 v178, v178
    v_fma_mix_f32 v159, v222, v223, 0 op_sel_hi:[1,1,0]
    v_pk_fma_f16 v189, v188, v188, s84 neg_lo:[0,1,0] neg_hi:[0,1,0]
    v_mfma_f32_16x16x32_bf16 v[200:203], v[224:227], v[24:27], v[200:203]
    ds_read_u16_d16_hi v179, v179
    v_lshlrev_b32_sdwa v180, 1, v180 dst_sel:DWORD dst_unused:UNUSED_PAD src0_sel:DWORD src1_sel:WORD_1
    v_pk_fma_f16 v191, v190, v190, s84 neg_lo:[0,1,0] neg_hi:[0,1,0]
    v_mfma_f32_16x16x32_bf16 v[204:207], v[224:227], v[28:31], v[204:207]
    v_bfe_u32 v224, v253, 8, 1
    v_mul_u32_u24 v224, 50176, v224
    v_subrev_u32 v224, 131080, v224
    v_add_u32 v254, v254, v224
    s_cmp_lt_u32 s19, 8
    s_cbranch_scc1 L_rd8_slow
L_rd8_go:
    ds_read_b64_tr_b16 v[224:225], v254 offset:10240
    v_lshlrev_b32_sdwa v181, 1, v181 dst_sel:DWORD dst_unused:UNUSED_PAD src0_sel:DWORD src1_sel:WORD_1
    v_fma_mix_f32 v223, v222, v223, 0 op_sel:[1,1,0] op_sel_hi:[1,1,0]
    s_waitcnt lgkmcnt(12)
    v_mfma_f32_16x16x32_bf16 v[112:115], v[228:231], v[160:163], v[112:115]
    ds_read_b64_tr_b16 v[226:227], v254 offset:10496
    v_or_b32 v151, v214, v215
    v_pk_mul_f16 v189, v189, v188
    v_mfma_f32_16x16x32_bf16 v[120:123], v[228:231], v[164:167], v[120:123]
    ds_read_u16_d16 v180, v180
    v_pk_mul_f16 v191, v191, v190
    v_lshlrev_b32_sdwa v182, 1, v182 dst_sel:DWORD dst_unused:UNUSED_PAD src0_sel:DWORD src1_sel:WORD_1
    v_mfma_f32_16x16x32_bf16 v[128:131], v[228:231], v[168:171], v[128:131]
    ds_read_u16_d16_hi v181, v181
    v_cvt_pk_bf16_f32 v159, v159, v223
    v_lshlrev_b32_sdwa v183, 1, v183 dst_sel:DWORD dst_unused:UNUSED_PAD src0_sel:DWORD src1_sel:WORD_1
    v_mfma_f32_16x16x32_bf16 v[136:139], v[228:231], v[172:175], v[136:139]
    ds_read_b64_tr_b16 v[228:229], v255 offset:13312
    v_exp_f16_sdwa v189, v189 dst_sel:WORD_0 dst_unused:UNUSED_PRESERVE src0_sel:WORD_0
    s_waitcnt lgkmcnt(11)
    v_mfma_f32_16x16x32_bf16 v[192:195], v[232:235], v[32:35], v[192:195]
    ds_read_b64_tr_b16 v[230:231], v255 offset:14080
    v_or_b32 v154, v216, v217
    v_mfma_f32_16x16x32_bf16 v[196:199], v[232:235], v[36:39], v[196:199]
    ds_read_u16_d16 v182, v182
    v_exp_f16_sdwa v191, v191 dst_sel:WORD_0 dst_unused:UNUSED_PRESERVE src0_sel:WORD_0
    v_lshlrev_b32_sdwa v184, 1, v184 dst_sel:DWORD dst_unused:UNUSED_PAD src0_sel:DWORD src1_sel:WORD_1
    v_mfma_f32_16x16x32_bf16 v[200:203], v[232:235], v[40:43], v[200:203]
    ds_read_u16_d16_hi v183, v183
    v_lshlrev_b32_sdwa v185, 1, v185 dst_sel:DWORD dst_unused:UNUSED_PAD src0_sel:DWORD src1_sel:WORD_1
    v_mfma_f32_16x16x32_bf16 v[204:207], v[232:235], v[44:47], v[204:207]
    ds_read_b64_tr_b16 v[232:233], v254 offset:11264
    v_exp_f16_sdwa v189, v189 dst_sel:WORD_1 dst_unused:UNUSED_PRESERVE src0_sel:WORD_1
    s_waitcnt lgkmcnt(11)
    v_mfma_f32_16x16x32_bf16 v[116:119], v[236:239], v[160:163], v[116:119]
    ds_read_b64_tr_b16 v[234:235], v254 offset:11520
    v_or_b32 v155, v218, v219
    v_exp_f16_sdwa v191, v191 dst_sel:WORD_1 dst_unused:UNUSED_PRESERVE src0_sel:WORD_1
    v_mfma_f32_16x16x32_bf16 v[124:127], v[236:239], v[164:167], v[124:127]
    ds_read_u16_d16 v184, v184
    v_lshlrev_b32_sdwa v186, 1, v186 dst_sel:DWORD dst_unused:UNUSED_PAD src0_sel:DWORD src1_sel:WORD_1
    v_mfma_f32_16x16x32_bf16 v[132:135], v[236:239], v[168:171], v[132:135]
    ds_read_u16_d16_hi v185, v185
    v_lshlrev_b32_sdwa v187, 1, v187 dst_sel:DWORD dst_unused:UNUSED_PAD src0_sel:DWORD src1_sel:WORD_1
    v_pk_fma_f16 v189, v189, s85, s85
    v_mfma_f32_16x16x32_bf16 v[140:143], v[236:239], v[172:175], v[140:143]
    ds_read_b64_tr_b16 v[236:237], v255 offset:13320
    v_or_b32 v158, v220, v221
    v_pk_fma_f16 v191, v191, s85, s85
    s_waitcnt lgkmcnt(11)
    v_mfma_f32_16x16x32_bf16 v[208:211], v[224:227], v[0:3], 0
    ds_read_b64_tr_b16 v[238:239], v255 offset:14088
    v_or_b32 v160, v176, v177
    v_mfma_f32_16x16x32_bf16 v[212:215], v[224:227], v[4:7], 0
    ds_read_u16_d16 v186, v186
    v_rcp_f16_sdwa v189, v189 dst_sel:WORD_0 dst_unused:UNUSED_PRESERVE src0_sel:WORD_0
    v_lshlrev_b32_sdwa v192, 1, v192 dst_sel:DWORD dst_unused:UNUSED_PAD src0_sel:DWORD src1_sel:WORD_1
    v_mfma_f32_16x16x32_bf16 v[216:219], v[224:227], v[8:11], 0
    ds_read_u16_d16_hi v187, v187
    v_rcp_f16_sdwa v191, v191 dst_sel:WORD_0 dst_unused:UNUSED_PRESERVE src0_sel:WORD_0
    v_mfma_f32_16x16x32_bf16 v[220:223], v[224:227], v[12:15], 0
    ds_read_b64_tr_b16 v[224:225], v254 offset:12288
    v_lshlrev_b32_sdwa v193, 1, v193 dst_sel:DWORD dst_unused:UNUSED_PAD src0_sel:DWORD src1_sel:WORD_1
    v_or_b32 v161, v178, v179
    s_waitcnt lgkmcnt(11)
    v_mfma_f32_16x16x32_bf16 v[48:51], v[228:231], v[144:147], v[48:51]
    ds_read_b64_tr_b16 v[226:227], v254 offset:12544
    v_fma_mixlo_f16 v206, v206, s83, 0
    v_mfma_f32_16x16x32_bf16 v[56:59], v[228:231], v[148:151], v[56:59]
    ds_read_u16_d16 v192, v192
    s_waitcnt vmcnt(1)
    v_mfma_f32_16x16x16_bf16 v[80:83], v[242:243], v[248:249], v[80:83]
    v_lshlrev_b32_sdwa v194, 1, v194 dst_sel:DWORD dst_unused:UNUSED_PAD src0_sel:DWORD src1_sel:WORD_1
    v_mfma_f32_16x16x32_bf16 v[64:67], v[228:231], v[152:155], v[64:67]
    ds_read_u16_d16_hi v193, v193
    v_rcp_f16_sdwa v189, v189 dst_sel:WORD_1 dst_unused:UNUSED_PRESERVE src0_sel:WORD_1
    v_mfma_f32_16x16x32_bf16 v[72:75], v[228:231], v[156:159], v[72:75]
    ds_read_b64_tr_b16 v[228:229], v255 offset:13376
    v_mfma_f32_16x16x16_bf16 v[84:87], v[242:243], v[250:251], v[84:87]
    v_lshlrev_b32_sdwa v195, 1, v195 dst_sel:DWORD dst_unused:UNUSED_PAD src0_sel:DWORD src1_sel:WORD_1
    v_or_b32 v164, v180, v181
    s_waitcnt lgkmcnt(11)
    v_mfma_f32_16x16x32_bf16 v[208:211], v[232:235], v[16:19], v[208:211]
    ds_read_b64_tr_b16 v[230:231], v255 offset:14144
    buffer_load_dwordx4 v[248:251], v252, s[4:7], s24 offen offset:192 sc1
    v_mfma_f32_16x16x32_bf16 v[212:215], v[232:235], v[20:23], v[212:215]
    ds_read_u16_d16 v194, v194
    v_rcp_f16_sdwa v191, v191 dst_sel:WORD_1 dst_unused:UNUSED_PRESERVE src0_sel:WORD_1
    v_lshlrev_b32_sdwa v196, 1, v196 dst_sel:DWORD dst_unused:UNUSED_PAD src0_sel:DWORD src1_sel:WORD_1
    v_mfma_f32_16x16x32_bf16 v[216:219], v[232:235], v[24:27], v[216:219]
    ds_read_u16_d16_hi v195, v195
    v_fma_mixhi_f16 v206, v207, s83, 0
    v_lshlrev_b32_sdwa v197, 1, v197 dst_sel:DWORD dst_unused:UNUSED_PAD src0_sel:DWORD src1_sel:WORD_1
    v_mfma_f32_16x16x32_bf16 v[220:223], v[232:235], v[28:31], v[220:223]
    ds_read_b64_tr_b16 v[232:233], v254 offset:10248
    ds_read_b64_tr_b16 v[234:235], v254 offset:10504
    v_fma_mix_f32 v172, v188, v189, 0 op_sel_hi:[1,1,0]
    v_or_b32 v165, v182, v183
    s_waitcnt lgkmcnt(12)
    v_mfma_f32_16x16x32_bf16 v[52:55], v[236:239], v[144:147], v[52:55]
    ds_read_u16_d16 v196, v196
    v_fma_mix_f32 v173, v190, v191, 0 op_sel_hi:[1,1,0]
    v_mfma_f32_16x16x32_bf16 v[60:63], v[236:239], v[148:151], v[60:63]
    ds_read_u16_d16_hi v197, v197
    v_lshlrev_b32_sdwa v198, 1, v198 dst_sel:DWORD dst_unused:UNUSED_PAD src0_sel:DWORD src1_sel:WORD_1
    v_pk_fma_f16 v207, v206, v206, s84 neg_lo:[0,1,0] neg_hi:[0,1,0]
    v_mfma_f32_16x16x32_bf16 v[68:71], v[236:239], v[152:155], v[68:71]
    ds_read_u16_d16 v198, v198
    v_lshlrev_b32_sdwa v199, 1, v199 dst_sel:DWORD dst_unused:UNUSED_PAD src0_sel:DWORD src1_sel:WORD_1
    v_fma_mix_f32 v189, v188, v189, 0 op_sel:[1,1,0] op_sel_hi:[1,1,0]
    v_mfma_f32_16x16x32_bf16 v[76:79], v[236:239], v[156:159], v[76:79]
    ds_read_b64_tr_b16 v[236:237], v255 offset:13384
    v_or_b32 v168, v184, v185
    v_fma_mix_f32 v191, v190, v191, 0 op_sel:[1,1,0] op_sel_hi:[1,1,0]
    s_waitcnt lgkmcnt(12)
    v_mfma_f32_16x16x32_bf16 v[208:211], v[224:227], v[32:35], v[208:211]
    ds_read_b64_tr_b16 v[238:239], v255 offset:14152
    v_lshlrev_b32_sdwa v200, 1, v200 dst_sel:DWORD dst_unused:UNUSED_PAD src0_sel:DWORD src1_sel:WORD_1
    v_pk_mul_f16 v207, v207, v206
    v_mfma_f32_16x16x32_bf16 v[212:215], v[224:227], v[36:39], v[212:215]
    ds_read_u16_d16_hi v199, v199
    v_cvt_pk_bf16_f32 v172, v172, v189
    v_lshlrev_b32_sdwa v201, 1, v201 dst_sel:DWORD dst_unused:UNUSED_PAD src0_sel:DWORD src1_sel:WORD_1
    v_mfma_f32_16x16x32_bf16 v[216:219], v[224:227], v[40:43], v[216:219]
    ds_read_u16_d16 v200, v200
    v_cvt_pk_bf16_f32 v173, v173, v191
    v_or_b32 v169, v186, v187
    v_mfma_f32_16x16x32_bf16 v[220:223], v[224:227], v[44:47], v[220:223]
    ds_read_b64_tr_b16 v[224:225], v254 offset:11272
    v_exp_f16_sdwa v207, v207 dst_sel:WORD_0 dst_unused:UNUSED_PRESERVE src0_sel:WORD_0
    s_waitcnt lgkmcnt(12)
    v_mfma_f32_16x16x32_bf16 v[80:83], v[228:231], v[144:147], v[80:83]
    ds_read_b64_tr_b16 v[226:227], v254 offset:11528
    v_lshlrev_b32_sdwa v202, 1, v202 dst_sel:DWORD dst_unused:UNUSED_PAD src0_sel:DWORD src1_sel:WORD_1
    v_mfma_f32_16x16x32_bf16 v[88:91], v[228:231], v[148:151], v[88:91]
    ds_read_u16_d16_hi v201, v201
    v_lshlrev_b32_sdwa v203, 1, v203 dst_sel:DWORD dst_unused:UNUSED_PAD src0_sel:DWORD src1_sel:WORD_1
    v_exp_f16_sdwa v207, v207 dst_sel:WORD_1 dst_unused:UNUSED_PRESERVE src0_sel:WORD_1
    v_mfma_f32_16x16x32_bf16 v[96:99], v[228:231], v[152:155], v[96:99]
    ds_read_u16_d16 v202, v202
    v_lshlrev_b32_sdwa v204, 1, v204 dst_sel:DWORD dst_unused:UNUSED_PAD src0_sel:DWORD src1_sel:WORD_1
    v_mfma_f32_16x16x32_bf16 v[104:107], v[228:231], v[156:159], v[104:107]
    ds_read_b64_tr_b16 v[228:229], v255 offset:13440
    ds_read_b64_tr_b16 v[230:231], v255 offset:14208
    v_lshlrev_b32_sdwa v205, 1, v205 dst_sel:DWORD dst_unused:UNUSED_PAD src0_sel:DWORD src1_sel:WORD_1
    v_pk_fma_f16 v207, v207, s85, s85
    s_waitcnt lgkmcnt(13)
    v_mfma_f32_16x16x32_bf16 v[176:179], v[232:235], v[0:3], 0
    ds_read_u16_d16_hi v203, v203
    v_or_b32 v162, v192, v193
    v_mfma_f32_16x16x32_bf16 v[180:183], v[232:235], v[4:7], 0
    ds_read_u16_d16 v204, v204
    v_rcp_f16_sdwa v207, v207 dst_sel:WORD_0 dst_unused:UNUSED_PRESERVE src0_sel:WORD_0
    v_lshlrev_b32_sdwa v208, 1, v208 dst_sel:DWORD dst_unused:UNUSED_PAD src0_sel:DWORD src1_sel:WORD_1
    v_mfma_f32_16x16x32_bf16 v[184:187], v[232:235], v[8:11], 0
    ds_read_u16_d16_hi v205, v205
    v_fma_mixlo_f16 v220, v220, s83, 0
    v_lshlrev_b32_sdwa v209, 1, v209 dst_sel:DWORD dst_unused:UNUSED_PAD src0_sel:DWORD src1_sel:WORD_1
    v_mfma_f32_16x16x32_bf16 v[188:191], v[232:235], v[12:15], 0
    ds_read_b64_tr_b16 v[232:233], v254 offset:12296
    v_fma_mixlo_f16 v222, v222, s83, 0
    s_waitcnt lgkmcnt(12)
    v_mfma_f32_16x16x32_bf16 v[84:87], v[236:239], v[144:147], v[84:87]
    ds_read_b64_tr_b16 v[234:235], v254 offset:12552
    v_or_b32 v163, v194, v195
    v_rcp_f16_sdwa v207, v207 dst_sel:WORD_1 dst_unused:UNUSED_PRESERVE src0_sel:WORD_1
    v_mfma_f32_16x16x32_bf16 v[92:95], v[236:239], v[148:151], v[92:95]
    ds_read_u16_d16 v208, v208
    v_lshlrev_b32_sdwa v210, 1, v210 dst_sel:DWORD dst_unused:UNUSED_PAD src0_sel:DWORD src1_sel:WORD_1
    v_mfma_f32_16x16x32_bf16 v[100:103], v[236:239], v[152:155], v[100:103]
    ds_read_u16_d16_hi v209, v209
    v_fma_mixhi_f16 v220, v221, s83, 0
    v_lshlrev_b32_sdwa v211, 1, v211 dst_sel:DWORD dst_unused:UNUSED_PAD src0_sel:DWORD src1_sel:WORD_1
    v_mfma_f32_16x16x32_bf16 v[108:111], v[236:239], v[156:159], v[108:111]
    ds_read_b64_tr_b16 v[236:237], v255 offset:13448
    v_fma_mixhi_f16 v222, v223, s83, 0
    v_or_b32 v166, v196, v197
    s_waitcnt lgkmcnt(12)
    v_mfma_f32_16x16x32_bf16 v[176:179], v[224:227], v[16:19], v[176:179]
    ds_read_b64_tr_b16 v[238:239], v255 offset:14216
    v_fma_mix_f32 v175, v206, v207, 0 op_sel_hi:[1,1,0]
    v_pk_fma_f16 v221, v220, v220, s84 neg_lo:[0,1,0] neg_hi:[0,1,0]
    v_mfma_f32_16x16x32_bf16 v[180:183], v[224:227], v[20:23], v[180:183]
    ds_read_u16_d16 v210, v210
    v_lshlrev_b32_sdwa v212, 1, v212 dst_sel:DWORD dst_unused:UNUSED_PAD src0_sel:DWORD src1_sel:WORD_1
    v_mfma_f32_16x16x32_bf16 v[184:187], v[224:227], v[24:27], v[184:187]
    ds_read_u16_d16_hi v211, v211
    v_pk_fma_f16 v223, v222, v222, s84 neg_lo:[0,1,0] neg_hi:[0,1,0]
    v_lshlrev_b32_sdwa v213, 1, v213 dst_sel:DWORD dst_unused:UNUSED_PAD src0_sel:DWORD src1_sel:WORD_1
    v_mfma_f32_16x16x32_bf16 v[188:191], v[224:227], v[28:31], v[188:191]
    s_cmp_lt_u32 s19, 10
    s_cbranch_scc1 L_rd10_slow
L_rd10_go:
    ds_read_b64_tr_b16 v[224:225], v254 offset:16384
    v_fma_mix_f32 v207, v206, v207, 0 op_sel:[1,1,0] op_sel_hi:[1,1,0]
    v_or_b32 v167, v198, v199
    s_waitcnt lgkmcnt(12)
    v_mfma_f32_16x16x32_bf16 v[112:115], v[228:231], v[144:147], v[112:115]
    ds_read_b64_tr_b16 v[226:227], v254 offset:16640
    v_pk_mul_f16 v221, v221, v220
    v_pk_mul_f16 v223, v223, v222
    v_mfma_f32_16x16x32_bf16 v[120:123], v[228:231], v[148:151], v[120:123]
    ds_read_u16_d16 v212, v212
    v_lshlrev_b32_sdwa v214, 1, v214 dst_sel:DWORD dst_unused:UNUSED_PAD src0_sel:DWORD src1_sel:WORD_1
    v_cvt_pk_bf16_f32 v175, v175, v207
    v_mfma_f32_16x16x32_bf16 v[128:131], v[228:231], v[152:155], v[128:131]
    ds_read_u16_d16_hi v213, v213
    v_lshlrev_b32_sdwa v215, 1, v215 dst_sel:DWORD dst_unused:UNUSED_PAD src0_sel:DWORD src1_sel:WORD_1
    v_mfma_f32_16x16x32_bf16 v[136:139], v[228:231], v[156:159], v[136:139]
    ds_read_b64_tr_b16 v[228:229], v255 offset:19456
    v_exp_f16_sdwa v221, v221 dst_sel:WORD_0 dst_unused:UNUSED_PRESERVE src0_sel:WORD_0
    s_waitcnt lgkmcnt(11)
    v_mfma_f32_16x16x32_bf16 v[176:179], v[232:235], v[32:35], v[176:179]
    ds_read_b64_tr_b16 v[230:231], v255 offset:20224
    v_or_b32 v170, v200, v201
    v_exp_f16_sdwa v223, v223 dst_sel:WORD_0 dst_unused:UNUSED_PRESERVE src0_sel:WORD_0
    v_mfma_f32_16x16x32_bf16 v[180:183], v[232:235], v[36:39], v[180:183]
    ds_read_u16_d16 v214, v214
    v_lshlrev_b32_sdwa v216, 1, v216 dst_sel:DWORD dst_unused:UNUSED_PAD src0_sel:DWORD src1_sel:WORD_1
    v_mfma_f32_16x16x32_bf16 v[184:187], v[232:235], v[40:43], v[184:187]
    ds_read_u16_d16_hi v215, v215
    v_lshlrev_b32_sdwa v217, 1, v217 dst_sel:DWORD dst_unused:UNUSED_PAD src0_sel:DWORD src1_sel:WORD_1
    v_mfma_f32_16x16x32_bf16 v[188:191], v[232:235], v[44:47], v[188:191]
    ds_read_b64_tr_b16 v[232:233], v254 offset:17408
    v_exp_f16_sdwa v221, v221 dst_sel:WORD_1 dst_unused:UNUSED_PRESERVE src0_sel:WORD_1
    v_or_b32 v171, v202, v203
    s_waitcnt lgkmcnt(11)
    v_mfma_f32_16x16x32_bf16 v[116:119], v[236:239], v[144:147], v[116:119]
    ds_read_b64_tr_b16 v[234:235], v254 offset:17664
    v_exp_f16_sdwa v223, v223 dst_sel:WORD_1 dst_unused:UNUSED_PRESERVE src0_sel:WORD_1
    v_mfma_f32_16x16x32_bf16 v[124:127], v[236:239], v[148:151], v[124:127]
    ds_read_u16_d16 v216, v216
    v_lshlrev_b32_sdwa v218, 1, v218 dst_sel:DWORD dst_unused:UNUSED_PAD src0_sel:DWORD src1_sel:WORD_1
    v_mfma_f32_16x16x32_bf16 v[132:135], v[236:239], v[152:155], v[132:135]
    ds_read_u16_d16_hi v217, v217
    v_lshlrev_b32_sdwa v219, 1, v219 dst_sel:DWORD dst_unused:UNUSED_PAD src0_sel:DWORD src1_sel:WORD_1
    v_pk_fma_f16 v221, v221, s85, s85
    v_mfma_f32_16x16x32_bf16 v[140:143], v[236:239], v[156:159], v[140:143]
    ds_read_b64_tr_b16 v[236:237], v255 offset:19464
    v_or_b32 v174, v204, v205
    v_pk_fma_f16 v223, v223, s85, s85
    s_waitcnt lgkmcnt(11)
    v_mfma_f32_16x16x32_bf16 v[192:195], v[224:227], v[0:3], 0
    ds_read_b64_tr_b16 v[238:239], v255 offset:20232
    v_or_b32 v144, v208, v209
    v_mfma_f32_16x16x32_bf16 v[196:199], v[224:227], v[4:7], 0
    ds_read_u16_d16 v218, v218
    v_rcp_f16_sdwa v221, v221 dst_sel:WORD_0 dst_unused:UNUSED_PRESERVE src0_sel:WORD_0
    v_lshlrev_b32_sdwa v176, 1, v176 dst_sel:DWORD dst_unused:UNUSED_PAD src0_sel:DWORD src1_sel:WORD_1
    v_mfma_f32_16x16x32_bf16 v[200:203], v[224:227], v[8:11], 0
    ds_read_u16_d16_hi v219, v219
    v_rcp_f16_sdwa v223, v223 dst_sel:WORD_0 dst_unused:UNUSED_PRESERVE src0_sel:WORD_0
    v_mfma_f32_16x16x32_bf16 v[204:207], v[224:227], v[12:15], 0
    ds_read_b64_tr_b16 v[224:225], v254 offset:18432
    v_lshlrev_b32_sdwa v177, 1, v177 dst_sel:DWORD dst_unused:UNUSED_PAD src0_sel:DWORD src1_sel:WORD_1
    v_or_b32 v145, v210, v211
    s_waitcnt lgkmcnt(11)
    v_mfma_f32_16x16x32_bf16 v[48:51], v[228:231], v[160:163], v[48:51]
    ds_read_b64_tr_b16 v[226:227], v254 offset:18688
    v_fma_mixlo_f16 v190, v190, s83, 0
    v_mfma_f32_16x16x32_bf16 v[56:59], v[228:231], v[164:167], v[56:59]
    ds_read_u16_d16 v176, v176
    s_waitcnt vmcnt(1)
    v_mfma_f32_16x16x16_bf16 v[112:115], v[242:243], v[244:245], v[112:115]
    v_lshlrev_b32_sdwa v178, 1, v178 dst_sel:DWORD dst_unused:UNUSED_PAD src0_sel:DWORD src1_sel:WORD_1
    v_mfma_f32_16x16x32_bf16 v[64:67], v[228:231], v[168:171], v[64:67]
    ds_read_u16_d16_hi v177, v177
    v_rcp_f16_sdwa v221, v221 dst_sel:WORD_1 dst_unused:UNUSED_PRESERVE src0_sel:WORD_1
    v_mfma_f32_16x16x32_bf16 v[72:75], v[228:231], v[172:175], v[72:75]
    ds_read_b64_tr_b16 v[228:229], v255 offset:19520
    v_mfma_f32_16x16x16_bf16 v[116:119], v[242:243], v[246:247], v[116:119]
    v_lshlrev_b32_sdwa v179, 1, v179 dst_sel:DWORD dst_unused:UNUSED_PAD src0_sel:DWORD src1_sel:WORD_1
    v_or_b32 v148, v212, v213
    s_waitcnt lgkmcnt(11)
    v_mfma_f32_16x16x32_bf16 v[192:195], v[232:235], v[16:19], v[192:195]
    ds_read_b64_tr_b16 v[230:231], v255 offset:20288
    buffer_load_dwordx4 v[244:247], v252, s[4:7], s24 offen offset:256 sc1
    v_mfma_f32_16x16x32_bf16 v[196:199], v[232:235], v[20:23], v[196:199]
    ds_read_u16_d16 v178, v178
    v_rcp_f16_sdwa v223, v223 dst_sel:WORD_1 dst_unused:UNUSED_PRESERVE src0_sel:WORD_1
    v_lshlrev_b32_sdwa v180, 1, v180 dst_sel:DWORD dst_unused:UNUSED_PAD src0_sel:DWORD src1_sel:WORD_1
    v_mfma_f32_16x16x32_bf16 v[200:203], v[232:235], v[24:27], v[200:203]
    ds_read_u16_d16_hi v179, v179
    v_fma_mixhi_f16 v190, v191, s83, 0
    v_lshlrev_b32_sdwa v181, 1, v181 dst_sel:DWORD dst_unused:UNUSED_PAD src0_sel:DWORD src1_sel:WORD_1
    v_mfma_f32_16x16x32_bf16 v[204:207], v[232:235], v[28:31], v[204:207]
    ds_read_b64_tr_b16 v[232:233], v254 offset:16392
    ds_read_b64_tr_b16 v[234:235], v254 offset:16648
    v_fma_mix_f32 v156, v220, v221, 0 op_sel_hi:[1,1,0]
    v_or_b32 v149, v214, v215
    s_waitcnt lgkmcnt(12)
    v_mfma_f32_16x16x32_bf16 v[52:55], v[236:239], v[160:163], v[52:55]
    ds_read_u16_d16 v180, v180
    v_fma_mix_f32 v157, v222, v223, 0 op_sel_hi:[1,1,0]
    v_mfma_f32_16x16x32_bf16 v[60:63], v[236:239], v[164:167], v[60:63]
    ds_read_u16_d16_hi v181, v181
    v_lshlrev_b32_sdwa v182, 1, v182 dst_sel:DWORD dst_unused:UNUSED_PAD src0_sel:DWORD src1_sel:WORD_1
    v_pk_fma_f16 v191, v190, v190, s84 neg_lo:[0,1,0] neg_hi:[0,1,0]
    v_mfma_f32_16x16x32_bf16 v[68:71], v[236:239], v[168:171], v[68:71]
    ds_read_u16_d16 v182, v182
    v_lshlrev_b32_sdwa v183, 1, v183 dst_sel:DWORD dst_unused:UNUSED_PAD src0_sel:DWORD src1_sel:WORD_1
    v_fma_mix_f32 v221, v220, v221, 0 op_sel:[1,1,0] op_sel_hi:[1,1,0]
    v_mfma_f32_16x16x32_bf16 v[76:79], v[236:239], v[172:175], v[76:79]
    ds_read_b64_tr_b16 v[236:237], v255 offset:19528
    v_or_b32 v152, v216, v217
    v_fma_mix_f32 v223, v222, v223, 0 op_sel:[1,1,0] op_sel_hi:[1,1,0]
    s_waitcnt lgkmcnt(12)
    v_mfma_f32_16x16x32_bf16 v[192:195], v[224:227], v[32:35], v[192:195]
    ds_read_b64_tr_b16 v[238:239], v255 offset:20296
    v_lshlrev_b32_sdwa v184, 1, v184 dst_sel:DWORD dst_unused:UNUSED_PAD src0_sel:DWORD src1_sel:WORD_1
    v_pk_mul_f16 v191, v191, v190
    v_mfma_f32_16x16x32_bf16 v[196:199], v[224:227], v[36:39], v[196:199]
    ds_read_u16_d16_hi v183, v183
    v_cvt_pk_bf16_f32 v156, v156, v221
    v_lshlrev_b32_sdwa v185, 1, v185 dst_sel:DWORD dst_unused:UNUSED_PAD src0_sel:DWORD src1_sel:WORD_1
    v_mfma_f32_16x16x32_bf16 v[200:203], v[224:227], v[40:43], v[200:203]
    ds_read_u16_d16 v184, v184
    v_cvt_pk_bf16_f32 v157, v157, v223
    v_or_b32 v153, v218, v219
    v_mfma_f32_16x16x32_bf16 v[204:207], v[224:227], v[44:47], v[204:207]
    ds_read_b64_tr_b16 v[224:225], v254 offset:17416
    v_exp_f16_sdwa v191, v191 dst_sel:WORD_0 dst_unused:UNUSED_PRESERVE src0_sel:WORD_0
    s_waitcnt lgkmcnt(12)
    v_mfma_f32_16x16x32_bf16 v[80:83], v[228:231], v[160:163], v[80:83]
    ds_read_b64_tr_b16 v[226:227], v254 offset:17672
    v_lshlrev_b32_sdwa v186, 1, v186 dst_sel:DWORD dst_unused:UNUSED_PAD src0_sel:DWORD src1_sel:WORD_1
    v_mfma_f32_16x16x32_bf16 v[88:91], v[228:231], v[164:167], v[88:91]
    ds_read_u16_d16_hi v185, v185
    v_lshlrev_b32_sdwa v187, 1, v187 dst_sel:DWORD dst_unused:UNUSED_PAD src0_sel:DWORD src1_sel:WORD_1
    v_exp_f16_sdwa v191, v191 dst_sel:WORD_1 dst_unused:UNUSED_PRESERVE src0_sel:WORD_1
    v_mfma_f32_16x16x32_bf16 v[96:99], v[228:231], v[168:171], v[96:99]
    ds_read_u16_d16 v186, v186
    v_lshlrev_b32_sdwa v188, 1, v188 dst_sel:DWORD dst_unused:UNUSED_PAD src0_sel:DWORD src1_sel:WORD_1
    v_mfma_f32_16x16x32_bf16 v[104:107], v[228:231], v[172:175], v[104:107]
    ds_read_b64_tr_b16 v[228:229], v255 offset:19584
    ds_read_b64_tr_b16 v[230:231], v255 offset:20352
    v_lshlrev_b32_sdwa v189, 1, v189 dst_sel:DWORD dst_unused:UNUSED_PAD src0_sel:DWORD src1_sel:WORD_1
    v_pk_fma_f16 v191, v191, s85, s85
    s_waitcnt lgkmcnt(13)
    v_mfma_f32_16x16x32_bf16 v[208:211], v[232:235], v[0:3], 0
    ds_read_u16_d16_hi v187, v187
    v_or_b32 v146, v176, v177
    v_mfma_f32_16x16x32_bf16 v[212:215], v[232:235], v[4:7], 0
    ds_read_u16_d16 v188, v188
    v_rcp_f16_sdwa v191, v191 dst_sel:WORD_0 dst_unused:UNUSED_PRESERVE src0_sel:WORD_0
    v_lshlrev_b32_sdwa v192, 1, v192 dst_sel:DWORD dst_unused:UNUSED_PAD src0_sel:DWORD src1_sel:WORD_1
    v_mfma_f32_16x16x32_bf16 v[216:219], v[232:235], v[8:11], 0
    ds_read_u16_d16_hi v189, v189
    v_fma_mixlo_f16 v204, v204, s83, 0
    v_lshlrev_b32_sdwa v193, 1, v193 dst_sel:DWORD dst_unused:UNUSED_PAD src0_sel:DWORD src1_sel:WORD_1
    v_mfma_f32_16x16x32_bf16 v[220:223], v[232:235], v[12:15], 0
    ds_read_b64_tr_b16 v[232:233], v254 offset:18440
    v_fma_mixlo_f16 v206, v206, s83, 0
    v_or_b32 v147, v178, v179
    s_waitcnt lgkmcnt(12)
    v_mfma_f32_16x16x32_bf16 v[84:87], v[236:239], v[160:163], v[84:87]
    ds_read_b64_tr_b16 v[234:235], v254 offset:18696
    v_rcp_f16_sdwa v191, v191 dst_sel:WORD_1 dst_unused:UNUSED_PRESERVE src0_sel:WORD_1
    v_mfma_f32_16x16x32_bf16 v[92:95], v[236:239], v[164:167], v[92:95]
    ds_read_u16_d16 v192, v192
    s_waitcnt vmcnt(1)
    v_mfma_f32_16x16x16_bf16 v[56:59], v[242:243], v[248:249], v[56:59]
    v_lshlrev_b32_sdwa v194, 1, v194 dst_sel:DWORD dst_unused:UNUSED_PAD src0_sel:DWORD src1_sel:WORD_1
    v_mfma_f32_16x16x32_bf16 v[100:103], v[236:239], v[168:171], v[100:103]
    ds_read_u16_d16_hi v193, v193
    v_fma_mixhi_f16 v204, v205, s83, 0
    v_mfma_f32_16x16x32_bf16 v[108:111], v[236:239], v[172:175], v[108:111]
    ds_read_b64_tr_b16 v[236:237], v255 offset:19592
    v_mfma_f32_16x16x16_bf16 v[60:63], v[242:243], v[250:251], v[60:63]
    v_lshlrev_b32_sdwa v195, 1, v195 dst_sel:DWORD dst_unused:UNUSED_PAD src0_sel:DWORD src1_sel:WORD_1
    v_fma_mixhi_f16 v206, v207, s83, 0
    s_waitcnt lgkmcnt(12)
    v_mfma_f32_16x16x32_bf16 v[208:211], v[224:227], v[16:19], v[208:211]
    ds_read_b64_tr_b16 v[238:239], v255 offset:20360
    buffer_load_dwordx4 v[248:251], v252, s[4:7], s24 offen offset:320 sc1
    v_or_b32 v150, v180, v181
    v_mfma_f32_16x16x32_bf16 v[212:215], v[224:227], v[20:23], v[212:215]
    ds_read_u16_d16 v194, v194
    v_fma_mix_f32 v159, v190, v191, 0 op_sel_hi:[1,1,0]
    v_pk_fma_f16 v205, v204, v204, s84 neg_lo:[0,1,0] neg_hi:[0,1,0]
    v_mfma_f32_16x16x32_bf16 v[216:219], v[224:227], v[24:27], v[216:219]
    ds_read_u16_d16_hi v195, v195
    v_lshlrev_b32_sdwa v196, 1, v196 dst_sel:DWORD dst_unused:UNUSED_PAD src0_sel:DWORD src1_sel:WORD_1
    v_pk_fma_f16 v207, v206, v206, s84 neg_lo:[0,1,0] neg_hi:[0,1,0]
    v_mfma_f32_16x16x32_bf16 v[220:223], v[224:227], v[28:31], v[220:223]
    s_cmp_lt_u32 s19, 12
    s_cbranch_scc1 L_rd12_slow
L_rd12_go:
    ds_read_b64_tr_b16 v[224:225], v254 offset:22528
    v_lshlrev_b32_sdwa v197, 1, v197 dst_sel:DWORD dst_unused:UNUSED_PAD src0_sel:DWORD src1_sel:WORD_1
    v_fma_mix_f32 v191, v190, v191, 0 op_sel:[1,1,0] op_sel_hi:[1,1,0]
    s_waitcnt lgkmcnt(12)
    v_mfma_f32_16x16x32_bf16 v[112:115], v[228:231], v[160:163], v[112:115]
    ds_read_b64_tr_b16 v[226:227], v254 offset:22784
    v_or_b32 v151, v182, v183
    v_pk_mul_f16 v205, v205, v204
    v_mfma_f32_16x16x32_bf16 v[120:123], v[228:231], v[164:167], v[120:123]
    ds_read_u16_d16 v196, v196
    v_pk_mul_f16 v207, v207, v206
    v_lshlrev_b32_sdwa v198, 1, v198 dst_sel:DWORD dst_unused:UNUSED_PAD src0_sel:DWORD src1_sel:WORD_1
    v_mfma_f32_16x16x32_bf16 v[128:131], v[228:231], v[168:171], v[128:131]
    ds_read_u16_d16_hi v197, v197
    v_cvt_pk_bf16_f32 v159, v159, v191
    v_lshlrev_b32_sdwa v199, 1, v199 dst_sel:DWORD dst_unused:UNUSED_PAD src0_sel:DWORD src1_sel:WORD_1
    v_mfma_f32_16x16x32_bf16 v[136:139], v[228:231], v[172:175], v[136:139]
    ds_read_b64_tr_b16 v[228:229], v255 offset:25600
    v_exp_f16_sdwa v205, v205 dst_sel:WORD_0 dst_unused:UNUSED_PRESERVE src0_sel:WORD_0
    s_waitcnt lgkmcnt(11)
    v_mfma_f32_16x16x32_bf16 v[208:211], v[232:235], v[32:35], v[208:211]
    ds_read_b64_tr_b16 v[230:231], v255 offset:26368
    v_or_b32 v154, v184, v185
    v_mfma_f32_16x16x32_bf16 v[212:215], v[232:235], v[36:39], v[212:215]
    ds_read_u16_d16 v198, v198
    v_exp_f16_sdwa v207, v207 dst_sel:WORD_0 dst_unused:UNUSED_PRESERVE src0_sel:WORD_0
    v_lshlrev_b32_sdwa v200, 1, v200 dst_sel:DWORD dst_unused:UNUSED_PAD src0_sel:DWORD src1_sel:WORD_1
    v_mfma_f32_16x16x32_bf16 v[216:219], v[232:235], v[40:43], v[216:219]
    ds_read_u16_d16_hi v199, v199
    v_lshlrev_b32_sdwa v201, 1, v201 dst_sel:DWORD dst_unused:UNUSED_PAD src0_sel:DWORD src1_sel:WORD_1
    v_mfma_f32_16x16x32_bf16 v[220:223], v[232:235], v[44:47], v[220:223]
    ds_read_b64_tr_b16 v[232:233], v254 offset:23552
    v_exp_f16_sdwa v205, v205 dst_sel:WORD_1 dst_unused:UNUSED_PRESERVE src0_sel:WORD_1
    s_waitcnt lgkmcnt(11)
    v_mfma_f32_16x16x32_bf16 v[116:119], v[236:239], v[160:163], v[116:119]
    ds_read_b64_tr_b16 v[234:235], v254 offset:23808
    v_or_b32 v155, v186, v187
    v_exp_f16_sdwa v207, v207 dst_sel:WORD_1 dst_unused:UNUSED_PRESERVE src0_sel:WORD_1
    v_mfma_f32_16x16x32_bf16 v[124:127], v[236:239], v[164:167], v[124:127]
    ds_read_u16_d16 v200, v200
    v_lshlrev_b32_sdwa v202, 1, v202 dst_sel:DWORD dst_unused:UNUSED_PAD src0_sel:DWORD src1_sel:WORD_1
    v_mfma_f32_16x16x32_bf16 v[132:135], v[236:239], v[168:171], v[132:135]
    ds_read_u16_d16_hi v201, v201
    v_lshlrev_b32_sdwa v203, 1, v203 dst_sel:DWORD dst_unused:UNUSED_PAD src0_sel:DWORD src1_sel:WORD_1
    v_pk_fma_f16 v205, v205, s85, s85
    v_mfma_f32_16x16x32_bf16 v[140:143], v[236:239], v[172:175], v[140:143]
    ds_read_b64_tr_b16 v[236:237], v255 offset:25608
    v_or_b32 v158, v188, v189
    v_pk_fma_f16 v207, v207, s85, s85
    s_waitcnt lgkmcnt(11)
    v_mfma_f32_16x16x32_bf16 v[176:179], v[224:227], v[0:3], 0
    ds_read_b64_tr_b16 v[238:239], v255 offset:26376
    v_or_b32 v160, v192, v193
    v_mfma_f32_16x16x32_bf16 v[180:183], v[224:227], v[4:7], 0
    ds_read_u16_d16 v202, v202
    v_rcp_f16_sdwa v205, v205 dst_sel:WORD_0 dst_unused:UNUSED_PRESERVE src0_sel:WORD_0
    v_lshlrev_b32_sdwa v208, 1, v208 dst_sel:DWORD dst_unused:UNUSED_PAD src0_sel:DWORD src1_sel:WORD_1
    v_mfma_f32_16x16x32_bf16 v[184:187], v[224:227], v[8:11], 0
    ds_read_u16_d16_hi v203, v203
    v_rcp_f16_sdwa v207, v207 dst_sel:WORD_0 dst_unused:UNUSED_PRESERVE src0_sel:WORD_0
    v_mfma_f32_16x16x32_bf16 v[188:191], v[224:227], v[12:15], 0
    ds_read_b64_tr_b16 v[224:225], v254 offset:24576
    v_lshlrev_b32_sdwa v209, 1, v209 dst_sel:DWORD dst_unused:UNUSED_PAD src0_sel:DWORD src1_sel:WORD_1
    s_waitcnt lgkmcnt(11)
    v_mfma_f32_16x16x32_bf16 v[48:51], v[228:231], v[144:147], v[48:51]
    ds_read_b64_tr_b16 v[226:227], v254 offset:24832
    v_or_b32 v161, v194, v195
    v_fma_mixlo_f16 v222, v222, s83, 0
    v_mfma_f32_16x16x32_bf16 v[56:59], v[228:231], v[148:151], v[56:59]
    ds_read_u16_d16 v208, v208
    v_lshlrev_b32_sdwa v210, 1, v210 dst_sel:DWORD dst_unused:UNUSED_PAD src0_sel:DWORD src1_sel:WORD_1
    v_mfma_f32_16x16x32_bf16 v[64:67], v[228:231], v[152:155], v[64:67]
    ds_read_u16_d16_hi v209, v209
    v_rcp_f16_sdwa v205, v205 dst_sel:WORD_1 dst_unused:UNUSED_PRESERVE src0_sel:WORD_1
    v_lshlrev_b32_sdwa v211, 1, v211 dst_sel:DWORD dst_unused:UNUSED_PAD src0_sel:DWORD src1_sel:WORD_1
    v_mfma_f32_16x16x32_bf16 v[72:75], v[228:231], v[156:159], v[72:75]
    ds_read_b64_tr_b16 v[228:229], v255 offset:25664
    v_or_b32 v164, v196, v197
    s_waitcnt lgkmcnt(11)
    v_mfma_f32_16x16x32_bf16 v[176:179], v[232:235], v[16:19], v[176:179]
    ds_read_b64_tr_b16 v[230:231], v255 offset:26432
    v_rcp_f16_sdwa v207, v207 dst_sel:WORD_1 dst_unused:UNUSED_PRESERVE src0_sel:WORD_1
    v_mfma_f32_16x16x32_bf16 v[180:183], v[232:235], v[20:23], v[180:183]
    ds_read_u16_d16 v210, v210
    v_lshlrev_b32_sdwa v212, 1, v212 dst_sel:DWORD dst_unused:UNUSED_PAD src0_sel:DWORD src1_sel:WORD_1
    v_fma_mixhi_f16 v222, v223, s83, 0
    v_mfma_f32_16x16x32_bf16 v[184:187], v[232:235], v[24:27], v[184:187]
    ds_read_u16_d16_hi v211, v211
    v_lshlrev_b32_sdwa v213, 1, v213 dst_sel:DWORD dst_unused:UNUSED_PAD src0_sel:DWORD src1_sel:WORD_1
    v_fma_mix_f32 v172, v204, v205, 0 op_sel_hi:[1,1,0]
    v_mfma_f32_16x16x32_bf16 v[188:191], v[232:235], v[28:31], v[188:191]
    ds_read_b64_tr_b16 v[232:233], v254 offset:22536
    ds_read_b64_tr_b16 v[234:235], v254 offset:22792
    v_or_b32 v165, v198, v199
    v_fma_mix_f32 v173, v206, v207, 0 op_sel_hi:[1,1,0]
    s_waitcnt lgkmcnt(12)
    v_mfma_f32_16x16x32_bf16 v[52:55], v[236:239], v[144:147], v[52:55]
    ds_read_u16_d16 v212, v212
    v_lshlrev_b32_sdwa v214, 1, v214 dst_sel:DWORD dst_unused:UNUSED_PAD src0_sel:DWORD src1_sel:WORD_1
    v_mfma_f32_16x16x32_bf16 v[60:63], v[236:239], v[148:151], v[60:63]
    ds_read_u16_d16_hi v213, v213
    v_pk_fma_f16 v223, v222, v222, s84 neg_lo:[0,1,0] neg_hi:[0,1,0]
    v_lshlrev_b32_sdwa v215, 1, v215 dst_sel:DWORD dst_unused:UNUSED_PAD src0_sel:DWORD src1_sel:WORD_1
    v_mfma_f32_16x16x32_bf16 v[68:71], v[236:239], v[152:155], v[68:71]
    ds_read_u16_d16 v214, v214
    v_fma_mix_f32 v205, v204, v205, 0 op_sel:[1,1,0] op_sel_hi:[1,1,0]
    v_or_b32 v168, v200, v201
    v_mfma_f32_16x16x32_bf16 v[76:79], v[236:239], v[156:159], v[76:79]
    ds_read_b64_tr_b16 v[236:237], v255 offset:25672
    v_fma_mix_f32 v207, v206, v207, 0 op_sel:[1,1,0] op_sel_hi:[1,1,0]
    v_lshlrev_b32_sdwa v216, 1, v216 dst_sel:DWORD dst_unused:UNUSED_PAD src0_sel:DWORD src1_sel:WORD_1
    s_waitcnt lgkmcnt(12)
    v_mfma_f32_16x16x32_bf16 v[176:179], v[224:227], v[32:35], v[176:179]
    ds_read_b64_tr_b16 v[238:239], v255 offset:26440
    v_pk_mul_f16 v223, v223, v222
    v_mfma_f32_16x16x32_bf16 v[180:183], v[224:227], v[36:39], v[180:183]
    ds_read_u16_d16_hi v215, v215
    v_cvt_pk_bf16_f32 v172, v172, v205
    v_lshlrev_b32_sdwa v217, 1, v217 dst_sel:DWORD dst_unused:UNUSED_PAD src0_sel:DWORD src1_sel:WORD_1
    v_mfma_f32_16x16x32_bf16 v[184:187], v[224:227], v[40:43], v[184:187]
    ds_read_u16_d16 v216, v216
    v_cvt_pk_bf16_f32 v173, v173, v207
    v_or_b32 v169, v202, v203
    v_mfma_f32_16x16x32_bf16 v[188:191], v[224:227], v[44:47], v[188:191]
    ds_read_b64_tr_b16 v[224:225], v254 offset:23560
    v_exp_f16_sdwa v223, v223 dst_sel:WORD_0 dst_unused:UNUSED_PRESERVE src0_sel:WORD_0
    s_waitcnt lgkmcnt(12)
    v_mfma_f32_16x16x32_bf16 v[80:83], v[228:231], v[144:147], v[80:83]
    ds_read_b64_tr_b16 v[226:227], v254 offset:23816
    v_lshlrev_b32_sdwa v218, 1, v218 dst_sel:DWORD dst_unused:UNUSED_PAD src0_sel:DWORD src1_sel:WORD_1
    v_lshlrev_b32_sdwa v219, 1, v219 dst_sel:DWORD dst_unused:UNUSED_PAD src0_sel:DWORD src1_sel:WORD_1
    v_mfma_f32_16x16x32_bf16 v[88:91], v[228:231], v[148:151], v[88:91]
    ds_read_u16_d16_hi v217, v217
    v_exp_f16_sdwa v223, v223 dst_sel:WORD_1 dst_unused:UNUSED_PRESERVE src0_sel:WORD_1
    v_mfma_f32_16x16x32_bf16 v[96:99], v[228:231], v[152:155], v[96:99]
    ds_read_u16_d16 v218, v218
    v_lshlrev_b32_sdwa v220, 1, v220 dst_sel:DWORD dst_unused:UNUSED_PAD src0_sel:DWORD src1_sel:WORD_1
    v_mfma_f32_16x16x32_bf16 v[104:107], v[228:231], v[156:159], v[104:107]
    ds_read_b64_tr_b16 v[228:229], v255 offset:25728
    ds_read_b64_tr_b16 v[230:231], v255 offset:26496
    v_lshlrev_b32_sdwa v221, 1, v221 dst_sel:DWORD dst_unused:UNUSED_PAD src0_sel:DWORD src1_sel:WORD_1
    v_pk_fma_f16 v223, v223, s85, s85
    s_cmp_lg_u32 s17, 0
    s_cbranch_scc1 L_pu2
L_pb2:
    s_waitcnt lgkmcnt(13)
    v_mfma_f32_16x16x32_bf16 v[192:195], v[232:235], v[0:3], 0
    ds_read_u16_d16_hi v219, v219
    v_or_b32 v162, v208, v209
    v_mfma_f32_16x16x32_bf16 v[196:199], v[232:235], v[4:7], 0
    ds_read_u16_d16 v220, v220
    v_rcp_f16_sdwa v223, v223 dst_sel:WORD_0 dst_unused:UNUSED_PRESERVE src0_sel:WORD_0
    v_lshlrev_b32_sdwa v176, 1, v176 dst_sel:DWORD dst_unused:UNUSED_PAD src0_sel:DWORD src1_sel:WORD_1
    v_mfma_f32_16x16x32_bf16 v[200:203], v[232:235], v[8:11], 0
    ds_read_u16_d16_hi v221, v221
    v_fma_mixlo_f16 v188, v188, s83, 0
    v_lshlrev_b32_sdwa v177, 1, v177 dst_sel:DWORD dst_unused:UNUSED_PAD src0_sel:DWORD src1_sel:WORD_1
    v_mfma_f32_16x16x32_bf16 v[204:207], v[232:235], v[12:15], 0
    ds_read_b64_tr_b16 v[232:233], v254 offset:24584
    v_fma_mixlo_f16 v190, v190, s83, 0
    v_or_b32 v163, v210, v211
    s_waitcnt lgkmcnt(12)
    v_mfma_f32_16x16x32_bf16 v[84:87], v[236:239], v[144:147], v[84:87]
    ds_read_b64_tr_b16 v[234:235], v254 offset:24840
    v_rcp_f16_sdwa v223, v223 dst_sel:WORD_1 dst_unused:UNUSED_PRESERVE src0_sel:WORD_1
    v_mfma_f32_16x16x32_bf16 v[92:95], v[236:239], v[148:151], v[92:95]
    ds_read_u16_d16 v176, v176
    s_waitcnt vmcnt(1)
    v_mfma_f32_16x16x16_bf16 v[88:91], v[242:243], v[244:245], v[88:91]
    v_lshlrev_b32_sdwa v178, 1, v178 dst_sel:DWORD dst_unused:UNUSED_PAD src0_sel:DWORD src1_sel:WORD_1
    v_mfma_f32_16x16x32_bf16 v[100:103], v[236:239], v[152:155], v[100:103]
    ds_read_u16_d16_hi v177, v177
    v_fma_mixhi_f16 v188, v189, s83, 0
    v_mfma_f32_16x16x32_bf16 v[108:111], v[236:239], v[156:159], v[108:111]
    ds_read_b64_tr_b16 v[236:237], v255 offset:25736
    v_lshlrev_b32_sdwa v179, 1, v179 dst_sel:DWORD dst_unused:UNUSED_PAD src0_sel:DWORD src1_sel:WORD_1
    v_fma_mixhi_f16 v190, v191, s83, 0
    s_waitcnt lgkmcnt(12)
    v_mfma_f32_16x16x32_bf16 v[192:195], v[224:227], v[16:19], v[192:195]
    ds_read_b64_tr_b16 v[238:239], v255 offset:26504
    v_mfma_f32_16x16x16_bf16 v[92:95], v[242:243], v[246:247], v[92:95]
    v_or_b32 v166, v212, v213
    v_fma_mix_f32 v175, v222, v223, 0 op_sel_hi:[1,1,0]
    v_mfma_f32_16x16x32_bf16 v[196:199], v[224:227], v[20:23], v[196:199]
    ds_read_u16_d16 v178, v178
    buffer_load_dwordx4 v[244:247], v252, s[4:7], s25 offen offset:0 sc1
    v_pk_fma_f16 v189, v188, v188, s84 neg_lo:[0,1,0] neg_hi:[0,1,0]
    v_mfma_f32_16x16x32_bf16 v[200:203], v[224:227], v[24:27], v[200:203]
    ds_read_u16_d16_hi v179, v179
    v_lshlrev_b32_sdwa v180, 1, v180 dst_sel:DWORD dst_unused:UNUSED_PAD src0_sel:DWORD src1_sel:WORD_1
    v_pk_fma_f16 v191, v190, v190, s84 neg_lo:[0,1,0] neg_hi:[0,1,0]
    v_mfma_f32_16x16x32_bf16 v[204:207], v[224:227], v[28:31], v[204:207]
    s_cmp_lt_u32 s19, 14
    s_cbranch_scc1 L_rd14_slow
L_rd14_go:
    ds_read_b64_tr_b16 v[224:225], v254 offset:28672
    v_lshlrev_b32_sdwa v181, 1, v181 dst_sel:DWORD dst_unused:UNUSED_PAD src0_sel:DWORD src1_sel:WORD_1
    v_fma_mix_f32 v223, v222, v223, 0 op_sel:[1,1,0] op_sel_hi:[1,1,0]
    s_waitcnt lgkmcnt(12)
    v_mfma_f32_16x16x32_bf16 v[112:115], v[228:231], v[144:147], v[112:115]
    ds_read_b64_tr_b16 v[226:227], v254 offset:28928
    v_or_b32 v167, v214, v215
    v_pk_mul_f16 v189, v189, v188
    v_mfma_f32_16x16x32_bf16 v[120:123], v[228:231], v[148:151], v[120:123]
    ds_read_u16_d16 v180, v180
    v_pk_mul_f16 v191, v191, v190
    v_lshlrev_b32_sdwa v182, 1, v182 dst_sel:DWORD dst_unused:UNUSED_PAD src0_sel:DWORD src1_sel:WORD_1
    v_mfma_f32_16x16x32_bf16 v[128:131], v[228:231], v[152:155], v[128:131]
    ds_read_u16_d16_hi v181, v181
    v_cvt_pk_bf16_f32 v175, v175, v223
    v_lshlrev_b32_sdwa v183, 1, v183 dst_sel:DWORD dst_unused:UNUSED_PAD src0_sel:DWORD src1_sel:WORD_1
    v_mfma_f32_16x16x32_bf16 v[136:139], v[228:231], v[156:159], v[136:139]
    ds_read_b64_tr_b16 v[228:229], v255 offset:31744
    v_exp_f16_sdwa v189, v189 dst_sel:WORD_0 dst_unused:UNUSED_PRESERVE src0_sel:WORD_0
    s_waitcnt lgkmcnt(11)
    v_mfma_f32_16x16x32_bf16 v[192:195], v[232:235], v[32:35], v[192:195]
    ds_read_b64_tr_b16 v[230:231], v255 offset:32512
    v_or_b32 v170, v216, v217
    v_mfma_f32_16x16x32_bf16 v[196:199], v[232:235], v[36:39], v[196:199]
    ds_read_u16_d16 v182, v182
    v_exp_f16_sdwa v191, v191 dst_sel:WORD_0 dst_unused:UNUSED_PRESERVE src0_sel:WORD_0
    v_lshlrev_b32_sdwa v184, 1, v184 dst_sel:DWORD dst_unused:UNUSED_PAD src0_sel:DWORD src1_sel:WORD_1
    v_mfma_f32_16x16x32_bf16 v[200:203], v[232:235], v[40:43], v[200:203]
    ds_read_u16_d16_hi v183, v183
    v_lshlrev_b32_sdwa v185, 1, v185 dst_sel:DWORD dst_unused:UNUSED_PAD src0_sel:DWORD src1_sel:WORD_1
    v_mfma_f32_16x16x32_bf16 v[204:207], v[232:235], v[44:47], v[204:207]
    ds_read_b64_tr_b16 v[232:233], v254 offset:29696
    v_exp_f16_sdwa v189, v189 dst_sel:WORD_1 dst_unused:UNUSED_PRESERVE src0_sel:WORD_1
    s_waitcnt lgkmcnt(11)
    v_mfma_f32_16x16x32_bf16 v[116:119], v[236:239], v[144:147], v[116:119]
    ds_read_b64_tr_b16 v[234:235], v254 offset:29952
    v_or_b32 v171, v218, v219
    v_exp_f16_sdwa v191, v191 dst_sel:WORD_1 dst_unused:UNUSED_PRESERVE src0_sel:WORD_1
    v_mfma_f32_16x16x32_bf16 v[124:127], v[236:239], v[148:151], v[124:127]
    ds_read_u16_d16 v184, v184
    v_lshlrev_b32_sdwa v186, 1, v186 dst_sel:DWORD dst_unused:UNUSED_PAD src0_sel:DWORD src1_sel:WORD_1
    v_mfma_f32_16x16x32_bf16 v[132:135], v[236:239], v[152:155], v[132:135]
    ds_read_u16_d16_hi v185, v185
    v_lshlrev_b32_sdwa v187, 1, v187 dst_sel:DWORD dst_unused:UNUSED_PAD src0_sel:DWORD src1_sel:WORD_1
    v_pk_fma_f16 v189, v189, s85, s85
    v_mfma_f32_16x16x32_bf16 v[140:143], v[236:239], v[156:159], v[140:143]
    ds_read_b64_tr_b16 v[236:237], v255 offset:31752
    v_or_b32 v174, v220, v221
    v_pk_fma_f16 v191, v191, s85, s85
    s_waitcnt lgkmcnt(11)
    v_mfma_f32_16x16x32_bf16 v[208:211], v[224:227], v[0:3], 0
    ds_read_b64_tr_b16 v[238:239], v255 offset:32520
    v_or_b32 v144, v176, v177
    v_mfma_f32_16x16x32_bf16 v[212:215], v[224:227], v[4:7], 0
    ds_read_u16_d16 v186, v186
    v_rcp_f16_sdwa v189, v189 dst_sel:WORD_0 dst_unused:UNUSED_PRESERVE src0_sel:WORD_0
    v_lshlrev_b32_sdwa v192, 1, v192 dst_sel:DWORD dst_unused:UNUSED_PAD src0_sel:DWORD src1_sel:WORD_1
    v_mfma_f32_16x16x32_bf16 v[216:219], v[224:227], v[8:11], 0
    ds_read_u16_d16_hi v187, v187
    v_rcp_f16_sdwa v191, v191 dst_sel:WORD_0 dst_unused:UNUSED_PRESERVE src0_sel:WORD_0
    v_mfma_f32_16x16x32_bf16 v[220:223], v[224:227], v[12:15], 0
    ds_read_b64_tr_b16 v[224:225], v254 offset:30720
    v_lshlrev_b32_sdwa v193, 1, v193 dst_sel:DWORD dst_unused:UNUSED_PAD src0_sel:DWORD src1_sel:WORD_1
    v_or_b32 v145, v178, v179
    s_waitcnt lgkmcnt(11)
    v_mfma_f32_16x16x32_bf16 v[48:51], v[228:231], v[160:163], v[48:51]
    ds_read_b64_tr_b16 v[226:227], v254 offset:30976
    v_fma_mixlo_f16 v206, v206, s83, 0
    v_mfma_f32_16x16x32_bf16 v[56:59], v[228:231], v[164:167], v[56:59]
    ds_read_u16_d16 v192, v192
    s_waitcnt vmcnt(1)
    v_mfma_f32_16x16x16_bf16 v[120:123], v[242:243], v[248:249], v[120:123]
    v_lshlrev_b32_sdwa v194, 1, v194 dst_sel:DWORD dst_unused:UNUSED_PAD src0_sel:DWORD src1_sel:WORD_1
    v_mfma_f32_16x16x32_bf16 v[64:67], v[228:231], v[168:171], v[64:67]
    ds_read_u16_d16_hi v193, v193
    v_rcp_f16_sdwa v189, v189 dst_sel:WORD_1 dst_unused:UNUSED_PRESERVE src0_sel:WORD_1
    v_mfma_f32_16x16x32_bf16 v[72:75], v[228:231], v[172:175], v[72:75]
    ds_read_b64_tr_b16 v[228:229], v255 offset:31808
    v_mfma_f32_16x16x16_bf16 v[124:127], v[242:243], v[250:251], v[124:127]
    v_lshlrev_b32_sdwa v195, 1, v195 dst_sel:DWORD dst_unused:UNUSED_PAD src0_sel:DWORD src1_sel:WORD_1
    v_or_b32 v148, v180, v181
    s_waitcnt lgkmcnt(11)
    v_mfma_f32_16x16x32_bf16 v[208:211], v[232:235], v[16:19], v[208:211]
    ds_read_b64_tr_b16 v[230:231], v255 offset:32576
    buffer_load_dwordx4 v[248:251], v252, s[4:7], s25 offen offset:64 sc1
    v_mfma_f32_16x16x32_bf16 v[212:215], v[232:235], v[20:23], v[212:215]
    ds_read_u16_d16 v194, v194
    v_rcp_f16_sdwa v191, v191 dst_sel:WORD_1 dst_unused:UNUSED_PRESERVE src0_sel:WORD_1
    v_lshlrev_b32_sdwa v196, 1, v196 dst_sel:DWORD dst_unused:UNUSED_PAD src0_sel:DWORD src1_sel:WORD_1
    v_mfma_f32_16x16x32_bf16 v[216:219], v[232:235], v[24:27], v[216:219]
    ds_read_u16_d16_hi v195, v195
    v_fma_mixhi_f16 v206, v207, s83, 0
    v_lshlrev_b32_sdwa v197, 1, v197 dst_sel:DWORD dst_unused:UNUSED_PAD src0_sel:DWORD src1_sel:WORD_1
    v_mfma_f32_16x16x32_bf16 v[220:223], v[232:235], v[28:31], v[220:223]
    ds_read_b64_tr_b16 v[232:233], v254 offset:28680
    ds_read_b64_tr_b16 v[234:235], v254 offset:28936
    v_fma_mix_f32 v156, v188, v189, 0 op_sel_hi:[1,1,0]
    v_or_b32 v149, v182, v183
    s_waitcnt lgkmcnt(12)
    v_mfma_f32_16x16x32_bf16 v[52:55], v[236:239], v[160:163], v[52:55]
    ds_read_u16_d16 v196, v196
    v_fma_mix_f32 v157, v190, v191, 0 op_sel_hi:[1,1,0]
    v_mfma_f32_16x16x32_bf16 v[60:63], v[236:239], v[164:167], v[60:63]
    ds_read_u16_d16_hi v197, v197
    v_lshlrev_b32_sdwa v198, 1, v198 dst_sel:DWORD dst_unused:UNUSED_PAD src0_sel:DWORD src1_sel:WORD_1
    v_pk_fma_f16 v207, v206, v206, s84 neg_lo:[0,1,0] neg_hi:[0,1,0]
    v_mfma_f32_16x16x32_bf16 v[68:71], v[236:239], v[168:171], v[68:71]
    ds_read_u16_d16 v198, v198
    v_lshlrev_b32_sdwa v199, 1, v199 dst_sel:DWORD dst_unused:UNUSED_PAD src0_sel:DWORD src1_sel:WORD_1
    v_fma_mix_f32 v189, v188, v189, 0 op_sel:[1,1,0] op_sel_hi:[1,1,0]
    v_mfma_f32_16x16x32_bf16 v[76:79], v[236:239], v[172:175], v[76:79]
    ds_read_b64_tr_b16 v[236:237], v255 offset:31816
    v_or_b32 v152, v184, v185
    v_fma_mix_f32 v191, v190, v191, 0 op_sel:[1,1,0] op_sel_hi:[1,1,0]
    s_waitcnt lgkmcnt(12)
    v_mfma_f32_16x16x32_bf16 v[208:211], v[224:227], v[32:35], v[208:211]
    ds_read_b64_tr_b16 v[238:239], v255 offset:32584
    v_lshlrev_b32_sdwa v200, 1, v200 dst_sel:DWORD dst_unused:UNUSED_PAD src0_sel:DWORD src1_sel:WORD_1
    v_pk_mul_f16 v207, v207, v206
    v_mfma_f32_16x16x32_bf16 v[212:215], v[224:227], v[36:39], v[212:215]
    ds_read_u16_d16_hi v199, v199
    v_cvt_pk_bf16_f32 v156, v156, v189
    v_lshlrev_b32_sdwa v201, 1, v201 dst_sel:DWORD dst_unused:UNUSED_PAD src0_sel:DWORD src1_sel:WORD_1
    v_mfma_f32_16x16x32_bf16 v[216:219], v[224:227], v[40:43], v[216:219]
    ds_read_u16_d16 v200, v200
    v_cvt_pk_bf16_f32 v157, v157, v191
    v_or_b32 v153, v186, v187
    v_mfma_f32_16x16x32_bf16 v[220:223], v[224:227], v[44:47], v[220:223]
    ds_read_b64_tr_b16 v[224:225], v254 offset:29704
    v_exp_f16_sdwa v207, v207 dst_sel:WORD_0 dst_unused:UNUSED_PRESERVE src0_sel:WORD_0
    s_waitcnt lgkmcnt(12)
    v_mfma_f32_16x16x32_bf16 v[80:83], v[228:231], v[160:163], v[80:83]
    ds_read_b64_tr_b16 v[226:227], v254 offset:29960
    v_lshlrev_b32_sdwa v202, 1, v202 dst_sel:DWORD dst_unused:UNUSED_PAD src0_sel:DWORD src1_sel:WORD_1
    v_mfma_f32_16x16x32_bf16 v[88:91], v[228:231], v[164:167], v[88:91]
    ds_read_u16_d16_hi v201, v201
    v_lshlrev_b32_sdwa v203, 1, v203 dst_sel:DWORD dst_unused:UNUSED_PAD src0_sel:DWORD src1_sel:WORD_1
    v_exp_f16_sdwa v207, v207 dst_sel:WORD_1 dst_unused:UNUSED_PRESERVE src0_sel:WORD_1
    v_mfma_f32_16x16x32_bf16 v[96:99], v[228:231], v[168:171], v[96:99]
    ds_read_u16_d16 v202, v202
    v_lshlrev_b32_sdwa v204, 1, v204 dst_sel:DWORD dst_unused:UNUSED_PAD src0_sel:DWORD src1_sel:WORD_1
    v_mfma_f32_16x16x32_bf16 v[104:107], v[228:231], v[172:175], v[104:107]
    ds_read_b64_tr_b16 v[228:229], v255 offset:31872
    ds_read_b64_tr_b16 v[230:231], v255 offset:32640
    v_lshlrev_b32_sdwa v205, 1, v205 dst_sel:DWORD dst_unused:UNUSED_PAD src0_sel:DWORD src1_sel:WORD_1
    v_pk_fma_f16 v207, v207, s85, s85
    s_waitcnt lgkmcnt(13)
    v_mfma_f32_16x16x32_bf16 v[176:179], v[232:235], v[0:3], 0
    ds_read_u16_d16_hi v203, v203
    v_or_b32 v146, v192, v193
    v_mfma_f32_16x16x32_bf16 v[180:183], v[232:235], v[4:7], 0
    ds_read_u16_d16 v204, v204
    v_rcp_f16_sdwa v207, v207 dst_sel:WORD_0 dst_unused:UNUSED_PRESERVE src0_sel:WORD_0
    v_lshlrev_b32_sdwa v208, 1, v208 dst_sel:DWORD dst_unused:UNUSED_PAD src0_sel:DWORD src1_sel:WORD_1
    v_mfma_f32_16x16x32_bf16 v[184:187], v[232:235], v[8:11], 0
    ds_read_u16_d16_hi v205, v205
    v_fma_mixlo_f16 v220, v220, s83, 0
    v_lshlrev_b32_sdwa v209, 1, v209 dst_sel:DWORD dst_unused:UNUSED_PAD src0_sel:DWORD src1_sel:WORD_1
    v_mfma_f32_16x16x32_bf16 v[188:191], v[232:235], v[12:15], 0
    ds_read_b64_tr_b16 v[232:233], v254 offset:30728
    v_fma_mixlo_f16 v222, v222, s83, 0
    s_waitcnt lgkmcnt(12)
    v_mfma_f32_16x16x32_bf16 v[84:87], v[236:239], v[160:163], v[84:87]
    ds_read_b64_tr_b16 v[234:235], v254 offset:30984
    v_or_b32 v147, v194, v195
    v_rcp_f16_sdwa v207, v207 dst_sel:WORD_1 dst_unused:UNUSED_PRESERVE src0_sel:WORD_1
    v_mfma_f32_16x16x32_bf16 v[92:95], v[236:239], v[164:167], v[92:95]
    ds_read_u16_d16 v208, v208
    v_lshlrev_b32_sdwa v210, 1, v210 dst_sel:DWORD dst_unused:UNUSED_PAD src0_sel:DWORD src1_sel:WORD_1
    v_mfma_f32_16x16x32_bf16 v[100:103], v[236:239], v[168:171], v[100:103]
    ds_read_u16_d16_hi v209, v209
    v_fma_mixhi_f16 v220, v221, s83, 0
    v_lshlrev_b32_sdwa v211, 1, v211 dst_sel:DWORD dst_unused:UNUSED_PAD src0_sel:DWORD src1_sel:WORD_1
    v_mfma_f32_16x16x32_bf16 v[108:111], v[236:239], v[172:175], v[108:111]
    ds_read_b64_tr_b16 v[236:237], v255 offset:31880
    v_fma_mixhi_f16 v222, v223, s83, 0
    v_or_b32 v150, v196, v197
    s_waitcnt lgkmcnt(12)
    v_mfma_f32_16x16x32_bf16 v[176:179], v[224:227], v[16:19], v[176:179]
    ds_read_b64_tr_b16 v[238:239], v255 offset:32648
    v_fma_mix_f32 v159, v206, v207, 0 op_sel_hi:[1,1,0]
    v_pk_fma_f16 v221, v220, v220, s84 neg_lo:[0,1,0] neg_hi:[0,1,0]
    v_mfma_f32_16x16x32_bf16 v[180:183], v[224:227], v[20:23], v[180:183]
    ds_read_u16_d16 v210, v210
    v_lshlrev_b32_sdwa v212, 1, v212 dst_sel:DWORD dst_unused:UNUSED_PAD src0_sel:DWORD src1_sel:WORD_1
    v_mfma_f32_16x16x32_bf16 v[184:187], v[224:227], v[24:27], v[184:187]
    ds_read_u16_d16_hi v211, v211
    v_pk_fma_f16 v223, v222, v222, s84 neg_lo:[0,1,0] neg_hi:[0,1,0]
    v_lshlrev_b32_sdwa v213, 1, v213 dst_sel:DWORD dst_unused:UNUSED_PAD src0_sel:DWORD src1_sel:WORD_1
    v_mfma_f32_16x16x32_bf16 v[188:191], v[224:227], v[28:31], v[188:191]
    s_cmp_lt_u32 s19, 16
    s_cbranch_scc1 L_rd16_slow
L_rd16_go:
    ds_read_b64_tr_b16 v[224:225], v254 offset:34816
    v_fma_mix_f32 v207, v206, v207, 0 op_sel:[1,1,0] op_sel_hi:[1,1,0]
    v_or_b32 v151, v198, v199
    s_waitcnt lgkmcnt(12)
    v_mfma_f32_16x16x32_bf16 v[112:115], v[228:231], v[160:163], v[112:115]
    ds_read_b64_tr_b16 v[226:227], v254 offset:35072
    v_pk_mul_f16 v221, v221, v220
    v_pk_mul_f16 v223, v223, v222
    v_mfma_f32_16x16x32_bf16 v[120:123], v[228:231], v[164:167], v[120:123]
    ds_read_u16_d16 v212, v212
    v_lshlrev_b32_sdwa v214, 1, v214 dst_sel:DWORD dst_unused:UNUSED_PAD src0_sel:DWORD src1_sel:WORD_1
    v_cvt_pk_bf16_f32 v159, v159, v207
    v_mfma_f32_16x16x32_bf16 v[128:131], v[228:231], v[168:171], v[128:131]
    ds_read_u16_d16_hi v213, v213
    v_lshlrev_b32_sdwa v215, 1, v215 dst_sel:DWORD dst_unused:UNUSED_PAD src0_sel:DWORD src1_sel:WORD_1
    v_mfma_f32_16x16x32_bf16 v[136:139], v[228:231], v[172:175], v[136:139]
    ds_read_b64_tr_b16 v[228:229], v255 offset:37888
    v_exp_f16_sdwa v221, v221 dst_sel:WORD_0 dst_unused:UNUSED_PRESERVE src0_sel:WORD_0
    s_waitcnt lgkmcnt(11)
    v_mfma_f32_16x16x32_bf16 v[176:179], v[232:235], v[32:35], v[176:179]
    ds_read_b64_tr_b16 v[230:231], v255 offset:38656
    v_or_b32 v154, v200, v201
    v_exp_f16_sdwa v223, v223 dst_sel:WORD_0 dst_unused:UNUSED_PRESERVE src0_sel:WORD_0
    v_mfma_f32_16x16x32_bf16 v[180:183], v[232:235], v[36:39], v[180:183]
    ds_read_u16_d16 v214, v214
    v_lshlrev_b32_sdwa v216, 1, v216 dst_sel:DWORD dst_unused:UNUSED_PAD src0_sel:DWORD src1_sel:WORD_1
    v_mfma_f32_16x16x32_bf16 v[184:187], v[232:235], v[40:43], v[184:187]
    ds_read_u16_d16_hi v215, v215
    v_lshlrev_b32_sdwa v217, 1, v217 dst_sel:DWORD dst_unused:UNUSED_PAD src0_sel:DWORD src1_sel:WORD_1
    v_mfma_f32_16x16x32_bf16 v[188:191], v[232:235], v[44:47], v[188:191]
    ds_read_b64_tr_b16 v[232:233], v254 offset:35840
    v_exp_f16_sdwa v221, v221 dst_sel:WORD_1 dst_unused:UNUSED_PRESERVE src0_sel:WORD_1
    v_or_b32 v155, v202, v203
    s_waitcnt lgkmcnt(11)
    v_mfma_f32_16x16x32_bf16 v[116:119], v[236:239], v[160:163], v[116:119]
    ds_read_b64_tr_b16 v[234:235], v254 offset:36096
    v_exp_f16_sdwa v223, v223 dst_sel:WORD_1 dst_unused:UNUSED_PRESERVE src0_sel:WORD_1
    v_mfma_f32_16x16x32_bf16 v[124:127], v[236:239], v[164:167], v[124:127]
    ds_read_u16_d16 v216, v216
    v_lshlrev_b32_sdwa v218, 1, v218 dst_sel:DWORD dst_unused:UNUSED_PAD src0_sel:DWORD src1_sel:WORD_1
    v_mfma_f32_16x16x32_bf16 v[132:135], v[236:239], v[168:171], v[132:135]
    ds_read_u16_d16_hi v217, v217
    v_lshlrev_b32_sdwa v219, 1, v219 dst_sel:DWORD dst_unused:UNUSED_PAD src0_sel:DWORD src1_sel:WORD_1
    v_pk_fma_f16 v221, v221, s85, s85
    v_mfma_f32_16x16x32_bf16 v[140:143], v[236:239], v[172:175], v[140:143]
    ds_read_b64_tr_b16 v[236:237], v255 offset:37896
    v_or_b32 v158, v204, v205
    v_pk_fma_f16 v223, v223, s85, s85
    s_waitcnt lgkmcnt(11)
    v_mfma_f32_16x16x32_bf16 v[192:195], v[224:227], v[0:3], 0
    ds_read_b64_tr_b16 v[238:239], v255 offset:38664
    v_or_b32 v160, v208, v209
    v_mfma_f32_16x16x32_bf16 v[196:199], v[224:227], v[4:7], 0
    ds_read_u16_d16 v218, v218
    v_rcp_f16_sdwa v221, v221 dst_sel:WORD_0 dst_unused:UNUSED_PRESERVE src0_sel:WORD_0
    v_lshlrev_b32_sdwa v176, 1, v176 dst_sel:DWORD dst_unused:UNUSED_PAD src0_sel:DWORD src1_sel:WORD_1
    v_mfma_f32_16x16x32_bf16 v[200:203], v[224:227], v[8:11], 0
    ds_read_u16_d16_hi v219, v219
    v_rcp_f16_sdwa v223, v223 dst_sel:WORD_0 dst_unused:UNUSED_PRESERVE src0_sel:WORD_0
    v_mfma_f32_16x16x32_bf16 v[204:207], v[224:227], v[12:15], 0
    ds_read_b64_tr_b16 v[224:225], v254 offset:36864
    v_lshlrev_b32_sdwa v177, 1, v177 dst_sel:DWORD dst_unused:UNUSED_PAD src0_sel:DWORD src1_sel:WORD_1
    v_or_b32 v161, v210, v211
    s_waitcnt lgkmcnt(11)
    v_mfma_f32_16x16x32_bf16 v[48:51], v[228:231], v[144:147], v[48:51]
    ds_read_b64_tr_b16 v[226:227], v254 offset:37120
    v_fma_mixlo_f16 v190, v190, s83, 0
    v_mfma_f32_16x16x32_bf16 v[56:59], v[228:231], v[148:151], v[56:59]
    ds_read_u16_d16 v176, v176
    s_waitcnt vmcnt(1)
    v_mfma_f32_16x16x16_bf16 v[68:71], v[242:243], v[246:247], v[68:71]
    v_lshlrev_b32_sdwa v178, 1, v178 dst_sel:DWORD dst_unused:UNUSED_PAD src0_sel:DWORD src1_sel:WORD_1
    v_mfma_f32_16x16x32_bf16 v[64:67], v[228:231], v[152:155], v[64:67]
    ds_read_u16_d16_hi v177, v177
    v_rcp_f16_sdwa v221, v221 dst_sel:WORD_1 dst_unused:UNUSED_PRESERVE src0_sel:WORD_1
    v_mfma_f32_16x16x32_bf16 v[72:75], v[228:231], v[156:159], v[72:75]
    ds_read_b64_tr_b16 v[228:229], v255 offset:37952
    v_lshlrev_b32_sdwa v179, 1, v179 dst_sel:DWORD dst_unused:UNUSED_PAD src0_sel:DWORD src1_sel:WORD_1
    v_or_b32 v164, v212, v213
    s_waitcnt lgkmcnt(11)
    v_mfma_f32_16x16x32_bf16 v[192:195], v[232:235], v[16:19], v[192:195]
    ds_read_b64_tr_b16 v[230:231], v255 offset:38720
    v_rcp_f16_sdwa v223, v223 dst_sel:WORD_1 dst_unused:UNUSED_PRESERVE src0_sel:WORD_1
    v_mfma_f32_16x16x32_bf16 v[196:199], v[232:235], v[20:23], v[196:199]
    ds_read_u16_d16 v178, v178
    v_mfma_f32_16x16x16_bf16 v[64:67], v[242:243], v[244:245], v[64:67]
    v_lshlrev_b32_sdwa v180, 1, v180 dst_sel:DWORD dst_unused:UNUSED_PAD src0_sel:DWORD src1_sel:WORD_1
    v_fma_mixhi_f16 v190, v191, s83, 0
    v_mfma_f32_16x16x32_bf16 v[200:203], v[232:235], v[24:27], v[200:203]
    ds_read_u16_d16_hi v179, v179
    buffer_load_dwordx4 v[244:247], v252, s[4:7], s25 offen offset:128 sc1
    v_lshlrev_b32_sdwa v181, 1, v181 dst_sel:DWORD dst_unused:UNUSED_PAD src0_sel:DWORD src1_sel:WORD_1
    v_mfma_f32_16x16x32_bf16 v[204:207], v[232:235], v[28:31], v[204:207]
    ds_read_b64_tr_b16 v[232:233], v254 offset:34824
    ds_read_b64_tr_b16 v[234:235], v254 offset:35080
    v_fma_mix_f32 v172, v220, v221, 0 op_sel_hi:[1,1,0]
    v_or_b32 v165, v214, v215
    s_waitcnt lgkmcnt(12)
    v_mfma_f32_16x16x32_bf16 v[52:55], v[236:239], v[144:147], v[52:55]
    ds_read_u16_d16 v180, v180
    v_fma_mix_f32 v173, v222, v223, 0 op_sel_hi:[1,1,0]
    v_mfma_f32_16x16x32_bf16 v[60:63], v[236:239], v[148:151], v[60:63]
    ds_read_u16_d16_hi v181, v181
    v_lshlrev_b32_sdwa v182, 1, v182 dst_sel:DWORD dst_unused:UNUSED_PAD src0_sel:DWORD src1_sel:WORD_1
    v_pk_fma_f16 v191, v190, v190, s84 neg_lo:[0,1,0] neg_hi:[0,1,0]
    v_mfma_f32_16x16x32_bf16 v[68:71], v[236:239], v[152:155], v[68:71]
    ds_read_u16_d16 v182, v182
    v_lshlrev_b32_sdwa v183, 1, v183 dst_sel:DWORD dst_unused:UNUSED_PAD src0_sel:DWORD src1_sel:WORD_1
    v_fma_mix_f32 v221, v220, v221, 0 op_sel:[1,1,0] op_sel_hi:[1,1,0]
    v_mfma_f32_16x16x32_bf16 v[76:79], v[236:239], v[156:159], v[76:79]
    ds_read_b64_tr_b16 v[236:237], v255 offset:37960
    v_or_b32 v168, v216, v217
    v_fma_mix_f32 v223, v222, v223, 0 op_sel:[1,1,0] op_sel_hi:[1,1,0]
    s_waitcnt lgkmcnt(12)
    v_mfma_f32_16x16x32_bf16 v[192:195], v[224:227], v[32:35], v[192:195]
    ds_read_b64_tr_b16 v[238:239], v255 offset:38728
    v_lshlrev_b32_sdwa v184, 1, v184 dst_sel:DWORD dst_unused:UNUSED_PAD src0_sel:DWORD src1_sel:WORD_1
    v_pk_mul_f16 v191, v191, v190
    v_mfma_f32_16x16x32_bf16 v[196:199], v[224:227], v[36:39], v[196:199]
    ds_read_u16_d16_hi v183, v183
    v_cvt_pk_bf16_f32 v172, v172, v221
    v_lshlrev_b32_sdwa v185, 1, v185 dst_sel:DWORD dst_unused:UNUSED_PAD src0_sel:DWORD src1_sel:WORD_1
    v_mfma_f32_16x16x32_bf16 v[200:203], v[224:227], v[40:43], v[200:203]
    ds_read_u16_d16 v184, v184
    v_cvt_pk_bf16_f32 v173, v173, v223
    v_or_b32 v169, v218, v219
    v_mfma_f32_16x16x32_bf16 v[204:207], v[224:227], v[44:47], v[204:207]
    ds_read_b64_tr_b16 v[224:225], v254 offset:35848
    v_exp_f16_sdwa v191, v191 dst_sel:WORD_0 dst_unused:UNUSED_PRESERVE src0_sel:WORD_0
    s_waitcnt lgkmcnt(12)
    v_mfma_f32_16x16x32_bf16 v[80:83], v[228:231], v[144:147], v[80:83]
    ds_read_b64_tr_b16 v[226:227], v254 offset:36104
    v_lshlrev_b32_sdwa v186, 1, v186 dst_sel:DWORD dst_unused:UNUSED_PAD src0_sel:DWORD src1_sel:WORD_1
    v_mfma_f32_16x16x32_bf16 v[88:91], v[228:231], v[148:151], v[88:91]
    ds_read_u16_d16_hi v185, v185
    v_lshlrev_b32_sdwa v187, 1, v187 dst_sel:DWORD dst_unused:UNUSED_PAD src0_sel:DWORD src1_sel:WORD_1
    v_exp_f16_sdwa v191, v191 dst_sel:WORD_1 dst_unused:UNUSED_PRESERVE src0_sel:WORD_1
    v_mfma_f32_16x16x32_bf16 v[96:99], v[228:231], v[152:155], v[96:99]
    ds_read_u16_d16 v186, v186
    v_lshlrev_b32_sdwa v188, 1, v188 dst_sel:DWORD dst_unused:UNUSED_PAD src0_sel:DWORD src1_sel:WORD_1
    v_mfma_f32_16x16x32_bf16 v[104:107], v[228:231], v[156:159], v[104:107]
    ds_read_b64_tr_b16 v[228:229], v255 offset:38016
    ds_read_b64_tr_b16 v[230:231], v255 offset:38784
    v_lshlrev_b32_sdwa v189, 1, v189 dst_sel:DWORD dst_unused:UNUSED_PAD src0_sel:DWORD src1_sel:WORD_1
    v_pk_fma_f16 v191, v191, s85, s85
    s_waitcnt lgkmcnt(13)
    v_mfma_f32_16x16x32_bf16 v[208:211], v[232:235], v[0:3], 0
    ds_read_u16_d16_hi v187, v187
    v_or_b32 v162, v176, v177
    v_mfma_f32_16x16x32_bf16 v[212:215], v[232:235], v[4:7], 0
    ds_read_u16_d16 v188, v188
    v_rcp_f16_sdwa v191, v191 dst_sel:WORD_0 dst_unused:UNUSED_PRESERVE src0_sel:WORD_0
    v_lshlrev_b32_sdwa v192, 1, v192 dst_sel:DWORD dst_unused:UNUSED_PAD src0_sel:DWORD src1_sel:WORD_1
    v_mfma_f32_16x16x32_bf16 v[216:219], v[232:235], v[8:11], 0
    ds_read_u16_d16_hi v189, v189
    v_fma_mixlo_f16 v204, v204, s83, 0
    v_lshlrev_b32_sdwa v193, 1, v193 dst_sel:DWORD dst_unused:UNUSED_PAD src0_sel:DWORD src1_sel:WORD_1
    v_mfma_f32_16x16x32_bf16 v[220:223], v[232:235], v[12:15], 0
    ds_read_b64_tr_b16 v[232:233], v254 offset:36872
    v_fma_mixlo_f16 v206, v206, s83, 0
    v_or_b32 v163, v178, v179
    s_waitcnt lgkmcnt(12)
    v_mfma_f32_16x16x32_bf16 v[84:87], v[236:239], v[144:147], v[84:87]
    ds_read_b64_tr_b16 v[234:235], v254 offset:37128
    v_rcp_f16_sdwa v191, v191 dst_sel:WORD_1 dst_unused:UNUSED_PRESERVE src0_sel:WORD_1
    v_mfma_f32_16x16x32_bf16 v[92:95], v[236:239], v[148:151], v[92:95]
    ds_read_u16_d16 v192, v192
    s_waitcnt vmcnt(1)
    v_mfma_f32_16x16x16_bf16 v[96:99], v[242:243], v[248:249], v[96:99]
    v_lshlrev_b32_sdwa v194, 1, v194 dst_sel:DWORD dst_unused:UNUSED_PAD src0_sel:DWORD src1_sel:WORD_1
    v_mfma_f32_16x16x32_bf16 v[100:103], v[236:239], v[152:155], v[100:103]
    ds_read_u16_d16_hi v193, v193
    v_fma_mixhi_f16 v204, v205, s83, 0
    v_mfma_f32_16x16x32_bf16 v[108:111], v[236:239], v[156:159], v[108:111]
    ds_read_b64_tr_b16 v[236:237], v255 offset:38024
    v_lshlrev_b32_sdwa v195, 1, v195 dst_sel:DWORD dst_unused:UNUSED_PAD src0_sel:DWORD src1_sel:WORD_1
    v_fma_mixhi_f16 v206, v207, s83, 0
    s_waitcnt lgkmcnt(12)
    v_mfma_f32_16x16x32_bf16 v[208:211], v[224:227], v[16:19], v[208:211]
    ds_read_b64_tr_b16 v[238:239], v255 offset:38792
    v_or_b32 v166, v180, v181
    v_fma_mix_f32 v175, v190, v191, 0 op_sel_hi:[1,1,0]
    v_mfma_f32_16x16x32_bf16 v[212:215], v[224:227], v[20:23], v[212:215]
    ds_read_u16_d16 v194, v194
    v_mfma_f32_16x16x16_bf16 v[100:103], v[242:243], v[250:251], v[100:103]
    v_pk_fma_f16 v205, v204, v204, s84 neg_lo:[0,1,0] neg_hi:[0,1,0]
    v_lshlrev_b32_sdwa v196, 1, v196 dst_sel:DWORD dst_unused:UNUSED_PAD src0_sel:DWORD src1_sel:WORD_1
    v_mfma_f32_16x16x32_bf16 v[216:219], v[224:227], v[24:27], v[216:219]
    ds_read_u16_d16_hi v195, v195
    buffer_load_dwordx4 v[248:251], v252, s[4:7], s25 offen offset:192 sc1
    v_pk_fma_f16 v207, v206, v206, s84 neg_lo:[0,1,0] neg_hi:[0,1,0]
    v_mfma_f32_16x16x32_bf16 v[220:223], v[224:227], v[28:31], v[220:223]
    s_cmp_lt_u32 s19, 18
    s_cbranch_scc1 L_rd18_slow
L_rd18_go:
    ds_read_b64_tr_b16 v[224:225], v254 offset:40960
    v_lshlrev_b32_sdwa v197, 1, v197 dst_sel:DWORD dst_unused:UNUSED_PAD src0_sel:DWORD src1_sel:WORD_1
    v_fma_mix_f32 v191, v190, v191, 0 op_sel:[1,1,0] op_sel_hi:[1,1,0]
    s_waitcnt lgkmcnt(12)
    v_mfma_f32_16x16x32_bf16 v[112:115], v[228:231], v[144:147], v[112:115]
    ds_read_b64_tr_b16 v[226:227], v254 offset:41216
    v_or_b32 v167, v182, v183
    v_pk_mul_f16 v205, v205, v204
    v_mfma_f32_16x16x32_bf16 v[120:123], v[228:231], v[148:151], v[120:123]
    ds_read_u16_d16 v196, v196
    v_pk_mul_f16 v207, v207, v206
    v_lshlrev_b32_sdwa v198, 1, v198 dst_sel:DWORD dst_unused:UNUSED_PAD src0_sel:DWORD src1_sel:WORD_1
    v_mfma_f32_16x16x32_bf16 v[128:131], v[228:231], v[152:155], v[128:131]
    ds_read_u16_d16_hi v197, v197
    v_cvt_pk_bf16_f32 v175, v175, v191
    v_lshlrev_b32_sdwa v199, 1, v199 dst_sel:DWORD dst_unused:UNUSED_PAD src0_sel:DWORD src1_sel:WORD_1
    v_mfma_f32_16x16x32_bf16 v[136:139], v[228:231], v[156:159], v[136:139]
    ds_read_b64_tr_b16 v[228:229], v255 offset:44032
    v_exp_f16_sdwa v205, v205 dst_sel:WORD_0 dst_unused:UNUSED_PRESERVE src0_sel:WORD_0
    s_waitcnt lgkmcnt(11)
    v_mfma_f32_16x16x32_bf16 v[208:211], v[232:235], v[32:35], v[208:211]
    ds_read_b64_tr_b16 v[230:231], v255 offset:44800
    v_or_b32 v170, v184, v185
    v_mfma_f32_16x16x32_bf16 v[212:215], v[232:235], v[36:39], v[212:215]
    ds_read_u16_d16 v198, v198
    v_exp_f16_sdwa v207, v207 dst_sel:WORD_0 dst_unused:UNUSED_PRESERVE src0_sel:WORD_0
    v_lshlrev_b32_sdwa v200, 1, v200 dst_sel:DWORD dst_unused:UNUSED_PAD src0_sel:DWORD src1_sel:WORD_1
    v_mfma_f32_16x16x32_bf16 v[216:219], v[232:235], v[40:43], v[216:219]
    ds_read_u16_d16_hi v199, v199
    v_lshlrev_b32_sdwa v201, 1, v201 dst_sel:DWORD dst_unused:UNUSED_PAD src0_sel:DWORD src1_sel:WORD_1
    v_mfma_f32_16x16x32_bf16 v[220:223], v[232:235], v[44:47], v[220:223]
    ds_read_b64_tr_b16 v[232:233], v254 offset:41984
    v_exp_f16_sdwa v205, v205 dst_sel:WORD_1 dst_unused:UNUSED_PRESERVE src0_sel:WORD_1
    s_waitcnt lgkmcnt(11)
    v_mfma_f32_16x16x32_bf16 v[116:119], v[236:239], v[144:147], v[116:119]
    ds_read_b64_tr_b16 v[234:235], v254 offset:42240
    v_or_b32 v171, v186, v187
    v_exp_f16_sdwa v207, v207 dst_sel:WORD_1 dst_unused:UNUSED_PRESERVE src0_sel:WORD_1
    v_mfma_f32_16x16x32_bf16 v[124:127], v[236:239], v[148:151], v[124:127]
    ds_read_u16_d16 v200, v200
    v_lshlrev_b32_sdwa v202, 1, v202 dst_sel:DWORD dst_unused:UNUSED_PAD src0_sel:DWORD src1_sel:WORD_1
    v_mfma_f32_16x16x32_bf16 v[132:135], v[236:239], v[152:155], v[132:135]
    ds_read_u16_d16_hi v201, v201
    v_lshlrev_b32_sdwa v203, 1, v203 dst_sel:DWORD dst_unused:UNUSED_PAD src0_sel:DWORD src1_sel:WORD_1
    v_pk_fma_f16 v205, v205, s85, s85
    v_mfma_f32_16x16x32_bf16 v[140:143], v[236:239], v[156:159], v[140:143]
    ds_read_b64_tr_b16 v[236:237], v255 offset:44040
    v_or_b32 v174, v188, v189
    v_pk_fma_f16 v207, v207, s85, s85
    s_waitcnt lgkmcnt(11)
    v_mfma_f32_16x16x32_bf16 v[176:179], v[224:227], v[0:3], 0
    ds_read_b64_tr_b16 v[238:239], v255 offset:44808
    v_or_b32 v144, v192, v193
    v_mfma_f32_16x16x32_bf16 v[180:183], v[224:227], v[4:7], 0
    ds_read_u16_d16 v202, v202
    v_rcp_f16_sdwa v205, v205 dst_sel:WORD_0 dst_unused:UNUSED_PRESERVE src0_sel:WORD_0
    v_lshlrev_b32_sdwa v208, 1, v208 dst_sel:DWORD dst_unused:UNUSED_PAD src0_sel:DWORD src1_sel:WORD_1
    v_mfma_f32_16x16x32_bf16 v[184:187], v[224:227], v[8:11], 0
    ds_read_u16_d16_hi v203, v203
    v_rcp_f16_sdwa v207, v207 dst_sel:WORD_0 dst_unused:UNUSED_PRESERVE src0_sel:WORD_0
    v_mfma_f32_16x16x32_bf16 v[188:191], v[224:227], v[12:15], 0
    ds_read_b64_tr_b16 v[224:225], v254 offset:43008
    v_lshlrev_b32_sdwa v209, 1, v209 dst_sel:DWORD dst_unused:UNUSED_PAD src0_sel:DWORD src1_sel:WORD_1
    s_waitcnt lgkmcnt(11)
    v_mfma_f32_16x16x32_bf16 v[48:51], v[228:231], v[160:163], v[48:51]
    ds_read_b64_tr_b16 v[226:227], v254 offset:43264
    v_or_b32 v145, v194, v195
    v_fma_mixlo_f16 v222, v222, s83, 0
    v_mfma_f32_16x16x32_bf16 v[56:59], v[228:231], v[164:167], v[56:59]
    ds_read_u16_d16 v208, v208
    v_lshlrev_b32_sdwa v210, 1, v210 dst_sel:DWORD dst_unused:UNUSED_PAD src0_sel:DWORD src1_sel:WORD_1
    v_mfma_f32_16x16x32_bf16 v[64:67], v[228:231], v[168:171], v[64:67]
    ds_read_u16_d16_hi v209, v209
    v_rcp_f16_sdwa v205, v205 dst_sel:WORD_1 dst_unused:UNUSED_PRESERVE src0_sel:WORD_1
    v_lshlrev_b32_sdwa v211, 1, v211 dst_sel:DWORD dst_unused:UNUSED_PAD src0_sel:DWORD src1_sel:WORD_1
    v_mfma_f32_16x16x32_bf16 v[72:75], v[228:231], v[172:175], v[72:75]
    ds_read_b64_tr_b16 v[228:229], v255 offset:44096
    v_or_b32 v148, v196, v197
    s_waitcnt lgkmcnt(11)
    v_mfma_f32_16x16x32_bf16 v[176:179], v[232:235], v[16:19], v[176:179]
    ds_read_b64_tr_b16 v[230:231], v255 offset:44864
    v_rcp_f16_sdwa v207, v207 dst_sel:WORD_1 dst_unused:UNUSED_PRESERVE src0_sel:WORD_1
    v_mfma_f32_16x16x32_bf16 v[180:183], v[232:235], v[20:23], v[180:183]
    ds_read_u16_d16 v210, v210
    v_lshlrev_b32_sdwa v212, 1, v212 dst_sel:DWORD dst_unused:UNUSED_PAD src0_sel:DWORD src1_sel:WORD_1
    v_fma_mixhi_f16 v222, v223, s83, 0
    v_mfma_f32_16x16x32_bf16 v[184:187], v[232:235], v[24:27], v[184:187]
    ds_read_u16_d16_hi v211, v211
    v_lshlrev_b32_sdwa v213, 1, v213 dst_sel:DWORD dst_unused:UNUSED_PAD src0_sel:DWORD src1_sel:WORD_1
    v_fma_mix_f32 v156, v204, v205, 0 op_sel_hi:[1,1,0]
    v_mfma_f32_16x16x32_bf16 v[188:191], v[232:235], v[28:31], v[188:191]
    ds_read_b64_tr_b16 v[232:233], v254 offset:40968
    ds_read_b64_tr_b16 v[234:235], v254 offset:41224
    v_or_b32 v149, v198, v199
    v_fma_mix_f32 v157, v206, v207, 0 op_sel_hi:[1,1,0]
    s_waitcnt lgkmcnt(12)
    v_mfma_f32_16x16x32_bf16 v[52:55], v[236:239], v[160:163], v[52:55]
    ds_read_u16_d16 v212, v212
    v_lshlrev_b32_sdwa v214, 1, v214 dst_sel:DWORD dst_unused:UNUSED_PAD src0_sel:DWORD src1_sel:WORD_1
    v_mfma_f32_16x16x32_bf16 v[60:63], v[236:239], v[164:167], v[60:63]
    ds_read_u16_d16_hi v213, v213
    v_pk_fma_f16 v223, v222, v222, s84 neg_lo:[0,1,0] neg_hi:[0,1,0]
    v_lshlrev_b32_sdwa v215, 1, v215 dst_sel:DWORD dst_unused:UNUSED_PAD src0_sel:DWORD src1_sel:WORD_1
    v_mfma_f32_16x16x32_bf16 v[68:71], v[236:239], v[168:171], v[68:71]
    ds_read_u16_d16 v214, v214
    v_fma_mix_f32 v205, v204, v205, 0 op_sel:[1,1,0] op_sel_hi:[1,1,0]
    v_or_b32 v152, v200, v201
    v_mfma_f32_16x16x32_bf16 v[76:79], v[236:239], v[172:175], v[76:79]
    ds_read_b64_tr_b16 v[236:237], v255 offset:44104
    v_fma_mix_f32 v207, v206, v207, 0 op_sel:[1,1,0] op_sel_hi:[1,1,0]
    v_lshlrev_b32_sdwa v216, 1, v216 dst_sel:DWORD dst_unused:UNUSED_PAD src0_sel:DWORD src1_sel:WORD_1
    s_waitcnt lgkmcnt(12)
    v_mfma_f32_16x16x32_bf16 v[176:179], v[224:227], v[32:35], v[176:179]
    ds_read_b64_tr_b16 v[238:239], v255 offset:44872
    v_pk_mul_f16 v223, v223, v222
    v_mfma_f32_16x16x32_bf16 v[180:183], v[224:227], v[36:39], v[180:183]
    ds_read_u16_d16_hi v215, v215
    v_cvt_pk_bf16_f32 v156, v156, v205
    v_lshlrev_b32_sdwa v217, 1, v217 dst_sel:DWORD dst_unused:UNUSED_PAD src0_sel:DWORD src1_sel:WORD_1
    v_mfma_f32_16x16x32_bf16 v[184:187], v[224:227], v[40:43], v[184:187]
    ds_read_u16_d16 v216, v216
    v_cvt_pk_bf16_f32 v157, v157, v207
    v_or_b32 v153, v202, v203
    v_mfma_f32_16x16x32_bf16 v[188:191], v[224:227], v[44:47], v[188:191]
    ds_read_b64_tr_b16 v[224:225], v254 offset:41992
    v_exp_f16_sdwa v223, v223 dst_sel:WORD_0 dst_unused:UNUSED_PRESERVE src0_sel:WORD_0
    s_waitcnt lgkmcnt(12)
    v_mfma_f32_16x16x32_bf16 v[80:83], v[228:231], v[160:163], v[80:83]
    ds_read_b64_tr_b16 v[226:227], v254 offset:42248
    v_lshlrev_b32_sdwa v218, 1, v218 dst_sel:DWORD dst_unused:UNUSED_PAD src0_sel:DWORD src1_sel:WORD_1
    v_lshlrev_b32_sdwa v219, 1, v219 dst_sel:DWORD dst_unused:UNUSED_PAD src0_sel:DWORD src1_sel:WORD_1
    v_mfma_f32_16x16x32_bf16 v[88:91], v[228:231], v[164:167], v[88:91]
    ds_read_u16_d16_hi v217, v217
    v_exp_f16_sdwa v223, v223 dst_sel:WORD_1 dst_unused:UNUSED_PRESERVE src0_sel:WORD_1
    v_mfma_f32_16x16x32_bf16 v[96:99], v[228:231], v[168:171], v[96:99]
    ds_read_u16_d16 v218, v218
    v_lshlrev_b32_sdwa v220, 1, v220 dst_sel:DWORD dst_unused:UNUSED_PAD src0_sel:DWORD src1_sel:WORD_1
    v_mfma_f32_16x16x32_bf16 v[104:107], v[228:231], v[172:175], v[104:107]
    ds_read_b64_tr_b16 v[228:229], v255 offset:44160
    ds_read_b64_tr_b16 v[230:231], v255 offset:44928
    v_lshlrev_b32_sdwa v221, 1, v221 dst_sel:DWORD dst_unused:UNUSED_PAD src0_sel:DWORD src1_sel:WORD_1
    v_pk_fma_f16 v223, v223, s85, s85
    s_waitcnt lgkmcnt(13)
    v_mfma_f32_16x16x32_bf16 v[192:195], v[232:235], v[0:3], 0
    ds_read_u16_d16_hi v219, v219
    v_or_b32 v146, v208, v209
    v_mfma_f32_16x16x32_bf16 v[196:199], v[232:235], v[4:7], 0
    ds_read_u16_d16 v220, v220
    v_rcp_f16_sdwa v223, v223 dst_sel:WORD_0 dst_unused:UNUSED_PRESERVE src0_sel:WORD_0
    v_lshlrev_b32_sdwa v176, 1, v176 dst_sel:DWORD dst_unused:UNUSED_PAD src0_sel:DWORD src1_sel:WORD_1
    v_mfma_f32_16x16x32_bf16 v[200:203], v[232:235], v[8:11], 0
    ds_read_u16_d16_hi v221, v221
    v_fma_mixlo_f16 v188, v188, s83, 0
    v_lshlrev_b32_sdwa v177, 1, v177 dst_sel:DWORD dst_unused:UNUSED_PAD src0_sel:DWORD src1_sel:WORD_1
    v_mfma_f32_16x16x32_bf16 v[204:207], v[232:235], v[12:15], 0
    ds_read_b64_tr_b16 v[232:233], v254 offset:43016
    v_fma_mixlo_f16 v190, v190, s83, 0
    v_or_b32 v147, v210, v211
    s_waitcnt lgkmcnt(12)
    v_mfma_f32_16x16x32_bf16 v[84:87], v[236:239], v[160:163], v[84:87]
    ds_read_b64_tr_b16 v[234:235], v254 offset:43272
    v_rcp_f16_sdwa v223, v223 dst_sel:WORD_1 dst_unused:UNUSED_PRESERVE src0_sel:WORD_1
    v_mfma_f32_16x16x32_bf16 v[92:95], v[236:239], v[164:167], v[92:95]
    ds_read_u16_d16 v176, v176
    s_waitcnt vmcnt(1)
    v_mfma_f32_16x16x16_bf16 v[128:131], v[242:243], v[244:245], v[128:131]
    v_lshlrev_b32_sdwa v178, 1, v178 dst_sel:DWORD dst_unused:UNUSED_PAD src0_sel:DWORD src1_sel:WORD_1
    v_mfma_f32_16x16x32_bf16 v[100:103], v[236:239], v[168:171], v[100:103]
    ds_read_u16_d16_hi v177, v177
    v_fma_mixhi_f16 v188, v189, s83, 0
    v_mfma_f32_16x16x32_bf16 v[108:111], v[236:239], v[172:175], v[108:111]
    ds_read_b64_tr_b16 v[236:237], v255 offset:44168
    v_mfma_f32_16x16x16_bf16 v[132:135], v[242:243], v[246:247], v[132:135]
    v_lshlrev_b32_sdwa v179, 1, v179 dst_sel:DWORD dst_unused:UNUSED_PAD src0_sel:DWORD src1_sel:WORD_1
    v_fma_mixhi_f16 v190, v191, s83, 0
    s_waitcnt lgkmcnt(12)
    v_mfma_f32_16x16x32_bf16 v[192:195], v[224:227], v[16:19], v[192:195]
    ds_read_b64_tr_b16 v[238:239], v255 offset:44936
    buffer_load_dwordx4 v[244:247], v252, s[4:7], s25 offen offset:256 sc1
    v_or_b32 v150, v212, v213
    v_mfma_f32_16x16x32_bf16 v[196:199], v[224:227], v[20:23], v[196:199]
    ds_read_u16_d16 v178, v178
    v_fma_mix_f32 v159, v222, v223, 0 op_sel_hi:[1,1,0]
    v_pk_fma_f16 v189, v188, v188, s84 neg_lo:[0,1,0] neg_hi:[0,1,0]
    v_mfma_f32_16x16x32_bf16 v[200:203], v[224:227], v[24:27], v[200:203]
    ds_read_u16_d16_hi v179, v179
    v_lshlrev_b32_sdwa v180, 1, v180 dst_sel:DWORD dst_unused:UNUSED_PAD src0_sel:DWORD src1_sel:WORD_1
    v_pk_fma_f16 v191, v190, v190, s84 neg_lo:[0,1,0] neg_hi:[0,1,0]
    v_mfma_f32_16x16x32_bf16 v[204:207], v[224:227], v[28:31], v[204:207]
    s_cmp_lt_u32 s19, 20
    s_cbranch_scc1 L_rd20_slow
L_rd20_go:
    ds_read_b64_tr_b16 v[224:225], v254 offset:47104
    v_lshlrev_b32_sdwa v181, 1, v181 dst_sel:DWORD dst_unused:UNUSED_PAD src0_sel:DWORD src1_sel:WORD_1
    v_fma_mix_f32 v223, v222, v223, 0 op_sel:[1,1,0] op_sel_hi:[1,1,0]
    s_waitcnt lgkmcnt(12)
    v_mfma_f32_16x16x32_bf16 v[112:115], v[228:231], v[160:163], v[112:115]
    ds_read_b64_tr_b16 v[226:227], v254 offset:47360
    v_or_b32 v151, v214, v215
    v_pk_mul_f16 v189, v189, v188
    v_mfma_f32_16x16x32_bf16 v[120:123], v[228:231], v[164:167], v[120:123]
    ds_read_u16_d16 v180, v180
    v_pk_mul_f16 v191, v191, v190
    v_lshlrev_b32_sdwa v182, 1, v182 dst_sel:DWORD dst_unused:UNUSED_PAD src0_sel:DWORD src1_sel:WORD_1
    v_mfma_f32_16x16x32_bf16 v[128:131], v[228:231], v[168:171], v[128:131]
    ds_read_u16_d16_hi v181, v181
    v_cvt_pk_bf16_f32 v159, v159, v223
    v_lshlrev_b32_sdwa v183, 1, v183 dst_sel:DWORD dst_unused:UNUSED_PAD src0_sel:DWORD src1_sel:WORD_1
    v_mfma_f32_16x16x32_bf16 v[136:139], v[228:231], v[172:175], v[136:139]
    ds_read_b64_tr_b16 v[228:229], v255 offset:50176
    v_exp_f16_sdwa v189, v189 dst_sel:WORD_0 dst_unused:UNUSED_PRESERVE src0_sel:WORD_0
    s_waitcnt lgkmcnt(11)
    v_mfma_f32_16x16x32_bf16 v[192:195], v[232:235], v[32:35], v[192:195]
    ds_read_b64_tr_b16 v[230:231], v255 offset:50944
    v_or_b32 v154, v216, v217
    v_mfma_f32_16x16x32_bf16 v[196:199], v[232:235], v[36:39], v[196:199]
    ds_read_u16_d16 v182, v182
    v_exp_f16_sdwa v191, v191 dst_sel:WORD_0 dst_unused:UNUSED_PRESERVE src0_sel:WORD_0
    v_lshlrev_b32_sdwa v184, 1, v184 dst_sel:DWORD dst_unused:UNUSED_PAD src0_sel:DWORD src1_sel:WORD_1
    v_mfma_f32_16x16x32_bf16 v[200:203], v[232:235], v[40:43], v[200:203]
    ds_read_u16_d16_hi v183, v183
    v_lshlrev_b32_sdwa v185, 1, v185 dst_sel:DWORD dst_unused:UNUSED_PAD src0_sel:DWORD src1_sel:WORD_1
    v_mfma_f32_16x16x32_bf16 v[204:207], v[232:235], v[44:47], v[204:207]
    ds_read_b64_tr_b16 v[232:233], v254 offset:48128
    v_exp_f16_sdwa v189, v189 dst_sel:WORD_1 dst_unused:UNUSED_PRESERVE src0_sel:WORD_1
    s_waitcnt lgkmcnt(11)
    v_mfma_f32_16x16x32_bf16 v[116:119], v[236:239], v[160:163], v[116:119]
    ds_read_b64_tr_b16 v[234:235], v254 offset:48384
    v_or_b32 v155, v218, v219
    v_exp_f16_sdwa v191, v191 dst_sel:WORD_1 dst_unused:UNUSED_PRESERVE src0_sel:WORD_1
    v_mfma_f32_16x16x32_bf16 v[124:127], v[236:239], v[164:167], v[124:127]
    ds_read_u16_d16 v184, v184
    v_lshlrev_b32_sdwa v186, 1, v186 dst_sel:DWORD dst_unused:UNUSED_PAD src0_sel:DWORD src1_sel:WORD_1
    v_mfma_f32_16x16x32_bf16 v[132:135], v[236:239], v[168:171], v[132:135]
    ds_read_u16_d16_hi v185, v185
    v_lshlrev_b32_sdwa v187, 1, v187 dst_sel:DWORD dst_unused:UNUSED_PAD src0_sel:DWORD src1_sel:WORD_1
    v_pk_fma_f16 v189, v189, s85, s85
    v_mfma_f32_16x16x32_bf16 v[140:143], v[236:239], v[172:175], v[140:143]
    ds_read_b64_tr_b16 v[236:237], v255 offset:50184
    v_or_b32 v158, v220, v221
    v_pk_fma_f16 v191, v191, s85, s85
    s_waitcnt lgkmcnt(11)
    v_mfma_f32_16x16x32_bf16 v[208:211], v[224:227], v[0:3], 0
    ds_read_b64_tr_b16 v[238:239], v255 offset:50952
    v_or_b32 v160, v176, v177
    v_mfma_f32_16x16x32_bf16 v[212:215], v[224:227], v[4:7], 0
    ds_read_u16_d16 v186, v186
    v_rcp_f16_sdwa v189, v189 dst_sel:WORD_0 dst_unused:UNUSED_PRESERVE src0_sel:WORD_0
    v_lshlrev_b32_sdwa v192, 1, v192 dst_sel:DWORD dst_unused:UNUSED_PAD src0_sel:DWORD src1_sel:WORD_1
    v_mfma_f32_16x16x32_bf16 v[216:219], v[224:227], v[8:11], 0
    ds_read_u16_d16_hi v187, v187
    v_rcp_f16_sdwa v191, v191 dst_sel:WORD_0 dst_unused:UNUSED_PRESERVE src0_sel:WORD_0
    v_mfma_f32_16x16x32_bf16 v[220:223], v[224:227], v[12:15], 0
    ds_read_b64_tr_b16 v[224:225], v254 offset:49152
    v_lshlrev_b32_sdwa v193, 1, v193 dst_sel:DWORD dst_unused:UNUSED_PAD src0_sel:DWORD src1_sel:WORD_1
    v_or_b32 v161, v178, v179
    s_waitcnt lgkmcnt(11)
    v_mfma_f32_16x16x32_bf16 v[48:51], v[228:231], v[144:147], v[48:51]
    ds_read_b64_tr_b16 v[226:227], v254 offset:49408
    v_fma_mixlo_f16 v206, v206, s83, 0
    v_mfma_f32_16x16x32_bf16 v[56:59], v[228:231], v[148:151], v[56:59]
    ds_read_u16_d16 v192, v192
    s_waitcnt vmcnt(1)
    v_mfma_f32_16x16x16_bf16 v[76:79], v[242:243], v[250:251], v[76:79]
    v_lshlrev_b32_sdwa v194, 1, v194 dst_sel:DWORD dst_unused:UNUSED_PAD src0_sel:DWORD src1_sel:WORD_1
    v_mfma_f32_16x16x32_bf16 v[64:67], v[228:231], v[152:155], v[64:67]
    ds_read_u16_d16_hi v193, v193
    v_rcp_f16_sdwa v189, v189 dst_sel:WORD_1 dst_unused:UNUSED_PRESERVE src0_sel:WORD_1
    v_mfma_f32_16x16x32_bf16 v[72:75], v[228:231], v[156:159], v[72:75]
    ds_read_b64_tr_b16 v[228:229], v255 offset:50240
    v_lshlrev_b32_sdwa v195, 1, v195 dst_sel:DWORD dst_unused:UNUSED_PAD src0_sel:DWORD src1_sel:WORD_1
    v_or_b32 v164, v180, v181
    s_waitcnt lgkmcnt(11)
    v_mfma_f32_16x16x32_bf16 v[208:211], v[232:235], v[16:19], v[208:211]
    ds_read_b64_tr_b16 v[230:231], v255 offset:51008
    v_rcp_f16_sdwa v191, v191 dst_sel:WORD_1 dst_unused:UNUSED_PRESERVE src0_sel:WORD_1
    v_mfma_f32_16x16x32_bf16 v[212:215], v[232:235], v[20:23], v[212:215]
    ds_read_u16_d16 v194, v194
    v_lshlrev_b32_sdwa v196, 1, v196 dst_sel:DWORD dst_unused:UNUSED_PAD src0_sel:DWORD src1_sel:WORD_1
    v_fma_mixhi_f16 v206, v207, s83, 0
    v_mfma_f32_16x16x32_bf16 v[216:219], v[232:235], v[24:27], v[216:219]
    ds_read_u16_d16_hi v195, v195
    v_mfma_f32_16x16x16_bf16 v[72:75], v[242:243], v[248:249], v[72:75]
    v_lshlrev_b32_sdwa v197, 1, v197 dst_sel:DWORD dst_unused:UNUSED_PAD src0_sel:DWORD src1_sel:WORD_1
    v_fma_mix_f32 v172, v188, v189, 0 op_sel_hi:[1,1,0]
    v_mfma_f32_16x16x32_bf16 v[220:223], v[232:235], v[28:31], v[220:223]
    ds_read_b64_tr_b16 v[232:233], v254 offset:47112
    ds_read_b64_tr_b16 v[234:235], v254 offset:47368
    buffer_load_dwordx4 v[248:251], v252, s[4:7], s25 offen offset:320 sc1
    v_or_b32 v165, v182, v183
    s_waitcnt lgkmcnt(12)
    v_mfma_f32_16x16x32_bf16 v[52:55], v[236:239], v[144:147], v[52:55]
    ds_read_u16_d16 v196, v196
    v_fma_mix_f32 v173, v190, v191, 0 op_sel_hi:[1,1,0]
    v_mfma_f32_16x16x32_bf16 v[60:63], v[236:239], v[148:151], v[60:63]
    ds_read_u16_d16_hi v197, v197
    v_lshlrev_b32_sdwa v198, 1, v198 dst_sel:DWORD dst_unused:UNUSED_PAD src0_sel:DWORD src1_sel:WORD_1
    v_pk_fma_f16 v207, v206, v206, s84 neg_lo:[0,1,0] neg_hi:[0,1,0]
    v_mfma_f32_16x16x32_bf16 v[68:71], v[236:239], v[152:155], v[68:71]
    ds_read_u16_d16 v198, v198
    v_lshlrev_b32_sdwa v199, 1, v199 dst_sel:DWORD dst_unused:UNUSED_PAD src0_sel:DWORD src1_sel:WORD_1
    v_fma_mix_f32 v189, v188, v189, 0 op_sel:[1,1,0] op_sel_hi:[1,1,0]
    v_mfma_f32_16x16x32_bf16 v[76:79], v[236:239], v[156:159], v[76:79]
    ds_read_b64_tr_b16 v[236:237], v255 offset:50248
    v_or_b32 v168, v184, v185
    v_fma_mix_f32 v191, v190, v191, 0 op_sel:[1,1,0] op_sel_hi:[1,1,0]
    s_waitcnt lgkmcnt(12)
    v_mfma_f32_16x16x32_bf16 v[208:211], v[224:227], v[32:35], v[208:211]
    ds_read_b64_tr_b16 v[238:239], v255 offset:51016
    v_lshlrev_b32_sdwa v200, 1, v200 dst_sel:DWORD dst_unused:UNUSED_PAD src0_sel:DWORD src1_sel:WORD_1
    v_pk_mul_f16 v207, v207, v206
    v_mfma_f32_16x16x32_bf16 v[212:215], v[224:227], v[36:39], v[212:215]
    ds_read_u16_d16_hi v199, v199
    v_cvt_pk_bf16_f32 v172, v172, v189
    v_lshlrev_b32_sdwa v201, 1, v201 dst_sel:DWORD dst_unused:UNUSED_PAD src0_sel:DWORD src1_sel:WORD_1
    v_mfma_f32_16x16x32_bf16 v[216:219], v[224:227], v[40:43], v[216:219]
    ds_read_u16_d16 v200, v200
    v_cvt_pk_bf16_f32 v173, v173, v191
    v_or_b32 v169, v186, v187
    v_mfma_f32_16x16x32_bf16 v[220:223], v[224:227], v[44:47], v[220:223]
    ds_read_b64_tr_b16 v[224:225], v254 offset:48136
    v_exp_f16_sdwa v207, v207 dst_sel:WORD_0 dst_unused:UNUSED_PRESERVE src0_sel:WORD_0
    s_waitcnt lgkmcnt(12)
    v_mfma_f32_16x16x32_bf16 v[80:83], v[228:231], v[144:147], v[80:83]
    ds_read_b64_tr_b16 v[226:227], v254 offset:48392
    v_lshlrev_b32_sdwa v202, 1, v202 dst_sel:DWORD dst_unused:UNUSED_PAD src0_sel:DWORD src1_sel:WORD_1
    v_mfma_f32_16x16x32_bf16 v[88:91], v[228:231], v[148:151], v[88:91]
    ds_read_u16_d16_hi v201, v201
    v_lshlrev_b32_sdwa v203, 1, v203 dst_sel:DWORD dst_unused:UNUSED_PAD src0_sel:DWORD src1_sel:WORD_1
    v_exp_f16_sdwa v207, v207 dst_sel:WORD_1 dst_unused:UNUSED_PRESERVE src0_sel:WORD_1
    v_mfma_f32_16x16x32_bf16 v[96:99], v[228:231], v[152:155], v[96:99]
    ds_read_u16_d16 v202, v202
    v_lshlrev_b32_sdwa v204, 1, v204 dst_sel:DWORD dst_unused:UNUSED_PAD src0_sel:DWORD src1_sel:WORD_1
    v_mfma_f32_16x16x32_bf16 v[104:107], v[228:231], v[156:159], v[104:107]
    ds_read_b64_tr_b16 v[228:229], v255 offset:50304
    ds_read_b64_tr_b16 v[230:231], v255 offset:51072
    v_lshlrev_b32_sdwa v205, 1, v205 dst_sel:DWORD dst_unused:UNUSED_PAD src0_sel:DWORD src1_sel:WORD_1
    v_pk_fma_f16 v207, v207, s85, s85
    s_waitcnt lgkmcnt(13)
    v_mfma_f32_16x16x32_bf16 v[176:179], v[232:235], v[0:3], 0
    ds_read_u16_d16_hi v203, v203
    v_or_b32 v162, v192, v193
    v_mfma_f32_16x16x32_bf16 v[180:183], v[232:235], v[4:7], 0
    ds_read_u16_d16 v204, v204
    v_rcp_f16_sdwa v207, v207 dst_sel:WORD_0 dst_unused:UNUSED_PRESERVE src0_sel:WORD_0
    v_lshlrev_b32_sdwa v208, 1, v208 dst_sel:DWORD dst_unused:UNUSED_PAD src0_sel:DWORD src1_sel:WORD_1
    v_mfma_f32_16x16x32_bf16 v[184:187], v[232:235], v[8:11], 0
    ds_read_u16_d16_hi v205, v205
    v_fma_mixlo_f16 v220, v220, s83, 0
    v_lshlrev_b32_sdwa v209, 1, v209 dst_sel:DWORD dst_unused:UNUSED_PAD src0_sel:DWORD src1_sel:WORD_1
    v_mfma_f32_16x16x32_bf16 v[188:191], v[232:235], v[12:15], 0
    ds_read_b64_tr_b16 v[232:233], v254 offset:49160
    v_fma_mixlo_f16 v222, v222, s83, 0
    s_waitcnt lgkmcnt(12)
    v_mfma_f32_16x16x32_bf16 v[84:87], v[236:239], v[144:147], v[84:87]
    ds_read_b64_tr_b16 v[234:235], v254 offset:49416
    v_or_b32 v163, v194, v195
    v_rcp_f16_sdwa v207, v207 dst_sel:WORD_1 dst_unused:UNUSED_PRESERVE src0_sel:WORD_1
    v_mfma_f32_16x16x32_bf16 v[92:95], v[236:239], v[148:151], v[92:95]
    ds_read_u16_d16 v208, v208
    v_lshlrev_b32_sdwa v210, 1, v210 dst_sel:DWORD dst_unused:UNUSED_PAD src0_sel:DWORD src1_sel:WORD_1
    v_mfma_f32_16x16x32_bf16 v[100:103], v[236:239], v[152:155], v[100:103]
    ds_read_u16_d16_hi v209, v209
    v_fma_mixhi_f16 v220, v221, s83, 0
    v_lshlrev_b32_sdwa v211, 1, v211 dst_sel:DWORD dst_unused:UNUSED_PAD src0_sel:DWORD src1_sel:WORD_1
    v_mfma_f32_16x16x32_bf16 v[108:111], v[236:239], v[156:159], v[108:111]
    ds_read_b64_tr_b16 v[236:237], v255 offset:50312
    v_fma_mixhi_f16 v222, v223, s83, 0
    v_or_b32 v166, v196, v197
    s_waitcnt lgkmcnt(12)
    v_mfma_f32_16x16x32_bf16 v[176:179], v[224:227], v[16:19], v[176:179]
    ds_read_b64_tr_b16 v[238:239], v255 offset:51080
    v_fma_mix_f32 v175, v206, v207, 0 op_sel_hi:[1,1,0]
    v_pk_fma_f16 v221, v220, v220, s84 neg_lo:[0,1,0] neg_hi:[0,1,0]
    v_mfma_f32_16x16x32_bf16 v[180:183], v[224:227], v[20:23], v[180:183]
    ds_read_u16_d16 v210, v210
    v_lshlrev_b32_sdwa v212, 1, v212 dst_sel:DWORD dst_unused:UNUSED_PAD src0_sel:DWORD src1_sel:WORD_1
    v_mfma_f32_16x16x32_bf16 v[184:187], v[224:227], v[24:27], v[184:187]
    ds_read_u16_d16_hi v211, v211
    v_pk_fma_f16 v223, v222, v222, s84 neg_lo:[0,1,0] neg_hi:[0,1,0]
    v_lshlrev_b32_sdwa v213, 1, v213 dst_sel:DWORD dst_unused:UNUSED_PAD src0_sel:DWORD src1_sel:WORD_1
    v_mfma_f32_16x16x32_bf16 v[188:191], v[224:227], v[28:31], v[188:191]
    s_cmp_lt_u32 s19, 22
    s_cbranch_scc1 L_rd22_slow
L_rd22_go:
    ds_read_b64_tr_b16 v[224:225], v254 offset:53248
    v_fma_mix_f32 v207, v206, v207, 0 op_sel:[1,1,0] op_sel_hi:[1,1,0]
    v_or_b32 v167, v198, v199
    s_waitcnt lgkmcnt(12)
    v_mfma_f32_16x16x32_bf16 v[112:115], v[228:231], v[144:147], v[112:115]
    ds_read_b64_tr_b16 v[226:227], v254 offset:53504
    v_pk_mul_f16 v221, v221, v220
    v_pk_mul_f16 v223, v223, v222
    v_mfma_f32_16x16x32_bf16 v[120:123], v[228:231], v[148:151], v[120:123]
    ds_read_u16_d16 v212, v212
    v_lshlrev_b32_sdwa v214, 1, v214 dst_sel:DWORD dst_unused:UNUSED_PAD src0_sel:DWORD src1_sel:WORD_1
    v_cvt_pk_bf16_f32 v175, v175, v207
    v_mfma_f32_16x16x32_bf16 v[128:131], v[228:231], v[152:155], v[128:131]
    ds_read_u16_d16_hi v213, v213
    v_lshlrev_b32_sdwa v215, 1, v215 dst_sel:DWORD dst_unused:UNUSED_PAD src0_sel:DWORD src1_sel:WORD_1
    v_mfma_f32_16x16x32_bf16 v[136:139], v[228:231], v[156:159], v[136:139]
    ds_read_b64_tr_b16 v[228:229], v255 offset:56320
    v_exp_f16_sdwa v221, v221 dst_sel:WORD_0 dst_unused:UNUSED_PRESERVE src0_sel:WORD_0
    s_waitcnt lgkmcnt(11)
    v_mfma_f32_16x16x32_bf16 v[176:179], v[232:235], v[32:35], v[176:179]
    ds_read_b64_tr_b16 v[230:231], v255 offset:57088
    v_or_b32 v170, v200, v201
    v_exp_f16_sdwa v223, v223 dst_sel:WORD_0 dst_unused:UNUSED_PRESERVE src0_sel:WORD_0
    v_mfma_f32_16x16x32_bf16 v[180:183], v[232:235], v[36:39], v[180:183]
    ds_read_u16_d16 v214, v214
    v_lshlrev_b32_sdwa v216, 1, v216 dst_sel:DWORD dst_unused:UNUSED_PAD src0_sel:DWORD src1_sel:WORD_1
    v_mfma_f32_16x16x32_bf16 v[184:187], v[232:235], v[40:43], v[184:187]
    ds_read_u16_d16_hi v215, v215
    v_lshlrev_b32_sdwa v217, 1, v217 dst_sel:DWORD dst_unused:UNUSED_PAD src0_sel:DWORD src1_sel:WORD_1
    v_mfma_f32_16x16x32_bf16 v[188:191], v[232:235], v[44:47], v[188:191]
    ds_read_b64_tr_b16 v[232:233], v254 offset:54272
    v_exp_f16_sdwa v221, v221 dst_sel:WORD_1 dst_unused:UNUSED_PRESERVE src0_sel:WORD_1
    v_or_b32 v171, v202, v203
    s_waitcnt lgkmcnt(11)
    v_mfma_f32_16x16x32_bf16 v[116:119], v[236:239], v[144:147], v[116:119]
    ds_read_b64_tr_b16 v[234:235], v254 offset:54528
    v_exp_f16_sdwa v223, v223 dst_sel:WORD_1 dst_unused:UNUSED_PRESERVE src0_sel:WORD_1
    v_mfma_f32_16x16x32_bf16 v[124:127], v[236:239], v[148:151], v[124:127]
    ds_read_u16_d16 v216, v216
    v_lshlrev_b32_sdwa v218, 1, v218 dst_sel:DWORD dst_unused:UNUSED_PAD src0_sel:DWORD src1_sel:WORD_1
    v_mfma_f32_16x16x32_bf16 v[132:135], v[236:239], v[152:155], v[132:135]
    ds_read_u16_d16_hi v217, v217
    v_lshlrev_b32_sdwa v219, 1, v219 dst_sel:DWORD dst_unused:UNUSED_PAD src0_sel:DWORD src1_sel:WORD_1
    v_pk_fma_f16 v221, v221, s85, s85
    v_mfma_f32_16x16x32_bf16 v[140:143], v[236:239], v[156:159], v[140:143]
    ds_read_b64_tr_b16 v[236:237], v255 offset:56328
    v_or_b32 v174, v204, v205
    v_pk_fma_f16 v223, v223, s85, s85
    s_waitcnt lgkmcnt(11)
    v_mfma_f32_16x16x32_bf16 v[192:195], v[224:227], v[0:3], 0
    ds_read_b64_tr_b16 v[238:239], v255 offset:57096
    v_or_b32 v144, v208, v209
    v_mfma_f32_16x16x32_bf16 v[196:199], v[224:227], v[4:7], 0
    ds_read_u16_d16 v218, v218
    v_rcp_f16_sdwa v221, v221 dst_sel:WORD_0 dst_unused:UNUSED_PRESERVE src0_sel:WORD_0
    v_lshlrev_b32_sdwa v176, 1, v176 dst_sel:DWORD dst_unused:UNUSED_PAD src0_sel:DWORD src1_sel:WORD_1
    v_mfma_f32_16x16x32_bf16 v[200:203], v[224:227], v[8:11], 0
    ds_read_u16_d16_hi v219, v219
    v_rcp_f16_sdwa v223, v223 dst_sel:WORD_0 dst_unused:UNUSED_PRESERVE src0_sel:WORD_0
    v_mfma_f32_16x16x32_bf16 v[204:207], v[224:227], v[12:15], 0
    ds_read_b64_tr_b16 v[224:225], v254 offset:55296
    v_lshlrev_b32_sdwa v177, 1, v177 dst_sel:DWORD dst_unused:UNUSED_PAD src0_sel:DWORD src1_sel:WORD_1
    s_waitcnt lgkmcnt(11)
    v_mfma_f32_16x16x32_bf16 v[48:51], v[228:231], v[160:163], v[48:51]
    ds_read_b64_tr_b16 v[226:227], v254 offset:55552
    v_or_b32 v145, v210, v211
    v_fma_mixlo_f16 v190, v190, s83, 0
    v_mfma_f32_16x16x32_bf16 v[56:59], v[228:231], v[164:167], v[56:59]
    ds_read_u16_d16 v176, v176
    s_waitcnt vmcnt(1)
    v_mfma_f32_16x16x16_bf16 v[104:107], v[242:243], v[244:245], v[104:107]
    v_lshlrev_b32_sdwa v178, 1, v178 dst_sel:DWORD dst_unused:UNUSED_PAD src0_sel:DWORD src1_sel:WORD_1
    v_mfma_f32_16x16x32_bf16 v[64:67], v[228:231], v[168:171], v[64:67]
    ds_read_u16_d16_hi v177, v177
    v_rcp_f16_sdwa v221, v221 dst_sel:WORD_1 dst_unused:UNUSED_PRESERVE src0_sel:WORD_1
    v_mfma_f32_16x16x32_bf16 v[72:75], v[228:231], v[172:175], v[72:75]
    ds_read_b64_tr_b16 v[228:229], v255 offset:56384
    v_mfma_f32_16x16x16_bf16 v[108:111], v[242:243], v[246:247], v[108:111]
    v_lshlrev_b32_sdwa v179, 1, v179 dst_sel:DWORD dst_unused:UNUSED_PAD src0_sel:DWORD src1_sel:WORD_1
    v_or_b32 v148, v212, v213
    s_waitcnt lgkmcnt(11)
    v_mfma_f32_16x16x32_bf16 v[192:195], v[232:235], v[16:19], v[192:195]
    ds_read_b64_tr_b16 v[230:231], v255 offset:57152
    v_rcp_f16_sdwa v223, v223 dst_sel:WORD_1 dst_unused:UNUSED_PRESERVE src0_sel:WORD_1
    v_mfma_f32_16x16x32_bf16 v[196:199], v[232:235], v[20:23], v[196:199]
    ds_read_u16_d16 v178, v178
    v_lshlrev_b32_sdwa v180, 1, v180 dst_sel:DWORD dst_unused:UNUSED_PAD src0_sel:DWORD src1_sel:WORD_1
    v_mfma_f32_16x16x32_bf16 v[200:203], v[232:235], v[24:27], v[200:203]
    ds_read_u16_d16_hi v179, v179
    v_fma_mixhi_f16 v190, v191, s83, 0
    v_lshlrev_b32_sdwa v181, 1, v181 dst_sel:DWORD dst_unused:UNUSED_PAD src0_sel:DWORD src1_sel:WORD_1
    v_mfma_f32_16x16x32_bf16 v[204:207], v[232:235], v[28:31], v[204:207]
    ds_read_b64_tr_b16 v[232:233], v254 offset:53256
    ds_read_b64_tr_b16 v[234:235], v254 offset:53512
    v_fma_mix_f32 v156, v220, v221, 0 op_sel_hi:[1,1,0]
    v_or_b32 v149, v214, v215
    s_waitcnt lgkmcnt(12)
    v_mfma_f32_16x16x32_bf16 v[52:55], v[236:239], v[160:163], v[52:55]
    ds_read_u16_d16 v180, v180
    v_fma_mix_f32 v157, v222, v223, 0 op_sel_hi:[1,1,0]
    v_lshlrev_b32_sdwa v182, 1, v182 dst_sel:DWORD dst_unused:UNUSED_PAD src0_sel:DWORD src1_sel:WORD_1
    v_mfma_f32_16x16x32_bf16 v[60:63], v[236:239], v[164:167], v[60:63]
    ds_read_u16_d16_hi v181, v181
    v_pk_fma_f16 v191, v190, v190, s84 neg_lo:[0,1,0] neg_hi:[0,1,0]
    v_lshlrev_b32_sdwa v183, 1, v183 dst_sel:DWORD dst_unused:UNUSED_PAD src0_sel:DWORD src1_sel:WORD_1
    v_mfma_f32_16x16x32_bf16 v[68:71], v[236:239], v[168:171], v[68:71]
    ds_read_u16_d16 v182, v182
    v_fma_mix_f32 v221, v220, v221, 0 op_sel:[1,1,0] op_sel_hi:[1,1,0]
    v_or_b32 v152, v216, v217
    v_mfma_f32_16x16x32_bf16 v[76:79], v[236:239], v[172:175], v[76:79]
    ds_read_b64_tr_b16 v[236:237], v255 offset:56392
    v_fma_mix_f32 v223, v222, v223, 0 op_sel:[1,1,0] op_sel_hi:[1,1,0]
    s_waitcnt lgkmcnt(12)
    v_mfma_f32_16x16x32_bf16 v[192:195], v[224:227], v[32:35], v[192:195]
    ds_read_b64_tr_b16 v[238:239], v255 offset:57160
    v_lshlrev_b32_sdwa v184, 1, v184 dst_sel:DWORD dst_unused:UNUSED_PAD src0_sel:DWORD src1_sel:WORD_1
    v_pk_mul_f16 v191, v191, v190
    v_mfma_f32_16x16x32_bf16 v[196:199], v[224:227], v[36:39], v[196:199]
    ds_read_u16_d16_hi v183, v183
    v_cvt_pk_bf16_f32 v156, v156, v221
    v_lshlrev_b32_sdwa v185, 1, v185 dst_sel:DWORD dst_unused:UNUSED_PAD src0_sel:DWORD src1_sel:WORD_1
    v_mfma_f32_16x16x32_bf16 v[200:203], v[224:227], v[40:43], v[200:203]
    ds_read_u16_d16 v184, v184
    v_cvt_pk_bf16_f32 v157, v157, v223
    v_or_b32 v153, v218, v219
    v_mfma_f32_16x16x32_bf16 v[204:207], v[224:227], v[44:47], v[204:207]
    ds_read_b64_tr_b16 v[224:225], v254 offset:54280
    v_exp_f16_sdwa v191, v191 dst_sel:WORD_0 dst_unused:UNUSED_PRESERVE src0_sel:WORD_0
    s_waitcnt lgkmcnt(12)
    v_mfma_f32_16x16x32_bf16 v[80:83], v[228:231], v[160:163], v[80:83]
    ds_read_b64_tr_b16 v[226:227], v254 offset:54536
    v_lshlrev_b32_sdwa v186, 1, v186 dst_sel:DWORD dst_unused:UNUSED_PAD src0_sel:DWORD src1_sel:WORD_1
    v_lshlrev_b32_sdwa v187, 1, v187 dst_sel:DWORD dst_unused:UNUSED_PAD src0_sel:DWORD src1_sel:WORD_1
    v_mfma_f32_16x16x32_bf16 v[88:91], v[228:231], v[164:167], v[88:91]
    ds_read_u16_d16_hi v185, v185
    v_exp_f16_sdwa v191, v191 dst_sel:WORD_1 dst_unused:UNUSED_PRESERVE src0_sel:WORD_1
    v_mfma_f32_16x16x32_bf16 v[96:99], v[228:231], v[168:171], v[96:99]
    ds_read_u16_d16 v186, v186
    v_lshlrev_b32_sdwa v188, 1, v188 dst_sel:DWORD dst_unused:UNUSED_PAD src0_sel:DWORD src1_sel:WORD_1
    v_mfma_f32_16x16x32_bf16 v[104:107], v[228:231], v[172:175], v[104:107]
    ds_read_b64_tr_b16 v[228:229], v255 offset:56448
    ds_read_b64_tr_b16 v[230:231], v255 offset:57216
    v_lshlrev_b32_sdwa v189, 1, v189 dst_sel:DWORD dst_unused:UNUSED_PAD src0_sel:DWORD src1_sel:WORD_1
    v_pk_fma_f16 v191, v191, s85, s85
    s_waitcnt lgkmcnt(13)
    v_mfma_f32_16x16x32_bf16 v[208:211], v[232:235], v[0:3], 0
    ds_read_u16_d16_hi v187, v187
    v_or_b32 v146, v176, v177
    v_mfma_f32_16x16x32_bf16 v[212:215], v[232:235], v[4:7], 0
    ds_read_u16_d16 v188, v188
    v_rcp_f16_sdwa v191, v191 dst_sel:WORD_0 dst_unused:UNUSED_PRESERVE src0_sel:WORD_0
    v_lshlrev_b32_sdwa v192, 1, v192 dst_sel:DWORD dst_unused:UNUSED_PAD src0_sel:DWORD src1_sel:WORD_1
    v_mfma_f32_16x16x32_bf16 v[216:219], v[232:235], v[8:11], 0
    ds_read_u16_d16_hi v189, v189
    v_fma_mixlo_f16 v204, v204, s83, 0
    v_lshlrev_b32_sdwa v193, 1, v193 dst_sel:DWORD dst_unused:UNUSED_PAD src0_sel:DWORD src1_sel:WORD_1
    v_mfma_f32_16x16x32_bf16 v[220:223], v[232:235], v[12:15], 0
    ds_read_b64_tr_b16 v[232:233], v254 offset:55304
    v_fma_mixlo_f16 v206, v206, s83, 0
    v_or_b32 v147, v178, v179
    s_waitcnt lgkmcnt(12)
    v_mfma_f32_16x16x32_bf16 v[84:87], v[236:239], v[160:163], v[84:87]
    ds_read_b64_tr_b16 v[234:235], v254 offset:55560
    v_rcp_f16_sdwa v191, v191 dst_sel:WORD_1 dst_unused:UNUSED_PRESERVE src0_sel:WORD_1
    v_mfma_f32_16x16x32_bf16 v[92:95], v[236:239], v[164:167], v[92:95]
    ds_read_u16_d16 v192, v192
    s_waitcnt vmcnt(0)
    v_mfma_f32_16x16x16_bf16 v[136:139], v[242:243], v[248:249], v[136:139]
    v_mfma_f32_16x16x32_bf16 v[100:103], v[236:239], v[168:171], v[100:103]
    ds_read_u16_d16_hi v193, v193
    v_lshlrev_b32_sdwa v194, 1, v194 dst_sel:DWORD dst_unused:UNUSED_PAD src0_sel:DWORD src1_sel:WORD_1
    v_fma_mixhi_f16 v204, v205, s83, 0
    v_mfma_f32_16x16x32_bf16 v[108:111], v[236:239], v[172:175], v[108:111]
    ds_read_b64_tr_b16 v[236:237], v255 offset:56456
    v_mfma_f32_16x16x16_bf16 v[140:143], v[242:243], v[250:251], v[140:143]
    v_lshlrev_b32_sdwa v195, 1, v195 dst_sel:DWORD dst_unused:UNUSED_PAD src0_sel:DWORD src1_sel:WORD_1
    v_fma_mixhi_f16 v206, v207, s83, 0
    s_waitcnt lgkmcnt(12)
    v_mfma_f32_16x16x32_bf16 v[208:211], v[224:227], v[16:19], v[208:211]
    ds_read_b64_tr_b16 v[238:239], v255 offset:57224
    v_or_b32 v150, v180, v181
    v_fma_mix_f32 v159, v190, v191, 0 op_sel_hi:[1,1,0]
    v_mfma_f32_16x16x32_bf16 v[212:215], v[224:227], v[20:23], v[212:215]
    ds_read_u16_d16 v194, v194
    v_pk_fma_f16 v205, v204, v204, s84 neg_lo:[0,1,0] neg_hi:[0,1,0]
    v_lshlrev_b32_sdwa v196, 1, v196 dst_sel:DWORD dst_unused:UNUSED_PAD src0_sel:DWORD src1_sel:WORD_1
    v_mfma_f32_16x16x32_bf16 v[216:219], v[224:227], v[24:27], v[216:219]
    ds_read_u16_d16_hi v195, v195
    v_pk_fma_f16 v207, v206, v206, s84 neg_lo:[0,1,0] neg_hi:[0,1,0]
    v_lshlrev_b32_sdwa v197, 1, v197 dst_sel:DWORD dst_unused:UNUSED_PAD src0_sel:DWORD src1_sel:WORD_1
    v_mfma_f32_16x16x32_bf16 v[220:223], v[224:227], v[28:31], v[220:223]
    s_cmp_lt_u32 s19, 25
    s_cbranch_scc1 L_rd25_slow
L_rd25_go:
    ds_read_b64_tr_b16 v[224:225], v255 offset:59392
    v_fma_mix_f32 v191, v190, v191, 0 op_sel:[1,1,0] op_sel_hi:[1,1,0]
    v_or_b32 v151, v182, v183
    s_waitcnt lgkmcnt(12)
    v_mfma_f32_16x16x32_bf16 v[112:115], v[228:231], v[160:163], v[112:115]
    ds_read_b64_tr_b16 v[226:227], v255 offset:60160
    v_pk_mul_f16 v205, v205, v204
    v_mfma_f32_16x16x32_bf16 v[120:123], v[228:231], v[164:167], v[120:123]
    ds_read_u16_d16 v196, v196
    v_pk_mul_f16 v207, v207, v206
    v_lshlrev_b32_sdwa v198, 1, v198 dst_sel:DWORD dst_unused:UNUSED_PAD src0_sel:DWORD src1_sel:WORD_1
    v_mfma_f32_16x16x32_bf16 v[128:131], v[228:231], v[168:171], v[128:131]
    ds_read_u16_d16_hi v197, v197
    v_cvt_pk_bf16_f32 v159, v159, v191
    v_lshlrev_b32_sdwa v199, 1, v199 dst_sel:DWORD dst_unused:UNUSED_PAD src0_sel:DWORD src1_sel:WORD_1
    v_mfma_f32_16x16x32_bf16 v[136:139], v[228:231], v[172:175], v[136:139]
    ds_read_b64_tr_b16 v[228:229], v255 offset:59400
    v_exp_f16_sdwa v205, v205 dst_sel:WORD_0 dst_unused:UNUSED_PRESERVE src0_sel:WORD_0
    s_waitcnt lgkmcnt(11)
    v_mfma_f32_16x16x32_bf16 v[208:211], v[232:235], v[32:35], v[208:211]
    ds_read_b64_tr_b16 v[230:231], v255 offset:60168
    v_or_b32 v154, v184, v185
    v_mfma_f32_16x16x32_bf16 v[212:215], v[232:235], v[36:39], v[212:215]
    ds_read_u16_d16 v198, v198
    v_exp_f16_sdwa v207, v207 dst_sel:WORD_0 dst_unused:UNUSED_PRESERVE src0_sel:WORD_0
    v_lshlrev_b32_sdwa v200, 1, v200 dst_sel:DWORD dst_unused:UNUSED_PAD src0_sel:DWORD src1_sel:WORD_1
    v_mfma_f32_16x16x32_bf16 v[216:219], v[232:235], v[40:43], v[216:219]
    ds_read_u16_d16_hi v199, v199
    v_lshlrev_b32_sdwa v201, 1, v201 dst_sel:DWORD dst_unused:UNUSED_PAD src0_sel:DWORD src1_sel:WORD_1
    v_mfma_f32_16x16x32_bf16 v[220:223], v[232:235], v[44:47], v[220:223]
    ds_read_b64_tr_b16 v[232:233], v255 offset:59456
    v_exp_f16_sdwa v205, v205 dst_sel:WORD_1 dst_unused:UNUSED_PRESERVE src0_sel:WORD_1
    v_or_b32 v155, v186, v187
    s_waitcnt lgkmcnt(11)
    v_mfma_f32_16x16x32_bf16 v[116:119], v[236:239], v[160:163], v[116:119]
    ds_read_b64_tr_b16 v[234:235], v255 offset:60224
    v_exp_f16_sdwa v207, v207 dst_sel:WORD_1 dst_unused:UNUSED_PRESERVE src0_sel:WORD_1
    v_mfma_f32_16x16x32_bf16 v[124:127], v[236:239], v[164:167], v[124:127]
    ds_read_u16_d16 v200, v200
    v_lshlrev_b32_sdwa v202, 1, v202 dst_sel:DWORD dst_unused:UNUSED_PAD src0_sel:DWORD src1_sel:WORD_1
    v_mfma_f32_16x16x32_bf16 v[132:135], v[236:239], v[168:171], v[132:135]
    ds_read_u16_d16_hi v201, v201
    v_lshlrev_b32_sdwa v203, 1, v203 dst_sel:DWORD dst_unused:UNUSED_PAD src0_sel:DWORD src1_sel:WORD_1
    v_pk_fma_f16 v205, v205, s85, s85
    v_mfma_f32_16x16x32_bf16 v[140:143], v[236:239], v[172:175], v[140:143]
    ds_read_b64_tr_b16 v[236:237], v255 offset:59464
    v_or_b32 v158, v188, v189
    v_pk_fma_f16 v207, v207, s85, s85
    s_waitcnt lgkmcnt(11)
    v_mfma_f32_16x16x32_bf16 v[48:51], v[224:227], v[144:147], v[48:51]
    ds_read_b64_tr_b16 v[238:239], v255 offset:60232
    s_waitcnt vmcnt(0)
    v_lshrrev_b32 v244, 7, v253
    v_mul_u32_u24 v244, 640, v244
    v_add_u32 v244, v244, v253
    v_add_u32 v245, 196608, v244
    buffer_load_dwordx4 v[16:19], v244, s[8:11], s36 offen offset:0
    v_mfma_f32_16x16x32_bf16 v[56:59], v[224:227], v[148:151], v[56:59]
    ds_read_u16_d16 v202, v202
    ds_read_u16_d16_hi v203, v203
    buffer_load_dwordx4 v[20:23], v244, s[8:11], s36 offen offset:128
    v_or_b32 v160, v192, v193
    v_rcp_f16_sdwa v205, v205 dst_sel:WORD_0 dst_unused:UNUSED_PRESERVE src0_sel:WORD_0
    v_mfma_f32_16x16x32_bf16 v[64:67], v[224:227], v[152:155], v[64:67]
    buffer_load_dwordx4 v[24:27], v244, s[8:11], s36 offen offset:256
    v_lshlrev_b32_sdwa v208, 1, v208 dst_sel:DWORD dst_unused:UNUSED_PAD src0_sel:DWORD src1_sel:WORD_1
    v_rcp_f16_sdwa v207, v207 dst_sel:WORD_0 dst_unused:UNUSED_PRESERVE src0_sel:WORD_0
    v_lshlrev_b32_sdwa v209, 1, v209 dst_sel:DWORD dst_unused:UNUSED_PAD src0_sel:DWORD src1_sel:WORD_1
    v_mfma_f32_16x16x32_bf16 v[72:75], v[224:227], v[156:159], v[72:75]
    ds_read_b64_tr_b16 v[224:225], v255 offset:59520
    buffer_load_dwordx4 v[28:31], v244, s[8:11], s37 offen offset:0
    v_or_b32 v161, v194, v195
    v_fma_mixlo_f16 v222, v222, s83, 0
    v_lshlrev_b32_sdwa v210, 1, v210 dst_sel:DWORD dst_unused:UNUSED_PAD src0_sel:DWORD src1_sel:WORD_1
    v_rcp_f16_sdwa v205, v205 dst_sel:WORD_1 dst_unused:UNUSED_PRESERVE src0_sel:WORD_1
    s_waitcnt lgkmcnt(11)
    v_mfma_f32_16x16x32_bf16 v[52:55], v[228:231], v[144:147], v[52:55]
    ds_read_b64_tr_b16 v[226:227], v255 offset:60288
    ds_read_u16_d16 v208, v208
    buffer_load_dwordx4 v[32:35], v244, s[8:11], s37 offen offset:128
    v_lshlrev_b32_sdwa v211, 1, v211 dst_sel:DWORD dst_unused:UNUSED_PAD src0_sel:DWORD src1_sel:WORD_1
    v_or_b32 v164, v196, v197
    v_rcp_f16_sdwa v207, v207 dst_sel:WORD_1 dst_unused:UNUSED_PRESERVE src0_sel:WORD_1
    v_mfma_f32_16x16x32_bf16 v[60:63], v[228:231], v[148:151], v[60:63]
    ds_read_u16_d16_hi v209, v209
    ds_read_u16_d16 v210, v210
    buffer_load_dwordx4 v[36:39], v244, s[8:11], s37 offen offset:256
    v_lshlrev_b32_sdwa v212, 1, v212 dst_sel:DWORD dst_unused:UNUSED_PAD src0_sel:DWORD src1_sel:WORD_1
    v_fma_mixhi_f16 v222, v223, s83, 0
    v_lshlrev_b32_sdwa v213, 1, v213 dst_sel:DWORD dst_unused:UNUSED_PAD src0_sel:DWORD src1_sel:WORD_1
    v_mfma_f32_16x16x32_bf16 v[68:71], v[228:231], v[152:155], v[68:71]
    ds_read_u16_d16_hi v211, v211
    buffer_load_dwordx4 v[40:43], v245, s[8:11], s36 offen offset:0
    v_fma_mix_f32 v172, v204, v205, 0 op_sel_hi:[1,1,0]
    s_waitcnt lgkmcnt(14)
    v_or_b32 v165, v198, v199
    v_fma_mix_f32 v173, v206, v207, 0 op_sel_hi:[1,1,0]
    v_lshlrev_b32_sdwa v214, 1, v214 dst_sel:DWORD dst_unused:UNUSED_PAD src0_sel:DWORD src1_sel:WORD_1
    v_mfma_f32_16x16x32_bf16 v[76:79], v[228:231], v[156:159], v[76:79]
    ds_read_b64_tr_b16 v[228:229], v255 offset:59528
    ds_read_b64_tr_b16 v[230:231], v255 offset:60296
    ds_read_u16_d16 v212, v212
    buffer_load_dwordx4 v[44:47], v245, s[8:11], s36 offen offset:128
    v_pk_fma_f16 v223, v222, v222, s84 neg_lo:[0,1,0] neg_hi:[0,1,0]
    v_lshlrev_b32_sdwa v215, 1, v215 dst_sel:DWORD dst_unused:UNUSED_PAD src0_sel:DWORD src1_sel:WORD_1
    v_fma_mix_f32 v205, v204, v205, 0 op_sel:[1,1,0] op_sel_hi:[1,1,0]
    s_waitcnt lgkmcnt(13)
    v_or_b32 v168, v200, v201
    v_mfma_f32_16x16x32_bf16 v[80:83], v[232:235], v[144:147], v[80:83]
    ds_read_u16_d16_hi v213, v213
    ds_read_u16_d16 v214, v214
    buffer_load_dwordx4 v[0:3], v245, s[8:11], s36 offen offset:256
    v_fma_mix_f32 v207, v206, v207, 0 op_sel:[1,1,0] op_sel_hi:[1,1,0]
    v_lshlrev_b32_sdwa v216, 1, v216 dst_sel:DWORD dst_unused:UNUSED_PAD src0_sel:DWORD src1_sel:WORD_1
    v_pk_mul_f16 v223, v223, v222
    v_cvt_pk_bf16_f32 v172, v172, v205
    v_mfma_f32_16x16x32_bf16 v[88:91], v[232:235], v[148:151], v[88:91]
    ds_read_u16_d16_hi v215, v215
    buffer_load_dwordx4 v[4:7], v245, s[8:11], s37 offen offset:0
    v_lshlrev_b32_sdwa v217, 1, v217 dst_sel:DWORD dst_unused:UNUSED_PAD src0_sel:DWORD src1_sel:WORD_1
    v_cvt_pk_bf16_f32 v173, v173, v207
    s_waitcnt lgkmcnt(12)
    v_or_b32 v169, v202, v203
    v_exp_f16_sdwa v223, v223 dst_sel:WORD_0 dst_unused:UNUSED_PRESERVE src0_sel:WORD_0
    v_mfma_f32_16x16x32_bf16 v[96:99], v[232:235], v[152:155], v[96:99]
    ds_read_u16_d16 v216, v216
    ds_read_u16_d16_hi v217, v217
    buffer_load_dwordx4 v[8:11], v245, s[8:11], s37 offen offset:128
    v_lshlrev_b32_sdwa v218, 1, v218 dst_sel:DWORD dst_unused:UNUSED_PAD src0_sel:DWORD src1_sel:WORD_1
    v_lshlrev_b32_sdwa v219, 1, v219 dst_sel:DWORD dst_unused:UNUSED_PAD src0_sel:DWORD src1_sel:WORD_1
    v_exp_f16_sdwa v223, v223 dst_sel:WORD_1 dst_unused:UNUSED_PRESERVE src0_sel:WORD_1
    v_mfma_f32_16x16x32_bf16 v[104:107], v[232:235], v[156:159], v[104:107]
    ds_read_b64_tr_b16 v[232:233], v255 offset:62464
    ds_read_b64_tr_b16 v[234:235], v255 offset:63232
    buffer_load_dwordx4 v[12:15], v245, s[8:11], s37 offen offset:256
    v_lshlrev_b32_sdwa v220, 1, v220 dst_sel:DWORD dst_unused:UNUSED_PAD src0_sel:DWORD src1_sel:WORD_1
    v_lshlrev_b32_sdwa v221, 1, v221 dst_sel:DWORD dst_unused:UNUSED_PAD src0_sel:DWORD src1_sel:WORD_1
    v_pk_fma_f16 v223, v223, s85, s85
    v_mfma_f32_16x16x32_bf16 v[84:87], v[236:239], v[144:147], v[84:87]
    ds_read_u16_d16 v218, v218
    s_waitcnt lgkmcnt(13)
    v_or_b32 v162, v208, v209
    v_mfma_f32_16x16x32_bf16 v[92:95], v[236:239], v[148:151], v[92:95]
    ds_read_u16_d16_hi v219, v219
    v_rcp_f16_sdwa v223, v223 dst_sel:WORD_0 dst_unused:UNUSED_PRESERVE src0_sel:WORD_0
    s_waitcnt lgkmcnt(12)
    v_or_b32 v163, v210, v211
    v_mfma_f32_16x16x32_bf16 v[100:103], v[236:239], v[152:155], v[100:103]
    ds_read_u16_d16 v220, v220
    v_bfe_u32 v244, v253, 4, 3
    v_mul_u32_u24 v244, 768, v244
    v_bfe_u32 v245, v253, 7, 1
    v_lshl_add_u32 v244, v245, 6, v244
    v_lshrrev_b32 v245, 8, v253
    v_lshl_add_u32 v244, v245, 4, v244
    v_add_u32 v244, s35, v244
    v_xor_b32 v245, 196608, v244
    v_mfma_f32_16x16x32_bf16 v[108:111], v[236:239], v[156:159], v[108:111]
    ds_read_b64_tr_b16 v[236:237], v255 offset:62472
    v_mfma_f32_16x16x32_bf16 v[112:115], v[224:227], v[144:147], v[112:115]
    ds_read_b64_tr_b16 v[238:239], v255 offset:63240
    v_mfma_f32_16x16x32_bf16 v[120:123], v[224:227], v[148:151], v[120:123]
    ds_read_u16_d16_hi v221, v221
    v_mfma_f32_16x16x32_bf16 v[128:131], v[224:227], v[152:155], v[128:131]
    s_waitcnt lgkmcnt(12)
    v_or_b32 v166, v212, v213
    v_mfma_f32_16x16x32_bf16 v[136:139], v[224:227], v[156:159], v[136:139]
    ds_read_b64_tr_b16 v[224:225], v255 offset:62528
    v_rcp_f16_sdwa v223, v223 dst_sel:WORD_1 dst_unused:UNUSED_PRESERVE src0_sel:WORD_1
    v_mfma_f32_16x16x32_bf16 v[116:119], v[228:231], v[144:147], v[116:119]
    ds_read_b64_tr_b16 v[226:227], v255 offset:63296
    s_waitcnt lgkmcnt(12)
    v_or_b32 v167, v214, v215
    s_waitcnt lgkmcnt(10)
    v_or_b32 v170, v216, v217
    v_mfma_f32_16x16x32_bf16 v[124:127], v[228:231], v[148:151], v[124:127]
    v_fma_mix_f32 v175, v222, v223, 0 op_sel_hi:[1,1,0]
    v_mfma_f32_16x16x32_bf16 v[132:135], v[228:231], v[152:155], v[132:135]
    s_waitcnt lgkmcnt(6)
    v_or_b32 v171, v218, v219
    v_fma_mix_f32 v223, v222, v223, 0 op_sel:[1,1,0] op_sel_hi:[1,1,0]
    v_mfma_f32_16x16x32_bf16 v[140:143], v[228:231], v[156:159], v[140:143]
    ds_read_b64_tr_b16 v[228:229], v255 offset:62536
    s_waitcnt lgkmcnt(3)
    v_or_b32 v174, v220, v221
    v_cvt_pk_bf16_f32 v175, v175, v223
    v_mfma_f32_16x16x32_bf16 v[48:51], v[232:235], v[160:163], v[48:51]
    ds_read_b64_tr_b16 v[230:231], v255 offset:63304
    v_mfma_f32_16x16x32_bf16 v[56:59], v[232:235], v[164:167], v[56:59]
    v_mfma_f32_16x16x32_bf16 v[64:67], v[232:235], v[168:171], v[64:67]
    v_mfma_f32_16x16x32_bf16 v[72:75], v[232:235], v[172:175], v[72:75]
    ds_read_b64_tr_b16 v[232:233], v255 offset:62592
    v_mfma_f32_16x16x32_bf16 v[52:55], v[236:239], v[160:163], v[52:55]
    ds_read_b64_tr_b16 v[234:235], v255 offset:63360
    v_mfma_f32_16x16x32_bf16 v[60:63], v[236:239], v[164:167], v[60:63]
    v_mfma_f32_16x16x32_bf16 v[68:71], v[236:239], v[168:171], v[68:71]
    v_mfma_f32_16x16x32_bf16 v[76:79], v[236:239], v[172:175], v[76:79]
    ds_read_b64_tr_b16 v[236:237], v255 offset:62600
    s_waitcnt lgkmcnt(5)
    v_mfma_f32_16x16x32_bf16 v[80:83], v[224:227], v[160:163], v[80:83]
    ds_read_b64_tr_b16 v[238:239], v255 offset:63368
    v_mfma_f32_16x16x32_bf16 v[88:91], v[224:227], v[164:167], v[88:91]
    v_mfma_f32_16x16x32_bf16 v[96:99], v[224:227], v[168:171], v[96:99]
    v_mfma_f32_16x16x32_bf16 v[104:107], v[224:227], v[172:175], v[104:107]
    s_waitcnt lgkmcnt(4)
    v_mfma_f32_16x16x32_bf16 v[84:87], v[228:231], v[160:163], v[84:87]
    v_cvt_pk_bf16_f32 v48, v48, v49
    v_cvt_pk_bf16_f32 v49, v50, v51
    v_cvt_pk_bf16_f32 v50, v52, v53
    v_cvt_pk_bf16_f32 v51, v54, v55
    v_mfma_f32_16x16x32_bf16 v[92:95], v[228:231], v[164:167], v[92:95]
    v_cvt_pk_bf16_f32 v56, v56, v57
    v_cvt_pk_bf16_f32 v57, v58, v59
    v_cvt_pk_bf16_f32 v58, v60, v61
    v_cvt_pk_bf16_f32 v59, v62, v63
    v_mfma_f32_16x16x32_bf16 v[100:103], v[228:231], v[168:171], v[100:103]
    v_cvt_pk_bf16_f32 v64, v64, v65
    v_cvt_pk_bf16_f32 v65, v66, v67
    v_cvt_pk_bf16_f32 v66, v68, v69
    v_cvt_pk_bf16_f32 v67, v70, v71
    v_mfma_f32_16x16x32_bf16 v[108:111], v[228:231], v[172:175], v[108:111]
    v_cvt_pk_bf16_f32 v72, v72, v73
    v_cvt_pk_bf16_f32 v73, v74, v75
    v_cvt_pk_bf16_f32 v74, v76, v77
    v_cvt_pk_bf16_f32 v75, v78, v79
    s_waitcnt lgkmcnt(2)
    v_mfma_f32_16x16x32_bf16 v[112:115], v[232:235], v[160:163], v[112:115]
    v_mfma_f32_16x16x32_bf16 v[120:123], v[232:235], v[164:167], v[120:123]
    v_mfma_f32_16x16x32_bf16 v[128:131], v[232:235], v[168:171], v[128:131]
    v_mfma_f32_16x16x32_bf16 v[136:139], v[232:235], v[172:175], v[136:139]
    s_waitcnt lgkmcnt(0)
    v_mfma_f32_16x16x32_bf16 v[116:119], v[236:239], v[160:163], v[116:119]
    v_cvt_pk_bf16_f32 v80, v80, v81
    v_cvt_pk_bf16_f32 v81, v82, v83
    v_cvt_pk_bf16_f32 v82, v84, v85
    v_cvt_pk_bf16_f32 v83, v86, v87
    v_mfma_f32_16x16x32_bf16 v[124:127], v[236:239], v[164:167], v[124:127]
    v_cvt_pk_bf16_f32 v88, v88, v89
    v_cvt_pk_bf16_f32 v89, v90, v91
    v_cvt_pk_bf16_f32 v90, v92, v93
    v_cvt_pk_bf16_f32 v91, v94, v95
    v_mfma_f32_16x16x32_bf16 v[132:135], v[236:239], v[168:171], v[132:135]
    v_cvt_pk_bf16_f32 v96, v96, v97
    v_cvt_pk_bf16_f32 v97, v98, v99
    v_cvt_pk_bf16_f32 v98, v100, v101
    v_cvt_pk_bf16_f32 v99, v102, v103
    v_mfma_f32_16x16x32_bf16 v[140:143], v[236:239], v[172:175], v[140:143]
    v_cvt_pk_bf16_f32 v104, v104, v105
    v_cvt_pk_bf16_f32 v105, v106, v107
    v_cvt_pk_bf16_f32 v106, v108, v109
    v_cvt_pk_bf16_f32 v107, v110, v111
    v_mov_b32 v52, v48
    v_mov_b32 v53, v49
    v_mov_b32 v54, v50
    v_mov_b32 v55, v51
    v_mov_b32_dpp v48, v80 row_ror:8 row_mask:0xf bank_mask:0xc
    v_mov_b32_dpp v49, v81 row_ror:8 row_mask:0xf bank_mask:0xc
    v_mov_b32_dpp v50, v82 row_ror:8 row_mask:0xf bank_mask:0xc
    v_mov_b32_dpp v51, v83 row_ror:8 row_mask:0xf bank_mask:0xc
    v_mov_b32_dpp v80, v52 row_ror:8 row_mask:0xf bank_mask:0x3
    v_mov_b32_dpp v81, v53 row_ror:8 row_mask:0xf bank_mask:0x3
    v_mov_b32_dpp v82, v54 row_ror:8 row_mask:0xf bank_mask:0x3
    v_mov_b32_dpp v83, v55 row_ror:8 row_mask:0xf bank_mask:0x3
    buffer_store_dwordx4 v[48:51], v244, s[8:11], s24 offen offset:0 sc1
    buffer_store_dwordx4 v[80:83], v245, s[8:11], s24 offen offset:0 sc1
    v_mov_b32 v68, v64
    v_mov_b32 v69, v65
    v_mov_b32 v70, v66
    v_mov_b32 v71, v67
    v_mov_b32_dpp v64, v96 row_ror:8 row_mask:0xf bank_mask:0xc
    v_mov_b32_dpp v65, v97 row_ror:8 row_mask:0xf bank_mask:0xc
    v_mov_b32_dpp v66, v98 row_ror:8 row_mask:0xf bank_mask:0xc
    v_mov_b32_dpp v67, v99 row_ror:8 row_mask:0xf bank_mask:0xc
    v_mov_b32_dpp v96, v68 row_ror:8 row_mask:0xf bank_mask:0x3
    v_mov_b32_dpp v97, v69 row_ror:8 row_mask:0xf bank_mask:0x3
    v_mov_b32_dpp v98, v70 row_ror:8 row_mask:0xf bank_mask:0x3
    v_mov_b32_dpp v99, v71 row_ror:8 row_mask:0xf bank_mask:0x3
    buffer_store_dwordx4 v[64:67], v244, s[8:11], s25 offen offset:0 sc1
    buffer_store_dwordx4 v[96:99], v245, s[8:11], s25 offen offset:0 sc1
    v_cvt_pk_bf16_f32 v112, v112, v113
    v_cvt_pk_bf16_f32 v113, v114, v115
    v_cvt_pk_bf16_f32 v114, v116, v117
    v_cvt_pk_bf16_f32 v115, v118, v119
    v_cvt_pk_bf16_f32 v120, v120, v121
    v_cvt_pk_bf16_f32 v121, v122, v123
    v_cvt_pk_bf16_f32 v122, v124, v125
    v_cvt_pk_bf16_f32 v123, v126, v127
    v_mov_b32 v116, v112
    v_mov_b32 v117, v113
    v_mov_b32 v118, v114
    v_mov_b32 v119, v115
    v_mov_b32_dpp v112, v56 row_ror:8 row_mask:0xf bank_mask:0xc
    v_mov_b32_dpp v113, v57 row_ror:8 row_mask:0xf bank_mask:0xc
    v_mov_b32_dpp v114, v58 row_ror:8 row_mask:0xf bank_mask:0xc
    v_mov_b32_dpp v115, v59 row_ror:8 row_mask:0xf bank_mask:0xc
    v_mov_b32_dpp v56, v116 row_ror:8 row_mask:0xf bank_mask:0x3
    v_mov_b32_dpp v57, v117 row_ror:8 row_mask:0xf bank_mask:0x3
    v_mov_b32_dpp v58, v118 row_ror:8 row_mask:0xf bank_mask:0x3
    v_mov_b32_dpp v59, v119 row_ror:8 row_mask:0xf bank_mask:0x3
    buffer_store_dwordx4 v[112:115], v244, s[8:11], s24 offen offset:128 sc1
    buffer_store_dwordx4 v[56:59], v245, s[8:11], s24 offen offset:128 sc1
    v_mov_b32 v92, v88
    v_mov_b32 v93, v89
    v_mov_b32 v94, v90
    v_mov_b32 v95, v91
    v_mov_b32_dpp v88, v120 row_ror:8 row_mask:0xf bank_mask:0xc
    v_mov_b32_dpp v89, v121 row_ror:8 row_mask:0xf bank_mask:0xc
    v_mov_b32_dpp v90, v122 row_ror:8 row_mask:0xf bank_mask:0xc
    v_mov_b32_dpp v91, v123 row_ror:8 row_mask:0xf bank_mask:0xc
    v_mov_b32_dpp v120, v92 row_ror:8 row_mask:0xf bank_mask:0x3
    v_mov_b32_dpp v121, v93 row_ror:8 row_mask:0xf bank_mask:0x3
    v_mov_b32_dpp v122, v94 row_ror:8 row_mask:0xf bank_mask:0x3
    v_mov_b32_dpp v123, v95 row_ror:8 row_mask:0xf bank_mask:0x3
    buffer_store_dwordx4 v[88:91], v244, s[8:11], s24 offen offset:256 sc1
    buffer_store_dwordx4 v[120:123], v245, s[8:11], s24 offen offset:256 sc1
    v_cvt_pk_bf16_f32 v128, v128, v129
    v_cvt_pk_bf16_f32 v129, v130, v131
    v_cvt_pk_bf16_f32 v130, v132, v133
    v_cvt_pk_bf16_f32 v131, v134, v135
    v_cvt_pk_bf16_f32 v136, v136, v137
    v_cvt_pk_bf16_f32 v137, v138, v139
    v_cvt_pk_bf16_f32 v138, v140, v141
    v_cvt_pk_bf16_f32 v139, v142, v143
    v_mov_b32 v132, v128
    v_mov_b32 v133, v129
    v_mov_b32 v134, v130
    v_mov_b32 v135, v131
    v_mov_b32_dpp v128, v72 row_ror:8 row_mask:0xf bank_mask:0xc
    v_mov_b32_dpp v129, v73 row_ror:8 row_mask:0xf bank_mask:0xc
    v_mov_b32_dpp v130, v74 row_ror:8 row_mask:0xf bank_mask:0xc
    v_mov_b32_dpp v131, v75 row_ror:8 row_mask:0xf bank_mask:0xc
    v_mov_b32_dpp v72, v132 row_ror:8 row_mask:0xf bank_mask:0x3
    v_mov_b32_dpp v73, v133 row_ror:8 row_mask:0xf bank_mask:0x3
    v_mov_b32_dpp v74, v134 row_ror:8 row_mask:0xf bank_mask:0x3
    v_mov_b32_dpp v75, v135 row_ror:8 row_mask:0xf bank_mask:0x3
    buffer_store_dwordx4 v[128:131], v244, s[8:11], s25 offen offset:128 sc1
    buffer_store_dwordx4 v[72:75], v245, s[8:11], s25 offen offset:128 sc1
    v_mov_b32 v108, v104
    v_mov_b32 v109, v105
    v_mov_b32 v110, v106
    v_mov_b32 v111, v107
    v_mov_b32_dpp v104, v136 row_ror:8 row_mask:0xf bank_mask:0xc
    v_mov_b32_dpp v105, v137 row_ror:8 row_mask:0xf bank_mask:0xc
    v_mov_b32_dpp v106, v138 row_ror:8 row_mask:0xf bank_mask:0xc
    v_mov_b32_dpp v107, v139 row_ror:8 row_mask:0xf bank_mask:0xc
    v_mov_b32_dpp v136, v108 row_ror:8 row_mask:0xf bank_mask:0x3
    v_mov_b32_dpp v137, v109 row_ror:8 row_mask:0xf bank_mask:0x3
    v_mov_b32_dpp v138, v110 row_ror:8 row_mask:0xf bank_mask:0x3
    v_mov_b32_dpp v139, v111 row_ror:8 row_mask:0xf bank_mask:0x3
    buffer_store_dwordx4 v[104:107], v244, s[8:11], s25 offen offset:256 sc1
    buffer_store_dwordx4 v[136:139], v245, s[8:11], s25 offen offset:256 sc1

    s_cmp_lg_u32 s17, 0
    s_cbranch_scc1 L_end
    s_mov_b32 s17, 1
    s_mov_b32 s24, s36
    s_mov_b32 s25, s37
    s_mov_b32 s36, 1073741824
    s_mov_b32 s37, 1073741824

    s_branch L_mtile

L_rd1_slow:
    v_mov_b32 v224, 161976

    s_mov_b32 s29, 200000
L_rd1:
    ds_read_b32 v225, v224
    s_waitcnt lgkmcnt(0)
    v_cmp_le_u32 vcc, 1, v225
    s_cmp_eq_u64 vcc, exec
    s_cbranch_scc1 L_rd1_ok
    s_sleep 2
    s_sub_u32 s29, s29, 1
    s_cmp_lg_u32 s29, 0
    s_cbranch_scc1 L_rd1
L_rd1_ok:

    v_readfirstlane_b32 s19, v225
    s_min_u32 s19, s19, 24
    s_branch L_rd1_go
L_fix:
    v_lshlrev_b32 v176, 16, v0
    v_and_b32 v177, 0xffff0000, v0
    v_mul_f32 v176, s99, v176
    v_mul_f32 v177, s99, v177
    v_cvt_pk_bf16_f32 v0, v176, v177
    v_lshlrev_b32 v176, 16, v1
    v_and_b32 v177, 0xffff0000, v1
    v_mul_f32 v176, s99, v176
    v_mul_f32 v177, s99, v177
    v_cvt_pk_bf16_f32 v1, v176, v177
    v_lshlrev_b32 v176, 16, v2
    v_and_b32 v177, 0xffff0000, v2
    v_mul_f32 v176, s99, v176
    v_mul_f32 v177, s99, v177
    v_cvt_pk_bf16_f32 v2, v176, v177
    v_lshlrev_b32 v176, 16, v3
    v_and_b32 v177, 0xffff0000, v3
    v_mul_f32 v176, s99, v176
    v_mul_f32 v177, s99, v177
    v_cvt_pk_bf16_f32 v3, v176, v177
    v_lshlrev_b32 v176, 16, v4
    v_and_b32 v177, 0xffff0000, v4
    v_mul_f32 v176, s99, v176
    v_mul_f32 v177, s99, v177
    v_cvt_pk_bf16_f32 v4, v176, v177
    v_lshlrev_b32 v176, 16, v5
    v_and_b32 v177, 0xffff0000, v5
    v_mul_f32 v176, s99, v176
    v_mul_f32 v177, s99, v177
    v_cvt_pk_bf16_f32 v5, v176, v177
    v_lshlrev_b32 v176, 16, v6
    v_and_b32 v177, 0xffff0000, v6
    v_mul_f32 v176, s99, v176
    v_mul_f32 v177, s99, v177
    v_cvt_pk_bf16_f32 v6, v176, v177
    v_lshlrev_b32 v176, 16, v7
    v_and_b32 v177, 0xffff0000, v7
    v_mul_f32 v176, s99, v176
    v_mul_f32 v177, s99, v177
    v_cvt_pk_bf16_f32 v7, v176, v177
    v_lshlrev_b32 v176, 16, v8
    v_and_b32 v177, 0xffff0000, v8
    v_mul_f32 v176, s99, v176
    v_mul_f32 v177, s99, v177
    v_cvt_pk_bf16_f32 v8, v176, v177
    v_lshlrev_b32 v176, 16, v9
    v_and_b32 v177, 0xffff0000, v9
    v_mul_f32 v176, s99, v176
    v_mul_f32 v177, s99, v177
    v_cvt_pk_bf16_f32 v9, v176, v177
    v_lshlrev_b32 v176, 16, v10
    v_and_b32 v177, 0xffff0000, v10
    v_mul_f32 v176, s99, v176
    v_mul_f32 v177, s99, v177
    v_cvt_pk_bf16_f32 v10, v176, v177
    v_lshlrev_b32 v176, 16, v11
    v_and_b32 v177, 0xffff0000, v11
    v_mul_f32 v176, s99, v176
    v_mul_f32 v177, s99, v177
    v_cvt_pk_bf16_f32 v11, v176, v177
    v_lshlrev_b32 v176, 16, v12
    v_and_b32 v177, 0xffff0000, v12
    v_mul_f32 v176, s99, v176
    v_mul_f32 v177, s99, v177
    v_cvt_pk_bf16_f32 v12, v176, v177
    v_lshlrev_b32 v176, 16, v13
    v_and_b32 v177, 0xffff0000, v13
    v_mul_f32 v176, s99, v176
    v_mul_f32 v177, s99, v177
    v_cvt_pk_bf16_f32 v13, v176, v177
    v_lshlrev_b32 v176, 16, v14
    v_and_b32 v177, 0xffff0000, v14
    v_mul_f32 v176, s99, v176
    v_mul_f32 v177, s99, v177
    v_cvt_pk_bf16_f32 v14, v176, v177
    v_lshlrev_b32 v176, 16, v15
    v_and_b32 v177, 0xffff0000, v15
    v_mul_f32 v176, s99, v176
    v_mul_f32 v177, s99, v177
    v_cvt_pk_bf16_f32 v15, v176, v177
    v_lshlrev_b32 v176, 16, v16
    v_and_b32 v177, 0xffff0000, v16
    v_mul_f32 v176, s99, v176
    v_mul_f32 v177, s99, v177
    v_cvt_pk_bf16_f32 v16, v176, v177
    v_lshlrev_b32 v176, 16, v17
    v_and_b32 v177, 0xffff0000, v17
    v_mul_f32 v176, s99, v176
    v_mul_f32 v177, s99, v177
    v_cvt_pk_bf16_f32 v17, v176, v177
    v_lshlrev_b32 v176, 16, v18
    v_and_b32 v177, 0xffff0000, v18
    v_mul_f32 v176, s99, v176
    v_mul_f32 v177, s99, v177
    v_cvt_pk_bf16_f32 v18, v176, v177
    v_lshlrev_b32 v176, 16, v19
    v_and_b32 v177, 0xffff0000, v19
    v_mul_f32 v176, s99, v176
    v_mul_f32 v177, s99, v177
    v_cvt_pk_bf16_f32 v19, v176, v177
    v_lshlrev_b32 v176, 16, v20
    v_and_b32 v177, 0xffff0000, v20
    v_mul_f32 v176, s99, v176
    v_mul_f32 v177, s99, v177
    v_cvt_pk_bf16_f32 v20, v176, v177
    v_lshlrev_b32 v176, 16, v21
    v_and_b32 v177, 0xffff0000, v21
    v_mul_f32 v176, s99, v176
    v_mul_f32 v177, s99, v177
    v_cvt_pk_bf16_f32 v21, v176, v177
    v_lshlrev_b32 v176, 16, v22
    v_and_b32 v177, 0xffff0000, v22
    v_mul_f32 v176, s99, v176
    v_mul_f32 v177, s99, v177
    v_cvt_pk_bf16_f32 v22, v176, v177
    v_lshlrev_b32 v176, 16, v23
    v_and_b32 v177, 0xffff0000, v23
    v_mul_f32 v176, s99, v176
    v_mul_f32 v177, s99, v177
    v_cvt_pk_bf16_f32 v23, v176, v177
    v_lshlrev_b32 v176, 16, v24
    v_and_b32 v177, 0xffff0000, v24
    v_mul_f32 v176, s99, v176
    v_mul_f32 v177, s99, v177
    v_cvt_pk_bf16_f32 v24, v176, v177
    v_lshlrev_b32 v176, 16, v25
    v_and_b32 v177, 0xffff0000, v25
    v_mul_f32 v176, s99, v176
    v_mul_f32 v177, s99, v177
    v_cvt_pk_bf16_f32 v25, v176, v177
    v_lshlrev_b32 v176, 16, v26
    v_and_b32 v177, 0xffff0000, v26
    v_mul_f32 v176, s99, v176
    v_mul_f32 v177, s99, v177
    v_cvt_pk_bf16_f32 v26, v176, v177
    v_lshlrev_b32 v176, 16, v27
    v_and_b32 v177, 0xffff0000, v27
    v_mul_f32 v176, s99, v176
    v_mul_f32 v177, s99, v177
    v_cvt_pk_bf16_f32 v27, v176, v177
    v_lshlrev_b32 v176, 16, v28
    v_and_b32 v177, 0xffff0000, v28
    v_mul_f32 v176, s99, v176
    v_mul_f32 v177, s99, v177
    v_cvt_pk_bf16_f32 v28, v176, v177
    v_lshlrev_b32 v176, 16, v29
    v_and_b32 v177, 0xffff0000, v29
    v_mul_f32 v176, s99, v176
    v_mul_f32 v177, s99, v177
    v_cvt_pk_bf16_f32 v29, v176, v177
    v_lshlrev_b32 v176, 16, v30
    v_and_b32 v177, 0xffff0000, v30
    v_mul_f32 v176, s99, v176
    v_mul_f32 v177, s99, v177
    v_cvt_pk_bf16_f32 v30, v176, v177
    v_lshlrev_b32 v176, 16, v31
    v_and_b32 v177, 0xffff0000, v31
    v_mul_f32 v176, s99, v176
    v_mul_f32 v177, s99, v177
    v_cvt_pk_bf16_f32 v31, v176, v177
    v_lshlrev_b32 v176, 16, v32
    v_and_b32 v177, 0xffff0000, v32
    v_mul_f32 v176, s99, v176
    v_mul_f32 v177, s99, v177
    v_cvt_pk_bf16_f32 v32, v176, v177
    v_lshlrev_b32 v176, 16, v33
    v_and_b32 v177, 0xffff0000, v33
    v_mul_f32 v176, s99, v176
    v_mul_f32 v177, s99, v177
    v_cvt_pk_bf16_f32 v33, v176, v177
    v_lshlrev_b32 v176, 16, v34
    v_and_b32 v177, 0xffff0000, v34
    v_mul_f32 v176, s99, v176
    v_mul_f32 v177, s99, v177
    v_cvt_pk_bf16_f32 v34, v176, v177
    v_lshlrev_b32 v176, 16, v35
    v_and_b32 v177, 0xffff0000, v35
    v_mul_f32 v176, s99, v176
    v_mul_f32 v177, s99, v177
    v_cvt_pk_bf16_f32 v35, v176, v177
    v_lshlrev_b32 v176, 16, v36
    v_and_b32 v177, 0xffff0000, v36
    v_mul_f32 v176, s99, v176
    v_mul_f32 v177, s99, v177
    v_cvt_pk_bf16_f32 v36, v176, v177
    v_lshlrev_b32 v176, 16, v37
    v_and_b32 v177, 0xffff0000, v37
    v_mul_f32 v176, s99, v176
    v_mul_f32 v177, s99, v177
    v_cvt_pk_bf16_f32 v37, v176, v177
    v_lshlrev_b32 v176, 16, v38
    v_and_b32 v177, 0xffff0000, v38
    v_mul_f32 v176, s99, v176
    v_mul_f32 v177, s99, v177
    v_cvt_pk_bf16_f32 v38, v176, v177
    v_lshlrev_b32 v176, 16, v39
    v_and_b32 v177, 0xffff0000, v39
    v_mul_f32 v176, s99, v176
    v_mul_f32 v177, s99, v177
    v_cvt_pk_bf16_f32 v39, v176, v177
    v_lshlrev_b32 v176, 16, v40
    v_and_b32 v177, 0xffff0000, v40
    v_mul_f32 v176, s99, v176
    v_mul_f32 v177, s99, v177
    v_cvt_pk_bf16_f32 v40, v176, v177
    v_lshlrev_b32 v176, 16, v41
    v_and_b32 v177, 0xffff0000, v41
    v_mul_f32 v176, s99, v176
    v_mul_f32 v177, s99, v177
    v_cvt_pk_bf16_f32 v41, v176, v177
    v_lshlrev_b32 v176, 16, v42
    v_and_b32 v177, 0xffff0000, v42
    v_mul_f32 v176, s99, v176
    v_mul_f32 v177, s99, v177
    v_cvt_pk_bf16_f32 v42, v176, v177
    v_lshlrev_b32 v176, 16, v43
    v_and_b32 v177, 0xffff0000, v43
    v_mul_f32 v176, s99, v176
    v_mul_f32 v177, s99, v177
    v_cvt_pk_bf16_f32 v43, v176, v177
    v_lshlrev_b32 v176, 16, v44
    v_and_b32 v177, 0xffff0000, v44
    v_mul_f32 v176, s99, v176
    v_mul_f32 v177, s99, v177
    v_cvt_pk_bf16_f32 v44, v176, v177
    v_lshlrev_b32 v176, 16, v45
    v_and_b32 v177, 0xffff0000, v45
    v_mul_f32 v176, s99, v176
    v_mul_f32 v177, s99, v177
    v_cvt_pk_bf16_f32 v45, v176, v177
    v_lshlrev_b32 v176, 16, v46
    v_and_b32 v177, 0xffff0000, v46
    v_mul_f32 v176, s99, v176
    v_mul_f32 v177, s99, v177
    v_cvt_pk_bf16_f32 v46, v176, v177
    v_lshlrev_b32 v176, 16, v47
    v_and_b32 v177, 0xffff0000, v47
    v_mul_f32 v176, s99, v176
    v_mul_f32 v177, s99, v177
    v_cvt_pk_bf16_f32 v47, v176, v177
    s_nop 1
    s_branch L_fixed
L_rd2_slow:
    v_mov_b32 v232, 161976

    s_mov_b32 s29, 200000
L_rd2:
    ds_read_b32 v233, v232
    s_waitcnt lgkmcnt(0)
    v_cmp_le_u32 vcc, 2, v233
    s_cmp_eq_u64 vcc, exec
    s_cbranch_scc1 L_rd2_ok
    s_sleep 2
    s_sub_u32 s29, s29, 1
    s_cmp_lg_u32 s29, 0
    s_cbranch_scc1 L_rd2
L_rd2_ok:

    v_readfirstlane_b32 s19, v233
    s_min_u32 s19, s19, 24
    s_branch L_rd2_go
L_rd3_slow:
    v_mov_b32 v224, 161976

    s_mov_b32 s29, 200000
L_rd3:
    ds_read_b32 v225, v224
    s_waitcnt lgkmcnt(0)
    v_cmp_le_u32 vcc, 3, v225
    s_cmp_eq_u64 vcc, exec
    s_cbranch_scc1 L_rd3_ok
    s_sleep 2
    s_sub_u32 s29, s29, 1
    s_cmp_lg_u32 s29, 0
    s_cbranch_scc1 L_rd3
L_rd3_ok:

    v_readfirstlane_b32 s19, v225
    s_min_u32 s19, s19, 24
    s_branch L_rd3_go
L_rd4_slow:
    v_mov_b32 v228, 161976

    s_mov_b32 s29, 200000
L_rd4:
    ds_read_b32 v229, v228
    s_waitcnt lgkmcnt(0)
    v_cmp_le_u32 vcc, 4, v229
    s_cmp_eq_u64 vcc, exec
    s_cbranch_scc1 L_rd4_ok
    s_sleep 2
    s_sub_u32 s29, s29, 1
    s_cmp_lg_u32 s29, 0
    s_cbranch_scc1 L_rd4
L_rd4_ok:

    v_readfirstlane_b32 s19, v229
    s_min_u32 s19, s19, 24
    s_branch L_rd4_go
L_park:
    v_mov_b32 v244, 161972

    s_mov_b32 s29, 200000
L_wi9:
    ds_read_b32 v245, v244
    s_waitcnt lgkmcnt(0)
    v_cmp_eq_u32 vcc, 9, v245
    s_cmp_eq_u64 vcc, exec
    s_cbranch_scc1 L_wi9_ok
    s_sleep 2
    s_sub_u32 s29, s29, 1
    s_cmp_lg_u32 s29, 0
    s_cbranch_scc1 L_wi9
L_wi9_ok:

    v_lshrrev_b32 v244, 7, v253
    v_mul_u32_u24 v244, 640, v244
    v_add_u32 v244, v244, v253
    v_add_u32 v245, 196608, v244
    buffer_store_dwordx4 v[48:51], v244, s[8:11], s36 offen offset:0 sc1
    buffer_store_dwordx4 v[52:55], v244, s[8:11], s36 offen offset:128 sc1
    buffer_store_dwordx4 v[56:59], v244, s[8:11], s36 offen offset:256 sc1
    buffer_store_dwordx4 v[60:63], v244, s[8:11], s37 offen offset:0 sc1
    buffer_store_dwordx4 v[64:67], v244, s[8:11], s37 offen offset:128 sc1
    buffer_store_dwordx4 v[68:71], v244, s[8:11], s37 offen offset:256 sc1
    buffer_store_dwordx4 v[72:75], v245, s[8:11], s36 offen offset:0 sc1
    buffer_store_dwordx4 v[76:79], v245, s[8:11], s36 offen offset:128 sc1
    buffer_store_dwordx4 v[80:83], v245, s[8:11], s36 offen offset:256 sc1
    buffer_store_dwordx4 v[84:87], v245, s[8:11], s37 offen offset:0 sc1
    buffer_store_dwordx4 v[88:91], v245, s[8:11], s37 offen offset:128 sc1
    buffer_store_dwordx4 v[92:95], v245, s[8:11], s37 offen offset:256 sc1
    s_mov_b32 s38, 0
    s_nop 1
    s_branch L_parked
L_rd6_slow:
    v_mov_b32 v224, 161976

    s_mov_b32 s29, 200000
L_rd6:
    ds_read_b32 v225, v224
    s_waitcnt lgkmcnt(0)
    v_cmp_le_u32 vcc, 6, v225
    s_cmp_eq_u64 vcc, exec
    s_cbranch_scc1 L_rd6_ok
    s_sleep 2
    s_sub_u32 s29, s29, 1
    s_cmp_lg_u32 s29, 0
    s_cbranch_scc1 L_rd6
L_rd6_ok:

    v_readfirstlane_b32 s19, v225
    s_min_u32 s19, s19, 24
    s_branch L_rd6_go
L_rd8_slow:
    v_mov_b32 v224, 161976

    s_mov_b32 s29, 200000
L_rd8:
    ds_read_b32 v225, v224
    s_waitcnt lgkmcnt(0)
    v_cmp_le_u32 vcc, 8, v225
    s_cmp_eq_u64 vcc, exec
    s_cbranch_scc1 L_rd8_ok
    s_sleep 2
    s_sub_u32 s29, s29, 1
    s_cmp_lg_u32 s29, 0
    s_cbranch_scc1 L_rd8
L_rd8_ok:

    v_readfirstlane_b32 s19, v225
    s_min_u32 s19, s19, 24
    s_branch L_rd8_go
L_rd10_slow:
    v_mov_b32 v224, 161976

    s_mov_b32 s29, 200000
L_rd10:
    ds_read_b32 v225, v224
    s_waitcnt lgkmcnt(0)
    v_cmp_le_u32 vcc, 10, v225
    s_cmp_eq_u64 vcc, exec
    s_cbranch_scc1 L_rd10_ok
    s_sleep 2
    s_sub_u32 s29, s29, 1
    s_cmp_lg_u32 s29, 0
    s_cbranch_scc1 L_rd10
L_rd10_ok:

    v_readfirstlane_b32 s19, v225
    s_min_u32 s19, s19, 24
    s_branch L_rd10_go
L_rd12_slow:
    v_mov_b32 v224, 161976

    s_mov_b32 s29, 200000
L_rd12:
    ds_read_b32 v225, v224
    s_waitcnt lgkmcnt(0)
    v_cmp_le_u32 vcc, 12, v225
    s_cmp_eq_u64 vcc, exec
    s_cbranch_scc1 L_rd12_ok
    s_sleep 2
    s_sub_u32 s29, s29, 1
    s_cmp_lg_u32 s29, 0
    s_cbranch_scc1 L_rd12
L_rd12_ok:

    v_readfirstlane_b32 s19, v225
    s_min_u32 s19, s19, 24
    s_branch L_rd12_go
L_pu2:
    s_setprio 0
    s_branch L_pb2
L_rd14_slow:
    v_mov_b32 v224, 161976

    s_mov_b32 s29, 200000
L_rd14:
    ds_read_b32 v225, v224
    s_waitcnt lgkmcnt(0)
    v_cmp_le_u32 vcc, 14, v225
    s_cmp_eq_u64 vcc, exec
    s_cbranch_scc1 L_rd14_ok
    s_sleep 2
    s_sub_u32 s29, s29, 1
    s_cmp_lg_u32 s29, 0
    s_cbranch_scc1 L_rd14
L_rd14_ok:

    v_readfirstlane_b32 s19, v225
    s_min_u32 s19, s19, 24
    s_branch L_rd14_go
L_rd16_slow:
    v_mov_b32 v224, 161976

    s_mov_b32 s29, 200000
L_rd16:
    ds_read_b32 v225, v224
    s_waitcnt lgkmcnt(0)
    v_cmp_le_u32 vcc, 16, v225
    s_cmp_eq_u64 vcc, exec
    s_cbranch_scc1 L_rd16_ok
    s_sleep 2
    s_sub_u32 s29, s29, 1
    s_cmp_lg_u32 s29, 0
    s_cbranch_scc1 L_rd16
L_rd16_ok:

    v_readfirstlane_b32 s19, v225
    s_min_u32 s19, s19, 24
    s_branch L_rd16_go
L_rd18_slow:
    v_mov_b32 v224, 161976

    s_mov_b32 s29, 200000
L_rd18:
    ds_read_b32 v225, v224
    s_waitcnt lgkmcnt(0)
    v_cmp_le_u32 vcc, 18, v225
    s_cmp_eq_u64 vcc, exec
    s_cbranch_scc1 L_rd18_ok
    s_sleep 2
    s_sub_u32 s29, s29, 1
    s_cmp_lg_u32 s29, 0
    s_cbranch_scc1 L_rd18
L_rd18_ok:

    v_readfirstlane_b32 s19, v225
    s_min_u32 s19, s19, 24
    s_branch L_rd18_go
L_rd20_slow:
    v_mov_b32 v224, 161976

    s_mov_b32 s29, 200000
L_rd20:
    ds_read_b32 v225, v224
    s_waitcnt lgkmcnt(0)
    v_cmp_le_u32 vcc, 20, v225
    s_cmp_eq_u64 vcc, exec
    s_cbranch_scc1 L_rd20_ok
    s_sleep 2
    s_sub_u32 s29, s29, 1
    s_cmp_lg_u32 s29, 0
    s_cbranch_scc1 L_rd20
L_rd20_ok:

    v_readfirstlane_b32 s19, v225
    s_min_u32 s19, s19, 24
    s_branch L_rd20_go
L_rd22_slow:
    v_mov_b32 v224, 161976

    s_mov_b32 s29, 200000
L_rd22:
    ds_read_b32 v225, v224
    s_waitcnt lgkmcnt(0)
    v_cmp_le_u32 vcc, 22, v225
    s_cmp_eq_u64 vcc, exec
    s_cbranch_scc1 L_rd22_ok
    s_sleep 2
    s_sub_u32 s29, s29, 1
    s_cmp_lg_u32 s29, 0
    s_cbranch_scc1 L_rd22
L_rd22_ok:

    v_readfirstlane_b32 s19, v225
    s_min_u32 s19, s19, 24
    s_branch L_rd22_go
L_rd25_slow:
    v_mov_b32 v224, 161976

    s_mov_b32 s29, 200000
L_rd25:
    ds_read_b32 v225, v224
    s_waitcnt lgkmcnt(0)
    v_cmp_le_u32 vcc, 25, v225
    s_cmp_eq_u64 vcc, exec
    s_cbranch_scc1 L_rd25_ok
    s_sleep 2
    s_sub_u32 s29, s29, 1
    s_cmp_lg_u32 s29, 0
    s_cbranch_scc1 L_rd25
L_rd25_ok:

    v_readfirstlane_b32 s19, v225

    s_cmp_lt_u32 s19, 256
    s_cbranch_scc1 L_rd25_go
    s_lshl_b32 s98, s19, 15
    s_cmp_eq_u32 s98, 931135488
    s_cbranch_scc1 L_rd25_go
    s_waitcnt vmcnt(0) lgkmcnt(0)
    s_nop 7
    s_barrier
    s_cmp_lt_u32 s16, 6
    s_cbranch_scc1 L_notab

    s_add_u32 s28, s98, 8388608
    s_and_b32 s26, s16, 1
    s_lshl_b32 s26, s26, 6
    v_lshrrev_b32 v49, 4, v253
    v_add_u32 v49, s26, v49
    v_lshlrev_b32 v50, 2, v49
    v_add_u32 v51, 65536, v50
    v_lshlrev_b32 v52, 17, v49
    v_or_b32 v52, 0x8000, v52
    v_cmp_gt_u32 vcc, 64, v49
    v_mov_b32 v53, s98
    v_mov_b32 v54, s28
    v_cndmask_b32 v53, v53, v54, vcc
    v_cndmask_b32 v54, 0, v54, vcc
    v_add_u32 v52, v52, v53
    v_mov_b32 v53, 0x1000000
    v_mov_b32 v55, 0x800000
    v_cndmask_b32 v53, v53, v55, vcc
    s_mov_b32 s26, 0x3dd2d3e8
    v_mov_b32 v55, 0x40135761
    s_mov_b32 s27, 14
L_tablb:
    v_add_u32 v57, 0x10000, v52
    v_sub_f32 v56, v52, v54
    v_sub_f32 v57, v57, v54
    v_mul_f32 v58, v56, v56
    v_mul_f32 v59, v57, v57
    v_fma_f32 v58, v58, s26, v55
    v_fma_f32 v59, v59, s26, v55
    v_mul_f32 v58, v58, v56
    v_mul_f32 v59, v59, v57
    v_exp_f32 v58, -v58
    v_exp_f32 v59, -v59
    s_nop 0
    v_add_f32 v60, 1.0, v58
    v_add_f32 v61, 1.0, v59
    v_rcp_f32 v60, v60
    v_rcp_f32 v61, v61
    s_nop 0
    v_mul_f32 v56, v56, v60
    v_mul_f32 v57, v57, v61
    v_mul_f32 v58, -v56, v58
    v_mul_f32 v59, -v57, v59
    v_cvt_pk_bf16_f32 v60, v56, v57
    v_cvt_pk_bf16_f32 v61, v58, v59
    ds_write_b32 v50, v60
    ds_write_b32 v51, v61
    v_add_u32 v52, v52, v53
    v_mov_b32 v53, 0x1000000
    v_mov_b32 v54, 0
    v_add_u32 v50, 512, v50
    v_add_u32 v51, 512, v51
    s_sub_u32 s27, s27, 1
    s_cmp_lg_u32 s27, 0
    s_cbranch_scc1 L_tablb
    v_mov_b32 v51, 65536
    ds_write_b16 v54, v54
    ds_write_b16 v51, v54

L_notab:
    s_add_u32 s83, s98, 0x3eefde6e
    s_sub_u32 s99, 1996488704, s98
    s_waitcnt lgkmcnt(0)
    s_barrier
    s_branch L_mtile

L_end:
    s_endpgm

.section .rodata,"a"

.p2align 6
.amdhsa_kernel standalone__modern_conv_block_replknet__vision_kernel
.amdhsa_next_free_vgpr 256
.amdhsa_next_free_sgpr 100
.amdhsa_accum_offset 256
.amdhsa_group_segment_fixed_size 0
.amdhsa_kernarg_size 64
.amdhsa_user_sgpr_count 2
.amdhsa_user_sgpr_kernarg_segment_ptr 1
.amdhsa_system_sgpr_workgroup_id_x 1
.amdhsa_float_denorm_mode_32 3
.end_amdhsa_kernel
```

```asm
; @launch grid=(256,1,1) block=(512,1,1) lds=162320
.amdgcn_target "amdgcn-amd-amdhsa--gfx950"
.text

.globl standalone__modern_conv_block_replknet__vision_kernel
.p2align 8
.type standalone__modern_conv_block_replknet__vision_kernel,@function
standalone__modern_conv_block_replknet__vision_kernel:
    s_cmp_ge_u32 s2, 256
    s_cbranch_scc1 L_end
    s_load_dwordx8 s[64:71], s[0:1], 0
    s_load_dwordx4 s[72:75], s[0:1], 32

    s_getpc_b64 s[96:97]
L_pc0:
    v_add_u32 v16, 448, v0
    v_and_b32 v16, 511, v16
    v_lshlrev_b32_e64 v16, 7, v16
    v_min_u32 v16, L_end-L_pc0, v16
    v_mov_b32 v17, s97
    v_add_co_u32 v16, vcc, s96, v16
    s_nop 1
    v_addc_co_u32 v17, vcc, 0, v17, vcc
    global_load_dword v18, v[16:17], off sc1
    s_setprio 3
    v_mov_b32 v14, v0
    v_lshrrev_b32 v1, 6, v0
    v_and_b32 v0, 63, v0
    v_mov_b32 v10, 1073741824
    v_readfirstlane_b32 s16, v1
    v_lshlrev_b32_e64 v2, 2, v0
    v_add_u32 v2, 161808, v2
    v_add_u32 v3, -10, v0
    v_cmp_gt_u32 vcc, 10, v3
    v_cmp_eq_u32 s[56:57], 36, v0
    s_or_b64 vcc, vcc, s[56:57]
    v_cmp_eq_u32 s[56:57], 41, v0
    s_or_b64 vcc, vcc, s[56:57]
    v_cndmask_b32 v3, 0, 1, vcc
    v_lshlrev_b32 v253, 4, v0
    v_min_u32 v240, 1, v0
    ds_write_b32 v2, v3
    v_lshlrev_b32 v240, 2, v240
    s_and_b32 s26, s2, 3
    s_lshl_b32 s26, s26, 2
    s_bfe_u32 s27, s2, 0x20003
    s_add_u32 s26, s26, s27
    s_lshl_b32 s22, s26, 5
    s_bfe_u32 s26, s2, 0x10002
    s_lshl_b32 s26, s26, 3
    s_lshr_b32 s27, s2, 5
    s_add_u32 s26, s26, s27
    s_lshl_b32 s23, s26, 5
    s_and_b32 s34, s26, 1
    s_mul_i32 s35, s34, 196608
    s_mul_i32 s34, s34, 3
    v_bfe_u32 v12, v0, 3, 2
    v_and_b32 v13, 7, v0
    v_bfe_u32 v4, v0, 4, 1
    v_bfe_u32 v5, v0, 2, 1
    v_lshl_add_u32 v4, v4, 1, v5
    v_and_or_b32 v5, v0, 3, 8
    v_cmp_gt_u32 vcc, 32, v0
    s_nop 1
    v_cndmask_b32 v12, v4, v12, vcc
    v_cndmask_b32 v13, v5, v13, vcc
    v_xor_b32_e64 v5, s34, v12
    v_mul_u32_u24 v5, 98304, v5
    v_lshl_add_u32 v5, v13, 4, v5
    s_mov_b32 vcc_lo, -1
    s_mov_b32 vcc_hi, 0x00ff00ff
    v_cmp_gt_u32 s[58:59], 2, v12
    s_cmp_eq_u32 s22, 0
    s_cselect_b32 s80, 1073741824, 0
    v_cndmask_b32 v247, v10, v5, vcc
    s_mov_b32 s82, 3840
    s_cmp_eq_u32 s22, 480
    s_cselect_b32 s81, 1073741824, s82
    s_add_u32 s18, s16, 0
    s_and_b32 s18, s18, 7
    v_add_u32 v15, -256, v14

    s_waitcnt lgkmcnt(0)
    s_mov_b32 s4, s64
    s_and_b32 s5, s65, 0xffff
    s_mov_b32 s6, 50331648
    s_mov_b32 s7, 0x20000
    s_mov_b32 s48, s66
    s_and_b32 s49, s67, 0xffff
    s_mov_b32 s50, 1728
    s_mov_b32 s51, 0x20000
    s_mov_b32 s52, s68
    s_and_b32 s53, s69, 0xffff
    s_mov_b32 s54, 4800
    s_mov_b32 s55, 0x20000
    s_mov_b32 s40, s70
    s_and_b32 s41, s71, 0xffff
    s_mov_b32 s42, 73728
    s_mov_b32 s43, 0x20000
    s_mov_b32 s44, s72
    s_and_b32 s45, s73, 0xffff
    s_mov_b32 s46, 73728
    s_mov_b32 s47, 0x20000
    s_mov_b32 s8, s74
    s_and_b32 s9, s75, 0xffff
    s_mov_b32 s10, 50331648
    s_mov_b32 s11, 0x20000

    s_cmp_lg_u32 s18, 0
    s_cbranch_scc1 L_pb0
    s_mov_b32 m0, 131328
    s_mov_b32 s26, 4096

    buffer_load_dwordx4 v253, s[52:55], 0 offen offset:0 lds
    buffer_load_dwordx4 v253, s[52:55], 0 offen offset:1024 lds
    buffer_load_dwordx4 v253, s[52:55], 0 offen offset:2048 lds
    buffer_load_dwordx4 v253, s[52:55], 0 offen offset:3072 lds
    s_mov_b32 m0, 135424
    s_nop 0
    buffer_load_dwordx4 v253, s[52:55], s26 offen lds
    s_mov_b32 m0, 136448
    s_nop 0
    buffer_load_dwordx4 v253, s[48:51], 0 offen offset:0 lds
    buffer_load_dwordx4 v253, s[48:51], 0 offen offset:1024 lds

    s_sub_u32 s26, 8, s18
    s_cmp_eq_u32 s34, 0
    s_cselect_b32 s26, s18, s26
    s_lshl_b32 s26, s26, 2
    s_add_u32 s26, s26, s23
    s_lshl_b32 s27, s26, 9
    s_add_u32 s27, s27, s22
    s_mul_i32 s27, s27, 192
    s_cmp_lt_u32 s26, 2
    s_cselect_b64 vcc, s[58:59], 0
    v_mov_b32 v248, 1073741824
    s_sub_u32 s28, s27, 196608
    v_add_u32 v255, s28, v247
    v_cndmask_b32 v248, v255, v248, vcc
    v_add_u32 v255, -384, v248

    buffer_load_dwordx4 v[48:51], v255, s[4:7], s80 offen offset:0 sc1
    buffer_load_dwordx4 v[52:55], v255, s[4:7], s80 offen offset:192 sc1
    buffer_load_dwordx4 v[56:59], v248, s[4:7], 0 offen offset:0 sc1
    buffer_load_dwordx4 v[60:63], v248, s[4:7], 0 offen offset:192 sc1
    buffer_load_dwordx4 v[64:67], v248, s[4:7], 0 offen offset:384 sc1
    buffer_load_dwordx4 v[68:71], v248, s[4:7], 0 offen offset:576 sc1
    buffer_load_dwordx4 v[72:75], v248, s[4:7], 0 offen offset:768 sc1
    buffer_load_dwordx4 v[76:79], v248, s[4:7], 0 offen offset:960 sc1
    buffer_load_dwordx4 v[80:83], v248, s[4:7], 0 offen offset:1152 sc1
    buffer_load_dwordx4 v[84:87], v248, s[4:7], 0 offen offset:1344 sc1
    buffer_load_dwordx4 v[88:91], v248, s[4:7], 0 offen offset:1536 sc1
    buffer_load_dwordx4 v[92:95], v248, s[4:7], 0 offen offset:1728 sc1
    buffer_load_dwordx4 v[96:99], v248, s[4:7], 0 offen offset:1920 sc1
    buffer_load_dwordx4 v[100:103], v248, s[4:7], 0 offen offset:2112 sc1
    buffer_load_dwordx4 v[104:107], v248, s[4:7], 0 offen offset:2304 sc1
    buffer_load_dwordx4 v[108:111], v248, s[4:7], 0 offen offset:2496 sc1
    buffer_load_dwordx4 v[112:115], v248, s[4:7], 0 offen offset:2688 sc1
    buffer_load_dwordx4 v[116:119], v248, s[4:7], 0 offen offset:2880 sc1
    buffer_load_dwordx4 v[120:123], v248, s[4:7], 0 offen offset:3072 sc1
    buffer_load_dwordx4 v[124:127], v248, s[4:7], 0 offen offset:3264 sc1
    buffer_load_dwordx4 v[128:131], v248, s[4:7], 0 offen offset:3456 sc1
    buffer_load_dwordx4 v[132:135], v248, s[4:7], 0 offen offset:3648 sc1
    buffer_load_dwordx4 v[136:139], v248, s[4:7], s82 offen offset:0 sc1
    buffer_load_dwordx4 v[140:143], v248, s[4:7], s82 offen offset:192 sc1
    buffer_load_dwordx4 v[144:147], v248, s[4:7], s82 offen offset:384 sc1
    buffer_load_dwordx4 v[148:151], v248, s[4:7], s82 offen offset:576 sc1
    buffer_load_dwordx4 v[152:155], v248, s[4:7], s82 offen offset:768 sc1
    buffer_load_dwordx4 v[156:159], v248, s[4:7], s82 offen offset:960 sc1
    buffer_load_dwordx4 v[160:163], v248, s[4:7], s82 offen offset:1152 sc1
    buffer_load_dwordx4 v[164:167], v248, s[4:7], s82 offen offset:1344 sc1
    buffer_load_dwordx4 v[168:171], v248, s[4:7], s82 offen offset:1536 sc1
    buffer_load_dwordx4 v[172:175], v248, s[4:7], s82 offen offset:1728 sc1
    buffer_load_dwordx4 v[176:179], v248, s[4:7], s82 offen offset:1920 sc1
    buffer_load_dwordx4 v[180:183], v248, s[4:7], s82 offen offset:2112 sc1
    buffer_load_dwordx4 v[184:187], v248, s[4:7], s81 offen offset:2304 sc1
    buffer_load_dwordx4 v[188:191], v248, s[4:7], s81 offen offset:2496 sc1

    s_barrier
    v_mov_b32 v254, 161972
    v_mov_b32 v255, 1

    s_waitcnt vmcnt(36)
    ds_write_b32 v254, v255 offset:12

L_pb0:
L_pb:
    s_mov_b32 s98, 931135488
    s_mov_b32 s20, 0x05040100
    s_mov_b32 s21, 0x07060302
    s_lshr_b32 s26, s2, 3
    s_mul_i32 s27, s26, 43
    s_lshr_b32 s27, s27, 9
    s_mul_i32 s27, s27, 12
    s_sub_u32 s39, s26, s27
    v_bfe_u32 v1, v0, 3, 1
    v_lshrrev_b32_e64 v2, 5, v0
    v_bfe_u32 v3, v0, 4, 1
    v_bfe_u32 v4, v0, 2, 1
    v_sub_u32 v3, v3, v4
    v_and_b32 v4, 3, v0
    v_mul_u32_u24 v5, 65440, v1
    v_lshl_add_u32 v5, v4, 4, v5
    v_add_u32 v5, 50176, v5
    v_cmp_eq_u32 s[56:57], v1, v2
    v_add_u32 v6, 0, v3
    v_cmp_gt_u32 vcc, 5, v6
    v_lshl_add_u32 v7, v6, 6, v5
    s_and_b64 vcc, vcc, s[56:57]
    v_cndmask_b32 v241, v10, v7, vcc
    v_add_u32_e64 v6, 2, v3
    v_lshl_add_u32 v7, v6, 6, v5
    v_cndmask_b32 v242, v10, v7, s[56:57]
    v_add_u32 v6, 4, v3
    v_cmp_gt_u32 vcc, 5, v6
    v_lshl_add_u32 v7, v6, 6, v5
    s_and_b64 vcc, vcc, s[56:57]
    v_cndmask_b32 v243, v10, v7, vcc
    v_mul_u32_u24 v2, 1168, v2
    v_and_b32_e64 v3, 7, v0
    v_lshl_add_u32 v250, v3, 3, v2
    v_mul_u32_u24 v3, 768, v3
    v_mul_u32_u24 v4, 196608, v1
    v_xor_b32 v4, s35, v4
    v_add_u32 v3, v3, v4
    v_lshrrev_b32_e64 v4, 4, v0
    v_lshl_add_u32 v252, v4, 4, v3

    v_bfe_u32 v3, v0, 4, 1
    v_mul_u32_u24 v3, 7104, v3
    v_add_u32_e64 v250, v250, v3
    v_cmp_eq_u32 s[56:57], 1, v1
    v_and_b32_e64 v5, 1, v12
    v_mul_u32_u24 v5, 7104, v5
    v_mul_u32_u24 v6, 584, v13
    v_add_u32 v249, v5, v6
    s_sub_u32 s26, 7, s16
    s_cmp_eq_u32 s34, 0
    s_cselect_b32 s26, s16, s26
    s_cselect_b32 s27, 0, 98304
    s_cselect_b32 s28, 98304, 0
    s_lshl_b32 s26, s26, 2
    s_add_u32 s26, s26, s23
    s_lshl_b32 s26, s26, 9
    s_add_u32 s26, s26, s22
    s_mul_i32 s26, s26, 192
    s_add_u32 s36, s26, s27
    s_add_u32 s37, s26, s28
    s_add_u32 s24, s36, 384
    s_add_u32 s25, s37, 384
    s_cmp_lt_u32 s18, 1
    s_cbranch_scc1 L_perm
    s_barrier
    s_cmp_lt_u32 s18, 4
    s_cbranch_scc1 L_xload

    v_mov_b32 v254, 161984

    s_mov_b32 s29, 200000
L_wraw:
    ds_read_b32 v255, v254
    s_waitcnt lgkmcnt(0)
    v_cmp_eq_u32 vcc, 1, v255
    s_cmp_eq_u64 vcc, exec
    s_cbranch_scc1 L_wraw_ok
    s_sleep 2
    s_sub_u32 s29, s29, 1
    s_cmp_lg_u32 s29, 0
    s_cbranch_scc1 L_wraw
L_wraw_ok:

    v_add_u32 v1, 0, v15
    v_mul_u32_u24 v128, 683, v1
    v_lshrrev_b32_e64 v128, 16, v128
    v_mul_u32_u24 v129, 96, v128
    v_sub_u32_e64 v129, v1, v129
    v_mul_u32_u24 v2, 960, v128
    v_lshl_add_u32 v2, v129, 1, v2
    v_add_u32 v2, 131328, v2
    v_add_u32_e64 v1, -1, v128
    v_mul_u32_u24 v3, 576, v1
    v_lshl_add_u32 v3, v129, 1, v3
    v_add_u32 v3, 136448, v3
    v_cmp_gt_u32 vcc, 3, v1
    s_nop 1
    v_cndmask_b32 v3, v10, v3, vcc

    ds_read_u16 v132, v2 offset:0
    ds_read_u16 v133, v2 offset:192
    ds_read_u16 v134, v2 offset:384
    ds_read_u16 v135, v2 offset:576
    ds_read_u16 v136, v2 offset:768
    ds_read_u16 v137, v3 offset:0
    ds_read_u16 v138, v3 offset:192
    ds_read_u16 v139, v3 offset:384

    v_add_u32 v1, 256, v15
    v_mul_u32_u24 v144, 683, v1
    v_lshrrev_b32 v144, 16, v144
    v_mul_u32_u24 v145, 96, v144
    v_sub_u32_e64 v145, v1, v145
    v_mul_u32_u24 v2, 960, v144
    v_lshl_add_u32 v2, v145, 1, v2
    v_add_u32 v2, 131328, v2
    v_add_u32_e64 v1, -1, v144
    v_mul_u32_u24 v3, 576, v1
    v_lshl_add_u32 v3, v145, 1, v3
    v_add_u32 v3, 136448, v3
    v_cmp_gt_u32 vcc, 3, v1
    s_nop 1
    v_cndmask_b32 v3, v10, v3, vcc

    ds_read_u16 v148, v2 offset:0
    ds_read_u16 v149, v2 offset:192
    ds_read_u16 v150, v2 offset:384
    ds_read_u16 v151, v2 offset:576
    ds_read_u16 v152, v2 offset:768
    ds_read_u16 v153, v3 offset:0
    ds_read_u16 v154, v3 offset:192
    ds_read_u16 v155, v3 offset:384
    s_waitcnt lgkmcnt(0)
    v_lshlrev_b32 v132, 16, v132
    v_lshlrev_b32 v133, 16, v133
    v_lshlrev_b32 v134, 16, v134
    v_lshlrev_b32 v135, 16, v135
    v_lshlrev_b32 v136, 16, v136
    v_lshlrev_b32 v137, 16, v137
    v_lshlrev_b32 v138, 16, v138
    v_lshlrev_b32 v139, 16, v139

    v_add_f32 v133, v133, v137
    v_add_f32 v134, v134, v138
    v_add_f32_e64 v135, v135, v139
    v_mul_f32 v132, 0x27800000, v132
    v_mul_f32 v133, 0x27800000, v133
    v_mul_f32 v134, 0x27800000, v134
    v_mul_f32 v135, 0x27800000, v135
    v_mul_f32 v136, 0x27800000, v136
    v_mov_b32_e64 v1, 0
    v_cvt_pk_bf16_f32 v160, v132, v133
    v_cvt_pk_bf16_f32 v161, v134, v135
    v_cvt_pk_bf16_f32 v162, v136, v1
    v_mov_b32_e64 v163, 0
    v_cvt_pk_bf16_f32 v164, v1, v132
    v_cvt_pk_bf16_f32 v165, v133, v134
    v_cvt_pk_bf16_f32 v166, v135, v136
    v_mov_b32 v167, 0
    v_mov_b32 v168, 0
    v_mov_b32 v169, v160
    v_mov_b32 v170, v161
    v_mov_b32 v171, v162
    v_mov_b32 v172, 0
    v_mov_b32 v173, v164
    v_mov_b32 v174, v165
    v_mov_b32 v175, v166
    v_lshrrev_b32 v2, 5, v129
    v_and_b32_e64 v3, 15, v129
    v_lshl_add_u32 v2, v2, 4, v3
    v_mul_u32_u24 v2, 320, v2
    v_bfe_u32 v3, v129, 4, 1
    v_mul_u32_u24 v3, 65440, v3
    v_add_u32 v2, v2, v3
    v_sub_u32 v3, 4, v128
    s_cmp_eq_u32 s34, 0
    s_cselect_b64 vcc, -1, 0
    v_cndmask_b32 v3, v3, v128, vcc
    v_lshl_add_u32 v2, v3, 6, v2
    v_add_u32 v2, 50176, v2
    v_cmp_gt_u32 vcc, 5, v128
    s_nop 1
    v_cndmask_b32 v2, v10, v2, vcc
    ds_write_b128 v2, v[160:163]
    ds_write_b128 v2, v[164:167] offset:16
    ds_write_b128 v2, v[168:171] offset:32
    ds_write_b128 v2, v[172:175] offset:48

    v_lshlrev_b32 v148, 16, v148
    v_lshlrev_b32 v149, 16, v149
    v_lshlrev_b32 v150, 16, v150
    v_lshlrev_b32 v151, 16, v151
    v_lshlrev_b32 v152, 16, v152
    v_lshlrev_b32 v153, 16, v153
    v_lshlrev_b32 v154, 16, v154
    v_lshlrev_b32 v155, 16, v155

    v_add_f32 v149, v149, v153
    v_add_f32 v150, v150, v154
    v_add_f32_e64 v151, v151, v155
    v_mul_f32 v148, 0x27800000, v148
    v_mul_f32 v149, 0x27800000, v149
    v_mul_f32 v150, 0x27800000, v150
    v_mul_f32 v151, 0x27800000, v151
    v_mul_f32 v152, 0x27800000, v152
    v_mov_b32_e64 v1, 0
    v_cvt_pk_bf16_f32 v176, v148, v149
    v_cvt_pk_bf16_f32 v177, v150, v151
    v_cvt_pk_bf16_f32 v178, v152, v1
    v_mov_b32_e64 v179, 0
    v_cvt_pk_bf16_f32 v180, v1, v148
    v_cvt_pk_bf16_f32 v181, v149, v150
    v_cvt_pk_bf16_f32 v182, v151, v152
    v_mov_b32 v183, 0
    v_mov_b32 v184, 0
    v_mov_b32 v185, v176
    v_mov_b32 v186, v177
    v_mov_b32 v187, v178
    v_mov_b32 v188, 0
    v_mov_b32 v189, v180
    v_mov_b32 v190, v181
    v_mov_b32 v191, v182
    v_lshrrev_b32 v2, 5, v145
    v_and_b32_e64 v3, 15, v145
    v_lshl_add_u32 v2, v2, 4, v3
    v_mul_u32_u24 v2, 320, v2
    v_bfe_u32 v3, v145, 4, 1
    v_mul_u32_u24 v3, 65440, v3
    v_add_u32 v2, v2, v3
    v_sub_u32 v3, 4, v144
    s_cmp_eq_u32 s34, 0
    s_cselect_b64 vcc, -1, 0
    v_cndmask_b32 v3, v3, v144, vcc
    v_lshl_add_u32 v2, v3, 6, v2
    v_add_u32 v2, 50176, v2
    v_cmp_gt_u32 vcc, 5, v144
    s_nop 1
    v_cndmask_b32 v2, v10, v2, vcc
    ds_write_b128 v2, v[176:179]
    ds_write_b128 v2, v[180:183] offset:16
    ds_write_b128 v2, v[184:187] offset:32
    ds_write_b128 v2, v[188:191] offset:48

    v_mov_b32 v254, 161968
    v_mov_b32 v255, 1
    s_waitcnt lgkmcnt(0)
    s_mov_b64 exec, 1
    ds_add_u32 v254, v255
    s_mov_b64 exec, -1

    s_cmp_lt_u32 s18, 6
    s_cbranch_scc1 L_xload

    s_add_u32 s28, s98, 8388608
    s_and_b32 s26, s16, 1
    s_lshl_b32 s26, s26, 6
    v_lshrrev_b32 v1, 4, v253
    v_add_u32 v1, s26, v1
    v_lshlrev_b32_e64 v2, 2, v1
    v_add_u32 v3, 65536, v2
    v_lshlrev_b32_e64 v4, 17, v1
    v_or_b32 v4, 0x8000, v4
    v_cmp_gt_u32 vcc, 64, v1
    v_mov_b32 v5, s98
    v_mov_b32 v6, s28
    v_cndmask_b32 v5, v5, v6, vcc
    v_cndmask_b32 v6, 0, v6, vcc
    v_add_u32 v4, v4, v5
    v_mov_b32 v5, 0x1000000
    v_mov_b32 v7, 0x800000
    v_cndmask_b32 v5, v5, v7, vcc
    s_mov_b32 s26, 0x3dd2d3e8
    v_mov_b32 v7, 0x40135761
    s_mov_b32 s27, 14
L_tabla:
    v_add_u32 v9, 0x10000, v4
    v_sub_f32 v8, v4, v6
    v_sub_f32 v9, v9, v6
    v_mul_f32 v10, v8, v8
    v_mul_f32 v11, v9, v9
    v_fma_f32 v10, v10, s26, v7
    v_fma_f32 v11, v11, s26, v7
    v_mul_f32 v10, v10, v8
    v_mul_f32 v11, v11, v9
    v_exp_f32 v10, -v10
    v_exp_f32 v11, -v11
    s_nop 0
    v_add_f32 v12, 1.0, v10
    v_add_f32 v13, 1.0, v11
    v_rcp_f32 v12, v12
    v_rcp_f32 v13, v13
    s_nop 0
    v_mul_f32 v8, v8, v12
    v_mul_f32 v9, v9, v13
    v_mul_f32 v10, -v8, v10
    v_mul_f32 v11, -v9, v11
    v_cvt_pk_bf16_f32 v12, v8, v9
    v_cvt_pk_bf16_f32 v13, v10, v11
    ds_write_b32 v2, v12
    ds_write_b32 v3, v13
    v_add_u32_e64 v4, v4, v5
    v_mov_b32 v5, 0x1000000
    v_mov_b32_e64 v6, 0
    v_add_u32 v2, 512, v2
    v_add_u32 v3, 512, v3
    s_sub_u32 s27, s27, 1
    s_cmp_lg_u32 s27, 0
    s_cbranch_scc1 L_tabla
    v_mov_b32 v3, 65536
    ds_write_b16 v6, v6
    ds_write_b16 v3, v6

    v_mov_b32 v254, 161980
    v_mov_b32 v255, 1
    s_waitcnt lgkmcnt(0)
    s_mov_b64 exec, 1
    ds_add_u32 v254, v255
    s_mov_b64 exec, -1

L_xload:
    v_mov_b32 v254, 161972

    s_mov_b32 s29, 200000
L_wiss:
    ds_read_b32 v255, v254
    s_waitcnt lgkmcnt(0)
    v_cmp_eq_u32 vcc, s18, v255
    s_cmp_eq_u64 vcc, exec
    s_cbranch_scc1 L_wiss_ok
    s_sleep 2
    s_sub_u32 s29, s29, 1
    s_cmp_lg_u32 s29, 0
    s_cbranch_scc1 L_wiss
L_wiss_ok:

    s_cmp_lg_u32 s18, 5
    s_cbranch_scc1 L_nocpb

    s_getpc_b64 s[96:97]
L_pcb:
    s_add_u32 s96, s96, L_loader-L_pcb
    s_addc_u32 s97, s97, 0
    v_lshlrev_b32 v20, 3, v253
    v_mov_b32 v23, s97

    v_add_u32 v21, 0, v20
    v_min_u32 v21, L_end-L_loader, v21
    v_add_co_u32 v24, vcc, s96, v21
    s_nop 1
    v_addc_co_u32 v25, vcc, 0, v23, vcc
    global_load_dword v22, v[24:25], off sc1

    v_add_u32 v21, 8192, v20
    v_min_u32 v21, L_end-L_loader, v21
    v_add_co_u32 v26, vcc, s96, v21
    s_nop 1
    v_addc_co_u32 v27, vcc, 0, v23, vcc
    global_load_dword v22, v[26:27], off sc1

L_nocpb:

    s_sub_u32 s26, 8, s18
    s_cmp_eq_u32 s34, 0
    s_cselect_b32 s26, s18, s26
    s_lshl_b32 s26, s26, 2
    s_add_u32 s26, s26, s23
    s_lshl_b32 s27, s26, 9
    s_add_u32 s27, s27, s22
    s_mul_i32 s27, s27, 192
    s_cmp_lt_u32 s26, 2
    s_cselect_b64 vcc, s[58:59], 0
    v_mov_b32 v248, 1073741824
    s_sub_u32 s28, s27, 196608
    v_add_u32 v255, s28, v247
    v_cndmask_b32 v248, v255, v248, vcc
    v_add_u32 v255, -384, v248

    buffer_load_dwordx4 v[48:51], v255, s[4:7], s80 offen offset:0 sc1
    buffer_load_dwordx4 v[52:55], v255, s[4:7], s80 offen offset:192 sc1
    buffer_load_dwordx4 v[56:59], v248, s[4:7], 0 offen offset:0 sc1
    buffer_load_dwordx4 v[60:63], v248, s[4:7], 0 offen offset:192 sc1
    buffer_load_dwordx4 v[64:67], v248, s[4:7], 0 offen offset:384 sc1
    buffer_load_dwordx4 v[68:71], v248, s[4:7], 0 offen offset:576 sc1
    buffer_load_dwordx4 v[72:75], v248, s[4:7], 0 offen offset:768 sc1
    buffer_load_dwordx4 v[76:79], v248, s[4:7], 0 offen offset:960 sc1
    buffer_load_dwordx4 v[80:83], v248, s[4:7], 0 offen offset:1152 sc1
    buffer_load_dwordx4 v[84:87], v248, s[4:7], 0 offen offset:1344 sc1
    buffer_load_dwordx4 v[88:91], v248, s[4:7], 0 offen offset:1536 sc1
    buffer_load_dwordx4 v[92:95], v248, s[4:7], 0 offen offset:1728 sc1
    buffer_load_dwordx4 v[96:99], v248, s[4:7], 0 offen offset:1920 sc1
    buffer_load_dwordx4 v[100:103], v248, s[4:7], 0 offen offset:2112 sc1
    buffer_load_dwordx4 v[104:107], v248, s[4:7], 0 offen offset:2304 sc1
    buffer_load_dwordx4 v[108:111], v248, s[4:7], 0 offen offset:2496 sc1
    buffer_load_dwordx4 v[112:115], v248, s[4:7], 0 offen offset:2688 sc1
    buffer_load_dwordx4 v[116:119], v248, s[4:7], 0 offen offset:2880 sc1
    buffer_load_dwordx4 v[120:123], v248, s[4:7], 0 offen offset:3072 sc1
    buffer_load_dwordx4 v[124:127], v248, s[4:7], 0 offen offset:3264 sc1
    buffer_load_dwordx4 v[128:131], v248, s[4:7], 0 offen offset:3456 sc1
    buffer_load_dwordx4 v[132:135], v248, s[4:7], 0 offen offset:3648 sc1
    buffer_load_dwordx4 v[136:139], v248, s[4:7], s82 offen offset:0 sc1
    buffer_load_dwordx4 v[140:143], v248, s[4:7], s82 offen offset:192 sc1
    buffer_load_dwordx4 v[144:147], v248, s[4:7], s82 offen offset:384 sc1
    buffer_load_dwordx4 v[148:151], v248, s[4:7], s82 offen offset:576 sc1
    buffer_load_dwordx4 v[152:155], v248, s[4:7], s82 offen offset:768 sc1
    buffer_load_dwordx4 v[156:159], v248, s[4:7], s82 offen offset:960 sc1
    buffer_load_dwordx4 v[160:163], v248, s[4:7], s82 offen offset:1152 sc1
    buffer_load_dwordx4 v[164:167], v248, s[4:7], s82 offen offset:1344 sc1
    buffer_load_dwordx4 v[168:171], v248, s[4:7], s82 offen offset:1536 sc1
    buffer_load_dwordx4 v[172:175], v248, s[4:7], s82 offen offset:1728 sc1
    buffer_load_dwordx4 v[176:179], v248, s[4:7], s82 offen offset:1920 sc1
    buffer_load_dwordx4 v[180:183], v248, s[4:7], s82 offen offset:2112 sc1
    buffer_load_dwordx4 v[184:187], v248, s[4:7], s81 offen offset:2304 sc1
    buffer_load_dwordx4 v[188:191], v248, s[4:7], s81 offen offset:2496 sc1

    s_add_u32 s26, s18, 1
    v_mov_b32 v255, s26
    ds_write_b32 v254, v255

L_perm:
    s_mov_b32 exec_hi, 0x00ff00ff
    s_waitcnt vmcnt(32)
    v_perm_b32 v192, v52, v48, s20
    v_perm_b32 v193, v60, v56, s20
    v_perm_b32 v194, v52, v48, s21
    v_perm_b32 v195, v60, v56, s21
    v_perm_b32 v196, v53, v49, s20
    v_perm_b32 v197, v61, v57, s20
    v_perm_b32 v198, v53, v49, s21
    v_perm_b32 v199, v61, v57, s21
    v_perm_b32 v200, v54, v50, s20
    v_perm_b32 v201, v62, v58, s20
    v_perm_b32 v202, v54, v50, s21
    v_perm_b32 v203, v62, v58, s21
    v_perm_b32 v204, v55, v51, s20
    v_perm_b32 v205, v63, v59, s20
    v_perm_b32 v206, v55, v51, s21
    v_perm_b32 v207, v63, v59, s21
    s_waitcnt vmcnt(28)
    v_perm_b32 v48, v68, v64, s20
    v_perm_b32 v49, v76, v72, s20
    v_perm_b32 v50, v68, v64, s21
    v_perm_b32 v51, v76, v72, s21
    v_perm_b32 v52, v69, v65, s20
    v_perm_b32 v53, v77, v73, s20
    v_perm_b32 v54, v69, v65, s21
    v_perm_b32 v55, v77, v73, s21
    v_perm_b32 v56, v70, v66, s20
    v_perm_b32 v57, v78, v74, s20
    v_perm_b32 v58, v70, v66, s21
    v_perm_b32 v59, v78, v74, s21
    v_perm_b32 v60, v71, v67, s20
    v_perm_b32 v61, v79, v75, s20
    v_perm_b32 v62, v71, v67, s21
    v_perm_b32 v63, v79, v75, s21
    s_waitcnt vmcnt(24)
    v_perm_b32 v64, v84, v80, s20
    v_perm_b32 v65, v92, v88, s20
    v_perm_b32 v66, v84, v80, s21
    v_perm_b32 v67, v92, v88, s21
    v_perm_b32 v68, v85, v81, s20
    v_perm_b32 v69, v93, v89, s20
    v_perm_b32 v70, v85, v81, s21
    v_perm_b32 v71, v93, v89, s21
    v_perm_b32 v72, v86, v82, s20
    v_perm_b32 v73, v94, v90, s20
    v_perm_b32 v74, v86, v82, s21
    v_perm_b32 v75, v94, v90, s21
    v_perm_b32 v76, v87, v83, s20
    v_perm_b32 v77, v95, v91, s20
    v_perm_b32 v78, v87, v83, s21
    v_perm_b32 v79, v95, v91, s21
    s_waitcnt vmcnt(20)
    v_perm_b32 v80, v100, v96, s20
    v_perm_b32 v81, v108, v104, s20
    v_perm_b32 v82, v100, v96, s21
    v_perm_b32 v83, v108, v104, s21
    v_perm_b32 v84, v101, v97, s20
    v_perm_b32 v85, v109, v105, s20
    v_perm_b32 v86, v101, v97, s21
    v_perm_b32 v87, v109, v105, s21
    v_perm_b32 v88, v102, v98, s20
    v_perm_b32 v89, v110, v106, s20
    v_perm_b32 v90, v102, v98, s21
    v_perm_b32 v91, v110, v106, s21
    v_perm_b32 v92, v103, v99, s20
    v_perm_b32 v93, v111, v107, s20
    v_perm_b32 v94, v103, v99, s21
    v_perm_b32 v95, v111, v107, s21
    s_waitcnt vmcnt(16)
    v_perm_b32 v96, v116, v112, s20
    v_perm_b32 v97, v124, v120, s20
    v_perm_b32 v98, v116, v112, s21
    v_perm_b32 v99, v124, v120, s21
    v_perm_b32 v100, v117, v113, s20
    v_perm_b32 v101, v125, v121, s20
    v_perm_b32 v102, v117, v113, s21
    v_perm_b32 v103, v125, v121, s21
    v_perm_b32 v104, v118, v114, s20
    v_perm_b32 v105, v126, v122, s20
    v_perm_b32 v106, v118, v114, s21
    v_perm_b32 v107, v126, v122, s21
    v_perm_b32 v108, v119, v115, s20
    v_perm_b32 v109, v127, v123, s20
    v_perm_b32 v110, v119, v115, s21
    v_perm_b32 v111, v127, v123, s21
    s_waitcnt vmcnt(12)
    v_perm_b32 v112, v132, v128, s20
    v_perm_b32 v113, v140, v136, s20
    v_perm_b32 v114, v132, v128, s21
    v_perm_b32 v115, v140, v136, s21
    v_perm_b32 v116, v133, v129, s20
    v_perm_b32 v117, v141, v137, s20
    v_perm_b32 v118, v133, v129, s21
    v_perm_b32 v119, v141, v137, s21
    v_perm_b32 v120, v134, v130, s20
    v_perm_b32 v121, v142, v138, s20
    v_perm_b32 v122, v134, v130, s21
    v_perm_b32 v123, v142, v138, s21
    v_perm_b32 v124, v135, v131, s20
    v_perm_b32 v125, v143, v139, s20
    v_perm_b32 v126, v135, v131, s21
    v_perm_b32 v127, v143, v139, s21
    s_waitcnt vmcnt(8)
    v_perm_b32 v128, v148, v144, s20
    v_perm_b32 v129, v156, v152, s20
    v_perm_b32 v130, v148, v144, s21
    v_perm_b32 v131, v156, v152, s21
    v_perm_b32 v132, v149, v145, s20
    v_perm_b32 v133, v157, v153, s20
    v_perm_b32 v134, v149, v145, s21
    v_perm_b32 v135, v157, v153, s21
    v_perm_b32 v136, v150, v146, s20
    v_perm_b32 v137, v158, v154, s20
    v_perm_b32 v138, v150, v146, s21
    v_perm_b32 v139, v158, v154, s21
    v_perm_b32 v140, v151, v147, s20
    v_perm_b32 v141, v159, v155, s20
    v_perm_b32 v142, v151, v147, s21
    v_perm_b32 v143, v159, v155, s21
    s_waitcnt vmcnt(4)
    v_perm_b32 v144, v164, v160, s20
    v_perm_b32 v145, v172, v168, s20
    v_perm_b32 v146, v164, v160, s21
    v_perm_b32 v147, v172, v168, s21
    v_perm_b32 v148, v165, v161, s20
    v_perm_b32 v149, v173, v169, s20
    v_perm_b32 v150, v165, v161, s21
    v_perm_b32 v151, v173, v169, s21
    v_perm_b32 v152, v166, v162, s20
    v_perm_b32 v153, v174, v170, s20
    v_perm_b32 v154, v166, v162, s21
    v_perm_b32 v155, v174, v170, s21
    v_perm_b32 v156, v167, v163, s20
    v_perm_b32 v157, v175, v171, s20
    v_perm_b32 v158, v167, v163, s21
    v_perm_b32 v159, v175, v171, s21
    s_waitcnt vmcnt(0)
    v_perm_b32 v160, v180, v176, s20
    v_perm_b32 v161, v188, v184, s20
    v_perm_b32 v162, v180, v176, s21
    v_perm_b32 v163, v188, v184, s21
    v_perm_b32 v164, v181, v177, s20
    v_perm_b32 v165, v189, v185, s20
    v_perm_b32 v166, v181, v177, s21
    v_perm_b32 v167, v189, v185, s21
    v_perm_b32 v168, v182, v178, s20
    v_perm_b32 v169, v190, v186, s20
    v_perm_b32 v170, v182, v178, s21
    v_perm_b32 v171, v190, v186, s21
    v_perm_b32 v172, v183, v179, s20
    v_perm_b32 v173, v191, v187, s20
    v_perm_b32 v174, v183, v179, s21
    v_perm_b32 v175, v191, v187, s21
    s_mov_b32 exec_hi, -1
    s_cmp_lg_u32 s18, 3
    s_cbranch_scc1 L_wt3_ok
    v_mov_b32 v254, 161968

    s_mov_b32 s29, 200000
L_wt3:
    ds_read_b32 v255, v254
    s_waitcnt lgkmcnt(0)
    v_cmp_eq_u32 vcc, 4, v255
    s_cmp_eq_u64 vcc, exec
    s_cbranch_scc1 L_wt3_ok
    s_sleep 2
    s_sub_u32 s29, s29, 1
    s_cmp_lg_u32 s29, 0
    s_cbranch_scc1 L_wt3
L_wt3_ok:

    s_lshr_b32 s26, 384, s18
    s_and_b32 s26, s26, 1
    s_add_u32 s26, s26, s18
    s_lshl_b32 s26, s26, 3
    s_add_u32 s26, s26, 161852

    v_add_u32 v254, s26, v240

    s_mov_b32 s29, 200000
L_wslot:
    ds_read_b32 v255, v254
    s_waitcnt lgkmcnt(0)
    v_cmp_ne_u32 vcc, 0, v255
    s_cmp_eq_u64 vcc, exec
    s_cbranch_scc1 L_wslot_ok
    s_sleep 2
    s_sub_u32 s29, s29, 1
    s_cmp_lg_u32 s29, 0
    s_cbranch_scc1 L_wslot
L_wslot_ok:

    s_lshl_b32 s30, s18, 1
    s_lshr_b32 s30, 149961, s30
    s_and_b32 s30, s30, 3
    s_cmp_eq_u32 s30, 3
    s_mul_i32 s30, s30, 14336
    s_cselect_b32 s31, 72704, s30
    s_cselect_b32 s30, 124160, s30
    s_add_u32 s30, s30, 7168
    s_add_u32 s31, s31, 72832

    v_add_u32 v254, s30, v249
    v_add_u32_e64 v255, s31, v249
    v_cndmask_b32 v254, v255, v254, s[58:59]
    s_mov_b32 exec_hi, 0x00ff00ff

    ds_write_b64 v254, v[192:193] offset:0
    ds_write_b64 v254, v[194:195] offset:72
    ds_write_b64 v254, v[196:197] offset:144
    ds_write_b64 v254, v[198:199] offset:216
    ds_write_b64 v254, v[200:201] offset:288
    ds_write_b64 v254, v[202:203] offset:360
    ds_write_b64 v254, v[204:205] offset:432
    ds_write_b64 v254, v[206:207] offset:504
    ds_write_b64 v254, v[48:49] offset:8
    ds_write_b64 v254, v[50:51] offset:80
    ds_write_b64 v254, v[52:53] offset:152
    ds_write_b64 v254, v[54:55] offset:224
    ds_write_b64 v254, v[56:57] offset:296
    ds_write_b64 v254, v[58:59] offset:368
    ds_write_b64 v254, v[60:61] offset:440
    ds_write_b64 v254, v[62:63] offset:512
    ds_write_b64 v254, v[64:65] offset:16
    ds_write_b64 v254, v[66:67] offset:88
    ds_write_b64 v254, v[68:69] offset:160
    ds_write_b64 v254, v[70:71] offset:232
    ds_write_b64 v254, v[72:73] offset:304
    ds_write_b64 v254, v[74:75] offset:376
    ds_write_b64 v254, v[76:77] offset:448
    ds_write_b64 v254, v[78:79] offset:520
    ds_write_b64 v254, v[80:81] offset:24
    ds_write_b64 v254, v[82:83] offset:96
    ds_write_b64 v254, v[84:85] offset:168
    ds_write_b64 v254, v[86:87] offset:240
    ds_write_b64 v254, v[88:89] offset:312
    ds_write_b64 v254, v[90:91] offset:384
    ds_write_b64 v254, v[92:93] offset:456
    ds_write_b64 v254, v[94:95] offset:528
    ds_write_b64 v254, v[96:97] offset:32
    ds_write_b64 v254, v[98:99] offset:104
    ds_write_b64 v254, v[100:101] offset:176
    ds_write_b64 v254, v[102:103] offset:248
    ds_write_b64 v254, v[104:105] offset:320
    ds_write_b64 v254, v[106:107] offset:392
    ds_write_b64 v254, v[108:109] offset:464
    ds_write_b64 v254, v[110:111] offset:536
    ds_write_b64 v254, v[112:113] offset:40
    ds_write_b64 v254, v[114:115] offset:112
    ds_write_b64 v254, v[116:117] offset:184
    ds_write_b64 v254, v[118:119] offset:256
    ds_write_b64 v254, v[120:121] offset:328
    ds_write_b64 v254, v[122:123] offset:400
    ds_write_b64 v254, v[124:125] offset:472
    ds_write_b64 v254, v[126:127] offset:544
    ds_write_b64 v254, v[128:129] offset:48
    ds_write_b64 v254, v[130:131] offset:120
    ds_write_b64 v254, v[132:133] offset:192
    ds_write_b64 v254, v[134:135] offset:264
    ds_write_b64 v254, v[136:137] offset:336
    ds_write_b64 v254, v[138:139] offset:408
    ds_write_b64 v254, v[140:141] offset:480
    ds_write_b64 v254, v[142:143] offset:552
    ds_write_b64 v254, v[144:145] offset:56
    ds_write_b64 v254, v[146:147] offset:128
    ds_write_b64 v254, v[148:149] offset:200
    ds_write_b64 v254, v[150:151] offset:272
    ds_write_b64 v254, v[152:153] offset:344
    ds_write_b64 v254, v[154:155] offset:416
    ds_write_b64 v254, v[156:157] offset:488
    ds_write_b64 v254, v[158:159] offset:560
    ds_write_b64 v254, v[160:161] offset:64
    ds_write_b64 v254, v[162:163] offset:136
    ds_write_b64 v254, v[164:165] offset:208
    ds_write_b64 v254, v[166:167] offset:280
    ds_write_b64 v254, v[168:169] offset:352
    ds_write_b64 v254, v[170:171] offset:424
    ds_write_b64 v254, v[172:173] offset:496
    ds_write_b64 v254, v[174:175] offset:568

    s_mov_b32 exec_hi, -1
    s_lshl_b32 s26, s18, 2
    s_add_u32 s26, s26, 161808
    v_mov_b32 v254, s26
    v_mov_b32 v255, 1
    s_waitcnt lgkmcnt(0)
    ds_write_b32 v254, v255

    s_cmp_eq_u32 s18, 8
    s_cbranch_scc1 L_loader
    s_setprio 0
L_hp1:
    s_add_u32 s27, s18, 1

    s_lshl_b32 s32, s27, 1
    s_lshr_b32 s32, 149961, s32
    s_and_b32 s32, s32, 3
    s_cmp_eq_u32 s32, 3
    s_mul_i32 s32, s32, 14336
    s_cselect_b32 s33, 72704, s32
    s_cselect_b32 s32, 124160, s32
    s_add_u32 s32, s32, 7168
    s_add_u32 s33, s33, 72832

    v_add_u32 v232, s30, v250
    v_add_u32 v233, s31, v250
    v_add_u32 v234, s32, v250
    v_add_u32 v235, s33, v250
    v_cndmask_b32 v244, v232, v233, s[56:57]
    v_cndmask_b32 v245, v233, v234, s[56:57]
    v_cndmask_b32 v246, v234, v235, s[56:57]
    v_mov_b32 v254, 161968

    s_mov_b32 s29, 200000
L_wt:
    ds_read_b32 v255, v254
    s_waitcnt lgkmcnt(0)
    v_cmp_eq_u32 vcc, 4, v255
    s_cmp_eq_u64 vcc, exec
    s_cbranch_scc1 L_wt_ok
    s_sleep 2
    s_sub_u32 s29, s29, 1
    s_cmp_lg_u32 s29, 0
    s_cbranch_scc1 L_wt
L_wt_ok:

    ds_read_b128 v[192:195], v241 offset:0
    ds_read_b64 v[212:213], v244 offset:0
    ds_read_b64 v[214:215], v244 offset:8
    ds_read_b128 v[196:199], v241 offset:320
    ds_read_b64 v[216:217], v244 offset:72
    ds_read_b64 v[218:219], v244 offset:80
    ds_read_b128 v[200:203], v241 offset:640
    ds_read_b64 v[220:221], v244 offset:144
    ds_read_b64 v[222:223], v244 offset:152
    ds_read_b128 v[204:207], v241 offset:960
    ds_read_b64 v[224:225], v244 offset:216
    ds_read_b64 v[226:227], v244 offset:224
    ds_read_b128 v[208:211], v241 offset:1280
    ds_read_b64 v[228:229], v244 offset:288
    ds_read_b64 v[230:231], v244 offset:296
    s_waitcnt lgkmcnt(9)
    v_mfma_f32_16x16x32_bf16 v[0:3], v[192:195], v[212:215], 0
    ds_read_b128 v[192:195], v241 offset:1600
    ds_read_b64 v[212:213], v244 offset:360
    ds_read_b64 v[214:215], v244 offset:368
    v_mfma_f32_16x16x32_bf16 v[4:7], v[196:199], v[216:219], 0
    ds_read_b128 v[196:199], v241 offset:1920
    ds_read_b64 v[216:217], v244 offset:432
    ds_read_b64 v[218:219], v244 offset:440
    s_waitcnt lgkmcnt(9)
    v_mfma_f32_16x16x32_bf16 v[8:11], v[200:203], v[220:223], 0
    ds_read_b128 v[200:203], v241 offset:2240
    ds_read_b64 v[220:221], v244 offset:504
    ds_read_b64 v[222:223], v244 offset:512
    v_mfma_f32_16x16x32_bf16 v[12:15], v[204:207], v[224:227], 0
    ds_read_b128 v[204:207], v241 offset:2560
    ds_read_b64 v[224:225], v244 offset:584
    ds_read_b64 v[226:227], v244 offset:592
    s_waitcnt lgkmcnt(9)
    v_mfma_f32_16x16x32_bf16 v[16:19], v[208:211], v[228:231], 0
    ds_read_b128 v[208:211], v241 offset:2880
    ds_read_b64 v[228:229], v244 offset:656
    ds_read_b64 v[230:231], v244 offset:664
    v_mfma_f32_16x16x32_bf16 v[20:23], v[192:195], v[212:215], 0
    ds_read_b128 v[192:195], v241 offset:3200
    ds_read_b64 v[212:213], v244 offset:728
    ds_read_b64 v[214:215], v244 offset:736
    s_waitcnt lgkmcnt(9)
    v_mfma_f32_16x16x32_bf16 v[24:27], v[196:199], v[216:219], 0
    ds_read_b128 v[196:199], v241 offset:3520
    ds_read_b64 v[216:217], v244 offset:800
    ds_read_b64 v[218:219], v244 offset:808
    v_mfma_f32_16x16x32_bf16 v[28:31], v[200:203], v[220:223], 0
    ds_read_b128 v[200:203], v241 offset:3840
    ds_read_b64 v[220:221], v244 offset:872
    ds_read_b64 v[222:223], v244 offset:880
    s_waitcnt lgkmcnt(9)
    v_mfma_f32_16x16x32_bf16 v[32:35], v[204:207], v[224:227], 0
    ds_read_b128 v[204:207], v241 offset:4160
    ds_read_b64 v[224:225], v244 offset:944
    ds_read_b64 v[226:227], v244 offset:952
    v_mfma_f32_16x16x32_bf16 v[36:39], v[208:211], v[228:231], 0
    ds_read_b128 v[208:211], v241 offset:4480
    ds_read_b64 v[228:229], v244 offset:1016
    ds_read_b64 v[230:231], v244 offset:1024
    s_waitcnt lgkmcnt(9)
    v_mfma_f32_16x16x32_bf16 v[40:43], v[192:195], v[212:215], 0
    ds_read_b128 v[192:195], v241 offset:4800
    ds_read_b64 v[212:213], v244 offset:1088
    ds_read_b64 v[214:215], v244 offset:1096
    v_mfma_f32_16x16x32_bf16 v[44:47], v[196:199], v[216:219], 0
    ds_read_b128 v[196:199], v241 offset:5120
    ds_read_b64 v[216:217], v244 offset:2336
    ds_read_b64 v[218:219], v244 offset:2344
    s_waitcnt lgkmcnt(9)
    v_mfma_f32_16x16x32_bf16 v[48:51], v[200:203], v[220:223], 0
    ds_read_b128 v[200:203], v241 offset:5440
    ds_read_b64 v[220:221], v244 offset:2408
    ds_read_b64 v[222:223], v244 offset:2416
    v_mfma_f32_16x16x32_bf16 v[52:55], v[204:207], v[224:227], 0
    ds_read_b128 v[204:207], v241 offset:5760
    ds_read_b64 v[224:225], v244 offset:2480
    ds_read_b64 v[226:227], v244 offset:2488
    s_waitcnt lgkmcnt(9)
    v_mfma_f32_16x16x32_bf16 v[56:59], v[208:211], v[228:231], 0
    ds_read_b128 v[208:211], v241 offset:6080
    ds_read_b64 v[228:229], v244 offset:2552
    ds_read_b64 v[230:231], v244 offset:2560
    v_mfma_f32_16x16x32_bf16 v[60:63], v[192:195], v[212:215], 0
    ds_read_b128 v[192:195], v241 offset:6400
    ds_read_b64 v[212:213], v244 offset:2624
    ds_read_b64 v[214:215], v244 offset:2632
    s_waitcnt lgkmcnt(9)
    v_mfma_f32_16x16x32_bf16 v[64:67], v[196:199], v[216:219], 0
    ds_read_b128 v[196:199], v241 offset:6720
    ds_read_b64 v[216:217], v244 offset:2696
    ds_read_b64 v[218:219], v244 offset:2704
    v_mfma_f32_16x16x32_bf16 v[68:71], v[200:203], v[220:223], 0
    ds_read_b128 v[200:203], v241 offset:7040
    ds_read_b64 v[220:221], v244 offset:2768
    ds_read_b64 v[222:223], v244 offset:2776
    s_waitcnt lgkmcnt(9)
    v_mfma_f32_16x16x32_bf16 v[72:75], v[204:207], v[224:227], 0
    ds_read_b128 v[204:207], v241 offset:7360
    ds_read_b64 v[224:225], v244 offset:2840
    ds_read_b64 v[226:227], v244 offset:2848
    v_mfma_f32_16x16x32_bf16 v[76:79], v[208:211], v[228:231], 0
    ds_read_b128 v[208:211], v241 offset:7680
    ds_read_b64 v[228:229], v244 offset:2920
    ds_read_b64 v[230:231], v244 offset:2928
    s_waitcnt lgkmcnt(9)
    v_mfma_f32_16x16x32_bf16 v[80:83], v[192:195], v[212:215], 0
    ds_read_b128 v[192:195], v241 offset:8000
    ds_read_b64 v[212:213], v244 offset:2992
    ds_read_b64 v[214:215], v244 offset:3000
    v_mfma_f32_16x16x32_bf16 v[84:87], v[196:199], v[216:219], 0
    ds_read_b128 v[196:199], v241 offset:8320
    ds_read_b64 v[216:217], v244 offset:3064
    ds_read_b64 v[218:219], v244 offset:3072
    s_waitcnt lgkmcnt(9)
    v_mfma_f32_16x16x32_bf16 v[88:91], v[200:203], v[220:223], 0
    ds_read_b128 v[200:203], v241 offset:8640
    ds_read_b64 v[220:221], v244 offset:3136
    ds_read_b64 v[222:223], v244 offset:3144
    v_mfma_f32_16x16x32_bf16 v[92:95], v[204:207], v[224:227], 0
    ds_read_b128 v[204:207], v241 offset:8960
    ds_read_b64 v[224:225], v244 offset:3208
    ds_read_b64 v[226:227], v244 offset:3216
    s_waitcnt lgkmcnt(9)
    v_mfma_f32_16x16x32_bf16 v[96:99], v[208:211], v[228:231], 0
    ds_read_b128 v[208:211], v241 offset:9280
    ds_read_b64 v[228:229], v244 offset:3280
    ds_read_b64 v[230:231], v244 offset:3288
    v_mfma_f32_16x16x32_bf16 v[100:103], v[192:195], v[212:215], 0
    ds_read_b128 v[192:195], v241 offset:9600
    ds_read_b64 v[212:213], v244 offset:3352
    ds_read_b64 v[214:215], v244 offset:3360
    s_waitcnt lgkmcnt(9)
    v_mfma_f32_16x16x32_bf16 v[104:107], v[196:199], v[216:219], 0
    ds_read_b128 v[196:199], v241 offset:9920
    ds_read_b64 v[216:217], v244 offset:3424
    ds_read_b64 v[218:219], v244 offset:3432
    v_mfma_f32_16x16x32_bf16 v[108:111], v[200:203], v[220:223], 0
    ds_read_b128 v[200:203], v241 offset:10240
    ds_read_b64 v[220:221], v244 offset:4672
    ds_read_b64 v[222:223], v244 offset:4680
    s_waitcnt lgkmcnt(9)
    v_mfma_f32_16x16x32_bf16 v[112:115], v[204:207], v[224:227], 0
    ds_read_b128 v[204:207], v241 offset:10560
    ds_read_b64 v[224:225], v244 offset:4744
    ds_read_b64 v[226:227], v244 offset:4752
    v_mfma_f32_16x16x32_bf16 v[116:119], v[208:211], v[228:231], 0
    ds_read_b128 v[208:211], v241 offset:10880
    ds_read_b64 v[228:229], v244 offset:4816
    ds_read_b64 v[230:231], v244 offset:4824
    s_waitcnt lgkmcnt(9)
    v_mfma_f32_16x16x32_bf16 v[120:123], v[192:195], v[212:215], 0
    ds_read_b128 v[192:195], v241 offset:11200
    ds_read_b64 v[212:213], v244 offset:4888
    ds_read_b64 v[214:215], v244 offset:4896
    v_mfma_f32_16x16x32_bf16 v[124:127], v[196:199], v[216:219], 0
    ds_read_b128 v[196:199], v241 offset:11520
    ds_read_b64 v[216:217], v244 offset:4960
    ds_read_b64 v[218:219], v244 offset:4968
    s_waitcnt lgkmcnt(9)
    v_mfma_f32_16x16x32_bf16 v[128:131], v[200:203], v[220:223], 0
    ds_read_b128 v[200:203], v241 offset:11840
    ds_read_b64 v[220:221], v244 offset:5032
    ds_read_b64 v[222:223], v244 offset:5040
    v_mfma_f32_16x16x32_bf16 v[132:135], v[204:207], v[224:227], 0
    ds_read_b128 v[204:207], v241 offset:12160
    ds_read_b64 v[224:225], v244 offset:5104
    ds_read_b64 v[226:227], v244 offset:5112
    s_waitcnt lgkmcnt(9)
    v_mfma_f32_16x16x32_bf16 v[136:139], v[208:211], v[228:231], 0
    ds_read_b128 v[208:211], v241 offset:12480
    ds_read_b64 v[228:229], v244 offset:5176
    ds_read_b64 v[230:231], v244 offset:5184
    v_mfma_f32_16x16x32_bf16 v[140:143], v[192:195], v[212:215], 0
    ds_read_b128 v[192:195], v241 offset:12800
    ds_read_b64 v[212:213], v244 offset:5256
    ds_read_b64 v[214:215], v244 offset:5264
    s_waitcnt lgkmcnt(9)
    v_mfma_f32_16x16x32_bf16 v[144:147], v[196:199], v[216:219], 0
    ds_read_b128 v[196:199], v241 offset:13120
    ds_read_b64 v[216:217], v244 offset:5328
    ds_read_b64 v[218:219], v244 offset:5336
    v_mfma_f32_16x16x32_bf16 v[148:151], v[200:203], v[220:223], 0
    ds_read_b128 v[200:203], v241 offset:13440
    ds_read_b64 v[220:221], v244 offset:5400
    ds_read_b64 v[222:223], v244 offset:5408
    s_waitcnt lgkmcnt(9)
    v_mfma_f32_16x16x32_bf16 v[152:155], v[204:207], v[224:227], 0
    ds_read_b128 v[204:207], v241 offset:13760
    ds_read_b64 v[224:225], v244 offset:5472
    ds_read_b64 v[226:227], v244 offset:5480
    v_mfma_f32_16x16x32_bf16 v[156:159], v[208:211], v[228:231], 0
    ds_read_b128 v[208:211], v241 offset:14080
    ds_read_b64 v[228:229], v244 offset:5544
    ds_read_b64 v[230:231], v244 offset:5552
    s_waitcnt lgkmcnt(9)
    v_mfma_f32_16x16x32_bf16 v[160:163], v[192:195], v[212:215], 0
    ds_read_b128 v[192:195], v241 offset:14400
    ds_read_b64 v[212:213], v244 offset:5616
    ds_read_b64 v[214:215], v244 offset:5624
    v_mfma_f32_16x16x32_bf16 v[164:167], v[196:199], v[216:219], 0
    ds_read_b128 v[196:199], v241 offset:14720
    ds_read_b64 v[216:217], v244 offset:5688
    ds_read_b64 v[218:219], v244 offset:5696
    s_waitcnt lgkmcnt(9)
    v_mfma_f32_16x16x32_bf16 v[168:171], v[200:203], v[220:223], 0
    ds_read_b128 v[200:203], v241 offset:15040
    ds_read_b64 v[220:221], v244 offset:5760
    ds_read_b64 v[222:223], v244 offset:5768
    v_mfma_f32_16x16x32_bf16 v[172:175], v[204:207], v[224:227], 0
    v_add_u32_e64 v254, s26, v240

    s_mov_b32 s29, 200000
L_wrdy:
    ds_read_b32 v255, v254
    s_waitcnt lgkmcnt(0)
    v_cmp_ne_u32 vcc, 0, v255
    s_cmp_eq_u64 vcc, exec
    s_cbranch_scc1 L_wrdy_ok
    s_sleep 2
    s_sub_u32 s29, s29, 1
    s_cmp_lg_u32 s29, 0
    s_cbranch_scc1 L_wrdy
L_wrdy_ok:

    s_lshl_b32 s26, s16, 3
    s_add_u32 s26, s26, 161888
    v_mov_b32 v254, s26
    v_mov_b32_e64 v255, 1

    ds_read_b128 v[204:207], v242 offset:0
    ds_read_b64 v[224:225], v245 offset:0
    ds_read_b64 v[226:227], v245 offset:8
    s_waitcnt lgkmcnt(9)
    v_mfma_f32_16x16x32_bf16 v[176:179], v[208:211], v[228:231], 0
    ds_read_b128 v[208:211], v242 offset:320
    ds_read_b64 v[228:229], v245 offset:72
    ds_read_b64 v[230:231], v245 offset:80
    v_mfma_f32_16x16x32_bf16 v[180:183], v[192:195], v[212:215], 0
    ds_read_b128 v[192:195], v242 offset:640
    ds_read_b64 v[212:213], v245 offset:144
    ds_read_b64 v[214:215], v245 offset:152
    s_waitcnt lgkmcnt(9)
    v_mfma_f32_16x16x32_bf16 v[184:187], v[196:199], v[216:219], 0
    ds_read_b128 v[196:199], v242 offset:960
    ds_read_b64 v[216:217], v245 offset:216
    ds_read_b64 v[218:219], v245 offset:224
    v_mfma_f32_16x16x32_bf16 v[188:191], v[200:203], v[220:223], 0
    ds_read_b128 v[200:203], v242 offset:1280
    ds_read_b64 v[220:221], v245 offset:288
    ds_read_b64 v[222:223], v245 offset:296
    s_waitcnt lgkmcnt(9)
    v_mfma_f32_16x16x32_bf16 v[0:3], v[204:207], v[224:227], v[0:3]
    ds_read_b128 v[204:207], v242 offset:1600
    ds_read_b64 v[224:225], v245 offset:360
    ds_read_b64 v[226:227], v245 offset:368
    v_mfma_f32_16x16x32_bf16 v[4:7], v[208:211], v[228:231], v[4:7]
    ds_read_b128 v[208:211], v242 offset:1920
    ds_read_b64 v[228:229], v245 offset:432
    ds_read_b64 v[230:231], v245 offset:440
    s_waitcnt lgkmcnt(9)
    v_mfma_f32_16x16x32_bf16 v[8:11], v[192:195], v[212:215], v[8:11]
    ds_read_b128 v[192:195], v242 offset:2240
    ds_read_b64 v[212:213], v245 offset:504
    ds_read_b64 v[214:215], v245 offset:512
    v_mfma_f32_16x16x32_bf16 v[12:15], v[196:199], v[216:219], v[12:15]
    ds_read_b128 v[196:199], v242 offset:2560
    ds_read_b64 v[216:217], v245 offset:584
    ds_read_b64 v[218:219], v245 offset:592
    s_waitcnt lgkmcnt(9)
    v_mfma_f32_16x16x32_bf16 v[16:19], v[200:203], v[220:223], v[16:19]
    ds_read_b128 v[200:203], v242 offset:2880
    ds_read_b64 v[220:221], v245 offset:656
    ds_read_b64 v[222:223], v245 offset:664
    v_mfma_f32_16x16x32_bf16 v[20:23], v[204:207], v[224:227], v[20:23]
    ds_read_b128 v[204:207], v242 offset:3200
    ds_read_b64 v[224:225], v245 offset:728
    ds_read_b64 v[226:227], v245 offset:736
    s_waitcnt lgkmcnt(9)
    v_mfma_f32_16x16x32_bf16 v[24:27], v[208:211], v[228:231], v[24:27]
    ds_read_b128 v[208:211], v242 offset:3520
    ds_read_b64 v[228:229], v245 offset:800
    ds_read_b64 v[230:231], v245 offset:808
    v_mfma_f32_16x16x32_bf16 v[28:31], v[192:195], v[212:215], v[28:31]
    ds_read_b128 v[192:195], v242 offset:3840
    ds_read_b64 v[212:213], v245 offset:872
    ds_read_b64 v[214:215], v245 offset:880
    s_waitcnt lgkmcnt(9)
    v_mfma_f32_16x16x32_bf16 v[32:35], v[196:199], v[216:219], v[32:35]
    ds_read_b128 v[196:199], v242 offset:4160
    ds_read_b64 v[216:217], v245 offset:944
    ds_read_b64 v[218:219], v245 offset:952
    v_mfma_f32_16x16x32_bf16 v[36:39], v[200:203], v[220:223], v[36:39]
    ds_read_b128 v[200:203], v242 offset:4480
    ds_read_b64 v[220:221], v245 offset:1016
    ds_read_b64 v[222:223], v245 offset:1024
    s_waitcnt lgkmcnt(9)
    v_mfma_f32_16x16x32_bf16 v[40:43], v[204:207], v[224:227], v[40:43]
    ds_read_b128 v[204:207], v242 offset:4800
    ds_read_b64 v[224:225], v245 offset:1088
    ds_read_b64 v[226:227], v245 offset:1096
    v_mfma_f32_16x16x32_bf16 v[44:47], v[208:211], v[228:231], v[44:47]
    ds_read_b128 v[208:211], v242 offset:5120
    ds_read_b64 v[228:229], v245 offset:2336
    ds_read_b64 v[230:231], v245 offset:2344
    s_waitcnt lgkmcnt(9)
    v_mfma_f32_16x16x32_bf16 v[48:51], v[192:195], v[212:215], v[48:51]
    ds_read_b128 v[192:195], v242 offset:5440
    ds_read_b64 v[212:213], v245 offset:2408
    ds_read_b64 v[214:215], v245 offset:2416
    v_mfma_f32_16x16x32_bf16 v[52:55], v[196:199], v[216:219], v[52:55]
    ds_read_b128 v[196:199], v242 offset:5760
    ds_read_b64 v[216:217], v245 offset:2480
    ds_read_b64 v[218:219], v245 offset:2488
    s_waitcnt lgkmcnt(9)
    v_mfma_f32_16x16x32_bf16 v[56:59], v[200:203], v[220:223], v[56:59]
    ds_read_b128 v[200:203], v242 offset:6080
    ds_read_b64 v[220:221], v245 offset:2552
    ds_read_b64 v[222:223], v245 offset:2560
    v_mfma_f32_16x16x32_bf16 v[60:63], v[204:207], v[224:227], v[60:63]
    ds_read_b128 v[204:207], v242 offset:6400
    ds_read_b64 v[224:225], v245 offset:2624
    ds_read_b64 v[226:227], v245 offset:2632
    s_waitcnt lgkmcnt(9)
    v_mfma_f32_16x16x32_bf16 v[64:67], v[208:211], v[228:231], v[64:67]
    ds_read_b128 v[208:211], v242 offset:6720
    ds_read_b64 v[228:229], v245 offset:2696
    ds_read_b64 v[230:231], v245 offset:2704
    v_mfma_f32_16x16x32_bf16 v[68:71], v[192:195], v[212:215], v[68:71]
    ds_read_b128 v[192:195], v242 offset:7040
    ds_read_b64 v[212:213], v245 offset:2768
    ds_read_b64 v[214:215], v245 offset:2776
    s_waitcnt lgkmcnt(9)
    v_mfma_f32_16x16x32_bf16 v[72:75], v[196:199], v[216:219], v[72:75]
    ds_read_b128 v[196:199], v242 offset:7360
    ds_read_b64 v[216:217], v245 offset:2840
    ds_read_b64 v[218:219], v245 offset:2848
    v_mfma_f32_16x16x32_bf16 v[76:79], v[200:203], v[220:223], v[76:79]
    ds_read_b128 v[200:203], v242 offset:7680
    ds_read_b64 v[220:221], v245 offset:2920
    ds_read_b64 v[222:223], v245 offset:2928
    s_waitcnt lgkmcnt(9)
    v_mfma_f32_16x16x32_bf16 v[80:83], v[204:207], v[224:227], v[80:83]
    ds_read_b128 v[204:207], v242 offset:8000
    ds_read_b64 v[224:225], v245 offset:2992
    ds_read_b64 v[226:227], v245 offset:3000
    v_mfma_f32_16x16x32_bf16 v[84:87], v[208:211], v[228:231], v[84:87]
    ds_read_b128 v[208:211], v242 offset:8320
    ds_read_b64 v[228:229], v245 offset:3064
    ds_read_b64 v[230:231], v245 offset:3072
    s_waitcnt lgkmcnt(9)
    v_mfma_f32_16x16x32_bf16 v[88:91], v[192:195], v[212:215], v[88:91]
    ds_read_b128 v[192:195], v242 offset:8640
    ds_read_b64 v[212:213], v245 offset:3136
    ds_read_b64 v[214:215], v245 offset:3144
    v_mfma_f32_16x16x32_bf16 v[92:95], v[196:199], v[216:219], v[92:95]
    ds_read_b128 v[196:199], v242 offset:8960
    ds_read_b64 v[216:217], v245 offset:3208
    ds_read_b64 v[218:219], v245 offset:3216
    s_waitcnt lgkmcnt(9)
    v_mfma_f32_16x16x32_bf16 v[96:99], v[200:203], v[220:223], v[96:99]
    ds_read_b128 v[200:203], v242 offset:9280
    ds_read_b64 v[220:221], v245 offset:3280
    ds_read_b64 v[222:223], v245 offset:3288
    v_mfma_f32_16x16x32_bf16 v[100:103], v[204:207], v[224:227], v[100:103]
    ds_read_b128 v[204:207], v242 offset:9600
    ds_read_b64 v[224:225], v245 offset:3352
    ds_read_b64 v[226:227], v245 offset:3360
    s_waitcnt lgkmcnt(9)
    v_mfma_f32_16x16x32_bf16 v[104:107], v[208:211], v[228:231], v[104:107]
    ds_read_b128 v[208:211], v242 offset:9920
    ds_read_b64 v[228:229], v245 offset:3424
    ds_read_b64 v[230:231], v245 offset:3432
    v_mfma_f32_16x16x32_bf16 v[108:111], v[192:195], v[212:215], v[108:111]
    ds_read_b128 v[192:195], v242 offset:10240
    ds_read_b64 v[212:213], v245 offset:4672
    ds_read_b64 v[214:215], v245 offset:4680
    s_waitcnt lgkmcnt(9)
    v_mfma_f32_16x16x32_bf16 v[112:115], v[196:199], v[216:219], v[112:115]
    ds_read_b128 v[196:199], v242 offset:10560
    ds_read_b64 v[216:217], v245 offset:4744
    ds_read_b64 v[218:219], v245 offset:4752
    v_mfma_f32_16x16x32_bf16 v[116:119], v[200:203], v[220:223], v[116:119]
    ds_read_b128 v[200:203], v242 offset:10880
    ds_read_b64 v[220:221], v245 offset:4816
    ds_read_b64 v[222:223], v245 offset:4824
    s_waitcnt lgkmcnt(9)
    v_mfma_f32_16x16x32_bf16 v[120:123], v[204:207], v[224:227], v[120:123]
    ds_read_b128 v[204:207], v242 offset:11200
    ds_read_b64 v[224:225], v245 offset:4888
    ds_read_b64 v[226:227], v245 offset:4896
    v_mfma_f32_16x16x32_bf16 v[124:127], v[208:211], v[228:231], v[124:127]
    ds_read_b128 v[208:211], v242 offset:11520
    ds_read_b64 v[228:229], v245 offset:4960
    ds_read_b64 v[230:231], v245 offset:4968
    s_waitcnt lgkmcnt(9)
    v_mfma_f32_16x16x32_bf16 v[128:131], v[192:195], v[212:215], v[128:131]
    ds_read_b128 v[192:195], v242 offset:11840
    ds_read_b64 v[212:213], v245 offset:5032
    ds_read_b64 v[214:215], v245 offset:5040
    v_mfma_f32_16x16x32_bf16 v[132:135], v[196:199], v[216:219], v[132:135]
    ds_read_b128 v[196:199], v242 offset:12160
    ds_read_b64 v[216:217], v245 offset:5104
    ds_read_b64 v[218:219], v245 offset:5112
    s_waitcnt lgkmcnt(9)
    v_mfma_f32_16x16x32_bf16 v[136:139], v[200:203], v[220:223], v[136:139]
    ds_read_b128 v[200:203], v242 offset:12480
    ds_read_b64 v[220:221], v245 offset:5176
    ds_read_b64 v[222:223], v245 offset:5184
    v_mfma_f32_16x16x32_bf16 v[140:143], v[204:207], v[224:227], v[140:143]
    ds_read_b128 v[204:207], v242 offset:12800
    ds_read_b64 v[224:225], v245 offset:5256
    ds_read_b64 v[226:227], v245 offset:5264
    s_waitcnt lgkmcnt(9)
    v_mfma_f32_16x16x32_bf16 v[144:147], v[208:211], v[228:231], v[144:147]
    ds_read_b128 v[208:211], v242 offset:13120
    ds_read_b64 v[228:229], v245 offset:5328
    ds_read_b64 v[230:231], v245 offset:5336
    v_mfma_f32_16x16x32_bf16 v[148:151], v[192:195], v[212:215], v[148:151]
    ds_read_b128 v[192:195], v242 offset:13440
    ds_read_b64 v[212:213], v245 offset:5400
    ds_read_b64 v[214:215], v245 offset:5408
    s_waitcnt lgkmcnt(9)
    v_mfma_f32_16x16x32_bf16 v[152:155], v[196:199], v[216:219], v[152:155]
    ds_read_b128 v[196:199], v242 offset:13760
    ds_read_b64 v[216:217], v245 offset:5472
    ds_read_b64 v[218:219], v245 offset:5480
    v_mfma_f32_16x16x32_bf16 v[156:159], v[200:203], v[220:223], v[156:159]
    ds_read_b128 v[200:203], v242 offset:14080
    ds_read_b64 v[220:221], v245 offset:5544
    ds_read_b64 v[222:223], v245 offset:5552
    s_waitcnt lgkmcnt(9)
    v_mfma_f32_16x16x32_bf16 v[160:163], v[204:207], v[224:227], v[160:163]
    ds_read_b128 v[204:207], v242 offset:14400
    ds_read_b64 v[224:225], v245 offset:5616
    ds_read_b64 v[226:227], v245 offset:5624
    v_mfma_f32_16x16x32_bf16 v[164:167], v[208:211], v[228:231], v[164:167]
    ds_read_b128 v[208:211], v242 offset:14720
    ds_read_b64 v[228:229], v245 offset:5688
    ds_read_b64 v[230:231], v245 offset:5696
    s_waitcnt lgkmcnt(9)
    v_mfma_f32_16x16x32_bf16 v[168:171], v[192:195], v[212:215], v[168:171]
    ds_read_b128 v[192:195], v242 offset:15040
    ds_read_b64 v[212:213], v245 offset:5760
    ds_read_b64 v[214:215], v245 offset:5768
    v_mfma_f32_16x16x32_bf16 v[172:175], v[196:199], v[216:219], v[172:175]
    ds_read_b128 v[196:199], v243 offset:0
    ds_read_b64 v[216:217], v246 offset:0
    ds_read_b64 v[218:219], v246 offset:8
    s_waitcnt lgkmcnt(9)
    v_mfma_f32_16x16x32_bf16 v[176:179], v[200:203], v[220:223], v[176:179]
    ds_read_b128 v[200:203], v243 offset:320
    ds_read_b64 v[220:221], v246 offset:72
    ds_read_b64 v[222:223], v246 offset:80
    v_mfma_f32_16x16x32_bf16 v[180:183], v[204:207], v[224:227], v[180:183]
    ds_read_b128 v[204:207], v243 offset:640
    ds_read_b64 v[224:225], v246 offset:144
    ds_read_b64 v[226:227], v246 offset:152
    s_waitcnt lgkmcnt(9)
    v_mfma_f32_16x16x32_bf16 v[184:187], v[208:211], v[228:231], v[184:187]
    ds_read_b128 v[208:211], v243 offset:960
    ds_read_b64 v[228:229], v246 offset:216
    ds_read_b64 v[230:231], v246 offset:224
    v_mfma_f32_16x16x32_bf16 v[188:191], v[192:195], v[212:215], v[188:191]
    ds_read_b128 v[192:195], v243 offset:1280
    ds_read_b64 v[212:213], v246 offset:288
    ds_read_b64 v[214:215], v246 offset:296
    s_waitcnt lgkmcnt(9)
    ds_write_b32 v254, v255
    v_mfma_f32_16x16x32_bf16 v[0:3], v[196:199], v[216:219], v[0:3]
    ds_read_b128 v[196:199], v243 offset:1600
    ds_read_b64 v[216:217], v246 offset:360
    ds_read_b64 v[218:219], v246 offset:368
    v_mfma_f32_16x16x32_bf16 v[4:7], v[200:203], v[220:223], v[4:7]
    s_waitcnt lgkmcnt(12)
    ds_read_b128 v[200:203], v243 offset:1920
    ds_read_b64 v[220:221], v246 offset:432
    ds_read_b64 v[222:223], v246 offset:440
    s_waitcnt lgkmcnt(9)
    v_mfma_f32_16x16x32_bf16 v[8:11], v[204:207], v[224:227], v[8:11]
    ds_read_b128 v[204:207], v243 offset:2240
    ds_read_b64 v[224:225], v246 offset:504
    ds_read_b64 v[226:227], v246 offset:512
    v_mfma_f32_16x16x32_bf16 v[12:15], v[208:211], v[228:231], v[12:15]
    ds_read_b128 v[208:211], v243 offset:2560
    ds_read_b64 v[228:229], v246 offset:584
    ds_read_b64 v[230:231], v246 offset:592
    s_waitcnt lgkmcnt(9)
    v_mfma_f32_16x16x32_bf16 v[16:19], v[192:195], v[212:215], v[16:19]
    ds_read_b128 v[192:195], v243 offset:2880
    ds_read_b64 v[212:213], v246 offset:656
    ds_read_b64 v[214:215], v246 offset:664
    v_mfma_f32_16x16x32_bf16 v[20:23], v[196:199], v[216:219], v[20:23]
    ds_read_b128 v[196:199], v243 offset:3200
    ds_read_b64 v[216:217], v246 offset:728
    ds_read_b64 v[218:219], v246 offset:736
    s_waitcnt lgkmcnt(9)
    v_mfma_f32_16x16x32_bf16 v[24:27], v[200:203], v[220:223], v[24:27]
    ds_read_b128 v[200:203], v243 offset:3520
    ds_read_b64 v[220:221], v246 offset:800
    ds_read_b64 v[222:223], v246 offset:808
    v_mfma_f32_16x16x32_bf16 v[28:31], v[204:207], v[224:227], v[28:31]
    ds_read_b128 v[204:207], v243 offset:3840
    ds_read_b64 v[224:225], v246 offset:872
    ds_read_b64 v[226:227], v246 offset:880
    s_waitcnt lgkmcnt(9)
    v_mfma_f32_16x16x32_bf16 v[32:35], v[208:211], v[228:231], v[32:35]
    ds_read_b128 v[208:211], v243 offset:4160
    ds_read_b64 v[228:229], v246 offset:944
    ds_read_b64 v[230:231], v246 offset:952
    v_mfma_f32_16x16x32_bf16 v[36:39], v[192:195], v[212:215], v[36:39]
    ds_read_b128 v[192:195], v243 offset:4480
    ds_read_b64 v[212:213], v246 offset:1016
    ds_read_b64 v[214:215], v246 offset:1024
    s_waitcnt lgkmcnt(9)
    v_mfma_f32_16x16x32_bf16 v[40:43], v[196:199], v[216:219], v[40:43]
    ds_read_b128 v[196:199], v243 offset:4800
    ds_read_b64 v[216:217], v246 offset:1088
    ds_read_b64 v[218:219], v246 offset:1096
    v_mfma_f32_16x16x32_bf16 v[44:47], v[200:203], v[220:223], v[44:47]
    ds_read_b128 v[200:203], v243 offset:5120
    ds_read_b64 v[220:221], v246 offset:2336
    ds_read_b64 v[222:223], v246 offset:2344
    s_waitcnt lgkmcnt(9)
    v_mfma_f32_16x16x32_bf16 v[48:51], v[204:207], v[224:227], v[48:51]
    ds_read_b128 v[204:207], v243 offset:5440
    ds_read_b64 v[224:225], v246 offset:2408
    ds_read_b64 v[226:227], v246 offset:2416
    v_mfma_f32_16x16x32_bf16 v[52:55], v[208:211], v[228:231], v[52:55]
    ds_read_b128 v[208:211], v243 offset:5760
    ds_read_b64 v[228:229], v246 offset:2480
    ds_read_b64 v[230:231], v246 offset:2488
    s_waitcnt lgkmcnt(9)
    v_mfma_f32_16x16x32_bf16 v[56:59], v[192:195], v[212:215], v[56:59]
    ds_read_b128 v[192:195], v243 offset:6080
    ds_read_b64 v[212:213], v246 offset:2552
    ds_read_b64 v[214:215], v246 offset:2560
    v_mfma_f32_16x16x32_bf16 v[60:63], v[196:199], v[216:219], v[60:63]
    ds_read_b128 v[196:199], v243 offset:6400
    ds_read_b64 v[216:217], v246 offset:2624
    ds_read_b64 v[218:219], v246 offset:2632
    s_waitcnt lgkmcnt(9)
    v_mfma_f32_16x16x32_bf16 v[64:67], v[200:203], v[220:223], v[64:67]
    ds_read_b128 v[200:203], v243 offset:6720
    ds_read_b64 v[220:221], v246 offset:2696
    ds_read_b64 v[222:223], v246 offset:2704
    v_mfma_f32_16x16x32_bf16 v[68:71], v[204:207], v[224:227], v[68:71]
    ds_read_b128 v[204:207], v243 offset:7040
    ds_read_b64 v[224:225], v246 offset:2768
    ds_read_b64 v[226:227], v246 offset:2776
    s_waitcnt lgkmcnt(9)
    v_mfma_f32_16x16x32_bf16 v[72:75], v[208:211], v[228:231], v[72:75]
    ds_read_b128 v[208:211], v243 offset:7360
    ds_read_b64 v[228:229], v246 offset:2840
    ds_read_b64 v[230:231], v246 offset:2848
    v_mfma_f32_16x16x32_bf16 v[76:79], v[192:195], v[212:215], v[76:79]
    ds_read_b128 v[192:195], v243 offset:7680
    ds_read_b64 v[212:213], v246 offset:2920
    ds_read_b64 v[214:215], v246 offset:2928
    s_waitcnt lgkmcnt(9)
    v_mfma_f32_16x16x32_bf16 v[80:83], v[196:199], v[216:219], v[80:83]
    ds_read_b128 v[196:199], v243 offset:8000
    ds_read_b64 v[216:217], v246 offset:2992
    ds_read_b64 v[218:219], v246 offset:3000
    v_mfma_f32_16x16x32_bf16 v[84:87], v[200:203], v[220:223], v[84:87]
    ds_read_b128 v[200:203], v243 offset:8320
    ds_read_b64 v[220:221], v246 offset:3064
    ds_read_b64 v[222:223], v246 offset:3072
    s_waitcnt lgkmcnt(9)
    v_mfma_f32_16x16x32_bf16 v[88:91], v[204:207], v[224:227], v[88:91]
    ds_read_b128 v[204:207], v243 offset:8640
    ds_read_b64 v[224:225], v246 offset:3136
    ds_read_b64 v[226:227], v246 offset:3144
    v_mfma_f32_16x16x32_bf16 v[92:95], v[208:211], v[228:231], v[92:95]
    ds_read_b128 v[208:211], v243 offset:8960
    ds_read_b64 v[228:229], v246 offset:3208
    ds_read_b64 v[230:231], v246 offset:3216
    s_waitcnt lgkmcnt(9)
    v_mfma_f32_16x16x32_bf16 v[96:99], v[192:195], v[212:215], v[96:99]
    ds_read_b128 v[192:195], v243 offset:9280
    ds_read_b64 v[212:213], v246 offset:3280
    ds_read_b64 v[214:215], v246 offset:3288
    v_mfma_f32_16x16x32_bf16 v[100:103], v[196:199], v[216:219], v[100:103]
    ds_read_b128 v[196:199], v243 offset:9600
    ds_read_b64 v[216:217], v246 offset:3352
    ds_read_b64 v[218:219], v246 offset:3360
    s_waitcnt lgkmcnt(9)
    v_mfma_f32_16x16x32_bf16 v[104:107], v[200:203], v[220:223], v[104:107]
    ds_read_b128 v[200:203], v243 offset:9920
    ds_read_b64 v[220:221], v246 offset:3424
    ds_read_b64 v[222:223], v246 offset:3432
    v_mfma_f32_16x16x32_bf16 v[108:111], v[204:207], v[224:227], v[108:111]
    ds_read_b128 v[204:207], v243 offset:10240
    ds_read_b64 v[224:225], v246 offset:4672
    ds_read_b64 v[226:227], v246 offset:4680
    s_waitcnt lgkmcnt(9)
    v_mfma_f32_16x16x32_bf16 v[112:115], v[208:211], v[228:231], v[112:115]
    ds_read_b128 v[208:211], v243 offset:10560
    ds_read_b64 v[228:229], v246 offset:4744
    ds_read_b64 v[230:231], v246 offset:4752
    v_mfma_f32_16x16x32_bf16 v[116:119], v[192:195], v[212:215], v[116:119]
    ds_read_b128 v[192:195], v243 offset:10880
    ds_read_b64 v[212:213], v246 offset:4816
    ds_read_b64 v[214:215], v246 offset:4824
    s_waitcnt lgkmcnt(9)
    v_mfma_f32_16x16x32_bf16 v[120:123], v[196:199], v[216:219], v[120:123]
    ds_read_b128 v[196:199], v243 offset:11200
    ds_read_b64 v[216:217], v246 offset:4888
    ds_read_b64 v[218:219], v246 offset:4896
    v_mfma_f32_16x16x32_bf16 v[124:127], v[200:203], v[220:223], v[124:127]
    ds_read_b128 v[200:203], v243 offset:11520
    ds_read_b64 v[220:221], v246 offset:4960
    ds_read_b64 v[222:223], v246 offset:4968
    s_waitcnt lgkmcnt(9)
    v_mfma_f32_16x16x32_bf16 v[128:131], v[204:207], v[224:227], v[128:131]
    ds_read_b128 v[204:207], v243 offset:11840
    ds_read_b64 v[224:225], v246 offset:5032
    ds_read_b64 v[226:227], v246 offset:5040
    v_mfma_f32_16x16x32_bf16 v[132:135], v[208:211], v[228:231], v[132:135]
    ds_read_b128 v[208:211], v243 offset:12160
    ds_read_b64 v[228:229], v246 offset:5104
    ds_read_b64 v[230:231], v246 offset:5112
    s_waitcnt lgkmcnt(9)
    v_mfma_f32_16x16x32_bf16 v[136:139], v[192:195], v[212:215], v[136:139]
    ds_read_b128 v[192:195], v243 offset:12480
    ds_read_b64 v[212:213], v246 offset:5176
    ds_read_b64 v[214:215], v246 offset:5184
    v_mfma_f32_16x16x32_bf16 v[140:143], v[196:199], v[216:219], v[140:143]
    ds_read_b128 v[196:199], v243 offset:12800
    ds_read_b64 v[216:217], v246 offset:5256
    ds_read_b64 v[218:219], v246 offset:5264
    s_waitcnt lgkmcnt(9)
    v_mfma_f32_16x16x32_bf16 v[144:147], v[200:203], v[220:223], v[144:147]
    ds_read_b128 v[200:203], v243 offset:13120
    ds_read_b64 v[220:221], v246 offset:5328
    ds_read_b64 v[222:223], v246 offset:5336
    v_mfma_f32_16x16x32_bf16 v[148:151], v[204:207], v[224:227], v[148:151]
    ds_read_b128 v[204:207], v243 offset:13440
    ds_read_b64 v[224:225], v246 offset:5400
    ds_read_b64 v[226:227], v246 offset:5408
    s_waitcnt lgkmcnt(9)
    v_mfma_f32_16x16x32_bf16 v[152:155], v[208:211], v[228:231], v[152:155]
    ds_read_b128 v[208:211], v243 offset:13760
    ds_read_b64 v[228:229], v246 offset:5472
    ds_read_b64 v[230:231], v246 offset:5480
    v_mfma_f32_16x16x32_bf16 v[156:159], v[192:195], v[212:215], v[156:159]
    ds_read_b128 v[192:195], v243 offset:14080
    ds_read_b64 v[212:213], v246 offset:5544
    ds_read_b64 v[214:215], v246 offset:5552
    s_waitcnt lgkmcnt(9)
    v_mfma_f32_16x16x32_bf16 v[160:163], v[196:199], v[216:219], v[160:163]
    ds_read_b128 v[196:199], v243 offset:14400
    ds_read_b64 v[216:217], v246 offset:5616
    ds_read_b64 v[218:219], v246 offset:5624
    v_mfma_f32_16x16x32_bf16 v[164:167], v[200:203], v[220:223], v[164:167]
    ds_read_b128 v[200:203], v243 offset:14720
    ds_read_b64 v[220:221], v246 offset:5688
    ds_read_b64 v[222:223], v246 offset:5696
    s_waitcnt lgkmcnt(9)
    v_mfma_f32_16x16x32_bf16 v[168:171], v[204:207], v[224:227], v[168:171]
    ds_read_b128 v[204:207], v243 offset:15040
    ds_read_b64 v[224:225], v246 offset:5760
    ds_read_b64 v[226:227], v246 offset:5768
    v_mfma_f32_16x16x32_bf16 v[172:175], v[208:211], v[228:231], v[172:175]
    s_waitcnt lgkmcnt(6)
    v_mfma_f32_16x16x32_bf16 v[176:179], v[192:195], v[212:215], v[176:179]
    v_mfma_f32_16x16x32_bf16 v[180:183], v[196:199], v[216:219], v[180:183]
    s_waitcnt lgkmcnt(0)
    v_mfma_f32_16x16x32_bf16 v[184:187], v[200:203], v[220:223], v[184:187]
    ds_write_b32 v254, v255 offset:4
    v_mfma_f32_16x16x32_bf16 v[188:191], v[204:207], v[224:227], v[188:191]
    s_setprio 2
L_hp2:

    s_cmp_lg_u32 s16, 1
    s_cbranch_scc1 L_nopf
    s_lshr_b32 s26, s2, 3
    s_mul_i32 s26, s26, 2304
    v_lshlrev_b32 v230, 2, v253
    buffer_load_dword v231, v230, s[40:43], s26 offen
    buffer_load_dword v231, v230, s[44:47], s26 offen
L_nopf:

    v_pk_add_f32 v[232:233], v[0:1], v[4:5]
    v_pk_mul_f32 v[236:237], v[0:1], v[0:1]
    v_pk_add_f32 v[234:235], v[2:3], v[6:7]
    v_pk_mul_f32 v[238:239], v[2:3], v[2:3]
    v_pk_fma_f32 v[236:237], v[4:5], v[4:5], v[236:237]
    v_pk_fma_f32 v[238:239], v[6:7], v[6:7], v[238:239]
    v_pk_add_f32 v[232:233], v[232:233], v[8:9]
    v_pk_fma_f32 v[236:237], v[8:9], v[8:9], v[236:237]
    v_pk_add_f32 v[234:235], v[234:235], v[10:11]
    v_pk_fma_f32 v[238:239], v[10:11], v[10:11], v[238:239]
    v_pk_add_f32 v[232:233], v[232:233], v[12:13]
    v_pk_fma_f32 v[236:237], v[12:13], v[12:13], v[236:237]
    v_pk_add_f32 v[234:235], v[234:235], v[14:15]
    v_pk_fma_f32 v[238:239], v[14:15], v[14:15], v[238:239]
    v_pk_add_f32 v[232:233], v[232:233], v[16:17]
    v_pk_fma_f32 v[236:237], v[16:17], v[16:17], v[236:237]
    v_pk_add_f32 v[234:235], v[234:235], v[18:19]
    v_pk_fma_f32 v[238:239], v[18:19], v[18:19], v[238:239]
    v_pk_add_f32 v[232:233], v[232:233], v[20:21]
    v_pk_fma_f32 v[236:237], v[20:21], v[20:21], v[236:237]
    v_pk_add_f32 v[234:235], v[234:235], v[22:23]
    v_pk_fma_f32 v[238:239], v[22:23], v[22:23], v[238:239]
    v_pk_add_f32 v[232:233], v[232:233], v[24:25]
    v_pk_fma_f32 v[236:237], v[24:25], v[24:25], v[236:237]
    v_pk_add_f32 v[234:235], v[234:235], v[26:27]
    v_pk_fma_f32 v[238:239], v[26:27], v[26:27], v[238:239]
    v_pk_add_f32 v[232:233], v[232:233], v[28:29]
    v_pk_fma_f32 v[236:237], v[28:29], v[28:29], v[236:237]
    v_pk_add_f32 v[234:235], v[234:235], v[30:31]
    v_pk_fma_f32 v[238:239], v[30:31], v[30:31], v[238:239]
    v_pk_add_f32 v[232:233], v[232:233], v[32:33]
    v_pk_fma_f32 v[236:237], v[32:33], v[32:33], v[236:237]
    v_pk_add_f32 v[234:235], v[234:235], v[34:35]
    v_pk_fma_f32 v[238:239], v[34:35], v[34:35], v[238:239]
    v_pk_add_f32 v[232:233], v[232:233], v[36:37]
    v_pk_fma_f32 v[236:237], v[36:37], v[36:37], v[236:237]
    v_pk_add_f32 v[234:235], v[234:235], v[38:39]
    v_pk_fma_f32 v[238:239], v[38:39], v[38:39], v[238:239]
    v_pk_add_f32 v[232:233], v[232:233], v[40:41]
    v_pk_fma_f32 v[236:237], v[40:41], v[40:41], v[236:237]
    v_pk_add_f32 v[234:235], v[234:235], v[42:43]
    v_pk_fma_f32 v[238:239], v[42:43], v[42:43], v[238:239]
    v_pk_add_f32 v[232:233], v[232:233], v[44:45]
    v_pk_fma_f32 v[236:237], v[44:45], v[44:45], v[236:237]
    v_pk_add_f32 v[234:235], v[234:235], v[46:47]
    v_pk_fma_f32 v[238:239], v[46:47], v[46:47], v[238:239]
    v_pk_add_f32 v[232:233], v[232:233], v[48:49]
    v_pk_fma_f32 v[236:237], v[48:49], v[48:49], v[236:237]
    v_pk_add_f32 v[234:235], v[234:235], v[50:51]
    v_pk_fma_f32 v[238:239], v[50:51], v[50:51], v[238:239]
    v_pk_add_f32 v[232:233], v[232:233], v[52:53]
    v_pk_fma_f32 v[236:237], v[52:53], v[52:53], v[236:237]
    v_pk_add_f32 v[234:235], v[234:235], v[54:55]
    v_pk_fma_f32 v[238:239], v[54:55], v[54:55], v[238:239]
    v_pk_add_f32 v[232:233], v[232:233], v[56:57]
    v_pk_fma_f32 v[236:237], v[56:57], v[56:57], v[236:237]
    v_pk_add_f32 v[234:235], v[234:235], v[58:59]
    v_pk_fma_f32 v[238:239], v[58:59], v[58:59], v[238:239]
    v_pk_add_f32 v[232:233], v[232:233], v[60:61]
    v_pk_fma_f32 v[236:237], v[60:61], v[60:61], v[236:237]
    v_pk_add_f32 v[234:235], v[234:235], v[62:63]
    v_pk_fma_f32 v[238:239], v[62:63], v[62:63], v[238:239]
    v_pk_add_f32 v[232:233], v[232:233], v[64:65]
    v_pk_fma_f32 v[236:237], v[64:65], v[64:65], v[236:237]
    v_pk_add_f32 v[234:235], v[234:235], v[66:67]
    v_pk_fma_f32 v[238:239], v[66:67], v[66:67], v[238:239]
    v_pk_add_f32 v[232:233], v[232:233], v[68:69]
    v_pk_fma_f32 v[236:237], v[68:69], v[68:69], v[236:237]
    v_pk_add_f32 v[234:235], v[234:235], v[70:71]
    v_pk_fma_f32 v[238:239], v[70:71], v[70:71], v[238:239]
    v_pk_add_f32 v[232:233], v[232:233], v[72:73]
    v_pk_fma_f32 v[236:237], v[72:73], v[72:73], v[236:237]
    v_pk_add_f32 v[234:235], v[234:235], v[74:75]
    v_pk_fma_f32 v[238:239], v[74:75], v[74:75], v[238:239]
    v_pk_add_f32 v[232:233], v[232:233], v[76:77]
    v_pk_fma_f32 v[236:237], v[76:77], v[76:77], v[236:237]
    v_pk_add_f32 v[234:235], v[234:235], v[78:79]
    v_pk_fma_f32 v[238:239], v[78:79], v[78:79], v[238:239]
    v_pk_add_f32 v[232:233], v[232:233], v[80:81]
    v_pk_fma_f32 v[236:237], v[80:81], v[80:81], v[236:237]
    v_pk_add_f32 v[234:235], v[234:235], v[82:83]
    v_pk_fma_f32 v[238:239], v[82:83], v[82:83], v[238:239]
    v_pk_add_f32 v[232:233], v[232:233], v[84:85]
    v_pk_fma_f32 v[236:237], v[84:85], v[84:85], v[236:237]
    v_pk_add_f32 v[234:235], v[234:235], v[86:87]
    v_pk_fma_f32 v[238:239], v[86:87], v[86:87], v[238:239]
    v_pk_add_f32 v[232:233], v[232:233], v[88:89]
    v_pk_fma_f32 v[236:237], v[88:89], v[88:89], v[236:237]
    v_pk_add_f32 v[234:235], v[234:235], v[90:91]
    v_pk_fma_f32 v[238:239], v[90:91], v[90:91], v[238:239]
    v_pk_add_f32 v[232:233], v[232:233], v[92:93]
    v_pk_fma_f32 v[236:237], v[92:93], v[92:93], v[236:237]
    v_pk_add_f32 v[234:235], v[234:235], v[94:95]
    v_pk_fma_f32 v[238:239], v[94:95], v[94:95], v[238:239]
    v_pk_add_f32 v[232:233], v[232:233], v[96:97]
    v_pk_fma_f32 v[236:237], v[96:97], v[96:97], v[236:237]
    v_pk_add_f32 v[234:235], v[234:235], v[98:99]
    v_pk_fma_f32 v[238:239], v[98:99], v[98:99], v[238:239]
    v_pk_add_f32 v[232:233], v[232:233], v[100:101]
    v_pk_fma_f32 v[236:237], v[100:101], v[100:101], v[236:237]
    v_pk_add_f32 v[234:235], v[234:235], v[102:103]
    v_pk_fma_f32 v[238:239], v[102:103], v[102:103], v[238:239]
    v_pk_add_f32 v[232:233], v[232:233], v[104:105]
    v_pk_fma_f32 v[236:237], v[104:105], v[104:105], v[236:237]
    v_pk_add_f32 v[234:235], v[234:235], v[106:107]
    v_pk_fma_f32 v[238:239], v[106:107], v[106:107], v[238:239]
    v_pk_add_f32 v[232:233], v[232:233], v[108:109]
    v_pk_fma_f32 v[236:237], v[108:109], v[108:109], v[236:237]
    v_pk_add_f32 v[234:235], v[234:235], v[110:111]
    v_pk_fma_f32 v[238:239], v[110:111], v[110:111], v[238:239]
    v_pk_add_f32 v[232:233], v[232:233], v[112:113]
    v_pk_fma_f32 v[236:237], v[112:113], v[112:113], v[236:237]
    v_pk_add_f32 v[234:235], v[234:235], v[114:115]
    v_pk_fma_f32 v[238:239], v[114:115], v[114:115], v[238:239]
    v_pk_add_f32 v[232:233], v[232:233], v[116:117]
    v_pk_fma_f32 v[236:237], v[116:117], v[116:117], v[236:237]
    v_pk_add_f32 v[234:235], v[234:235], v[118:119]
    v_pk_fma_f32 v[238:239], v[118:119], v[118:119], v[238:239]
    v_pk_add_f32 v[232:233], v[232:233], v[120:121]
    v_pk_fma_f32 v[236:237], v[120:121], v[120:121], v[236:237]
    v_pk_add_f32 v[234:235], v[234:235], v[122:123]
    v_pk_fma_f32 v[238:239], v[122:123], v[122:123], v[238:239]
    v_pk_add_f32 v[232:233], v[232:233], v[124:125]
    v_pk_fma_f32 v[236:237], v[124:125], v[124:125], v[236:237]
    v_pk_add_f32 v[234:235], v[234:235], v[126:127]
    v_pk_fma_f32 v[238:239], v[126:127], v[126:127], v[238:239]
    v_pk_add_f32 v[232:233], v[232:233], v[128:129]
    v_pk_fma_f32 v[236:237], v[128:129], v[128:129], v[236:237]
    v_pk_add_f32 v[234:235], v[234:235], v[130:131]
    v_pk_fma_f32 v[238:239], v[130:131], v[130:131], v[238:239]
    v_pk_add_f32 v[232:233], v[232:233], v[132:133]
    v_pk_fma_f32 v[236:237], v[132:133], v[132:133], v[236:237]
    v_pk_add_f32 v[234:235], v[234:235], v[134:135]
    v_pk_fma_f32 v[238:239], v[134:135], v[134:135], v[238:239]
    v_pk_add_f32 v[232:233], v[232:233], v[136:137]
    v_pk_fma_f32 v[236:237], v[136:137], v[136:137], v[236:237]
    v_pk_add_f32 v[234:235], v[234:235], v[138:139]
    v_pk_fma_f32 v[238:239], v[138:139], v[138:139], v[238:239]
    v_pk_add_f32 v[232:233], v[232:233], v[140:141]
    v_pk_fma_f32 v[236:237], v[140:141], v[140:141], v[236:237]
    v_pk_add_f32 v[234:235], v[234:235], v[142:143]
    v_pk_fma_f32 v[238:239], v[142:143], v[142:143], v[238:239]
    v_pk_add_f32 v[232:233], v[232:233], v[144:145]
    v_pk_fma_f32 v[236:237], v[144:145], v[144:145], v[236:237]
    v_pk_add_f32 v[234:235], v[234:235], v[146:147]
    v_pk_fma_f32 v[238:239], v[146:147], v[146:147], v[238:239]
    v_pk_add_f32 v[232:233], v[232:233], v[148:149]
    v_pk_fma_f32 v[236:237], v[148:149], v[148:149], v[236:237]
    v_pk_add_f32 v[234:235], v[234:235], v[150:151]
    v_pk_fma_f32 v[238:239], v[150:151], v[150:151], v[238:239]
    v_pk_add_f32 v[232:233], v[232:233], v[152:153]
    v_pk_fma_f32 v[236:237], v[152:153], v[152:153], v[236:237]
    v_pk_add_f32 v[234:235], v[234:235], v[154:155]
    v_pk_fma_f32 v[238:239], v[154:155], v[154:155], v[238:239]
    v_pk_add_f32 v[232:233], v[232:233], v[156:157]
    v_pk_fma_f32 v[236:237], v[156:157], v[156:157], v[236:237]
    v_pk_add_f32 v[234:235], v[234:235], v[158:159]
    v_pk_fma_f32 v[238:239], v[158:159], v[158:159], v[238:239]
    v_pk_add_f32 v[232:233], v[232:233], v[160:161]
    v_pk_fma_f32 v[236:237], v[160:161], v[160:161], v[236:237]
    v_pk_add_f32 v[234:235], v[234:235], v[162:163]
    v_pk_fma_f32 v[238:239], v[162:163], v[162:163], v[238:239]
    v_pk_add_f32 v[232:233], v[232:233], v[164:165]
    v_pk_fma_f32 v[236:237], v[164:165], v[164:165], v[236:237]
    v_pk_add_f32 v[234:235], v[234:235], v[166:167]
    v_pk_fma_f32 v[238:239], v[166:167], v[166:167], v[238:239]
    v_pk_add_f32 v[232:233], v[232:233], v[168:169]
    v_pk_fma_f32 v[236:237], v[168:169], v[168:169], v[236:237]
    v_pk_add_f32 v[234:235], v[234:235], v[170:171]
    v_pk_fma_f32 v[238:239], v[170:171], v[170:171], v[238:239]
    v_pk_add_f32 v[232:233], v[232:233], v[172:173]
    v_pk_fma_f32 v[236:237], v[172:173], v[172:173], v[236:237]
    v_pk_add_f32 v[234:235], v[234:235], v[174:175]
    v_pk_fma_f32 v[238:239], v[174:175], v[174:175], v[238:239]
    v_pk_add_f32 v[232:233], v[232:233], v[176:177]
    v_pk_fma_f32 v[236:237], v[176:177], v[176:177], v[236:237]
    v_pk_add_f32 v[234:235], v[234:235], v[178:179]
    v_pk_fma_f32 v[238:239], v[178:179], v[178:179], v[238:239]
    v_pk_add_f32 v[232:233], v[232:233], v[180:181]
    v_pk_fma_f32 v[236:237], v[180:181], v[180:181], v[236:237]
    v_pk_add_f32 v[234:235], v[234:235], v[182:183]
    v_pk_fma_f32 v[238:239], v[182:183], v[182:183], v[238:239]
    v_pk_add_f32 v[232:233], v[232:233], v[184:185]
    v_pk_fma_f32 v[236:237], v[184:185], v[184:185], v[236:237]
    v_pk_add_f32 v[234:235], v[234:235], v[186:187]
    v_pk_fma_f32 v[238:239], v[186:187], v[186:187], v[238:239]
    v_pk_add_f32 v[232:233], v[232:233], v[188:189]
    v_pk_fma_f32 v[236:237], v[188:189], v[188:189], v[236:237]
    v_pk_add_f32 v[234:235], v[234:235], v[190:191]
    v_pk_fma_f32 v[238:239], v[190:191], v[190:191], v[238:239]

    s_nop 1
    v_permlane32_swap_b32 v232, v233
    v_permlane32_swap_b32 v234, v235
    v_permlane32_swap_b32 v236, v237
    v_permlane32_swap_b32 v238, v239

    v_add_f32 v232, v232, v233
    v_add_f32_e64 v236, v236, v237
    v_mul_f32 v232, 0x3c2aaaab, v232
    v_mul_f32 v236, 0x3c2aaaab, v236
    v_fma_f32 v236, -v232, v232, v236
    v_max_f32_e64 v236, 0, v236
    v_add_f32 v236, 0x0727c5ac, v236
    v_rsq_f32 v236, v236
    s_nop 0
    v_mul_f32_e64 v232, v232, v236
    v_mul_f32 v236, 0x08000000, v236
    v_mul_f32 v232, 0x88000000, v232
    v_mov_b32 v237, v236
    v_mov_b32 v233, v232

    v_add_f32 v234, v234, v235
    v_add_f32 v238, v238, v239
    v_mul_f32 v234, 0x3c2aaaab, v234
    v_mul_f32 v238, 0x3c2aaaab, v238
    v_fma_f32 v238, -v234, v234, v238
    v_max_f32_e64 v238, 0, v238
    v_add_f32 v238, 0x0727c5ac, v238
    v_rsq_f32 v238, v238
    s_nop 0
    v_mul_f32_e64 v234, v234, v238
    v_mul_f32 v238, 0x08000000, v238
    v_mul_f32 v234, 0x88000000, v234
    v_mov_b32 v239, v238
    v_mov_b32 v235, v234

    s_nop 1
    v_permlane32_swap_b32 v232, v233
    v_permlane32_swap_b32 v234, v235
    v_permlane32_swap_b32 v236, v237
    v_permlane32_swap_b32 v238, v239

    v_pk_fma_f32 v[0:1], v[0:1], v[236:237], v[232:233]
    v_pk_fma_f32 v[2:3], v[2:3], v[238:239], v[234:235]
    v_pk_fma_f32 v[4:5], v[4:5], v[236:237], v[232:233]
    v_pk_fma_f32 v[6:7], v[6:7], v[238:239], v[234:235]
    v_pk_fma_f32 v[8:9], v[8:9], v[236:237], v[232:233]
    v_pk_fma_f32 v[10:11], v[10:11], v[238:239], v[234:235]
    v_pk_fma_f32 v[12:13], v[12:13], v[236:237], v[232:233]
    v_pk_fma_f32 v[14:15], v[14:15], v[238:239], v[234:235]
    v_pk_fma_f32 v[16:17], v[16:17], v[236:237], v[232:233]
    v_pk_fma_f32 v[18:19], v[18:19], v[238:239], v[234:235]
    v_pk_fma_f32 v[20:21], v[20:21], v[236:237], v[232:233]
    v_pk_fma_f32 v[22:23], v[22:23], v[238:239], v[234:235]
    v_pk_fma_f32 v[24:25], v[24:25], v[236:237], v[232:233]
    v_pk_fma_f32 v[26:27], v[26:27], v[238:239], v[234:235]
    v_pk_fma_f32 v[28:29], v[28:29], v[236:237], v[232:233]
    v_pk_fma_f32 v[30:31], v[30:31], v[238:239], v[234:235]
    v_pk_fma_f32 v[32:33], v[32:33], v[236:237], v[232:233]
    v_pk_fma_f32 v[34:35], v[34:35], v[238:239], v[234:235]
    v_pk_fma_f32 v[36:37], v[36:37], v[236:237], v[232:233]
    v_pk_fma_f32 v[38:39], v[38:39], v[238:239], v[234:235]
    v_pk_fma_f32 v[40:41], v[40:41], v[236:237], v[232:233]
    v_pk_fma_f32 v[42:43], v[42:43], v[238:239], v[234:235]
    v_pk_fma_f32 v[44:45], v[44:45], v[236:237], v[232:233]
    v_pk_fma_f32 v[46:47], v[46:47], v[238:239], v[234:235]
    v_pk_fma_f32 v[48:49], v[48:49], v[236:237], v[232:233]
    v_pk_fma_f32 v[50:51], v[50:51], v[238:239], v[234:235]
    v_pk_fma_f32 v[52:53], v[52:53], v[236:237], v[232:233]
    v_pk_fma_f32 v[54:55], v[54:55], v[238:239], v[234:235]
    v_pk_fma_f32 v[56:57], v[56:57], v[236:237], v[232:233]
    v_pk_fma_f32 v[58:59], v[58:59], v[238:239], v[234:235]
    v_pk_fma_f32 v[60:61], v[60:61], v[236:237], v[232:233]
    v_pk_fma_f32 v[62:63], v[62:63], v[238:239], v[234:235]
    v_cvt_pk_bf16_f32 v192, v0, v4
    v_cvt_pk_bf16_f32 v193, v8, v12
    v_cvt_pk_bf16_f32 v194, v16, v20
    v_cvt_pk_bf16_f32 v195, v24, v28
    v_cvt_pk_bf16_f32 v200, v32, v36
    v_cvt_pk_bf16_f32 v201, v40, v44
    v_cvt_pk_bf16_f32 v202, v48, v52
    v_cvt_pk_bf16_f32 v203, v56, v60
    v_cvt_pk_bf16_f32 v196, v1, v5
    v_cvt_pk_bf16_f32 v197, v9, v13
    v_cvt_pk_bf16_f32 v198, v17, v21
    v_cvt_pk_bf16_f32 v199, v25, v29
    v_cvt_pk_bf16_f32 v204, v33, v37
    v_cvt_pk_bf16_f32 v205, v41, v45
    v_cvt_pk_bf16_f32 v206, v49, v53
    v_cvt_pk_bf16_f32 v207, v57, v61
    v_cvt_pk_bf16_f32 v208, v2, v6
    v_cvt_pk_bf16_f32 v209, v10, v14
    v_cvt_pk_bf16_f32 v210, v18, v22
    v_cvt_pk_bf16_f32 v211, v26, v30
    v_cvt_pk_bf16_f32 v216, v34, v38
    v_cvt_pk_bf16_f32 v217, v42, v46
    v_cvt_pk_bf16_f32 v218, v50, v54
    v_cvt_pk_bf16_f32 v219, v58, v62
    v_cvt_pk_bf16_f32 v212, v3, v7
    v_cvt_pk_bf16_f32 v213, v11, v15
    v_cvt_pk_bf16_f32 v214, v19, v23
    v_cvt_pk_bf16_f32 v215, v27, v31
    v_cvt_pk_bf16_f32 v220, v35, v39
    v_cvt_pk_bf16_f32 v221, v43, v47
    v_cvt_pk_bf16_f32 v222, v51, v55
    v_cvt_pk_bf16_f32 v223, v59, v63
    s_nop 0
    v_permlane16_swap_b32 v192, v200
    v_permlane16_swap_b32 v193, v201
    v_permlane16_swap_b32 v194, v202
    v_permlane16_swap_b32 v195, v203
    v_permlane16_swap_b32 v196, v204
    v_permlane16_swap_b32 v197, v205
    v_permlane16_swap_b32 v198, v206
    v_permlane16_swap_b32 v199, v207
    v_permlane16_swap_b32 v208, v216
    v_permlane16_swap_b32 v209, v217
    v_permlane16_swap_b32 v210, v218
    v_permlane16_swap_b32 v211, v219
    v_permlane16_swap_b32 v212, v220
    v_permlane16_swap_b32 v213, v221
    v_permlane16_swap_b32 v214, v222
    v_permlane16_swap_b32 v215, v223
    v_mov_b32 v0, v208
    v_mov_b32 v1, v209
    v_mov_b32 v2, v210
    v_mov_b32 v3, v211
    v_mov_b32 v4, v212
    v_mov_b32 v5, v213
    v_mov_b32 v6, v214
    v_mov_b32 v7, v215
    v_mov_b32 v8, v216
    v_mov_b32 v9, v217
    v_mov_b32 v10, v218
    v_mov_b32 v11, v219
    v_mov_b32 v12, v220
    v_mov_b32 v13, v221
    v_mov_b32 v14, v222
    v_mov_b32 v15, v223
    v_pk_fma_f32 v[64:65], v[64:65], v[236:237], v[232:233]
    v_pk_fma_f32 v[66:67], v[66:67], v[238:239], v[234:235]
    v_pk_fma_f32 v[68:69], v[68:69], v[236:237], v[232:233]
    v_pk_fma_f32 v[70:71], v[70:71], v[238:239], v[234:235]
    v_pk_fma_f32 v[72:73], v[72:73], v[236:237], v[232:233]
    v_pk_fma_f32 v[74:75], v[74:75], v[238:239], v[234:235]
    v_pk_fma_f32 v[76:77], v[76:77], v[236:237], v[232:233]
    v_pk_fma_f32 v[78:79], v[78:79], v[238:239], v[234:235]
    v_pk_fma_f32 v[80:81], v[80:81], v[236:237], v[232:233]
    v_pk_fma_f32 v[82:83], v[82:83], v[238:239], v[234:235]
    v_pk_fma_f32 v[84:85], v[84:85], v[236:237], v[232:233]
    v_pk_fma_f32 v[86:87], v[86:87], v[238:239], v[234:235]
    v_pk_fma_f32 v[88:89], v[88:89], v[236:237], v[232:233]
    v_pk_fma_f32 v[90:91], v[90:91], v[238:239], v[234:235]
    v_pk_fma_f32 v[92:93], v[92:93], v[236:237], v[232:233]
    v_pk_fma_f32 v[94:95], v[94:95], v[238:239], v[234:235]
    v_pk_fma_f32 v[96:97], v[96:97], v[236:237], v[232:233]
    v_pk_fma_f32 v[98:99], v[98:99], v[238:239], v[234:235]
    v_pk_fma_f32 v[100:101], v[100:101], v[236:237], v[232:233]
    v_pk_fma_f32 v[102:103], v[102:103], v[238:239], v[234:235]
    v_pk_fma_f32 v[104:105], v[104:105], v[236:237], v[232:233]
    v_pk_fma_f32 v[106:107], v[106:107], v[238:239], v[234:235]
    v_pk_fma_f32 v[108:109], v[108:109], v[236:237], v[232:233]
    v_pk_fma_f32 v[110:111], v[110:111], v[238:239], v[234:235]
    v_pk_fma_f32 v[112:113], v[112:113], v[236:237], v[232:233]
    v_pk_fma_f32 v[114:115], v[114:115], v[238:239], v[234:235]
    v_pk_fma_f32 v[116:117], v[116:117], v[236:237], v[232:233]
    v_pk_fma_f32 v[118:119], v[118:119], v[238:239], v[234:235]
    v_pk_fma_f32 v[120:121], v[120:121], v[236:237], v[232:233]
    v_pk_fma_f32 v[122:123], v[122:123], v[238:239], v[234:235]
    v_pk_fma_f32 v[124:125], v[124:125], v[236:237], v[232:233]
    v_pk_fma_f32 v[126:127], v[126:127], v[238:239], v[234:235]
    v_cvt_pk_bf16_f32 v48, v64, v68
    v_cvt_pk_bf16_f32 v49, v72, v76
    v_cvt_pk_bf16_f32 v50, v80, v84
    v_cvt_pk_bf16_f32 v51, v88, v92
    v_cvt_pk_bf16_f32 v56, v96, v100
    v_cvt_pk_bf16_f32 v57, v104, v108
    v_cvt_pk_bf16_f32 v58, v112, v116
    v_cvt_pk_bf16_f32 v59, v120, v124
    v_cvt_pk_bf16_f32 v52, v65, v69
    v_cvt_pk_bf16_f32 v53, v73, v77
    v_cvt_pk_bf16_f32 v54, v81, v85
    v_cvt_pk_bf16_f32 v55, v89, v93
    v_cvt_pk_bf16_f32 v60, v97, v101
    v_cvt_pk_bf16_f32 v61, v105, v109
    v_cvt_pk_bf16_f32 v62, v113, v117
    v_cvt_pk_bf16_f32 v63, v121, v125
    v_cvt_pk_bf16_f32 v16, v66, v70
    v_cvt_pk_bf16_f32 v17, v74, v78
    v_cvt_pk_bf16_f32 v18, v82, v86
    v_cvt_pk_bf16_f32 v19, v90, v94
    v_cvt_pk_bf16_f32 v24, v98, v102
    v_cvt_pk_bf16_f32 v25, v106, v110
    v_cvt_pk_bf16_f32 v26, v114, v118
    v_cvt_pk_bf16_f32 v27, v122, v126
    v_cvt_pk_bf16_f32 v20, v67, v71
    v_cvt_pk_bf16_f32 v21, v75, v79
    v_cvt_pk_bf16_f32 v22, v83, v87
    v_cvt_pk_bf16_f32 v23, v91, v95
    v_cvt_pk_bf16_f32 v28, v99, v103
    v_cvt_pk_bf16_f32 v29, v107, v111
    v_cvt_pk_bf16_f32 v30, v115, v119
    v_cvt_pk_bf16_f32 v31, v123, v127
    s_nop 0
    v_permlane16_swap_b32 v48, v56
    v_permlane16_swap_b32 v49, v57
    v_permlane16_swap_b32 v50, v58
    v_permlane16_swap_b32 v51, v59
    v_permlane16_swap_b32 v52, v60
    v_permlane16_swap_b32 v53, v61
    v_permlane16_swap_b32 v54, v62
    v_permlane16_swap_b32 v55, v63
    v_permlane16_swap_b32 v16, v24
    v_permlane16_swap_b32 v17, v25
    v_permlane16_swap_b32 v18, v26
    v_permlane16_swap_b32 v19, v27
    v_permlane16_swap_b32 v20, v28
    v_permlane16_swap_b32 v21, v29
    v_permlane16_swap_b32 v22, v30
    v_permlane16_swap_b32 v23, v31
    v_mov_b32 v80, v192
    v_mov_b32 v81, v193
    v_mov_b32 v82, v194
    v_mov_b32 v83, v195
    v_mov_b32 v84, v196
    v_mov_b32 v85, v197
    v_mov_b32 v86, v198
    v_mov_b32 v87, v199
    v_mov_b32 v88, v200
    v_mov_b32 v89, v201
    v_mov_b32 v90, v202
    v_mov_b32 v91, v203
    v_mov_b32 v92, v204
    v_mov_b32 v93, v205
    v_mov_b32 v94, v206
    v_mov_b32_e64 v95, v207
    v_pk_fma_f32 v[128:129], v[128:129], v[236:237], v[232:233]
    v_pk_fma_f32 v[130:131], v[130:131], v[238:239], v[234:235]
    v_pk_fma_f32 v[132:133], v[132:133], v[236:237], v[232:233]
    v_pk_fma_f32 v[134:135], v[134:135], v[238:239], v[234:235]
    v_pk_fma_f32 v[136:137], v[136:137], v[236:237], v[232:233]
    v_pk_fma_f32 v[138:139], v[138:139], v[238:239], v[234:235]
    v_pk_fma_f32 v[140:141], v[140:141], v[236:237], v[232:233]
    v_pk_fma_f32 v[142:143], v[142:143], v[238:239], v[234:235]
    v_pk_fma_f32 v[144:145], v[144:145], v[236:237], v[232:233]
    v_pk_fma_f32 v[146:147], v[146:147], v[238:239], v[234:235]
    v_pk_fma_f32 v[148:149], v[148:149], v[236:237], v[232:233]
    v_pk_fma_f32 v[150:151], v[150:151], v[238:239], v[234:235]
    v_pk_fma_f32 v[152:153], v[152:153], v[236:237], v[232:233]
    v_pk_fma_f32 v[154:155], v[154:155], v[238:239], v[234:235]
    v_pk_fma_f32 v[156:157], v[156:157], v[236:237], v[232:233]
    v_pk_fma_f32 v[158:159], v[158:159], v[238:239], v[234:235]
    v_pk_fma_f32 v[160:161], v[160:161], v[236:237], v[232:233]
    v_pk_fma_f32 v[162:163], v[162:163], v[238:239], v[234:235]
    v_pk_fma_f32 v[164:165], v[164:165], v[236:237], v[232:233]
    v_pk_fma_f32 v[166:167], v[166:167], v[238:239], v[234:235]
    v_pk_fma_f32 v[168:169], v[168:169], v[236:237], v[232:233]
    v_pk_fma_f32 v[170:171], v[170:171], v[238:239], v[234:235]
    v_pk_fma_f32 v[172:173], v[172:173], v[236:237], v[232:233]
    v_pk_fma_f32 v[174:175], v[174:175], v[238:239], v[234:235]
    v_pk_fma_f32 v[176:177], v[176:177], v[236:237], v[232:233]
    v_pk_fma_f32 v[178:179], v[178:179], v[238:239], v[234:235]
    v_pk_fma_f32 v[180:181], v[180:181], v[236:237], v[232:233]
    v_pk_fma_f32 v[182:183], v[182:183], v[238:239], v[234:235]
    v_pk_fma_f32 v[184:185], v[184:185], v[236:237], v[232:233]
    v_pk_fma_f32 v[186:187], v[186:187], v[238:239], v[234:235]
    v_pk_fma_f32 v[188:189], v[188:189], v[236:237], v[232:233]
    v_pk_fma_f32 v[190:191], v[190:191], v[238:239], v[234:235]
    v_cvt_pk_bf16_f32 v64, v128, v132
    v_cvt_pk_bf16_f32 v65, v136, v140
    v_cvt_pk_bf16_f32 v66, v144, v148
    v_cvt_pk_bf16_f32 v67, v152, v156
    v_cvt_pk_bf16_f32 v72, v160, v164
    v_cvt_pk_bf16_f32 v73, v168, v172
    v_cvt_pk_bf16_f32 v74, v176, v180
    v_cvt_pk_bf16_f32 v75, v184, v188
    v_cvt_pk_bf16_f32 v68, v129, v133
    v_cvt_pk_bf16_f32 v69, v137, v141
    v_cvt_pk_bf16_f32 v70, v145, v149
    v_cvt_pk_bf16_f32 v71, v153, v157
    v_cvt_pk_bf16_f32 v76, v161, v165
    v_cvt_pk_bf16_f32 v77, v169, v173
    v_cvt_pk_bf16_f32 v78, v177, v181
    v_cvt_pk_bf16_f32 v79, v185, v189
    v_cvt_pk_bf16_f32 v32, v130, v134
    v_cvt_pk_bf16_f32 v33, v138, v142
    v_cvt_pk_bf16_f32 v34, v146, v150
    v_cvt_pk_bf16_f32 v35, v154, v158
    v_cvt_pk_bf16_f32 v40, v162, v166
    v_cvt_pk_bf16_f32 v41, v170, v174
    v_cvt_pk_bf16_f32 v42, v178, v182
    v_cvt_pk_bf16_f32 v43, v186, v190
    v_cvt_pk_bf16_f32 v36, v131, v135
    v_cvt_pk_bf16_f32 v37, v139, v143
    v_cvt_pk_bf16_f32 v38, v147, v151
    v_cvt_pk_bf16_f32 v39, v155, v159
    v_cvt_pk_bf16_f32 v44, v163, v167
    v_cvt_pk_bf16_f32 v45, v171, v175
    v_cvt_pk_bf16_f32 v46, v179, v183
    v_cvt_pk_bf16_f32 v47, v187, v191
    s_nop 0
    v_permlane16_swap_b32 v64, v72
    v_permlane16_swap_b32 v65, v73
    v_permlane16_swap_b32 v66, v74
    v_permlane16_swap_b32 v67, v75
    v_permlane16_swap_b32 v68, v76
    v_permlane16_swap_b32 v69, v77
    v_permlane16_swap_b32 v70, v78
    v_permlane16_swap_b32 v71, v79
    v_permlane16_swap_b32 v32, v40
    v_permlane16_swap_b32 v33, v41
    v_permlane16_swap_b32 v34, v42
    v_permlane16_swap_b32 v35, v43
    v_permlane16_swap_b32 v36, v44
    v_permlane16_swap_b32 v37, v45
    v_permlane16_swap_b32 v38, v46
    v_permlane16_swap_b32 v39, v47

    s_mov_b32 s18, 8
    s_mov_b32 s38, 1
    s_sub_u32 s26, s16, 1
    s_cmp_lt_u32 s26, 7
    s_cbranch_scc1 L_p2
    s_mov_b32 s38, 0

    v_lshrrev_b32 v232, 7, v253
    v_mul_u32_u24 v232, 640, v232
    v_add_u32_e64 v232, v232, v253
    v_add_u32 v233, 196608, v232
    buffer_store_dwordx4 v[48:51], v232, s[8:11], s36 offen offset:0 sc1
    buffer_store_dwordx4 v[52:55], v232, s[8:11], s36 offen offset:128 sc1
    buffer_store_dwordx4 v[56:59], v232, s[8:11], s36 offen offset:256 sc1
    buffer_store_dwordx4 v[60:63], v232, s[8:11], s37 offen offset:0 sc1
    buffer_store_dwordx4 v[64:67], v232, s[8:11], s37 offen offset:128 sc1
    buffer_store_dwordx4 v[68:71], v232, s[8:11], s37 offen offset:256 sc1
    buffer_store_dwordx4 v[72:75], v233, s[8:11], s36 offen offset:0 sc1
    buffer_store_dwordx4 v[76:79], v233, s[8:11], s36 offen offset:128 sc1
    buffer_store_dwordx4 v[80:83], v233, s[8:11], s36 offen offset:256 sc1
    buffer_store_dwordx4 v[84:87], v233, s[8:11], s37 offen offset:0 sc1
    buffer_store_dwordx4 v[88:91], v233, s[8:11], s37 offen offset:128 sc1
    buffer_store_dwordx4 v[92:95], v233, s[8:11], s37 offen offset:256 sc1

    s_cmp_lg_u32 s16, 0
    s_cbranch_scc1 L_p2
    s_setprio 3
    s_branch L_xload
L_loader:

    v_lshrrev_b32_e64 v60, 9, v253
    v_mul_u32_u24 v61, 1536, v60
    v_add_u32_e64 v61, v61, v253
    v_bfe_u32 v254, v253, 6, 3
    v_lshl_add_u32 v60, v60, 4, v254
    v_mul_u32_u24 v60, 768, v60
    v_and_b32 v254, 48, v253
    v_add_u32 v60, v60, v254

    v_mov_b32 v76, 0
    v_mov_b32 v77, 0
    v_lshrrev_b32_e64 v78, 1, v253
    v_add_u32 v79, 65544, v78
    v_add_u32 v80, 131080, v78

    v_add_u32 v254, 161932, v240

    s_mov_b32 s29, 200000
L_wg1:
    ds_read_b32 v255, v254
    s_waitcnt lgkmcnt(0)
    v_cmp_ne_u32 vcc, 0, v255
    s_cmp_eq_u64 vcc, exec
    s_cbranch_scc1 L_wg1_ok
    s_sleep 2
    s_sub_u32 s29, s29, 1
    s_cmp_lg_u32 s29, 0
    s_cbranch_scc1 L_wg1
L_wg1_ok:

    s_add_u32 s26, s39, 1
    s_cmp_ge_u32 s26, 12
    s_cselect_b32 s27, 12, 0
    s_sub_u32 s26, s26, s27
    s_mul_i32 s26, s26, 6144

    s_mov_b32 m0, 7168
    s_add_u32 s30, s26, 0
    s_add_u32 s31, s26, 1536
    buffer_load_dwordx4 v253, s[44:47], s30 offen lds
    buffer_load_dwordx4 v61, s[44:47], s30 offen offset:1024 lds
    buffer_load_dwordx4 v253, s[44:47], s31 offen offset:2048 lds
    s_mov_b32 m0, 72712
    s_add_u32 s30, s26, 1536
    s_add_u32 s31, s26, 3072
    buffer_load_dwordx4 v253, s[44:47], s30 offen lds
    buffer_load_dwordx4 v61, s[44:47], s30 offen offset:1024 lds
    buffer_load_dwordx4 v253, s[44:47], s31 offen offset:2048 lds

    s_add_u32 s26, s39, 4
    s_cmp_ge_u32 s26, 12
    s_cselect_b32 s27, 12, 0
    s_sub_u32 s26, s26, s27
    s_mul_i32 s26, s26, 64

    s_mov_b32 m0, 10240
    s_add_u32 s30, s26, 0
    s_add_u32 s31, s26, 23552
    s_add_u32 s32, s26, 47104
    buffer_load_dwordx4 v60, s[40:43], s30 offen offset:0 lds
    buffer_load_dwordx4 v60, s[40:43], s31 offen offset:1024 lds
    buffer_load_dwordx4 v60, s[40:43], s32 offen offset:2048 lds
    s_mov_b32 m0, 75784
    s_add_u32 s30, s26, 6144
    s_add_u32 s31, s26, 29696
    s_add_u32 s32, s26, 53248
    buffer_load_dwordx4 v60, s[40:43], s30 offen offset:0 lds
    buffer_load_dwordx4 v60, s[40:43], s31 offen offset:1024 lds
    buffer_load_dwordx4 v60, s[40:43], s32 offen offset:2048 lds

    s_add_u32 s26, s39, 2
    s_cmp_ge_u32 s26, 12
    s_cselect_b32 s27, 12, 0
    s_sub_u32 s26, s26, s27
    s_mul_i32 s26, s26, 6144

    s_mov_b32 m0, 13312
    s_add_u32 s30, s26, 0
    s_add_u32 s31, s26, 1536
    buffer_load_dwordx4 v253, s[44:47], s30 offen lds
    buffer_load_dwordx4 v61, s[44:47], s30 offen offset:1024 lds
    buffer_load_dwordx4 v253, s[44:47], s31 offen offset:2048 lds
    s_mov_b32 m0, 78856
    s_add_u32 s30, s26, 1536
    s_add_u32 s31, s26, 3072
    buffer_load_dwordx4 v253, s[44:47], s30 offen lds
    buffer_load_dwordx4 v61, s[44:47], s30 offen offset:1024 lds
    buffer_load_dwordx4 v253, s[44:47], s31 offen offset:2048 lds

    s_add_u32 s26, s39, 5
    s_cmp_ge_u32 s26, 12
    s_cselect_b32 s27, 12, 0
    s_sub_u32 s26, s26, s27
    s_mul_i32 s26, s26, 64

    s_mov_b32 m0, 16384
    s_add_u32 s30, s26, 0
    s_add_u32 s31, s26, 23552
    s_add_u32 s32, s26, 47104
    buffer_load_dwordx4 v60, s[40:43], s30 offen offset:0 lds
    buffer_load_dwordx4 v60, s[40:43], s31 offen offset:1024 lds
    buffer_load_dwordx4 v60, s[40:43], s32 offen offset:2048 lds
    s_mov_b32 m0, 81928
    s_add_u32 s30, s26, 6144
    s_add_u32 s31, s26, 29696
    s_add_u32 s32, s26, 53248
    buffer_load_dwordx4 v60, s[40:43], s30 offen offset:0 lds
    buffer_load_dwordx4 v60, s[40:43], s31 offen offset:1024 lds
    buffer_load_dwordx4 v60, s[40:43], s32 offen offset:2048 lds
    v_mov_b32 v254, 161976

    s_mov_b32 s29, 200000
L_wo1:
    ds_read_b32 v255, v254
    s_waitcnt lgkmcnt(0)
    v_cmp_eq_u32 vcc, 5, v255
    s_cmp_eq_u64 vcc, exec
    s_cbranch_scc1 L_wo1_ok
    s_sleep 2
    s_sub_u32 s29, s29, 1
    s_cmp_lg_u32 s29, 0
    s_cbranch_scc1 L_wo1
L_wo1_ok:

    ds_read_b64 v[96:97], v80 offset:0
    ds_read_b64 v[98:99], v80 offset:512
    ds_read_b64 v[100:101], v80 offset:1024
    ds_read_b64 v[102:103], v80 offset:1536
    ds_read_b64 v[104:105], v80 offset:2048
    ds_read_b64 v[106:107], v80 offset:2560
    ds_read_b64 v[108:109], v80 offset:15368
    ds_read_b64 v[110:111], v80 offset:15880
    ds_read_b64 v[112:113], v80 offset:16392
    ds_read_b64 v[114:115], v80 offset:16904
    ds_read_b64 v[116:117], v80 offset:17416
    s_waitcnt lgkmcnt(7)
    v_pk_maximum3_f16 v76, v76, v96, v96 neg_lo:[0,0,1] neg_hi:[0,0,1]
    v_pk_maximum3_f16 v77, v77, v97, v97 neg_lo:[0,0,1] neg_hi:[0,0,1]
    ds_read_b64 v[118:119], v80 offset:17928
    v_pk_maximum3_f16 v76, v76, v98, v98 neg_lo:[0,0,1] neg_hi:[0,0,1]
    v_pk_maximum3_f16 v77, v77, v99, v99 neg_lo:[0,0,1] neg_hi:[0,0,1]
    ds_read_b64 v[120:121], v80 offset:3072
    v_pk_maximum3_f16 v76, v76, v100, v100 neg_lo:[0,0,1] neg_hi:[0,0,1]
    v_pk_maximum3_f16 v77, v77, v101, v101 neg_lo:[0,0,1] neg_hi:[0,0,1]
    ds_read_b64 v[122:123], v80 offset:3584
    v_pk_maximum3_f16 v76, v76, v102, v102 neg_lo:[0,0,1] neg_hi:[0,0,1]
    v_pk_maximum3_f16 v77, v77, v103, v103 neg_lo:[0,0,1] neg_hi:[0,0,1]
    ds_read_b64 v[124:125], v80 offset:4096
    s_waitcnt lgkmcnt(7)
    v_pk_maximum3_f16 v76, v76, v104, v104 neg_lo:[0,0,1] neg_hi:[0,0,1]
    v_pk_maximum3_f16 v77, v77, v105, v105 neg_lo:[0,0,1] neg_hi:[0,0,1]
    ds_read_b64 v[126:127], v80 offset:4608
    v_pk_maximum3_f16 v76, v76, v106, v106 neg_lo:[0,0,1] neg_hi:[0,0,1]
    v_pk_maximum3_f16 v77, v77, v107, v107 neg_lo:[0,0,1] neg_hi:[0,0,1]
    ds_read_b64 v[128:129], v80 offset:5120
    v_pk_maximum3_f16 v76, v76, v108, v108 neg_lo:[0,0,1] neg_hi:[0,0,1]
    v_pk_maximum3_f16 v77, v77, v109, v109 neg_lo:[0,0,1] neg_hi:[0,0,1]
    ds_read_b64 v[130:131], v80 offset:5632
    v_pk_maximum3_f16 v76, v76, v110, v110 neg_lo:[0,0,1] neg_hi:[0,0,1]
    v_pk_maximum3_f16 v77, v77, v111, v111 neg_lo:[0,0,1] neg_hi:[0,0,1]
    ds_read_b64 v[132:133], v80 offset:18440
    s_waitcnt lgkmcnt(7)
    v_pk_maximum3_f16 v76, v76, v112, v112 neg_lo:[0,0,1] neg_hi:[0,0,1]
    v_pk_maximum3_f16 v77, v77, v113, v113 neg_lo:[0,0,1] neg_hi:[0,0,1]
    ds_read_b64 v[134:135], v80 offset:18952
    v_pk_maximum3_f16 v76, v76, v114, v114 neg_lo:[0,0,1] neg_hi:[0,0,1]
    v_pk_maximum3_f16 v77, v77, v115, v115 neg_lo:[0,0,1] neg_hi:[0,0,1]
    ds_read_b64 v[136:137], v80 offset:19464
    v_pk_maximum3_f16 v76, v76, v116, v116 neg_lo:[0,0,1] neg_hi:[0,0,1]
    v_pk_maximum3_f16 v77, v77, v117, v117 neg_lo:[0,0,1] neg_hi:[0,0,1]
    ds_read_b64 v[138:139], v80 offset:19976
    v_pk_maximum3_f16 v76, v76, v118, v118 neg_lo:[0,0,1] neg_hi:[0,0,1]
    v_pk_maximum3_f16 v77, v77, v119, v119 neg_lo:[0,0,1] neg_hi:[0,0,1]
    ds_read_b64 v[140:141], v80 offset:20488
    s_waitcnt lgkmcnt(7)
    v_pk_maximum3_f16 v76, v76, v120, v120 neg_lo:[0,0,1] neg_hi:[0,0,1]
    v_pk_maximum3_f16 v77, v77, v121, v121 neg_lo:[0,0,1] neg_hi:[0,0,1]
    ds_read_b64 v[142:143], v80 offset:21000
    v_pk_maximum3_f16 v76, v76, v122, v122 neg_lo:[0,0,1] neg_hi:[0,0,1]
    v_pk_maximum3_f16 v77, v77, v123, v123 neg_lo:[0,0,1] neg_hi:[0,0,1]
    ds_read_b64 v[144:145], v80 offset:6144
    v_pk_maximum3_f16 v76, v76, v124, v124 neg_lo:[0,0,1] neg_hi:[0,0,1]
    v_pk_maximum3_f16 v77, v77, v125, v125 neg_lo:[0,0,1] neg_hi:[0,0,1]
    ds_read_b64 v[146:147], v80 offset:6656
    v_pk_maximum3_f16 v76, v76, v126, v126 neg_lo:[0,0,1] neg_hi:[0,0,1]
    v_pk_maximum3_f16 v77, v77, v127, v127 neg_lo:[0,0,1] neg_hi:[0,0,1]
    ds_read_b64 v[148:149], v80 offset:7168
    s_waitcnt lgkmcnt(7)
    v_pk_maximum3_f16 v76, v76, v128, v128 neg_lo:[0,0,1] neg_hi:[0,0,1]
    v_pk_maximum3_f16 v77, v77, v129, v129 neg_lo:[0,0,1] neg_hi:[0,0,1]
    ds_read_b64 v[150:151], v80 offset:7680
    v_pk_maximum3_f16 v76, v76, v130, v130 neg_lo:[0,0,1] neg_hi:[0,0,1]
    v_pk_maximum3_f16 v77, v77, v131, v131 neg_lo:[0,0,1] neg_hi:[0,0,1]
    ds_read_b64 v[152:153], v80 offset:8192
    v_pk_maximum3_f16 v76, v76, v132, v132 neg_lo:[0,0,1] neg_hi:[0,0,1]
    v_pk_maximum3_f16 v77, v77, v133, v133 neg_lo:[0,0,1] neg_hi:[0,0,1]
    ds_read_b64 v[154:155], v80 offset:8704
    v_pk_maximum3_f16 v76, v76, v134, v134 neg_lo:[0,0,1] neg_hi:[0,0,1]
    v_pk_maximum3_f16 v77, v77, v135, v135 neg_lo:[0,0,1] neg_hi:[0,0,1]
    ds_read_b64 v[156:157], v80 offset:21512
    s_waitcnt lgkmcnt(7)
    v_pk_maximum3_f16 v76, v76, v136, v136 neg_lo:[0,0,1] neg_hi:[0,0,1]
    v_pk_maximum3_f16 v77, v77, v137, v137 neg_lo:[0,0,1] neg_hi:[0,0,1]
    ds_read_b64 v[158:159], v80 offset:22024
    v_pk_maximum3_f16 v76, v76, v138, v138 neg_lo:[0,0,1] neg_hi:[0,0,1]
    v_pk_maximum3_f16 v77, v77, v139, v139 neg_lo:[0,0,1] neg_hi:[0,0,1]
    ds_read_b64 v[160:161], v80 offset:22536
    v_pk_maximum3_f16 v76, v76, v140, v140 neg_lo:[0,0,1] neg_hi:[0,0,1]
    v_pk_maximum3_f16 v77, v77, v141, v141 neg_lo:[0,0,1] neg_hi:[0,0,1]
    ds_read_b64 v[162:163], v80 offset:23048
    v_pk_maximum3_f16 v76, v76, v142, v142 neg_lo:[0,0,1] neg_hi:[0,0,1]
    v_pk_maximum3_f16 v77, v77, v143, v143 neg_lo:[0,0,1] neg_hi:[0,0,1]
    ds_read_b64 v[164:165], v80 offset:23560
    s_waitcnt lgkmcnt(7)
    v_pk_maximum3_f16 v76, v76, v144, v144 neg_lo:[0,0,1] neg_hi:[0,0,1]
    v_pk_maximum3_f16 v77, v77, v145, v145 neg_lo:[0,0,1] neg_hi:[0,0,1]
    ds_read_b64 v[166:167], v80 offset:24072
    v_pk_maximum3_f16 v76, v76, v146, v146 neg_lo:[0,0,1] neg_hi:[0,0,1]
    v_pk_maximum3_f16 v77, v77, v147, v147 neg_lo:[0,0,1] neg_hi:[0,0,1]
    ds_read_b64 v[168:169], v80 offset:12288
    v_pk_maximum3_f16 v76, v76, v148, v148 neg_lo:[0,0,1] neg_hi:[0,0,1]
    v_pk_maximum3_f16 v77, v77, v149, v149 neg_lo:[0,0,1] neg_hi:[0,0,1]
    ds_read_b64 v[170:171], v80 offset:12800
    v_pk_maximum3_f16 v76, v76, v150, v150 neg_lo:[0,0,1] neg_hi:[0,0,1]
    v_pk_maximum3_f16 v77, v77, v151, v151 neg_lo:[0,0,1] neg_hi:[0,0,1]
    ds_read_b64 v[172:173], v80 offset:13312
    s_waitcnt lgkmcnt(7)
    v_pk_maximum3_f16 v76, v76, v152, v152 neg_lo:[0,0,1] neg_hi:[0,0,1]
    v_pk_maximum3_f16 v77, v77, v153, v153 neg_lo:[0,0,1] neg_hi:[0,0,1]
    ds_read_b64 v[174:175], v80 offset:13824
    v_pk_maximum3_f16 v76, v76, v154, v154 neg_lo:[0,0,1] neg_hi:[0,0,1]
    v_pk_maximum3_f16 v77, v77, v155, v155 neg_lo:[0,0,1] neg_hi:[0,0,1]
    ds_read_b64 v[176:177], v80 offset:14336
    v_pk_maximum3_f16 v76, v76, v156, v156 neg_lo:[0,0,1] neg_hi:[0,0,1]
    v_pk_maximum3_f16 v77, v77, v157, v157 neg_lo:[0,0,1] neg_hi:[0,0,1]
    ds_read_b64 v[178:179], v80 offset:14848
    v_pk_maximum3_f16 v76, v76, v158, v158 neg_lo:[0,0,1] neg_hi:[0,0,1]
    v_pk_maximum3_f16 v77, v77, v159, v159 neg_lo:[0,0,1] neg_hi:[0,0,1]
    ds_read_b64 v[180:181], v80 offset:27656
    s_waitcnt lgkmcnt(7)
    v_pk_maximum3_f16 v76, v76, v160, v160 neg_lo:[0,0,1] neg_hi:[0,0,1]
    v_pk_maximum3_f16 v77, v77, v161, v161 neg_lo:[0,0,1] neg_hi:[0,0,1]
    ds_read_b64 v[182:183], v80 offset:28168
    v_pk_maximum3_f16 v76, v76, v162, v162 neg_lo:[0,0,1] neg_hi:[0,0,1]
    v_pk_maximum3_f16 v77, v77, v163, v163 neg_lo:[0,0,1] neg_hi:[0,0,1]
    ds_read_b64 v[184:185], v80 offset:28680
    v_pk_maximum3_f16 v76, v76, v164, v164 neg_lo:[0,0,1] neg_hi:[0,0,1]
    v_pk_maximum3_f16 v77, v77, v165, v165 neg_lo:[0,0,1] neg_hi:[0,0,1]
    ds_read_b64 v[186:187], v80 offset:29192
    v_pk_maximum3_f16 v76, v76, v166, v166 neg_lo:[0,0,1] neg_hi:[0,0,1]
    v_pk_maximum3_f16 v77, v77, v167, v167 neg_lo:[0,0,1] neg_hi:[0,0,1]
    ds_read_b64 v[188:189], v80 offset:29704
    s_waitcnt lgkmcnt(7)
    v_pk_maximum3_f16 v76, v76, v168, v168 neg_lo:[0,0,1] neg_hi:[0,0,1]
    v_pk_maximum3_f16 v77, v77, v169, v169 neg_lo:[0,0,1] neg_hi:[0,0,1]
    ds_read_b64 v[190:191], v80 offset:30216
    v_pk_maximum3_f16 v76, v76, v170, v170 neg_lo:[0,0,1] neg_hi:[0,0,1]
    v_pk_maximum3_f16 v77, v77, v171, v171 neg_lo:[0,0,1] neg_hi:[0,0,1]
    v_pk_maximum3_f16 v76, v76, v172, v172 neg_lo:[0,0,1] neg_hi:[0,0,1]
    v_pk_maximum3_f16 v77, v77, v173, v173 neg_lo:[0,0,1] neg_hi:[0,0,1]
    v_pk_maximum3_f16 v76, v76, v174, v174 neg_lo:[0,0,1] neg_hi:[0,0,1]
    v_pk_maximum3_f16 v77, v77, v175, v175 neg_lo:[0,0,1] neg_hi:[0,0,1]
    s_waitcnt lgkmcnt(7)
    v_pk_maximum3_f16 v76, v76, v176, v176 neg_lo:[0,0,1] neg_hi:[0,0,1]
    v_pk_maximum3_f16 v77, v77, v177, v177 neg_lo:[0,0,1] neg_hi:[0,0,1]
    s_waitcnt lgkmcnt(6)
    v_pk_maximum3_f16 v76, v76, v178, v178 neg_lo:[0,0,1] neg_hi:[0,0,1]
    v_pk_maximum3_f16 v77, v77, v179, v179 neg_lo:[0,0,1] neg_hi:[0,0,1]
    s_waitcnt lgkmcnt(5)
    v_pk_maximum3_f16 v76, v76, v180, v180 neg_lo:[0,0,1] neg_hi:[0,0,1]
    v_pk_maximum3_f16 v77, v77, v181, v181 neg_lo:[0,0,1] neg_hi:[0,0,1]
    s_waitcnt lgkmcnt(4)
    v_pk_maximum3_f16 v76, v76, v182, v182 neg_lo:[0,0,1] neg_hi:[0,0,1]
    v_pk_maximum3_f16 v77, v77, v183, v183 neg_lo:[0,0,1] neg_hi:[0,0,1]
    s_waitcnt lgkmcnt(3)
    v_pk_maximum3_f16 v76, v76, v184, v184 neg_lo:[0,0,1] neg_hi:[0,0,1]
    v_pk_maximum3_f16 v77, v77, v185, v185 neg_lo:[0,0,1] neg_hi:[0,0,1]
    s_waitcnt lgkmcnt(2)
    v_pk_maximum3_f16 v76, v76, v186, v186 neg_lo:[0,0,1] neg_hi:[0,0,1]
    v_pk_maximum3_f16 v77, v77, v187, v187 neg_lo:[0,0,1] neg_hi:[0,0,1]
    s_waitcnt lgkmcnt(1)
    v_pk_maximum3_f16 v76, v76, v188, v188 neg_lo:[0,0,1] neg_hi:[0,0,1]
    v_pk_maximum3_f16 v77, v77, v189, v189 neg_lo:[0,0,1] neg_hi:[0,0,1]
    s_waitcnt lgkmcnt(0)
    v_pk_maximum3_f16 v76, v76, v190, v190 neg_lo:[0,0,1] neg_hi:[0,0,1]
    v_pk_maximum3_f16 v77, v77, v191, v191 neg_lo:[0,0,1] neg_hi:[0,0,1]
    v_mov_b32 v254, 161976
    v_mov_b32 v64, 6
    s_waitcnt vmcnt(18)
    ds_write_b32 v254, v64
    v_mov_b32 v65, 7
    s_waitcnt vmcnt(12)
    ds_write_b32 v254, v65
    v_mov_b32 v66, 8
    s_waitcnt vmcnt(6)
    ds_write_b32 v254, v66
    v_mov_b32 v67, 9
    s_waitcnt vmcnt(0)
    ds_write_b32 v254, v67
    v_add_u32 v254, 161940, v240

    s_mov_b32 s29, 200000
L_wg2:
    ds_read_b32 v255, v254
    s_waitcnt lgkmcnt(0)
    v_cmp_ne_u32 vcc, 0, v255
    s_cmp_eq_u64 vcc, exec
    s_cbranch_scc1 L_wg2_ok
    s_sleep 2
    s_sub_u32 s29, s29, 1
    s_cmp_lg_u32 s29, 0
    s_cbranch_scc1 L_wg2
L_wg2_ok:

    s_add_u32 s26, s39, 3
    s_cmp_ge_u32 s26, 12
    s_cselect_b32 s27, 12, 0
    s_sub_u32 s26, s26, s27
    s_mul_i32 s26, s26, 6144

    s_mov_b32 m0, 19456
    s_add_u32 s30, s26, 0
    s_add_u32 s31, s26, 1536
    buffer_load_dwordx4 v253, s[44:47], s30 offen lds
    buffer_load_dwordx4 v61, s[44:47], s30 offen offset:1024 lds
    buffer_load_dwordx4 v253, s[44:47], s31 offen offset:2048 lds
    s_mov_b32 m0, 85000
    s_add_u32 s30, s26, 1536
    s_add_u32 s31, s26, 3072
    buffer_load_dwordx4 v253, s[44:47], s30 offen lds
    buffer_load_dwordx4 v61, s[44:47], s30 offen offset:1024 lds
    buffer_load_dwordx4 v253, s[44:47], s31 offen offset:2048 lds

    s_add_u32 s26, s39, 6
    s_cmp_ge_u32 s26, 12
    s_cselect_b32 s27, 12, 0
    s_sub_u32 s26, s26, s27
    s_mul_i32 s26, s26, 64

    s_mov_b32 m0, 22528
    s_add_u32 s30, s26, 0
    s_add_u32 s31, s26, 23552
    s_add_u32 s32, s26, 47104
    buffer_load_dwordx4 v60, s[40:43], s30 offen offset:0 lds
    buffer_load_dwordx4 v60, s[40:43], s31 offen offset:1024 lds
    buffer_load_dwordx4 v60, s[40:43], s32 offen offset:2048 lds
    s_mov_b32 m0, 88072
    s_add_u32 s30, s26, 6144
    s_add_u32 s31, s26, 29696
    s_add_u32 s32, s26, 53248
    buffer_load_dwordx4 v60, s[40:43], s30 offen offset:0 lds
    buffer_load_dwordx4 v60, s[40:43], s31 offen offset:1024 lds
    buffer_load_dwordx4 v60, s[40:43], s32 offen offset:2048 lds

    s_add_u32 s26, s39, 4
    s_cmp_ge_u32 s26, 12
    s_cselect_b32 s27, 12, 0
    s_sub_u32 s26, s26, s27
    s_mul_i32 s26, s26, 6144

    s_mov_b32 m0, 25600
    s_add_u32 s30, s26, 0
    s_add_u32 s31, s26, 1536
    buffer_load_dwordx4 v253, s[44:47], s30 offen lds
    buffer_load_dwordx4 v61, s[44:47], s30 offen offset:1024 lds
    buffer_load_dwordx4 v253, s[44:47], s31 offen offset:2048 lds
    s_mov_b32 m0, 91144
    s_add_u32 s30, s26, 1536
    s_add_u32 s31, s26, 3072
    buffer_load_dwordx4 v253, s[44:47], s30 offen lds
    buffer_load_dwordx4 v61, s[44:47], s30 offen offset:1024 lds
    buffer_load_dwordx4 v253, s[44:47], s31 offen offset:2048 lds

    s_add_u32 s26, s39, 7
    s_cmp_ge_u32 s26, 12
    s_cselect_b32 s27, 12, 0
    s_sub_u32 s26, s26, s27
    s_mul_i32 s26, s26, 64

    s_mov_b32 m0, 28672
    s_add_u32 s30, s26, 0
    s_add_u32 s31, s26, 23552
    s_add_u32 s32, s26, 47104
    buffer_load_dwordx4 v60, s[40:43], s30 offen offset:0 lds
    buffer_load_dwordx4 v60, s[40:43], s31 offen offset:1024 lds
    buffer_load_dwordx4 v60, s[40:43], s32 offen offset:2048 lds
    s_mov_b32 m0, 94216
    s_add_u32 s30, s26, 6144
    s_add_u32 s31, s26, 29696
    s_add_u32 s32, s26, 53248
    buffer_load_dwordx4 v60, s[40:43], s30 offen offset:0 lds
    buffer_load_dwordx4 v60, s[40:43], s31 offen offset:1024 lds
    buffer_load_dwordx4 v60, s[40:43], s32 offen offset:2048 lds

    s_add_u32 s26, s39, 5
    s_cmp_ge_u32 s26, 12
    s_cselect_b32 s27, 12, 0
    s_sub_u32 s26, s26, s27
    s_mul_i32 s26, s26, 6144

    s_mov_b32 m0, 31744
    s_add_u32 s30, s26, 0
    s_add_u32 s31, s26, 1536
    buffer_load_dwordx4 v253, s[44:47], s30 offen lds
    buffer_load_dwordx4 v61, s[44:47], s30 offen offset:1024 lds
    buffer_load_dwordx4 v253, s[44:47], s31 offen offset:2048 lds
    s_mov_b32 m0, 97288
    s_add_u32 s30, s26, 1536
    s_add_u32 s31, s26, 3072
    buffer_load_dwordx4 v253, s[44:47], s30 offen lds
    buffer_load_dwordx4 v61, s[44:47], s30 offen offset:1024 lds
    buffer_load_dwordx4 v253, s[44:47], s31 offen offset:2048 lds
    ds_read_b64 v[96:97], v78 offset:10240
    ds_read_b64 v[98:99], v78 offset:10752
    ds_read_b64 v[100:101], v78 offset:11264
    ds_read_b64 v[102:103], v78 offset:11776
    ds_read_b64 v[104:105], v78 offset:12288
    ds_read_b64 v[106:107], v78 offset:12800
    ds_read_b64 v[108:109], v79 offset:10240
    ds_read_b64 v[110:111], v79 offset:10752
    ds_read_b64 v[112:113], v79 offset:11264
    ds_read_b64 v[114:115], v79 offset:11776
    ds_read_b64 v[116:117], v79 offset:12288
    s_waitcnt lgkmcnt(7)
    v_pk_maximum3_f16 v76, v76, v96, v96 neg_lo:[0,0,1] neg_hi:[0,0,1]
    v_pk_maximum3_f16 v77, v77, v97, v97 neg_lo:[0,0,1] neg_hi:[0,0,1]
    ds_read_b64 v[118:119], v79 offset:12800
    v_pk_maximum3_f16 v76, v76, v98, v98 neg_lo:[0,0,1] neg_hi:[0,0,1]
    v_pk_maximum3_f16 v77, v77, v99, v99 neg_lo:[0,0,1] neg_hi:[0,0,1]
    ds_read_b64 v[120:121], v78 offset:16384
    v_pk_maximum3_f16 v76, v76, v100, v100 neg_lo:[0,0,1] neg_hi:[0,0,1]
    v_pk_maximum3_f16 v77, v77, v101, v101 neg_lo:[0,0,1] neg_hi:[0,0,1]
    ds_read_b64 v[122:123], v78 offset:16896
    v_pk_maximum3_f16 v76, v76, v102, v102 neg_lo:[0,0,1] neg_hi:[0,0,1]
    v_pk_maximum3_f16 v77, v77, v103, v103 neg_lo:[0,0,1] neg_hi:[0,0,1]
    ds_read_b64 v[124:125], v78 offset:17408
    s_waitcnt lgkmcnt(7)
    v_pk_maximum3_f16 v76, v76, v104, v104 neg_lo:[0,0,1] neg_hi:[0,0,1]
    v_pk_maximum3_f16 v77, v77, v105, v105 neg_lo:[0,0,1] neg_hi:[0,0,1]
    ds_read_b64 v[126:127], v78 offset:17920
    v_pk_maximum3_f16 v76, v76, v106, v106 neg_lo:[0,0,1] neg_hi:[0,0,1]
    v_pk_maximum3_f16 v77, v77, v107, v107 neg_lo:[0,0,1] neg_hi:[0,0,1]
    ds_read_b64 v[128:129], v78 offset:18432
    v_pk_maximum3_f16 v76, v76, v108, v108 neg_lo:[0,0,1] neg_hi:[0,0,1]
    v_pk_maximum3_f16 v77, v77, v109, v109 neg_lo:[0,0,1] neg_hi:[0,0,1]
    ds_read_b64 v[130:131], v78 offset:18944
    v_pk_maximum3_f16 v76, v76, v110, v110 neg_lo:[0,0,1] neg_hi:[0,0,1]
    v_pk_maximum3_f16 v77, v77, v111, v111 neg_lo:[0,0,1] neg_hi:[0,0,1]
    ds_read_b64 v[132:133], v79 offset:16384
    s_waitcnt lgkmcnt(7)
    v_pk_maximum3_f16 v76, v76, v112, v112 neg_lo:[0,0,1] neg_hi:[0,0,1]
    v_pk_maximum3_f16 v77, v77, v113, v113 neg_lo:[0,0,1] neg_hi:[0,0,1]
    ds_read_b64 v[134:135], v79 offset:16896
    v_pk_maximum3_f16 v76, v76, v114, v114 neg_lo:[0,0,1] neg_hi:[0,0,1]
    v_pk_maximum3_f16 v77, v77, v115, v115 neg_lo:[0,0,1] neg_hi:[0,0,1]
    ds_read_b64 v[136:137], v79 offset:17408
    v_pk_maximum3_f16 v76, v76, v116, v116 neg_lo:[0,0,1] neg_hi:[0,0,1]
    v_pk_maximum3_f16 v77, v77, v117, v117 neg_lo:[0,0,1] neg_hi:[0,0,1]
    ds_read_b64 v[138:139], v79 offset:17920
    v_pk_maximum3_f16 v76, v76, v118, v118 neg_lo:[0,0,1] neg_hi:[0,0,1]
    v_pk_maximum3_f16 v77, v77, v119, v119 neg_lo:[0,0,1] neg_hi:[0,0,1]
    ds_read_b64 v[140:141], v79 offset:18432
    s_waitcnt lgkmcnt(7)
    v_pk_maximum3_f16 v76, v76, v120, v120 neg_lo:[0,0,1] neg_hi:[0,0,1]
    v_pk_maximum3_f16 v77, v77, v121, v121 neg_lo:[0,0,1] neg_hi:[0,0,1]
    ds_read_b64 v[142:143], v79 offset:18944
    v_pk_maximum3_f16 v76, v76, v122, v122 neg_lo:[0,0,1] neg_hi:[0,0,1]
    v_pk_maximum3_f16 v77, v77, v123, v123 neg_lo:[0,0,1] neg_hi:[0,0,1]
    v_pk_maximum3_f16 v76, v76, v124, v124 neg_lo:[0,0,1] neg_hi:[0,0,1]
    v_pk_maximum3_f16 v77, v77, v125, v125 neg_lo:[0,0,1] neg_hi:[0,0,1]
    v_pk_maximum3_f16 v76, v76, v126, v126 neg_lo:[0,0,1] neg_hi:[0,0,1]
    v_pk_maximum3_f16 v77, v77, v127, v127 neg_lo:[0,0,1] neg_hi:[0,0,1]
    s_waitcnt lgkmcnt(7)
    v_pk_maximum3_f16 v76, v76, v128, v128 neg_lo:[0,0,1] neg_hi:[0,0,1]
    v_pk_maximum3_f16 v77, v77, v129, v129 neg_lo:[0,0,1] neg_hi:[0,0,1]
    s_waitcnt lgkmcnt(6)
    v_pk_maximum3_f16 v76, v76, v130, v130 neg_lo:[0,0,1] neg_hi:[0,0,1]
    v_pk_maximum3_f16 v77, v77, v131, v131 neg_lo:[0,0,1] neg_hi:[0,0,1]
    s_waitcnt lgkmcnt(5)
    v_pk_maximum3_f16 v76, v76, v132, v132 neg_lo:[0,0,1] neg_hi:[0,0,1]
    v_pk_maximum3_f16 v77, v77, v133, v133 neg_lo:[0,0,1] neg_hi:[0,0,1]
    s_waitcnt lgkmcnt(4)
    v_pk_maximum3_f16 v76, v76, v134, v134 neg_lo:[0,0,1] neg_hi:[0,0,1]
    v_pk_maximum3_f16 v77, v77, v135, v135 neg_lo:[0,0,1] neg_hi:[0,0,1]
    s_waitcnt lgkmcnt(3)
    v_pk_maximum3_f16 v76, v76, v136, v136 neg_lo:[0,0,1] neg_hi:[0,0,1]
    v_pk_maximum3_f16 v77, v77, v137, v137 neg_lo:[0,0,1] neg_hi:[0,0,1]
    s_waitcnt lgkmcnt(2)
    v_pk_maximum3_f16 v76, v76, v138, v138 neg_lo:[0,0,1] neg_hi:[0,0,1]
    v_pk_maximum3_f16 v77, v77, v139, v139 neg_lo:[0,0,1] neg_hi:[0,0,1]
    s_waitcnt lgkmcnt(1)
    v_pk_maximum3_f16 v76, v76, v140, v140 neg_lo:[0,0,1] neg_hi:[0,0,1]
    v_pk_maximum3_f16 v77, v77, v141, v141 neg_lo:[0,0,1] neg_hi:[0,0,1]
    s_waitcnt lgkmcnt(0)
    v_pk_maximum3_f16 v76, v76, v142, v142 neg_lo:[0,0,1] neg_hi:[0,0,1]
    v_pk_maximum3_f16 v77, v77, v143, v143 neg_lo:[0,0,1] neg_hi:[0,0,1]
    v_mov_b32 v254, 161976
    v_mov_b32 v64, 10
    s_waitcnt vmcnt(24)
    ds_write_b32 v254, v64
    v_mov_b32 v65, 11
    s_waitcnt vmcnt(18)
    ds_write_b32 v254, v65
    v_mov_b32 v66, 12
    s_waitcnt vmcnt(12)
    ds_write_b32 v254, v66
    v_mov_b32 v67, 13
    s_waitcnt vmcnt(6)
    ds_write_b32 v254, v67
    v_mov_b32 v68, 14
    s_waitcnt vmcnt(0)
    ds_write_b32 v254, v68
    v_add_u32 v254, 161948, v240

    s_mov_b32 s29, 200000
L_wg3:
    ds_read_b32 v255, v254
    s_waitcnt lgkmcnt(0)
    v_cmp_ne_u32 vcc, 0, v255
    s_cmp_eq_u64 vcc, exec
    s_cbranch_scc1 L_wg3_ok
    s_sleep 2
    s_sub_u32 s29, s29, 1
    s_cmp_lg_u32 s29, 0
    s_cbranch_scc1 L_wg3
L_wg3_ok:

    s_add_u32 s26, s39, 8
    s_cmp_ge_u32 s26, 12
    s_cselect_b32 s27, 12, 0
    s_sub_u32 s26, s26, s27
    s_mul_i32 s26, s26, 64

    s_mov_b32 m0, 34816
    s_add_u32 s30, s26, 0
    s_add_u32 s31, s26, 23552
    s_add_u32 s32, s26, 47104
    buffer_load_dwordx4 v60, s[40:43], s30 offen offset:0 lds
    buffer_load_dwordx4 v60, s[40:43], s31 offen offset:1024 lds
    buffer_load_dwordx4 v60, s[40:43], s32 offen offset:2048 lds
    s_mov_b32 m0, 100360
    s_add_u32 s30, s26, 6144
    s_add_u32 s31, s26, 29696
    s_add_u32 s32, s26, 53248
    buffer_load_dwordx4 v60, s[40:43], s30 offen offset:0 lds
    buffer_load_dwordx4 v60, s[40:43], s31 offen offset:1024 lds
    buffer_load_dwordx4 v60, s[40:43], s32 offen offset:2048 lds

    s_add_u32 s26, s39, 6
    s_cmp_ge_u32 s26, 12
    s_cselect_b32 s27, 12, 0
    s_sub_u32 s26, s26, s27
    s_mul_i32 s26, s26, 6144

    s_mov_b32 m0, 37888
    s_add_u32 s30, s26, 0
    s_add_u32 s31, s26, 1536
    buffer_load_dwordx4 v253, s[44:47], s30 offen lds
    buffer_load_dwordx4 v61, s[44:47], s30 offen offset:1024 lds
    buffer_load_dwordx4 v253, s[44:47], s31 offen offset:2048 lds
    s_mov_b32 m0, 103432
    s_add_u32 s30, s26, 1536
    s_add_u32 s31, s26, 3072
    buffer_load_dwordx4 v253, s[44:47], s30 offen lds
    buffer_load_dwordx4 v61, s[44:47], s30 offen offset:1024 lds
    buffer_load_dwordx4 v253, s[44:47], s31 offen offset:2048 lds

    s_add_u32 s26, s39, 9
    s_cmp_ge_u32 s26, 12
    s_cselect_b32 s27, 12, 0
    s_sub_u32 s26, s26, s27
    s_mul_i32 s26, s26, 64

    s_mov_b32 m0, 40960
    s_add_u32 s30, s26, 0
    s_add_u32 s31, s26, 23552
    s_add_u32 s32, s26, 47104
    buffer_load_dwordx4 v60, s[40:43], s30 offen offset:0 lds
    buffer_load_dwordx4 v60, s[40:43], s31 offen offset:1024 lds
    buffer_load_dwordx4 v60, s[40:43], s32 offen offset:2048 lds
    s_mov_b32 m0, 106504
    s_add_u32 s30, s26, 6144
    s_add_u32 s31, s26, 29696
    s_add_u32 s32, s26, 53248
    buffer_load_dwordx4 v60, s[40:43], s30 offen offset:0 lds
    buffer_load_dwordx4 v60, s[40:43], s31 offen offset:1024 lds
    buffer_load_dwordx4 v60, s[40:43], s32 offen offset:2048 lds

    s_add_u32 s26, s39, 7
    s_cmp_ge_u32 s26, 12
    s_cselect_b32 s27, 12, 0
    s_sub_u32 s26, s26, s27
    s_mul_i32 s26, s26, 6144

    s_mov_b32 m0, 44032
    s_add_u32 s30, s26, 0
    s_add_u32 s31, s26, 1536
    buffer_load_dwordx4 v253, s[44:47], s30 offen lds
    buffer_load_dwordx4 v61, s[44:47], s30 offen offset:1024 lds
    buffer_load_dwordx4 v253, s[44:47], s31 offen offset:2048 lds
    s_mov_b32 m0, 109576
    s_add_u32 s30, s26, 1536
    s_add_u32 s31, s26, 3072
    buffer_load_dwordx4 v253, s[44:47], s30 offen lds
    buffer_load_dwordx4 v61, s[44:47], s30 offen offset:1024 lds
    buffer_load_dwordx4 v253, s[44:47], s31 offen offset:2048 lds

    s_add_u32 s26, s39, 10
    s_cmp_ge_u32 s26, 12
    s_cselect_b32 s27, 12, 0
    s_sub_u32 s26, s26, s27
    s_mul_i32 s26, s26, 64

    s_mov_b32 m0, 47104
    s_add_u32 s30, s26, 0
    s_add_u32 s31, s26, 23552
    s_add_u32 s32, s26, 47104
    buffer_load_dwordx4 v60, s[40:43], s30 offen offset:0 lds
    buffer_load_dwordx4 v60, s[40:43], s31 offen offset:1024 lds
    buffer_load_dwordx4 v60, s[40:43], s32 offen offset:2048 lds
    s_mov_b32 m0, 112648
    s_add_u32 s30, s26, 6144
    s_add_u32 s31, s26, 29696
    s_add_u32 s32, s26, 53248
    buffer_load_dwordx4 v60, s[40:43], s30 offen offset:0 lds
    buffer_load_dwordx4 v60, s[40:43], s31 offen offset:1024 lds
    buffer_load_dwordx4 v60, s[40:43], s32 offen offset:2048 lds

    s_add_u32 s26, s39, 8
    s_cmp_ge_u32 s26, 12
    s_cselect_b32 s27, 12, 0
    s_sub_u32 s26, s26, s27
    s_mul_i32 s26, s26, 6144

    s_mov_b32 m0, 50176
    s_add_u32 s30, s26, 0
    s_add_u32 s31, s26, 1536
    buffer_load_dwordx4 v253, s[44:47], s30 offen lds
    buffer_load_dwordx4 v61, s[44:47], s30 offen offset:1024 lds
    buffer_load_dwordx4 v253, s[44:47], s31 offen offset:2048 lds
    s_mov_b32 m0, 115720
    s_add_u32 s30, s26, 1536
    s_add_u32 s31, s26, 3072
    buffer_load_dwordx4 v253, s[44:47], s30 offen lds
    buffer_load_dwordx4 v61, s[44:47], s30 offen offset:1024 lds
    buffer_load_dwordx4 v253, s[44:47], s31 offen offset:2048 lds

    s_add_u32 s26, s39, 11
    s_cmp_ge_u32 s26, 12
    s_cselect_b32 s27, 12, 0
    s_sub_u32 s26, s26, s27
    s_mul_i32 s26, s26, 64

    s_mov_b32 m0, 53248
    s_add_u32 s30, s26, 0
    s_add_u32 s31, s26, 23552
    s_add_u32 s32, s26, 47104
    buffer_load_dwordx4 v60, s[40:43], s30 offen offset:0 lds
    buffer_load_dwordx4 v60, s[40:43], s31 offen offset:1024 lds
    buffer_load_dwordx4 v60, s[40:43], s32 offen offset:2048 lds
    s_mov_b32 m0, 118792
    s_add_u32 s30, s26, 6144
    s_add_u32 s31, s26, 29696
    s_add_u32 s32, s26, 53248
    buffer_load_dwordx4 v60, s[40:43], s30 offen offset:0 lds
    buffer_load_dwordx4 v60, s[40:43], s31 offen offset:1024 lds
    buffer_load_dwordx4 v60, s[40:43], s32 offen offset:2048 lds

    s_add_u32 s26, s39, 9
    s_cmp_ge_u32 s26, 12
    s_cselect_b32 s27, 12, 0
    s_sub_u32 s26, s26, s27
    s_mul_i32 s26, s26, 6144

    s_mov_b32 m0, 56320
    s_add_u32 s30, s26, 0
    s_add_u32 s31, s26, 1536
    buffer_load_dwordx4 v253, s[44:47], s30 offen lds
    buffer_load_dwordx4 v61, s[44:47], s30 offen offset:1024 lds
    buffer_load_dwordx4 v253, s[44:47], s31 offen offset:2048 lds
    s_mov_b32 m0, 121864
    s_add_u32 s30, s26, 1536
    s_add_u32 s31, s26, 3072
    buffer_load_dwordx4 v253, s[44:47], s30 offen lds
    buffer_load_dwordx4 v61, s[44:47], s30 offen offset:1024 lds
    buffer_load_dwordx4 v253, s[44:47], s31 offen offset:2048 lds

    s_add_u32 s26, s39, 10
    s_cmp_ge_u32 s26, 12
    s_cselect_b32 s27, 12, 0
    s_sub_u32 s26, s26, s27
    s_mul_i32 s26, s26, 6144

    s_mov_b32 m0, 59392
    s_add_u32 s30, s26, 0
    s_add_u32 s31, s26, 1536
    buffer_load_dwordx4 v253, s[44:47], s30 offen lds
    buffer_load_dwordx4 v61, s[44:47], s30 offen offset:1024 lds
    buffer_load_dwordx4 v253, s[44:47], s31 offen offset:2048 lds
    s_mov_b32 m0, 124936
    s_add_u32 s30, s26, 1536
    s_add_u32 s31, s26, 3072
    buffer_load_dwordx4 v253, s[44:47], s30 offen lds
    buffer_load_dwordx4 v61, s[44:47], s30 offen offset:1024 lds
    buffer_load_dwordx4 v253, s[44:47], s31 offen offset:2048 lds

    s_add_u32 s26, s39, 11
    s_cmp_ge_u32 s26, 12
    s_cselect_b32 s27, 12, 0
    s_sub_u32 s26, s26, s27
    s_mul_i32 s26, s26, 6144

    s_mov_b32 m0, 62464
    s_add_u32 s30, s26, 0
    s_add_u32 s31, s26, 1536
    buffer_load_dwordx4 v253, s[44:47], s30 offen lds
    buffer_load_dwordx4 v61, s[44:47], s30 offen offset:1024 lds
    buffer_load_dwordx4 v253, s[44:47], s31 offen offset:2048 lds
    s_mov_b32 m0, 128008
    s_add_u32 s30, s26, 1536
    s_add_u32 s31, s26, 3072
    buffer_load_dwordx4 v253, s[44:47], s30 offen lds
    buffer_load_dwordx4 v61, s[44:47], s30 offen offset:1024 lds
    buffer_load_dwordx4 v253, s[44:47], s31 offen offset:2048 lds
    ds_read_b64 v[96:97], v78 offset:22528
    ds_read_b64 v[98:99], v78 offset:23040
    ds_read_b64 v[100:101], v78 offset:23552
    ds_read_b64 v[102:103], v78 offset:24064
    ds_read_b64 v[104:105], v78 offset:24576
    ds_read_b64 v[106:107], v78 offset:25088
    ds_read_b64 v[108:109], v79 offset:22528
    ds_read_b64 v[110:111], v79 offset:23040
    ds_read_b64 v[112:113], v79 offset:23552
    ds_read_b64 v[114:115], v79 offset:24064
    ds_read_b64 v[116:117], v79 offset:24576
    s_waitcnt lgkmcnt(7)
    v_pk_maximum3_f16 v76, v76, v96, v96 neg_lo:[0,0,1] neg_hi:[0,0,1]
    v_pk_maximum3_f16 v77, v77, v97, v97 neg_lo:[0,0,1] neg_hi:[0,0,1]
    ds_read_b64 v[118:119], v79 offset:25088
    v_pk_maximum3_f16 v76, v76, v98, v98 neg_lo:[0,0,1] neg_hi:[0,0,1]
    v_pk_maximum3_f16 v77, v77, v99, v99 neg_lo:[0,0,1] neg_hi:[0,0,1]
    ds_read_b64 v[120:121], v78 offset:28672
    v_pk_maximum3_f16 v76, v76, v100, v100 neg_lo:[0,0,1] neg_hi:[0,0,1]
    v_pk_maximum3_f16 v77, v77, v101, v101 neg_lo:[0,0,1] neg_hi:[0,0,1]
    ds_read_b64 v[122:123], v78 offset:29184
    v_pk_maximum3_f16 v76, v76, v102, v102 neg_lo:[0,0,1] neg_hi:[0,0,1]
    v_pk_maximum3_f16 v77, v77, v103, v103 neg_lo:[0,0,1] neg_hi:[0,0,1]
    ds_read_b64 v[124:125], v78 offset:29696
    s_waitcnt lgkmcnt(7)
    v_pk_maximum3_f16 v76, v76, v104, v104 neg_lo:[0,0,1] neg_hi:[0,0,1]
    v_pk_maximum3_f16 v77, v77, v105, v105 neg_lo:[0,0,1] neg_hi:[0,0,1]
    ds_read_b64 v[126:127], v78 offset:30208
    v_pk_maximum3_f16 v76, v76, v106, v106 neg_lo:[0,0,1] neg_hi:[0,0,1]
    v_pk_maximum3_f16 v77, v77, v107, v107 neg_lo:[0,0,1] neg_hi:[0,0,1]
    ds_read_b64 v[128:129], v78 offset:30720
    v_pk_maximum3_f16 v76, v76, v108, v108 neg_lo:[0,0,1] neg_hi:[0,0,1]
    v_pk_maximum3_f16 v77, v77, v109, v109 neg_lo:[0,0,1] neg_hi:[0,0,1]
    ds_read_b64 v[130:131], v78 offset:31232
    v_pk_maximum3_f16 v76, v76, v110, v110 neg_lo:[0,0,1] neg_hi:[0,0,1]
    v_pk_maximum3_f16 v77, v77, v111, v111 neg_lo:[0,0,1] neg_hi:[0,0,1]
    ds_read_b64 v[132:133], v79 offset:28672
    s_waitcnt lgkmcnt(7)
    v_pk_maximum3_f16 v76, v76, v112, v112 neg_lo:[0,0,1] neg_hi:[0,0,1]
    v_pk_maximum3_f16 v77, v77, v113, v113 neg_lo:[0,0,1] neg_hi:[0,0,1]
    ds_read_b64 v[134:135], v79 offset:29184
    v_pk_maximum3_f16 v76, v76, v114, v114 neg_lo:[0,0,1] neg_hi:[0,0,1]
    v_pk_maximum3_f16 v77, v77, v115, v115 neg_lo:[0,0,1] neg_hi:[0,0,1]
    ds_read_b64 v[136:137], v79 offset:29696
    v_pk_maximum3_f16 v76, v76, v116, v116 neg_lo:[0,0,1] neg_hi:[0,0,1]
    v_pk_maximum3_f16 v77, v77, v117, v117 neg_lo:[0,0,1] neg_hi:[0,0,1]
    ds_read_b64 v[138:139], v79 offset:30208
    v_pk_maximum3_f16 v76, v76, v118, v118 neg_lo:[0,0,1] neg_hi:[0,0,1]
    v_pk_maximum3_f16 v77, v77, v119, v119 neg_lo:[0,0,1] neg_hi:[0,0,1]
    ds_read_b64 v[140:141], v79 offset:30720
    s_waitcnt lgkmcnt(7)
    v_pk_maximum3_f16 v76, v76, v120, v120 neg_lo:[0,0,1] neg_hi:[0,0,1]
    v_pk_maximum3_f16 v77, v77, v121, v121 neg_lo:[0,0,1] neg_hi:[0,0,1]
    ds_read_b64 v[142:143], v79 offset:31232
    v_pk_maximum3_f16 v76, v76, v122, v122 neg_lo:[0,0,1] neg_hi:[0,0,1]
    v_pk_maximum3_f16 v77, v77, v123, v123 neg_lo:[0,0,1] neg_hi:[0,0,1]
    v_pk_maximum3_f16 v76, v76, v124, v124 neg_lo:[0,0,1] neg_hi:[0,0,1]
    v_pk_maximum3_f16 v77, v77, v125, v125 neg_lo:[0,0,1] neg_hi:[0,0,1]
    v_pk_maximum3_f16 v76, v76, v126, v126 neg_lo:[0,0,1] neg_hi:[0,0,1]
    v_pk_maximum3_f16 v77, v77, v127, v127 neg_lo:[0,0,1] neg_hi:[0,0,1]
    s_waitcnt lgkmcnt(7)
    v_pk_maximum3_f16 v76, v76, v128, v128 neg_lo:[0,0,1] neg_hi:[0,0,1]
    v_pk_maximum3_f16 v77, v77, v129, v129 neg_lo:[0,0,1] neg_hi:[0,0,1]
    s_waitcnt lgkmcnt(6)
    v_pk_maximum3_f16 v76, v76, v130, v130 neg_lo:[0,0,1] neg_hi:[0,0,1]
    v_pk_maximum3_f16 v77, v77, v131, v131 neg_lo:[0,0,1] neg_hi:[0,0,1]
    s_waitcnt lgkmcnt(5)
    v_pk_maximum3_f16 v76, v76, v132, v132 neg_lo:[0,0,1] neg_hi:[0,0,1]
    v_pk_maximum3_f16 v77, v77, v133, v133 neg_lo:[0,0,1] neg_hi:[0,0,1]
    s_waitcnt lgkmcnt(4)
    v_pk_maximum3_f16 v76, v76, v134, v134 neg_lo:[0,0,1] neg_hi:[0,0,1]
    v_pk_maximum3_f16 v77, v77, v135, v135 neg_lo:[0,0,1] neg_hi:[0,0,1]
    s_waitcnt lgkmcnt(3)
    v_pk_maximum3_f16 v76, v76, v136, v136 neg_lo:[0,0,1] neg_hi:[0,0,1]
    v_pk_maximum3_f16 v77, v77, v137, v137 neg_lo:[0,0,1] neg_hi:[0,0,1]
    s_waitcnt lgkmcnt(2)
    v_pk_maximum3_f16 v76, v76, v138, v138 neg_lo:[0,0,1] neg_hi:[0,0,1]
    v_pk_maximum3_f16 v77, v77, v139, v139 neg_lo:[0,0,1] neg_hi:[0,0,1]
    s_waitcnt lgkmcnt(1)
    v_pk_maximum3_f16 v76, v76, v140, v140 neg_lo:[0,0,1] neg_hi:[0,0,1]
    v_pk_maximum3_f16 v77, v77, v141, v141 neg_lo:[0,0,1] neg_hi:[0,0,1]
    s_waitcnt lgkmcnt(0)
    v_pk_maximum3_f16 v76, v76, v142, v142 neg_lo:[0,0,1] neg_hi:[0,0,1]
    v_pk_maximum3_f16 v77, v77, v143, v143 neg_lo:[0,0,1] neg_hi:[0,0,1]
    v_mov_b32 v254, 161976
    v_mov_b32 v64, 15
    s_waitcnt vmcnt(54)
    ds_write_b32 v254, v64
    v_mov_b32 v65, 16
    s_waitcnt vmcnt(48)
    ds_write_b32 v254, v65
    v_mov_b32 v66, 17
    s_waitcnt vmcnt(42)
    ds_write_b32 v254, v66
    v_mov_b32 v67, 18
    s_waitcnt vmcnt(36)
    ds_write_b32 v254, v67
    v_mov_b32 v68, 19
    s_waitcnt vmcnt(30)
    ds_write_b32 v254, v68
    v_mov_b32 v69, 20
    s_waitcnt vmcnt(24)
    ds_write_b32 v254, v69
    v_mov_b32 v70, 21
    s_waitcnt vmcnt(18)
    ds_write_b32 v254, v70
    v_mov_b32 v71, 22
    s_waitcnt vmcnt(12)
    ds_write_b32 v254, v71
    v_mov_b32 v72, 23
    s_waitcnt vmcnt(6)
    ds_write_b32 v254, v72
    v_mov_b32 v73, 24
    s_waitcnt vmcnt(0)
    ds_write_b32 v254, v73
    s_waitcnt lgkmcnt(0)
    ds_read_b64 v[96:97], v78 offset:34816
    ds_read_b64 v[98:99], v78 offset:35328
    ds_read_b64 v[100:101], v78 offset:35840
    ds_read_b64 v[102:103], v78 offset:36352
    ds_read_b64 v[104:105], v78 offset:36864
    ds_read_b64 v[106:107], v78 offset:37376
    ds_read_b64 v[108:109], v79 offset:34816
    ds_read_b64 v[110:111], v79 offset:35328
    ds_read_b64 v[112:113], v79 offset:35840
    ds_read_b64 v[114:115], v79 offset:36352
    ds_read_b64 v[116:117], v79 offset:36864
    s_waitcnt lgkmcnt(7)
    v_pk_maximum3_f16 v76, v76, v96, v96 neg_lo:[0,0,1] neg_hi:[0,0,1]
    v_pk_maximum3_f16 v77, v77, v97, v97 neg_lo:[0,0,1] neg_hi:[0,0,1]
    ds_read_b64 v[118:119], v79 offset:37376
    v_pk_maximum3_f16 v76, v76, v98, v98 neg_lo:[0,0,1] neg_hi:[0,0,1]
    v_pk_maximum3_f16 v77, v77, v99, v99 neg_lo:[0,0,1] neg_hi:[0,0,1]
    ds_read_b64 v[120:121], v78 offset:40960
    v_pk_maximum3_f16 v76, v76, v100, v100 neg_lo:[0,0,1] neg_hi:[0,0,1]
    v_pk_maximum3_f16 v77, v77, v101, v101 neg_lo:[0,0,1] neg_hi:[0,0,1]
    ds_read_b64 v[122:123], v78 offset:41472
    v_pk_maximum3_f16 v76, v76, v102, v102 neg_lo:[0,0,1] neg_hi:[0,0,1]
    v_pk_maximum3_f16 v77, v77, v103, v103 neg_lo:[0,0,1] neg_hi:[0,0,1]
    ds_read_b64 v[124:125], v78 offset:41984
    s_waitcnt lgkmcnt(7)
    v_pk_maximum3_f16 v76, v76, v104, v104 neg_lo:[0,0,1] neg_hi:[0,0,1]
    v_pk_maximum3_f16 v77, v77, v105, v105 neg_lo:[0,0,1] neg_hi:[0,0,1]
    ds_read_b64 v[126:127], v78 offset:42496
    v_pk_maximum3_f16 v76, v76, v106, v106 neg_lo:[0,0,1] neg_hi:[0,0,1]
    v_pk_maximum3_f16 v77, v77, v107, v107 neg_lo:[0,0,1] neg_hi:[0,0,1]
    ds_read_b64 v[128:129], v78 offset:43008
    v_pk_maximum3_f16 v76, v76, v108, v108 neg_lo:[0,0,1] neg_hi:[0,0,1]
    v_pk_maximum3_f16 v77, v77, v109, v109 neg_lo:[0,0,1] neg_hi:[0,0,1]
    ds_read_b64 v[130:131], v78 offset:43520
    v_pk_maximum3_f16 v76, v76, v110, v110 neg_lo:[0,0,1] neg_hi:[0,0,1]
    v_pk_maximum3_f16 v77, v77, v111, v111 neg_lo:[0,0,1] neg_hi:[0,0,1]
    ds_read_b64 v[132:133], v79 offset:40960
    s_waitcnt lgkmcnt(7)
    v_pk_maximum3_f16 v76, v76, v112, v112 neg_lo:[0,0,1] neg_hi:[0,0,1]
    v_pk_maximum3_f16 v77, v77, v113, v113 neg_lo:[0,0,1] neg_hi:[0,0,1]
    ds_read_b64 v[134:135], v79 offset:41472
    v_pk_maximum3_f16 v76, v76, v114, v114 neg_lo:[0,0,1] neg_hi:[0,0,1]
    v_pk_maximum3_f16 v77, v77, v115, v115 neg_lo:[0,0,1] neg_hi:[0,0,1]
    ds_read_b64 v[136:137], v79 offset:41984
    v_pk_maximum3_f16 v76, v76, v116, v116 neg_lo:[0,0,1] neg_hi:[0,0,1]
    v_pk_maximum3_f16 v77, v77, v117, v117 neg_lo:[0,0,1] neg_hi:[0,0,1]
    ds_read_b64 v[138:139], v79 offset:42496
    v_pk_maximum3_f16 v76, v76, v118, v118 neg_lo:[0,0,1] neg_hi:[0,0,1]
    v_pk_maximum3_f16 v77, v77, v119, v119 neg_lo:[0,0,1] neg_hi:[0,0,1]
    ds_read_b64 v[140:141], v79 offset:43008
    s_waitcnt lgkmcnt(7)
    v_pk_maximum3_f16 v76, v76, v120, v120 neg_lo:[0,0,1] neg_hi:[0,0,1]
    v_pk_maximum3_f16 v77, v77, v121, v121 neg_lo:[0,0,1] neg_hi:[0,0,1]
    ds_read_b64 v[142:143], v79 offset:43520
    v_pk_maximum3_f16 v76, v76, v122, v122 neg_lo:[0,0,1] neg_hi:[0,0,1]
    v_pk_maximum3_f16 v77, v77, v123, v123 neg_lo:[0,0,1] neg_hi:[0,0,1]
    ds_read_b64 v[144:145], v78 offset:47104
    v_pk_maximum3_f16 v76, v76, v124, v124 neg_lo:[0,0,1] neg_hi:[0,0,1]
    v_pk_maximum3_f16 v77, v77, v125, v125 neg_lo:[0,0,1] neg_hi:[0,0,1]
    ds_read_b64 v[146:147], v78 offset:47616
    v_pk_maximum3_f16 v76, v76, v126, v126 neg_lo:[0,0,1] neg_hi:[0,0,1]
    v_pk_maximum3_f16 v77, v77, v127, v127 neg_lo:[0,0,1] neg_hi:[0,0,1]
    ds_read_b64 v[148:149], v78 offset:48128
    s_waitcnt lgkmcnt(7)
    v_pk_maximum3_f16 v76, v76, v128, v128 neg_lo:[0,0,1] neg_hi:[0,0,1]
    v_pk_maximum3_f16 v77, v77, v129, v129 neg_lo:[0,0,1] neg_hi:[0,0,1]
    ds_read_b64 v[150:151], v78 offset:48640
    v_pk_maximum3_f16 v76, v76, v130, v130 neg_lo:[0,0,1] neg_hi:[0,0,1]
    v_pk_maximum3_f16 v77, v77, v131, v131 neg_lo:[0,0,1] neg_hi:[0,0,1]
    ds_read_b64 v[152:153], v78 offset:49152
    v_pk_maximum3_f16 v76, v76, v132, v132 neg_lo:[0,0,1] neg_hi:[0,0,1]
    v_pk_maximum3_f16 v77, v77, v133, v133 neg_lo:[0,0,1] neg_hi:[0,0,1]
    ds_read_b64 v[154:155], v78 offset:49664
    v_pk_maximum3_f16 v76, v76, v134, v134 neg_lo:[0,0,1] neg_hi:[0,0,1]
    v_pk_maximum3_f16 v77, v77, v135, v135 neg_lo:[0,0,1] neg_hi:[0,0,1]
    ds_read_b64 v[156:157], v79 offset:47104
    s_waitcnt lgkmcnt(7)
    v_pk_maximum3_f16 v76, v76, v136, v136 neg_lo:[0,0,1] neg_hi:[0,0,1]
    v_pk_maximum3_f16 v77, v77, v137, v137 neg_lo:[0,0,1] neg_hi:[0,0,1]
    ds_read_b64 v[158:159], v79 offset:47616
    v_pk_maximum3_f16 v76, v76, v138, v138 neg_lo:[0,0,1] neg_hi:[0,0,1]
    v_pk_maximum3_f16 v77, v77, v139, v139 neg_lo:[0,0,1] neg_hi:[0,0,1]
    ds_read_b64 v[160:161], v79 offset:48128
    v_pk_maximum3_f16 v76, v76, v140, v140 neg_lo:[0,0,1] neg_hi:[0,0,1]
    v_pk_maximum3_f16 v77, v77, v141, v141 neg_lo:[0,0,1] neg_hi:[0,0,1]
    ds_read_b64 v[162:163], v79 offset:48640
    v_pk_maximum3_f16 v76, v76, v142, v142 neg_lo:[0,0,1] neg_hi:[0,0,1]
    v_pk_maximum3_f16 v77, v77, v143, v143 neg_lo:[0,0,1] neg_hi:[0,0,1]
    ds_read_b64 v[164:165], v79 offset:49152
    s_waitcnt lgkmcnt(7)
    v_pk_maximum3_f16 v76, v76, v144, v144 neg_lo:[0,0,1] neg_hi:[0,0,1]
    v_pk_maximum3_f16 v77, v77, v145, v145 neg_lo:[0,0,1] neg_hi:[0,0,1]
    ds_read_b64 v[166:167], v79 offset:49664
    v_pk_maximum3_f16 v76, v76, v146, v146 neg_lo:[0,0,1] neg_hi:[0,0,1]
    v_pk_maximum3_f16 v77, v77, v147, v147 neg_lo:[0,0,1] neg_hi:[0,0,1]
    ds_read_b64 v[168:169], v78 offset:53248
    v_pk_maximum3_f16 v76, v76, v148, v148 neg_lo:[0,0,1] neg_hi:[0,0,1]
    v_pk_maximum3_f16 v77, v77, v149, v149 neg_lo:[0,0,1] neg_hi:[0,0,1]
    ds_read_b64 v[170:171], v78 offset:53760
    v_pk_maximum3_f16 v76, v76, v150, v150 neg_lo:[0,0,1] neg_hi:[0,0,1]
    v_pk_maximum3_f16 v77, v77, v151, v151 neg_lo:[0,0,1] neg_hi:[0,0,1]
    ds_read_b64 v[172:173], v78 offset:54272
    s_waitcnt lgkmcnt(7)
    v_pk_maximum3_f16 v76, v76, v152, v152 neg_lo:[0,0,1] neg_hi:[0,0,1]
    v_pk_maximum3_f16 v77, v77, v153, v153 neg_lo:[0,0,1] neg_hi:[0,0,1]
    ds_read_b64 v[174:175], v78 offset:54784
    v_pk_maximum3_f16 v76, v76, v154, v154 neg_lo:[0,0,1] neg_hi:[0,0,1]
    v_pk_maximum3_f16 v77, v77, v155, v155 neg_lo:[0,0,1] neg_hi:[0,0,1]
    ds_read_b64 v[176:177], v78 offset:55296
    v_pk_maximum3_f16 v76, v76, v156, v156 neg_lo:[0,0,1] neg_hi:[0,0,1]
    v_pk_maximum3_f16 v77, v77, v157, v157 neg_lo:[0,0,1] neg_hi:[0,0,1]
    ds_read_b64 v[178:179], v78 offset:55808
    v_pk_maximum3_f16 v76, v76, v158, v158 neg_lo:[0,0,1] neg_hi:[0,0,1]
    v_pk_maximum3_f16 v77, v77, v159, v159 neg_lo:[0,0,1] neg_hi:[0,0,1]
    ds_read_b64 v[180:181], v79 offset:53248
    s_waitcnt lgkmcnt(7)
    v_pk_maximum3_f16 v76, v76, v160, v160 neg_lo:[0,0,1] neg_hi:[0,0,1]
    v_pk_maximum3_f16 v77, v77, v161, v161 neg_lo:[0,0,1] neg_hi:[0,0,1]
    ds_read_b64 v[182:183], v79 offset:53760
    v_pk_maximum3_f16 v76, v76, v162, v162 neg_lo:[0,0,1] neg_hi:[0,0,1]
    v_pk_maximum3_f16 v77, v77, v163, v163 neg_lo:[0,0,1] neg_hi:[0,0,1]
    ds_read_b64 v[184:185], v79 offset:54272
    v_pk_maximum3_f16 v76, v76, v164, v164 neg_lo:[0,0,1] neg_hi:[0,0,1]
    v_pk_maximum3_f16 v77, v77, v165, v165 neg_lo:[0,0,1] neg_hi:[0,0,1]
    ds_read_b64 v[186:187], v79 offset:54784
    v_pk_maximum3_f16 v76, v76, v166, v166 neg_lo:[0,0,1] neg_hi:[0,0,1]
    v_pk_maximum3_f16 v77, v77, v167, v167 neg_lo:[0,0,1] neg_hi:[0,0,1]
    ds_read_b64 v[188:189], v79 offset:55296
    s_waitcnt lgkmcnt(7)
    v_pk_maximum3_f16 v76, v76, v168, v168 neg_lo:[0,0,1] neg_hi:[0,0,1]
    v_pk_maximum3_f16 v77, v77, v169, v169 neg_lo:[0,0,1] neg_hi:[0,0,1]
    ds_read_b64 v[190:191], v79 offset:55808
    v_pk_maximum3_f16 v76, v76, v170, v170 neg_lo:[0,0,1] neg_hi:[0,0,1]
    v_pk_maximum3_f16 v77, v77, v171, v171 neg_lo:[0,0,1] neg_hi:[0,0,1]
    v_pk_maximum3_f16 v76, v76, v172, v172 neg_lo:[0,0,1] neg_hi:[0,0,1]
    v_pk_maximum3_f16 v77, v77, v173, v173 neg_lo:[0,0,1] neg_hi:[0,0,1]
    v_pk_maximum3_f16 v76, v76, v174, v174 neg_lo:[0,0,1] neg_hi:[0,0,1]
    v_pk_maximum3_f16 v77, v77, v175, v175 neg_lo:[0,0,1] neg_hi:[0,0,1]
    s_waitcnt lgkmcnt(7)
    v_pk_maximum3_f16 v76, v76, v176, v176 neg_lo:[0,0,1] neg_hi:[0,0,1]
    v_pk_maximum3_f16 v77, v77, v177, v177 neg_lo:[0,0,1] neg_hi:[0,0,1]
    s_waitcnt lgkmcnt(6)
    v_pk_maximum3_f16 v76, v76, v178, v178 neg_lo:[0,0,1] neg_hi:[0,0,1]
    v_pk_maximum3_f16 v77, v77, v179, v179 neg_lo:[0,0,1] neg_hi:[0,0,1]
    s_waitcnt lgkmcnt(5)
    v_pk_maximum3_f16 v76, v76, v180, v180 neg_lo:[0,0,1] neg_hi:[0,0,1]
    v_pk_maximum3_f16 v77, v77, v181, v181 neg_lo:[0,0,1] neg_hi:[0,0,1]
    s_waitcnt lgkmcnt(4)
    v_pk_maximum3_f16 v76, v76, v182, v182 neg_lo:[0,0,1] neg_hi:[0,0,1]
    v_pk_maximum3_f16 v77, v77, v183, v183 neg_lo:[0,0,1] neg_hi:[0,0,1]
    s_waitcnt lgkmcnt(3)
    v_pk_maximum3_f16 v76, v76, v184, v184 neg_lo:[0,0,1] neg_hi:[0,0,1]
    v_pk_maximum3_f16 v77, v77, v185, v185 neg_lo:[0,0,1] neg_hi:[0,0,1]
    s_waitcnt lgkmcnt(2)
    v_pk_maximum3_f16 v76, v76, v186, v186 neg_lo:[0,0,1] neg_hi:[0,0,1]
    v_pk_maximum3_f16 v77, v77, v187, v187 neg_lo:[0,0,1] neg_hi:[0,0,1]
    s_waitcnt lgkmcnt(1)
    v_pk_maximum3_f16 v76, v76, v188, v188 neg_lo:[0,0,1] neg_hi:[0,0,1]
    v_pk_maximum3_f16 v77, v77, v189, v189 neg_lo:[0,0,1] neg_hi:[0,0,1]
    s_waitcnt lgkmcnt(0)
    v_pk_maximum3_f16 v76, v76, v190, v190 neg_lo:[0,0,1] neg_hi:[0,0,1]
    v_pk_maximum3_f16 v77, v77, v191, v191 neg_lo:[0,0,1] neg_hi:[0,0,1]

    v_and_b32 v76, 0x7fff7fff, v76
    v_and_b32 v77, 0x7fff7fff, v77
    v_pk_max_u16 v76, v76, v77
    s_nop 0
    v_lshrrev_b32 v77, 16, v76
    v_and_b32 v76, 0xffff, v76
    v_max_u32 v76, v76, v77
    ds_max_u32 v254, v76 offset:16
    ds_read_b32 v255, v254 offset:16
    s_waitcnt lgkmcnt(0)
    v_readfirstlane_b32 s26, v255
    s_lshr_b32 s26, s26, 7
    s_max_u32 s26, s26, 21
    s_min_u32 s26, s26, 140
    s_sub_u32 s26, s26, 20
    s_sub_u32 s27, 111, s26
    s_cmp_le_u32 s27, 12
    s_cselect_b32 s26, 111, s26
    s_lshl_b32 s26, s26, 8
    v_mov_b32_e64 v255, s26
    ds_write_b32 v254, v255

L_p2:
    s_cmp_lg_u32 s16, 1
    s_cbranch_scc1 L_nodma0
    s_setprio 3

    v_lshrrev_b32 v176, 9, v253
    v_mul_u32_u24 v177, 1536, v176
    v_add_u32_e64 v177, v177, v253
    v_bfe_u32 v254, v253, 6, 3
    v_lshl_add_u32 v176, v176, 4, v254
    v_mul_u32_u24 v176, 768, v176
    v_and_b32 v254, 48, v253
    v_add_u32 v176, v176, v254

    v_add_u32 v254, 161908, v240

    s_mov_b32 s29, 200000
L_wg0:
    ds_read_b32 v255, v254
    s_waitcnt lgkmcnt(0)
    v_cmp_ne_u32 vcc, 0, v255
    s_cmp_eq_u64 vcc, exec
    s_cbranch_scc1 L_wg0_ok
    s_sleep 2
    s_sub_u32 s29, s29, 1
    s_cmp_lg_u32 s29, 0
    s_cbranch_scc1 L_wg0
L_wg0_ok:

    s_add_u32 s26, s39, 0
    s_cmp_ge_u32 s26, 12
    s_cselect_b32 s27, 12, 0
    s_sub_u32 s26, s26, s27
    s_mul_i32 s26, s26, 64

    s_mov_b32 m0, 131080
    s_add_u32 s30, s26, 0
    s_add_u32 s31, s26, 23552
    s_add_u32 s32, s26, 47104
    buffer_load_dwordx4 v176, s[40:43], s30 offen offset:0 lds
    buffer_load_dwordx4 v176, s[40:43], s31 offen offset:1024 lds
    buffer_load_dwordx4 v176, s[40:43], s32 offen offset:2048 lds
    s_mov_b32 m0, 146448
    s_add_u32 s30, s26, 6144
    s_add_u32 s31, s26, 29696
    s_add_u32 s32, s26, 53248
    buffer_load_dwordx4 v176, s[40:43], s30 offen offset:0 lds
    buffer_load_dwordx4 v176, s[40:43], s31 offen offset:1024 lds
    buffer_load_dwordx4 v176, s[40:43], s32 offen offset:2048 lds

    s_add_u32 s26, s39, 1
    s_cmp_ge_u32 s26, 12
    s_cselect_b32 s27, 12, 0
    s_sub_u32 s26, s26, s27
    s_mul_i32 s26, s26, 64

    s_mov_b32 m0, 134152
    s_add_u32 s30, s26, 0
    s_add_u32 s31, s26, 23552
    s_add_u32 s32, s26, 47104
    buffer_load_dwordx4 v176, s[40:43], s30 offen offset:0 lds
    buffer_load_dwordx4 v176, s[40:43], s31 offen offset:1024 lds
    buffer_load_dwordx4 v176, s[40:43], s32 offen offset:2048 lds
    s_mov_b32 m0, 149520
    s_add_u32 s30, s26, 6144
    s_add_u32 s31, s26, 29696
    s_add_u32 s32, s26, 53248
    buffer_load_dwordx4 v176, s[40:43], s30 offen offset:0 lds
    buffer_load_dwordx4 v176, s[40:43], s31 offen offset:1024 lds
    buffer_load_dwordx4 v176, s[40:43], s32 offen offset:2048 lds

    s_add_u32 s26, s39, 2
    s_cmp_ge_u32 s26, 12
    s_cselect_b32 s27, 12, 0
    s_sub_u32 s26, s26, s27
    s_mul_i32 s26, s26, 64

    s_mov_b32 m0, 137224
    s_add_u32 s30, s26, 0
    s_add_u32 s31, s26, 23552
    s_add_u32 s32, s26, 47104
    buffer_load_dwordx4 v176, s[40:43], s30 offen offset:0 lds
    buffer_load_dwordx4 v176, s[40:43], s31 offen offset:1024 lds
    buffer_load_dwordx4 v176, s[40:43], s32 offen offset:2048 lds
    s_mov_b32 m0, 152592
    s_add_u32 s30, s26, 6144
    s_add_u32 s31, s26, 29696
    s_add_u32 s32, s26, 53248
    buffer_load_dwordx4 v176, s[40:43], s30 offen offset:0 lds
    buffer_load_dwordx4 v176, s[40:43], s31 offen offset:1024 lds
    buffer_load_dwordx4 v176, s[40:43], s32 offen offset:2048 lds

    s_add_u32 s26, s39, 0
    s_cmp_ge_u32 s26, 12
    s_cselect_b32 s27, 12, 0
    s_sub_u32 s26, s26, s27
    s_mul_i32 s26, s26, 6144

    s_mov_b32 m0, 140296
    s_add_u32 s30, s26, 0
    s_add_u32 s31, s26, 1536
    buffer_load_dwordx4 v253, s[44:47], s30 offen lds
    buffer_load_dwordx4 v177, s[44:47], s30 offen offset:1024 lds
    buffer_load_dwordx4 v253, s[44:47], s31 offen offset:2048 lds
    s_mov_b32 m0, 155664
    s_add_u32 s30, s26, 1536
    s_add_u32 s31, s26, 3072
    buffer_load_dwordx4 v253, s[44:47], s30 offen lds
    buffer_load_dwordx4 v177, s[44:47], s30 offen offset:1024 lds
    buffer_load_dwordx4 v253, s[44:47], s31 offen offset:2048 lds

    s_add_u32 s26, s39, 3
    s_cmp_ge_u32 s26, 12
    s_cselect_b32 s27, 12, 0
    s_sub_u32 s26, s26, s27
    s_mul_i32 s26, s26, 64

    s_mov_b32 m0, 143368
    s_add_u32 s30, s26, 0
    s_add_u32 s31, s26, 23552
    s_add_u32 s32, s26, 47104
    buffer_load_dwordx4 v176, s[40:43], s30 offen offset:0 lds
    buffer_load_dwordx4 v176, s[40:43], s31 offen offset:1024 lds
    buffer_load_dwordx4 v176, s[40:43], s32 offen offset:2048 lds
    s_mov_b32 m0, 158736
    s_add_u32 s30, s26, 6144
    s_add_u32 s31, s26, 29696
    s_add_u32 s32, s26, 53248
    buffer_load_dwordx4 v176, s[40:43], s30 offen offset:0 lds
    buffer_load_dwordx4 v176, s[40:43], s31 offen offset:1024 lds
    buffer_load_dwordx4 v176, s[40:43], s32 offen offset:2048 lds
    v_mov_b32 v254, 161976
    v_mov_b32 v180, 1
    s_waitcnt vmcnt(24)
    ds_write_b32 v254, v180
    v_mov_b32 v181, 2
    s_waitcnt vmcnt(18)
    ds_write_b32 v254, v181
    v_mov_b32 v182, 3
    s_waitcnt vmcnt(12)
    ds_write_b32 v254, v182
    v_mov_b32 v183, 4
    s_waitcnt vmcnt(6)
    ds_write_b32 v254, v183
    v_mov_b32 v184, 5
    s_waitcnt vmcnt(0)
    ds_write_b32 v254, v184
L_nodma0:
    v_mov_b32 v254, 161980

    s_mov_b32 s29, 200000
L_wi:
    ds_read_b32 v255, v254
    s_waitcnt lgkmcnt(0)
    v_cmp_eq_u32 vcc, 2, v255
    s_cmp_eq_u64 vcc, exec
    s_cbranch_scc1 L_wi_ok
    s_sleep 2
    s_sub_u32 s29, s29, 1
    s_cmp_lg_u32 s29, 0
    s_cbranch_scc1 L_wi
L_wi_ok:

    v_bfe_u32 v176, v253, 6, 2
    v_and_b32 v177, 48, v253
    v_lshrrev_b32_e64 v178, 9, v253
    v_lshl_add_u32 v176, v178, 3, v176
    v_lshl_add_u32 v254, v176, 6, v177
    v_mul_u32_u24 v176, 192, v176
    v_add_u32_e64 v255, v176, v177
    v_bfe_u32 v176, v253, 8, 1
    v_mul_u32_u24 v177, 65544, v176
    v_add_u32 v254, v254, v177
    v_add_u32 v255, v255, v177
    v_lshrrev_b32_e64 v176, 8, v253
    v_bfe_u32 v177, v253, 6, 2
    v_cmp_eq_u32 vcc, v176, v177
    v_and_b32 v176, 16, v253
    v_mov_b32 v177, 0x3f80
    v_lshlrev_b32 v176, v176, v177
    v_cndmask_b32 v176, 0, v176, vcc
    v_and_b32 v177, 32, v253
    v_cmp_eq_u32 vcc, 0, v177
    s_nop 1
    v_cndmask_b32 v242, 0, v176, vcc
    v_sub_u32_e64 v243, v176, v242
    s_mov_b32 s84, 0xc4eac4ea
    s_mov_b32 s85, 0x377f377f
    s_add_u32 s83, s98, 0x3eefde6e
    s_mov_b32 s86, 0x00003f80
    s_mov_b32 s87, 0x3f800000
    s_mov_b32 s17, 0
    s_mov_b32 s19, 0
    s_mov_b32 s99, 0
    s_mov_b32 s90, 0xff00ff00
    s_mov_b32 s91, 0xff00ff00

    s_setprio 1

L_mtile:

    v_bfe_u32 v224, v253, 8, 1
    v_mul_u32_u24 v224, 50176, v224
    v_subrev_u32 v224, 131080, v224
    v_sub_u32 v254, v254, v224
    s_cmp_lt_u32 s19, 1
    s_cbranch_scc1 L_rd1_slow
L_rd1_go:
    ds_read_b64_tr_b16 v[224:225], v254 offset:0
    ds_read_b64_tr_b16 v[226:227], v254 offset:256
    ds_read_b64_tr_b16 v[228:229], v254 offset:1024
    ds_read_b64_tr_b16 v[230:231], v254 offset:1280
    ds_read_b64_tr_b16 v[232:233], v254 offset:2048
    ds_read_b64_tr_b16 v[234:235], v254 offset:2304
    ds_read_b64_tr_b16 v[236:237], v254 offset:8
    ds_read_b64_tr_b16 v[238:239], v254 offset:264
    s_waitcnt vmcnt(12)
    s_cmp_lg_u32 s99, 0
    s_cbranch_scc1 L_fix
L_fixed:
    s_waitcnt lgkmcnt(6)
    v_mfma_f32_16x16x32_bf16 v[176:179], v[224:227], v[0:3], 0
    v_mfma_f32_16x16x32_bf16 v[180:183], v[224:227], v[4:7], 0
    v_mfma_f32_16x16x32_bf16 v[184:187], v[224:227], v[8:11], 0
    v_mfma_f32_16x16x32_bf16 v[188:191], v[224:227], v[12:15], 0
    ds_read_b64_tr_b16 v[224:225], v254 offset:1032
    s_waitcnt lgkmcnt(5)
    v_mfma_f32_16x16x32_bf16 v[176:179], v[228:231], v[16:19], v[176:179]
    ds_read_b64_tr_b16 v[226:227], v254 offset:1288
    v_mfma_f32_16x16x32_bf16 v[180:183], v[228:231], v[20:23], v[180:183]
    v_mfma_f32_16x16x32_bf16 v[184:187], v[228:231], v[24:27], v[184:187]
    v_mfma_f32_16x16x32_bf16 v[188:191], v[228:231], v[28:31], v[188:191]
    ds_read_b64_tr_b16 v[228:229], v254 offset:2056
    s_waitcnt lgkmcnt(5)
    v_mfma_f32_16x16x32_bf16 v[176:179], v[232:235], v[32:35], v[176:179]
    ds_read_b64_tr_b16 v[230:231], v254 offset:2312
    v_mfma_f32_16x16x32_bf16 v[180:183], v[232:235], v[36:39], v[180:183]
    v_mfma_f32_16x16x32_bf16 v[184:187], v[232:235], v[40:43], v[184:187]
    v_mfma_f32_16x16x32_bf16 v[188:191], v[232:235], v[44:47], v[188:191]
    s_cmp_lt_u32 s19, 2
    s_cbranch_scc1 L_rd2_slow
L_rd2_go:
    ds_read_b64_tr_b16 v[232:233], v254 offset:3072
    s_waitcnt lgkmcnt(5)
    v_mfma_f32_16x16x32_bf16 v[192:195], v[236:239], v[0:3], 0
    ds_read_b64_tr_b16 v[234:235], v254 offset:3328
    v_mfma_f32_16x16x32_bf16 v[196:199], v[236:239], v[4:7], 0
    v_mfma_f32_16x16x32_bf16 v[200:203], v[236:239], v[8:11], 0
    v_lshlrev_b32_sdwa v176, 1, v176 dst_sel:DWORD dst_unused:UNUSED_PAD src0_sel:DWORD src1_sel:WORD_1
    v_fma_mixlo_f16 v188, v188, s83, 0
    v_fma_mixlo_f16 v190, v190, s83, 0
    v_mfma_f32_16x16x32_bf16 v[204:207], v[236:239], v[12:15], 0
    ds_read_b64_tr_b16 v[236:237], v254 offset:4096
    ds_read_b64_tr_b16 v[238:239], v254 offset:4352
    v_lshlrev_b32_sdwa v177, 1, v177 dst_sel:DWORD dst_unused:UNUSED_PAD src0_sel:DWORD src1_sel:WORD_1
    v_fma_mixhi_f16 v188, v189, s83, 0
    v_lshlrev_b32_sdwa v178, 1, v178 dst_sel:DWORD dst_unused:UNUSED_PAD src0_sel:DWORD src1_sel:WORD_1
    s_waitcnt lgkmcnt(6)
    v_mfma_f32_16x16x32_bf16 v[192:195], v[224:227], v[16:19], v[192:195]
    ds_read_u16_d16 v176, v176
    v_fma_mixhi_f16 v190, v191, s83, 0
    v_pk_fma_f16 v189, v188, v188, s84 neg_lo:[0,1,0] neg_hi:[0,1,0]
    v_lshlrev_b32_sdwa v179, 1, v179 dst_sel:DWORD dst_unused:UNUSED_PAD src0_sel:DWORD src1_sel:WORD_1
    v_mfma_f32_16x16x32_bf16 v[196:199], v[224:227], v[20:23], v[196:199]
    ds_read_u16_d16_hi v177, v177
    ds_read_u16_d16 v178, v178
    v_pk_fma_f16 v191, v190, v190, s84 neg_lo:[0,1,0] neg_hi:[0,1,0]
    v_lshlrev_b32_sdwa v180, 1, v180 dst_sel:DWORD dst_unused:UNUSED_PAD src0_sel:DWORD src1_sel:WORD_1
    v_pk_mul_f16 v189, v189, v188
    v_mfma_f32_16x16x32_bf16 v[200:203], v[224:227], v[24:27], v[200:203]
    ds_read_u16_d16_hi v179, v179
    v_pk_mul_f16 v191, v191, v190
    v_lshlrev_b32_sdwa v181, 1, v181 dst_sel:DWORD dst_unused:UNUSED_PAD src0_sel:DWORD src1_sel:WORD_1
    v_exp_f16_sdwa v189, v189 dst_sel:WORD_0 dst_unused:UNUSED_PRESERVE src0_sel:WORD_0
    v_mfma_f32_16x16x32_bf16 v[204:207], v[224:227], v[28:31], v[204:207]
    ds_read_b64_tr_b16 v[224:225], v254 offset:5120
    ds_read_b64_tr_b16 v[226:227], v254 offset:5376
    v_lshlrev_b32_sdwa v182, 1, v182 dst_sel:DWORD dst_unused:UNUSED_PAD src0_sel:DWORD src1_sel:WORD_1
    v_exp_f16_sdwa v191, v191 dst_sel:WORD_0 dst_unused:UNUSED_PRESERVE src0_sel:WORD_0
    s_waitcnt lgkmcnt(7)
    v_mfma_f32_16x16x32_bf16 v[192:195], v[228:231], v[32:35], v[192:195]
    ds_read_u16_d16 v180, v180
    v_lshlrev_b32_sdwa v183, 1, v183 dst_sel:DWORD dst_unused:UNUSED_PAD src0_sel:DWORD src1_sel:WORD_1
    v_lshlrev_b32_sdwa v184, 1, v184 dst_sel:DWORD dst_unused:UNUSED_PAD src0_sel:DWORD src1_sel:WORD_1
    v_mfma_f32_16x16x32_bf16 v[196:199], v[228:231], v[36:39], v[196:199]
    ds_read_u16_d16_hi v181, v181
    ds_read_u16_d16 v182, v182
    v_exp_f16_sdwa v189, v189 dst_sel:WORD_1 dst_unused:UNUSED_PRESERVE src0_sel:WORD_1
    v_lshlrev_b32_sdwa v185, 1, v185 dst_sel:DWORD dst_unused:UNUSED_PAD src0_sel:DWORD src1_sel:WORD_1
    v_mfma_f32_16x16x32_bf16 v[200:203], v[228:231], v[40:43], v[200:203]
    ds_read_u16_d16_hi v183, v183
    v_exp_f16_sdwa v191, v191 dst_sel:WORD_1 dst_unused:UNUSED_PRESERVE src0_sel:WORD_1
    v_lshlrev_b32_sdwa v186, 1, v186 dst_sel:DWORD dst_unused:UNUSED_PAD src0_sel:DWORD src1_sel:WORD_1
    v_mfma_f32_16x16x32_bf16 v[204:207], v[228:231], v[44:47], v[204:207]
    ds_read_b64_tr_b16 v[228:229], v254 offset:3080
    ds_read_b64_tr_b16 v[230:231], v254 offset:3336
    ds_read_u16_d16 v184, v184
    v_pk_fma_f16 v189, v189, s85, s85
    v_lshlrev_b32_sdwa v187, 1, v187 dst_sel:DWORD dst_unused:UNUSED_PAD src0_sel:DWORD src1_sel:WORD_1
    v_pk_fma_f16 v191, v191, s85, s85
    v_mfma_f32_16x16x32_bf16 v[208:211], v[232:235], v[0:3], 0
    ds_read_u16_d16_hi v185, v185
    v_mfma_f32_16x16x32_bf16 v[212:215], v[232:235], v[4:7], 0
    ds_read_u16_d16 v186, v186
    ds_read_u16_d16_hi v187, v187
    v_mfma_f32_16x16x32_bf16 v[216:219], v[232:235], v[8:11], 0
    s_waitcnt lgkmcnt(7)
    v_or_b32_e64 v144, v176, v177
    v_rcp_f16_sdwa v189, v189 dst_sel:WORD_0 dst_unused:UNUSED_PRESERVE src0_sel:WORD_0
    v_lshlrev_b32_sdwa v192, 1, v192 dst_sel:DWORD dst_unused:UNUSED_PAD src0_sel:DWORD src1_sel:WORD_1
    v_mfma_f32_16x16x32_bf16 v[220:223], v[232:235], v[12:15], 0
    ds_read_b64_tr_b16 v[232:233], v254 offset:4104
    v_rcp_f16_sdwa v191, v191 dst_sel:WORD_0 dst_unused:UNUSED_PRESERVE src0_sel:WORD_0
    v_lshlrev_b32_sdwa v193, 1, v193 dst_sel:DWORD dst_unused:UNUSED_PAD src0_sel:DWORD src1_sel:WORD_1
    v_or_b32_e64 v145, v178, v179
    v_fma_mixlo_f16 v206, v206, s83, 0
    v_mfma_f32_16x16x32_bf16 v[208:211], v[236:239], v[16:19], v[208:211]
    ds_read_b64_tr_b16 v[234:235], v254 offset:4360
    ds_read_u16_d16 v192, v192
    v_lshlrev_b32_sdwa v194, 1, v194 dst_sel:DWORD dst_unused:UNUSED_PAD src0_sel:DWORD src1_sel:WORD_1
    v_rcp_f16_sdwa v189, v189 dst_sel:WORD_1 dst_unused:UNUSED_PRESERVE src0_sel:WORD_1
    v_lshlrev_b32_sdwa v195, 1, v195 dst_sel:DWORD dst_unused:UNUSED_PAD src0_sel:DWORD src1_sel:WORD_1
    v_mfma_f32_16x16x32_bf16 v[212:215], v[236:239], v[20:23], v[212:215]
    ds_read_u16_d16_hi v193, v193
    ds_read_u16_d16 v194, v194
    v_or_b32_e64 v148, v180, v181
    v_rcp_f16_sdwa v191, v191 dst_sel:WORD_1 dst_unused:UNUSED_PRESERVE src0_sel:WORD_1
    v_lshlrev_b32_sdwa v196, 1, v196 dst_sel:DWORD dst_unused:UNUSED_PAD src0_sel:DWORD src1_sel:WORD_1
    v_mfma_f32_16x16x32_bf16 v[216:219], v[236:239], v[24:27], v[216:219]
    ds_read_u16_d16_hi v195, v195
    v_fma_mixhi_f16 v206, v207, s83, 0
    v_lshlrev_b32_sdwa v197, 1, v197 dst_sel:DWORD dst_unused:UNUSED_PAD src0_sel:DWORD src1_sel:WORD_1
    v_fma_mix_f32 v156, v188, v189, 0 op_sel_hi:[1,1,0]
    s_waitcnt lgkmcnt(7)
    v_or_b32 v149, v182, v183
    v_fma_mix_f32 v157, v190, v191, 0 op_sel_hi:[1,1,0]
    v_mfma_f32_16x16x32_bf16 v[220:223], v[236:239], v[28:31], v[220:223]
    ds_read_b64_tr_b16 v[236:237], v254 offset:5128
    ds_read_b64_tr_b16 v[238:239], v254 offset:5384
    v_lshlrev_b32_sdwa v198, 1, v198 dst_sel:DWORD dst_unused:UNUSED_PAD src0_sel:DWORD src1_sel:WORD_1
    v_pk_fma_f16 v207, v206, v206, s84 neg_lo:[0,1,0] neg_hi:[0,1,0]
    v_lshlrev_b32_sdwa v199, 1, v199 dst_sel:DWORD dst_unused:UNUSED_PAD src0_sel:DWORD src1_sel:WORD_1
    v_fma_mix_f32 v189, v188, v189, 0 op_sel:[1,1,0] op_sel_hi:[1,1,0]
    v_mfma_f32_16x16x32_bf16 v[208:211], v[224:227], v[32:35], v[208:211]
    ds_read_u16_d16 v196, v196
    ds_read_u16_d16_hi v197, v197
    v_or_b32_e64 v152, v184, v185
    v_fma_mix_f32 v191, v190, v191, 0 op_sel:[1,1,0] op_sel_hi:[1,1,0]
    v_lshlrev_b32_sdwa v200, 1, v200 dst_sel:DWORD dst_unused:UNUSED_PAD src0_sel:DWORD src1_sel:WORD_1
    v_pk_mul_f16 v207, v207, v206
    v_mfma_f32_16x16x32_bf16 v[212:215], v[224:227], v[36:39], v[212:215]
    ds_read_u16_d16 v198, v198
    v_cvt_pk_bf16_f32 v156, v156, v189
    v_lshlrev_b32_sdwa v201, 1, v201 dst_sel:DWORD dst_unused:UNUSED_PAD src0_sel:DWORD src1_sel:WORD_1
    v_cvt_pk_bf16_f32 v157, v157, v191
    s_waitcnt lgkmcnt(7)
    v_or_b32 v153, v186, v187
    v_mfma_f32_16x16x32_bf16 v[216:219], v[224:227], v[40:43], v[216:219]
    ds_read_u16_d16_hi v199, v199
    ds_read_u16_d16 v200, v200
    v_exp_f16_sdwa v207, v207 dst_sel:WORD_0 dst_unused:UNUSED_PRESERVE src0_sel:WORD_0
    v_lshlrev_b32_sdwa v202, 1, v202 dst_sel:DWORD dst_unused:UNUSED_PAD src0_sel:DWORD src1_sel:WORD_1
    v_lshlrev_b32_sdwa v203, 1, v203 dst_sel:DWORD dst_unused:UNUSED_PAD src0_sel:DWORD src1_sel:WORD_1
    v_mfma_f32_16x16x32_bf16 v[220:223], v[224:227], v[44:47], v[220:223]
    s_cmp_lt_u32 s19, 3
    s_cbranch_scc1 L_rd3_slow
L_rd3_go:
    ds_read_b64_tr_b16 v[224:225], v254 offset:6144
    ds_read_b64_tr_b16 v[226:227], v254 offset:6400
    ds_read_u16_d16_hi v201, v201
    v_exp_f16_sdwa v207, v207 dst_sel:WORD_1 dst_unused:UNUSED_PRESERVE src0_sel:WORD_1
    v_lshlrev_b32_sdwa v204, 1, v204 dst_sel:DWORD dst_unused:UNUSED_PAD src0_sel:DWORD src1_sel:WORD_1
    v_lshlrev_b32_sdwa v205, 1, v205 dst_sel:DWORD dst_unused:UNUSED_PAD src0_sel:DWORD src1_sel:WORD_1
    v_pk_fma_f16 v207, v207, s85, s85
    v_mfma_f32_16x16x32_bf16 v[176:179], v[228:231], v[0:3], 0
    ds_read_u16_d16 v202, v202
    v_mfma_f32_16x16x32_bf16 v[180:183], v[228:231], v[4:7], 0
    ds_read_u16_d16_hi v203, v203
    ds_read_u16_d16 v204, v204
    v_mfma_f32_16x16x32_bf16 v[184:187], v[228:231], v[8:11], 0
    ds_read_u16_d16_hi v205, v205
    v_or_b32_e64 v146, v192, v193
    v_rcp_f16_sdwa v207, v207 dst_sel:WORD_0 dst_unused:UNUSED_PRESERVE src0_sel:WORD_0
    v_lshlrev_b32_sdwa v208, 1, v208 dst_sel:DWORD dst_unused:UNUSED_PAD src0_sel:DWORD src1_sel:WORD_1
    v_mfma_f32_16x16x32_bf16 v[188:191], v[228:231], v[12:15], 0
    v_bfe_u32 v228, v253, 8, 1
    v_mul_u32_u24 v228, 50176, v228
    v_subrev_u32 v228, 131080, v228
    v_sub_u32 v255, v255, v228
    s_cmp_lt_u32 s19, 4
    s_cbranch_scc1 L_rd4_slow
L_rd4_go:
    ds_read_b64_tr_b16 v[228:229], v255 offset:9216
    ds_read_b64_tr_b16 v[230:231], v255 offset:9984
    v_fma_mixlo_f16 v220, v220, s83, 0
    v_lshlrev_b32_sdwa v209, 1, v209 dst_sel:DWORD dst_unused:UNUSED_PAD src0_sel:DWORD src1_sel:WORD_1
    v_fma_mixlo_f16 v222, v222, s83, 0
    s_waitcnt lgkmcnt(7)
    v_or_b32_e64 v147, v194, v195
    v_mfma_f32_16x16x32_bf16 v[176:179], v[232:235], v[16:19], v[176:179]
    ds_read_u16_d16 v208, v208
    v_rcp_f16_sdwa v207, v207 dst_sel:WORD_1 dst_unused:UNUSED_PRESERVE src0_sel:WORD_1
    v_lshlrev_b32_sdwa v210, 1, v210 dst_sel:DWORD dst_unused:UNUSED_PAD src0_sel:DWORD src1_sel:WORD_1
    v_fma_mixhi_f16 v220, v221, s83, 0
    v_lshlrev_b32_sdwa v211, 1, v211 dst_sel:DWORD dst_unused:UNUSED_PAD src0_sel:DWORD src1_sel:WORD_1
    v_mfma_f32_16x16x32_bf16 v[180:183], v[232:235], v[20:23], v[180:183]
    ds_read_u16_d16_hi v209, v209
    ds_read_u16_d16 v210, v210
    v_fma_mixhi_f16 v222, v223, s83, 0
    v_or_b32_e64 v150, v196, v197
    v_fma_mix_f32 v159, v206, v207, 0 op_sel_hi:[1,1,0]
    v_pk_fma_f16 v221, v220, v220, s84 neg_lo:[0,1,0] neg_hi:[0,1,0]
    v_lshlrev_b32_sdwa v212, 1, v212 dst_sel:DWORD dst_unused:UNUSED_PAD src0_sel:DWORD src1_sel:WORD_1
    v_mfma_f32_16x16x32_bf16 v[184:187], v[232:235], v[24:27], v[184:187]
    ds_read_u16_d16_hi v211, v211
    v_pk_fma_f16 v223, v222, v222, s84 neg_lo:[0,1,0] neg_hi:[0,1,0]
    v_lshlrev_b32_sdwa v213, 1, v213 dst_sel:DWORD dst_unused:UNUSED_PAD src0_sel:DWORD src1_sel:WORD_1
    v_fma_mix_f32 v207, v206, v207, 0 op_sel:[1,1,0] op_sel_hi:[1,1,0]
    v_or_b32_e64 v151, v198, v199
    v_mfma_f32_16x16x32_bf16 v[188:191], v[232:235], v[28:31], v[188:191]
    ds_read_b64_tr_b16 v[232:233], v254 offset:7168
    ds_read_b64_tr_b16 v[234:235], v254 offset:7424
    v_pk_mul_f16 v221, v221, v220
    v_pk_mul_f16 v223, v223, v222
    v_lshlrev_b32_sdwa v214, 1, v214 dst_sel:DWORD dst_unused:UNUSED_PAD src0_sel:DWORD src1_sel:WORD_1
    v_cvt_pk_bf16_f32 v159, v159, v207
    v_mfma_f32_16x16x32_bf16 v[176:179], v[236:239], v[32:35], v[176:179]
    ds_read_u16_d16 v212, v212
    v_lshlrev_b32_sdwa v215, 1, v215 dst_sel:DWORD dst_unused:UNUSED_PAD src0_sel:DWORD src1_sel:WORD_1
    v_exp_f16_sdwa v221, v221 dst_sel:WORD_0 dst_unused:UNUSED_PRESERVE src0_sel:WORD_0
    s_waitcnt lgkmcnt(7)
    v_or_b32 v154, v200, v201
    v_mfma_f32_16x16x32_bf16 v[180:183], v[236:239], v[36:39], v[180:183]
    ds_read_u16_d16_hi v213, v213
    ds_read_u16_d16 v214, v214
    v_exp_f16_sdwa v223, v223 dst_sel:WORD_0 dst_unused:UNUSED_PRESERVE src0_sel:WORD_0
    v_lshlrev_b32_sdwa v216, 1, v216 dst_sel:DWORD dst_unused:UNUSED_PAD src0_sel:DWORD src1_sel:WORD_1
    v_lshlrev_b32_sdwa v217, 1, v217 dst_sel:DWORD dst_unused:UNUSED_PAD src0_sel:DWORD src1_sel:WORD_1
    v_exp_f16_sdwa v221, v221 dst_sel:WORD_1 dst_unused:UNUSED_PRESERVE src0_sel:WORD_1
    v_mfma_f32_16x16x32_bf16 v[184:187], v[236:239], v[40:43], v[184:187]
    ds_read_u16_d16_hi v215, v215
    v_or_b32_e64 v155, v202, v203
    v_exp_f16_sdwa v223, v223 dst_sel:WORD_1 dst_unused:UNUSED_PRESERVE src0_sel:WORD_1
    v_lshlrev_b32_sdwa v218, 1, v218 dst_sel:DWORD dst_unused:UNUSED_PAD src0_sel:DWORD src1_sel:WORD_1
    v_mfma_f32_16x16x32_bf16 v[188:191], v[236:239], v[44:47], v[188:191]
    ds_read_b64_tr_b16 v[236:237], v255 offset:9224
    ds_read_b64_tr_b16 v[238:239], v255 offset:9992
    ds_read_u16_d16 v216, v216
    v_lshlrev_b32_sdwa v219, 1, v219 dst_sel:DWORD dst_unused:UNUSED_PAD src0_sel:DWORD src1_sel:WORD_1
    v_pk_fma_f16 v221, v221, s85, s85
    v_or_b32_e64 v158, v204, v205
    v_pk_fma_f16 v223, v223, s85, s85
    s_cmp_lg_u32 s38, 0
    s_cbranch_scc1 L_park
L_parked:
    v_mfma_f32_16x16x32_bf16 v[192:195], v[224:227], v[0:3], 0
    ds_read_u16_d16_hi v217, v217
    v_mfma_f32_16x16x32_bf16 v[196:199], v[224:227], v[4:7], 0
    ds_read_u16_d16 v218, v218
    v_mfma_f32_16x16x32_bf16 v[200:203], v[224:227], v[8:11], 0
    ds_read_u16_d16_hi v219, v219
    s_waitcnt lgkmcnt(7)
    v_or_b32 v160, v208, v209
    v_rcp_f16_sdwa v221, v221 dst_sel:WORD_0 dst_unused:UNUSED_PRESERVE src0_sel:WORD_0
    v_mfma_f32_16x16x32_bf16 v[204:207], v[224:227], v[12:15], 0
    ds_read_b64_tr_b16 v[224:225], v254 offset:8192
    v_lshlrev_b32_sdwa v176, 1, v176 dst_sel:DWORD dst_unused:UNUSED_PAD src0_sel:DWORD src1_sel:WORD_1
    v_mfma_f32_16x16x32_bf16 v[48:51], v[228:231], v[144:147], 0
    ds_read_b64_tr_b16 v[226:227], v254 offset:8448
    v_rcp_f16_sdwa v223, v223 dst_sel:WORD_0 dst_unused:UNUSED_PRESERVE src0_sel:WORD_0
    v_mfma_f32_16x16x32_bf16 v[56:59], v[228:231], v[148:151], 0
    ds_read_u16_d16 v176, v176
    v_lshlrev_b32_sdwa v177, 1, v177 dst_sel:DWORD dst_unused:UNUSED_PAD src0_sel:DWORD src1_sel:WORD_1
    v_or_b32_e64 v161, v210, v211
    v_mfma_f32_16x16x32_bf16 v[64:67], v[228:231], v[152:155], 0
    ds_read_u16_d16_hi v177, v177
    v_fma_mixlo_f16 v190, v190, s83, 0
    v_lshlrev_b32_sdwa v178, 1, v178 dst_sel:DWORD dst_unused:UNUSED_PAD src0_sel:DWORD src1_sel:WORD_1
    v_mfma_f32_16x16x32_bf16 v[72:75], v[228:231], v[156:159], 0
    ds_read_b64_tr_b16 v[228:229], v255 offset:9280
    v_rcp_f16_sdwa v221, v221 dst_sel:WORD_1 dst_unused:UNUSED_PRESERVE src0_sel:WORD_1
    v_mfma_f32_16x16x32_bf16 v[192:195], v[232:235], v[16:19], v[192:195]
    ds_read_b64_tr_b16 v[230:231], v255 offset:10048
    v_lshlrev_b32_sdwa v179, 1, v179 dst_sel:DWORD dst_unused:UNUSED_PAD src0_sel:DWORD src1_sel:WORD_1
    v_or_b32_e64 v164, v212, v213
    v_mfma_f32_16x16x32_bf16 v[196:199], v[232:235], v[20:23], v[196:199]
    ds_read_u16_d16 v178, v178
    v_rcp_f16_sdwa v223, v223 dst_sel:WORD_1 dst_unused:UNUSED_PRESERVE src0_sel:WORD_1
    v_mfma_f32_16x16x32_bf16 v[200:203], v[232:235], v[24:27], v[200:203]
    ds_read_u16_d16_hi v179, v179
    v_lshlrev_b32_sdwa v180, 1, v180 dst_sel:DWORD dst_unused:UNUSED_PAD src0_sel:DWORD src1_sel:WORD_1
    v_fma_mixhi_f16 v190, v191, s83, 0
    v_mfma_f32_16x16x32_bf16 v[204:207], v[232:235], v[28:31], v[204:207]
    ds_read_b64_tr_b16 v[232:233], v254 offset:6152
    ds_read_b64_tr_b16 v[234:235], v254 offset:6408
    v_lshlrev_b32_sdwa v181, 1, v181 dst_sel:DWORD dst_unused:UNUSED_PAD src0_sel:DWORD src1_sel:WORD_1
    v_fma_mix_f32 v172, v220, v221, 0 op_sel_hi:[1,1,0]
    s_waitcnt lgkmcnt(7)
    v_mfma_f32_16x16x32_bf16 v[52:55], v[236:239], v[144:147], 0
    ds_read_u16_d16 v180, v180
    v_or_b32 v165, v214, v215
    v_fma_mix_f32 v173, v222, v223, 0 op_sel_hi:[1,1,0]
    v_lshlrev_b32_sdwa v182, 1, v182 dst_sel:DWORD dst_unused:UNUSED_PAD src0_sel:DWORD src1_sel:WORD_1
    v_mfma_f32_16x16x32_bf16 v[60:63], v[236:239], v[148:151], 0
    ds_read_u16_d16_hi v181, v181
    v_pk_fma_f16 v191, v190, v190, s84 neg_lo:[0,1,0] neg_hi:[0,1,0]
    v_lshlrev_b32_sdwa v183, 1, v183 dst_sel:DWORD dst_unused:UNUSED_PAD src0_sel:DWORD src1_sel:WORD_1
    v_mfma_f32_16x16x32_bf16 v[68:71], v[236:239], v[152:155], 0
    ds_read_u16_d16 v182, v182
    v_fma_mix_f32 v221, v220, v221, 0 op_sel:[1,1,0] op_sel_hi:[1,1,0]
    v_or_b32_e64 v168, v216, v217
    v_mfma_f32_16x16x32_bf16 v[76:79], v[236:239], v[156:159], 0
    ds_read_b64_tr_b16 v[236:237], v255 offset:9288
    v_fma_mix_f32 v223, v222, v223, 0 op_sel:[1,1,0] op_sel_hi:[1,1,0]
    v_lshlrev_b32_sdwa v184, 1, v184 dst_sel:DWORD dst_unused:UNUSED_PAD src0_sel:DWORD src1_sel:WORD_1
    v_mfma_f32_16x16x32_bf16 v[192:195], v[224:227], v[32:35], v[192:195]
    ds_read_b64_tr_b16 v[238:239], v255 offset:10056
    v_pk_mul_f16 v191, v191, v190
    v_cvt_pk_bf16_f32 v172, v172, v221
    v_mfma_f32_16x16x32_bf16 v[196:199], v[224:227], v[36:39], v[196:199]
    ds_read_u16_d16_hi v183, v183
    v_lshlrev_b32_sdwa v185, 1, v185 dst_sel:DWORD dst_unused:UNUSED_PAD src0_sel:DWORD src1_sel:WORD_1
    v_cvt_pk_bf16_f32 v173, v173, v223
    v_mfma_f32_16x16x32_bf16 v[200:203], v[224:227], v[40:43], v[200:203]
    ds_read_u16_d16 v184, v184
    v_or_b32_e64 v169, v218, v219
    v_mfma_f32_16x16x32_bf16 v[204:207], v[224:227], v[44:47], v[204:207]
    ds_read_b64_tr_b16 v[224:225], v254 offset:7176
    v_exp_f16_sdwa v191, v191 dst_sel:WORD_0 dst_unused:UNUSED_PRESERVE src0_sel:WORD_0
    v_lshlrev_b32_sdwa v186, 1, v186 dst_sel:DWORD dst_unused:UNUSED_PAD src0_sel:DWORD src1_sel:WORD_1
    s_waitcnt lgkmcnt(7)
    v_mfma_f32_16x16x32_bf16 v[80:83], v[228:231], v[144:147], 0
    ds_read_b64_tr_b16 v[226:227], v254 offset:7432
    v_lshlrev_b32_sdwa v187, 1, v187 dst_sel:DWORD dst_unused:UNUSED_PAD src0_sel:DWORD src1_sel:WORD_1
    v_mfma_f32_16x16x32_bf16 v[88:91], v[228:231], v[148:151], 0
    ds_read_u16_d16_hi v185, v185
    v_exp_f16_sdwa v191, v191 dst_sel:WORD_1 dst_unused:UNUSED_PRESERVE src0_sel:WORD_1
    v_lshlrev_b32_sdwa v188, 1, v188 dst_sel:DWORD dst_unused:UNUSED_PAD src0_sel:DWORD src1_sel:WORD_1
    v_mfma_f32_16x16x32_bf16 v[96:99], v[228:231], v[152:155], 0
    ds_read_u16_d16 v186, v186
    buffer_load_dwordx4 v[244:247], v252, s[4:7], s24 offen offset:0 sc1
    buffer_load_dwordx4 v[248:251], v252, s[4:7], s24 offen offset:64 sc1
    v_mfma_f32_16x16x32_bf16 v[104:107], v[228:231], v[156:159], 0
    ds_read_b64_tr_b16 v[228:229], v255 offset:9344
    ds_read_b64_tr_b16 v[230:231], v255 offset:10112
    v_lshlrev_b32_sdwa v189, 1, v189 dst_sel:DWORD dst_unused:UNUSED_PAD src0_sel:DWORD src1_sel:WORD_1
    v_pk_fma_f16 v191, v191, s85, s85
    v_mfma_f32_16x16x32_bf16 v[208:211], v[232:235], v[0:3], 0
    ds_read_u16_d16_hi v187, v187
    v_or_b32 v162, v176, v177
    v_mfma_f32_16x16x32_bf16 v[212:215], v[232:235], v[4:7], 0
    ds_read_u16_d16 v188, v188
    v_rcp_f16_sdwa v191, v191 dst_sel:WORD_0 dst_unused:UNUSED_PRESERVE src0_sel:WORD_0
    v_lshlrev_b32_sdwa v192, 1, v192 dst_sel:DWORD dst_unused:UNUSED_PAD src0_sel:DWORD src1_sel:WORD_1
    v_mfma_f32_16x16x32_bf16 v[216:219], v[232:235], v[8:11], 0
    ds_read_u16_d16_hi v189, v189
    v_fma_mixlo_f16 v204, v204, s83, 0
    v_lshlrev_b32_sdwa v193, 1, v193 dst_sel:DWORD dst_unused:UNUSED_PAD src0_sel:DWORD src1_sel:WORD_1
    v_mfma_f32_16x16x32_bf16 v[220:223], v[232:235], v[12:15], 0
    ds_read_b64_tr_b16 v[232:233], v254 offset:8200
    v_fma_mixlo_f16 v206, v206, s83, 0
    s_waitcnt lgkmcnt(7)
    v_mfma_f32_16x16x32_bf16 v[84:87], v[236:239], v[144:147], 0
    ds_read_b64_tr_b16 v[234:235], v254 offset:8456
    v_or_b32 v163, v178, v179
    v_rcp_f16_sdwa v191, v191 dst_sel:WORD_1 dst_unused:UNUSED_PRESERVE src0_sel:WORD_1
    v_mfma_f32_16x16x32_bf16 v[92:95], v[236:239], v[148:151], 0
    ds_read_u16_d16 v192, v192
    v_lshlrev_b32_sdwa v194, 1, v194 dst_sel:DWORD dst_unused:UNUSED_PAD src0_sel:DWORD src1_sel:WORD_1
    v_mfma_f32_16x16x32_bf16 v[100:103], v[236:239], v[152:155], 0
    ds_read_u16_d16_hi v193, v193
    v_fma_mixhi_f16 v204, v205, s83, 0
    v_lshlrev_b32_sdwa v195, 1, v195 dst_sel:DWORD dst_unused:UNUSED_PAD src0_sel:DWORD src1_sel:WORD_1
    v_mfma_f32_16x16x32_bf16 v[108:111], v[236:239], v[156:159], 0
    ds_read_b64_tr_b16 v[236:237], v255 offset:9352
    v_fma_mixhi_f16 v206, v207, s83, 0
    v_or_b32_e64 v166, v180, v181
    v_mfma_f32_16x16x32_bf16 v[208:211], v[224:227], v[16:19], v[208:211]
    ds_read_b64_tr_b16 v[238:239], v255 offset:10120
    v_fma_mix_f32 v175, v190, v191, 0 op_sel_hi:[1,1,0]
    v_pk_fma_f16 v205, v204, v204, s84 neg_lo:[0,1,0] neg_hi:[0,1,0]
    v_mfma_f32_16x16x32_bf16 v[212:215], v[224:227], v[20:23], v[212:215]
    ds_read_u16_d16 v194, v194
    v_lshlrev_b32_sdwa v196, 1, v196 dst_sel:DWORD dst_unused:UNUSED_PAD src0_sel:DWORD src1_sel:WORD_1
    v_mfma_f32_16x16x32_bf16 v[216:219], v[224:227], v[24:27], v[216:219]
    ds_read_u16_d16_hi v195, v195
    v_pk_fma_f16 v207, v206, v206, s84 neg_lo:[0,1,0] neg_hi:[0,1,0]
    v_lshlrev_b32_sdwa v197, 1, v197 dst_sel:DWORD dst_unused:UNUSED_PAD src0_sel:DWORD src1_sel:WORD_1
    v_mfma_f32_16x16x32_bf16 v[220:223], v[224:227], v[28:31], v[220:223]
    s_cmp_lt_u32 s19, 6
    s_cbranch_scc1 L_rd6_slow
L_rd6_go:
    ds_read_b64_tr_b16 v[224:225], v254 offset:12288
    v_fma_mix_f32 v191, v190, v191, 0 op_sel:[1,1,0] op_sel_hi:[1,1,0]
    v_or_b32 v167, v182, v183
    s_waitcnt lgkmcnt(7)
    v_mfma_f32_16x16x32_bf16 v[112:115], v[228:231], v[144:147], 0
    ds_read_b64_tr_b16 v[226:227], v254 offset:12544
    v_pk_mul_f16 v205, v205, v204
    v_pk_mul_f16 v207, v207, v206
    v_mfma_f32_16x16x32_bf16 v[120:123], v[228:231], v[148:151], 0
    ds_read_u16_d16 v196, v196
    v_lshlrev_b32_sdwa v198, 1, v198 dst_sel:DWORD dst_unused:UNUSED_PAD src0_sel:DWORD src1_sel:WORD_1
    v_cvt_pk_bf16_f32 v175, v175, v191
    v_mfma_f32_16x16x32_bf16 v[128:131], v[228:231], v[152:155], 0
    ds_read_u16_d16_hi v197, v197
    v_lshlrev_b32_sdwa v199, 1, v199 dst_sel:DWORD dst_unused:UNUSED_PAD src0_sel:DWORD src1_sel:WORD_1
    v_mfma_f32_16x16x32_bf16 v[136:139], v[228:231], v[156:159], 0
    v_bfe_u32 v228, v253, 8, 1
    v_mul_u32_u24 v228, 50176, v228
    v_subrev_u32 v228, 131080, v228
    v_add_u32_e64 v255, v255, v228
    ds_read_b64_tr_b16 v[228:229], v255 offset:7168
    v_exp_f16_sdwa v205, v205 dst_sel:WORD_0 dst_unused:UNUSED_PRESERVE src0_sel:WORD_0
    v_mfma_f32_16x16x32_bf16 v[208:211], v[232:235], v[32:35], v[208:211]
    ds_read_b64_tr_b16 v[230:231], v255 offset:7936
    v_or_b32_e64 v170, v184, v185
    v_exp_f16_sdwa v207, v207 dst_sel:WORD_0 dst_unused:UNUSED_PRESERVE src0_sel:WORD_0
    v_mfma_f32_16x16x32_bf16 v[212:215], v[232:235], v[36:39], v[212:215]
    ds_read_u16_d16 v198, v198
    v_lshlrev_b32_sdwa v200, 1, v200 dst_sel:DWORD dst_unused:UNUSED_PAD src0_sel:DWORD src1_sel:WORD_1
    v_mfma_f32_16x16x32_bf16 v[216:219], v[232:235], v[40:43], v[216:219]
    ds_read_u16_d16_hi v199, v199
    v_lshlrev_b32_sdwa v201, 1, v201 dst_sel:DWORD dst_unused:UNUSED_PAD src0_sel:DWORD src1_sel:WORD_1
    v_mfma_f32_16x16x32_bf16 v[220:223], v[232:235], v[44:47], v[220:223]
    ds_read_b64_tr_b16 v[232:233], v254 offset:13312
    v_exp_f16_sdwa v205, v205 dst_sel:WORD_1 dst_unused:UNUSED_PRESERVE src0_sel:WORD_1
    v_or_b32 v171, v186, v187
    s_waitcnt lgkmcnt(7)
    v_mfma_f32_16x16x32_bf16 v[116:119], v[236:239], v[144:147], 0
    ds_read_b64_tr_b16 v[234:235], v254 offset:13568
    v_exp_f16_sdwa v207, v207 dst_sel:WORD_1 dst_unused:UNUSED_PRESERVE src0_sel:WORD_1
    v_mfma_f32_16x16x32_bf16 v[124:127], v[236:239], v[148:151], 0
    ds_read_u16_d16 v200, v200
    v_lshlrev_b32_sdwa v202, 1, v202 dst_sel:DWORD dst_unused:UNUSED_PAD src0_sel:DWORD src1_sel:WORD_1
    v_mfma_f32_16x16x32_bf16 v[132:135], v[236:239], v[152:155], 0
    ds_read_u16_d16_hi v201, v201
    v_lshlrev_b32_sdwa v203, 1, v203 dst_sel:DWORD dst_unused:UNUSED_PAD src0_sel:DWORD src1_sel:WORD_1
    v_pk_fma_f16 v205, v205, s85, s85
    v_mfma_f32_16x16x32_bf16 v[140:143], v[236:239], v[156:159], 0
    ds_read_b64_tr_b16 v[236:237], v255 offset:7176
    v_or_b32_e64 v174, v188, v189
    v_pk_fma_f16 v207, v207, s85, s85
    v_mfma_f32_16x16x32_bf16 v[176:179], v[224:227], v[0:3], 0
    ds_read_b64_tr_b16 v[238:239], v255 offset:7944
    v_or_b32_e64 v144, v192, v193
    v_mfma_f32_16x16x32_bf16 v[180:183], v[224:227], v[4:7], 0
    ds_read_u16_d16 v202, v202
    v_rcp_f16_sdwa v205, v205 dst_sel:WORD_0 dst_unused:UNUSED_PRESERVE src0_sel:WORD_0
    v_lshlrev_b32_sdwa v208, 1, v208 dst_sel:DWORD dst_unused:UNUSED_PAD src0_sel:DWORD src1_sel:WORD_1
    v_mfma_f32_16x16x32_bf16 v[184:187], v[224:227], v[8:11], 0
    ds_read_u16_d16_hi v203, v203
    v_rcp_f16_sdwa v207, v207 dst_sel:WORD_0 dst_unused:UNUSED_PRESERVE src0_sel:WORD_0
    v_mfma_f32_16x16x32_bf16 v[188:191], v[224:227], v[12:15], 0
    ds_read_b64_tr_b16 v[224:225], v254 offset:14336
    v_lshlrev_b32_sdwa v209, 1, v209 dst_sel:DWORD dst_unused:UNUSED_PAD src0_sel:DWORD src1_sel:WORD_1
    s_waitcnt lgkmcnt(7)
    v_mfma_f32_16x16x32_bf16 v[48:51], v[228:231], v[160:163], v[48:51]
    ds_read_b64_tr_b16 v[226:227], v254 offset:14592
    v_or_b32 v145, v194, v195
    v_fma_mixlo_f16 v222, v222, s83, 0
    v_mfma_f32_16x16x32_bf16 v[56:59], v[228:231], v[164:167], v[56:59]
    ds_read_u16_d16 v208, v208
    v_lshlrev_b32_sdwa v210, 1, v210 dst_sel:DWORD dst_unused:UNUSED_PAD src0_sel:DWORD src1_sel:WORD_1
    v_mfma_f32_16x16x32_bf16 v[64:67], v[228:231], v[168:171], v[64:67]
    ds_read_u16_d16_hi v209, v209
    v_rcp_f16_sdwa v205, v205 dst_sel:WORD_1 dst_unused:UNUSED_PRESERVE src0_sel:WORD_1
    v_lshlrev_b32_sdwa v211, 1, v211 dst_sel:DWORD dst_unused:UNUSED_PAD src0_sel:DWORD src1_sel:WORD_1
    v_mfma_f32_16x16x32_bf16 v[72:75], v[228:231], v[172:175], v[72:75]
    ds_read_b64_tr_b16 v[228:229], v255 offset:7232
    v_or_b32_e64 v148, v196, v197
    v_mfma_f32_16x16x32_bf16 v[176:179], v[232:235], v[16:19], v[176:179]
    ds_read_b64_tr_b16 v[230:231], v255 offset:8000
    v_rcp_f16_sdwa v207, v207 dst_sel:WORD_1 dst_unused:UNUSED_PRESERVE src0_sel:WORD_1
    v_mfma_f32_16x16x32_bf16 v[180:183], v[232:235], v[20:23], v[180:183]
    ds_read_u16_d16 v210, v210
    v_lshlrev_b32_sdwa v212, 1, v212 dst_sel:DWORD dst_unused:UNUSED_PAD src0_sel:DWORD src1_sel:WORD_1
    v_fma_mixhi_f16 v222, v223, s83, 0
    v_mfma_f32_16x16x32_bf16 v[184:187], v[232:235], v[24:27], v[184:187]
    ds_read_u16_d16_hi v211, v211
    v_lshlrev_b32_sdwa v213, 1, v213 dst_sel:DWORD dst_unused:UNUSED_PAD src0_sel:DWORD src1_sel:WORD_1
    v_fma_mix_f32 v156, v204, v205, 0 op_sel_hi:[1,1,0]
    v_mfma_f32_16x16x32_bf16 v[188:191], v[232:235], v[28:31], v[188:191]
    ds_read_b64_tr_b16 v[232:233], v254 offset:12296
    ds_read_b64_tr_b16 v[234:235], v254 offset:12552
    v_or_b32_e64 v149, v198, v199
    v_fma_mix_f32 v157, v206, v207, 0 op_sel_hi:[1,1,0]
    s_waitcnt lgkmcnt(7)
    v_mfma_f32_16x16x32_bf16 v[52:55], v[236:239], v[160:163], v[52:55]
    ds_read_u16_d16 v212, v212
    v_lshlrev_b32_sdwa v214, 1, v214 dst_sel:DWORD dst_unused:UNUSED_PAD src0_sel:DWORD src1_sel:WORD_1
    v_mfma_f32_16x16x32_bf16 v[60:63], v[236:239], v[164:167], v[60:63]
    ds_read_u16_d16_hi v213, v213
    v_pk_fma_f16 v223, v222, v222, s84 neg_lo:[0,1,0] neg_hi:[0,1,0]
    v_lshlrev_b32_sdwa v215, 1, v215 dst_sel:DWORD dst_unused:UNUSED_PAD src0_sel:DWORD src1_sel:WORD_1
    v_mfma_f32_16x16x32_bf16 v[68:71], v[236:239], v[168:171], v[68:71]
    ds_read_u16_d16 v214, v214
    v_fma_mix_f32 v205, v204, v205, 0 op_sel:[1,1,0] op_sel_hi:[1,1,0]
    v_or_b32 v152, v200, v201
    v_mfma_f32_16x16x32_bf16 v[76:79], v[236:239], v[172:175], v[76:79]
    ds_read_b64_tr_b16 v[236:237], v255 offset:7240
    v_fma_mix_f32 v207, v206, v207, 0 op_sel:[1,1,0] op_sel_hi:[1,1,0]
    v_lshlrev_b32_sdwa v216, 1, v216 dst_sel:DWORD dst_unused:UNUSED_PAD src0_sel:DWORD src1_sel:WORD_1
    v_mfma_f32_16x16x32_bf16 v[176:179], v[224:227], v[32:35], v[176:179]
    ds_read_b64_tr_b16 v[238:239], v255 offset:8008
    v_pk_mul_f16 v223, v223, v222
    v_mfma_f32_16x16x32_bf16 v[180:183], v[224:227], v[36:39], v[180:183]
    ds_read_u16_d16_hi v215, v215
    v_cvt_pk_bf16_f32 v156, v156, v205
    v_lshlrev_b32_sdwa v217, 1, v217 dst_sel:DWORD dst_unused:UNUSED_PAD src0_sel:DWORD src1_sel:WORD_1
    v_mfma_f32_16x16x32_bf16 v[184:187], v[224:227], v[40:43], v[184:187]
    ds_read_u16_d16 v216, v216
    v_cvt_pk_bf16_f32 v157, v157, v207
    v_or_b32_e64 v153, v202, v203
    v_mfma_f32_16x16x32_bf16 v[188:191], v[224:227], v[44:47], v[188:191]
    ds_read_b64_tr_b16 v[224:225], v254 offset:13320
    v_exp_f16_sdwa v223, v223 dst_sel:WORD_0 dst_unused:UNUSED_PRESERVE src0_sel:WORD_0
    s_waitcnt lgkmcnt(7)
    v_mfma_f32_16x16x32_bf16 v[80:83], v[228:231], v[160:163], v[80:83]
    ds_read_b64_tr_b16 v[226:227], v254 offset:13576
    v_lshlrev_b32_sdwa v218, 1, v218 dst_sel:DWORD dst_unused:UNUSED_PAD src0_sel:DWORD src1_sel:WORD_1
    v_lshlrev_b32_sdwa v219, 1, v219 dst_sel:DWORD dst_unused:UNUSED_PAD src0_sel:DWORD src1_sel:WORD_1
    v_mfma_f32_16x16x32_bf16 v[88:91], v[228:231], v[164:167], v[88:91]
    ds_read_u16_d16_hi v217, v217
    v_exp_f16_sdwa v223, v223 dst_sel:WORD_1 dst_unused:UNUSED_PRESERVE src0_sel:WORD_1
    v_mfma_f32_16x16x32_bf16 v[96:99], v[228:231], v[168:171], v[96:99]
    ds_read_u16_d16 v218, v218
    v_lshlrev_b32_sdwa v220, 1, v220 dst_sel:DWORD dst_unused:UNUSED_PAD src0_sel:DWORD src1_sel:WORD_1
    v_mfma_f32_16x16x32_bf16 v[104:107], v[228:231], v[172:175], v[104:107]
    ds_read_b64_tr_b16 v[228:229], v255 offset:7296
    ds_read_b64_tr_b16 v[230:231], v255 offset:8064
    v_lshlrev_b32_sdwa v221, 1, v221 dst_sel:DWORD dst_unused:UNUSED_PAD src0_sel:DWORD src1_sel:WORD_1
    v_pk_fma_f16 v223, v223, s85, s85
    v_mfma_f32_16x16x32_bf16 v[192:195], v[232:235], v[0:3], 0
    ds_read_u16_d16_hi v219, v219
    v_or_b32 v146, v208, v209
    v_mfma_f32_16x16x32_bf16 v[196:199], v[232:235], v[4:7], 0
    ds_read_u16_d16 v220, v220
    v_rcp_f16_sdwa v223, v223 dst_sel:WORD_0 dst_unused:UNUSED_PRESERVE src0_sel:WORD_0
    v_lshlrev_b32_sdwa v176, 1, v176 dst_sel:DWORD dst_unused:UNUSED_PAD src0_sel:DWORD src1_sel:WORD_1
    v_mfma_f32_16x16x32_bf16 v[200:203], v[232:235], v[8:11], 0
    ds_read_u16_d16_hi v221, v221
    v_fma_mixlo_f16 v188, v188, s83, 0
    v_lshlrev_b32_sdwa v177, 1, v177 dst_sel:DWORD dst_unused:UNUSED_PAD src0_sel:DWORD src1_sel:WORD_1
    v_mfma_f32_16x16x32_bf16 v[204:207], v[232:235], v[12:15], 0
    ds_read_b64_tr_b16 v[232:233], v254 offset:14344
    v_fma_mixlo_f16 v190, v190, s83, 0
    v_or_b32 v147, v210, v211
    s_waitcnt lgkmcnt(7)
    v_mfma_f32_16x16x32_bf16 v[84:87], v[236:239], v[160:163], v[84:87]
    ds_read_b64_tr_b16 v[234:235], v254 offset:14600
    v_rcp_f16_sdwa v223, v223 dst_sel:WORD_1 dst_unused:UNUSED_PRESERVE src0_sel:WORD_1
    v_mfma_f32_16x16x32_bf16 v[92:95], v[236:239], v[164:167], v[92:95]
    ds_read_u16_d16 v176, v176
    s_waitcnt vmcnt(1)
    v_mfma_f32_16x16x16_bf16 v[48:51], v[242:243], v[244:245], v[48:51]
    v_lshlrev_b32_sdwa v178, 1, v178 dst_sel:DWORD dst_unused:UNUSED_PAD src0_sel:DWORD src1_sel:WORD_1
    v_mfma_f32_16x16x32_bf16 v[100:103], v[236:239], v[168:171], v[100:103]
    ds_read_u16_d16_hi v177, v177
    v_fma_mixhi_f16 v188, v189, s83, 0
    v_mfma_f32_16x16x32_bf16 v[108:111], v[236:239], v[172:175], v[108:111]
    ds_read_b64_tr_b16 v[236:237], v255 offset:7304
    v_mfma_f32_16x16x16_bf16 v[52:55], v[242:243], v[246:247], v[52:55]
    v_lshlrev_b32_sdwa v179, 1, v179 dst_sel:DWORD dst_unused:UNUSED_PAD src0_sel:DWORD src1_sel:WORD_1
    v_fma_mixhi_f16 v190, v191, s83, 0
    v_mfma_f32_16x16x32_bf16 v[192:195], v[224:227], v[16:19], v[192:195]
    ds_read_b64_tr_b16 v[238:239], v255 offset:8072
    buffer_load_dwordx4 v[244:247], v252, s[4:7], s24 offen offset:128 sc1
    v_or_b32 v150, v212, v213
    v_mfma_f32_16x16x32_bf16 v[196:199], v[224:227], v[20:23], v[196:199]
    ds_read_u16_d16 v178, v178
    v_fma_mix_f32 v159, v222, v223, 0 op_sel_hi:[1,1,0]
    v_pk_fma_f16 v189, v188, v188, s84 neg_lo:[0,1,0] neg_hi:[0,1,0]
    v_mfma_f32_16x16x32_bf16 v[200:203], v[224:227], v[24:27], v[200:203]
    ds_read_u16_d16_hi v179, v179
    v_lshlrev_b32_sdwa v180, 1, v180 dst_sel:DWORD dst_unused:UNUSED_PAD src0_sel:DWORD src1_sel:WORD_1
    v_pk_fma_f16 v191, v190, v190, s84 neg_lo:[0,1,0] neg_hi:[0,1,0]
    v_mfma_f32_16x16x32_bf16 v[204:207], v[224:227], v[28:31], v[204:207]
    v_bfe_u32 v224, v253, 8, 1
    v_mul_u32_u24 v224, 50176, v224
    v_subrev_u32 v224, 131080, v224
    v_add_u32 v254, v254, v224
    s_cmp_lt_u32 s19, 8
    s_cbranch_scc1 L_rd8_slow
L_rd8_go:
    ds_read_b64_tr_b16 v[224:225], v254 offset:10240
    v_lshlrev_b32_sdwa v181, 1, v181 dst_sel:DWORD dst_unused:UNUSED_PAD src0_sel:DWORD src1_sel:WORD_1
    v_fma_mix_f32 v223, v222, v223, 0 op_sel:[1,1,0] op_sel_hi:[1,1,0]
    s_waitcnt lgkmcnt(7)
    v_mfma_f32_16x16x32_bf16 v[112:115], v[228:231], v[160:163], v[112:115]
    ds_read_b64_tr_b16 v[226:227], v254 offset:10496
    v_or_b32_e64 v151, v214, v215
    v_pk_mul_f16 v189, v189, v188
    v_mfma_f32_16x16x32_bf16 v[120:123], v[228:231], v[164:167], v[120:123]
    ds_read_u16_d16 v180, v180
    v_pk_mul_f16 v191, v191, v190
    v_lshlrev_b32_sdwa v182, 1, v182 dst_sel:DWORD dst_unused:UNUSED_PAD src0_sel:DWORD src1_sel:WORD_1
    v_mfma_f32_16x16x32_bf16 v[128:131], v[228:231], v[168:171], v[128:131]
    ds_read_u16_d16_hi v181, v181
    v_cvt_pk_bf16_f32 v159, v159, v223
    v_lshlrev_b32_sdwa v183, 1, v183 dst_sel:DWORD dst_unused:UNUSED_PAD src0_sel:DWORD src1_sel:WORD_1
    v_mfma_f32_16x16x32_bf16 v[136:139], v[228:231], v[172:175], v[136:139]
    ds_read_b64_tr_b16 v[228:229], v255 offset:13312
    v_exp_f16_sdwa v189, v189 dst_sel:WORD_0 dst_unused:UNUSED_PRESERVE src0_sel:WORD_0
    v_mfma_f32_16x16x32_bf16 v[192:195], v[232:235], v[32:35], v[192:195]
    ds_read_b64_tr_b16 v[230:231], v255 offset:14080
    v_or_b32_e64 v154, v216, v217
    v_mfma_f32_16x16x32_bf16 v[196:199], v[232:235], v[36:39], v[196:199]
    ds_read_u16_d16 v182, v182
    v_exp_f16_sdwa v191, v191 dst_sel:WORD_0 dst_unused:UNUSED_PRESERVE src0_sel:WORD_0
    v_lshlrev_b32_sdwa v184, 1, v184 dst_sel:DWORD dst_unused:UNUSED_PAD src0_sel:DWORD src1_sel:WORD_1
    v_mfma_f32_16x16x32_bf16 v[200:203], v[232:235], v[40:43], v[200:203]
    ds_read_u16_d16_hi v183, v183
    v_lshlrev_b32_sdwa v185, 1, v185 dst_sel:DWORD dst_unused:UNUSED_PAD src0_sel:DWORD src1_sel:WORD_1
    v_mfma_f32_16x16x32_bf16 v[204:207], v[232:235], v[44:47], v[204:207]
    ds_read_b64_tr_b16 v[232:233], v254 offset:11264
    v_exp_f16_sdwa v189, v189 dst_sel:WORD_1 dst_unused:UNUSED_PRESERVE src0_sel:WORD_1
    s_waitcnt lgkmcnt(7)
    v_mfma_f32_16x16x32_bf16 v[116:119], v[236:239], v[160:163], v[116:119]
    ds_read_b64_tr_b16 v[234:235], v254 offset:11520
    v_or_b32 v155, v218, v219
    v_exp_f16_sdwa v191, v191 dst_sel:WORD_1 dst_unused:UNUSED_PRESERVE src0_sel:WORD_1
    v_mfma_f32_16x16x32_bf16 v[124:127], v[236:239], v[164:167], v[124:127]
    ds_read_u16_d16 v184, v184
    v_lshlrev_b32_sdwa v186, 1, v186 dst_sel:DWORD dst_unused:UNUSED_PAD src0_sel:DWORD src1_sel:WORD_1
    v_mfma_f32_16x16x32_bf16 v[132:135], v[236:239], v[168:171], v[132:135]
    ds_read_u16_d16_hi v185, v185
    v_lshlrev_b32_sdwa v187, 1, v187 dst_sel:DWORD dst_unused:UNUSED_PAD src0_sel:DWORD src1_sel:WORD_1
    v_pk_fma_f16 v189, v189, s85, s85
    v_mfma_f32_16x16x32_bf16 v[140:143], v[236:239], v[172:175], v[140:143]
    ds_read_b64_tr_b16 v[236:237], v255 offset:13320
    v_or_b32_e64 v158, v220, v221
    v_pk_fma_f16 v191, v191, s85, s85
    v_mfma_f32_16x16x32_bf16 v[208:211], v[224:227], v[0:3], 0
    ds_read_b64_tr_b16 v[238:239], v255 offset:14088
    v_or_b32_e64 v160, v176, v177
    v_mfma_f32_16x16x32_bf16 v[212:215], v[224:227], v[4:7], 0
    ds_read_u16_d16 v186, v186
    v_rcp_f16_sdwa v189, v189 dst_sel:WORD_0 dst_unused:UNUSED_PRESERVE src0_sel:WORD_0
    v_lshlrev_b32_sdwa v192, 1, v192 dst_sel:DWORD dst_unused:UNUSED_PAD src0_sel:DWORD src1_sel:WORD_1
    v_mfma_f32_16x16x32_bf16 v[216:219], v[224:227], v[8:11], 0
    ds_read_u16_d16_hi v187, v187
    v_rcp_f16_sdwa v191, v191 dst_sel:WORD_0 dst_unused:UNUSED_PRESERVE src0_sel:WORD_0
    v_mfma_f32_16x16x32_bf16 v[220:223], v[224:227], v[12:15], 0
    ds_read_b64_tr_b16 v[224:225], v254 offset:12288
    v_lshlrev_b32_sdwa v193, 1, v193 dst_sel:DWORD dst_unused:UNUSED_PAD src0_sel:DWORD src1_sel:WORD_1
    v_or_b32 v161, v178, v179
    s_waitcnt lgkmcnt(7)
    v_mfma_f32_16x16x32_bf16 v[48:51], v[228:231], v[144:147], v[48:51]
    ds_read_b64_tr_b16 v[226:227], v254 offset:12544
    v_fma_mixlo_f16 v206, v206, s83, 0
    v_mfma_f32_16x16x32_bf16 v[56:59], v[228:231], v[148:151], v[56:59]
    ds_read_u16_d16 v192, v192
    s_waitcnt vmcnt(1)
    v_mfma_f32_16x16x16_bf16 v[80:83], v[242:243], v[248:249], v[80:83]
    v_lshlrev_b32_sdwa v194, 1, v194 dst_sel:DWORD dst_unused:UNUSED_PAD src0_sel:DWORD src1_sel:WORD_1
    v_mfma_f32_16x16x32_bf16 v[64:67], v[228:231], v[152:155], v[64:67]
    ds_read_u16_d16_hi v193, v193
    v_rcp_f16_sdwa v189, v189 dst_sel:WORD_1 dst_unused:UNUSED_PRESERVE src0_sel:WORD_1
    v_mfma_f32_16x16x32_bf16 v[72:75], v[228:231], v[156:159], v[72:75]
    ds_read_b64_tr_b16 v[228:229], v255 offset:13376
    v_mfma_f32_16x16x16_bf16 v[84:87], v[242:243], v[250:251], v[84:87]
    v_lshlrev_b32_sdwa v195, 1, v195 dst_sel:DWORD dst_unused:UNUSED_PAD src0_sel:DWORD src1_sel:WORD_1
    v_or_b32 v164, v180, v181
    v_mfma_f32_16x16x32_bf16 v[208:211], v[232:235], v[16:19], v[208:211]
    ds_read_b64_tr_b16 v[230:231], v255 offset:14144
    buffer_load_dwordx4 v[248:251], v252, s[4:7], s24 offen offset:192 sc1
    v_mfma_f32_16x16x32_bf16 v[212:215], v[232:235], v[20:23], v[212:215]
    ds_read_u16_d16 v194, v194
    v_rcp_f16_sdwa v191, v191 dst_sel:WORD_1 dst_unused:UNUSED_PRESERVE src0_sel:WORD_1
    v_lshlrev_b32_sdwa v196, 1, v196 dst_sel:DWORD dst_unused:UNUSED_PAD src0_sel:DWORD src1_sel:WORD_1
    v_mfma_f32_16x16x32_bf16 v[216:219], v[232:235], v[24:27], v[216:219]
    ds_read_u16_d16_hi v195, v195
    v_fma_mixhi_f16 v206, v207, s83, 0
    v_lshlrev_b32_sdwa v197, 1, v197 dst_sel:DWORD dst_unused:UNUSED_PAD src0_sel:DWORD src1_sel:WORD_1
    v_mfma_f32_16x16x32_bf16 v[220:223], v[232:235], v[28:31], v[220:223]
    ds_read_b64_tr_b16 v[232:233], v254 offset:10248
    ds_read_b64_tr_b16 v[234:235], v254 offset:10504
    v_fma_mix_f32 v172, v188, v189, 0 op_sel_hi:[1,1,0]
    v_or_b32 v165, v182, v183
    s_waitcnt lgkmcnt(7)
    v_mfma_f32_16x16x32_bf16 v[52:55], v[236:239], v[144:147], v[52:55]
    ds_read_u16_d16 v196, v196
    v_fma_mix_f32 v173, v190, v191, 0 op_sel_hi:[1,1,0]
    v_mfma_f32_16x16x32_bf16 v[60:63], v[236:239], v[148:151], v[60:63]
    ds_read_u16_d16_hi v197, v197
    v_lshlrev_b32_sdwa v198, 1, v198 dst_sel:DWORD dst_unused:UNUSED_PAD src0_sel:DWORD src1_sel:WORD_1
    v_pk_fma_f16 v207, v206, v206, s84 neg_lo:[0,1,0] neg_hi:[0,1,0]
    v_mfma_f32_16x16x32_bf16 v[68:71], v[236:239], v[152:155], v[68:71]
    ds_read_u16_d16 v198, v198
    v_lshlrev_b32_sdwa v199, 1, v199 dst_sel:DWORD dst_unused:UNUSED_PAD src0_sel:DWORD src1_sel:WORD_1
    v_fma_mix_f32 v189, v188, v189, 0 op_sel:[1,1,0] op_sel_hi:[1,1,0]
    v_mfma_f32_16x16x32_bf16 v[76:79], v[236:239], v[156:159], v[76:79]
    ds_read_b64_tr_b16 v[236:237], v255 offset:13384
    v_or_b32_e64 v168, v184, v185
    v_fma_mix_f32 v191, v190, v191, 0 op_sel:[1,1,0] op_sel_hi:[1,1,0]
    v_mfma_f32_16x16x32_bf16 v[208:211], v[224:227], v[32:35], v[208:211]
    ds_read_b64_tr_b16 v[238:239], v255 offset:14152
    v_lshlrev_b32_sdwa v200, 1, v200 dst_sel:DWORD dst_unused:UNUSED_PAD src0_sel:DWORD src1_sel:WORD_1
    v_pk_mul_f16 v207, v207, v206
    v_mfma_f32_16x16x32_bf16 v[212:215], v[224:227], v[36:39], v[212:215]
    ds_read_u16_d16_hi v199, v199
    v_cvt_pk_bf16_f32 v172, v172, v189
    v_lshlrev_b32_sdwa v201, 1, v201 dst_sel:DWORD dst_unused:UNUSED_PAD src0_sel:DWORD src1_sel:WORD_1
    v_mfma_f32_16x16x32_bf16 v[216:219], v[224:227], v[40:43], v[216:219]
    ds_read_u16_d16 v200, v200
    v_cvt_pk_bf16_f32 v173, v173, v191
    v_or_b32_e64 v169, v186, v187
    v_mfma_f32_16x16x32_bf16 v[220:223], v[224:227], v[44:47], v[220:223]
    ds_read_b64_tr_b16 v[224:225], v254 offset:11272
    v_exp_f16_sdwa v207, v207 dst_sel:WORD_0 dst_unused:UNUSED_PRESERVE src0_sel:WORD_0
    s_waitcnt lgkmcnt(7)
    v_mfma_f32_16x16x32_bf16 v[80:83], v[228:231], v[144:147], v[80:83]
    ds_read_b64_tr_b16 v[226:227], v254 offset:11528
    v_lshlrev_b32_sdwa v202, 1, v202 dst_sel:DWORD dst_unused:UNUSED_PAD src0_sel:DWORD src1_sel:WORD_1
    v_mfma_f32_16x16x32_bf16 v[88:91], v[228:231], v[148:151], v[88:91]
    ds_read_u16_d16_hi v201, v201
    v_lshlrev_b32_sdwa v203, 1, v203 dst_sel:DWORD dst_unused:UNUSED_PAD src0_sel:DWORD src1_sel:WORD_1
    v_exp_f16_sdwa v207, v207 dst_sel:WORD_1 dst_unused:UNUSED_PRESERVE src0_sel:WORD_1
    v_mfma_f32_16x16x32_bf16 v[96:99], v[228:231], v[152:155], v[96:99]
    ds_read_u16_d16 v202, v202
    v_lshlrev_b32_sdwa v204, 1, v204 dst_sel:DWORD dst_unused:UNUSED_PAD src0_sel:DWORD src1_sel:WORD_1
    v_mfma_f32_16x16x32_bf16 v[104:107], v[228:231], v[156:159], v[104:107]
    ds_read_b64_tr_b16 v[228:229], v255 offset:13440
    ds_read_b64_tr_b16 v[230:231], v255 offset:14208
    v_lshlrev_b32_sdwa v205, 1, v205 dst_sel:DWORD dst_unused:UNUSED_PAD src0_sel:DWORD src1_sel:WORD_1
    v_pk_fma_f16 v207, v207, s85, s85
    v_mfma_f32_16x16x32_bf16 v[176:179], v[232:235], v[0:3], 0
    ds_read_u16_d16_hi v203, v203
    v_or_b32 v162, v192, v193
    v_mfma_f32_16x16x32_bf16 v[180:183], v[232:235], v[4:7], 0
    ds_read_u16_d16 v204, v204
    v_rcp_f16_sdwa v207, v207 dst_sel:WORD_0 dst_unused:UNUSED_PRESERVE src0_sel:WORD_0
    v_lshlrev_b32_sdwa v208, 1, v208 dst_sel:DWORD dst_unused:UNUSED_PAD src0_sel:DWORD src1_sel:WORD_1
    v_mfma_f32_16x16x32_bf16 v[184:187], v[232:235], v[8:11], 0
    ds_read_u16_d16_hi v205, v205
    v_fma_mixlo_f16 v220, v220, s83, 0
    v_lshlrev_b32_sdwa v209, 1, v209 dst_sel:DWORD dst_unused:UNUSED_PAD src0_sel:DWORD src1_sel:WORD_1
    v_mfma_f32_16x16x32_bf16 v[188:191], v[232:235], v[12:15], 0
    ds_read_b64_tr_b16 v[232:233], v254 offset:12296
    v_fma_mixlo_f16 v222, v222, s83, 0
    s_waitcnt lgkmcnt(7)
    v_mfma_f32_16x16x32_bf16 v[84:87], v[236:239], v[144:147], v[84:87]
    ds_read_b64_tr_b16 v[234:235], v254 offset:12552
    v_or_b32 v163, v194, v195
    v_rcp_f16_sdwa v207, v207 dst_sel:WORD_1 dst_unused:UNUSED_PRESERVE src0_sel:WORD_1
    v_mfma_f32_16x16x32_bf16 v[92:95], v[236:239], v[148:151], v[92:95]
    ds_read_u16_d16 v208, v208
    v_lshlrev_b32_sdwa v210, 1, v210 dst_sel:DWORD dst_unused:UNUSED_PAD src0_sel:DWORD src1_sel:WORD_1
    v_mfma_f32_16x16x32_bf16 v[100:103], v[236:239], v[152:155], v[100:103]
    ds_read_u16_d16_hi v209, v209
    v_fma_mixhi_f16 v220, v221, s83, 0
    v_lshlrev_b32_sdwa v211, 1, v211 dst_sel:DWORD dst_unused:UNUSED_PAD src0_sel:DWORD src1_sel:WORD_1
    v_mfma_f32_16x16x32_bf16 v[108:111], v[236:239], v[156:159], v[108:111]
    ds_read_b64_tr_b16 v[236:237], v255 offset:13448
    v_fma_mixhi_f16 v222, v223, s83, 0
    v_or_b32_e64 v166, v196, v197
    v_mfma_f32_16x16x32_bf16 v[176:179], v[224:227], v[16:19], v[176:179]
    ds_read_b64_tr_b16 v[238:239], v255 offset:14216
    v_fma_mix_f32 v175, v206, v207, 0 op_sel_hi:[1,1,0]
    v_pk_fma_f16 v221, v220, v220, s84 neg_lo:[0,1,0] neg_hi:[0,1,0]
    v_mfma_f32_16x16x32_bf16 v[180:183], v[224:227], v[20:23], v[180:183]
    ds_read_u16_d16 v210, v210
    v_lshlrev_b32_sdwa v212, 1, v212 dst_sel:DWORD dst_unused:UNUSED_PAD src0_sel:DWORD src1_sel:WORD_1
    v_mfma_f32_16x16x32_bf16 v[184:187], v[224:227], v[24:27], v[184:187]
    ds_read_u16_d16_hi v211, v211
    v_pk_fma_f16 v223, v222, v222, s84 neg_lo:[0,1,0] neg_hi:[0,1,0]
    v_lshlrev_b32_sdwa v213, 1, v213 dst_sel:DWORD dst_unused:UNUSED_PAD src0_sel:DWORD src1_sel:WORD_1
    v_mfma_f32_16x16x32_bf16 v[188:191], v[224:227], v[28:31], v[188:191]
    s_cmp_lt_u32 s19, 10
    s_cbranch_scc1 L_rd10_slow
L_rd10_go:
    ds_read_b64_tr_b16 v[224:225], v254 offset:16384
    v_fma_mix_f32 v207, v206, v207, 0 op_sel:[1,1,0] op_sel_hi:[1,1,0]
    v_or_b32 v167, v198, v199
    s_waitcnt lgkmcnt(7)
    v_mfma_f32_16x16x32_bf16 v[112:115], v[228:231], v[144:147], v[112:115]
    ds_read_b64_tr_b16 v[226:227], v254 offset:16640
    v_pk_mul_f16 v221, v221, v220
    v_pk_mul_f16 v223, v223, v222
    v_mfma_f32_16x16x32_bf16 v[120:123], v[228:231], v[148:151], v[120:123]
    ds_read_u16_d16 v212, v212
    v_lshlrev_b32_sdwa v214, 1, v214 dst_sel:DWORD dst_unused:UNUSED_PAD src0_sel:DWORD src1_sel:WORD_1
    v_cvt_pk_bf16_f32 v175, v175, v207
    v_mfma_f32_16x16x32_bf16 v[128:131], v[228:231], v[152:155], v[128:131]
    ds_read_u16_d16_hi v213, v213
    v_lshlrev_b32_sdwa v215, 1, v215 dst_sel:DWORD dst_unused:UNUSED_PAD src0_sel:DWORD src1_sel:WORD_1
    v_mfma_f32_16x16x32_bf16 v[136:139], v[228:231], v[156:159], v[136:139]
    ds_read_b64_tr_b16 v[228:229], v255 offset:19456
    v_exp_f16_sdwa v221, v221 dst_sel:WORD_0 dst_unused:UNUSED_PRESERVE src0_sel:WORD_0
    v_mfma_f32_16x16x32_bf16 v[176:179], v[232:235], v[32:35], v[176:179]
    ds_read_b64_tr_b16 v[230:231], v255 offset:20224
    v_or_b32_e64 v170, v200, v201
    v_exp_f16_sdwa v223, v223 dst_sel:WORD_0 dst_unused:UNUSED_PRESERVE src0_sel:WORD_0
    v_mfma_f32_16x16x32_bf16 v[180:183], v[232:235], v[36:39], v[180:183]
    ds_read_u16_d16 v214, v214
    v_lshlrev_b32_sdwa v216, 1, v216 dst_sel:DWORD dst_unused:UNUSED_PAD src0_sel:DWORD src1_sel:WORD_1
    v_mfma_f32_16x16x32_bf16 v[184:187], v[232:235], v[40:43], v[184:187]
    ds_read_u16_d16_hi v215, v215
    v_lshlrev_b32_sdwa v217, 1, v217 dst_sel:DWORD dst_unused:UNUSED_PAD src0_sel:DWORD src1_sel:WORD_1
    v_mfma_f32_16x16x32_bf16 v[188:191], v[232:235], v[44:47], v[188:191]
    ds_read_b64_tr_b16 v[232:233], v254 offset:17408
    v_exp_f16_sdwa v221, v221 dst_sel:WORD_1 dst_unused:UNUSED_PRESERVE src0_sel:WORD_1
    v_or_b32 v171, v202, v203
    s_waitcnt lgkmcnt(7)
    v_mfma_f32_16x16x32_bf16 v[116:119], v[236:239], v[144:147], v[116:119]
    ds_read_b64_tr_b16 v[234:235], v254 offset:17664
    v_exp_f16_sdwa v223, v223 dst_sel:WORD_1 dst_unused:UNUSED_PRESERVE src0_sel:WORD_1
    v_mfma_f32_16x16x32_bf16 v[124:127], v[236:239], v[148:151], v[124:127]
    ds_read_u16_d16 v216, v216
    v_lshlrev_b32_sdwa v218, 1, v218 dst_sel:DWORD dst_unused:UNUSED_PAD src0_sel:DWORD src1_sel:WORD_1
    v_mfma_f32_16x16x32_bf16 v[132:135], v[236:239], v[152:155], v[132:135]
    ds_read_u16_d16_hi v217, v217
    v_lshlrev_b32_sdwa v219, 1, v219 dst_sel:DWORD dst_unused:UNUSED_PAD src0_sel:DWORD src1_sel:WORD_1
    v_pk_fma_f16 v221, v221, s85, s85
    v_mfma_f32_16x16x32_bf16 v[140:143], v[236:239], v[156:159], v[140:143]
    ds_read_b64_tr_b16 v[236:237], v255 offset:19464
    v_or_b32_e64 v174, v204, v205
    v_pk_fma_f16 v223, v223, s85, s85
    v_mfma_f32_16x16x32_bf16 v[192:195], v[224:227], v[0:3], 0
    ds_read_b64_tr_b16 v[238:239], v255 offset:20232
    v_or_b32_e64 v144, v208, v209
    v_mfma_f32_16x16x32_bf16 v[196:199], v[224:227], v[4:7], 0
    ds_read_u16_d16 v218, v218
    v_rcp_f16_sdwa v221, v221 dst_sel:WORD_0 dst_unused:UNUSED_PRESERVE src0_sel:WORD_0
    v_lshlrev_b32_sdwa v176, 1, v176 dst_sel:DWORD dst_unused:UNUSED_PAD src0_sel:DWORD src1_sel:WORD_1
    v_mfma_f32_16x16x32_bf16 v[200:203], v[224:227], v[8:11], 0
    ds_read_u16_d16_hi v219, v219
    v_rcp_f16_sdwa v223, v223 dst_sel:WORD_0 dst_unused:UNUSED_PRESERVE src0_sel:WORD_0
    v_mfma_f32_16x16x32_bf16 v[204:207], v[224:227], v[12:15], 0
    ds_read_b64_tr_b16 v[224:225], v254 offset:18432
    v_lshlrev_b32_sdwa v177, 1, v177 dst_sel:DWORD dst_unused:UNUSED_PAD src0_sel:DWORD src1_sel:WORD_1
    v_or_b32 v145, v210, v211
    s_waitcnt lgkmcnt(7)
    v_mfma_f32_16x16x32_bf16 v[48:51], v[228:231], v[160:163], v[48:51]
    ds_read_b64_tr_b16 v[226:227], v254 offset:18688
    v_fma_mixlo_f16 v190, v190, s83, 0
    v_mfma_f32_16x16x32_bf16 v[56:59], v[228:231], v[164:167], v[56:59]
    ds_read_u16_d16 v176, v176
    s_waitcnt vmcnt(1)
    v_mfma_f32_16x16x16_bf16 v[112:115], v[242:243], v[244:245], v[112:115]
    v_lshlrev_b32_sdwa v178, 1, v178 dst_sel:DWORD dst_unused:UNUSED_PAD src0_sel:DWORD src1_sel:WORD_1
    v_mfma_f32_16x16x32_bf16 v[64:67], v[228:231], v[168:171], v[64:67]
    ds_read_u16_d16_hi v177, v177
    v_rcp_f16_sdwa v221, v221 dst_sel:WORD_1 dst_unused:UNUSED_PRESERVE src0_sel:WORD_1
    v_mfma_f32_16x16x32_bf16 v[72:75], v[228:231], v[172:175], v[72:75]
    ds_read_b64_tr_b16 v[228:229], v255 offset:19520
    v_mfma_f32_16x16x16_bf16 v[116:119], v[242:243], v[246:247], v[116:119]
    v_lshlrev_b32_sdwa v179, 1, v179 dst_sel:DWORD dst_unused:UNUSED_PAD src0_sel:DWORD src1_sel:WORD_1
    v_or_b32 v148, v212, v213
    v_mfma_f32_16x16x32_bf16 v[192:195], v[232:235], v[16:19], v[192:195]
    ds_read_b64_tr_b16 v[230:231], v255 offset:20288
    buffer_load_dwordx4 v[244:247], v252, s[4:7], s24 offen offset:256 sc1
    v_mfma_f32_16x16x32_bf16 v[196:199], v[232:235], v[20:23], v[196:199]
    ds_read_u16_d16 v178, v178
    v_rcp_f16_sdwa v223, v223 dst_sel:WORD_1 dst_unused:UNUSED_PRESERVE src0_sel:WORD_1
    v_lshlrev_b32_sdwa v180, 1, v180 dst_sel:DWORD dst_unused:UNUSED_PAD src0_sel:DWORD src1_sel:WORD_1
    v_mfma_f32_16x16x32_bf16 v[200:203], v[232:235], v[24:27], v[200:203]
    ds_read_u16_d16_hi v179, v179
    v_fma_mixhi_f16 v190, v191, s83, 0
    v_lshlrev_b32_sdwa v181, 1, v181 dst_sel:DWORD dst_unused:UNUSED_PAD src0_sel:DWORD src1_sel:WORD_1
    v_mfma_f32_16x16x32_bf16 v[204:207], v[232:235], v[28:31], v[204:207]
    ds_read_b64_tr_b16 v[232:233], v254 offset:16392
    ds_read_b64_tr_b16 v[234:235], v254 offset:16648
    v_fma_mix_f32 v156, v220, v221, 0 op_sel_hi:[1,1,0]
    v_or_b32 v149, v214, v215
    s_waitcnt lgkmcnt(7)
    v_mfma_f32_16x16x32_bf16 v[52:55], v[236:239], v[160:163], v[52:55]
    ds_read_u16_d16 v180, v180
    v_fma_mix_f32 v157, v222, v223, 0 op_sel_hi:[1,1,0]
    v_mfma_f32_16x16x32_bf16 v[60:63], v[236:239], v[164:167], v[60:63]
    ds_read_u16_d16_hi v181, v181
    v_lshlrev_b32_sdwa v182, 1, v182 dst_sel:DWORD dst_unused:UNUSED_PAD src0_sel:DWORD src1_sel:WORD_1
    v_pk_fma_f16 v191, v190, v190, s84 neg_lo:[0,1,0] neg_hi:[0,1,0]
    v_mfma_f32_16x16x32_bf16 v[68:71], v[236:239], v[168:171], v[68:71]
    ds_read_u16_d16 v182, v182
    v_lshlrev_b32_sdwa v183, 1, v183 dst_sel:DWORD dst_unused:UNUSED_PAD src0_sel:DWORD src1_sel:WORD_1
    v_fma_mix_f32 v221, v220, v221, 0 op_sel:[1,1,0] op_sel_hi:[1,1,0]
    v_mfma_f32_16x16x32_bf16 v[76:79], v[236:239], v[172:175], v[76:79]
    ds_read_b64_tr_b16 v[236:237], v255 offset:19528
    v_or_b32_e64 v152, v216, v217
    v_fma_mix_f32 v223, v222, v223, 0 op_sel:[1,1,0] op_sel_hi:[1,1,0]
    v_mfma_f32_16x16x32_bf16 v[192:195], v[224:227], v[32:35], v[192:195]
    ds_read_b64_tr_b16 v[238:239], v255 offset:20296
    v_lshlrev_b32_sdwa v184, 1, v184 dst_sel:DWORD dst_unused:UNUSED_PAD src0_sel:DWORD src1_sel:WORD_1
    v_pk_mul_f16 v191, v191, v190
    v_mfma_f32_16x16x32_bf16 v[196:199], v[224:227], v[36:39], v[196:199]
    ds_read_u16_d16_hi v183, v183
    v_cvt_pk_bf16_f32 v156, v156, v221
    v_lshlrev_b32_sdwa v185, 1, v185 dst_sel:DWORD dst_unused:UNUSED_PAD src0_sel:DWORD src1_sel:WORD_1
    v_mfma_f32_16x16x32_bf16 v[200:203], v[224:227], v[40:43], v[200:203]
    ds_read_u16_d16 v184, v184
    v_cvt_pk_bf16_f32 v157, v157, v223
    v_or_b32_e64 v153, v218, v219
    v_mfma_f32_16x16x32_bf16 v[204:207], v[224:227], v[44:47], v[204:207]
    ds_read_b64_tr_b16 v[224:225], v254 offset:17416
    v_exp_f16_sdwa v191, v191 dst_sel:WORD_0 dst_unused:UNUSED_PRESERVE src0_sel:WORD_0
    s_waitcnt lgkmcnt(7)
    v_mfma_f32_16x16x32_bf16 v[80:83], v[228:231], v[160:163], v[80:83]
    ds_read_b64_tr_b16 v[226:227], v254 offset:17672
    v_lshlrev_b32_sdwa v186, 1, v186 dst_sel:DWORD dst_unused:UNUSED_PAD src0_sel:DWORD src1_sel:WORD_1
    v_mfma_f32_16x16x32_bf16 v[88:91], v[228:231], v[164:167], v[88:91]
    ds_read_u16_d16_hi v185, v185
    v_lshlrev_b32_sdwa v187, 1, v187 dst_sel:DWORD dst_unused:UNUSED_PAD src0_sel:DWORD src1_sel:WORD_1
    v_exp_f16_sdwa v191, v191 dst_sel:WORD_1 dst_unused:UNUSED_PRESERVE src0_sel:WORD_1
    v_mfma_f32_16x16x32_bf16 v[96:99], v[228:231], v[168:171], v[96:99]
    ds_read_u16_d16 v186, v186
    v_lshlrev_b32_sdwa v188, 1, v188 dst_sel:DWORD dst_unused:UNUSED_PAD src0_sel:DWORD src1_sel:WORD_1
    v_mfma_f32_16x16x32_bf16 v[104:107], v[228:231], v[172:175], v[104:107]
    ds_read_b64_tr_b16 v[228:229], v255 offset:19584
    ds_read_b64_tr_b16 v[230:231], v255 offset:20352
    v_lshlrev_b32_sdwa v189, 1, v189 dst_sel:DWORD dst_unused:UNUSED_PAD src0_sel:DWORD src1_sel:WORD_1
    v_pk_fma_f16 v191, v191, s85, s85
    v_mfma_f32_16x16x32_bf16 v[208:211], v[232:235], v[0:3], 0
    ds_read_u16_d16_hi v187, v187
    v_or_b32 v146, v176, v177
    v_mfma_f32_16x16x32_bf16 v[212:215], v[232:235], v[4:7], 0
    ds_read_u16_d16 v188, v188
    v_rcp_f16_sdwa v191, v191 dst_sel:WORD_0 dst_unused:UNUSED_PRESERVE src0_sel:WORD_0
    v_lshlrev_b32_sdwa v192, 1, v192 dst_sel:DWORD dst_unused:UNUSED_PAD src0_sel:DWORD src1_sel:WORD_1
    v_mfma_f32_16x16x32_bf16 v[216:219], v[232:235], v[8:11], 0
    ds_read_u16_d16_hi v189, v189
    v_fma_mixlo_f16 v204, v204, s83, 0
    v_lshlrev_b32_sdwa v193, 1, v193 dst_sel:DWORD dst_unused:UNUSED_PAD src0_sel:DWORD src1_sel:WORD_1
    v_mfma_f32_16x16x32_bf16 v[220:223], v[232:235], v[12:15], 0
    ds_read_b64_tr_b16 v[232:233], v254 offset:18440
    v_fma_mixlo_f16 v206, v206, s83, 0
    v_or_b32 v147, v178, v179
    s_waitcnt lgkmcnt(7)
    v_mfma_f32_16x16x32_bf16 v[84:87], v[236:239], v[160:163], v[84:87]
    ds_read_b64_tr_b16 v[234:235], v254 offset:18696
    v_rcp_f16_sdwa v191, v191 dst_sel:WORD_1 dst_unused:UNUSED_PRESERVE src0_sel:WORD_1
    v_mfma_f32_16x16x32_bf16 v[92:95], v[236:239], v[164:167], v[92:95]
    ds_read_u16_d16 v192, v192
    s_waitcnt vmcnt(1)
    v_mfma_f32_16x16x16_bf16 v[56:59], v[242:243], v[248:249], v[56:59]
    v_lshlrev_b32_sdwa v194, 1, v194 dst_sel:DWORD dst_unused:UNUSED_PAD src0_sel:DWORD src1_sel:WORD_1
    v_mfma_f32_16x16x32_bf16 v[100:103], v[236:239], v[168:171], v[100:103]
    ds_read_u16_d16_hi v193, v193
    v_fma_mixhi_f16 v204, v205, s83, 0
    v_mfma_f32_16x16x32_bf16 v[108:111], v[236:239], v[172:175], v[108:111]
    ds_read_b64_tr_b16 v[236:237], v255 offset:19592
    v_mfma_f32_16x16x16_bf16 v[60:63], v[242:243], v[250:251], v[60:63]
    v_lshlrev_b32_sdwa v195, 1, v195 dst_sel:DWORD dst_unused:UNUSED_PAD src0_sel:DWORD src1_sel:WORD_1
    v_fma_mixhi_f16 v206, v207, s83, 0
    v_mfma_f32_16x16x32_bf16 v[208:211], v[224:227], v[16:19], v[208:211]
    ds_read_b64_tr_b16 v[238:239], v255 offset:20360
    buffer_load_dwordx4 v[248:251], v252, s[4:7], s24 offen offset:320 sc1
    v_or_b32 v150, v180, v181
    v_mfma_f32_16x16x32_bf16 v[212:215], v[224:227], v[20:23], v[212:215]
    ds_read_u16_d16 v194, v194
    v_fma_mix_f32 v159, v190, v191, 0 op_sel_hi:[1,1,0]
    v_pk_fma_f16 v205, v204, v204, s84 neg_lo:[0,1,0] neg_hi:[0,1,0]
    v_mfma_f32_16x16x32_bf16 v[216:219], v[224:227], v[24:27], v[216:219]
    ds_read_u16_d16_hi v195, v195
    v_lshlrev_b32_sdwa v196, 1, v196 dst_sel:DWORD dst_unused:UNUSED_PAD src0_sel:DWORD src1_sel:WORD_1
    v_pk_fma_f16 v207, v206, v206, s84 neg_lo:[0,1,0] neg_hi:[0,1,0]
    v_mfma_f32_16x16x32_bf16 v[220:223], v[224:227], v[28:31], v[220:223]
    s_cmp_lt_u32 s19, 12
    s_cbranch_scc1 L_rd12_slow
L_rd12_go:
    ds_read_b64_tr_b16 v[224:225], v254 offset:22528
    v_lshlrev_b32_sdwa v197, 1, v197 dst_sel:DWORD dst_unused:UNUSED_PAD src0_sel:DWORD src1_sel:WORD_1
    v_fma_mix_f32 v191, v190, v191, 0 op_sel:[1,1,0] op_sel_hi:[1,1,0]
    s_waitcnt lgkmcnt(7)
    v_mfma_f32_16x16x32_bf16 v[112:115], v[228:231], v[160:163], v[112:115]
    ds_read_b64_tr_b16 v[226:227], v254 offset:22784
    v_or_b32 v151, v182, v183
    v_pk_mul_f16 v205, v205, v204
    v_mfma_f32_16x16x32_bf16 v[120:123], v[228:231], v[164:167], v[120:123]
    ds_read_u16_d16 v196, v196
    v_pk_mul_f16 v207, v207, v206
    v_lshlrev_b32_sdwa v198, 1, v198 dst_sel:DWORD dst_unused:UNUSED_PAD src0_sel:DWORD src1_sel:WORD_1
    v_mfma_f32_16x16x32_bf16 v[128:131], v[228:231], v[168:171], v[128:131]
    ds_read_u16_d16_hi v197, v197
    v_cvt_pk_bf16_f32 v159, v159, v191
    v_lshlrev_b32_sdwa v199, 1, v199 dst_sel:DWORD dst_unused:UNUSED_PAD src0_sel:DWORD src1_sel:WORD_1
    v_mfma_f32_16x16x32_bf16 v[136:139], v[228:231], v[172:175], v[136:139]
    ds_read_b64_tr_b16 v[228:229], v255 offset:25600
    v_exp_f16_sdwa v205, v205 dst_sel:WORD_0 dst_unused:UNUSED_PRESERVE src0_sel:WORD_0
    v_mfma_f32_16x16x32_bf16 v[208:211], v[232:235], v[32:35], v[208:211]
    ds_read_b64_tr_b16 v[230:231], v255 offset:26368
    v_or_b32_e64 v154, v184, v185
    v_mfma_f32_16x16x32_bf16 v[212:215], v[232:235], v[36:39], v[212:215]
    ds_read_u16_d16 v198, v198
    v_exp_f16_sdwa v207, v207 dst_sel:WORD_0 dst_unused:UNUSED_PRESERVE src0_sel:WORD_0
    v_lshlrev_b32_sdwa v200, 1, v200 dst_sel:DWORD dst_unused:UNUSED_PAD src0_sel:DWORD src1_sel:WORD_1
    v_mfma_f32_16x16x32_bf16 v[216:219], v[232:235], v[40:43], v[216:219]
    ds_read_u16_d16_hi v199, v199
    v_lshlrev_b32_sdwa v201, 1, v201 dst_sel:DWORD dst_unused:UNUSED_PAD src0_sel:DWORD src1_sel:WORD_1
    v_mfma_f32_16x16x32_bf16 v[220:223], v[232:235], v[44:47], v[220:223]
    ds_read_b64_tr_b16 v[232:233], v254 offset:23552
    v_exp_f16_sdwa v205, v205 dst_sel:WORD_1 dst_unused:UNUSED_PRESERVE src0_sel:WORD_1
    s_waitcnt lgkmcnt(7)
    v_mfma_f32_16x16x32_bf16 v[116:119], v[236:239], v[160:163], v[116:119]
    ds_read_b64_tr_b16 v[234:235], v254 offset:23808
    v_or_b32 v155, v186, v187
    v_exp_f16_sdwa v207, v207 dst_sel:WORD_1 dst_unused:UNUSED_PRESERVE src0_sel:WORD_1
    v_mfma_f32_16x16x32_bf16 v[124:127], v[236:239], v[164:167], v[124:127]
    ds_read_u16_d16 v200, v200
    v_lshlrev_b32_sdwa v202, 1, v202 dst_sel:DWORD dst_unused:UNUSED_PAD src0_sel:DWORD src1_sel:WORD_1
    v_mfma_f32_16x16x32_bf16 v[132:135], v[236:239], v[168:171], v[132:135]
    ds_read_u16_d16_hi v201, v201
    v_lshlrev_b32_sdwa v203, 1, v203 dst_sel:DWORD dst_unused:UNUSED_PAD src0_sel:DWORD src1_sel:WORD_1
    v_pk_fma_f16 v205, v205, s85, s85
    v_mfma_f32_16x16x32_bf16 v[140:143], v[236:239], v[172:175], v[140:143]
    ds_read_b64_tr_b16 v[236:237], v255 offset:25608
    v_or_b32_e64 v158, v188, v189
    v_pk_fma_f16 v207, v207, s85, s85
    v_mfma_f32_16x16x32_bf16 v[176:179], v[224:227], v[0:3], 0
    ds_read_b64_tr_b16 v[238:239], v255 offset:26376
    v_or_b32_e64 v160, v192, v193
    v_mfma_f32_16x16x32_bf16 v[180:183], v[224:227], v[4:7], 0
    ds_read_u16_d16 v202, v202
    v_rcp_f16_sdwa v205, v205 dst_sel:WORD_0 dst_unused:UNUSED_PRESERVE src0_sel:WORD_0
    v_lshlrev_b32_sdwa v208, 1, v208 dst_sel:DWORD dst_unused:UNUSED_PAD src0_sel:DWORD src1_sel:WORD_1
    v_mfma_f32_16x16x32_bf16 v[184:187], v[224:227], v[8:11], 0
    ds_read_u16_d16_hi v203, v203
    v_rcp_f16_sdwa v207, v207 dst_sel:WORD_0 dst_unused:UNUSED_PRESERVE src0_sel:WORD_0
    v_mfma_f32_16x16x32_bf16 v[188:191], v[224:227], v[12:15], 0
    ds_read_b64_tr_b16 v[224:225], v254 offset:24576
    v_lshlrev_b32_sdwa v209, 1, v209 dst_sel:DWORD dst_unused:UNUSED_PAD src0_sel:DWORD src1_sel:WORD_1
    s_waitcnt lgkmcnt(7)
    v_mfma_f32_16x16x32_bf16 v[48:51], v[228:231], v[144:147], v[48:51]
    ds_read_b64_tr_b16 v[226:227], v254 offset:24832
    v_or_b32 v161, v194, v195
    v_fma_mixlo_f16 v222, v222, s83, 0
    v_mfma_f32_16x16x32_bf16 v[56:59], v[228:231], v[148:151], v[56:59]
    ds_read_u16_d16 v208, v208
    v_lshlrev_b32_sdwa v210, 1, v210 dst_sel:DWORD dst_unused:UNUSED_PAD src0_sel:DWORD src1_sel:WORD_1
    v_mfma_f32_16x16x32_bf16 v[64:67], v[228:231], v[152:155], v[64:67]
    ds_read_u16_d16_hi v209, v209
    v_rcp_f16_sdwa v205, v205 dst_sel:WORD_1 dst_unused:UNUSED_PRESERVE src0_sel:WORD_1
    v_lshlrev_b32_sdwa v211, 1, v211 dst_sel:DWORD dst_unused:UNUSED_PAD src0_sel:DWORD src1_sel:WORD_1
    v_mfma_f32_16x16x32_bf16 v[72:75], v[228:231], v[156:159], v[72:75]
    ds_read_b64_tr_b16 v[228:229], v255 offset:25664
    v_or_b32_e64 v164, v196, v197
    v_mfma_f32_16x16x32_bf16 v[176:179], v[232:235], v[16:19], v[176:179]
    ds_read_b64_tr_b16 v[230:231], v255 offset:26432
    v_rcp_f16_sdwa v207, v207 dst_sel:WORD_1 dst_unused:UNUSED_PRESERVE src0_sel:WORD_1
    v_mfma_f32_16x16x32_bf16 v[180:183], v[232:235], v[20:23], v[180:183]
    ds_read_u16_d16 v210, v210
    v_lshlrev_b32_sdwa v212, 1, v212 dst_sel:DWORD dst_unused:UNUSED_PAD src0_sel:DWORD src1_sel:WORD_1
    v_fma_mixhi_f16 v222, v223, s83, 0
    v_mfma_f32_16x16x32_bf16 v[184:187], v[232:235], v[24:27], v[184:187]
    ds_read_u16_d16_hi v211, v211
    v_lshlrev_b32_sdwa v213, 1, v213 dst_sel:DWORD dst_unused:UNUSED_PAD src0_sel:DWORD src1_sel:WORD_1
    v_fma_mix_f32 v172, v204, v205, 0 op_sel_hi:[1,1,0]
    v_mfma_f32_16x16x32_bf16 v[188:191], v[232:235], v[28:31], v[188:191]
    ds_read_b64_tr_b16 v[232:233], v254 offset:22536
    ds_read_b64_tr_b16 v[234:235], v254 offset:22792
    v_or_b32_e64 v165, v198, v199
    v_fma_mix_f32 v173, v206, v207, 0 op_sel_hi:[1,1,0]
    s_waitcnt lgkmcnt(7)
    v_mfma_f32_16x16x32_bf16 v[52:55], v[236:239], v[144:147], v[52:55]
    ds_read_u16_d16 v212, v212
    v_lshlrev_b32_sdwa v214, 1, v214 dst_sel:DWORD dst_unused:UNUSED_PAD src0_sel:DWORD src1_sel:WORD_1
    v_mfma_f32_16x16x32_bf16 v[60:63], v[236:239], v[148:151], v[60:63]
    ds_read_u16_d16_hi v213, v213
    v_pk_fma_f16 v223, v222, v222, s84 neg_lo:[0,1,0] neg_hi:[0,1,0]
    v_lshlrev_b32_sdwa v215, 1, v215 dst_sel:DWORD dst_unused:UNUSED_PAD src0_sel:DWORD src1_sel:WORD_1
    v_mfma_f32_16x16x32_bf16 v[68:71], v[236:239], v[152:155], v[68:71]
    ds_read_u16_d16 v214, v214
    v_fma_mix_f32 v205, v204, v205, 0 op_sel:[1,1,0] op_sel_hi:[1,1,0]
    v_or_b32 v168, v200, v201
    v_mfma_f32_16x16x32_bf16 v[76:79], v[236:239], v[156:159], v[76:79]
    ds_read_b64_tr_b16 v[236:237], v255 offset:25672
    v_fma_mix_f32 v207, v206, v207, 0 op_sel:[1,1,0] op_sel_hi:[1,1,0]
    v_lshlrev_b32_sdwa v216, 1, v216 dst_sel:DWORD dst_unused:UNUSED_PAD src0_sel:DWORD src1_sel:WORD_1
    v_mfma_f32_16x16x32_bf16 v[176:179], v[224:227], v[32:35], v[176:179]
    ds_read_b64_tr_b16 v[238:239], v255 offset:26440
    v_pk_mul_f16 v223, v223, v222
    v_mfma_f32_16x16x32_bf16 v[180:183], v[224:227], v[36:39], v[180:183]
    ds_read_u16_d16_hi v215, v215
    v_cvt_pk_bf16_f32 v172, v172, v205
    v_lshlrev_b32_sdwa v217, 1, v217 dst_sel:DWORD dst_unused:UNUSED_PAD src0_sel:DWORD src1_sel:WORD_1
    v_mfma_f32_16x16x32_bf16 v[184:187], v[224:227], v[40:43], v[184:187]
    ds_read_u16_d16 v216, v216
    v_cvt_pk_bf16_f32 v173, v173, v207
    v_or_b32_e64 v169, v202, v203
    v_mfma_f32_16x16x32_bf16 v[188:191], v[224:227], v[44:47], v[188:191]
    ds_read_b64_tr_b16 v[224:225], v254 offset:23560
    v_exp_f16_sdwa v223, v223 dst_sel:WORD_0 dst_unused:UNUSED_PRESERVE src0_sel:WORD_0
    s_waitcnt lgkmcnt(7)
    v_mfma_f32_16x16x32_bf16 v[80:83], v[228:231], v[144:147], v[80:83]
    ds_read_b64_tr_b16 v[226:227], v254 offset:23816
    v_lshlrev_b32_sdwa v218, 1, v218 dst_sel:DWORD dst_unused:UNUSED_PAD src0_sel:DWORD src1_sel:WORD_1
    v_lshlrev_b32_sdwa v219, 1, v219 dst_sel:DWORD dst_unused:UNUSED_PAD src0_sel:DWORD src1_sel:WORD_1
    v_mfma_f32_16x16x32_bf16 v[88:91], v[228:231], v[148:151], v[88:91]
    ds_read_u16_d16_hi v217, v217
    v_exp_f16_sdwa v223, v223 dst_sel:WORD_1 dst_unused:UNUSED_PRESERVE src0_sel:WORD_1
    v_mfma_f32_16x16x32_bf16 v[96:99], v[228:231], v[152:155], v[96:99]
    ds_read_u16_d16 v218, v218
    v_lshlrev_b32_sdwa v220, 1, v220 dst_sel:DWORD dst_unused:UNUSED_PAD src0_sel:DWORD src1_sel:WORD_1
    v_mfma_f32_16x16x32_bf16 v[104:107], v[228:231], v[156:159], v[104:107]
    ds_read_b64_tr_b16 v[228:229], v255 offset:25728
    ds_read_b64_tr_b16 v[230:231], v255 offset:26496
    v_lshlrev_b32_sdwa v221, 1, v221 dst_sel:DWORD dst_unused:UNUSED_PAD src0_sel:DWORD src1_sel:WORD_1
    v_pk_fma_f16 v223, v223, s85, s85
    s_cmp_lg_u32 s17, 0
    s_cbranch_scc1 L_pu2
L_pb2:
    v_mfma_f32_16x16x32_bf16 v[192:195], v[232:235], v[0:3], 0
    ds_read_u16_d16_hi v219, v219
    v_or_b32 v162, v208, v209
    v_mfma_f32_16x16x32_bf16 v[196:199], v[232:235], v[4:7], 0
    ds_read_u16_d16 v220, v220
    v_rcp_f16_sdwa v223, v223 dst_sel:WORD_0 dst_unused:UNUSED_PRESERVE src0_sel:WORD_0
    v_lshlrev_b32_sdwa v176, 1, v176 dst_sel:DWORD dst_unused:UNUSED_PAD src0_sel:DWORD src1_sel:WORD_1
    v_mfma_f32_16x16x32_bf16 v[200:203], v[232:235], v[8:11], 0
    ds_read_u16_d16_hi v221, v221
    v_fma_mixlo_f16 v188, v188, s83, 0
    v_lshlrev_b32_sdwa v177, 1, v177 dst_sel:DWORD dst_unused:UNUSED_PAD src0_sel:DWORD src1_sel:WORD_1
    v_mfma_f32_16x16x32_bf16 v[204:207], v[232:235], v[12:15], 0
    ds_read_b64_tr_b16 v[232:233], v254 offset:24584
    v_fma_mixlo_f16 v190, v190, s83, 0
    v_or_b32 v163, v210, v211
    s_waitcnt lgkmcnt(7)
    v_mfma_f32_16x16x32_bf16 v[84:87], v[236:239], v[144:147], v[84:87]
    ds_read_b64_tr_b16 v[234:235], v254 offset:24840
    v_rcp_f16_sdwa v223, v223 dst_sel:WORD_1 dst_unused:UNUSED_PRESERVE src0_sel:WORD_1
    v_mfma_f32_16x16x32_bf16 v[92:95], v[236:239], v[148:151], v[92:95]
    ds_read_u16_d16 v176, v176
    s_waitcnt vmcnt(1)
    v_mfma_f32_16x16x16_bf16 v[88:91], v[242:243], v[244:245], v[88:91]
    v_lshlrev_b32_sdwa v178, 1, v178 dst_sel:DWORD dst_unused:UNUSED_PAD src0_sel:DWORD src1_sel:WORD_1
    v_mfma_f32_16x16x32_bf16 v[100:103], v[236:239], v[152:155], v[100:103]
    ds_read_u16_d16_hi v177, v177
    v_fma_mixhi_f16 v188, v189, s83, 0
    v_mfma_f32_16x16x32_bf16 v[108:111], v[236:239], v[156:159], v[108:111]
    ds_read_b64_tr_b16 v[236:237], v255 offset:25736
    v_lshlrev_b32_sdwa v179, 1, v179 dst_sel:DWORD dst_unused:UNUSED_PAD src0_sel:DWORD src1_sel:WORD_1
    v_fma_mixhi_f16 v190, v191, s83, 0
    v_mfma_f32_16x16x32_bf16 v[192:195], v[224:227], v[16:19], v[192:195]
    ds_read_b64_tr_b16 v[238:239], v255 offset:26504
    v_mfma_f32_16x16x16_bf16 v[92:95], v[242:243], v[246:247], v[92:95]
    v_or_b32 v166, v212, v213
    v_fma_mix_f32 v175, v222, v223, 0 op_sel_hi:[1,1,0]
    v_mfma_f32_16x16x32_bf16 v[196:199], v[224:227], v[20:23], v[196:199]
    ds_read_u16_d16 v178, v178
    buffer_load_dwordx4 v[244:247], v252, s[4:7], s25 offen offset:0 sc1
    v_pk_fma_f16 v189, v188, v188, s84 neg_lo:[0,1,0] neg_hi:[0,1,0]
    v_mfma_f32_16x16x32_bf16 v[200:203], v[224:227], v[24:27], v[200:203]
    ds_read_u16_d16_hi v179, v179
    v_lshlrev_b32_sdwa v180, 1, v180 dst_sel:DWORD dst_unused:UNUSED_PAD src0_sel:DWORD src1_sel:WORD_1
    v_pk_fma_f16 v191, v190, v190, s84 neg_lo:[0,1,0] neg_hi:[0,1,0]
    v_mfma_f32_16x16x32_bf16 v[204:207], v[224:227], v[28:31], v[204:207]
    s_cmp_lt_u32 s19, 14
    s_cbranch_scc1 L_rd14_slow
L_rd14_go:
    ds_read_b64_tr_b16 v[224:225], v254 offset:28672
    v_lshlrev_b32_sdwa v181, 1, v181 dst_sel:DWORD dst_unused:UNUSED_PAD src0_sel:DWORD src1_sel:WORD_1
    v_fma_mix_f32 v223, v222, v223, 0 op_sel:[1,1,0] op_sel_hi:[1,1,0]
    s_waitcnt lgkmcnt(7)
    v_mfma_f32_16x16x32_bf16 v[112:115], v[228:231], v[144:147], v[112:115]
    ds_read_b64_tr_b16 v[226:227], v254 offset:28928
    v_or_b32 v167, v214, v215
    v_pk_mul_f16 v189, v189, v188
    v_mfma_f32_16x16x32_bf16 v[120:123], v[228:231], v[148:151], v[120:123]
    ds_read_u16_d16 v180, v180
    v_pk_mul_f16 v191, v191, v190
    v_lshlrev_b32_sdwa v182, 1, v182 dst_sel:DWORD dst_unused:UNUSED_PAD src0_sel:DWORD src1_sel:WORD_1
    v_mfma_f32_16x16x32_bf16 v[128:131], v[228:231], v[152:155], v[128:131]
    ds_read_u16_d16_hi v181, v181
    v_cvt_pk_bf16_f32 v175, v175, v223
    v_lshlrev_b32_sdwa v183, 1, v183 dst_sel:DWORD dst_unused:UNUSED_PAD src0_sel:DWORD src1_sel:WORD_1
    v_mfma_f32_16x16x32_bf16 v[136:139], v[228:231], v[156:159], v[136:139]
    ds_read_b64_tr_b16 v[228:229], v255 offset:31744
    v_exp_f16_sdwa v189, v189 dst_sel:WORD_0 dst_unused:UNUSED_PRESERVE src0_sel:WORD_0
    v_mfma_f32_16x16x32_bf16 v[192:195], v[232:235], v[32:35], v[192:195]
    ds_read_b64_tr_b16 v[230:231], v255 offset:32512
    v_or_b32_e64 v170, v216, v217
    v_mfma_f32_16x16x32_bf16 v[196:199], v[232:235], v[36:39], v[196:199]
    ds_read_u16_d16 v182, v182
    v_exp_f16_sdwa v191, v191 dst_sel:WORD_0 dst_unused:UNUSED_PRESERVE src0_sel:WORD_0
    v_lshlrev_b32_sdwa v184, 1, v184 dst_sel:DWORD dst_unused:UNUSED_PAD src0_sel:DWORD src1_sel:WORD_1
    v_mfma_f32_16x16x32_bf16 v[200:203], v[232:235], v[40:43], v[200:203]
    ds_read_u16_d16_hi v183, v183
    v_lshlrev_b32_sdwa v185, 1, v185 dst_sel:DWORD dst_unused:UNUSED_PAD src0_sel:DWORD src1_sel:WORD_1
    v_mfma_f32_16x16x32_bf16 v[204:207], v[232:235], v[44:47], v[204:207]
    ds_read_b64_tr_b16 v[232:233], v254 offset:29696
    v_exp_f16_sdwa v189, v189 dst_sel:WORD_1 dst_unused:UNUSED_PRESERVE src0_sel:WORD_1
    s_waitcnt lgkmcnt(7)
    v_mfma_f32_16x16x32_bf16 v[116:119], v[236:239], v[144:147], v[116:119]
    ds_read_b64_tr_b16 v[234:235], v254 offset:29952
    v_or_b32 v171, v218, v219
    v_exp_f16_sdwa v191, v191 dst_sel:WORD_1 dst_unused:UNUSED_PRESERVE src0_sel:WORD_1
    v_mfma_f32_16x16x32_bf16 v[124:127], v[236:239], v[148:151], v[124:127]
    ds_read_u16_d16 v184, v184
    v_lshlrev_b32_sdwa v186, 1, v186 dst_sel:DWORD dst_unused:UNUSED_PAD src0_sel:DWORD src1_sel:WORD_1
    v_mfma_f32_16x16x32_bf16 v[132:135], v[236:239], v[152:155], v[132:135]
    ds_read_u16_d16_hi v185, v185
    v_lshlrev_b32_sdwa v187, 1, v187 dst_sel:DWORD dst_unused:UNUSED_PAD src0_sel:DWORD src1_sel:WORD_1
    v_pk_fma_f16 v189, v189, s85, s85
    v_mfma_f32_16x16x32_bf16 v[140:143], v[236:239], v[156:159], v[140:143]
    ds_read_b64_tr_b16 v[236:237], v255 offset:31752
    v_or_b32_e64 v174, v220, v221
    v_pk_fma_f16 v191, v191, s85, s85
    v_mfma_f32_16x16x32_bf16 v[208:211], v[224:227], v[0:3], 0
    ds_read_b64_tr_b16 v[238:239], v255 offset:32520
    v_or_b32_e64 v144, v176, v177
    v_mfma_f32_16x16x32_bf16 v[212:215], v[224:227], v[4:7], 0
    ds_read_u16_d16 v186, v186
    v_rcp_f16_sdwa v189, v189 dst_sel:WORD_0 dst_unused:UNUSED_PRESERVE src0_sel:WORD_0
    v_lshlrev_b32_sdwa v192, 1, v192 dst_sel:DWORD dst_unused:UNUSED_PAD src0_sel:DWORD src1_sel:WORD_1
    v_mfma_f32_16x16x32_bf16 v[216:219], v[224:227], v[8:11], 0
    ds_read_u16_d16_hi v187, v187
    v_rcp_f16_sdwa v191, v191 dst_sel:WORD_0 dst_unused:UNUSED_PRESERVE src0_sel:WORD_0
    v_mfma_f32_16x16x32_bf16 v[220:223], v[224:227], v[12:15], 0
    ds_read_b64_tr_b16 v[224:225], v254 offset:30720
    v_lshlrev_b32_sdwa v193, 1, v193 dst_sel:DWORD dst_unused:UNUSED_PAD src0_sel:DWORD src1_sel:WORD_1
    v_or_b32 v145, v178, v179
    s_waitcnt lgkmcnt(7)
    v_mfma_f32_16x16x32_bf16 v[48:51], v[228:231], v[160:163], v[48:51]
    ds_read_b64_tr_b16 v[226:227], v254 offset:30976
    v_fma_mixlo_f16 v206, v206, s83, 0
    v_mfma_f32_16x16x32_bf16 v[56:59], v[228:231], v[164:167], v[56:59]
    ds_read_u16_d16 v192, v192
    s_waitcnt vmcnt(1)
    v_mfma_f32_16x16x16_bf16 v[120:123], v[242:243], v[248:249], v[120:123]
    v_lshlrev_b32_sdwa v194, 1, v194 dst_sel:DWORD dst_unused:UNUSED_PAD src0_sel:DWORD src1_sel:WORD_1
    v_mfma_f32_16x16x32_bf16 v[64:67], v[228:231], v[168:171], v[64:67]
    ds_read_u16_d16_hi v193, v193
    v_rcp_f16_sdwa v189, v189 dst_sel:WORD_1 dst_unused:UNUSED_PRESERVE src0_sel:WORD_1
    v_mfma_f32_16x16x32_bf16 v[72:75], v[228:231], v[172:175], v[72:75]
    ds_read_b64_tr_b16 v[228:229], v255 offset:31808
    v_mfma_f32_16x16x16_bf16 v[124:127], v[242:243], v[250:251], v[124:127]
    v_lshlrev_b32_sdwa v195, 1, v195 dst_sel:DWORD dst_unused:UNUSED_PAD src0_sel:DWORD src1_sel:WORD_1
    v_or_b32 v148, v180, v181
    v_mfma_f32_16x16x32_bf16 v[208:211], v[232:235], v[16:19], v[208:211]
    ds_read_b64_tr_b16 v[230:231], v255 offset:32576
    buffer_load_dwordx4 v[248:251], v252, s[4:7], s25 offen offset:64 sc1
    v_mfma_f32_16x16x32_bf16 v[212:215], v[232:235], v[20:23], v[212:215]
    ds_read_u16_d16 v194, v194
    v_rcp_f16_sdwa v191, v191 dst_sel:WORD_1 dst_unused:UNUSED_PRESERVE src0_sel:WORD_1
    v_lshlrev_b32_sdwa v196, 1, v196 dst_sel:DWORD dst_unused:UNUSED_PAD src0_sel:DWORD src1_sel:WORD_1
    v_mfma_f32_16x16x32_bf16 v[216:219], v[232:235], v[24:27], v[216:219]
    ds_read_u16_d16_hi v195, v195
    v_fma_mixhi_f16 v206, v207, s83, 0
    v_lshlrev_b32_sdwa v197, 1, v197 dst_sel:DWORD dst_unused:UNUSED_PAD src0_sel:DWORD src1_sel:WORD_1
    v_mfma_f32_16x16x32_bf16 v[220:223], v[232:235], v[28:31], v[220:223]
    ds_read_b64_tr_b16 v[232:233], v254 offset:28680
    ds_read_b64_tr_b16 v[234:235], v254 offset:28936
    v_fma_mix_f32 v156, v188, v189, 0 op_sel_hi:[1,1,0]
    v_or_b32 v149, v182, v183
    s_waitcnt lgkmcnt(7)
    v_mfma_f32_16x16x32_bf16 v[52:55], v[236:239], v[160:163], v[52:55]
    ds_read_u16_d16 v196, v196
    v_fma_mix_f32 v157, v190, v191, 0 op_sel_hi:[1,1,0]
    v_mfma_f32_16x16x32_bf16 v[60:63], v[236:239], v[164:167], v[60:63]
    ds_read_u16_d16_hi v197, v197
    v_lshlrev_b32_sdwa v198, 1, v198 dst_sel:DWORD dst_unused:UNUSED_PAD src0_sel:DWORD src1_sel:WORD_1
    v_pk_fma_f16 v207, v206, v206, s84 neg_lo:[0,1,0] neg_hi:[0,1,0]
    v_mfma_f32_16x16x32_bf16 v[68:71], v[236:239], v[168:171], v[68:71]
    ds_read_u16_d16 v198, v198
    v_lshlrev_b32_sdwa v199, 1, v199 dst_sel:DWORD dst_unused:UNUSED_PAD src0_sel:DWORD src1_sel:WORD_1
    v_fma_mix_f32 v189, v188, v189, 0 op_sel:[1,1,0] op_sel_hi:[1,1,0]
    v_mfma_f32_16x16x32_bf16 v[76:79], v[236:239], v[172:175], v[76:79]
    ds_read_b64_tr_b16 v[236:237], v255 offset:31816
    v_or_b32_e64 v152, v184, v185
    v_fma_mix_f32 v191, v190, v191, 0 op_sel:[1,1,0] op_sel_hi:[1,1,0]
    v_mfma_f32_16x16x32_bf16 v[208:211], v[224:227], v[32:35], v[208:211]
    ds_read_b64_tr_b16 v[238:239], v255 offset:32584
    v_lshlrev_b32_sdwa v200, 1, v200 dst_sel:DWORD dst_unused:UNUSED_PAD src0_sel:DWORD src1_sel:WORD_1
    v_pk_mul_f16 v207, v207, v206
    v_mfma_f32_16x16x32_bf16 v[212:215], v[224:227], v[36:39], v[212:215]
    ds_read_u16_d16_hi v199, v199
    v_cvt_pk_bf16_f32 v156, v156, v189
    v_lshlrev_b32_sdwa v201, 1, v201 dst_sel:DWORD dst_unused:UNUSED_PAD src0_sel:DWORD src1_sel:WORD_1
    v_mfma_f32_16x16x32_bf16 v[216:219], v[224:227], v[40:43], v[216:219]
    ds_read_u16_d16 v200, v200
    v_cvt_pk_bf16_f32 v157, v157, v191
    v_or_b32_e64 v153, v186, v187
    v_mfma_f32_16x16x32_bf16 v[220:223], v[224:227], v[44:47], v[220:223]
    ds_read_b64_tr_b16 v[224:225], v254 offset:29704
    v_exp_f16_sdwa v207, v207 dst_sel:WORD_0 dst_unused:UNUSED_PRESERVE src0_sel:WORD_0
    s_waitcnt lgkmcnt(7)
    v_mfma_f32_16x16x32_bf16 v[80:83], v[228:231], v[160:163], v[80:83]
    ds_read_b64_tr_b16 v[226:227], v254 offset:29960
    v_lshlrev_b32_sdwa v202, 1, v202 dst_sel:DWORD dst_unused:UNUSED_PAD src0_sel:DWORD src1_sel:WORD_1
    v_mfma_f32_16x16x32_bf16 v[88:91], v[228:231], v[164:167], v[88:91]
    ds_read_u16_d16_hi v201, v201
    v_lshlrev_b32_sdwa v203, 1, v203 dst_sel:DWORD dst_unused:UNUSED_PAD src0_sel:DWORD src1_sel:WORD_1
    v_exp_f16_sdwa v207, v207 dst_sel:WORD_1 dst_unused:UNUSED_PRESERVE src0_sel:WORD_1
    v_mfma_f32_16x16x32_bf16 v[96:99], v[228:231], v[168:171], v[96:99]
    ds_read_u16_d16 v202, v202
    v_lshlrev_b32_sdwa v204, 1, v204 dst_sel:DWORD dst_unused:UNUSED_PAD src0_sel:DWORD src1_sel:WORD_1
    v_mfma_f32_16x16x32_bf16 v[104:107], v[228:231], v[172:175], v[104:107]
    ds_read_b64_tr_b16 v[228:229], v255 offset:31872
    ds_read_b64_tr_b16 v[230:231], v255 offset:32640
    v_lshlrev_b32_sdwa v205, 1, v205 dst_sel:DWORD dst_unused:UNUSED_PAD src0_sel:DWORD src1_sel:WORD_1
    v_pk_fma_f16 v207, v207, s85, s85
    v_mfma_f32_16x16x32_bf16 v[176:179], v[232:235], v[0:3], 0
    ds_read_u16_d16_hi v203, v203
    v_or_b32 v146, v192, v193
    v_mfma_f32_16x16x32_bf16 v[180:183], v[232:235], v[4:7], 0
    ds_read_u16_d16 v204, v204
    v_rcp_f16_sdwa v207, v207 dst_sel:WORD_0 dst_unused:UNUSED_PRESERVE src0_sel:WORD_0
    v_lshlrev_b32_sdwa v208, 1, v208 dst_sel:DWORD dst_unused:UNUSED_PAD src0_sel:DWORD src1_sel:WORD_1
    v_mfma_f32_16x16x32_bf16 v[184:187], v[232:235], v[8:11], 0
    ds_read_u16_d16_hi v205, v205
    v_fma_mixlo_f16 v220, v220, s83, 0
    v_lshlrev_b32_sdwa v209, 1, v209 dst_sel:DWORD dst_unused:UNUSED_PAD src0_sel:DWORD src1_sel:WORD_1
    v_mfma_f32_16x16x32_bf16 v[188:191], v[232:235], v[12:15], 0
    ds_read_b64_tr_b16 v[232:233], v254 offset:30728
    v_fma_mixlo_f16 v222, v222, s83, 0
    s_waitcnt lgkmcnt(7)
    v_mfma_f32_16x16x32_bf16 v[84:87], v[236:239], v[160:163], v[84:87]
    ds_read_b64_tr_b16 v[234:235], v254 offset:30984
    v_or_b32 v147, v194, v195
    v_rcp_f16_sdwa v207, v207 dst_sel:WORD_1 dst_unused:UNUSED_PRESERVE src0_sel:WORD_1
    v_mfma_f32_16x16x32_bf16 v[92:95], v[236:239], v[164:167], v[92:95]
    ds_read_u16_d16 v208, v208
    v_lshlrev_b32_sdwa v210, 1, v210 dst_sel:DWORD dst_unused:UNUSED_PAD src0_sel:DWORD src1_sel:WORD_1
    v_mfma_f32_16x16x32_bf16 v[100:103], v[236:239], v[168:171], v[100:103]
    ds_read_u16_d16_hi v209, v209
    v_fma_mixhi_f16 v220, v221, s83, 0
    v_lshlrev_b32_sdwa v211, 1, v211 dst_sel:DWORD dst_unused:UNUSED_PAD src0_sel:DWORD src1_sel:WORD_1
    v_mfma_f32_16x16x32_bf16 v[108:111], v[236:239], v[172:175], v[108:111]
    ds_read_b64_tr_b16 v[236:237], v255 offset:31880
    v_fma_mixhi_f16 v222, v223, s83, 0
    v_or_b32_e64 v150, v196, v197
    v_mfma_f32_16x16x32_bf16 v[176:179], v[224:227], v[16:19], v[176:179]
    ds_read_b64_tr_b16 v[238:239], v255 offset:32648
    v_fma_mix_f32 v159, v206, v207, 0 op_sel_hi:[1,1,0]
    v_pk_fma_f16 v221, v220, v220, s84 neg_lo:[0,1,0] neg_hi:[0,1,0]
    v_mfma_f32_16x16x32_bf16 v[180:183], v[224:227], v[20:23], v[180:183]
    ds_read_u16_d16 v210, v210
    v_lshlrev_b32_sdwa v212, 1, v212 dst_sel:DWORD dst_unused:UNUSED_PAD src0_sel:DWORD src1_sel:WORD_1
    v_mfma_f32_16x16x32_bf16 v[184:187], v[224:227], v[24:27], v[184:187]
    ds_read_u16_d16_hi v211, v211
    v_pk_fma_f16 v223, v222, v222, s84 neg_lo:[0,1,0] neg_hi:[0,1,0]
    v_lshlrev_b32_sdwa v213, 1, v213 dst_sel:DWORD dst_unused:UNUSED_PAD src0_sel:DWORD src1_sel:WORD_1
    v_mfma_f32_16x16x32_bf16 v[188:191], v[224:227], v[28:31], v[188:191]
    s_cmp_lt_u32 s19, 16
    s_cbranch_scc1 L_rd16_slow
L_rd16_go:
    ds_read_b64_tr_b16 v[224:225], v254 offset:34816
    v_fma_mix_f32 v207, v206, v207, 0 op_sel:[1,1,0] op_sel_hi:[1,1,0]
    v_or_b32 v151, v198, v199
    s_waitcnt lgkmcnt(7)
    v_mfma_f32_16x16x32_bf16 v[112:115], v[228:231], v[160:163], v[112:115]
    ds_read_b64_tr_b16 v[226:227], v254 offset:35072
    v_pk_mul_f16 v221, v221, v220
    v_pk_mul_f16 v223, v223, v222
    v_mfma_f32_16x16x32_bf16 v[120:123], v[228:231], v[164:167], v[120:123]
    ds_read_u16_d16 v212, v212
    v_lshlrev_b32_sdwa v214, 1, v214 dst_sel:DWORD dst_unused:UNUSED_PAD src0_sel:DWORD src1_sel:WORD_1
    v_cvt_pk_bf16_f32 v159, v159, v207
    v_mfma_f32_16x16x32_bf16 v[128:131], v[228:231], v[168:171], v[128:131]
    ds_read_u16_d16_hi v213, v213
    v_lshlrev_b32_sdwa v215, 1, v215 dst_sel:DWORD dst_unused:UNUSED_PAD src0_sel:DWORD src1_sel:WORD_1
    v_mfma_f32_16x16x32_bf16 v[136:139], v[228:231], v[172:175], v[136:139]
    ds_read_b64_tr_b16 v[228:229], v255 offset:37888
    v_exp_f16_sdwa v221, v221 dst_sel:WORD_0 dst_unused:UNUSED_PRESERVE src0_sel:WORD_0
    v_mfma_f32_16x16x32_bf16 v[176:179], v[232:235], v[32:35], v[176:179]
    ds_read_b64_tr_b16 v[230:231], v255 offset:38656
    v_or_b32_e64 v154, v200, v201
    v_exp_f16_sdwa v223, v223 dst_sel:WORD_0 dst_unused:UNUSED_PRESERVE src0_sel:WORD_0
    v_mfma_f32_16x16x32_bf16 v[180:183], v[232:235], v[36:39], v[180:183]
    ds_read_u16_d16 v214, v214
    v_lshlrev_b32_sdwa v216, 1, v216 dst_sel:DWORD dst_unused:UNUSED_PAD src0_sel:DWORD src1_sel:WORD_1
    v_mfma_f32_16x16x32_bf16 v[184:187], v[232:235], v[40:43], v[184:187]
    ds_read_u16_d16_hi v215, v215
    v_lshlrev_b32_sdwa v217, 1, v217 dst_sel:DWORD dst_unused:UNUSED_PAD src0_sel:DWORD src1_sel:WORD_1
    v_mfma_f32_16x16x32_bf16 v[188:191], v[232:235], v[44:47], v[188:191]
    ds_read_b64_tr_b16 v[232:233], v254 offset:35840
    v_exp_f16_sdwa v221, v221 dst_sel:WORD_1 dst_unused:UNUSED_PRESERVE src0_sel:WORD_1
    v_or_b32 v155, v202, v203
    s_waitcnt lgkmcnt(7)
    v_mfma_f32_16x16x32_bf16 v[116:119], v[236:239], v[160:163], v[116:119]
    ds_read_b64_tr_b16 v[234:235], v254 offset:36096
    v_exp_f16_sdwa v223, v223 dst_sel:WORD_1 dst_unused:UNUSED_PRESERVE src0_sel:WORD_1
    v_mfma_f32_16x16x32_bf16 v[124:127], v[236:239], v[164:167], v[124:127]
    ds_read_u16_d16 v216, v216
    v_lshlrev_b32_sdwa v218, 1, v218 dst_sel:DWORD dst_unused:UNUSED_PAD src0_sel:DWORD src1_sel:WORD_1
    v_mfma_f32_16x16x32_bf16 v[132:135], v[236:239], v[168:171], v[132:135]
    ds_read_u16_d16_hi v217, v217
    v_lshlrev_b32_sdwa v219, 1, v219 dst_sel:DWORD dst_unused:UNUSED_PAD src0_sel:DWORD src1_sel:WORD_1
    v_pk_fma_f16 v221, v221, s85, s85
    v_mfma_f32_16x16x32_bf16 v[140:143], v[236:239], v[172:175], v[140:143]
    ds_read_b64_tr_b16 v[236:237], v255 offset:37896
    v_or_b32_e64 v158, v204, v205
    v_pk_fma_f16 v223, v223, s85, s85
    v_mfma_f32_16x16x32_bf16 v[192:195], v[224:227], v[0:3], 0
    ds_read_b64_tr_b16 v[238:239], v255 offset:38664
    v_or_b32_e64 v160, v208, v209
    v_mfma_f32_16x16x32_bf16 v[196:199], v[224:227], v[4:7], 0
    ds_read_u16_d16 v218, v218
    v_rcp_f16_sdwa v221, v221 dst_sel:WORD_0 dst_unused:UNUSED_PRESERVE src0_sel:WORD_0
    v_lshlrev_b32_sdwa v176, 1, v176 dst_sel:DWORD dst_unused:UNUSED_PAD src0_sel:DWORD src1_sel:WORD_1
    v_mfma_f32_16x16x32_bf16 v[200:203], v[224:227], v[8:11], 0
    ds_read_u16_d16_hi v219, v219
    v_rcp_f16_sdwa v223, v223 dst_sel:WORD_0 dst_unused:UNUSED_PRESERVE src0_sel:WORD_0
    v_mfma_f32_16x16x32_bf16 v[204:207], v[224:227], v[12:15], 0
    ds_read_b64_tr_b16 v[224:225], v254 offset:36864
    v_lshlrev_b32_sdwa v177, 1, v177 dst_sel:DWORD dst_unused:UNUSED_PAD src0_sel:DWORD src1_sel:WORD_1
    v_or_b32 v161, v210, v211
    s_waitcnt lgkmcnt(7)
    v_mfma_f32_16x16x32_bf16 v[48:51], v[228:231], v[144:147], v[48:51]
    ds_read_b64_tr_b16 v[226:227], v254 offset:37120
    v_fma_mixlo_f16 v190, v190, s83, 0
    v_mfma_f32_16x16x32_bf16 v[56:59], v[228:231], v[148:151], v[56:59]
    ds_read_u16_d16 v176, v176
    s_waitcnt vmcnt(1)
    v_mfma_f32_16x16x16_bf16 v[68:71], v[242:243], v[246:247], v[68:71]
    v_lshlrev_b32_sdwa v178, 1, v178 dst_sel:DWORD dst_unused:UNUSED_PAD src0_sel:DWORD src1_sel:WORD_1
    v_mfma_f32_16x16x32_bf16 v[64:67], v[228:231], v[152:155], v[64:67]
    ds_read_u16_d16_hi v177, v177
    v_rcp_f16_sdwa v221, v221 dst_sel:WORD_1 dst_unused:UNUSED_PRESERVE src0_sel:WORD_1
    v_mfma_f32_16x16x32_bf16 v[72:75], v[228:231], v[156:159], v[72:75]
    ds_read_b64_tr_b16 v[228:229], v255 offset:37952
    v_lshlrev_b32_sdwa v179, 1, v179 dst_sel:DWORD dst_unused:UNUSED_PAD src0_sel:DWORD src1_sel:WORD_1
    v_or_b32 v164, v212, v213
    v_mfma_f32_16x16x32_bf16 v[192:195], v[232:235], v[16:19], v[192:195]
    ds_read_b64_tr_b16 v[230:231], v255 offset:38720
    v_rcp_f16_sdwa v223, v223 dst_sel:WORD_1 dst_unused:UNUSED_PRESERVE src0_sel:WORD_1
    v_mfma_f32_16x16x32_bf16 v[196:199], v[232:235], v[20:23], v[196:199]
    ds_read_u16_d16 v178, v178
    v_mfma_f32_16x16x16_bf16 v[64:67], v[242:243], v[244:245], v[64:67]
    v_lshlrev_b32_sdwa v180, 1, v180 dst_sel:DWORD dst_unused:UNUSED_PAD src0_sel:DWORD src1_sel:WORD_1
    v_fma_mixhi_f16 v190, v191, s83, 0
    v_mfma_f32_16x16x32_bf16 v[200:203], v[232:235], v[24:27], v[200:203]
    ds_read_u16_d16_hi v179, v179
    buffer_load_dwordx4 v[244:247], v252, s[4:7], s25 offen offset:128 sc1
    v_lshlrev_b32_sdwa v181, 1, v181 dst_sel:DWORD dst_unused:UNUSED_PAD src0_sel:DWORD src1_sel:WORD_1
    v_mfma_f32_16x16x32_bf16 v[204:207], v[232:235], v[28:31], v[204:207]
    ds_read_b64_tr_b16 v[232:233], v254 offset:34824
    ds_read_b64_tr_b16 v[234:235], v254 offset:35080
    v_fma_mix_f32 v172, v220, v221, 0 op_sel_hi:[1,1,0]
    v_or_b32 v165, v214, v215
    s_waitcnt lgkmcnt(7)
    v_mfma_f32_16x16x32_bf16 v[52:55], v[236:239], v[144:147], v[52:55]
    ds_read_u16_d16 v180, v180
    v_fma_mix_f32 v173, v222, v223, 0 op_sel_hi:[1,1,0]
    v_mfma_f32_16x16x32_bf16 v[60:63], v[236:239], v[148:151], v[60:63]
    ds_read_u16_d16_hi v181, v181
    v_lshlrev_b32_sdwa v182, 1, v182 dst_sel:DWORD dst_unused:UNUSED_PAD src0_sel:DWORD src1_sel:WORD_1
    v_pk_fma_f16 v191, v190, v190, s84 neg_lo:[0,1,0] neg_hi:[0,1,0]
    v_mfma_f32_16x16x32_bf16 v[68:71], v[236:239], v[152:155], v[68:71]
    ds_read_u16_d16 v182, v182
    v_lshlrev_b32_sdwa v183, 1, v183 dst_sel:DWORD dst_unused:UNUSED_PAD src0_sel:DWORD src1_sel:WORD_1
    v_fma_mix_f32 v221, v220, v221, 0 op_sel:[1,1,0] op_sel_hi:[1,1,0]
    v_mfma_f32_16x16x32_bf16 v[76:79], v[236:239], v[156:159], v[76:79]
    ds_read_b64_tr_b16 v[236:237], v255 offset:37960
    v_or_b32_e64 v168, v216, v217
    v_fma_mix_f32 v223, v222, v223, 0 op_sel:[1,1,0] op_sel_hi:[1,1,0]
    v_mfma_f32_16x16x32_bf16 v[192:195], v[224:227], v[32:35], v[192:195]
    ds_read_b64_tr_b16 v[238:239], v255 offset:38728
    v_lshlrev_b32_sdwa v184, 1, v184 dst_sel:DWORD dst_unused:UNUSED_PAD src0_sel:DWORD src1_sel:WORD_1
    v_pk_mul_f16 v191, v191, v190
    v_mfma_f32_16x16x32_bf16 v[196:199], v[224:227], v[36:39], v[196:199]
    ds_read_u16_d16_hi v183, v183
    v_cvt_pk_bf16_f32 v172, v172, v221
    v_lshlrev_b32_sdwa v185, 1, v185 dst_sel:DWORD dst_unused:UNUSED_PAD src0_sel:DWORD src1_sel:WORD_1
    v_mfma_f32_16x16x32_bf16 v[200:203], v[224:227], v[40:43], v[200:203]
    ds_read_u16_d16 v184, v184
    v_cvt_pk_bf16_f32 v173, v173, v223
    v_or_b32_e64 v169, v218, v219
    v_mfma_f32_16x16x32_bf16 v[204:207], v[224:227], v[44:47], v[204:207]
    ds_read_b64_tr_b16 v[224:225], v254 offset:35848
    v_exp_f16_sdwa v191, v191 dst_sel:WORD_0 dst_unused:UNUSED_PRESERVE src0_sel:WORD_0
    s_waitcnt lgkmcnt(7)
    v_mfma_f32_16x16x32_bf16 v[80:83], v[228:231], v[144:147], v[80:83]
    ds_read_b64_tr_b16 v[226:227], v254 offset:36104
    v_lshlrev_b32_sdwa v186, 1, v186 dst_sel:DWORD dst_unused:UNUSED_PAD src0_sel:DWORD src1_sel:WORD_1
    v_mfma_f32_16x16x32_bf16 v[88:91], v[228:231], v[148:151], v[88:91]
    ds_read_u16_d16_hi v185, v185
    v_lshlrev_b32_sdwa v187, 1, v187 dst_sel:DWORD dst_unused:UNUSED_PAD src0_sel:DWORD src1_sel:WORD_1
    v_exp_f16_sdwa v191, v191 dst_sel:WORD_1 dst_unused:UNUSED_PRESERVE src0_sel:WORD_1
    v_mfma_f32_16x16x32_bf16 v[96:99], v[228:231], v[152:155], v[96:99]
    ds_read_u16_d16 v186, v186
    v_lshlrev_b32_sdwa v188, 1, v188 dst_sel:DWORD dst_unused:UNUSED_PAD src0_sel:DWORD src1_sel:WORD_1
    v_mfma_f32_16x16x32_bf16 v[104:107], v[228:231], v[156:159], v[104:107]
    ds_read_b64_tr_b16 v[228:229], v255 offset:38016
    ds_read_b64_tr_b16 v[230:231], v255 offset:38784
    v_lshlrev_b32_sdwa v189, 1, v189 dst_sel:DWORD dst_unused:UNUSED_PAD src0_sel:DWORD src1_sel:WORD_1
    v_pk_fma_f16 v191, v191, s85, s85
    v_mfma_f32_16x16x32_bf16 v[208:211], v[232:235], v[0:3], 0
    ds_read_u16_d16_hi v187, v187
    v_or_b32 v162, v176, v177
    v_mfma_f32_16x16x32_bf16 v[212:215], v[232:235], v[4:7], 0
    ds_read_u16_d16 v188, v188
    v_rcp_f16_sdwa v191, v191 dst_sel:WORD_0 dst_unused:UNUSED_PRESERVE src0_sel:WORD_0
    v_lshlrev_b32_sdwa v192, 1, v192 dst_sel:DWORD dst_unused:UNUSED_PAD src0_sel:DWORD src1_sel:WORD_1
    v_mfma_f32_16x16x32_bf16 v[216:219], v[232:235], v[8:11], 0
    ds_read_u16_d16_hi v189, v189
    v_fma_mixlo_f16 v204, v204, s83, 0
    v_lshlrev_b32_sdwa v193, 1, v193 dst_sel:DWORD dst_unused:UNUSED_PAD src0_sel:DWORD src1_sel:WORD_1
    v_mfma_f32_16x16x32_bf16 v[220:223], v[232:235], v[12:15], 0
    ds_read_b64_tr_b16 v[232:233], v254 offset:36872
    v_fma_mixlo_f16 v206, v206, s83, 0
    v_or_b32 v163, v178, v179
    s_waitcnt lgkmcnt(7)
    v_mfma_f32_16x16x32_bf16 v[84:87], v[236:239], v[144:147], v[84:87]
    ds_read_b64_tr_b16 v[234:235], v254 offset:37128
    v_rcp_f16_sdwa v191, v191 dst_sel:WORD_1 dst_unused:UNUSED_PRESERVE src0_sel:WORD_1
    v_mfma_f32_16x16x32_bf16 v[92:95], v[236:239], v[148:151], v[92:95]
    ds_read_u16_d16 v192, v192
    s_waitcnt vmcnt(1)
    v_mfma_f32_16x16x16_bf16 v[96:99], v[242:243], v[248:249], v[96:99]
    v_lshlrev_b32_sdwa v194, 1, v194 dst_sel:DWORD dst_unused:UNUSED_PAD src0_sel:DWORD src1_sel:WORD_1
    v_mfma_f32_16x16x32_bf16 v[100:103], v[236:239], v[152:155], v[100:103]
    ds_read_u16_d16_hi v193, v193
    v_fma_mixhi_f16 v204, v205, s83, 0
    v_mfma_f32_16x16x32_bf16 v[108:111], v[236:239], v[156:159], v[108:111]
    ds_read_b64_tr_b16 v[236:237], v255 offset:38024
    v_lshlrev_b32_sdwa v195, 1, v195 dst_sel:DWORD dst_unused:UNUSED_PAD src0_sel:DWORD src1_sel:WORD_1
    v_fma_mixhi_f16 v206, v207, s83, 0
    v_mfma_f32_16x16x32_bf16 v[208:211], v[224:227], v[16:19], v[208:211]
    ds_read_b64_tr_b16 v[238:239], v255 offset:38792
    v_or_b32 v166, v180, v181
    v_fma_mix_f32 v175, v190, v191, 0 op_sel_hi:[1,1,0]
    v_mfma_f32_16x16x32_bf16 v[212:215], v[224:227], v[20:23], v[212:215]
    ds_read_u16_d16 v194, v194
    v_mfma_f32_16x16x16_bf16 v[100:103], v[242:243], v[250:251], v[100:103]
    v_pk_fma_f16 v205, v204, v204, s84 neg_lo:[0,1,0] neg_hi:[0,1,0]
    v_lshlrev_b32_sdwa v196, 1, v196 dst_sel:DWORD dst_unused:UNUSED_PAD src0_sel:DWORD src1_sel:WORD_1
    v_mfma_f32_16x16x32_bf16 v[216:219], v[224:227], v[24:27], v[216:219]
    ds_read_u16_d16_hi v195, v195
    buffer_load_dwordx4 v[248:251], v252, s[4:7], s25 offen offset:192 sc1
    v_pk_fma_f16 v207, v206, v206, s84 neg_lo:[0,1,0] neg_hi:[0,1,0]
    v_mfma_f32_16x16x32_bf16 v[220:223], v[224:227], v[28:31], v[220:223]
    s_cmp_lt_u32 s19, 18
    s_cbranch_scc1 L_rd18_slow
L_rd18_go:
    ds_read_b64_tr_b16 v[224:225], v254 offset:40960
    v_lshlrev_b32_sdwa v197, 1, v197 dst_sel:DWORD dst_unused:UNUSED_PAD src0_sel:DWORD src1_sel:WORD_1
    v_fma_mix_f32 v191, v190, v191, 0 op_sel:[1,1,0] op_sel_hi:[1,1,0]
    s_waitcnt lgkmcnt(7)
    v_mfma_f32_16x16x32_bf16 v[112:115], v[228:231], v[144:147], v[112:115]
    ds_read_b64_tr_b16 v[226:227], v254 offset:41216
    v_or_b32 v167, v182, v183
    v_pk_mul_f16 v205, v205, v204
    v_mfma_f32_16x16x32_bf16 v[120:123], v[228:231], v[148:151], v[120:123]
    ds_read_u16_d16 v196, v196
    v_pk_mul_f16 v207, v207, v206
    v_lshlrev_b32_sdwa v198, 1, v198 dst_sel:DWORD dst_unused:UNUSED_PAD src0_sel:DWORD src1_sel:WORD_1
    v_mfma_f32_16x16x32_bf16 v[128:131], v[228:231], v[152:155], v[128:131]
    ds_read_u16_d16_hi v197, v197
    v_cvt_pk_bf16_f32 v175, v175, v191
    v_lshlrev_b32_sdwa v199, 1, v199 dst_sel:DWORD dst_unused:UNUSED_PAD src0_sel:DWORD src1_sel:WORD_1
    v_mfma_f32_16x16x32_bf16 v[136:139], v[228:231], v[156:159], v[136:139]
    ds_read_b64_tr_b16 v[228:229], v255 offset:44032
    v_exp_f16_sdwa v205, v205 dst_sel:WORD_0 dst_unused:UNUSED_PRESERVE src0_sel:WORD_0
    v_mfma_f32_16x16x32_bf16 v[208:211], v[232:235], v[32:35], v[208:211]
    ds_read_b64_tr_b16 v[230:231], v255 offset:44800
    v_or_b32_e64 v170, v184, v185
    v_mfma_f32_16x16x32_bf16 v[212:215], v[232:235], v[36:39], v[212:215]
    ds_read_u16_d16 v198, v198
    v_exp_f16_sdwa v207, v207 dst_sel:WORD_0 dst_unused:UNUSED_PRESERVE src0_sel:WORD_0
    v_lshlrev_b32_sdwa v200, 1, v200 dst_sel:DWORD dst_unused:UNUSED_PAD src0_sel:DWORD src1_sel:WORD_1
    v_mfma_f32_16x16x32_bf16 v[216:219], v[232:235], v[40:43], v[216:219]
    ds_read_u16_d16_hi v199, v199
    v_lshlrev_b32_sdwa v201, 1, v201 dst_sel:DWORD dst_unused:UNUSED_PAD src0_sel:DWORD src1_sel:WORD_1
    v_mfma_f32_16x16x32_bf16 v[220:223], v[232:235], v[44:47], v[220:223]
    ds_read_b64_tr_b16 v[232:233], v254 offset:41984
    v_exp_f16_sdwa v205, v205 dst_sel:WORD_1 dst_unused:UNUSED_PRESERVE src0_sel:WORD_1
    s_waitcnt lgkmcnt(7)
    v_mfma_f32_16x16x32_bf16 v[116:119], v[236:239], v[144:147], v[116:119]
    ds_read_b64_tr_b16 v[234:235], v254 offset:42240
    v_or_b32 v171, v186, v187
    v_exp_f16_sdwa v207, v207 dst_sel:WORD_1 dst_unused:UNUSED_PRESERVE src0_sel:WORD_1
    v_mfma_f32_16x16x32_bf16 v[124:127], v[236:239], v[148:151], v[124:127]
    ds_read_u16_d16 v200, v200
    v_lshlrev_b32_sdwa v202, 1, v202 dst_sel:DWORD dst_unused:UNUSED_PAD src0_sel:DWORD src1_sel:WORD_1
    v_mfma_f32_16x16x32_bf16 v[132:135], v[236:239], v[152:155], v[132:135]
    ds_read_u16_d16_hi v201, v201
    v_lshlrev_b32_sdwa v203, 1, v203 dst_sel:DWORD dst_unused:UNUSED_PAD src0_sel:DWORD src1_sel:WORD_1
    v_pk_fma_f16 v205, v205, s85, s85
    v_mfma_f32_16x16x32_bf16 v[140:143], v[236:239], v[156:159], v[140:143]
    ds_read_b64_tr_b16 v[236:237], v255 offset:44040
    v_or_b32_e64 v174, v188, v189
    v_pk_fma_f16 v207, v207, s85, s85
    v_mfma_f32_16x16x32_bf16 v[176:179], v[224:227], v[0:3], 0
    ds_read_b64_tr_b16 v[238:239], v255 offset:44808
    v_or_b32_e64 v144, v192, v193
    v_mfma_f32_16x16x32_bf16 v[180:183], v[224:227], v[4:7], 0
    ds_read_u16_d16 v202, v202
    v_rcp_f16_sdwa v205, v205 dst_sel:WORD_0 dst_unused:UNUSED_PRESERVE src0_sel:WORD_0
    v_lshlrev_b32_sdwa v208, 1, v208 dst_sel:DWORD dst_unused:UNUSED_PAD src0_sel:DWORD src1_sel:WORD_1
    v_mfma_f32_16x16x32_bf16 v[184:187], v[224:227], v[8:11], 0
    ds_read_u16_d16_hi v203, v203
    v_rcp_f16_sdwa v207, v207 dst_sel:WORD_0 dst_unused:UNUSED_PRESERVE src0_sel:WORD_0
    v_mfma_f32_16x16x32_bf16 v[188:191], v[224:227], v[12:15], 0
    ds_read_b64_tr_b16 v[224:225], v254 offset:43008
    v_lshlrev_b32_sdwa v209, 1, v209 dst_sel:DWORD dst_unused:UNUSED_PAD src0_sel:DWORD src1_sel:WORD_1
    s_waitcnt lgkmcnt(7)
    v_mfma_f32_16x16x32_bf16 v[48:51], v[228:231], v[160:163], v[48:51]
    ds_read_b64_tr_b16 v[226:227], v254 offset:43264
    v_or_b32 v145, v194, v195
    v_fma_mixlo_f16 v222, v222, s83, 0
    v_mfma_f32_16x16x32_bf16 v[56:59], v[228:231], v[164:167], v[56:59]
    ds_read_u16_d16 v208, v208
    v_lshlrev_b32_sdwa v210, 1, v210 dst_sel:DWORD dst_unused:UNUSED_PAD src0_sel:DWORD src1_sel:WORD_1
    v_mfma_f32_16x16x32_bf16 v[64:67], v[228:231], v[168:171], v[64:67]
    ds_read_u16_d16_hi v209, v209
    v_rcp_f16_sdwa v205, v205 dst_sel:WORD_1 dst_unused:UNUSED_PRESERVE src0_sel:WORD_1
    v_lshlrev_b32_sdwa v211, 1, v211 dst_sel:DWORD dst_unused:UNUSED_PAD src0_sel:DWORD src1_sel:WORD_1
    v_mfma_f32_16x16x32_bf16 v[72:75], v[228:231], v[172:175], v[72:75]
    ds_read_b64_tr_b16 v[228:229], v255 offset:44096
    v_or_b32_e64 v148, v196, v197
    v_mfma_f32_16x16x32_bf16 v[176:179], v[232:235], v[16:19], v[176:179]
    ds_read_b64_tr_b16 v[230:231], v255 offset:44864
    v_rcp_f16_sdwa v207, v207 dst_sel:WORD_1 dst_unused:UNUSED_PRESERVE src0_sel:WORD_1
    v_mfma_f32_16x16x32_bf16 v[180:183], v[232:235], v[20:23], v[180:183]
    ds_read_u16_d16 v210, v210
    v_lshlrev_b32_sdwa v212, 1, v212 dst_sel:DWORD dst_unused:UNUSED_PAD src0_sel:DWORD src1_sel:WORD_1
    v_fma_mixhi_f16 v222, v223, s83, 0
    v_mfma_f32_16x16x32_bf16 v[184:187], v[232:235], v[24:27], v[184:187]
    ds_read_u16_d16_hi v211, v211
    v_lshlrev_b32_sdwa v213, 1, v213 dst_sel:DWORD dst_unused:UNUSED_PAD src0_sel:DWORD src1_sel:WORD_1
    v_fma_mix_f32 v156, v204, v205, 0 op_sel_hi:[1,1,0]
    v_mfma_f32_16x16x32_bf16 v[188:191], v[232:235], v[28:31], v[188:191]
    ds_read_b64_tr_b16 v[232:233], v254 offset:40968
    ds_read_b64_tr_b16 v[234:235], v254 offset:41224
    v_or_b32_e64 v149, v198, v199
    v_fma_mix_f32 v157, v206, v207, 0 op_sel_hi:[1,1,0]
    s_waitcnt lgkmcnt(7)
    v_mfma_f32_16x16x32_bf16 v[52:55], v[236:239], v[160:163], v[52:55]
    ds_read_u16_d16 v212, v212
    v_lshlrev_b32_sdwa v214, 1, v214 dst_sel:DWORD dst_unused:UNUSED_PAD src0_sel:DWORD src1_sel:WORD_1
    v_mfma_f32_16x16x32_bf16 v[60:63], v[236:239], v[164:167], v[60:63]
    ds_read_u16_d16_hi v213, v213
    v_pk_fma_f16 v223, v222, v222, s84 neg_lo:[0,1,0] neg_hi:[0,1,0]
    v_lshlrev_b32_sdwa v215, 1, v215 dst_sel:DWORD dst_unused:UNUSED_PAD src0_sel:DWORD src1_sel:WORD_1
    v_mfma_f32_16x16x32_bf16 v[68:71], v[236:239], v[168:171], v[68:71]
    ds_read_u16_d16 v214, v214
    v_fma_mix_f32 v205, v204, v205, 0 op_sel:[1,1,0] op_sel_hi:[1,1,0]
    v_or_b32 v152, v200, v201
    v_mfma_f32_16x16x32_bf16 v[76:79], v[236:239], v[172:175], v[76:79]
    ds_read_b64_tr_b16 v[236:237], v255 offset:44104
    v_fma_mix_f32 v207, v206, v207, 0 op_sel:[1,1,0] op_sel_hi:[1,1,0]
    v_lshlrev_b32_sdwa v216, 1, v216 dst_sel:DWORD dst_unused:UNUSED_PAD src0_sel:DWORD src1_sel:WORD_1
    v_mfma_f32_16x16x32_bf16 v[176:179], v[224:227], v[32:35], v[176:179]
    ds_read_b64_tr_b16 v[238:239], v255 offset:44872
    v_pk_mul_f16 v223, v223, v222
    v_mfma_f32_16x16x32_bf16 v[180:183], v[224:227], v[36:39], v[180:183]
    ds_read_u16_d16_hi v215, v215
    v_cvt_pk_bf16_f32 v156, v156, v205
    v_lshlrev_b32_sdwa v217, 1, v217 dst_sel:DWORD dst_unused:UNUSED_PAD src0_sel:DWORD src1_sel:WORD_1
    v_mfma_f32_16x16x32_bf16 v[184:187], v[224:227], v[40:43], v[184:187]
    ds_read_u16_d16 v216, v216
    v_cvt_pk_bf16_f32 v157, v157, v207
    v_or_b32_e64 v153, v202, v203
    v_mfma_f32_16x16x32_bf16 v[188:191], v[224:227], v[44:47], v[188:191]
    ds_read_b64_tr_b16 v[224:225], v254 offset:41992
    v_exp_f16_sdwa v223, v223 dst_sel:WORD_0 dst_unused:UNUSED_PRESERVE src0_sel:WORD_0
    s_waitcnt lgkmcnt(7)
    v_mfma_f32_16x16x32_bf16 v[80:83], v[228:231], v[160:163], v[80:83]
    ds_read_b64_tr_b16 v[226:227], v254 offset:42248
    v_lshlrev_b32_sdwa v218, 1, v218 dst_sel:DWORD dst_unused:UNUSED_PAD src0_sel:DWORD src1_sel:WORD_1
    v_lshlrev_b32_sdwa v219, 1, v219 dst_sel:DWORD dst_unused:UNUSED_PAD src0_sel:DWORD src1_sel:WORD_1
    v_mfma_f32_16x16x32_bf16 v[88:91], v[228:231], v[164:167], v[88:91]
    ds_read_u16_d16_hi v217, v217
    v_exp_f16_sdwa v223, v223 dst_sel:WORD_1 dst_unused:UNUSED_PRESERVE src0_sel:WORD_1
    v_mfma_f32_16x16x32_bf16 v[96:99], v[228:231], v[168:171], v[96:99]
    ds_read_u16_d16 v218, v218
    v_lshlrev_b32_sdwa v220, 1, v220 dst_sel:DWORD dst_unused:UNUSED_PAD src0_sel:DWORD src1_sel:WORD_1
    v_mfma_f32_16x16x32_bf16 v[104:107], v[228:231], v[172:175], v[104:107]
    ds_read_b64_tr_b16 v[228:229], v255 offset:44160
    ds_read_b64_tr_b16 v[230:231], v255 offset:44928
    v_lshlrev_b32_sdwa v221, 1, v221 dst_sel:DWORD dst_unused:UNUSED_PAD src0_sel:DWORD src1_sel:WORD_1
    v_pk_fma_f16 v223, v223, s85, s85
    v_mfma_f32_16x16x32_bf16 v[192:195], v[232:235], v[0:3], 0
    ds_read_u16_d16_hi v219, v219
    v_or_b32 v146, v208, v209
    v_mfma_f32_16x16x32_bf16 v[196:199], v[232:235], v[4:7], 0
    ds_read_u16_d16 v220, v220
    v_rcp_f16_sdwa v223, v223 dst_sel:WORD_0 dst_unused:UNUSED_PRESERVE src0_sel:WORD_0
    v_lshlrev_b32_sdwa v176, 1, v176 dst_sel:DWORD dst_unused:UNUSED_PAD src0_sel:DWORD src1_sel:WORD_1
    v_mfma_f32_16x16x32_bf16 v[200:203], v[232:235], v[8:11], 0
    ds_read_u16_d16_hi v221, v221
    v_fma_mixlo_f16 v188, v188, s83, 0
    v_lshlrev_b32_sdwa v177, 1, v177 dst_sel:DWORD dst_unused:UNUSED_PAD src0_sel:DWORD src1_sel:WORD_1
    v_mfma_f32_16x16x32_bf16 v[204:207], v[232:235], v[12:15], 0
    ds_read_b64_tr_b16 v[232:233], v254 offset:43016
    v_fma_mixlo_f16 v190, v190, s83, 0
    v_or_b32 v147, v210, v211
    s_waitcnt lgkmcnt(7)
    v_mfma_f32_16x16x32_bf16 v[84:87], v[236:239], v[160:163], v[84:87]
    ds_read_b64_tr_b16 v[234:235], v254 offset:43272
    v_rcp_f16_sdwa v223, v223 dst_sel:WORD_1 dst_unused:UNUSED_PRESERVE src0_sel:WORD_1
    v_mfma_f32_16x16x32_bf16 v[92:95], v[236:239], v[164:167], v[92:95]
    ds_read_u16_d16 v176, v176
    s_waitcnt vmcnt(1)
    v_mfma_f32_16x16x16_bf16 v[128:131], v[242:243], v[244:245], v[128:131]
    v_lshlrev_b32_sdwa v178, 1, v178 dst_sel:DWORD dst_unused:UNUSED_PAD src0_sel:DWORD src1_sel:WORD_1
    v_mfma_f32_16x16x32_bf16 v[100:103], v[236:239], v[168:171], v[100:103]
    ds_read_u16_d16_hi v177, v177
    v_fma_mixhi_f16 v188, v189, s83, 0
    v_mfma_f32_16x16x32_bf16 v[108:111], v[236:239], v[172:175], v[108:111]
    ds_read_b64_tr_b16 v[236:237], v255 offset:44168
    v_mfma_f32_16x16x16_bf16 v[132:135], v[242:243], v[246:247], v[132:135]
    v_lshlrev_b32_sdwa v179, 1, v179 dst_sel:DWORD dst_unused:UNUSED_PAD src0_sel:DWORD src1_sel:WORD_1
    v_fma_mixhi_f16 v190, v191, s83, 0
    v_mfma_f32_16x16x32_bf16 v[192:195], v[224:227], v[16:19], v[192:195]
    ds_read_b64_tr_b16 v[238:239], v255 offset:44936
    buffer_load_dwordx4 v[244:247], v252, s[4:7], s25 offen offset:256 sc1
    v_or_b32 v150, v212, v213
    v_mfma_f32_16x16x32_bf16 v[196:199], v[224:227], v[20:23], v[196:199]
    ds_read_u16_d16 v178, v178
    v_fma_mix_f32 v159, v222, v223, 0 op_sel_hi:[1,1,0]
    v_pk_fma_f16 v189, v188, v188, s84 neg_lo:[0,1,0] neg_hi:[0,1,0]
    v_mfma_f32_16x16x32_bf16 v[200:203], v[224:227], v[24:27], v[200:203]
    ds_read_u16_d16_hi v179, v179
    v_lshlrev_b32_sdwa v180, 1, v180 dst_sel:DWORD dst_unused:UNUSED_PAD src0_sel:DWORD src1_sel:WORD_1
    v_pk_fma_f16 v191, v190, v190, s84 neg_lo:[0,1,0] neg_hi:[0,1,0]
    v_mfma_f32_16x16x32_bf16 v[204:207], v[224:227], v[28:31], v[204:207]
    s_cmp_lt_u32 s19, 20
    s_cbranch_scc1 L_rd20_slow
L_rd20_go:
    ds_read_b64_tr_b16 v[224:225], v254 offset:47104
    v_lshlrev_b32_sdwa v181, 1, v181 dst_sel:DWORD dst_unused:UNUSED_PAD src0_sel:DWORD src1_sel:WORD_1
    v_fma_mix_f32 v223, v222, v223, 0 op_sel:[1,1,0] op_sel_hi:[1,1,0]
    s_waitcnt lgkmcnt(7)
    v_mfma_f32_16x16x32_bf16 v[112:115], v[228:231], v[160:163], v[112:115]
    ds_read_b64_tr_b16 v[226:227], v254 offset:47360
    v_or_b32 v151, v214, v215
    v_pk_mul_f16 v189, v189, v188
    v_mfma_f32_16x16x32_bf16 v[120:123], v[228:231], v[164:167], v[120:123]
    ds_read_u16_d16 v180, v180
    v_pk_mul_f16 v191, v191, v190
    v_lshlrev_b32_sdwa v182, 1, v182 dst_sel:DWORD dst_unused:UNUSED_PAD src0_sel:DWORD src1_sel:WORD_1
    v_mfma_f32_16x16x32_bf16 v[128:131], v[228:231], v[168:171], v[128:131]
    ds_read_u16_d16_hi v181, v181
    v_cvt_pk_bf16_f32 v159, v159, v223
    v_lshlrev_b32_sdwa v183, 1, v183 dst_sel:DWORD dst_unused:UNUSED_PAD src0_sel:DWORD src1_sel:WORD_1
    v_mfma_f32_16x16x32_bf16 v[136:139], v[228:231], v[172:175], v[136:139]
    ds_read_b64_tr_b16 v[228:229], v255 offset:50176
    v_exp_f16_sdwa v189, v189 dst_sel:WORD_0 dst_unused:UNUSED_PRESERVE src0_sel:WORD_0
    v_mfma_f32_16x16x32_bf16 v[192:195], v[232:235], v[32:35], v[192:195]
    ds_read_b64_tr_b16 v[230:231], v255 offset:50944
    v_or_b32_e64 v154, v216, v217
    v_mfma_f32_16x16x32_bf16 v[196:199], v[232:235], v[36:39], v[196:199]
    ds_read_u16_d16 v182, v182
    v_exp_f16_sdwa v191, v191 dst_sel:WORD_0 dst_unused:UNUSED_PRESERVE src0_sel:WORD_0
    v_lshlrev_b32_sdwa v184, 1, v184 dst_sel:DWORD dst_unused:UNUSED_PAD src0_sel:DWORD src1_sel:WORD_1
    v_mfma_f32_16x16x32_bf16 v[200:203], v[232:235], v[40:43], v[200:203]
    ds_read_u16_d16_hi v183, v183
    v_lshlrev_b32_sdwa v185, 1, v185 dst_sel:DWORD dst_unused:UNUSED_PAD src0_sel:DWORD src1_sel:WORD_1
    v_mfma_f32_16x16x32_bf16 v[204:207], v[232:235], v[44:47], v[204:207]
    ds_read_b64_tr_b16 v[232:233], v254 offset:48128
    v_exp_f16_sdwa v189, v189 dst_sel:WORD_1 dst_unused:UNUSED_PRESERVE src0_sel:WORD_1
    s_waitcnt lgkmcnt(7)
    v_mfma_f32_16x16x32_bf16 v[116:119], v[236:239], v[160:163], v[116:119]
    ds_read_b64_tr_b16 v[234:235], v254 offset:48384
    v_or_b32 v155, v218, v219
    v_exp_f16_sdwa v191, v191 dst_sel:WORD_1 dst_unused:UNUSED_PRESERVE src0_sel:WORD_1
    v_mfma_f32_16x16x32_bf16 v[124:127], v[236:239], v[164:167], v[124:127]
    ds_read_u16_d16 v184, v184
    v_lshlrev_b32_sdwa v186, 1, v186 dst_sel:DWORD dst_unused:UNUSED_PAD src0_sel:DWORD src1_sel:WORD_1
    v_mfma_f32_16x16x32_bf16 v[132:135], v[236:239], v[168:171], v[132:135]
    ds_read_u16_d16_hi v185, v185
    v_lshlrev_b32_sdwa v187, 1, v187 dst_sel:DWORD dst_unused:UNUSED_PAD src0_sel:DWORD src1_sel:WORD_1
    v_pk_fma_f16 v189, v189, s85, s85
    v_mfma_f32_16x16x32_bf16 v[140:143], v[236:239], v[172:175], v[140:143]
    ds_read_b64_tr_b16 v[236:237], v255 offset:50184
    v_or_b32_e64 v158, v220, v221
    v_pk_fma_f16 v191, v191, s85, s85
    v_mfma_f32_16x16x32_bf16 v[208:211], v[224:227], v[0:3], 0
    ds_read_b64_tr_b16 v[238:239], v255 offset:50952
    v_or_b32_e64 v160, v176, v177
    v_mfma_f32_16x16x32_bf16 v[212:215], v[224:227], v[4:7], 0
    ds_read_u16_d16 v186, v186
    v_rcp_f16_sdwa v189, v189 dst_sel:WORD_0 dst_unused:UNUSED_PRESERVE src0_sel:WORD_0
    v_lshlrev_b32_sdwa v192, 1, v192 dst_sel:DWORD dst_unused:UNUSED_PAD src0_sel:DWORD src1_sel:WORD_1
    v_mfma_f32_16x16x32_bf16 v[216:219], v[224:227], v[8:11], 0
    ds_read_u16_d16_hi v187, v187
    v_rcp_f16_sdwa v191, v191 dst_sel:WORD_0 dst_unused:UNUSED_PRESERVE src0_sel:WORD_0
    v_mfma_f32_16x16x32_bf16 v[220:223], v[224:227], v[12:15], 0
    ds_read_b64_tr_b16 v[224:225], v254 offset:49152
    v_lshlrev_b32_sdwa v193, 1, v193 dst_sel:DWORD dst_unused:UNUSED_PAD src0_sel:DWORD src1_sel:WORD_1
    v_or_b32 v161, v178, v179
    s_waitcnt lgkmcnt(7)
    v_mfma_f32_16x16x32_bf16 v[48:51], v[228:231], v[144:147], v[48:51]
    ds_read_b64_tr_b16 v[226:227], v254 offset:49408
    v_fma_mixlo_f16 v206, v206, s83, 0
    v_mfma_f32_16x16x32_bf16 v[56:59], v[228:231], v[148:151], v[56:59]
    ds_read_u16_d16 v192, v192
    s_waitcnt vmcnt(1)
    v_mfma_f32_16x16x16_bf16 v[76:79], v[242:243], v[250:251], v[76:79]
    v_lshlrev_b32_sdwa v194, 1, v194 dst_sel:DWORD dst_unused:UNUSED_PAD src0_sel:DWORD src1_sel:WORD_1
    v_mfma_f32_16x16x32_bf16 v[64:67], v[228:231], v[152:155], v[64:67]
    ds_read_u16_d16_hi v193, v193
    v_rcp_f16_sdwa v189, v189 dst_sel:WORD_1 dst_unused:UNUSED_PRESERVE src0_sel:WORD_1
    v_mfma_f32_16x16x32_bf16 v[72:75], v[228:231], v[156:159], v[72:75]
    ds_read_b64_tr_b16 v[228:229], v255 offset:50240
    v_lshlrev_b32_sdwa v195, 1, v195 dst_sel:DWORD dst_unused:UNUSED_PAD src0_sel:DWORD src1_sel:WORD_1
    v_or_b32 v164, v180, v181
    v_mfma_f32_16x16x32_bf16 v[208:211], v[232:235], v[16:19], v[208:211]
    ds_read_b64_tr_b16 v[230:231], v255 offset:51008
    v_rcp_f16_sdwa v191, v191 dst_sel:WORD_1 dst_unused:UNUSED_PRESERVE src0_sel:WORD_1
    v_mfma_f32_16x16x32_bf16 v[212:215], v[232:235], v[20:23], v[212:215]
    ds_read_u16_d16 v194, v194
    v_lshlrev_b32_sdwa v196, 1, v196 dst_sel:DWORD dst_unused:UNUSED_PAD src0_sel:DWORD src1_sel:WORD_1
    v_fma_mixhi_f16 v206, v207, s83, 0
    v_mfma_f32_16x16x32_bf16 v[216:219], v[232:235], v[24:27], v[216:219]
    ds_read_u16_d16_hi v195, v195
    v_mfma_f32_16x16x16_bf16 v[72:75], v[242:243], v[248:249], v[72:75]
    v_lshlrev_b32_sdwa v197, 1, v197 dst_sel:DWORD dst_unused:UNUSED_PAD src0_sel:DWORD src1_sel:WORD_1
    v_fma_mix_f32 v172, v188, v189, 0 op_sel_hi:[1,1,0]
    v_mfma_f32_16x16x32_bf16 v[220:223], v[232:235], v[28:31], v[220:223]
    ds_read_b64_tr_b16 v[232:233], v254 offset:47112
    ds_read_b64_tr_b16 v[234:235], v254 offset:47368
    buffer_load_dwordx4 v[248:251], v252, s[4:7], s25 offen offset:320 sc1
    v_or_b32 v165, v182, v183
    s_waitcnt lgkmcnt(7)
    v_mfma_f32_16x16x32_bf16 v[52:55], v[236:239], v[144:147], v[52:55]
    ds_read_u16_d16 v196, v196
    v_fma_mix_f32 v173, v190, v191, 0 op_sel_hi:[1,1,0]
    v_mfma_f32_16x16x32_bf16 v[60:63], v[236:239], v[148:151], v[60:63]
    ds_read_u16_d16_hi v197, v197
    v_lshlrev_b32_sdwa v198, 1, v198 dst_sel:DWORD dst_unused:UNUSED_PAD src0_sel:DWORD src1_sel:WORD_1
    v_pk_fma_f16 v207, v206, v206, s84 neg_lo:[0,1,0] neg_hi:[0,1,0]
    v_mfma_f32_16x16x32_bf16 v[68:71], v[236:239], v[152:155], v[68:71]
    ds_read_u16_d16 v198, v198
    v_lshlrev_b32_sdwa v199, 1, v199 dst_sel:DWORD dst_unused:UNUSED_PAD src0_sel:DWORD src1_sel:WORD_1
    v_fma_mix_f32 v189, v188, v189, 0 op_sel:[1,1,0] op_sel_hi:[1,1,0]
    v_mfma_f32_16x16x32_bf16 v[76:79], v[236:239], v[156:159], v[76:79]
    ds_read_b64_tr_b16 v[236:237], v255 offset:50248
    v_or_b32_e64 v168, v184, v185
    v_fma_mix_f32 v191, v190, v191, 0 op_sel:[1,1,0] op_sel_hi:[1,1,0]
    v_mfma_f32_16x16x32_bf16 v[208:211], v[224:227], v[32:35], v[208:211]
    ds_read_b64_tr_b16 v[238:239], v255 offset:51016
    v_lshlrev_b32_sdwa v200, 1, v200 dst_sel:DWORD dst_unused:UNUSED_PAD src0_sel:DWORD src1_sel:WORD_1
    v_pk_mul_f16 v207, v207, v206
    v_mfma_f32_16x16x32_bf16 v[212:215], v[224:227], v[36:39], v[212:215]
    ds_read_u16_d16_hi v199, v199
    v_cvt_pk_bf16_f32 v172, v172, v189
    v_lshlrev_b32_sdwa v201, 1, v201 dst_sel:DWORD dst_unused:UNUSED_PAD src0_sel:DWORD src1_sel:WORD_1
    v_mfma_f32_16x16x32_bf16 v[216:219], v[224:227], v[40:43], v[216:219]
    ds_read_u16_d16 v200, v200
    v_cvt_pk_bf16_f32 v173, v173, v191
    v_or_b32_e64 v169, v186, v187
    v_mfma_f32_16x16x32_bf16 v[220:223], v[224:227], v[44:47], v[220:223]
    ds_read_b64_tr_b16 v[224:225], v254 offset:48136
    v_exp_f16_sdwa v207, v207 dst_sel:WORD_0 dst_unused:UNUSED_PRESERVE src0_sel:WORD_0
    s_waitcnt lgkmcnt(7)
    v_mfma_f32_16x16x32_bf16 v[80:83], v[228:231], v[144:147], v[80:83]
    ds_read_b64_tr_b16 v[226:227], v254 offset:48392
    v_lshlrev_b32_sdwa v202, 1, v202 dst_sel:DWORD dst_unused:UNUSED_PAD src0_sel:DWORD src1_sel:WORD_1
    v_mfma_f32_16x16x32_bf16 v[88:91], v[228:231], v[148:151], v[88:91]
    ds_read_u16_d16_hi v201, v201
    v_lshlrev_b32_sdwa v203, 1, v203 dst_sel:DWORD dst_unused:UNUSED_PAD src0_sel:DWORD src1_sel:WORD_1
    v_exp_f16_sdwa v207, v207 dst_sel:WORD_1 dst_unused:UNUSED_PRESERVE src0_sel:WORD_1
    v_mfma_f32_16x16x32_bf16 v[96:99], v[228:231], v[152:155], v[96:99]
    ds_read_u16_d16 v202, v202
    v_lshlrev_b32_sdwa v204, 1, v204 dst_sel:DWORD dst_unused:UNUSED_PAD src0_sel:DWORD src1_sel:WORD_1
    v_mfma_f32_16x16x32_bf16 v[104:107], v[228:231], v[156:159], v[104:107]
    ds_read_b64_tr_b16 v[228:229], v255 offset:50304
    ds_read_b64_tr_b16 v[230:231], v255 offset:51072
    v_lshlrev_b32_sdwa v205, 1, v205 dst_sel:DWORD dst_unused:UNUSED_PAD src0_sel:DWORD src1_sel:WORD_1
    v_pk_fma_f16 v207, v207, s85, s85
    v_mfma_f32_16x16x32_bf16 v[176:179], v[232:235], v[0:3], 0
    ds_read_u16_d16_hi v203, v203
    v_or_b32 v162, v192, v193
    v_mfma_f32_16x16x32_bf16 v[180:183], v[232:235], v[4:7], 0
    ds_read_u16_d16 v204, v204
    v_rcp_f16_sdwa v207, v207 dst_sel:WORD_0 dst_unused:UNUSED_PRESERVE src0_sel:WORD_0
    v_lshlrev_b32_sdwa v208, 1, v208 dst_sel:DWORD dst_unused:UNUSED_PAD src0_sel:DWORD src1_sel:WORD_1
    v_mfma_f32_16x16x32_bf16 v[184:187], v[232:235], v[8:11], 0
    ds_read_u16_d16_hi v205, v205
    v_fma_mixlo_f16 v220, v220, s83, 0
    v_lshlrev_b32_sdwa v209, 1, v209 dst_sel:DWORD dst_unused:UNUSED_PAD src0_sel:DWORD src1_sel:WORD_1
    v_mfma_f32_16x16x32_bf16 v[188:191], v[232:235], v[12:15], 0
    ds_read_b64_tr_b16 v[232:233], v254 offset:49160
    v_fma_mixlo_f16 v222, v222, s83, 0
    s_waitcnt lgkmcnt(7)
    v_mfma_f32_16x16x32_bf16 v[84:87], v[236:239], v[144:147], v[84:87]
    ds_read_b64_tr_b16 v[234:235], v254 offset:49416
    v_or_b32 v163, v194, v195
    v_rcp_f16_sdwa v207, v207 dst_sel:WORD_1 dst_unused:UNUSED_PRESERVE src0_sel:WORD_1
    v_mfma_f32_16x16x32_bf16 v[92:95], v[236:239], v[148:151], v[92:95]
    ds_read_u16_d16 v208, v208
    v_lshlrev_b32_sdwa v210, 1, v210 dst_sel:DWORD dst_unused:UNUSED_PAD src0_sel:DWORD src1_sel:WORD_1
    v_mfma_f32_16x16x32_bf16 v[100:103], v[236:239], v[152:155], v[100:103]
    ds_read_u16_d16_hi v209, v209
    v_fma_mixhi_f16 v220, v221, s83, 0
    v_lshlrev_b32_sdwa v211, 1, v211 dst_sel:DWORD dst_unused:UNUSED_PAD src0_sel:DWORD src1_sel:WORD_1
    v_mfma_f32_16x16x32_bf16 v[108:111], v[236:239], v[156:159], v[108:111]
    ds_read_b64_tr_b16 v[236:237], v255 offset:50312
    v_fma_mixhi_f16 v222, v223, s83, 0
    v_or_b32_e64 v166, v196, v197
    v_mfma_f32_16x16x32_bf16 v[176:179], v[224:227], v[16:19], v[176:179]
    ds_read_b64_tr_b16 v[238:239], v255 offset:51080
    v_fma_mix_f32 v175, v206, v207, 0 op_sel_hi:[1,1,0]
    v_pk_fma_f16 v221, v220, v220, s84 neg_lo:[0,1,0] neg_hi:[0,1,0]
    v_mfma_f32_16x16x32_bf16 v[180:183], v[224:227], v[20:23], v[180:183]
    ds_read_u16_d16 v210, v210
    v_lshlrev_b32_sdwa v212, 1, v212 dst_sel:DWORD dst_unused:UNUSED_PAD src0_sel:DWORD src1_sel:WORD_1
    v_mfma_f32_16x16x32_bf16 v[184:187], v[224:227], v[24:27], v[184:187]
    ds_read_u16_d16_hi v211, v211
    v_pk_fma_f16 v223, v222, v222, s84 neg_lo:[0,1,0] neg_hi:[0,1,0]
    v_lshlrev_b32_sdwa v213, 1, v213 dst_sel:DWORD dst_unused:UNUSED_PAD src0_sel:DWORD src1_sel:WORD_1
    v_mfma_f32_16x16x32_bf16 v[188:191], v[224:227], v[28:31], v[188:191]
    s_cmp_lt_u32 s19, 22
    s_cbranch_scc1 L_rd22_slow
L_rd22_go:
    ds_read_b64_tr_b16 v[224:225], v254 offset:53248
    v_fma_mix_f32 v207, v206, v207, 0 op_sel:[1,1,0] op_sel_hi:[1,1,0]
    v_or_b32 v167, v198, v199
    s_waitcnt lgkmcnt(7)
    v_mfma_f32_16x16x32_bf16 v[112:115], v[228:231], v[144:147], v[112:115]
    ds_read_b64_tr_b16 v[226:227], v254 offset:53504
    v_pk_mul_f16 v221, v221, v220
    v_pk_mul_f16 v223, v223, v222
    v_mfma_f32_16x16x32_bf16 v[120:123], v[228:231], v[148:151], v[120:123]
    ds_read_u16_d16 v212, v212
    v_lshlrev_b32_sdwa v214, 1, v214 dst_sel:DWORD dst_unused:UNUSED_PAD src0_sel:DWORD src1_sel:WORD_1
    v_cvt_pk_bf16_f32 v175, v175, v207
    v_mfma_f32_16x16x32_bf16 v[128:131], v[228:231], v[152:155], v[128:131]
    ds_read_u16_d16_hi v213, v213
    v_lshlrev_b32_sdwa v215, 1, v215 dst_sel:DWORD dst_unused:UNUSED_PAD src0_sel:DWORD src1_sel:WORD_1
    v_mfma_f32_16x16x32_bf16 v[136:139], v[228:231], v[156:159], v[136:139]
    ds_read_b64_tr_b16 v[228:229], v255 offset:56320
    v_exp_f16_sdwa v221, v221 dst_sel:WORD_0 dst_unused:UNUSED_PRESERVE src0_sel:WORD_0
    v_mfma_f32_16x16x32_bf16 v[176:179], v[232:235], v[32:35], v[176:179]
    ds_read_b64_tr_b16 v[230:231], v255 offset:57088
    v_or_b32_e64 v170, v200, v201
    v_exp_f16_sdwa v223, v223 dst_sel:WORD_0 dst_unused:UNUSED_PRESERVE src0_sel:WORD_0
    v_mfma_f32_16x16x32_bf16 v[180:183], v[232:235], v[36:39], v[180:183]
    ds_read_u16_d16 v214, v214
    v_lshlrev_b32_sdwa v216, 1, v216 dst_sel:DWORD dst_unused:UNUSED_PAD src0_sel:DWORD src1_sel:WORD_1
    v_mfma_f32_16x16x32_bf16 v[184:187], v[232:235], v[40:43], v[184:187]
    ds_read_u16_d16_hi v215, v215
    v_lshlrev_b32_sdwa v217, 1, v217 dst_sel:DWORD dst_unused:UNUSED_PAD src0_sel:DWORD src1_sel:WORD_1
    v_mfma_f32_16x16x32_bf16 v[188:191], v[232:235], v[44:47], v[188:191]
    ds_read_b64_tr_b16 v[232:233], v254 offset:54272
    v_exp_f16_sdwa v221, v221 dst_sel:WORD_1 dst_unused:UNUSED_PRESERVE src0_sel:WORD_1
    v_or_b32 v171, v202, v203
    s_waitcnt lgkmcnt(7)
    v_mfma_f32_16x16x32_bf16 v[116:119], v[236:239], v[144:147], v[116:119]
    ds_read_b64_tr_b16 v[234:235], v254 offset:54528
    v_exp_f16_sdwa v223, v223 dst_sel:WORD_1 dst_unused:UNUSED_PRESERVE src0_sel:WORD_1
    v_mfma_f32_16x16x32_bf16 v[124:127], v[236:239], v[148:151], v[124:127]
    ds_read_u16_d16 v216, v216
    v_lshlrev_b32_sdwa v218, 1, v218 dst_sel:DWORD dst_unused:UNUSED_PAD src0_sel:DWORD src1_sel:WORD_1
    v_mfma_f32_16x16x32_bf16 v[132:135], v[236:239], v[152:155], v[132:135]
    ds_read_u16_d16_hi v217, v217
    v_lshlrev_b32_sdwa v219, 1, v219 dst_sel:DWORD dst_unused:UNUSED_PAD src0_sel:DWORD src1_sel:WORD_1
    v_pk_fma_f16 v221, v221, s85, s85
    v_mfma_f32_16x16x32_bf16 v[140:143], v[236:239], v[156:159], v[140:143]
    ds_read_b64_tr_b16 v[236:237], v255 offset:56328
    v_or_b32_e64 v174, v204, v205
    v_pk_fma_f16 v223, v223, s85, s85
    v_mfma_f32_16x16x32_bf16 v[192:195], v[224:227], v[0:3], 0
    ds_read_b64_tr_b16 v[238:239], v255 offset:57096
    v_or_b32_e64 v144, v208, v209
    v_mfma_f32_16x16x32_bf16 v[196:199], v[224:227], v[4:7], 0
    ds_read_u16_d16 v218, v218
    v_rcp_f16_sdwa v221, v221 dst_sel:WORD_0 dst_unused:UNUSED_PRESERVE src0_sel:WORD_0
    v_lshlrev_b32_sdwa v176, 1, v176 dst_sel:DWORD dst_unused:UNUSED_PAD src0_sel:DWORD src1_sel:WORD_1
    v_mfma_f32_16x16x32_bf16 v[200:203], v[224:227], v[8:11], 0
    ds_read_u16_d16_hi v219, v219
    v_rcp_f16_sdwa v223, v223 dst_sel:WORD_0 dst_unused:UNUSED_PRESERVE src0_sel:WORD_0
    v_mfma_f32_16x16x32_bf16 v[204:207], v[224:227], v[12:15], 0
    ds_read_b64_tr_b16 v[224:225], v254 offset:55296
    v_lshlrev_b32_sdwa v177, 1, v177 dst_sel:DWORD dst_unused:UNUSED_PAD src0_sel:DWORD src1_sel:WORD_1
    s_waitcnt lgkmcnt(7)
    v_mfma_f32_16x16x32_bf16 v[48:51], v[228:231], v[160:163], v[48:51]
    ds_read_b64_tr_b16 v[226:227], v254 offset:55552
    v_or_b32 v145, v210, v211
    v_fma_mixlo_f16 v190, v190, s83, 0
    v_mfma_f32_16x16x32_bf16 v[56:59], v[228:231], v[164:167], v[56:59]
    ds_read_u16_d16 v176, v176
    s_waitcnt vmcnt(1)
    v_mfma_f32_16x16x16_bf16 v[104:107], v[242:243], v[244:245], v[104:107]
    v_lshlrev_b32_sdwa v178, 1, v178 dst_sel:DWORD dst_unused:UNUSED_PAD src0_sel:DWORD src1_sel:WORD_1
    v_mfma_f32_16x16x32_bf16 v[64:67], v[228:231], v[168:171], v[64:67]
    ds_read_u16_d16_hi v177, v177
    v_rcp_f16_sdwa v221, v221 dst_sel:WORD_1 dst_unused:UNUSED_PRESERVE src0_sel:WORD_1
    v_mfma_f32_16x16x32_bf16 v[72:75], v[228:231], v[172:175], v[72:75]
    ds_read_b64_tr_b16 v[228:229], v255 offset:56384
    v_mfma_f32_16x16x16_bf16 v[108:111], v[242:243], v[246:247], v[108:111]
    v_lshlrev_b32_sdwa v179, 1, v179 dst_sel:DWORD dst_unused:UNUSED_PAD src0_sel:DWORD src1_sel:WORD_1
    v_or_b32 v148, v212, v213
    v_mfma_f32_16x16x32_bf16 v[192:195], v[232:235], v[16:19], v[192:195]
    ds_read_b64_tr_b16 v[230:231], v255 offset:57152
    v_rcp_f16_sdwa v223, v223 dst_sel:WORD_1 dst_unused:UNUSED_PRESERVE src0_sel:WORD_1
    v_mfma_f32_16x16x32_bf16 v[196:199], v[232:235], v[20:23], v[196:199]
    ds_read_u16_d16 v178, v178
    v_lshlrev_b32_sdwa v180, 1, v180 dst_sel:DWORD dst_unused:UNUSED_PAD src0_sel:DWORD src1_sel:WORD_1
    v_mfma_f32_16x16x32_bf16 v[200:203], v[232:235], v[24:27], v[200:203]
    ds_read_u16_d16_hi v179, v179
    v_fma_mixhi_f16 v190, v191, s83, 0
    v_lshlrev_b32_sdwa v181, 1, v181 dst_sel:DWORD dst_unused:UNUSED_PAD src0_sel:DWORD src1_sel:WORD_1
    v_mfma_f32_16x16x32_bf16 v[204:207], v[232:235], v[28:31], v[204:207]
    ds_read_b64_tr_b16 v[232:233], v254 offset:53256
    ds_read_b64_tr_b16 v[234:235], v254 offset:53512
    v_fma_mix_f32 v156, v220, v221, 0 op_sel_hi:[1,1,0]
    v_or_b32 v149, v214, v215
    s_waitcnt lgkmcnt(7)
    v_mfma_f32_16x16x32_bf16 v[52:55], v[236:239], v[160:163], v[52:55]
    ds_read_u16_d16 v180, v180
    v_fma_mix_f32 v157, v222, v223, 0 op_sel_hi:[1,1,0]
    v_lshlrev_b32_sdwa v182, 1, v182 dst_sel:DWORD dst_unused:UNUSED_PAD src0_sel:DWORD src1_sel:WORD_1
    v_mfma_f32_16x16x32_bf16 v[60:63], v[236:239], v[164:167], v[60:63]
    ds_read_u16_d16_hi v181, v181
    v_pk_fma_f16 v191, v190, v190, s84 neg_lo:[0,1,0] neg_hi:[0,1,0]
    v_lshlrev_b32_sdwa v183, 1, v183 dst_sel:DWORD dst_unused:UNUSED_PAD src0_sel:DWORD src1_sel:WORD_1
    v_mfma_f32_16x16x32_bf16 v[68:71], v[236:239], v[168:171], v[68:71]
    ds_read_u16_d16 v182, v182
    v_fma_mix_f32 v221, v220, v221, 0 op_sel:[1,1,0] op_sel_hi:[1,1,0]
    v_or_b32_e64 v152, v216, v217
    v_mfma_f32_16x16x32_bf16 v[76:79], v[236:239], v[172:175], v[76:79]
    ds_read_b64_tr_b16 v[236:237], v255 offset:56392
    v_fma_mix_f32 v223, v222, v223, 0 op_sel:[1,1,0] op_sel_hi:[1,1,0]
    v_mfma_f32_16x16x32_bf16 v[192:195], v[224:227], v[32:35], v[192:195]
    ds_read_b64_tr_b16 v[238:239], v255 offset:57160
    v_lshlrev_b32_sdwa v184, 1, v184 dst_sel:DWORD dst_unused:UNUSED_PAD src0_sel:DWORD src1_sel:WORD_1
    v_pk_mul_f16 v191, v191, v190
    v_mfma_f32_16x16x32_bf16 v[196:199], v[224:227], v[36:39], v[196:199]
    ds_read_u16_d16_hi v183, v183
    v_cvt_pk_bf16_f32 v156, v156, v221
    v_lshlrev_b32_sdwa v185, 1, v185 dst_sel:DWORD dst_unused:UNUSED_PAD src0_sel:DWORD src1_sel:WORD_1
    v_mfma_f32_16x16x32_bf16 v[200:203], v[224:227], v[40:43], v[200:203]
    ds_read_u16_d16 v184, v184
    v_cvt_pk_bf16_f32 v157, v157, v223
    v_or_b32_e64 v153, v218, v219
    v_mfma_f32_16x16x32_bf16 v[204:207], v[224:227], v[44:47], v[204:207]
    ds_read_b64_tr_b16 v[224:225], v254 offset:54280
    v_exp_f16_sdwa v191, v191 dst_sel:WORD_0 dst_unused:UNUSED_PRESERVE src0_sel:WORD_0
    s_waitcnt lgkmcnt(7)
    v_mfma_f32_16x16x32_bf16 v[80:83], v[228:231], v[160:163], v[80:83]
    ds_read_b64_tr_b16 v[226:227], v254 offset:54536
    v_lshlrev_b32_sdwa v186, 1, v186 dst_sel:DWORD dst_unused:UNUSED_PAD src0_sel:DWORD src1_sel:WORD_1
    v_lshlrev_b32_sdwa v187, 1, v187 dst_sel:DWORD dst_unused:UNUSED_PAD src0_sel:DWORD src1_sel:WORD_1
    v_mfma_f32_16x16x32_bf16 v[88:91], v[228:231], v[164:167], v[88:91]
    ds_read_u16_d16_hi v185, v185
    v_exp_f16_sdwa v191, v191 dst_sel:WORD_1 dst_unused:UNUSED_PRESERVE src0_sel:WORD_1
    v_mfma_f32_16x16x32_bf16 v[96:99], v[228:231], v[168:171], v[96:99]
    ds_read_u16_d16 v186, v186
    v_lshlrev_b32_sdwa v188, 1, v188 dst_sel:DWORD dst_unused:UNUSED_PAD src0_sel:DWORD src1_sel:WORD_1
    v_mfma_f32_16x16x32_bf16 v[104:107], v[228:231], v[172:175], v[104:107]
    ds_read_b64_tr_b16 v[228:229], v255 offset:56448
    ds_read_b64_tr_b16 v[230:231], v255 offset:57216
    v_lshlrev_b32_sdwa v189, 1, v189 dst_sel:DWORD dst_unused:UNUSED_PAD src0_sel:DWORD src1_sel:WORD_1
    v_pk_fma_f16 v191, v191, s85, s85
    v_mfma_f32_16x16x32_bf16 v[208:211], v[232:235], v[0:3], 0
    ds_read_u16_d16_hi v187, v187
    v_or_b32 v146, v176, v177
    v_mfma_f32_16x16x32_bf16 v[212:215], v[232:235], v[4:7], 0
    ds_read_u16_d16 v188, v188
    v_rcp_f16_sdwa v191, v191 dst_sel:WORD_0 dst_unused:UNUSED_PRESERVE src0_sel:WORD_0
    v_lshlrev_b32_sdwa v192, 1, v192 dst_sel:DWORD dst_unused:UNUSED_PAD src0_sel:DWORD src1_sel:WORD_1
    v_mfma_f32_16x16x32_bf16 v[216:219], v[232:235], v[8:11], 0
    ds_read_u16_d16_hi v189, v189
    v_fma_mixlo_f16 v204, v204, s83, 0
    v_lshlrev_b32_sdwa v193, 1, v193 dst_sel:DWORD dst_unused:UNUSED_PAD src0_sel:DWORD src1_sel:WORD_1
    v_mfma_f32_16x16x32_bf16 v[220:223], v[232:235], v[12:15], 0
    ds_read_b64_tr_b16 v[232:233], v254 offset:55304
    v_fma_mixlo_f16 v206, v206, s83, 0
    v_or_b32 v147, v178, v179
    s_waitcnt lgkmcnt(7)
    v_mfma_f32_16x16x32_bf16 v[84:87], v[236:239], v[160:163], v[84:87]
    ds_read_b64_tr_b16 v[234:235], v254 offset:55560
    v_rcp_f16_sdwa v191, v191 dst_sel:WORD_1 dst_unused:UNUSED_PRESERVE src0_sel:WORD_1
    v_mfma_f32_16x16x32_bf16 v[92:95], v[236:239], v[164:167], v[92:95]
    ds_read_u16_d16 v192, v192
    s_waitcnt vmcnt(0)
    v_mfma_f32_16x16x16_bf16 v[136:139], v[242:243], v[248:249], v[136:139]
    v_mfma_f32_16x16x32_bf16 v[100:103], v[236:239], v[168:171], v[100:103]
    ds_read_u16_d16_hi v193, v193
    v_lshlrev_b32_sdwa v194, 1, v194 dst_sel:DWORD dst_unused:UNUSED_PAD src0_sel:DWORD src1_sel:WORD_1
    v_fma_mixhi_f16 v204, v205, s83, 0
    v_mfma_f32_16x16x32_bf16 v[108:111], v[236:239], v[172:175], v[108:111]
    ds_read_b64_tr_b16 v[236:237], v255 offset:56456
    v_mfma_f32_16x16x16_bf16 v[140:143], v[242:243], v[250:251], v[140:143]
    v_lshlrev_b32_sdwa v195, 1, v195 dst_sel:DWORD dst_unused:UNUSED_PAD src0_sel:DWORD src1_sel:WORD_1
    v_fma_mixhi_f16 v206, v207, s83, 0
    v_mfma_f32_16x16x32_bf16 v[208:211], v[224:227], v[16:19], v[208:211]
    ds_read_b64_tr_b16 v[238:239], v255 offset:57224
    v_or_b32 v150, v180, v181
    v_fma_mix_f32 v159, v190, v191, 0 op_sel_hi:[1,1,0]
    v_mfma_f32_16x16x32_bf16 v[212:215], v[224:227], v[20:23], v[212:215]
    ds_read_u16_d16 v194, v194
    v_pk_fma_f16 v205, v204, v204, s84 neg_lo:[0,1,0] neg_hi:[0,1,0]
    v_lshlrev_b32_sdwa v196, 1, v196 dst_sel:DWORD dst_unused:UNUSED_PAD src0_sel:DWORD src1_sel:WORD_1
    v_mfma_f32_16x16x32_bf16 v[216:219], v[224:227], v[24:27], v[216:219]
    ds_read_u16_d16_hi v195, v195
    v_pk_fma_f16 v207, v206, v206, s84 neg_lo:[0,1,0] neg_hi:[0,1,0]
    v_lshlrev_b32_sdwa v197, 1, v197 dst_sel:DWORD dst_unused:UNUSED_PAD src0_sel:DWORD src1_sel:WORD_1
    v_mfma_f32_16x16x32_bf16 v[220:223], v[224:227], v[28:31], v[220:223]
    s_cmp_lt_u32 s19, 25
    s_cbranch_scc1 L_rd25_slow
L_rd25_go:
    ds_read_b64_tr_b16 v[224:225], v255 offset:59392
    v_fma_mix_f32 v191, v190, v191, 0 op_sel:[1,1,0] op_sel_hi:[1,1,0]
    v_or_b32 v151, v182, v183
    s_waitcnt lgkmcnt(7)
    v_mfma_f32_16x16x32_bf16 v[112:115], v[228:231], v[160:163], v[112:115]
    ds_read_b64_tr_b16 v[226:227], v255 offset:60160
    v_pk_mul_f16 v205, v205, v204
    v_mfma_f32_16x16x32_bf16 v[120:123], v[228:231], v[164:167], v[120:123]
    ds_read_u16_d16 v196, v196
    v_pk_mul_f16 v207, v207, v206
    v_lshlrev_b32_sdwa v198, 1, v198 dst_sel:DWORD dst_unused:UNUSED_PAD src0_sel:DWORD src1_sel:WORD_1
    v_mfma_f32_16x16x32_bf16 v[128:131], v[228:231], v[168:171], v[128:131]
    ds_read_u16_d16_hi v197, v197
    v_cvt_pk_bf16_f32 v159, v159, v191
    v_lshlrev_b32_sdwa v199, 1, v199 dst_sel:DWORD dst_unused:UNUSED_PAD src0_sel:DWORD src1_sel:WORD_1
    v_mfma_f32_16x16x32_bf16 v[136:139], v[228:231], v[172:175], v[136:139]
    ds_read_b64_tr_b16 v[228:229], v255 offset:59400
    v_exp_f16_sdwa v205, v205 dst_sel:WORD_0 dst_unused:UNUSED_PRESERVE src0_sel:WORD_0
    v_mfma_f32_16x16x32_bf16 v[208:211], v[232:235], v[32:35], v[208:211]
    ds_read_b64_tr_b16 v[230:231], v255 offset:60168
    v_or_b32_e64 v154, v184, v185
    v_mfma_f32_16x16x32_bf16 v[212:215], v[232:235], v[36:39], v[212:215]
    ds_read_u16_d16 v198, v198
    v_exp_f16_sdwa v207, v207 dst_sel:WORD_0 dst_unused:UNUSED_PRESERVE src0_sel:WORD_0
    v_lshlrev_b32_sdwa v200, 1, v200 dst_sel:DWORD dst_unused:UNUSED_PAD src0_sel:DWORD src1_sel:WORD_1
    v_mfma_f32_16x16x32_bf16 v[216:219], v[232:235], v[40:43], v[216:219]
    ds_read_u16_d16_hi v199, v199
    v_lshlrev_b32_sdwa v201, 1, v201 dst_sel:DWORD dst_unused:UNUSED_PAD src0_sel:DWORD src1_sel:WORD_1
    v_mfma_f32_16x16x32_bf16 v[220:223], v[232:235], v[44:47], v[220:223]
    ds_read_b64_tr_b16 v[232:233], v255 offset:59456
    v_exp_f16_sdwa v205, v205 dst_sel:WORD_1 dst_unused:UNUSED_PRESERVE src0_sel:WORD_1
    v_or_b32 v155, v186, v187
    s_waitcnt lgkmcnt(7)
    v_mfma_f32_16x16x32_bf16 v[116:119], v[236:239], v[160:163], v[116:119]
    ds_read_b64_tr_b16 v[234:235], v255 offset:60224
    v_exp_f16_sdwa v207, v207 dst_sel:WORD_1 dst_unused:UNUSED_PRESERVE src0_sel:WORD_1
    v_mfma_f32_16x16x32_bf16 v[124:127], v[236:239], v[164:167], v[124:127]
    ds_read_u16_d16 v200, v200
    v_lshlrev_b32_sdwa v202, 1, v202 dst_sel:DWORD dst_unused:UNUSED_PAD src0_sel:DWORD src1_sel:WORD_1
    v_mfma_f32_16x16x32_bf16 v[132:135], v[236:239], v[168:171], v[132:135]
    ds_read_u16_d16_hi v201, v201
    v_lshlrev_b32_sdwa v203, 1, v203 dst_sel:DWORD dst_unused:UNUSED_PAD src0_sel:DWORD src1_sel:WORD_1
    v_pk_fma_f16 v205, v205, s85, s85
    v_mfma_f32_16x16x32_bf16 v[140:143], v[236:239], v[172:175], v[140:143]
    ds_read_b64_tr_b16 v[236:237], v255 offset:59464
    v_or_b32_e64 v158, v188, v189
    v_pk_fma_f16 v207, v207, s85, s85
    v_mfma_f32_16x16x32_bf16 v[48:51], v[224:227], v[144:147], v[48:51]
    ds_read_b64_tr_b16 v[238:239], v255 offset:60232
    s_waitcnt vmcnt(0)
    v_lshrrev_b32 v244, 7, v253
    v_mul_u32_u24 v244, 640, v244
    v_add_u32_e64 v244, v244, v253
    v_add_u32 v245, 196608, v244
    buffer_load_dwordx4 v[16:19], v244, s[8:11], s36 offen offset:0
    v_mfma_f32_16x16x32_bf16 v[56:59], v[224:227], v[148:151], v[56:59]
    ds_read_u16_d16 v202, v202
    ds_read_u16_d16_hi v203, v203
    buffer_load_dwordx4 v[20:23], v244, s[8:11], s36 offen offset:128
    v_or_b32_e64 v160, v192, v193
    v_rcp_f16_sdwa v205, v205 dst_sel:WORD_0 dst_unused:UNUSED_PRESERVE src0_sel:WORD_0
    v_mfma_f32_16x16x32_bf16 v[64:67], v[224:227], v[152:155], v[64:67]
    buffer_load_dwordx4 v[24:27], v244, s[8:11], s36 offen offset:256
    v_lshlrev_b32_sdwa v208, 1, v208 dst_sel:DWORD dst_unused:UNUSED_PAD src0_sel:DWORD src1_sel:WORD_1
    v_rcp_f16_sdwa v207, v207 dst_sel:WORD_0 dst_unused:UNUSED_PRESERVE src0_sel:WORD_0
    v_lshlrev_b32_sdwa v209, 1, v209 dst_sel:DWORD dst_unused:UNUSED_PAD src0_sel:DWORD src1_sel:WORD_1
    v_mfma_f32_16x16x32_bf16 v[72:75], v[224:227], v[156:159], v[72:75]
    ds_read_b64_tr_b16 v[224:225], v255 offset:59520
    buffer_load_dwordx4 v[28:31], v244, s[8:11], s37 offen offset:0
    v_or_b32_e64 v161, v194, v195
    v_fma_mixlo_f16 v222, v222, s83, 0
    v_lshlrev_b32_sdwa v210, 1, v210 dst_sel:DWORD dst_unused:UNUSED_PAD src0_sel:DWORD src1_sel:WORD_1
    v_rcp_f16_sdwa v205, v205 dst_sel:WORD_1 dst_unused:UNUSED_PRESERVE src0_sel:WORD_1
    s_waitcnt lgkmcnt(7)
    v_mfma_f32_16x16x32_bf16 v[52:55], v[228:231], v[144:147], v[52:55]
    ds_read_b64_tr_b16 v[226:227], v255 offset:60288
    ds_read_u16_d16 v208, v208
    buffer_load_dwordx4 v[32:35], v244, s[8:11], s37 offen offset:128
    v_lshlrev_b32_sdwa v211, 1, v211 dst_sel:DWORD dst_unused:UNUSED_PAD src0_sel:DWORD src1_sel:WORD_1
    v_or_b32 v164, v196, v197
    v_rcp_f16_sdwa v207, v207 dst_sel:WORD_1 dst_unused:UNUSED_PRESERVE src0_sel:WORD_1
    v_mfma_f32_16x16x32_bf16 v[60:63], v[228:231], v[148:151], v[60:63]
    ds_read_u16_d16_hi v209, v209
    ds_read_u16_d16 v210, v210
    buffer_load_dwordx4 v[36:39], v244, s[8:11], s37 offen offset:256
    v_lshlrev_b32_sdwa v212, 1, v212 dst_sel:DWORD dst_unused:UNUSED_PAD src0_sel:DWORD src1_sel:WORD_1
    v_fma_mixhi_f16 v222, v223, s83, 0
    v_lshlrev_b32_sdwa v213, 1, v213 dst_sel:DWORD dst_unused:UNUSED_PAD src0_sel:DWORD src1_sel:WORD_1
    v_mfma_f32_16x16x32_bf16 v[68:71], v[228:231], v[152:155], v[68:71]
    ds_read_u16_d16_hi v211, v211
    buffer_load_dwordx4 v[40:43], v245, s[8:11], s36 offen offset:0
    v_fma_mix_f32 v172, v204, v205, 0 op_sel_hi:[1,1,0]
    v_or_b32_e64 v165, v198, v199
    v_fma_mix_f32 v173, v206, v207, 0 op_sel_hi:[1,1,0]
    v_lshlrev_b32_sdwa v214, 1, v214 dst_sel:DWORD dst_unused:UNUSED_PAD src0_sel:DWORD src1_sel:WORD_1
    v_mfma_f32_16x16x32_bf16 v[76:79], v[228:231], v[156:159], v[76:79]
    ds_read_b64_tr_b16 v[228:229], v255 offset:59528
    ds_read_b64_tr_b16 v[230:231], v255 offset:60296
    ds_read_u16_d16 v212, v212
    buffer_load_dwordx4 v[44:47], v245, s[8:11], s36 offen offset:128
    v_pk_fma_f16 v223, v222, v222, s84 neg_lo:[0,1,0] neg_hi:[0,1,0]
    v_lshlrev_b32_sdwa v215, 1, v215 dst_sel:DWORD dst_unused:UNUSED_PAD src0_sel:DWORD src1_sel:WORD_1
    v_fma_mix_f32 v205, v204, v205, 0 op_sel:[1,1,0] op_sel_hi:[1,1,0]
    s_waitcnt lgkmcnt(7)
    v_or_b32 v168, v200, v201
    v_mfma_f32_16x16x32_bf16 v[80:83], v[232:235], v[144:147], v[80:83]
    ds_read_u16_d16_hi v213, v213
    ds_read_u16_d16 v214, v214
    buffer_load_dwordx4 v[0:3], v245, s[8:11], s36 offen offset:256
    v_fma_mix_f32 v207, v206, v207, 0 op_sel:[1,1,0] op_sel_hi:[1,1,0]
    v_lshlrev_b32_sdwa v216, 1, v216 dst_sel:DWORD dst_unused:UNUSED_PAD src0_sel:DWORD src1_sel:WORD_1
    v_pk_mul_f16 v223, v223, v222
    v_cvt_pk_bf16_f32 v172, v172, v205
    v_mfma_f32_16x16x32_bf16 v[88:91], v[232:235], v[148:151], v[88:91]
    ds_read_u16_d16_hi v215, v215
    buffer_load_dwordx4 v[4:7], v245, s[8:11], s37 offen offset:0
    v_lshlrev_b32_sdwa v217, 1, v217 dst_sel:DWORD dst_unused:UNUSED_PAD src0_sel:DWORD src1_sel:WORD_1
    v_cvt_pk_bf16_f32 v173, v173, v207
    v_or_b32_e64 v169, v202, v203
    v_exp_f16_sdwa v223, v223 dst_sel:WORD_0 dst_unused:UNUSED_PRESERVE src0_sel:WORD_0
    v_mfma_f32_16x16x32_bf16 v[96:99], v[232:235], v[152:155], v[96:99]
    ds_read_u16_d16 v216, v216
    ds_read_u16_d16_hi v217, v217
    buffer_load_dwordx4 v[8:11], v245, s[8:11], s37 offen offset:128
    v_lshlrev_b32_sdwa v218, 1, v218 dst_sel:DWORD dst_unused:UNUSED_PAD src0_sel:DWORD src1_sel:WORD_1
    v_lshlrev_b32_sdwa v219, 1, v219 dst_sel:DWORD dst_unused:UNUSED_PAD src0_sel:DWORD src1_sel:WORD_1
    v_exp_f16_sdwa v223, v223 dst_sel:WORD_1 dst_unused:UNUSED_PRESERVE src0_sel:WORD_1
    v_mfma_f32_16x16x32_bf16 v[104:107], v[232:235], v[156:159], v[104:107]
    ds_read_b64_tr_b16 v[232:233], v255 offset:62464
    ds_read_b64_tr_b16 v[234:235], v255 offset:63232
    buffer_load_dwordx4 v[12:15], v245, s[8:11], s37 offen offset:256
    v_lshlrev_b32_sdwa v220, 1, v220 dst_sel:DWORD dst_unused:UNUSED_PAD src0_sel:DWORD src1_sel:WORD_1
    v_lshlrev_b32_sdwa v221, 1, v221 dst_sel:DWORD dst_unused:UNUSED_PAD src0_sel:DWORD src1_sel:WORD_1
    v_pk_fma_f16 v223, v223, s85, s85
    v_mfma_f32_16x16x32_bf16 v[84:87], v[236:239], v[144:147], v[84:87]
    ds_read_u16_d16 v218, v218
    s_waitcnt lgkmcnt(7)
    v_or_b32 v162, v208, v209
    v_mfma_f32_16x16x32_bf16 v[92:95], v[236:239], v[148:151], v[92:95]
    ds_read_u16_d16_hi v219, v219
    v_rcp_f16_sdwa v223, v223 dst_sel:WORD_0 dst_unused:UNUSED_PRESERVE src0_sel:WORD_0
    v_or_b32_e64 v163, v210, v211
    v_mfma_f32_16x16x32_bf16 v[100:103], v[236:239], v[152:155], v[100:103]
    ds_read_u16_d16 v220, v220
    v_bfe_u32 v244, v253, 4, 3
    v_mul_u32_u24 v244, 768, v244
    v_bfe_u32 v245, v253, 7, 1
    v_lshl_add_u32 v244, v245, 6, v244
    v_lshrrev_b32_e64 v245, 8, v253
    v_lshl_add_u32 v244, v245, 4, v244
    v_add_u32_e64 v244, s35, v244
    v_xor_b32 v245, 196608, v244
    v_mfma_f32_16x16x32_bf16 v[108:111], v[236:239], v[156:159], v[108:111]
    ds_read_b64_tr_b16 v[236:237], v255 offset:62472
    v_mfma_f32_16x16x32_bf16 v[112:115], v[224:227], v[144:147], v[112:115]
    ds_read_b64_tr_b16 v[238:239], v255 offset:63240
    v_mfma_f32_16x16x32_bf16 v[120:123], v[224:227], v[148:151], v[120:123]
    ds_read_u16_d16_hi v221, v221
    v_mfma_f32_16x16x32_bf16 v[128:131], v[224:227], v[152:155], v[128:131]
    v_or_b32_e64 v166, v212, v213
    v_mfma_f32_16x16x32_bf16 v[136:139], v[224:227], v[156:159], v[136:139]
    ds_read_b64_tr_b16 v[224:225], v255 offset:62528
    v_rcp_f16_sdwa v223, v223 dst_sel:WORD_1 dst_unused:UNUSED_PRESERVE src0_sel:WORD_1
    v_mfma_f32_16x16x32_bf16 v[116:119], v[228:231], v[144:147], v[116:119]
    ds_read_b64_tr_b16 v[226:227], v255 offset:63296
    s_waitcnt lgkmcnt(7)
    v_or_b32 v167, v214, v215
    v_or_b32_e64 v170, v216, v217
    v_mfma_f32_16x16x32_bf16 v[124:127], v[228:231], v[148:151], v[124:127]
    v_fma_mix_f32 v175, v222, v223, 0 op_sel_hi:[1,1,0]
    v_mfma_f32_16x16x32_bf16 v[132:135], v[228:231], v[152:155], v[132:135]
    s_waitcnt lgkmcnt(6)
    v_or_b32 v171, v218, v219
    v_fma_mix_f32 v223, v222, v223, 0 op_sel:[1,1,0] op_sel_hi:[1,1,0]
    v_mfma_f32_16x16x32_bf16 v[140:143], v[228:231], v[156:159], v[140:143]
    ds_read_b64_tr_b16 v[228:229], v255 offset:62536
    s_waitcnt lgkmcnt(3)
    v_or_b32 v174, v220, v221
    v_cvt_pk_bf16_f32 v175, v175, v223
    v_mfma_f32_16x16x32_bf16 v[48:51], v[232:235], v[160:163], v[48:51]
    ds_read_b64_tr_b16 v[230:231], v255 offset:63304
    v_mfma_f32_16x16x32_bf16 v[56:59], v[232:235], v[164:167], v[56:59]
    v_mfma_f32_16x16x32_bf16 v[64:67], v[232:235], v[168:171], v[64:67]
    v_mfma_f32_16x16x32_bf16 v[72:75], v[232:235], v[172:175], v[72:75]
    ds_read_b64_tr_b16 v[232:233], v255 offset:62592
    v_mfma_f32_16x16x32_bf16 v[52:55], v[236:239], v[160:163], v[52:55]
    ds_read_b64_tr_b16 v[234:235], v255 offset:63360
    v_mfma_f32_16x16x32_bf16 v[60:63], v[236:239], v[164:167], v[60:63]
    v_mfma_f32_16x16x32_bf16 v[68:71], v[236:239], v[168:171], v[68:71]
    v_mfma_f32_16x16x32_bf16 v[76:79], v[236:239], v[172:175], v[76:79]
    ds_read_b64_tr_b16 v[236:237], v255 offset:62600
    s_waitcnt lgkmcnt(5)
    v_mfma_f32_16x16x32_bf16 v[80:83], v[224:227], v[160:163], v[80:83]
    ds_read_b64_tr_b16 v[238:239], v255 offset:63368
    v_mfma_f32_16x16x32_bf16 v[88:91], v[224:227], v[164:167], v[88:91]
    v_mfma_f32_16x16x32_bf16 v[96:99], v[224:227], v[168:171], v[96:99]
    v_mfma_f32_16x16x32_bf16 v[104:107], v[224:227], v[172:175], v[104:107]
    s_waitcnt lgkmcnt(4)
    v_mfma_f32_16x16x32_bf16 v[84:87], v[228:231], v[160:163], v[84:87]
    v_cvt_pk_bf16_f32 v48, v48, v49
    v_cvt_pk_bf16_f32 v49, v50, v51
    v_cvt_pk_bf16_f32 v50, v52, v53
    v_cvt_pk_bf16_f32 v51, v54, v55
    v_mfma_f32_16x16x32_bf16 v[92:95], v[228:231], v[164:167], v[92:95]
    v_cvt_pk_bf16_f32 v56, v56, v57
    v_cvt_pk_bf16_f32 v57, v58, v59
    v_cvt_pk_bf16_f32 v58, v60, v61
    v_cvt_pk_bf16_f32 v59, v62, v63
    v_mfma_f32_16x16x32_bf16 v[100:103], v[228:231], v[168:171], v[100:103]
    v_cvt_pk_bf16_f32 v64, v64, v65
    v_cvt_pk_bf16_f32 v65, v66, v67
    v_cvt_pk_bf16_f32 v66, v68, v69
    v_cvt_pk_bf16_f32 v67, v70, v71
    v_mfma_f32_16x16x32_bf16 v[108:111], v[228:231], v[172:175], v[108:111]
    v_cvt_pk_bf16_f32 v72, v72, v73
    v_cvt_pk_bf16_f32 v73, v74, v75
    v_cvt_pk_bf16_f32 v74, v76, v77
    v_cvt_pk_bf16_f32 v75, v78, v79
    s_waitcnt lgkmcnt(2)
    v_mfma_f32_16x16x32_bf16 v[112:115], v[232:235], v[160:163], v[112:115]
    v_mfma_f32_16x16x32_bf16 v[120:123], v[232:235], v[164:167], v[120:123]
    v_mfma_f32_16x16x32_bf16 v[128:131], v[232:235], v[168:171], v[128:131]
    v_mfma_f32_16x16x32_bf16 v[136:139], v[232:235], v[172:175], v[136:139]
    s_waitcnt lgkmcnt(0)
    v_mfma_f32_16x16x32_bf16 v[116:119], v[236:239], v[160:163], v[116:119]
    v_cvt_pk_bf16_f32 v80, v80, v81
    v_cvt_pk_bf16_f32 v81, v82, v83
    v_cvt_pk_bf16_f32 v82, v84, v85
    v_cvt_pk_bf16_f32 v83, v86, v87
    v_mfma_f32_16x16x32_bf16 v[124:127], v[236:239], v[164:167], v[124:127]
    v_cvt_pk_bf16_f32 v88, v88, v89
    v_cvt_pk_bf16_f32 v89, v90, v91
    v_cvt_pk_bf16_f32 v90, v92, v93
    v_cvt_pk_bf16_f32 v91, v94, v95
    v_mfma_f32_16x16x32_bf16 v[132:135], v[236:239], v[168:171], v[132:135]
    v_cvt_pk_bf16_f32 v96, v96, v97
    v_cvt_pk_bf16_f32 v97, v98, v99
    v_cvt_pk_bf16_f32 v98, v100, v101
    v_cvt_pk_bf16_f32 v99, v102, v103
    v_mfma_f32_16x16x32_bf16 v[140:143], v[236:239], v[172:175], v[140:143]
    v_cvt_pk_bf16_f32 v104, v104, v105
    v_cvt_pk_bf16_f32 v105, v106, v107
    v_cvt_pk_bf16_f32 v106, v108, v109
    v_cvt_pk_bf16_f32 v107, v110, v111
    v_mov_b32 v52, v48
    v_mov_b32 v53, v49
    v_mov_b32 v54, v50
    v_mov_b32 v55, v51
    v_mov_b32_dpp v48, v80 row_ror:8 row_mask:0xf bank_mask:0xc
    v_mov_b32_dpp v49, v81 row_ror:8 row_mask:0xf bank_mask:0xc
    v_mov_b32_dpp v50, v82 row_ror:8 row_mask:0xf bank_mask:0xc
    v_mov_b32_dpp v51, v83 row_ror:8 row_mask:0xf bank_mask:0xc
    v_mov_b32_dpp v80, v52 row_ror:8 row_mask:0xf bank_mask:0x3
    v_mov_b32_dpp v81, v53 row_ror:8 row_mask:0xf bank_mask:0x3
    v_mov_b32_dpp v82, v54 row_ror:8 row_mask:0xf bank_mask:0x3
    v_mov_b32_dpp v83, v55 row_ror:8 row_mask:0xf bank_mask:0x3
    buffer_store_dwordx4 v[48:51], v244, s[8:11], s24 offen offset:0 sc1
    buffer_store_dwordx4 v[80:83], v245, s[8:11], s24 offen offset:0 sc1
    v_mov_b32 v68, v64
    v_mov_b32 v69, v65
    v_mov_b32 v70, v66
    v_mov_b32 v71, v67
    v_mov_b32_dpp v64, v96 row_ror:8 row_mask:0xf bank_mask:0xc
    v_mov_b32_dpp v65, v97 row_ror:8 row_mask:0xf bank_mask:0xc
    v_mov_b32_dpp v66, v98 row_ror:8 row_mask:0xf bank_mask:0xc
    v_mov_b32_dpp v67, v99 row_ror:8 row_mask:0xf bank_mask:0xc
    v_mov_b32_dpp v96, v68 row_ror:8 row_mask:0xf bank_mask:0x3
    v_mov_b32_dpp v97, v69 row_ror:8 row_mask:0xf bank_mask:0x3
    v_mov_b32_dpp v98, v70 row_ror:8 row_mask:0xf bank_mask:0x3
    v_mov_b32_dpp v99, v71 row_ror:8 row_mask:0xf bank_mask:0x3
    buffer_store_dwordx4 v[64:67], v244, s[8:11], s25 offen offset:0 sc1
    buffer_store_dwordx4 v[96:99], v245, s[8:11], s25 offen offset:0 sc1
    v_cvt_pk_bf16_f32 v112, v112, v113
    v_cvt_pk_bf16_f32 v113, v114, v115
    v_cvt_pk_bf16_f32 v114, v116, v117
    v_cvt_pk_bf16_f32 v115, v118, v119
    v_cvt_pk_bf16_f32 v120, v120, v121
    v_cvt_pk_bf16_f32 v121, v122, v123
    v_cvt_pk_bf16_f32 v122, v124, v125
    v_cvt_pk_bf16_f32 v123, v126, v127
    v_mov_b32 v116, v112
    v_mov_b32 v117, v113
    v_mov_b32 v118, v114
    v_mov_b32 v119, v115
    v_mov_b32_dpp v112, v56 row_ror:8 row_mask:0xf bank_mask:0xc
    v_mov_b32_dpp v113, v57 row_ror:8 row_mask:0xf bank_mask:0xc
    v_mov_b32_dpp v114, v58 row_ror:8 row_mask:0xf bank_mask:0xc
    v_mov_b32_dpp v115, v59 row_ror:8 row_mask:0xf bank_mask:0xc
    v_mov_b32_dpp v56, v116 row_ror:8 row_mask:0xf bank_mask:0x3
    v_mov_b32_dpp v57, v117 row_ror:8 row_mask:0xf bank_mask:0x3
    v_mov_b32_dpp v58, v118 row_ror:8 row_mask:0xf bank_mask:0x3
    v_mov_b32_dpp v59, v119 row_ror:8 row_mask:0xf bank_mask:0x3
    buffer_store_dwordx4 v[112:115], v244, s[8:11], s24 offen offset:128 sc1
    buffer_store_dwordx4 v[56:59], v245, s[8:11], s24 offen offset:128 sc1
    v_mov_b32 v92, v88
    v_mov_b32 v93, v89
    v_mov_b32 v94, v90
    v_mov_b32 v95, v91
    v_mov_b32_dpp v88, v120 row_ror:8 row_mask:0xf bank_mask:0xc
    v_mov_b32_dpp v89, v121 row_ror:8 row_mask:0xf bank_mask:0xc
    v_mov_b32_dpp v90, v122 row_ror:8 row_mask:0xf bank_mask:0xc
    v_mov_b32_dpp v91, v123 row_ror:8 row_mask:0xf bank_mask:0xc
    v_mov_b32_dpp v120, v92 row_ror:8 row_mask:0xf bank_mask:0x3
    v_mov_b32_dpp v121, v93 row_ror:8 row_mask:0xf bank_mask:0x3
    v_mov_b32_dpp v122, v94 row_ror:8 row_mask:0xf bank_mask:0x3
    v_mov_b32_dpp v123, v95 row_ror:8 row_mask:0xf bank_mask:0x3
    buffer_store_dwordx4 v[88:91], v244, s[8:11], s24 offen offset:256 sc1
    buffer_store_dwordx4 v[120:123], v245, s[8:11], s24 offen offset:256 sc1
    v_cvt_pk_bf16_f32 v128, v128, v129
    v_cvt_pk_bf16_f32 v129, v130, v131
    v_cvt_pk_bf16_f32 v130, v132, v133
    v_cvt_pk_bf16_f32 v131, v134, v135
    v_cvt_pk_bf16_f32 v136, v136, v137
    v_cvt_pk_bf16_f32 v137, v138, v139
    v_cvt_pk_bf16_f32 v138, v140, v141
    v_cvt_pk_bf16_f32 v139, v142, v143
    v_mov_b32 v132, v128
    v_mov_b32 v133, v129
    v_mov_b32 v134, v130
    v_mov_b32 v135, v131
    v_mov_b32_dpp v128, v72 row_ror:8 row_mask:0xf bank_mask:0xc
    v_mov_b32_dpp v129, v73 row_ror:8 row_mask:0xf bank_mask:0xc
    v_mov_b32_dpp v130, v74 row_ror:8 row_mask:0xf bank_mask:0xc
    v_mov_b32_dpp v131, v75 row_ror:8 row_mask:0xf bank_mask:0xc
    v_mov_b32_dpp v72, v132 row_ror:8 row_mask:0xf bank_mask:0x3
    v_mov_b32_dpp v73, v133 row_ror:8 row_mask:0xf bank_mask:0x3
    v_mov_b32_dpp v74, v134 row_ror:8 row_mask:0xf bank_mask:0x3
    v_mov_b32_dpp v75, v135 row_ror:8 row_mask:0xf bank_mask:0x3
    buffer_store_dwordx4 v[128:131], v244, s[8:11], s25 offen offset:128 sc1
    buffer_store_dwordx4 v[72:75], v245, s[8:11], s25 offen offset:128 sc1
    v_mov_b32 v108, v104
    v_mov_b32 v109, v105
    v_mov_b32 v110, v106
    v_mov_b32 v111, v107
    v_mov_b32_dpp v104, v136 row_ror:8 row_mask:0xf bank_mask:0xc
    v_mov_b32_dpp v105, v137 row_ror:8 row_mask:0xf bank_mask:0xc
    v_mov_b32_dpp v106, v138 row_ror:8 row_mask:0xf bank_mask:0xc
    v_mov_b32_dpp v107, v139 row_ror:8 row_mask:0xf bank_mask:0xc
    v_mov_b32_dpp v136, v108 row_ror:8 row_mask:0xf bank_mask:0x3
    v_mov_b32_dpp v137, v109 row_ror:8 row_mask:0xf bank_mask:0x3
    v_mov_b32_dpp v138, v110 row_ror:8 row_mask:0xf bank_mask:0x3
    v_mov_b32_dpp v139, v111 row_ror:8 row_mask:0xf bank_mask:0x3
    buffer_store_dwordx4 v[104:107], v244, s[8:11], s25 offen offset:256 sc1
    buffer_store_dwordx4 v[136:139], v245, s[8:11], s25 offen offset:256 sc1

    s_cmp_lg_u32 s17, 0
    s_cbranch_scc1 L_end
    s_mov_b32 s17, 1
    s_mov_b32 s24, s36
    s_mov_b32 s25, s37
    s_mov_b32 s36, 1073741824
    s_mov_b32 s37, 1073741824

    s_branch L_mtile

L_rd1_slow:
    v_mov_b32 v224, 161976

    s_mov_b32 s29, 200000
L_rd1:
    ds_read_b32 v225, v224
    s_waitcnt lgkmcnt(0)
    v_cmp_le_u32 vcc, 1, v225
    s_cmp_eq_u64 vcc, exec
    s_cbranch_scc1 L_rd1_ok
    s_sleep 2
    s_sub_u32 s29, s29, 1
    s_cmp_lg_u32 s29, 0
    s_cbranch_scc1 L_rd1
L_rd1_ok:

    v_readfirstlane_b32 s19, v225
    s_min_u32 s19, s19, 24
    s_branch L_rd1_go
L_fix:
    v_lshlrev_b32 v176, 16, v0
    v_and_b32 v177, 0xffff0000, v0
    v_mul_f32 v176, s99, v176
    v_mul_f32 v177, s99, v177
    v_cvt_pk_bf16_f32 v0, v176, v177
    v_lshlrev_b32_e64 v176, 16, v1
    v_and_b32 v177, 0xffff0000, v1
    v_mul_f32 v176, s99, v176
    v_mul_f32 v177, s99, v177
    v_cvt_pk_bf16_f32 v1, v176, v177
    v_lshlrev_b32_e64 v176, 16, v2
    v_and_b32 v177, 0xffff0000, v2
    v_mul_f32 v176, s99, v176
    v_mul_f32 v177, s99, v177
    v_cvt_pk_bf16_f32 v2, v176, v177
    v_lshlrev_b32_e64 v176, 16, v3
    v_and_b32 v177, 0xffff0000, v3
    v_mul_f32 v176, s99, v176
    v_mul_f32 v177, s99, v177
    v_cvt_pk_bf16_f32 v3, v176, v177
    v_lshlrev_b32_e64 v176, 16, v4
    v_and_b32 v177, 0xffff0000, v4
    v_mul_f32 v176, s99, v176
    v_mul_f32 v177, s99, v177
    v_cvt_pk_bf16_f32 v4, v176, v177
    v_lshlrev_b32_e64 v176, 16, v5
    v_and_b32 v177, 0xffff0000, v5
    v_mul_f32 v176, s99, v176
    v_mul_f32 v177, s99, v177
    v_cvt_pk_bf16_f32 v5, v176, v177
    v_lshlrev_b32_e64 v176, 16, v6
    v_and_b32 v177, 0xffff0000, v6
    v_mul_f32 v176, s99, v176
    v_mul_f32 v177, s99, v177
    v_cvt_pk_bf16_f32 v6, v176, v177
    v_lshlrev_b32_e64 v176, 16, v7
    v_and_b32 v177, 0xffff0000, v7
    v_mul_f32 v176, s99, v176
    v_mul_f32 v177, s99, v177
    v_cvt_pk_bf16_f32 v7, v176, v177
    v_lshlrev_b32_e64 v176, 16, v8
    v_and_b32 v177, 0xffff0000, v8
    v_mul_f32 v176, s99, v176
    v_mul_f32 v177, s99, v177
    v_cvt_pk_bf16_f32 v8, v176, v177
    v_lshlrev_b32_e64 v176, 16, v9
    v_and_b32 v177, 0xffff0000, v9
    v_mul_f32 v176, s99, v176
    v_mul_f32 v177, s99, v177
    v_cvt_pk_bf16_f32 v9, v176, v177
    v_lshlrev_b32_e64 v176, 16, v10
    v_and_b32 v177, 0xffff0000, v10
    v_mul_f32 v176, s99, v176
    v_mul_f32 v177, s99, v177
    v_cvt_pk_bf16_f32 v10, v176, v177
    v_lshlrev_b32_e64 v176, 16, v11
    v_and_b32 v177, 0xffff0000, v11
    v_mul_f32 v176, s99, v176
    v_mul_f32 v177, s99, v177
    v_cvt_pk_bf16_f32 v11, v176, v177
    v_lshlrev_b32_e64 v176, 16, v12
    v_and_b32 v177, 0xffff0000, v12
    v_mul_f32 v176, s99, v176
    v_mul_f32 v177, s99, v177
    v_cvt_pk_bf16_f32 v12, v176, v177
    v_lshlrev_b32_e64 v176, 16, v13
    v_and_b32 v177, 0xffff0000, v13
    v_mul_f32 v176, s99, v176
    v_mul_f32 v177, s99, v177
    v_cvt_pk_bf16_f32 v13, v176, v177
    v_lshlrev_b32_e64 v176, 16, v14
    v_and_b32 v177, 0xffff0000, v14
    v_mul_f32 v176, s99, v176
    v_mul_f32 v177, s99, v177
    v_cvt_pk_bf16_f32 v14, v176, v177
    v_lshlrev_b32_e64 v176, 16, v15
    v_and_b32 v177, 0xffff0000, v15
    v_mul_f32 v176, s99, v176
    v_mul_f32 v177, s99, v177
    v_cvt_pk_bf16_f32 v15, v176, v177
    v_lshlrev_b32_e64 v176, 16, v16
    v_and_b32 v177, 0xffff0000, v16
    v_mul_f32 v176, s99, v176
    v_mul_f32 v177, s99, v177
    v_cvt_pk_bf16_f32 v16, v176, v177
    v_lshlrev_b32_e64 v176, 16, v17
    v_and_b32 v177, 0xffff0000, v17
    v_mul_f32 v176, s99, v176
    v_mul_f32 v177, s99, v177
    v_cvt_pk_bf16_f32 v17, v176, v177
    v_lshlrev_b32_e64 v176, 16, v18
    v_and_b32 v177, 0xffff0000, v18
    v_mul_f32 v176, s99, v176
    v_mul_f32 v177, s99, v177
    v_cvt_pk_bf16_f32 v18, v176, v177
    v_lshlrev_b32_e64 v176, 16, v19
    v_and_b32 v177, 0xffff0000, v19
    v_mul_f32 v176, s99, v176
    v_mul_f32 v177, s99, v177
    v_cvt_pk_bf16_f32 v19, v176, v177
    v_lshlrev_b32_e64 v176, 16, v20
    v_and_b32 v177, 0xffff0000, v20
    v_mul_f32 v176, s99, v176
    v_mul_f32 v177, s99, v177
    v_cvt_pk_bf16_f32 v20, v176, v177
    v_lshlrev_b32_e64 v176, 16, v21
    v_and_b32 v177, 0xffff0000, v21
    v_mul_f32 v176, s99, v176
    v_mul_f32 v177, s99, v177
    v_cvt_pk_bf16_f32 v21, v176, v177
    v_lshlrev_b32_e64 v176, 16, v22
    v_and_b32 v177, 0xffff0000, v22
    v_mul_f32 v176, s99, v176
    v_mul_f32 v177, s99, v177
    v_cvt_pk_bf16_f32 v22, v176, v177
    v_lshlrev_b32_e64 v176, 16, v23
    v_and_b32 v177, 0xffff0000, v23
    v_mul_f32 v176, s99, v176
    v_mul_f32 v177, s99, v177
    v_cvt_pk_bf16_f32 v23, v176, v177
    v_lshlrev_b32_e64 v176, 16, v24
    v_and_b32 v177, 0xffff0000, v24
    v_mul_f32 v176, s99, v176
    v_mul_f32 v177, s99, v177
    v_cvt_pk_bf16_f32 v24, v176, v177
    v_lshlrev_b32_e64 v176, 16, v25
    v_and_b32 v177, 0xffff0000, v25
    v_mul_f32 v176, s99, v176
    v_mul_f32 v177, s99, v177
    v_cvt_pk_bf16_f32 v25, v176, v177
    v_lshlrev_b32_e64 v176, 16, v26
    v_and_b32 v177, 0xffff0000, v26
    v_mul_f32 v176, s99, v176
    v_mul_f32 v177, s99, v177
    v_cvt_pk_bf16_f32 v26, v176, v177
    v_lshlrev_b32_e64 v176, 16, v27
    v_and_b32 v177, 0xffff0000, v27
    v_mul_f32 v176, s99, v176
    v_mul_f32 v177, s99, v177
    v_cvt_pk_bf16_f32 v27, v176, v177
    v_lshlrev_b32_e64 v176, 16, v28
    v_and_b32 v177, 0xffff0000, v28
    v_mul_f32 v176, s99, v176
    v_mul_f32 v177, s99, v177
    v_cvt_pk_bf16_f32 v28, v176, v177
    v_lshlrev_b32_e64 v176, 16, v29
    v_and_b32 v177, 0xffff0000, v29
    v_mul_f32 v176, s99, v176
    v_mul_f32 v177, s99, v177
    v_cvt_pk_bf16_f32 v29, v176, v177
    v_lshlrev_b32_e64 v176, 16, v30
    v_and_b32 v177, 0xffff0000, v30
    v_mul_f32 v176, s99, v176
    v_mul_f32 v177, s99, v177
    v_cvt_pk_bf16_f32 v30, v176, v177
    v_lshlrev_b32_e64 v176, 16, v31
    v_and_b32 v177, 0xffff0000, v31
    v_mul_f32 v176, s99, v176
    v_mul_f32 v177, s99, v177
    v_cvt_pk_bf16_f32 v31, v176, v177
    v_lshlrev_b32_e64 v176, 16, v32
    v_and_b32 v177, 0xffff0000, v32
    v_mul_f32 v176, s99, v176
    v_mul_f32 v177, s99, v177
    v_cvt_pk_bf16_f32 v32, v176, v177
    v_lshlrev_b32_e64 v176, 16, v33
    v_and_b32 v177, 0xffff0000, v33
    v_mul_f32 v176, s99, v176
    v_mul_f32 v177, s99, v177
    v_cvt_pk_bf16_f32 v33, v176, v177
    v_lshlrev_b32_e64 v176, 16, v34
    v_and_b32 v177, 0xffff0000, v34
    v_mul_f32 v176, s99, v176
    v_mul_f32 v177, s99, v177
    v_cvt_pk_bf16_f32 v34, v176, v177
    v_lshlrev_b32_e64 v176, 16, v35
    v_and_b32 v177, 0xffff0000, v35
    v_mul_f32 v176, s99, v176
    v_mul_f32 v177, s99, v177
    v_cvt_pk_bf16_f32 v35, v176, v177
    v_lshlrev_b32_e64 v176, 16, v36
    v_and_b32 v177, 0xffff0000, v36
    v_mul_f32 v176, s99, v176
    v_mul_f32 v177, s99, v177
    v_cvt_pk_bf16_f32 v36, v176, v177
    v_lshlrev_b32_e64 v176, 16, v37
    v_and_b32 v177, 0xffff0000, v37
    v_mul_f32 v176, s99, v176
    v_mul_f32 v177, s99, v177
    v_cvt_pk_bf16_f32 v37, v176, v177
    v_lshlrev_b32_e64 v176, 16, v38
    v_and_b32 v177, 0xffff0000, v38
    v_mul_f32 v176, s99, v176
    v_mul_f32 v177, s99, v177
    v_cvt_pk_bf16_f32 v38, v176, v177
    v_lshlrev_b32_e64 v176, 16, v39
    v_and_b32 v177, 0xffff0000, v39
    v_mul_f32 v176, s99, v176
    v_mul_f32 v177, s99, v177
    v_cvt_pk_bf16_f32 v39, v176, v177
    v_lshlrev_b32_e64 v176, 16, v40
    v_and_b32 v177, 0xffff0000, v40
    v_mul_f32 v176, s99, v176
    v_mul_f32 v177, s99, v177
    v_cvt_pk_bf16_f32 v40, v176, v177
    v_lshlrev_b32_e64 v176, 16, v41
    v_and_b32 v177, 0xffff0000, v41
    v_mul_f32 v176, s99, v176
    v_mul_f32 v177, s99, v177
    v_cvt_pk_bf16_f32 v41, v176, v177
    v_lshlrev_b32_e64 v176, 16, v42
    v_and_b32 v177, 0xffff0000, v42
    v_mul_f32 v176, s99, v176
    v_mul_f32 v177, s99, v177
    v_cvt_pk_bf16_f32 v42, v176, v177
    v_lshlrev_b32_e64 v176, 16, v43
    v_and_b32 v177, 0xffff0000, v43
    v_mul_f32 v176, s99, v176
    v_mul_f32 v177, s99, v177
    v_cvt_pk_bf16_f32 v43, v176, v177
    v_lshlrev_b32_e64 v176, 16, v44
    v_and_b32 v177, 0xffff0000, v44
    v_mul_f32 v176, s99, v176
    v_mul_f32 v177, s99, v177
    v_cvt_pk_bf16_f32 v44, v176, v177
    v_lshlrev_b32_e64 v176, 16, v45
    v_and_b32 v177, 0xffff0000, v45
    v_mul_f32 v176, s99, v176
    v_mul_f32 v177, s99, v177
    v_cvt_pk_bf16_f32 v45, v176, v177
    v_lshlrev_b32_e64 v176, 16, v46
    v_and_b32 v177, 0xffff0000, v46
    v_mul_f32 v176, s99, v176
    v_mul_f32 v177, s99, v177
    v_cvt_pk_bf16_f32 v46, v176, v177
    v_lshlrev_b32_e64 v176, 16, v47
    v_and_b32 v177, 0xffff0000, v47
    v_mul_f32 v176, s99, v176
    v_mul_f32 v177, s99, v177
    v_cvt_pk_bf16_f32 v47, v176, v177
    s_nop 1
    s_branch L_fixed
L_rd2_slow:
    v_mov_b32 v232, 161976

    s_mov_b32 s29, 200000
L_rd2:
    ds_read_b32 v233, v232
    s_waitcnt lgkmcnt(0)
    v_cmp_le_u32 vcc, 2, v233
    s_cmp_eq_u64 vcc, exec
    s_cbranch_scc1 L_rd2_ok
    s_sleep 2
    s_sub_u32 s29, s29, 1
    s_cmp_lg_u32 s29, 0
    s_cbranch_scc1 L_rd2
L_rd2_ok:

    v_readfirstlane_b32 s19, v233
    s_min_u32 s19, s19, 24
    s_branch L_rd2_go
L_rd3_slow:
    v_mov_b32 v224, 161976

    s_mov_b32 s29, 200000
L_rd3:
    ds_read_b32 v225, v224
    s_waitcnt lgkmcnt(0)
    v_cmp_le_u32 vcc, 3, v225
    s_cmp_eq_u64 vcc, exec
    s_cbranch_scc1 L_rd3_ok
    s_sleep 2
    s_sub_u32 s29, s29, 1
    s_cmp_lg_u32 s29, 0
    s_cbranch_scc1 L_rd3
L_rd3_ok:

    v_readfirstlane_b32 s19, v225
    s_min_u32 s19, s19, 24
    s_branch L_rd3_go
L_rd4_slow:
    v_mov_b32 v228, 161976

    s_mov_b32 s29, 200000
L_rd4:
    ds_read_b32 v229, v228
    s_waitcnt lgkmcnt(0)
    v_cmp_le_u32 vcc, 4, v229
    s_cmp_eq_u64 vcc, exec
    s_cbranch_scc1 L_rd4_ok
    s_sleep 2
    s_sub_u32 s29, s29, 1
    s_cmp_lg_u32 s29, 0
    s_cbranch_scc1 L_rd4
L_rd4_ok:

    v_readfirstlane_b32 s19, v229
    s_min_u32 s19, s19, 24
    s_branch L_rd4_go
L_park:
    v_mov_b32 v244, 161972

    s_mov_b32 s29, 200000
L_wi9:
    ds_read_b32 v245, v244
    s_waitcnt lgkmcnt(0)
    v_cmp_eq_u32 vcc, 9, v245
    s_cmp_eq_u64 vcc, exec
    s_cbranch_scc1 L_wi9_ok
    s_sleep 2
    s_sub_u32 s29, s29, 1
    s_cmp_lg_u32 s29, 0
    s_cbranch_scc1 L_wi9
L_wi9_ok:

    v_lshrrev_b32 v244, 7, v253
    v_mul_u32_u24 v244, 640, v244
    v_add_u32_e64 v244, v244, v253
    v_add_u32 v245, 196608, v244
    buffer_store_dwordx4 v[48:51], v244, s[8:11], s36 offen offset:0 sc1
    buffer_store_dwordx4 v[52:55], v244, s[8:11], s36 offen offset:128 sc1
    buffer_store_dwordx4 v[56:59], v244, s[8:11], s36 offen offset:256 sc1
    buffer_store_dwordx4 v[60:63], v244, s[8:11], s37 offen offset:0 sc1
    buffer_store_dwordx4 v[64:67], v244, s[8:11], s37 offen offset:128 sc1
    buffer_store_dwordx4 v[68:71], v244, s[8:11], s37 offen offset:256 sc1
    buffer_store_dwordx4 v[72:75], v245, s[8:11], s36 offen offset:0 sc1
    buffer_store_dwordx4 v[76:79], v245, s[8:11], s36 offen offset:128 sc1
    buffer_store_dwordx4 v[80:83], v245, s[8:11], s36 offen offset:256 sc1
    buffer_store_dwordx4 v[84:87], v245, s[8:11], s37 offen offset:0 sc1
    buffer_store_dwordx4 v[88:91], v245, s[8:11], s37 offen offset:128 sc1
    buffer_store_dwordx4 v[92:95], v245, s[8:11], s37 offen offset:256 sc1
    s_mov_b32 s38, 0
    s_nop 1
    s_branch L_parked
L_rd6_slow:
    v_mov_b32 v224, 161976

    s_mov_b32 s29, 200000
L_rd6:
    ds_read_b32 v225, v224
    s_waitcnt lgkmcnt(0)
    v_cmp_le_u32 vcc, 6, v225
    s_cmp_eq_u64 vcc, exec
    s_cbranch_scc1 L_rd6_ok
    s_sleep 2
    s_sub_u32 s29, s29, 1
    s_cmp_lg_u32 s29, 0
    s_cbranch_scc1 L_rd6
L_rd6_ok:

    v_readfirstlane_b32 s19, v225
    s_min_u32 s19, s19, 24
    s_branch L_rd6_go
L_rd8_slow:
    v_mov_b32 v224, 161976

    s_mov_b32 s29, 200000
L_rd8:
    ds_read_b32 v225, v224
    s_waitcnt lgkmcnt(0)
    v_cmp_le_u32 vcc, 8, v225
    s_cmp_eq_u64 vcc, exec
    s_cbranch_scc1 L_rd8_ok
    s_sleep 2
    s_sub_u32 s29, s29, 1
    s_cmp_lg_u32 s29, 0
    s_cbranch_scc1 L_rd8
L_rd8_ok:

    v_readfirstlane_b32 s19, v225
    s_min_u32 s19, s19, 24
    s_branch L_rd8_go
L_rd10_slow:
    v_mov_b32 v224, 161976

    s_mov_b32 s29, 200000
L_rd10:
    ds_read_b32 v225, v224
    s_waitcnt lgkmcnt(0)
    v_cmp_le_u32 vcc, 10, v225
    s_cmp_eq_u64 vcc, exec
    s_cbranch_scc1 L_rd10_ok
    s_sleep 2
    s_sub_u32 s29, s29, 1
    s_cmp_lg_u32 s29, 0
    s_cbranch_scc1 L_rd10
L_rd10_ok:

    v_readfirstlane_b32 s19, v225
    s_min_u32 s19, s19, 24
    s_branch L_rd10_go
L_rd12_slow:
    v_mov_b32 v224, 161976

    s_mov_b32 s29, 200000
L_rd12:
    ds_read_b32 v225, v224
    s_waitcnt lgkmcnt(0)
    v_cmp_le_u32 vcc, 12, v225
    s_cmp_eq_u64 vcc, exec
    s_cbranch_scc1 L_rd12_ok
    s_sleep 2
    s_sub_u32 s29, s29, 1
    s_cmp_lg_u32 s29, 0
    s_cbranch_scc1 L_rd12
L_rd12_ok:

    v_readfirstlane_b32 s19, v225
    s_min_u32 s19, s19, 24
    s_branch L_rd12_go
L_pu2:
    s_setprio 0
    s_branch L_pb2
L_rd14_slow:
    v_mov_b32 v224, 161976

    s_mov_b32 s29, 200000
L_rd14:
    ds_read_b32 v225, v224
    s_waitcnt lgkmcnt(0)
    v_cmp_le_u32 vcc, 14, v225
    s_cmp_eq_u64 vcc, exec
    s_cbranch_scc1 L_rd14_ok
    s_sleep 2
    s_sub_u32 s29, s29, 1
    s_cmp_lg_u32 s29, 0
    s_cbranch_scc1 L_rd14
L_rd14_ok:

    v_readfirstlane_b32 s19, v225
    s_min_u32 s19, s19, 24
    s_branch L_rd14_go
L_rd16_slow:
    v_mov_b32 v224, 161976

    s_mov_b32 s29, 200000
L_rd16:
    ds_read_b32 v225, v224
    s_waitcnt lgkmcnt(0)
    v_cmp_le_u32 vcc, 16, v225
    s_cmp_eq_u64 vcc, exec
    s_cbranch_scc1 L_rd16_ok
    s_sleep 2
    s_sub_u32 s29, s29, 1
    s_cmp_lg_u32 s29, 0
    s_cbranch_scc1 L_rd16
L_rd16_ok:

    v_readfirstlane_b32 s19, v225
    s_min_u32 s19, s19, 24
    s_branch L_rd16_go
L_rd18_slow:
    v_mov_b32 v224, 161976

    s_mov_b32 s29, 200000
L_rd18:
    ds_read_b32 v225, v224
    s_waitcnt lgkmcnt(0)
    v_cmp_le_u32 vcc, 18, v225
    s_cmp_eq_u64 vcc, exec
    s_cbranch_scc1 L_rd18_ok
    s_sleep 2
    s_sub_u32 s29, s29, 1
    s_cmp_lg_u32 s29, 0
    s_cbranch_scc1 L_rd18
L_rd18_ok:

    v_readfirstlane_b32 s19, v225
    s_min_u32 s19, s19, 24
    s_branch L_rd18_go
L_rd20_slow:
    v_mov_b32 v224, 161976

    s_mov_b32 s29, 200000
L_rd20:
    ds_read_b32 v225, v224
    s_waitcnt lgkmcnt(0)
    v_cmp_le_u32 vcc, 20, v225
    s_cmp_eq_u64 vcc, exec
    s_cbranch_scc1 L_rd20_ok
    s_sleep 2
    s_sub_u32 s29, s29, 1
    s_cmp_lg_u32 s29, 0
    s_cbranch_scc1 L_rd20
L_rd20_ok:

    v_readfirstlane_b32 s19, v225
    s_min_u32 s19, s19, 24
    s_branch L_rd20_go
L_rd22_slow:
    v_mov_b32 v224, 161976

    s_mov_b32 s29, 200000
L_rd22:
    ds_read_b32 v225, v224
    s_waitcnt lgkmcnt(0)
    v_cmp_le_u32 vcc, 22, v225
    s_cmp_eq_u64 vcc, exec
    s_cbranch_scc1 L_rd22_ok
    s_sleep 2
    s_sub_u32 s29, s29, 1
    s_cmp_lg_u32 s29, 0
    s_cbranch_scc1 L_rd22
L_rd22_ok:

    v_readfirstlane_b32 s19, v225
    s_min_u32 s19, s19, 24
    s_branch L_rd22_go
L_rd25_slow:
    v_mov_b32 v224, 161976

    s_mov_b32 s29, 200000
L_rd25:
    ds_read_b32 v225, v224
    s_waitcnt lgkmcnt(0)
    v_cmp_le_u32 vcc, 25, v225
    s_cmp_eq_u64 vcc, exec
    s_cbranch_scc1 L_rd25_ok
    s_sleep 2
    s_sub_u32 s29, s29, 1
    s_cmp_lg_u32 s29, 0
    s_cbranch_scc1 L_rd25
L_rd25_ok:

    v_readfirstlane_b32 s19, v225

    s_cmp_lt_u32 s19, 256
    s_cbranch_scc1 L_rd25_go
    s_lshl_b32 s98, s19, 15
    s_cmp_eq_u32 s98, 931135488
    s_cbranch_scc1 L_rd25_go
    s_waitcnt vmcnt(0) lgkmcnt(0)
    s_nop 7
    s_barrier
    s_cmp_lt_u32 s16, 6
    s_cbranch_scc1 L_notab

    s_add_u32 s28, s98, 8388608
    s_and_b32 s26, s16, 1
    s_lshl_b32 s26, s26, 6
    v_lshrrev_b32 v49, 4, v253
    v_add_u32 v49, s26, v49
    v_lshlrev_b32 v50, 2, v49
    v_add_u32 v51, 65536, v50
    v_lshlrev_b32_e64 v52, 17, v49
    v_or_b32 v52, 0x8000, v52
    v_cmp_gt_u32 vcc, 64, v49
    v_mov_b32 v53, s98
    v_mov_b32 v54, s28
    v_cndmask_b32 v53, v53, v54, vcc
    v_cndmask_b32 v54, 0, v54, vcc
    v_add_u32 v52, v52, v53
    v_mov_b32 v53, 0x1000000
    v_mov_b32 v55, 0x800000
    v_cndmask_b32 v53, v53, v55, vcc
    s_mov_b32 s26, 0x3dd2d3e8
    v_mov_b32 v55, 0x40135761
    s_mov_b32 s27, 14
L_tablb:
    v_add_u32 v57, 0x10000, v52
    v_sub_f32 v56, v52, v54
    v_sub_f32 v57, v57, v54
    v_mul_f32 v58, v56, v56
    v_mul_f32 v59, v57, v57
    v_fma_f32 v58, v58, s26, v55
    v_fma_f32 v59, v59, s26, v55
    v_mul_f32 v58, v58, v56
    v_mul_f32 v59, v59, v57
    v_exp_f32 v58, -v58
    v_exp_f32 v59, -v59
    s_nop 0
    v_add_f32 v60, 1.0, v58
    v_add_f32 v61, 1.0, v59
    v_rcp_f32 v60, v60
    v_rcp_f32 v61, v61
    s_nop 0
    v_mul_f32 v56, v56, v60
    v_mul_f32 v57, v57, v61
    v_mul_f32 v58, -v56, v58
    v_mul_f32 v59, -v57, v59
    v_cvt_pk_bf16_f32 v60, v56, v57
    v_cvt_pk_bf16_f32 v61, v58, v59
    ds_write_b32 v50, v60
    ds_write_b32 v51, v61
    v_add_u32_e64 v52, v52, v53
    v_mov_b32 v53, 0x1000000
    v_mov_b32_e64 v54, 0
    v_add_u32 v50, 512, v50
    v_add_u32 v51, 512, v51
    s_sub_u32 s27, s27, 1
    s_cmp_lg_u32 s27, 0
    s_cbranch_scc1 L_tablb
    v_mov_b32 v51, 65536
    ds_write_b16 v54, v54
    ds_write_b16 v51, v54

L_notab:
    s_add_u32 s83, s98, 0x3eefde6e
    s_sub_u32 s99, 1996488704, s98
    s_waitcnt lgkmcnt(0)
    s_barrier
    s_branch L_mtile

L_end:
    s_endpgm

.section .rodata,"a"

.p2align 6
.amdhsa_kernel standalone__modern_conv_block_replknet__vision_kernel
.amdhsa_next_free_vgpr 256
.amdhsa_next_free_sgpr 100
.amdhsa_accum_offset 256
.amdhsa_group_segment_fixed_size 0
.amdhsa_kernarg_size 64
.amdhsa_user_sgpr_count 2
.amdhsa_user_sgpr_kernarg_segment_ptr 1
.amdhsa_system_sgpr_workgroup_id_x 1
.amdhsa_float_denorm_mode_32 3
.end_amdhsa_kernel
```
